```python
import torch

def _softmax(x, axis=-1):
    return torch.softmax(x, dim=axis)

def _gelu(x):
    return torch.nn.functional.gelu(x, approximate='tanh')

def _silu(x):
    return torch.nn.functional.silu(x)

def _sigmoid(x):
    return torch.sigmoid(x)

def _layernorm(x, axis=-1, eps=1e-05):
    m = x.mean(dim=axis, keepdim=True)
    v = x.var(dim=axis, keepdim=True, unbiased=False)
    return (x - m) / torch.sqrt(v + eps)

def _scatter_add(tgt, idx, src, axis=0):
    return tgt.clone().index_add_(axis, idx, src)

def _segment_sum(src, seg, n):
    out = torch.zeros((n,) + src.shape[1:], dtype=src.dtype)
    return out.index_add_(0, seg, src)

def _pad(x, pw):
    flat = tuple((v for pair in reversed(pw) for v in pair))
    return torch.nn.functional.pad(x, flat)
kernel_name = 'concat_heads__spectral_gfnet__memory_aug_recurrent_mem_tr__prompt'

def setup_inputs():

    _w = lambda a: (lambda t: t.to(torch.bfloat16) if t.is_floating_point() else t)(torch.as_tensor(a))

    def _A_setup():
        B, S, D = (1, 2048, 1024)
        Df = D // 2 + 1
        return {'x': _w((lambda *s: torch.randn(*s, dtype=torch.bfloat16) * 0.05)(B, S, D)), 'w_r': _w((lambda *s: torch.randn(*s, dtype=torch.bfloat16) * 3.2)(S, Df) * 0.02), 'w_i': _w((lambda *s: torch.randn(*s, dtype=torch.bfloat16) * 3.2)(S, Df) * 0.02)}
    _A_in = _A_setup()

    def _B_setup():
        B, S, Dm = (1, 2048, 1024)
        H, Dh = (32, 128)
        M, seg = (8, 32)
        seg = min(seg, S)
        S = S // seg * seg
        return {'x': _w((lambda *s: torch.randn(*s, dtype=torch.bfloat16) * 0.05)(B, S, Dm)), 'mem0': _w((lambda *s: torch.randn(*s, dtype=torch.bfloat16) * 0.4)(B, M, Dm)), 'Wq': _w((lambda *s: torch.randn(*s, dtype=torch.bfloat16) * 6.4)(Dm, H, Dh) * Dm ** (-0.5)), 'Wk': _w((lambda *s: torch.randn(*s, dtype=torch.bfloat16) * 6.4)(Dm, H, Dh) * Dm ** (-0.5)), 'Wv': _w((lambda *s: torch.randn(*s, dtype=torch.bfloat16) * 0.4)(Dm, H, Dh) * Dm ** (-0.5)), 'Wo': _w((lambda *s: torch.randn(*s, dtype=torch.bfloat16) * 0.4)(H, Dh, Dm) * (H * Dh) ** (-0.5)), 'seg_len': seg}
    _B_in = _B_setup()
    return {'A_x': _A_in['x'], 'A_w_r': _A_in['w_r'], 'A_w_i': _A_in['w_i'], 'B_x': _B_in['x'], 'B_mem0': _B_in['mem0'], 'B_Wq': _B_in['Wq'], 'B_Wk': _B_in['Wk'], 'B_Wv': _B_in['Wv'], 'B_Wo': _B_in['Wo'], 'B_seg_len': _B_in['seg_len']}

def reference(A_x, A_w_r, A_w_i, B_x, B_mem0, B_Wq, B_Wk, B_Wv, B_Wo, B_seg_len):

    def _A_ref(x, w_r, w_i):
        B, S, D = x.shape
        X = (lambda x, axes=(-2, -1): torch.fft.rfft2(x.float(), dim=axes))(x, axes=(-2, -1))
        W = w_r + 1j * w_i
        X = X * W
        y = (lambda x, s, axes=(-2, -1): torch.fft.irfft2(x, s=s, dim=axes).to(torch.bfloat16))(X, (S, D), axes=(-2, -1))
        return y

    def _B_ref(x, mem0, Wq, Wk, Wv, Wo, seg_len):
        B, S, Dm = x.shape
        H, Dh = (Wq.shape[1], Wq.shape[2])
        M = mem0.shape[1]
        scale = Dh ** (-0.5)
        n_seg = S // seg_len
        L = M + seg_len
        idx = torch.arange(L)
        mask = (idx[:, None] < M) | (idx[:, None] >= idx[None, :])
        mem = mem0
        outs = []
        for s in range(n_seg):
            xs = x[:, s * seg_len:(s + 1) * seg_len, :].clone()
            h = torch.concatenate([mem, xs], axis=1)
            q = torch.einsum('btd,dhe->bhte', h, Wq)
            k = torch.einsum('btd,dhe->bhte', h, Wk)
            v = torch.einsum('btd,dhe->bhte', h, Wv)
            scores = torch.einsum('bhqe,bhke->bhqk', q, k) * scale
            scores = torch.where(mask[None, None], scores, -1000000000.0)
            p = _softmax(scores, axis=-1)
            o = torch.einsum('bhqk,bhke->bhqe', p, v)
            o = torch.einsum('bhte,hed->btd', o, Wo)
            mem = o[:, :M, :].clone()
            outs.append(o[:, M:, :])
        return torch.concatenate(outs, axis=1)
    a = _A_ref(A_x, A_w_r, A_w_i)
    b = _B_ref(B_x, B_mem0, B_Wq, B_Wk, B_Wv, B_Wo, B_seg_len)
    return torch.concatenate([a, b], axis=-1)
```

```asm
; @launch grid=(256,1,1) block=(512,1,1) lds=163840
.amdgcn_target "amdgcn-amd-amdhsa--gfx950"
.text
.globl concat_heads__spectral_gfnet__memory_aug_recurrent_mem_tr__prompt_kernel
.p2align 8
.type concat_heads__spectral_gfnet__memory_aug_recurrent_mem_tr__prompt_kernel,@function
concat_heads__spectral_gfnet__memory_aug_recurrent_mem_tr__prompt_kernel:
    s_load_dwordx2 s[8:9], s[0:1], 96
    s_load_dwordx2 s[12:13], s[0:1], 88
    s_load_dwordx2 s[16:17], s[0:1], 80
    s_load_dwordx2 s[20:21], s[0:1], 40
    s_load_dwordx2 s[24:25], s[0:1], 48
    s_load_dwordx2 s[28:29], s[0:1], 56
    s_load_dwordx2 s[32:33], s[0:1], 64
    s_load_dwordx2 s[36:37], s[0:1], 24
    s_load_dwordx2 s[40:41], s[0:1], 32
    s_load_dwordx2 s[44:45], s[0:1], 0
    s_load_dwordx2 s[48:49], s[0:1], 8
    s_load_dwordx2 s[52:53], s[0:1], 16
    s_mov_b32 s10, 0x10000000
    s_mov_b32 s11, 0x20000
    s_mov_b32 s14, 0x100
    s_mov_b32 s15, 0x20000
    s_mov_b32 s18, 0x800000
    s_mov_b32 s19, 0x20000
    s_mov_b32 s22, 0x800000
    s_mov_b32 s23, 0x20000
    s_mov_b32 s26, 0x800000
    s_mov_b32 s27, 0x20000
    s_mov_b32 s30, 0x800000
    s_mov_b32 s31, 0x20000
    s_mov_b32 s34, 0x800000
    s_mov_b32 s35, 0x20000
    s_mov_b32 s38, 0x400000
    s_mov_b32 s39, 0x20000
    s_mov_b32 s42, 0x4000
    s_mov_b32 s43, 0x20000
    s_mov_b32 s46, 0x400000
    s_mov_b32 s47, 0x20000
    s_mov_b32 s50, 0x201000
    s_mov_b32 s51, 0x20000
    s_mov_b32 s54, 0x201000
    s_mov_b32 s55, 0x20000
    s_waitcnt lgkmcnt(0)
    s_getreg_b32 s56, hwreg(HW_REG_XCC_ID, 0, 3)
    v_lshrrev_b32 v2, 6, v0
    v_and_b32 v1, 63, v0
    v_readfirstlane_b32 s58, v2
    s_nop 0
    s_cmp_lg_u32 s58, 0
    s_cbranch_scc1 notw0_1
    s_lshl_b32 s57, s56, 2
    v_mov_b32 v2, s57
    v_mov_b32 v3, 0x5ffffff0
    v_cmp_eq_u32 vcc, 0, v1
    s_nop 1
    v_cndmask_b32 v2, v3, v2, vcc
    v_mov_b32 v3, 1
    buffer_atomic_add v3, v2, s[12:15], 0 offen sc0 sc1
    v_mov_b32 v4, 0x27ff0
    s_waitcnt vmcnt(0)
    v_readfirstlane_b32 s3, v3
    s_nop 1
    v_mov_b32 v3, s3
    ds_write_b32 v4, v3
    s_waitcnt lgkmcnt(0)
notw0_1:
    s_barrier
    v_mov_b32 v4, 0x27ff0
    ds_read_b32 v3, v4
    s_waitcnt lgkmcnt(0)
    v_readfirstlane_b32 s57, v3
    s_nop 0
    s_cmp_lt_u32 s57, 32
    s_cbranch_scc1 go_3
    s_endpgm
go_3:
    s_cmp_ge_u32 s56, 4
    s_cbranch_scc1 bulk_2
    s_and_b32 s64, s57, 3
    s_lshr_b32 s65, s57, 2
    s_lshl_b32 s66, s56, 3
    s_add_u32 s66, s66, s65
    s_and_b32 s67, s58, 3
    s_mov_b32 s69, 0x40000
    v_and_b32 v6, 15, v1
    v_lshrrev_b32 v7, 4, v1
    v_lshlrev_b32 v8, 4, v1
    v_mov_b32 v34, -1
    v_mov_b32 v35, -1
    v_mov_b32 v36, -1
    v_mov_b32 v37, -1
    s_mov_b32 s86, 0
    s_mov_b32 s87, 0
    s_mov_b32 s88, 0
    s_mov_b32 s89, 0
    s_mov_b32 s90, 0
    s_mov_b32 s91, 0
    s_mov_b32 s92, 0
    s_mov_b32 s93, 0
    s_mov_b32 s94, 0
    s_mov_b32 s95, 0
    s_mov_b32 s96, 0
    s_mov_b32 s97, 0
    s_mov_b32 s98, 0
    v_and_b32 v2, 1, v1
    v_lshlrev_b32 v2, 4, v2
    v_mov_b32 v3, 0x3f80
    v_lshlrev_b32 v2, v2, v3
    v_lshrrev_b32 v3, 1, v6
    v_cmp_eq_u32 vcc, 0, v3
    s_nop 1
    v_cndmask_b32 v26, 0, v2, vcc
    v_cmp_eq_u32 vcc, 1, v3
    s_nop 1
    v_cndmask_b32 v27, 0, v2, vcc
    v_cmp_eq_u32 vcc, 2, v3
    s_nop 1
    v_cndmask_b32 v28, 0, v2, vcc
    v_cmp_eq_u32 vcc, 3, v3
    s_nop 1
    v_cndmask_b32 v29, 0, v2, vcc
    v_cmp_eq_u32 vcc, 4, v3
    s_nop 1
    v_cndmask_b32 v30, 0, v2, vcc
    v_cmp_eq_u32 vcc, 5, v3
    s_nop 1
    v_cndmask_b32 v31, 0, v2, vcc
    v_cmp_eq_u32 vcc, 6, v3
    s_nop 1
    v_cndmask_b32 v32, 0, v2, vcc
    v_cmp_eq_u32 vcc, 7, v3
    s_nop 1
    v_cndmask_b32 v33, 0, v2, vcc
    v_bfe_u32 v9, v1, 0, 4
    v_lshlrev_b32 v9, 4, v9
    v_bfe_u32 v2, v1, 4, 1
    v_lshl_or_b32 v9, v2, 3, v9
    v_bfe_u32 v2, v1, 5, 1
    v_lshl_or_b32 v9, v2, 8, v9
    s_lshl_b32 s70, s58, 9
    v_add_u32 v9, s70, v9
    v_mov_b32 v5, 0x5ffffff0
    v_bfe_u32 v3, v1, 0, 3
    v_lshlrev_b32 v3, 4, v3
    v_bfe_u32 v2, v1, 4, 1
    v_lshl_or_b32 v3, v2, 3, v3
    v_and_b32 v2, 0x28, v1
    v_cmp_eq_u32 vcc, 0, v2
    s_nop 1
    v_cndmask_b32 v47, v5, v3, vcc
    v_bfe_u32 v3, v1, 0, 4
    v_lshlrev_b32 v3, 4, v3
    v_bfe_u32 v2, v1, 4, 2
    v_lshl_or_b32 v3, v2, 10, v3
    v_cmp_gt_u32 vcc, 8, v6
    s_nop 1
    v_cndmask_b32 v48, v5, v3, vcc
    s_lshl_b32 s70, s56, 2
    s_add_u32 s70, s70, s64
    s_lshl_b32 s70, s70, 15
    s_add_u32 s70, s70, 0x4a00000
    s_lshl_b32 s71, s65, 2
    s_add_u32 s71, s71, s67
    s_lshl_b32 s72, s71, 10
    s_add_u32 s79, s70, s72
    s_lshl_b32 s72, s67, 13
    s_add_u32 s80, s70, s72
    s_lshl_b32 s72, s65, 7
    s_add_u32 s80, s80, s72
    s_bfe_u32 s78, s71, 0x40000
    s_lshl_b32 s78, s78, 10
    s_bfe_u32 s72, s71, 0x10004
    s_lshl_b32 s72, s72, 7
    s_or_b32 s78, s78, s72
    s_lshl_b32 s72, s56, 8
    s_add_u32 s78, s78, s72
    s_lshl_b32 s72, s64, 14
    s_add_u32 s72, s72, 0x4c10000
    s_add_u32 s78, s78, s72
    s_lshl_b32 s77, s58, 11
    s_add_u32 s77, s77, s72
    s_lshl_b32 s70, s66, 2
    s_add_u32 s70, s70, s67
    s_lshl_b32 s75, s70, 11
    s_add_u32 s75, s75, 0x4900000
    s_lshl_b32 s71, s56, 5
    s_add_u32 s71, s71, s57
    s_lshl_b32 s71, s71, 3
    s_add_u32 s71, s71, s58
    s_lshl_b32 s71, s71, 12
    s_add_u32 s71, s71, 0x4c00000
    buffer_store_dwordx4 v[34:37], v8, s[8:11], s71 offen offset:0 sc1
    buffer_store_dwordx4 v[34:37], v8, s[8:11], s71 offen offset:1024 sc1
    buffer_store_dwordx4 v[34:37], v8, s[8:11], s71 offen offset:2048 sc1
    buffer_store_dwordx4 v[34:37], v8, s[8:11], s71 offen offset:3072 sc1
    s_cmp_ge_u32 s58, 4
    s_cbranch_scc1 vo_arm_4
    s_lshl_b32 s73, s70, 12
    s_add_u32 s73, s73, 0x4800000
    v_bfe_u32 v46, v1, 0, 4
    v_lshlrev_b32 v46, 4, v46
    v_bfe_u32 v2, v1, 4, 2
    v_lshl_or_b32 v46, v2, 10, v46
    s_lshl_b32 s71, s64, 8
    v_add_u32 v46, s71, v46
    s_add_u32 s71, s73, 0x80000
    buffer_store_dwordx4 v[34:37], v46, s[8:11], s73 offen
    buffer_store_dwordx4 v[34:37], v46, s[8:11], s71 offen
    s_branch arm_done_5
vo_arm_4:
    s_mov_b32 s73, s75
    v_bfe_u32 v46, v1, 0, 4
    v_lshlrev_b32 v46, 4, v46
    v_bfe_u32 v2, v1, 4, 1
    v_lshl_or_b32 v46, v2, 8, v46
    v_bfe_u32 v2, v1, 5, 1
    v_lshl_or_b32 v46, v2, 10, v46
    s_bfe_u32 s71, s64, 0x10000
    s_lshl_b32 s71, s71, 3
    s_bfe_u32 s72, s64, 0x10001
    s_lshl_b32 s72, s72, 9
    s_or_b32 s71, s71, s72
    v_add_u32 v46, s71, v46
    s_add_u32 s71, s73, 0x40000
    buffer_store_dwordx2 v[34:35], v46, s[8:11], s73 offen
    buffer_store_dwordx2 v[34:35], v46, s[8:11], s71 offen
    s_add_u32 s71, s80, 0x0
    buffer_store_dwordx4 v[34:37], v48, s[8:11], s71 offen
    s_add_u32 s71, s80, 0x1000
    buffer_store_dwordx4 v[34:37], v48, s[8:11], s71 offen
    s_add_u32 s71, s80, 0x80000
    buffer_store_dwordx4 v[34:37], v48, s[8:11], s71 offen
    s_add_u32 s71, s80, 0x81000
    buffer_store_dwordx4 v[34:37], v48, s[8:11], s71 offen
arm_done_5:
    v_bfe_u32 v2, v1, 4, 1
    v_bfe_u32 v3, v1, 5, 1
    v_lshl_or_b32 v2, v3, 2, v2
    v_xor_b32 v2, v2, v6
    v_lshlrev_b32 v2, 4, v2
    v_lshl_add_u32 v49, v7, 13, v2
    v_xor_b32 v50, 0x80, v49
    v_lshrrev_b32 v3, 5, v1
    v_and_b32 v2, 31, v1
    v_lshlrev_b32 v4, 1, v3
    v_xor_b32 v2, v2, v4
    v_lshlrev_b32 v2, 4, v2
    v_lshl_add_u32 v51, v3, 11, v2
    v_bfe_u32 v4, v1, 2, 1
    v_lshlrev_b32 v4, 4, v4
    v_bfe_u32 v2, v1, 3, 1
    v_lshl_or_b32 v4, v2, 6, v4
    v_bfe_u32 v2, v1, 4, 1
    v_lshl_or_b32 v4, v2, 7, v4
    v_bfe_u32 v2, v1, 2, 2
    v_lshl_or_b32 v4, v2, 8, v4
    v_bfe_u32 v2, v1, 4, 2
    v_lshl_or_b32 v4, v2, 11, v4
    s_lshl_b32 s71, s67, 6
    v_xor_b32 v4, s71, v4
    v_bfe_u32 v3, v1, 0, 1
    v_lshlrev_b32 v3, 5, v3
    v_bfe_u32 v2, v1, 1, 1
    v_lshl_or_b32 v3, v2, 4, v3
    v_xor_b32 v52, v3, v4
    v_bfe_u32 v3, v1, 0, 1
    v_lshlrev_b32 v3, 3, v3
    v_bfe_u32 v2, v1, 1, 1
    v_lshl_or_b32 v3, v2, 5, v3
    v_xor_b32 v53, v3, v4
    v_bfe_u32 v4, v1, 2, 3
    v_lshlrev_b32 v4, 5, v4
    v_bfe_u32 v2, v1, 2, 3
    v_lshl_or_b32 v4, v2, 9, v4
    v_bfe_u32 v2, v1, 5, 1
    v_lshl_or_b32 v4, v2, 13, v4
    v_bfe_u32 v3, v1, 0, 2
    v_lshlrev_b32 v3, 4, v3
    v_xor_b32 v4, v3, v4
    s_lshl_b32 s71, s67, 7
    s_or_b32 s71, s71, 0x10000
    v_xor_b32 v54, s71, v4
    s_lshl_b32 s70, s64, 21
    s_lshl_b32 s71, s58, 18
    s_add_u32 s70, s70, s71
    s_lshl_b32 s71, s66, 8
    s_add_u32 s70, s70, s71
    s_lshl_b32 s71, s58, 13
    s_add_u32 s71, s71, 0
    s_mov_b32 m0, s71
    s_nop 0
    buffer_load_dwordx4 v49, s[20:23], s70 offen lds
    s_add_u32 s70, s70, 0x8000
    s_add_u32 s71, s71, 0x400
    s_mov_b32 m0, s71
    s_nop 0
    buffer_load_dwordx4 v49, s[20:23], s70 offen lds
    s_add_u32 s70, s70, 0x8000
    s_add_u32 s71, s71, 0x400
    s_mov_b32 m0, s71
    s_nop 0
    buffer_load_dwordx4 v50, s[20:23], s70 offen lds
    s_add_u32 s70, s70, 0x8000
    s_add_u32 s71, s71, 0x400
    s_mov_b32 m0, s71
    s_nop 0
    buffer_load_dwordx4 v50, s[20:23], s70 offen lds
    s_add_u32 s70, s70, 0x8000
    s_add_u32 s71, s71, 0x400
    s_mov_b32 m0, s71
    s_nop 0
    buffer_load_dwordx4 v49, s[20:23], s70 offen lds
    s_add_u32 s70, s70, 0x8000
    s_add_u32 s71, s71, 0x400
    s_mov_b32 m0, s71
    s_nop 0
    buffer_load_dwordx4 v49, s[20:23], s70 offen lds
    s_add_u32 s70, s70, 0x8000
    s_add_u32 s71, s71, 0x400
    s_mov_b32 m0, s71
    s_nop 0
    buffer_load_dwordx4 v50, s[20:23], s70 offen lds
    s_add_u32 s70, s70, 0x8000
    s_add_u32 s71, s71, 0x400
    s_mov_b32 m0, s71
    s_nop 0
    buffer_load_dwordx4 v50, s[20:23], s70 offen lds
    s_add_u32 s70, s70, 0x8000
    s_add_u32 s71, s71, 0x400
    s_lshl_b32 s70, s64, 21
    s_lshl_b32 s71, s58, 18
    s_add_u32 s70, s70, s71
    s_lshl_b32 s71, s66, 8
    s_add_u32 s70, s70, s71
    s_lshl_b32 s71, s58, 13
    s_add_u32 s71, s71, 65536
    s_mov_b32 m0, s71
    s_nop 0
    buffer_load_dwordx4 v49, s[24:27], s70 offen lds
    s_add_u32 s70, s70, 0x8000
    s_add_u32 s71, s71, 0x400
    s_mov_b32 m0, s71
    s_nop 0
    buffer_load_dwordx4 v49, s[24:27], s70 offen lds
    s_add_u32 s70, s70, 0x8000
    s_add_u32 s71, s71, 0x400
    s_mov_b32 m0, s71
    s_nop 0
    buffer_load_dwordx4 v50, s[24:27], s70 offen lds
    s_add_u32 s70, s70, 0x8000
    s_add_u32 s71, s71, 0x400
    s_mov_b32 m0, s71
    s_nop 0
    buffer_load_dwordx4 v50, s[24:27], s70 offen lds
    s_add_u32 s70, s70, 0x8000
    s_add_u32 s71, s71, 0x400
    s_mov_b32 m0, s71
    s_nop 0
    buffer_load_dwordx4 v49, s[24:27], s70 offen lds
    s_add_u32 s70, s70, 0x8000
    s_add_u32 s71, s71, 0x400
    s_mov_b32 m0, s71
    s_nop 0
    buffer_load_dwordx4 v49, s[24:27], s70 offen lds
    s_add_u32 s70, s70, 0x8000
    s_add_u32 s71, s71, 0x400
    s_mov_b32 m0, s71
    s_nop 0
    buffer_load_dwordx4 v50, s[24:27], s70 offen lds
    s_add_u32 s70, s70, 0x8000
    s_add_u32 s71, s71, 0x400
    s_mov_b32 m0, s71
    s_nop 0
    buffer_load_dwordx4 v50, s[24:27], s70 offen lds
    s_add_u32 s70, s70, 0x8000
    s_add_u32 s71, s71, 0x400
    s_waitcnt vmcnt(8)
    s_barrier
    s_cmp_lg_u32 s58, 4
    s_cbranch_scc1 nosig_6
    v_mov_b32 v2, 1
    v_cmp_eq_u32 vcc, 0, v1
    v_mov_b32 v3, 32
    v_mov_b32 v4, 0x5ffffff0
    v_cndmask_b32 v3, v4, v3, vcc
    buffer_atomic_add v2, v3, s[12:15], 0 offen sc1
    s_waitcnt vmcnt(0)
nosig_6:
    s_cmp_ge_u32 s58, 4
    s_cbranch_scc1 skip_7
    v_add_u32 v2, 0, v52
    v_xor_b32 v3, 8, v2
    ds_read_b64_tr_b16 v[128:129], v2 offset:0
    ds_read_b64_tr_b16 v[130:131], v2 offset:1024
    ds_read_b64_tr_b16 v[132:133], v2 offset:8192
    ds_read_b64_tr_b16 v[134:135], v2 offset:9216
    ds_read_b64_tr_b16 v[136:137], v2 offset:16384
    ds_read_b64_tr_b16 v[138:139], v2 offset:17408
    ds_read_b64_tr_b16 v[140:141], v2 offset:24576
    ds_read_b64_tr_b16 v[142:143], v2 offset:25600
    ds_read_b64_tr_b16 v[144:145], v2 offset:32768
    ds_read_b64_tr_b16 v[146:147], v2 offset:33792
    ds_read_b64_tr_b16 v[148:149], v2 offset:40960
    ds_read_b64_tr_b16 v[150:151], v2 offset:41984
    ds_read_b64_tr_b16 v[152:153], v2 offset:49152
    ds_read_b64_tr_b16 v[154:155], v2 offset:50176
    ds_read_b64_tr_b16 v[156:157], v2 offset:57344
    ds_read_b64_tr_b16 v[158:159], v2 offset:58368
    s_waitcnt lgkmcnt(0)
    ds_read_b64_tr_b16 v[160:161], v3 offset:0
    ds_read_b64_tr_b16 v[162:163], v3 offset:1024
    ds_read_b64_tr_b16 v[164:165], v3 offset:8192
    ds_read_b64_tr_b16 v[166:167], v3 offset:9216
    ds_read_b64_tr_b16 v[168:169], v3 offset:16384
    ds_read_b64_tr_b16 v[170:171], v3 offset:17408
    ds_read_b64_tr_b16 v[172:173], v3 offset:24576
    ds_read_b64_tr_b16 v[174:175], v3 offset:25600
    ds_read_b64_tr_b16 v[176:177], v3 offset:32768
    ds_read_b64_tr_b16 v[178:179], v3 offset:33792
    ds_read_b64_tr_b16 v[180:181], v3 offset:40960
    ds_read_b64_tr_b16 v[182:183], v3 offset:41984
    ds_read_b64_tr_b16 v[184:185], v3 offset:49152
    ds_read_b64_tr_b16 v[186:187], v3 offset:50176
    ds_read_b64_tr_b16 v[188:189], v3 offset:57344
    ds_read_b64_tr_b16 v[190:191], v3 offset:58368
    s_waitcnt lgkmcnt(0)
skip_7:
    s_barrier
    s_lshl_b32 s70, s64, 21
    s_lshl_b32 s71, s58, 18
    s_add_u32 s70, s70, s71
    s_lshl_b32 s71, s66, 8
    s_add_u32 s70, s70, s71
    s_lshl_b32 s71, s58, 13
    s_add_u32 s71, s71, 0
    s_mov_b32 m0, s71
    s_nop 0
    buffer_load_dwordx4 v49, s[28:31], s70 offen lds
    s_add_u32 s70, s70, 0x8000
    s_add_u32 s71, s71, 0x400
    s_mov_b32 m0, s71
    s_nop 0
    buffer_load_dwordx4 v49, s[28:31], s70 offen lds
    s_add_u32 s70, s70, 0x8000
    s_add_u32 s71, s71, 0x400
    s_mov_b32 m0, s71
    s_nop 0
    buffer_load_dwordx4 v50, s[28:31], s70 offen lds
    s_add_u32 s70, s70, 0x8000
    s_add_u32 s71, s71, 0x400
    s_mov_b32 m0, s71
    s_nop 0
    buffer_load_dwordx4 v50, s[28:31], s70 offen lds
    s_add_u32 s70, s70, 0x8000
    s_add_u32 s71, s71, 0x400
    s_mov_b32 m0, s71
    s_nop 0
    buffer_load_dwordx4 v49, s[28:31], s70 offen lds
    s_add_u32 s70, s70, 0x8000
    s_add_u32 s71, s71, 0x400
    s_mov_b32 m0, s71
    s_nop 0
    buffer_load_dwordx4 v49, s[28:31], s70 offen lds
    s_add_u32 s70, s70, 0x8000
    s_add_u32 s71, s71, 0x400
    s_mov_b32 m0, s71
    s_nop 0
    buffer_load_dwordx4 v50, s[28:31], s70 offen lds
    s_add_u32 s70, s70, 0x8000
    s_add_u32 s71, s71, 0x400
    s_mov_b32 m0, s71
    s_nop 0
    buffer_load_dwordx4 v50, s[28:31], s70 offen lds
    s_add_u32 s70, s70, 0x8000
    s_add_u32 s71, s71, 0x400
    s_waitcnt vmcnt(8)
    s_barrier
    s_cmp_ge_u32 s58, 4
    s_cbranch_scc1 skip_8
    v_add_u32 v2, 65536, v52
    v_xor_b32 v3, 8, v2
    ds_read_b64_tr_b16 v[192:193], v2 offset:0
    ds_read_b64_tr_b16 v[194:195], v2 offset:1024
    ds_read_b64_tr_b16 v[196:197], v2 offset:8192
    ds_read_b64_tr_b16 v[198:199], v2 offset:9216
    ds_read_b64_tr_b16 v[200:201], v2 offset:16384
    ds_read_b64_tr_b16 v[202:203], v2 offset:17408
    ds_read_b64_tr_b16 v[204:205], v2 offset:24576
    ds_read_b64_tr_b16 v[206:207], v2 offset:25600
    ds_read_b64_tr_b16 v[208:209], v2 offset:32768
    ds_read_b64_tr_b16 v[210:211], v2 offset:33792
    ds_read_b64_tr_b16 v[212:213], v2 offset:40960
    ds_read_b64_tr_b16 v[214:215], v2 offset:41984
    ds_read_b64_tr_b16 v[216:217], v2 offset:49152
    ds_read_b64_tr_b16 v[218:219], v2 offset:50176
    ds_read_b64_tr_b16 v[220:221], v2 offset:57344
    ds_read_b64_tr_b16 v[222:223], v2 offset:58368
    s_waitcnt lgkmcnt(0)
    ds_read_b64_tr_b16 v[224:225], v3 offset:0
    ds_read_b64_tr_b16 v[226:227], v3 offset:1024
    ds_read_b64_tr_b16 v[228:229], v3 offset:8192
    ds_read_b64_tr_b16 v[230:231], v3 offset:9216
    ds_read_b64_tr_b16 v[232:233], v3 offset:16384
    ds_read_b64_tr_b16 v[234:235], v3 offset:17408
    ds_read_b64_tr_b16 v[236:237], v3 offset:24576
    ds_read_b64_tr_b16 v[238:239], v3 offset:25600
    ds_read_b64_tr_b16 v[240:241], v3 offset:32768
    ds_read_b64_tr_b16 v[242:243], v3 offset:33792
    ds_read_b64_tr_b16 v[244:245], v3 offset:40960
    ds_read_b64_tr_b16 v[246:247], v3 offset:41984
    ds_read_b64_tr_b16 v[248:249], v3 offset:49152
    ds_read_b64_tr_b16 v[250:251], v3 offset:50176
    ds_read_b64_tr_b16 v[252:253], v3 offset:57344
    ds_read_b64_tr_b16 v[254:255], v3 offset:58368
    s_waitcnt lgkmcnt(0)
skip_8:
    s_barrier
    s_lshl_b32 s70, s66, 18
    s_lshl_b32 s71, s58, 15
    s_add_u32 s70, s70, s71
    s_lshl_b32 s71, s64, 9
    s_add_u32 s70, s70, s71
    s_lshl_b32 s71, s58, 13
    s_add_u32 s71, s71, 65536
    s_mov_b32 m0, s71
    v_xor_b32 v2, 0, v51
    buffer_load_dwordx4 v2, s[32:35], s70 offen lds
    s_add_u32 s70, s70, 0x1000
    s_add_u32 s71, s71, 0x400
    s_mov_b32 m0, s71
    v_xor_b32 v2, 64, v51
    buffer_load_dwordx4 v2, s[32:35], s70 offen lds
    s_add_u32 s70, s70, 0x1000
    s_add_u32 s71, s71, 0x400
    s_mov_b32 m0, s71
    v_xor_b32 v2, 128, v51
    buffer_load_dwordx4 v2, s[32:35], s70 offen lds
    s_add_u32 s70, s70, 0x1000
    s_add_u32 s71, s71, 0x400
    s_mov_b32 m0, s71
    v_xor_b32 v2, 192, v51
    buffer_load_dwordx4 v2, s[32:35], s70 offen lds
    s_add_u32 s70, s70, 0x1000
    s_add_u32 s71, s71, 0x400
    s_mov_b32 m0, s71
    v_xor_b32 v2, 0, v51
    buffer_load_dwordx4 v2, s[32:35], s70 offen lds
    s_add_u32 s70, s70, 0x1000
    s_add_u32 s71, s71, 0x400
    s_mov_b32 m0, s71
    v_xor_b32 v2, 64, v51
    buffer_load_dwordx4 v2, s[32:35], s70 offen lds
    s_add_u32 s70, s70, 0x1000
    s_add_u32 s71, s71, 0x400
    s_mov_b32 m0, s71
    v_xor_b32 v2, 128, v51
    buffer_load_dwordx4 v2, s[32:35], s70 offen lds
    s_add_u32 s70, s70, 0x1000
    s_add_u32 s71, s71, 0x400
    s_mov_b32 m0, s71
    v_xor_b32 v2, 192, v51
    buffer_load_dwordx4 v2, s[32:35], s70 offen lds
    s_add_u32 s70, s70, 0x1000
    s_add_u32 s71, s71, 0x400
    s_waitcnt vmcnt(8)
    s_barrier
    s_cmp_ge_u32 s58, 4
    s_cbranch_scc0 skip_9
    v_add_u32 v2, 0, v53
    v_xor_b32 v3, 16, v2
    ds_read_b64_tr_b16 v[128:129], v2 offset:0
    ds_read_b64_tr_b16 v[130:131], v2 offset:1024
    ds_read_b64_tr_b16 v[132:133], v2 offset:8192
    ds_read_b64_tr_b16 v[134:135], v2 offset:9216
    ds_read_b64_tr_b16 v[136:137], v2 offset:16384
    ds_read_b64_tr_b16 v[138:139], v2 offset:17408
    ds_read_b64_tr_b16 v[140:141], v2 offset:24576
    ds_read_b64_tr_b16 v[142:143], v2 offset:25600
    ds_read_b64_tr_b16 v[144:145], v2 offset:32768
    ds_read_b64_tr_b16 v[146:147], v2 offset:33792
    ds_read_b64_tr_b16 v[148:149], v2 offset:40960
    ds_read_b64_tr_b16 v[150:151], v2 offset:41984
    ds_read_b64_tr_b16 v[152:153], v2 offset:49152
    ds_read_b64_tr_b16 v[154:155], v2 offset:50176
    ds_read_b64_tr_b16 v[156:157], v2 offset:57344
    ds_read_b64_tr_b16 v[158:159], v2 offset:58368
    s_waitcnt lgkmcnt(0)
    ds_read_b64_tr_b16 v[160:161], v3 offset:0
    ds_read_b64_tr_b16 v[162:163], v3 offset:1024
    ds_read_b64_tr_b16 v[164:165], v3 offset:8192
    ds_read_b64_tr_b16 v[166:167], v3 offset:9216
    ds_read_b64_tr_b16 v[168:169], v3 offset:16384
    ds_read_b64_tr_b16 v[170:171], v3 offset:17408
    ds_read_b64_tr_b16 v[172:173], v3 offset:24576
    ds_read_b64_tr_b16 v[174:175], v3 offset:25600
    ds_read_b64_tr_b16 v[176:177], v3 offset:32768
    ds_read_b64_tr_b16 v[178:179], v3 offset:33792
    ds_read_b64_tr_b16 v[180:181], v3 offset:40960
    ds_read_b64_tr_b16 v[182:183], v3 offset:41984
    ds_read_b64_tr_b16 v[184:185], v3 offset:49152
    ds_read_b64_tr_b16 v[186:187], v3 offset:50176
    ds_read_b64_tr_b16 v[188:189], v3 offset:57344
    ds_read_b64_tr_b16 v[190:191], v3 offset:58368
    s_waitcnt lgkmcnt(0)
skip_9:
    s_waitcnt vmcnt(0)
    s_barrier
    s_cmp_ge_u32 s58, 4
    s_cbranch_scc0 skip_10
    v_xor_b32 v2, 0, v54
    ds_read_b64_tr_b16 v[192:193], v2 offset:0
    ds_read_b64_tr_b16 v[194:195], v2 offset:4096
    ds_read_b64_tr_b16 v[196:197], v2 offset:16384
    ds_read_b64_tr_b16 v[198:199], v2 offset:20480
    ds_read_b64_tr_b16 v[200:201], v2 offset:32768
    ds_read_b64_tr_b16 v[202:203], v2 offset:36864
    ds_read_b64_tr_b16 v[204:205], v2 offset:49152
    ds_read_b64_tr_b16 v[206:207], v2 offset:53248
    s_waitcnt lgkmcnt(0)
    v_xor_b32 v2, 8, v54
    ds_read_b64_tr_b16 v[208:209], v2 offset:0
    ds_read_b64_tr_b16 v[210:211], v2 offset:4096
    ds_read_b64_tr_b16 v[212:213], v2 offset:16384
    ds_read_b64_tr_b16 v[214:215], v2 offset:20480
    ds_read_b64_tr_b16 v[216:217], v2 offset:32768
    ds_read_b64_tr_b16 v[218:219], v2 offset:36864
    ds_read_b64_tr_b16 v[220:221], v2 offset:49152
    ds_read_b64_tr_b16 v[222:223], v2 offset:53248
    s_waitcnt lgkmcnt(0)
    v_xor_b32 v2, 64, v54
    ds_read_b64_tr_b16 v[224:225], v2 offset:0
    ds_read_b64_tr_b16 v[226:227], v2 offset:4096
    ds_read_b64_tr_b16 v[228:229], v2 offset:16384
    ds_read_b64_tr_b16 v[230:231], v2 offset:20480
    ds_read_b64_tr_b16 v[232:233], v2 offset:32768
    ds_read_b64_tr_b16 v[234:235], v2 offset:36864
    ds_read_b64_tr_b16 v[236:237], v2 offset:49152
    ds_read_b64_tr_b16 v[238:239], v2 offset:53248
    s_waitcnt lgkmcnt(0)
    v_xor_b32 v2, 72, v54
    ds_read_b64_tr_b16 v[240:241], v2 offset:0
    ds_read_b64_tr_b16 v[242:243], v2 offset:4096
    ds_read_b64_tr_b16 v[244:245], v2 offset:16384
    ds_read_b64_tr_b16 v[246:247], v2 offset:20480
    ds_read_b64_tr_b16 v[248:249], v2 offset:32768
    ds_read_b64_tr_b16 v[250:251], v2 offset:36864
    ds_read_b64_tr_b16 v[252:253], v2 offset:49152
    ds_read_b64_tr_b16 v[254:255], v2 offset:53248
    s_waitcnt lgkmcnt(0)
skip_10:
    v_mov_b32 v3, 32
armwait_11:
    buffer_load_dword v2, v3, s[12:15], 0 offen sc1
    s_waitcnt vmcnt(0)
    v_cmp_gt_u32 vcc, 256, v2
    s_cbranch_vccz armwait_ok_12
    s_sub_u32 s69, s69, 1
    s_cbranch_scc0 armwait_11
    s_mov_b32 s69, 0
armwait_ok_12:
    s_barrier
    v_bfe_u32 v2, v1, 0, 3
    v_lshlrev_b32 v2, 11, v2
    v_bfe_u32 v3, v1, 3, 1
    v_lshl_or_b32 v2, v3, 8, v2
    v_bfe_u32 v3, v1, 4, 1
    v_lshl_or_b32 v2, v3, 3, v2
    v_bfe_u32 v3, v1, 5, 1
    v_lshl_or_b32 v2, v3, 4, v2
    s_lshl_b32 s70, s64, 9
    s_lshl_b32 s71, s58, 5
    s_add_u32 s70, s70, s71
    buffer_load_dwordx2 v[42:43], v2, s[40:43], s70 offen
    s_mov_b32 s68, 0
    s_mov_b32 s83, 0
    s_mov_b32 s74, s73
    s_cmp_ge_u32 s58, 4
    s_cbranch_scc1 vo_main_13
    s_setprio 3
    v_bfe_u32 v121, v1, 0, 3
    v_lshlrev_b32 v121, 4, v121
    v_bfe_u32 v2, v1, 3, 1
    v_lshl_or_b32 v121, v2, 8, v121
    v_bfe_u32 v2, v1, 4, 2
    v_lshl_or_b32 v121, v2, 9, v121
    s_lshl_b32 s76, s66, 13
    s_lshl_b32 s70, s67, 11
    s_add_u32 s76, s76, s70
    s_add_u32 s76, s76, 0x1000000
    s_add_u32 s70, s70, 20992
    v_add_u32 v122, s70, v8
    v_mov_b32 v124, 128
    v_mov_b32 v3, 128
kv0_15:
    buffer_load_dword v123, v124, s[12:15], 0 offen sc1
    s_waitcnt vmcnt(0)
    v_cmp_gt_u32 vcc, v3, v123
    s_cbranch_vccz kv0_ok_16
    s_sub_u32 s69, s69, 1
    s_cbranch_scc0 kv0_15
    s_mov_b32 s69, 0
kv0_ok_16:
    s_add_u32 s70, s76, 0x1000000
    buffer_load_dwordx4 v[94:97], v121, s[8:11], s76 offen sc1
    buffer_load_dwordx4 v[98:101], v121, s[8:11], s76 offen offset:128 sc1
    buffer_load_dwordx4 v[102:105], v121, s[8:11], s70 offen sc1
    buffer_load_dwordx4 v[106:109], v121, s[8:11], s70 offen offset:128 sc1
    s_add_u32 s76, s76, 0x40000
    s_lshl_b32 s81, s66, 11
    s_lshl_b32 s70, s67, 9
    s_add_u32 s81, s81, s70
    s_add_u32 s81, s81, 0x4000000
    s_mul_i32 s70, s67, 3136
    s_add_u32 s70, s70, 4096
    v_add_u32 v118, s70, v8
    v_bfe_u32 v2, v1, 0, 3
    v_lshlrev_b32 v2, 4, v2
    v_bfe_u32 v3, v1, 4, 2
    v_lshl_or_b32 v2, v3, 7, v2
    v_mov_b32 v3, 0x5ffffff0
    v_cmp_le_u32 vcc, 8, v6
    s_nop 1
    v_cndmask_b32 v119, v3, v2, vcc
    v_bfe_u32 v120, v1, 0, 3
    v_lshlrev_b32 v120, 3, v120
    v_bfe_u32 v2, v1, 3, 1
    v_lshl_or_b32 v120, v2, 7, v120
    v_bfe_u32 v2, v1, 5, 1
    v_lshl_or_b32 v120, v2, 6, v120
    v_bfe_u32 v2, v1, 4, 1
    v_lshl_or_b32 v120, v2, 8, v120
    v_and_b32 v2, 1, v1
    v_lshlrev_b32 v2, 4, v2
    v_mov_b32 v3, 0x3f80
    v_lshlrev_b32 v2, v2, v3
    v_bfe_u32 v3, v1, 1, 3
    v_bfe_u32 v4, v1, 4, 1
    v_lshlrev_b32 v4, 1, v4
    v_xor_b32 v3, v3, v4
    v_cmp_eq_u32 vcc, 0, v3
    s_nop 1
    v_cndmask_b32 v110, 0, v2, vcc
    v_cndmask_b32 v112, 0, v2, vcc
    v_cmp_eq_u32 vcc, 1, v3
    s_nop 1
    v_cndmask_b32 v111, 0, v2, vcc
    v_cndmask_b32 v113, 0, v2, vcc
    v_cmp_eq_u32 vcc, 4, v3
    s_nop 1
    v_cndmask_b32 v114, 0, v2, vcc
    v_cndmask_b32 v116, 0, v2, vcc
    v_cmp_eq_u32 vcc, 5, v3
    s_nop 1
    v_cndmask_b32 v115, 0, v2, vcc
    v_cndmask_b32 v117, 0, v2, vcc
    s_waitcnt vmcnt(0)
    ds_write_b128 v122, v[102:105]
    ds_write_b128 v122, v[106:109] offset:1024
qk_loop_17:
    s_nop 3
    ds_write_b64 v9, v[42:43] offset:0
    s_waitcnt lgkmcnt(0)
    s_barrier
    ds_read_b128 v[10:13], v8 offset:0
    ds_read_b128 v[14:17], v8 offset:1024
    ds_read_b128 v[18:21], v8 offset:2048
    ds_read_b128 v[22:25], v8 offset:3072
    s_waitcnt lgkmcnt(3)
    v_mfma_f32_16x16x32_bf16 v[50:53], v[128:131], v[10:13], 0
    v_mfma_f32_16x16x32_bf16 v[54:57], v[144:147], v[10:13], 0
    v_mfma_f32_16x16x32_bf16 v[58:61], v[160:163], v[10:13], 0
    v_mfma_f32_16x16x32_bf16 v[62:65], v[176:179], v[10:13], 0
    v_mfma_f32_16x16x32_bf16 v[66:69], v[192:195], v[10:13], 0
    v_mfma_f32_16x16x32_bf16 v[70:73], v[208:211], v[10:13], 0
    v_mfma_f32_16x16x32_bf16 v[74:77], v[224:227], v[10:13], 0
    v_mfma_f32_16x16x32_bf16 v[78:81], v[240:243], v[10:13], 0
    s_waitcnt lgkmcnt(2)
    v_mfma_f32_16x16x32_bf16 v[50:53], v[132:135], v[14:17], v[50:53]
    v_mfma_f32_16x16x32_bf16 v[54:57], v[148:151], v[14:17], v[54:57]
    v_mfma_f32_16x16x32_bf16 v[58:61], v[164:167], v[14:17], v[58:61]
    v_mfma_f32_16x16x32_bf16 v[62:65], v[180:183], v[14:17], v[62:65]
    v_mfma_f32_16x16x32_bf16 v[66:69], v[196:199], v[14:17], v[66:69]
    v_mfma_f32_16x16x32_bf16 v[70:73], v[212:215], v[14:17], v[70:73]
    v_mfma_f32_16x16x32_bf16 v[74:77], v[228:231], v[14:17], v[74:77]
    v_mfma_f32_16x16x32_bf16 v[78:81], v[244:247], v[14:17], v[78:81]
    s_waitcnt lgkmcnt(1)
    v_mfma_f32_16x16x32_bf16 v[50:53], v[136:139], v[18:21], v[50:53]
    v_mfma_f32_16x16x32_bf16 v[54:57], v[152:155], v[18:21], v[54:57]
    v_mfma_f32_16x16x32_bf16 v[58:61], v[168:171], v[18:21], v[58:61]
    v_mfma_f32_16x16x32_bf16 v[62:65], v[184:187], v[18:21], v[62:65]
    v_mfma_f32_16x16x32_bf16 v[66:69], v[200:203], v[18:21], v[66:69]
    v_mfma_f32_16x16x32_bf16 v[70:73], v[216:219], v[18:21], v[70:73]
    v_mfma_f32_16x16x32_bf16 v[74:77], v[232:235], v[18:21], v[74:77]
    v_mfma_f32_16x16x32_bf16 v[78:81], v[248:251], v[18:21], v[78:81]
    s_waitcnt lgkmcnt(0)
    v_mfma_f32_16x16x32_bf16 v[50:53], v[140:143], v[22:25], v[50:53]
    v_mfma_f32_16x16x32_bf16 v[54:57], v[156:159], v[22:25], v[54:57]
    v_mfma_f32_16x16x32_bf16 v[58:61], v[172:175], v[22:25], v[58:61]
    v_mfma_f32_16x16x32_bf16 v[62:65], v[188:191], v[22:25], v[62:65]
    v_mfma_f32_16x16x32_bf16 v[66:69], v[204:207], v[22:25], v[66:69]
    v_mfma_f32_16x16x32_bf16 v[70:73], v[220:223], v[22:25], v[70:73]
    v_mfma_f32_16x16x32_bf16 v[74:77], v[236:239], v[22:25], v[74:77]
    v_mfma_f32_16x16x32_bf16 v[78:81], v[252:255], v[22:25], v[78:81]
    s_nop 1
    v_add_f32_dpp v82, v54, v50 row_ror:8 row_mask:0xf bank_mask:0x3
    v_add_f32_dpp v83, v55, v51 row_ror:8 row_mask:0xf bank_mask:0x3
    v_add_f32_dpp v84, v56, v52 row_ror:8 row_mask:0xf bank_mask:0x3
    v_add_f32_dpp v85, v57, v53 row_ror:8 row_mask:0xf bank_mask:0x3
    v_add_f32_dpp v86, v62, v58 row_ror:8 row_mask:0xf bank_mask:0x3
    v_add_f32_dpp v87, v63, v59 row_ror:8 row_mask:0xf bank_mask:0x3
    v_add_f32_dpp v88, v64, v60 row_ror:8 row_mask:0xf bank_mask:0x3
    v_add_f32_dpp v89, v65, v61 row_ror:8 row_mask:0xf bank_mask:0x3
    v_add_f32_dpp v82, v66, v70 row_ror:8 row_mask:0xf bank_mask:0xc
    v_add_f32_dpp v83, v67, v71 row_ror:8 row_mask:0xf bank_mask:0xc
    v_add_f32_dpp v84, v68, v72 row_ror:8 row_mask:0xf bank_mask:0xc
    v_add_f32_dpp v85, v69, v73 row_ror:8 row_mask:0xf bank_mask:0xc
    v_add_f32_dpp v86, v74, v78 row_ror:8 row_mask:0xf bank_mask:0xc
    v_add_f32_dpp v87, v75, v79 row_ror:8 row_mask:0xf bank_mask:0xc
    v_add_f32_dpp v88, v76, v80 row_ror:8 row_mask:0xf bank_mask:0xc
    v_add_f32_dpp v89, v77, v81 row_ror:8 row_mask:0xf bank_mask:0xc
    v_cvt_pk_bf16_f32 v90, v82, v83
    v_cvt_pk_bf16_f32 v91, v84, v85
    v_cvt_pk_bf16_f32 v92, v86, v87
    v_cvt_pk_bf16_f32 v93, v88, v89
    v_bfi_b32 v90, 1, s83, v90
    buffer_store_dwordx4 v[90:93], v46, s[8:11], s74 offen
    s_waitcnt vmcnt(0)
pollxqk_18:
    buffer_load_dwordx4 v[66:69], v8, s[8:11], s74 offen offset:0 sc1
    buffer_load_dwordx4 v[70:73], v8, s[8:11], s74 offen offset:1024 sc1
    buffer_load_dwordx4 v[74:77], v8, s[8:11], s74 offen offset:2048 sc1
    buffer_load_dwordx4 v[78:81], v8, s[8:11], s74 offen offset:3072 sc1
    s_waitcnt vmcnt(0)
    v_bitop3_b32 v2, v66, v70, s83 bitop3:0x7e
    v_bitop3_b32 v3, v74, v78, s83 bitop3:0x7e
    v_bitop3_b32 v2, v2, v3, 1 bitop3:0xa8
    v_cmp_ne_u32 vcc, 0, v2
    s_cbranch_vccz pollxqk_ok_19
    s_sub_u32 s69, s69, 1
    s_cbranch_scc0 pollxqk_18
    s_mov_b32 s69, 0
pollxqk_ok_19:
    v_mfma_f32_16x16x32_bf16 v[82:85], v[26:29], v[66:69], 0
    v_mfma_f32_16x16x32_bf16 v[86:89], v[26:29], v[74:77], 0
    v_mfma_f32_16x16x32_bf16 v[82:85], v[30:33], v[70:73], v[82:85]
    v_mfma_f32_16x16x32_bf16 v[86:89], v[30:33], v[78:81], v[86:89]
    s_nop 6
    v_cvt_pk_bf16_f32 v90, v82, v83
    v_cvt_pk_bf16_f32 v91, v84, v85
    v_cvt_pk_bf16_f32 v92, v86, v87
    v_cvt_pk_bf16_f32 v93, v88, v89
    s_nop 1
    v_mfma_f32_16x16x32_bf16 v[50:53], v[94:97], v[90:93], 0
    v_mfma_f32_16x16x32_bf16 v[54:57], v[98:101], v[90:93], 0
    v_mfma_f32_16x16x32_bf16 v[58:61], v[90:93], v[90:93], 0
    s_nop 5
    ds_write_b128 v118, v[50:53] offset:0
    ds_write_b128 v118, v[54:57] offset:1024
    ds_write_b128 v118, v[58:61] offset:2048
    s_waitcnt lgkmcnt(0)
    s_barrier
    s_setprio 0
    s_and_b32 s72, s68, 3
    s_cmp_lg_u32 s72, s64
    s_cbranch_scc1 nokm_20
    s_andn2_b32 s71, 1, s68
    s_lshl_b32 s71, s71, 18
    s_add_u32 s71, s71, s75
    buffer_load_dwordx4 v[66:69], v8, s[8:11], s71 offen offset:0 sc1
    buffer_load_dwordx4 v[70:73], v8, s[8:11], s71 offen offset:1024 sc1
    v_min_u32 v90, -2, v90
    buffer_store_dwordx4 v[90:93], v119, s[8:11], s81 offen sc1
    s_waitcnt vmcnt(1)
    s_cmp_eq_u32 s68, 0
    s_cbranch_scc1 nokm_20
    v_mfma_f32_16x16x32_bf16 v[82:85], v[110:113], v[66:69], 0
    v_mfma_f32_16x16x32_bf16 v[82:85], v[114:117], v[70:73], v[82:85]
    s_add_u32 s70, s81, 0x3f0000
    s_nop 6
    v_cvt_pk_bf16_f32 v82, v82, v83
    v_cvt_pk_bf16_f32 v83, v84, v85
    v_min_u32 v82, -2, v82
    buffer_store_dwordx2 v[82:83], v120, s[8:11], s70 offen sc1
nokm_20:
    s_cmp_lg_u32 s68, 63
    s_cbranch_scc1 tob2_21
    s_cmp_lg_u32 s64, 0
    s_cbranch_scc1 chain_end_14
    s_add_u32 s71, s75, 262144
pollvm_24:
    buffer_load_dwordx4 v[66:69], v8, s[8:11], s71 offen offset:0 sc1
    buffer_load_dwordx4 v[70:73], v8, s[8:11], s71 offen offset:1024 sc1
    s_waitcnt vmcnt(0)
    v_bitop3_b32 v2, v66, v68, s83 bitop3:0x7e
    v_bitop3_b32 v3, v70, v72, s83 bitop3:0x7e
    v_bitop3_b32 v2, v2, v3, 1 bitop3:0xa8
    v_cmp_ne_u32 vcc, 0, v2
    s_cbranch_vccz pollvm_ok_25
    s_sub_u32 s69, s69, 1
    s_cbranch_scc0 pollvm_24
    s_mov_b32 s69, 0
pollvm_ok_25:
    v_mfma_f32_16x16x32_bf16 v[82:85], v[110:113], v[66:69], 0
    v_mfma_f32_16x16x32_bf16 v[82:85], v[114:117], v[70:73], v[82:85]
    s_add_u32 s70, s81, 0x400000
    s_nop 6
    v_cvt_pk_bf16_f32 v82, v82, v83
    v_cvt_pk_bf16_f32 v83, v84, v85
    v_min_u32 v82, -2, v82
    buffer_store_dwordx2 v[82:83], v120, s[8:11], s70 offen sc1
    s_branch chain_end_14
tob2_21:
    s_and_b32 s72, s68, 7
    s_cmp_lg_u32 s72, 7
    s_cbranch_scc1 kv7_26
    v_cmp_gt_u32 vcc, 32, v123
    s_cbranch_vccz kv7_26
kvw_28:
    buffer_load_dword v123, v124, s[12:15], 0 offen sc1
    s_waitcnt vmcnt(0)
    v_cmp_gt_u32 vcc, 32, v123
    s_cbranch_vccz kvw_ok_29
    s_sub_u32 s69, s69, 1
    s_cbranch_scc0 kvw_28
    s_mov_b32 s69, 0
kvw_ok_29:
kv7_26:
    s_add_u32 s70, s76, 0x1000000
    buffer_load_dwordx4 v[94:97], v121, s[8:11], s76 offen sc1
    buffer_load_dwordx4 v[98:101], v121, s[8:11], s76 offen offset:128 sc1
    buffer_load_dwordx4 v[102:105], v121, s[8:11], s70 offen sc1
    buffer_load_dwordx4 v[106:109], v121, s[8:11], s70 offen offset:128 sc1
    s_add_u32 s76, s76, 0x40000
    s_cmp_lg_u32 s72, 6
    s_cbranch_scc1 kv6_27
    v_add_u32 v124, 4, v124
    buffer_load_dword v123, v124, s[12:15], 0 offen sc1
kv6_27:
    s_barrier
    s_waitcnt vmcnt(0)
    ds_write_b128 v122, v[102:105]
    ds_write_b128 v122, v[106:109] offset:1024
    s_add_u32 s81, s81, 0x10000
    s_add_u32 s68, s68, 1
    s_bfe_u32 s83, s68, 0x10001
    s_xor_b32 s74, s74, 0x80000
    s_setprio 3
    s_barrier
pollc_30:
    buffer_load_dwordx4 v[34:37], v8, s[8:11], s77 offen sc1
    buffer_load_dwordx4 v[38:41], v8, s[8:11], s77 offen offset:1024 sc1
    s_waitcnt vmcnt(0)
    v_max3_u32 v2, v34, v36, v38
    v_max_u32 v2, v2, v40
    v_cmp_eq_u32 vcc, -1, v2
    s_cbranch_vccz pollc_ok_31
    s_sub_u32 s69, s69, 1
    s_cbranch_scc0 pollc_30
    s_mov_b32 s69, 0
pollc_ok_31:
    v_mfma_f32_16x16x32_bf16 v[42:45], v[26:29], v[34:37], 0
    v_mfma_f32_16x16x32_bf16 v[42:45], v[30:33], v[38:41], v[42:45]
    s_add_u32 s77, s77, 0x10000
    s_nop 6
    v_cvt_pk_bf16_f32 v42, v42, v43
    v_cvt_pk_bf16_f32 v43, v44, v45
    s_branch qk_loop_17
vo_main_13:
    s_setprio 1
    v_mov_b32 v114, 0x3f803f80
    v_mov_b32 v118, 0x3e803e80
    v_mov_b32 v115, 0x3f803f80
    v_mov_b32 v119, 0x3e803e80
    v_mov_b32 v116, 0x3f803f80
    v_mov_b32 v120, 0x3e803e80
    v_mov_b32 v117, 0x3f803f80
    v_mov_b32 v121, 0x3e803e80
    s_mov_b32 s82, 0x3e0293ee
    v_lshrrev_b32 v2, 3, v6
    v_mul_u32_u24 v2, 6272, v2
    v_and_b32 v3, 7, v6
    v_lshl_add_u32 v2, v3, 4, v2
    v_add_u32 v2, 4096, v2
    v_lshl_add_u32 v122, v7, 8, v2
    v_or_b32 v3, 2, v7
    v_lshl_add_u32 v123, v3, 8, v2
    s_lshl_b32 s70, s67, 10
    v_add_u32 v124, s70, v8
    v_add_u32 v125, s70, v124
    s_waitcnt vmcnt(0)
vo_loop_32:
    s_nop 3
    ds_write_b64 v9, v[42:43] offset:0
    s_waitcnt lgkmcnt(0)
    s_barrier
    ds_read_b128 v[10:13], v8 offset:0
    ds_read_b128 v[14:17], v8 offset:1024
    ds_read_b128 v[18:21], v8 offset:2048
    ds_read_b128 v[22:25], v8 offset:3072
    ds_read_b128 v[74:77], v125 offset:20992
    ds_read_b128 v[78:81], v125 offset:22016
    s_waitcnt lgkmcnt(5)
    v_mfma_f32_16x16x32_bf16 v[50:53], v[10:13], v[128:131], 0
    v_mfma_f32_16x16x32_bf16 v[54:57], v[10:13], v[144:147], 0
    v_mfma_f32_16x16x32_bf16 v[58:61], v[10:13], v[160:163], 0
    v_mfma_f32_16x16x32_bf16 v[62:65], v[10:13], v[176:179], 0
    s_waitcnt lgkmcnt(4)
    v_mfma_f32_16x16x32_bf16 v[50:53], v[14:17], v[132:135], v[50:53]
    v_mfma_f32_16x16x32_bf16 v[54:57], v[14:17], v[148:151], v[54:57]
    v_mfma_f32_16x16x32_bf16 v[58:61], v[14:17], v[164:167], v[58:61]
    v_mfma_f32_16x16x32_bf16 v[62:65], v[14:17], v[180:183], v[62:65]
    s_waitcnt lgkmcnt(3)
    v_mfma_f32_16x16x32_bf16 v[50:53], v[18:21], v[136:139], v[50:53]
    v_mfma_f32_16x16x32_bf16 v[54:57], v[18:21], v[152:155], v[54:57]
    v_mfma_f32_16x16x32_bf16 v[58:61], v[18:21], v[168:171], v[58:61]
    v_mfma_f32_16x16x32_bf16 v[62:65], v[18:21], v[184:187], v[62:65]
    s_waitcnt lgkmcnt(2)
    v_mfma_f32_16x16x32_bf16 v[50:53], v[22:25], v[140:143], v[50:53]
    v_mfma_f32_16x16x32_bf16 v[54:57], v[22:25], v[156:159], v[54:57]
    v_mfma_f32_16x16x32_bf16 v[58:61], v[22:25], v[172:175], v[58:61]
    v_mfma_f32_16x16x32_bf16 v[62:65], v[22:25], v[188:191], v[62:65]
    s_nop 6
    v_permlane32_swap_b32 v50, v58
    v_permlane32_swap_b32 v54, v62
    v_permlane32_swap_b32 v51, v59
    v_permlane32_swap_b32 v55, v63
    v_permlane32_swap_b32 v52, v60
    v_permlane32_swap_b32 v56, v64
    v_permlane32_swap_b32 v53, v61
    v_permlane32_swap_b32 v57, v65
    v_add_f32 v50, v50, v62
    v_add_f32 v51, v51, v63
    v_add_f32 v52, v52, v64
    v_add_f32 v53, v53, v65
    v_cvt_pk_bf16_f32 v50, v50, v51
    v_cvt_pk_bf16_f32 v51, v52, v53
    v_bfi_b32 v50, 1, s83, v50
    buffer_store_dwordx2 v[50:51], v46, s[8:11], s74 offen
    s_and_b32 s70, s68, 1
    s_lshl_b32 s70, s70, 19
    s_add_u32 s71, s70, s80
    s_add_u32 s72, s71, 0x1000
    s_add_u32 s70, s70, s79
    s_waitcnt lgkmcnt(0)
    s_barrier
    s_cmp_eq_u32 s68, 63
    s_cbranch_scc1 chain_end_14
    ds_read_b128 v[82:85], v122 offset:0
    ds_read_b128 v[86:89], v122 offset:1024
    ds_read_b128 v[90:93], v123 offset:2048
    ds_read_b128 v[94:97], v122 offset:3136
    ds_read_b128 v[98:101], v122 offset:4160
    ds_read_b128 v[102:105], v123 offset:5184
    buffer_load_dwordx4 v[66:69], v8, s[8:11], s74 offen offset:0 sc1
    buffer_load_dwordx4 v[70:73], v8, s[8:11], s74 offen offset:1024 sc1
    s_waitcnt lgkmcnt(0)
    v_pk_add_f32 v[82:83], v[82:83], v[94:95]
    v_pk_add_f32 v[84:85], v[84:85], v[96:97]
    v_pk_add_f32 v[86:87], v[86:87], v[98:99]
    v_pk_add_f32 v[88:89], v[88:89], v[100:101]
    v_pk_add_f32 v[90:91], v[90:91], v[102:103]
    v_pk_add_f32 v[92:93], v[92:93], v[104:105]
    v_add_f32_dpp v82, v82, v82 row_ror:8 row_mask:0xf bank_mask:0xf
    v_add_f32_dpp v83, v83, v83 row_ror:8 row_mask:0xf bank_mask:0xf
    v_add_f32_dpp v84, v84, v84 row_ror:8 row_mask:0xf bank_mask:0xf
    v_add_f32_dpp v85, v85, v85 row_ror:8 row_mask:0xf bank_mask:0xf
    v_add_f32_dpp v86, v86, v86 row_ror:8 row_mask:0xf bank_mask:0xf
    v_add_f32_dpp v87, v87, v87 row_ror:8 row_mask:0xf bank_mask:0xf
    v_add_f32_dpp v88, v88, v88 row_ror:8 row_mask:0xf bank_mask:0xf
    v_add_f32_dpp v89, v89, v89 row_ror:8 row_mask:0xf bank_mask:0xf
    v_add_f32_dpp v90, v90, v90 row_ror:8 row_mask:0xf bank_mask:0xf
    v_add_f32_dpp v91, v91, v91 row_ror:8 row_mask:0xf bank_mask:0xf
    v_add_f32_dpp v92, v92, v92 row_ror:8 row_mask:0xf bank_mask:0xf
    v_add_f32_dpp v93, v93, v93 row_ror:8 row_mask:0xf bank_mask:0xf
    v_max3_f32 v2, v82, v83, v84
    v_max3_f32 v3, v85, v86, v87
    v_max3_f32 v2, v2, v88, v89
    v_max3_f32 v3, v3, v90, v91
    v_max3_f32 v2, v2, v92, v93
    v_max_f32 v2, v2, v3
    v_mov_b32 v3, v2
    s_nop 1
    v_permlane32_swap_b32 v2, v3
    v_max_f32 v2, v2, v3
    v_mov_b32 v3, v2
    s_nop 1
    v_permlane16_swap_b32 v2, v3
    v_max_f32 v2, v2, v3
    v_mul_f32 v2, s82, v2
    v_fma_f32 v82, v82, s82, -v2
    v_fma_f32 v83, v83, s82, -v2
    v_fma_f32 v84, v84, s82, -v2
    v_fma_f32 v85, v85, s82, -v2
    v_fma_f32 v86, v86, s82, -v2
    v_fma_f32 v87, v87, s82, -v2
    v_fma_f32 v88, v88, s82, -v2
    v_fma_f32 v89, v89, s82, -v2
    v_fma_f32 v90, v90, s82, -v2
    v_fma_f32 v91, v91, s82, -v2
    v_fma_f32 v92, v92, s82, -v2
    v_fma_f32 v93, v93, s82, -v2
    v_exp_f32 v82, v82
    v_exp_f32 v83, v83
    v_exp_f32 v84, v84
    v_exp_f32 v85, v85
    v_exp_f32 v86, v86
    v_exp_f32 v87, v87
    v_exp_f32 v88, v88
    v_exp_f32 v89, v89
    v_exp_f32 v90, v90
    v_exp_f32 v91, v91
    v_exp_f32 v92, v92
    v_exp_f32 v93, v93
    v_cvt_pk_bf16_f32 v106, v82, v83
    v_cvt_pk_bf16_f32 v107, v84, v85
    v_cvt_pk_bf16_f32 v108, v86, v87
    v_cvt_pk_bf16_f32 v109, v88, v89
    v_cvt_pk_bf16_f32 v110, v90, v91
    v_cvt_pk_bf16_f32 v111, v92, v93
    v_cvt_pk_bf16_f32 v112, v90, v91
    v_cvt_pk_bf16_f32 v113, v92, v93
    v_mfma_f32_16x16x32_bf16 v[102:105], v[114:117], v[106:109], 0
    v_mfma_f32_16x16x32_bf16 v[94:97], v[74:77], v[106:109], 0
    v_mfma_f32_16x16x32_bf16 v[102:105], v[118:121], v[110:113], v[102:105]
    v_mfma_f32_16x16x32_bf16 v[98:101], v[78:81], v[106:109], 0
    s_waitcnt vmcnt(0)
    v_bitop3_b32 v2, v66, v68, s83 bitop3:0x7e
    v_bitop3_b32 v3, v70, v72, s83 bitop3:0x7e
    v_bitop3_b32 v2, v2, v3, 1 bitop3:0xa8
    v_cmp_ne_u32 vcc, 0, v2
    s_cbranch_vccz pollxv_ok_34
pollxv_33:
    buffer_load_dwordx4 v[66:69], v8, s[8:11], s74 offen offset:0 sc1
    buffer_load_dwordx4 v[70:73], v8, s[8:11], s74 offen offset:1024 sc1
    s_waitcnt vmcnt(0)
    v_bitop3_b32 v2, v66, v68, s83 bitop3:0x7e
    v_bitop3_b32 v3, v70, v72, s83 bitop3:0x7e
    v_bitop3_b32 v2, v2, v3, 1 bitop3:0xa8
    v_cmp_ne_u32 vcc, 0, v2
    s_cbranch_vccz pollxv_ok_34
    s_sub_u32 s69, s69, 1
    s_cbranch_scc0 pollxv_33
    s_mov_b32 s69, 0
pollxv_ok_34:
    v_mfma_f32_16x16x32_bf16 v[94:97], v[66:69], v[110:113], v[94:97]
    v_mfma_f32_16x16x32_bf16 v[98:101], v[70:73], v[110:113], v[98:101]
    v_rcp_f32 v2, v102
    s_nop 5
    v_mul_f32 v94, v2, v94
    v_mul_f32 v95, v2, v95
    v_mul_f32 v96, v2, v96
    v_mul_f32 v97, v2, v97
    v_mul_f32 v98, v2, v98
    v_mul_f32 v99, v2, v99
    v_mul_f32 v100, v2, v100
    v_mul_f32 v101, v2, v101
    v_cvt_pk_bf16_f32 v106, v94, v95
    v_cvt_pk_bf16_f32 v107, v96, v97
    v_cvt_pk_bf16_f32 v108, v98, v99
    v_cvt_pk_bf16_f32 v109, v100, v101
    ds_write_b128 v124, v[106:109] offset:16896
    s_waitcnt lgkmcnt(0)
    s_barrier
    ds_read_b128 v[10:13], v8 offset:16896
    ds_read_b128 v[14:17], v8 offset:17920
    ds_read_b128 v[18:21], v8 offset:18944
    ds_read_b128 v[22:25], v8 offset:19968
    s_waitcnt lgkmcnt(3)
    v_mfma_f32_16x16x32_bf16 v[50:53], v[192:195], v[10:13], 0
    v_mfma_f32_16x16x32_bf16 v[54:57], v[208:211], v[10:13], 0
    s_waitcnt lgkmcnt(2)
    v_mfma_f32_16x16x32_bf16 v[50:53], v[196:199], v[14:17], v[50:53]
    v_mfma_f32_16x16x32_bf16 v[54:57], v[212:215], v[14:17], v[54:57]
    s_waitcnt lgkmcnt(1)
    v_mfma_f32_16x16x32_bf16 v[50:53], v[200:203], v[18:21], v[50:53]
    v_mfma_f32_16x16x32_bf16 v[54:57], v[216:219], v[18:21], v[54:57]
    s_waitcnt lgkmcnt(0)
    v_mfma_f32_16x16x32_bf16 v[50:53], v[204:207], v[22:25], v[50:53]
    v_mfma_f32_16x16x32_bf16 v[54:57], v[220:223], v[22:25], v[54:57]
    v_mfma_f32_16x16x32_bf16 v[58:61], v[224:227], v[10:13], 0
    v_mfma_f32_16x16x32_bf16 v[58:61], v[228:231], v[14:17], v[58:61]
    v_mfma_f32_16x16x32_bf16 v[58:61], v[232:235], v[18:21], v[58:61]
    v_mfma_f32_16x16x32_bf16 v[58:61], v[236:239], v[22:25], v[58:61]
    v_mfma_f32_16x16x32_bf16 v[62:65], v[240:243], v[10:13], 0
    s_nop 1
    v_cvt_pk_bf16_f32 v82, v50, v51
    v_cvt_pk_bf16_f32 v83, v52, v53
    v_mfma_f32_16x16x32_bf16 v[62:65], v[244:247], v[14:17], v[62:65]
    v_cvt_pk_bf16_f32 v84, v54, v55
    v_cvt_pk_bf16_f32 v85, v56, v57
    v_mfma_f32_16x16x32_bf16 v[62:65], v[248:251], v[18:21], v[62:65]
    v_bfi_b32 v82, 1, s83, v82
    buffer_store_dwordx4 v[82:85], v48, s[8:11], s71 offen
    v_mfma_f32_16x16x32_bf16 v[62:65], v[252:255], v[22:25], v[62:65]
    v_cvt_pk_bf16_f32 v86, v58, v59
    v_cvt_pk_bf16_f32 v87, v60, v61
    v_bfi_b32 v86, 1, s83, v86
    s_nop 4
    v_cvt_pk_bf16_f32 v88, v62, v63
    v_cvt_pk_bf16_f32 v89, v64, v65
    buffer_store_dwordx4 v[86:89], v48, s[8:11], s72 offen
    s_waitcnt vmcnt(0)
pollb_35:
    buffer_load_dwordx4 v[66:69], v8, s[8:11], s70 offen sc1
    s_waitcnt vmcnt(0)
    v_bitop3_b32 v2, v66, s83, 1 bitop3:0x28
    v_cmp_ne_u32 vcc, 0, v2
    s_cbranch_vccz pollb_ok_36
    s_sub_u32 s69, s69, 1
    s_cbranch_scc0 pollb_35
    s_mov_b32 s69, 0
pollb_ok_36:
    v_mfma_f32_16x16x32_bf16 v[42:45], v[26:29], v[66:69], 0
    s_add_u32 s68, s68, 1
    s_bfe_u32 s83, s68, 0x10001
    s_xor_b32 s74, s74, 0x40000
    s_nop 4
    v_add_f32_dpp v42, v42, v42 row_ror:8 row_mask:0xf bank_mask:0xf
    v_add_f32_dpp v43, v43, v43 row_ror:8 row_mask:0xf bank_mask:0xf
    v_add_f32_dpp v44, v44, v44 row_ror:8 row_mask:0xf bank_mask:0xf
    v_add_f32_dpp v45, v45, v45 row_ror:8 row_mask:0xf bank_mask:0xf
    v_cvt_pk_bf16_f32 v42, v42, v43
    v_cvt_pk_bf16_f32 v43, v44, v45
    v_min_u32 v42, -2, v42
    buffer_store_dwordx2 v[42:43], v47, s[8:11], s78 offen sc1
    s_add_u32 s78, s78, 0x10000
    s_waitcnt vmcnt(0)
    s_barrier
pollc_37:
    buffer_load_dwordx4 v[34:37], v8, s[8:11], s77 offen sc1
    buffer_load_dwordx4 v[38:41], v8, s[8:11], s77 offen offset:1024 sc1
    s_waitcnt vmcnt(0)
    v_max3_u32 v2, v34, v36, v38
    v_max_u32 v2, v2, v40
    v_cmp_eq_u32 vcc, -1, v2
    s_cbranch_vccz pollc_ok_38
    s_sub_u32 s69, s69, 1
    s_cbranch_scc0 pollc_37
    s_mov_b32 s69, 0
pollc_ok_38:
    v_mfma_f32_16x16x32_bf16 v[42:45], v[26:29], v[34:37], 0
    v_mfma_f32_16x16x32_bf16 v[42:45], v[30:33], v[38:41], v[42:45]
    s_add_u32 s77, s77, 0x10000
    s_nop 6
    v_cvt_pk_bf16_f32 v42, v42, v43
    v_cvt_pk_bf16_f32 v43, v44, v45
    s_branch vo_loop_32
chain_end_14:
    s_waitcnt vmcnt(0)
    s_endpgm
bulk_2:
    s_and_b32 s75, s56, 3
    s_lshl_b32 s76, s75, 5
    s_add_u32 s76, s76, s57
    s_mov_b32 s77, 0x40000
    v_bfe_u32 v207, v1, 0, 4
    v_lshlrev_b32 v207, 4, v207
    v_bfe_u32 v203, v1, 4, 2
    v_lshl_or_b32 v207, v203, 9, v207
    s_mov_b32 s78, 0
    v_bfe_u32 v204, v1, 2, 2
    v_sub_u32 v204, 0, v204
    v_lshrrev_b32 v203, 4, v1
    v_xor_b32 v204, v204, v203
    v_and_b32 v204, 3, v204
    v_bfe_u32 v200, v1, 0, 4
    v_lshlrev_b32 v200, 6, v200
    v_lshl_or_b32 v200, v204, 4, v200
    s_lshr_b32 s74, s58, 2
    s_mul_i32 s74, s74, 4096
    v_add_u32 v200, s74, v200
    v_bfe_u32 v201, v1, 0, 2
    v_lshlrev_b32 v201, 3, v201
    v_bfe_u32 v203, v1, 4, 1
    v_lshl_or_b32 v201, v203, 5, v201
    v_bfe_u32 v203, v1, 2, 2
    v_lshl_or_b32 v201, v203, 6, v201
    v_bfe_u32 v203, v1, 2, 2
    v_lshl_or_b32 v201, v203, 8, v201
    v_bfe_u32 v203, v1, 4, 2
    v_lshl_or_b32 v201, v203, 11, v201
    s_and_b32 s74, s58, 3
    s_mul_i32 s74, s74, 64
    s_or_b32 s74, s74, 8192
    v_xor_b32 v201, s74, v201
    s_and_b32 s79, s57, 1
    s_bfe_u32 s80, s76, 0x50001
    s_mov_b32 s83, 128
    s_cmp_ge_u32 s75, 2
    s_cbranch_scc1 v0_44
    s_mov_b64 s[60:61], s[36:37]
    s_mov_b32 s62, 0x400000
    s_mov_b32 s63, 0x20000
    s_mov_b64 s[64:65], s[24:25]
    s_mov_b32 s66, 0x800000
    s_mov_b32 s67, 0x20000
    v_lshrrev_b32 v204, 4, v1
    v_sub_u32 v204, 0, v204
    v_xor_b32 v204, v204, v1
    v_and_b32 v204, 3, v204
    s_mul_i32 s74, s58, 16
    v_lshrrev_b32 v205, 2, v1
    v_add3_u32 v205, v205, s74, 0
    v_lshlrev_b32 v196, 11, v205
    v_lshl_add_u32 v196, v204, 4, v196
    s_and_b32 s74, s58, 2
    v_bfe_u32 v204, v1, 0, 4
    v_bfe_u32 v205, v1, 4, 2
    v_lshlrev_b32 v205, 2, v205
    v_xor_b32 v204, v204, v205
    v_xor_b32 v204, s74, v204
    v_bfe_u32 v205, v204, 0, 1
    v_lshlrev_b32 v205, 5, v205
    v_bfe_u32 v203, v204, 1, 1
    v_lshl_or_b32 v205, v203, 4, v205
    v_bfe_u32 v203, v204, 2, 3
    v_lshl_or_b32 v205, v203, 6, v205
    v_lshrrev_b32 v204, 4, v1
    v_lshl_add_u32 v198, v204, 13, v205
    s_lshl_b32 s74, s58, 15
    v_add_u32 v198, s74, v198
    s_mov_b32 s70, 262144
    s_mul_i32 s68, s79, 262144
    s_mul_i32 s69, s80, 256
    s_mov_b32 s82, 0x40000
    s_lshl_b32 s81, s79, 1
    s_lshr_b32 s84, s58, 2
    s_add_u32 s81, s81, s84
    s_mul_i32 s81, s81, s82
    s_mul_i32 s81, s81, 2
    s_lshl_b32 s74, s80, 2
    s_and_b32 s84, s58, 3
    s_add_u32 s84, s84, s74
    s_mul_i32 s84, s84, 2048
    s_add_u32 s81, s81, s84
    s_add_u32 s81, s81, 0x1000000
    s_mul_i32 s71, s58, 1024
    s_mov_b32 m0, s71
    s_nop 0
    buffer_load_dwordx4 v196, s[60:63], s68 offen lds
    s_add_u32 m0, s71, 8192
    s_nop 0
    buffer_load_dwordx4 v198, s[64:67], s69 offen lds
    s_add_u32 s68, s68, 64
    s_add_u32 s69, s69, s70
    s_add_u32 s71, s71, 16384
    s_and_b32 s71, s71, 0x1ffff
    s_mov_b32 m0, s71
    s_nop 0
    buffer_load_dwordx4 v196, s[60:63], s68 offen lds
    s_add_u32 m0, s71, 8192
    s_nop 0
    buffer_load_dwordx4 v198, s[64:67], s69 offen lds
    s_add_u32 s68, s68, 64
    s_add_u32 s69, s69, s70
    s_add_u32 s71, s71, 16384
    s_and_b32 s71, s71, 0x1ffff
    s_mov_b32 m0, s71
    s_nop 0
    buffer_load_dwordx4 v196, s[60:63], s68 offen lds
    s_add_u32 m0, s71, 8192
    s_nop 0
    buffer_load_dwordx4 v198, s[64:67], s69 offen lds
    s_add_u32 s68, s68, 64
    s_add_u32 s69, s69, s70
    s_add_u32 s71, s71, 16384
    s_and_b32 s71, s71, 0x1ffff
    s_mov_b32 m0, s71
    s_nop 0
    buffer_load_dwordx4 v196, s[60:63], s68 offen lds
    s_add_u32 m0, s71, 8192
    s_nop 0
    buffer_load_dwordx4 v198, s[64:67], s69 offen lds
    s_add_u32 s68, s68, 64
    s_add_u32 s69, s69, s70
    s_add_u32 s71, s71, 16384
    s_and_b32 s71, s71, 0x1ffff
    s_mov_b32 m0, s71
    s_nop 0
    buffer_load_dwordx4 v196, s[60:63], s68 offen lds
    s_add_u32 m0, s71, 8192
    s_nop 0
    buffer_load_dwordx4 v198, s[64:67], s69 offen lds
    s_add_u32 s68, s68, 64
    s_add_u32 s69, s69, s70
    s_add_u32 s71, s71, 16384
    s_and_b32 s71, s71, 0x1ffff
    s_mov_b32 m0, s71
    s_nop 0
    buffer_load_dwordx4 v196, s[60:63], s68 offen lds
    s_add_u32 m0, s71, 8192
    s_nop 0
    buffer_load_dwordx4 v198, s[64:67], s69 offen lds
    s_add_u32 s68, s68, 64
    s_add_u32 s69, s69, s70
    s_add_u32 s71, s71, 16384
    s_and_b32 s71, s71, 0x1ffff
    s_mov_b32 m0, s71
    s_nop 0
    buffer_load_dwordx4 v196, s[60:63], s68 offen lds
    s_add_u32 m0, s71, 8192
    s_nop 0
    buffer_load_dwordx4 v198, s[64:67], s69 offen lds
    s_add_u32 s68, s68, 64
    s_add_u32 s69, s69, s70
    s_add_u32 s71, s71, 16384
    s_and_b32 s71, s71, 0x1ffff
    s_mov_b32 m0, s71
    s_nop 0
    buffer_load_dwordx4 v196, s[60:63], s68 offen lds
    s_add_u32 m0, s71, 8192
    s_nop 0
    buffer_load_dwordx4 v198, s[64:67], s69 offen lds
    s_add_u32 s68, s68, 64
    s_add_u32 s69, s69, s70
    s_add_u32 s71, s71, 16384
    s_and_b32 s71, s71, 0x1ffff
    s_branch arm_45
v0_44:
    s_mov_b64 s[60:61], s[36:37]
    s_mov_b32 s62, 0x400000
    s_mov_b32 s63, 0x20000
    s_mov_b64 s[64:65], s[28:29]
    s_mov_b32 s66, 0x800000
    s_mov_b32 s67, 0x20000
    v_lshrrev_b32 v204, 4, v1
    v_sub_u32 v204, 0, v204
    v_xor_b32 v204, v204, v1
    v_and_b32 v204, 3, v204
    s_mul_i32 s74, s58, 16
    v_lshrrev_b32 v205, 2, v1
    v_add3_u32 v205, v205, s74, 0
    v_bfe_u32 v196, v205, 0, 3
    v_lshlrev_b32 v196, 11, v196
    v_bfe_u32 v203, v205, 3, 1
    v_lshl_or_b32 v196, v203, 15, v196
    v_bfe_u32 v203, v205, 4, 1
    v_lshl_or_b32 v196, v203, 14, v196
    v_bfe_u32 v203, v205, 5, 3
    v_lshl_or_b32 v196, v203, 16, v196
    v_lshl_add_u32 v196, v204, 4, v196
    s_and_b32 s74, s58, 2
    v_bfe_u32 v204, v1, 0, 4
    v_bfe_u32 v205, v1, 4, 2
    v_lshlrev_b32 v205, 2, v205
    v_xor_b32 v204, v204, v205
    v_xor_b32 v204, s74, v204
    v_lshlrev_b32 v205, 4, v204
    v_lshrrev_b32 v204, 4, v1
    v_lshl_add_u32 v198, v204, 13, v205
    s_lshl_b32 s74, s58, 15
    v_add_u32 v198, s74, v198
    s_mov_b32 s70, 262144
    s_mul_i32 s68, s79, 262144
    s_mul_i32 s69, s80, 256
    s_mov_b32 s82, 0x40000
    s_lshl_b32 s81, s79, 1
    s_lshr_b32 s84, s58, 2
    s_add_u32 s81, s81, s84
    s_mul_i32 s81, s81, s82
    s_mul_i32 s81, s81, 2
    s_lshl_b32 s74, s80, 2
    s_and_b32 s84, s58, 3
    s_add_u32 s84, s84, s74
    s_mul_i32 s84, s84, 2048
    s_add_u32 s81, s81, s84
    s_add_u32 s81, s81, 0x2000000
    s_mul_i32 s71, s58, 1024
    s_mov_b32 m0, s71
    s_nop 0
    buffer_load_dwordx4 v196, s[60:63], s68 offen lds
    s_add_u32 m0, s71, 8192
    s_nop 0
    buffer_load_dwordx4 v198, s[64:67], s69 offen lds
    s_add_u32 s68, s68, 64
    s_add_u32 s69, s69, s70
    s_add_u32 s71, s71, 16384
    s_and_b32 s71, s71, 0x1ffff
    s_mov_b32 m0, s71
    s_nop 0
    buffer_load_dwordx4 v196, s[60:63], s68 offen lds
    s_add_u32 m0, s71, 8192
    s_nop 0
    buffer_load_dwordx4 v198, s[64:67], s69 offen lds
    s_add_u32 s68, s68, 64
    s_add_u32 s69, s69, s70
    s_add_u32 s71, s71, 16384
    s_and_b32 s71, s71, 0x1ffff
    s_mov_b32 m0, s71
    s_nop 0
    buffer_load_dwordx4 v196, s[60:63], s68 offen lds
    s_add_u32 m0, s71, 8192
    s_nop 0
    buffer_load_dwordx4 v198, s[64:67], s69 offen lds
    s_add_u32 s68, s68, 64
    s_add_u32 s69, s69, s70
    s_add_u32 s71, s71, 16384
    s_and_b32 s71, s71, 0x1ffff
    s_mov_b32 m0, s71
    s_nop 0
    buffer_load_dwordx4 v196, s[60:63], s68 offen lds
    s_add_u32 m0, s71, 8192
    s_nop 0
    buffer_load_dwordx4 v198, s[64:67], s69 offen lds
    s_add_u32 s68, s68, 64
    s_add_u32 s69, s69, s70
    s_add_u32 s71, s71, 16384
    s_and_b32 s71, s71, 0x1ffff
    s_mov_b32 m0, s71
    s_nop 0
    buffer_load_dwordx4 v196, s[60:63], s68 offen lds
    s_add_u32 m0, s71, 8192
    s_nop 0
    buffer_load_dwordx4 v198, s[64:67], s69 offen lds
    s_add_u32 s68, s68, 64
    s_add_u32 s69, s69, s70
    s_add_u32 s71, s71, 16384
    s_and_b32 s71, s71, 0x1ffff
    s_mov_b32 m0, s71
    s_nop 0
    buffer_load_dwordx4 v196, s[60:63], s68 offen lds
    s_add_u32 m0, s71, 8192
    s_nop 0
    buffer_load_dwordx4 v198, s[64:67], s69 offen lds
    s_add_u32 s68, s68, 64
    s_add_u32 s69, s69, s70
    s_add_u32 s71, s71, 16384
    s_and_b32 s71, s71, 0x1ffff
    s_mov_b32 m0, s71
    s_nop 0
    buffer_load_dwordx4 v196, s[60:63], s68 offen lds
    s_add_u32 m0, s71, 8192
    s_nop 0
    buffer_load_dwordx4 v198, s[64:67], s69 offen lds
    s_add_u32 s68, s68, 64
    s_add_u32 s69, s69, s70
    s_add_u32 s71, s71, 16384
    s_and_b32 s71, s71, 0x1ffff
    s_mov_b32 m0, s71
    s_nop 0
    buffer_load_dwordx4 v196, s[60:63], s68 offen lds
    s_add_u32 m0, s71, 8192
    s_nop 0
    buffer_load_dwordx4 v198, s[64:67], s69 offen lds
    s_add_u32 s68, s68, 64
    s_add_u32 s69, s69, s70
    s_add_u32 s71, s71, 16384
    s_and_b32 s71, s71, 0x1ffff
arm_45:
    v_mov_b32 v8, -1
    v_mov_b32 v9, -1
    v_mov_b32 v10, -1
    v_mov_b32 v11, -1
    v_lshlrev_b32 v2, 4, v1
    s_lshl_b32 s84, s76, 3
    s_add_u32 s84, s84, s58
    s_lshl_b32 s84, s84, 13
    s_add_u32 s84, s84, 0x4000000
    buffer_store_dwordx4 v[8:11], v2, s[8:11], s84 offen offset:0 sc1
    buffer_store_dwordx4 v[8:11], v2, s[8:11], s84 offen offset:1024 sc1
    buffer_store_dwordx4 v[8:11], v2, s[8:11], s84 offen offset:2048 sc1
    buffer_store_dwordx4 v[8:11], v2, s[8:11], s84 offen offset:3072 sc1
    s_add_u32 s84, s84, 4096
    buffer_store_dwordx4 v[8:11], v2, s[8:11], s84 offen offset:0 sc1
    buffer_store_dwordx4 v[8:11], v2, s[8:11], s84 offen offset:1024 sc1
    buffer_store_dwordx4 v[8:11], v2, s[8:11], s84 offen offset:2048 sc1
    buffer_store_dwordx4 v[8:11], v2, s[8:11], s84 offen offset:3072 sc1
    v_bfe_u32 v2, v1, 0, 4
    v_lshlrev_b32 v2, 9, v2
    s_lshl_b32 s84, s76, 2
    s_add_u32 s84, s84, 0x5100000
    v_mov_b32 v3, 0
    buffer_store_dword v3, v2, s[8:11], s84 offen
    s_lshl_b32 s84, s76, 3
    s_add_u32 s84, s84, s58
    v_lshlrev_b32 v2, 3, v1
    v_mul_u32_u24 v2, s84, v2
    v_and_b32 v3, 0x3ff, v2
    v_cvt_f32_u32 v3, v3
    v_mul_f32 v3, 0x3a800000, v3
    v_cos_f32 v4, v3
    v_sin_f32 v5, -v3
    v_add_u32 v2, s84, v2
    v_cvt_pk_bf16_f32 v8, v4, v5
    v_and_b32 v3, 0x3ff, v2
    v_cvt_f32_u32 v3, v3
    v_mul_f32 v3, 0x3a800000, v3
    v_cos_f32 v4, v3
    v_sin_f32 v5, -v3
    v_add_u32 v2, s84, v2
    v_cvt_pk_bf16_f32 v9, v4, v5
    v_and_b32 v3, 0x3ff, v2
    v_cvt_f32_u32 v3, v3
    v_mul_f32 v3, 0x3a800000, v3
    v_cos_f32 v4, v3
    v_sin_f32 v5, -v3
    v_add_u32 v2, s84, v2
    v_cvt_pk_bf16_f32 v10, v4, v5
    v_and_b32 v3, 0x3ff, v2
    v_cvt_f32_u32 v3, v3
    v_mul_f32 v3, 0x3a800000, v3
    v_cos_f32 v4, v3
    v_sin_f32 v5, -v3
    v_add_u32 v2, s84, v2
    v_cvt_pk_bf16_f32 v11, v4, v5
    v_and_b32 v3, 0x3ff, v2
    v_cvt_f32_u32 v3, v3
    v_mul_f32 v3, 0x3a800000, v3
    v_cos_f32 v4, v3
    v_sin_f32 v5, -v3
    v_add_u32 v2, s84, v2
    v_cvt_pk_bf16_f32 v12, v4, v5
    v_and_b32 v3, 0x3ff, v2
    v_cvt_f32_u32 v3, v3
    v_mul_f32 v3, 0x3a800000, v3
    v_cos_f32 v4, v3
    v_sin_f32 v5, -v3
    v_add_u32 v2, s84, v2
    v_cvt_pk_bf16_f32 v13, v4, v5
    v_and_b32 v3, 0x3ff, v2
    v_cvt_f32_u32 v3, v3
    v_mul_f32 v3, 0x3a800000, v3
    v_cos_f32 v4, v3
    v_sin_f32 v5, -v3
    v_add_u32 v2, s84, v2
    v_cvt_pk_bf16_f32 v14, v4, v5
    v_and_b32 v3, 0x3ff, v2
    v_cvt_f32_u32 v3, v3
    v_mul_f32 v3, 0x3a800000, v3
    v_cos_f32 v4, v3
    v_sin_f32 v5, -v3
    v_add_u32 v2, s84, v2
    v_cvt_pk_bf16_f32 v15, v4, v5
    v_mov_b32 v3, s84
    v_lshlrev_b32 v3, 31, v3
    v_or_b32 v3, 0x3f803f80, v3
    v_cmp_eq_u32 vcc, 0, v1
    s_nop 1
    v_cndmask_b32 v8, v8, v3, vcc
    v_lshlrev_b32 v6, 5, v1
    s_lshl_b32 s84, s84, 11
    s_add_u32 s84, s84, 0x5200000
    buffer_store_dwordx4 v[8:11], v6, s[8:11], s84 offen sc1
    buffer_store_dwordx4 v[12:15], v6, s[8:11], s84 offen offset:16 sc1
    s_waitcnt vmcnt(0)
    s_barrier
    s_cmp_lg_u32 s58, 0
    s_cbranch_scc1 sig_46
    v_mov_b32 v203, 0x5ffffff0
    v_mov_b32 v204, 32
    v_cmp_eq_u32 vcc, 0, v1
    s_nop 1
    v_cndmask_b32 v204, v203, v204, vcc
    v_mov_b32 v203, 1
    buffer_atomic_add v203, v204, s[12:15], 0 offen sc1
    s_waitcnt vmcnt(0)
sig_46:
    s_cmp_ge_u32 s75, 2
    s_cbranch_scc1 t128_40
f128_39:
    s_mov_b32 s72, 0
    s_waitcnt vmcnt(14)
    s_barrier
    v_add_u32 v202, s72, v200
    v_add_u32 v203, s72, v201
    v_xor_b32 v204, 32, v203
    s_add_u32 s72, s72, 16384
    s_and_b32 s72, s72, 0x1ffff
    ds_read_b128 v[132:135], v202 offset:0
    ds_read_b128 v[136:139], v202 offset:1024
    ds_read_b64_tr_b16 v[164:165], v203 offset:0
    ds_read_b64_tr_b16 v[166:167], v203 offset:1024
    ds_read_b64_tr_b16 v[168:169], v204 offset:0
    ds_read_b64_tr_b16 v[170:171], v204 offset:1024
    s_waitcnt lgkmcnt(0)
    v_mfma_f32_16x16x32_bf16 v[4:7], v[164:167], v[132:135], 0
    ds_read_b128 v[140:143], v202 offset:2048
    v_mfma_f32_16x16x32_bf16 v[8:11], v[168:171], v[132:135], 0
    ds_read_b128 v[144:147], v202 offset:3072
    v_mfma_f32_16x16x32_bf16 v[12:15], v[164:167], v[136:139], 0
    v_mfma_f32_16x16x32_bf16 v[16:19], v[168:171], v[136:139], 0
    s_waitcnt vmcnt(12) lgkmcnt(0)
    s_barrier
    v_mfma_f32_16x16x32_bf16 v[20:23], v[164:167], v[140:143], 0
    v_add_u32 v202, s72, v200
    v_add_u32 v203, s72, v201
    v_xor_b32 v204, 32, v203
    s_add_u32 s72, s72, 16384
    s_and_b32 s72, s72, 0x1ffff
    ds_read_b128 v[132:135], v202 offset:0
    v_mfma_f32_16x16x32_bf16 v[24:27], v[168:171], v[140:143], 0
    ds_read_b64_tr_b16 v[180:181], v203 offset:0
    ds_read_b64_tr_b16 v[182:183], v203 offset:1024
    ds_read_b64_tr_b16 v[184:185], v204 offset:0
    ds_read_b64_tr_b16 v[186:187], v204 offset:1024
    v_mfma_f32_16x16x32_bf16 v[28:31], v[164:167], v[144:147], 0
    ds_read_b128 v[136:139], v202 offset:1024
    s_mov_b32 m0, s71
    s_nop 0
    buffer_load_dwordx4 v196, s[60:63], s68 offen lds
    s_add_u32 m0, s71, 8192
    v_mfma_f32_16x16x32_bf16 v[32:35], v[168:171], v[144:147], 0
    buffer_load_dwordx4 v198, s[64:67], s69 offen lds
    s_add_u32 s68, s68, 64
    s_add_u32 s69, s69, s70
    s_add_u32 s71, s71, 16384
    s_and_b32 s71, s71, 0x1ffff
    s_waitcnt lgkmcnt(0)
    v_mfma_f32_16x16x32_bf16 v[4:7], v[180:183], v[132:135], v[4:7]
    ds_read_b128 v[140:143], v202 offset:2048
    v_mfma_f32_16x16x32_bf16 v[8:11], v[184:187], v[132:135], v[8:11]
    ds_read_b128 v[144:147], v202 offset:3072
    v_mfma_f32_16x16x32_bf16 v[12:15], v[180:183], v[136:139], v[12:15]
    v_mfma_f32_16x16x32_bf16 v[16:19], v[184:187], v[136:139], v[16:19]
    s_waitcnt vmcnt(12) lgkmcnt(0)
    s_barrier
    v_mfma_f32_16x16x32_bf16 v[20:23], v[180:183], v[140:143], v[20:23]
    v_add_u32 v202, s72, v200
    v_add_u32 v203, s72, v201
    v_xor_b32 v204, 32, v203
    s_add_u32 s72, s72, 16384
    s_and_b32 s72, s72, 0x1ffff
    ds_read_b128 v[132:135], v202 offset:0
    v_mfma_f32_16x16x32_bf16 v[24:27], v[184:187], v[140:143], v[24:27]
    ds_read_b64_tr_b16 v[164:165], v203 offset:0
    ds_read_b64_tr_b16 v[166:167], v203 offset:1024
    ds_read_b64_tr_b16 v[168:169], v204 offset:0
    ds_read_b64_tr_b16 v[170:171], v204 offset:1024
    v_mfma_f32_16x16x32_bf16 v[28:31], v[180:183], v[144:147], v[28:31]
    ds_read_b128 v[136:139], v202 offset:1024
    s_mov_b32 m0, s71
    s_nop 0
    buffer_load_dwordx4 v196, s[60:63], s68 offen lds
    s_add_u32 m0, s71, 8192
    v_mfma_f32_16x16x32_bf16 v[32:35], v[184:187], v[144:147], v[32:35]
    buffer_load_dwordx4 v198, s[64:67], s69 offen lds
    s_add_u32 s68, s68, 64
    s_add_u32 s69, s69, s70
    s_add_u32 s71, s71, 16384
    s_and_b32 s71, s71, 0x1ffff
    s_mov_b32 s73, 11
gl_47:
    s_waitcnt lgkmcnt(0)
    v_mfma_f32_16x16x32_bf16 v[4:7], v[164:167], v[132:135], v[4:7]
    ds_read_b128 v[140:143], v202 offset:2048
    v_mfma_f32_16x16x32_bf16 v[8:11], v[168:171], v[132:135], v[8:11]
    ds_read_b128 v[144:147], v202 offset:3072
    v_mfma_f32_16x16x32_bf16 v[12:15], v[164:167], v[136:139], v[12:15]
    v_mfma_f32_16x16x32_bf16 v[16:19], v[168:171], v[136:139], v[16:19]
    s_waitcnt vmcnt(12) lgkmcnt(0)
    s_barrier
    v_mfma_f32_16x16x32_bf16 v[20:23], v[164:167], v[140:143], v[20:23]
    v_add_u32 v202, s72, v200
    v_add_u32 v203, s72, v201
    v_xor_b32 v204, 32, v203
    s_add_u32 s72, s72, 16384
    s_and_b32 s72, s72, 0x1ffff
    ds_read_b128 v[132:135], v202 offset:0
    v_mfma_f32_16x16x32_bf16 v[24:27], v[168:171], v[140:143], v[24:27]
    ds_read_b64_tr_b16 v[180:181], v203 offset:0
    ds_read_b64_tr_b16 v[182:183], v203 offset:1024
    ds_read_b64_tr_b16 v[184:185], v204 offset:0
    ds_read_b64_tr_b16 v[186:187], v204 offset:1024
    v_mfma_f32_16x16x32_bf16 v[28:31], v[164:167], v[144:147], v[28:31]
    ds_read_b128 v[136:139], v202 offset:1024
    s_mov_b32 m0, s71
    s_nop 0
    buffer_load_dwordx4 v196, s[60:63], s68 offen lds
    s_add_u32 m0, s71, 8192
    v_mfma_f32_16x16x32_bf16 v[32:35], v[168:171], v[144:147], v[32:35]
    buffer_load_dwordx4 v198, s[64:67], s69 offen lds
    s_add_u32 s68, s68, 64
    s_add_u32 s69, s69, s70
    s_add_u32 s71, s71, 16384
    s_and_b32 s71, s71, 0x1ffff
    s_waitcnt lgkmcnt(0)
    v_mfma_f32_16x16x32_bf16 v[4:7], v[180:183], v[132:135], v[4:7]
    ds_read_b128 v[140:143], v202 offset:2048
    v_mfma_f32_16x16x32_bf16 v[8:11], v[184:187], v[132:135], v[8:11]
    ds_read_b128 v[144:147], v202 offset:3072
    v_mfma_f32_16x16x32_bf16 v[12:15], v[180:183], v[136:139], v[12:15]
    v_mfma_f32_16x16x32_bf16 v[16:19], v[184:187], v[136:139], v[16:19]
    s_waitcnt vmcnt(12) lgkmcnt(0)
    s_barrier
    v_mfma_f32_16x16x32_bf16 v[20:23], v[180:183], v[140:143], v[20:23]
    v_add_u32 v202, s72, v200
    v_add_u32 v203, s72, v201
    v_xor_b32 v204, 32, v203
    s_add_u32 s72, s72, 16384
    s_and_b32 s72, s72, 0x1ffff
    ds_read_b128 v[132:135], v202 offset:0
    v_mfma_f32_16x16x32_bf16 v[24:27], v[184:187], v[140:143], v[24:27]
    ds_read_b64_tr_b16 v[164:165], v203 offset:0
    ds_read_b64_tr_b16 v[166:167], v203 offset:1024
    ds_read_b64_tr_b16 v[168:169], v204 offset:0
    ds_read_b64_tr_b16 v[170:171], v204 offset:1024
    v_mfma_f32_16x16x32_bf16 v[28:31], v[180:183], v[144:147], v[28:31]
    ds_read_b128 v[136:139], v202 offset:1024
    s_mov_b32 m0, s71
    s_nop 0
    buffer_load_dwordx4 v196, s[60:63], s68 offen lds
    s_add_u32 m0, s71, 8192
    v_mfma_f32_16x16x32_bf16 v[32:35], v[184:187], v[144:147], v[32:35]
    buffer_load_dwordx4 v198, s[64:67], s69 offen lds
    s_add_u32 s68, s68, 64
    s_add_u32 s69, s69, s70
    s_add_u32 s71, s71, 16384
    s_and_b32 s71, s71, 0x1ffff
    s_sub_u32 s73, s73, 1
    s_cmp_lg_u32 s73, 0
    s_cbranch_scc1 gl_47
    s_waitcnt lgkmcnt(0)
    v_mfma_f32_16x16x32_bf16 v[4:7], v[164:167], v[132:135], v[4:7]
    ds_read_b128 v[140:143], v202 offset:2048
    v_mfma_f32_16x16x32_bf16 v[8:11], v[168:171], v[132:135], v[8:11]
    ds_read_b128 v[144:147], v202 offset:3072
    v_mfma_f32_16x16x32_bf16 v[12:15], v[164:167], v[136:139], v[12:15]
    v_mfma_f32_16x16x32_bf16 v[16:19], v[168:171], v[136:139], v[16:19]
    s_waitcnt vmcnt(12) lgkmcnt(0)
    s_barrier
    v_mfma_f32_16x16x32_bf16 v[20:23], v[164:167], v[140:143], v[20:23]
    v_add_u32 v202, s72, v200
    v_add_u32 v203, s72, v201
    v_xor_b32 v204, 32, v203
    s_add_u32 s72, s72, 16384
    s_and_b32 s72, s72, 0x1ffff
    v_mfma_f32_16x16x32_bf16 v[24:27], v[168:171], v[140:143], v[24:27]
    ds_read_b128 v[132:135], v202 offset:0
    ds_read_b64_tr_b16 v[180:181], v203 offset:0
    v_mfma_f32_16x16x32_bf16 v[28:31], v[164:167], v[144:147], v[28:31]
    ds_read_b64_tr_b16 v[182:183], v203 offset:1024
    ds_read_b64_tr_b16 v[184:185], v204 offset:0
    v_mfma_f32_16x16x32_bf16 v[32:35], v[168:171], v[144:147], v[32:35]
    ds_read_b64_tr_b16 v[186:187], v204 offset:1024
    ds_read_b128 v[136:139], v202 offset:1024
    s_waitcnt lgkmcnt(0)
    v_mfma_f32_16x16x32_bf16 v[4:7], v[180:183], v[132:135], v[4:7]
    ds_read_b128 v[140:143], v202 offset:2048
    v_mfma_f32_16x16x32_bf16 v[8:11], v[184:187], v[132:135], v[8:11]
    ds_read_b128 v[144:147], v202 offset:3072
    v_mfma_f32_16x16x32_bf16 v[12:15], v[180:183], v[136:139], v[12:15]
    v_mfma_f32_16x16x32_bf16 v[16:19], v[184:187], v[136:139], v[16:19]
    s_waitcnt vmcnt(10) lgkmcnt(0)
    s_barrier
    v_mfma_f32_16x16x32_bf16 v[20:23], v[180:183], v[140:143], v[20:23]
    v_add_u32 v202, s72, v200
    v_add_u32 v203, s72, v201
    v_xor_b32 v204, 32, v203
    s_add_u32 s72, s72, 16384
    s_and_b32 s72, s72, 0x1ffff
    v_mfma_f32_16x16x32_bf16 v[24:27], v[184:187], v[140:143], v[24:27]
    ds_read_b128 v[132:135], v202 offset:0
    ds_read_b64_tr_b16 v[164:165], v203 offset:0
    v_mfma_f32_16x16x32_bf16 v[28:31], v[180:183], v[144:147], v[28:31]
    ds_read_b64_tr_b16 v[166:167], v203 offset:1024
    ds_read_b64_tr_b16 v[168:169], v204 offset:0
    v_mfma_f32_16x16x32_bf16 v[32:35], v[184:187], v[144:147], v[32:35]
    ds_read_b64_tr_b16 v[170:171], v204 offset:1024
    ds_read_b128 v[136:139], v202 offset:1024
    s_waitcnt lgkmcnt(0)
    v_mfma_f32_16x16x32_bf16 v[4:7], v[164:167], v[132:135], v[4:7]
    ds_read_b128 v[140:143], v202 offset:2048
    v_mfma_f32_16x16x32_bf16 v[8:11], v[168:171], v[132:135], v[8:11]
    ds_read_b128 v[144:147], v202 offset:3072
    v_mfma_f32_16x16x32_bf16 v[12:15], v[164:167], v[136:139], v[12:15]
    v_mfma_f32_16x16x32_bf16 v[16:19], v[168:171], v[136:139], v[16:19]
    s_waitcnt vmcnt(8) lgkmcnt(0)
    s_barrier
    v_mfma_f32_16x16x32_bf16 v[20:23], v[164:167], v[140:143], v[20:23]
    v_add_u32 v202, s72, v200
    v_add_u32 v203, s72, v201
    v_xor_b32 v204, 32, v203
    s_add_u32 s72, s72, 16384
    s_and_b32 s72, s72, 0x1ffff
    v_mfma_f32_16x16x32_bf16 v[24:27], v[168:171], v[140:143], v[24:27]
    ds_read_b128 v[132:135], v202 offset:0
    ds_read_b64_tr_b16 v[180:181], v203 offset:0
    v_mfma_f32_16x16x32_bf16 v[28:31], v[164:167], v[144:147], v[28:31]
    ds_read_b64_tr_b16 v[182:183], v203 offset:1024
    ds_read_b64_tr_b16 v[184:185], v204 offset:0
    v_mfma_f32_16x16x32_bf16 v[32:35], v[168:171], v[144:147], v[32:35]
    ds_read_b64_tr_b16 v[186:187], v204 offset:1024
    ds_read_b128 v[136:139], v202 offset:1024
    s_waitcnt lgkmcnt(0)
    v_mfma_f32_16x16x32_bf16 v[4:7], v[180:183], v[132:135], v[4:7]
    ds_read_b128 v[140:143], v202 offset:2048
    v_mfma_f32_16x16x32_bf16 v[8:11], v[184:187], v[132:135], v[8:11]
    ds_read_b128 v[144:147], v202 offset:3072
    v_mfma_f32_16x16x32_bf16 v[12:15], v[180:183], v[136:139], v[12:15]
    v_mfma_f32_16x16x32_bf16 v[16:19], v[184:187], v[136:139], v[16:19]
    s_waitcnt vmcnt(6) lgkmcnt(0)
    s_barrier
    v_mfma_f32_16x16x32_bf16 v[20:23], v[180:183], v[140:143], v[20:23]
    v_add_u32 v202, s72, v200
    v_add_u32 v203, s72, v201
    v_xor_b32 v204, 32, v203
    s_add_u32 s72, s72, 16384
    s_and_b32 s72, s72, 0x1ffff
    v_mfma_f32_16x16x32_bf16 v[24:27], v[184:187], v[140:143], v[24:27]
    ds_read_b128 v[132:135], v202 offset:0
    ds_read_b64_tr_b16 v[164:165], v203 offset:0
    v_mfma_f32_16x16x32_bf16 v[28:31], v[180:183], v[144:147], v[28:31]
    ds_read_b64_tr_b16 v[166:167], v203 offset:1024
    ds_read_b64_tr_b16 v[168:169], v204 offset:0
    v_mfma_f32_16x16x32_bf16 v[32:35], v[184:187], v[144:147], v[32:35]
    ds_read_b64_tr_b16 v[170:171], v204 offset:1024
    ds_read_b128 v[136:139], v202 offset:1024
    s_waitcnt lgkmcnt(0)
    v_mfma_f32_16x16x32_bf16 v[4:7], v[164:167], v[132:135], v[4:7]
    ds_read_b128 v[140:143], v202 offset:2048
    v_mfma_f32_16x16x32_bf16 v[8:11], v[168:171], v[132:135], v[8:11]
    ds_read_b128 v[144:147], v202 offset:3072
    v_mfma_f32_16x16x32_bf16 v[12:15], v[164:167], v[136:139], v[12:15]
    v_mfma_f32_16x16x32_bf16 v[16:19], v[168:171], v[136:139], v[16:19]
    s_waitcnt vmcnt(4) lgkmcnt(0)
    s_barrier
    v_mfma_f32_16x16x32_bf16 v[20:23], v[164:167], v[140:143], v[20:23]
    v_add_u32 v202, s72, v200
    v_add_u32 v203, s72, v201
    v_xor_b32 v204, 32, v203
    s_add_u32 s72, s72, 16384
    s_and_b32 s72, s72, 0x1ffff
    v_mfma_f32_16x16x32_bf16 v[24:27], v[168:171], v[140:143], v[24:27]
    ds_read_b128 v[132:135], v202 offset:0
    ds_read_b64_tr_b16 v[180:181], v203 offset:0
    v_mfma_f32_16x16x32_bf16 v[28:31], v[164:167], v[144:147], v[28:31]
    ds_read_b64_tr_b16 v[182:183], v203 offset:1024
    ds_read_b64_tr_b16 v[184:185], v204 offset:0
    v_mfma_f32_16x16x32_bf16 v[32:35], v[168:171], v[144:147], v[32:35]
    ds_read_b64_tr_b16 v[186:187], v204 offset:1024
    ds_read_b128 v[136:139], v202 offset:1024
    s_waitcnt lgkmcnt(0)
    v_mfma_f32_16x16x32_bf16 v[4:7], v[180:183], v[132:135], v[4:7]
    ds_read_b128 v[140:143], v202 offset:2048
    v_mfma_f32_16x16x32_bf16 v[8:11], v[184:187], v[132:135], v[8:11]
    ds_read_b128 v[144:147], v202 offset:3072
    v_mfma_f32_16x16x32_bf16 v[12:15], v[180:183], v[136:139], v[12:15]
    v_mfma_f32_16x16x32_bf16 v[16:19], v[184:187], v[136:139], v[16:19]
    s_waitcnt vmcnt(2) lgkmcnt(0)
    s_barrier
    v_mfma_f32_16x16x32_bf16 v[20:23], v[180:183], v[140:143], v[20:23]
    v_add_u32 v202, s72, v200
    v_add_u32 v203, s72, v201
    v_xor_b32 v204, 32, v203
    s_add_u32 s72, s72, 16384
    s_and_b32 s72, s72, 0x1ffff
    v_mfma_f32_16x16x32_bf16 v[24:27], v[184:187], v[140:143], v[24:27]
    ds_read_b128 v[132:135], v202 offset:0
    ds_read_b64_tr_b16 v[164:165], v203 offset:0
    v_mfma_f32_16x16x32_bf16 v[28:31], v[180:183], v[144:147], v[28:31]
    ds_read_b64_tr_b16 v[166:167], v203 offset:1024
    ds_read_b64_tr_b16 v[168:169], v204 offset:0
    v_mfma_f32_16x16x32_bf16 v[32:35], v[184:187], v[144:147], v[32:35]
    ds_read_b64_tr_b16 v[170:171], v204 offset:1024
    ds_read_b128 v[136:139], v202 offset:1024
    s_waitcnt lgkmcnt(0)
    v_mfma_f32_16x16x32_bf16 v[4:7], v[164:167], v[132:135], v[4:7]
    ds_read_b128 v[140:143], v202 offset:2048
    v_mfma_f32_16x16x32_bf16 v[8:11], v[168:171], v[132:135], v[8:11]
    ds_read_b128 v[144:147], v202 offset:3072
    v_mfma_f32_16x16x32_bf16 v[12:15], v[164:167], v[136:139], v[12:15]
    v_mfma_f32_16x16x32_bf16 v[16:19], v[168:171], v[136:139], v[16:19]
    s_waitcnt vmcnt(0) lgkmcnt(0)
    s_barrier
    v_mfma_f32_16x16x32_bf16 v[20:23], v[164:167], v[140:143], v[20:23]
    v_add_u32 v202, s72, v200
    v_add_u32 v203, s72, v201
    v_xor_b32 v204, 32, v203
    s_add_u32 s72, s72, 16384
    s_and_b32 s72, s72, 0x1ffff
    v_mfma_f32_16x16x32_bf16 v[24:27], v[168:171], v[140:143], v[24:27]
    ds_read_b128 v[132:135], v202 offset:0
    ds_read_b64_tr_b16 v[180:181], v203 offset:0
    v_mfma_f32_16x16x32_bf16 v[28:31], v[164:167], v[144:147], v[28:31]
    ds_read_b64_tr_b16 v[182:183], v203 offset:1024
    ds_read_b64_tr_b16 v[184:185], v204 offset:0
    v_mfma_f32_16x16x32_bf16 v[32:35], v[168:171], v[144:147], v[32:35]
    ds_read_b64_tr_b16 v[186:187], v204 offset:1024
    ds_read_b128 v[136:139], v202 offset:1024
    s_waitcnt lgkmcnt(0)
    v_mfma_f32_16x16x32_bf16 v[4:7], v[180:183], v[132:135], v[4:7]
    ds_read_b128 v[140:143], v202 offset:2048
    v_mfma_f32_16x16x32_bf16 v[8:11], v[184:187], v[132:135], v[8:11]
    ds_read_b128 v[144:147], v202 offset:3072
    v_mfma_f32_16x16x32_bf16 v[12:15], v[180:183], v[136:139], v[12:15]
    v_mfma_f32_16x16x32_bf16 v[16:19], v[184:187], v[136:139], v[16:19]
    s_waitcnt lgkmcnt(0)
    v_mfma_f32_16x16x32_bf16 v[20:23], v[180:183], v[140:143], v[20:23]
    v_mfma_f32_16x16x32_bf16 v[24:27], v[184:187], v[140:143], v[24:27]
    v_mfma_f32_16x16x32_bf16 v[28:31], v[180:183], v[144:147], v[28:31]
    v_mfma_f32_16x16x32_bf16 v[32:35], v[184:187], v[144:147], v[32:35]
    v_cvt_pk_bf16_f32 v132, v4, v5
    v_cvt_pk_bf16_f32 v133, v6, v7
    v_cvt_pk_bf16_f32 v134, v8, v9
    v_cvt_pk_bf16_f32 v135, v10, v11
    buffer_store_dwordx4 v[132:135], v207, s[8:11], s81 offen offset:0 sc1
    v_cvt_pk_bf16_f32 v136, v12, v13
    v_cvt_pk_bf16_f32 v137, v14, v15
    v_cvt_pk_bf16_f32 v138, v16, v17
    v_cvt_pk_bf16_f32 v139, v18, v19
    buffer_store_dwordx4 v[136:139], v207, s[8:11], s81 offen offset:256 sc1
    s_add_u32 s81, s81, s82
    v_cvt_pk_bf16_f32 v140, v20, v21
    v_cvt_pk_bf16_f32 v141, v22, v23
    v_cvt_pk_bf16_f32 v142, v24, v25
    v_cvt_pk_bf16_f32 v143, v26, v27
    buffer_store_dwordx4 v[140:143], v207, s[8:11], s81 offen offset:0 sc1
    v_cvt_pk_bf16_f32 v144, v28, v29
    v_cvt_pk_bf16_f32 v145, v30, v31
    v_cvt_pk_bf16_f32 v146, v32, v33
    v_cvt_pk_bf16_f32 v147, v34, v35
    buffer_store_dwordx4 v[144:147], v207, s[8:11], s81 offen offset:256 sc1
    s_branch next_43
t128_40:
    s_mov_b32 s72, 0
    s_waitcnt vmcnt(14)
    s_barrier
    v_add_u32 v202, s72, v200
    v_add_u32 v203, s72, v201
    v_xor_b32 v204, 32, v203
    s_add_u32 s72, s72, 16384
    s_and_b32 s72, s72, 0x1ffff
    ds_read_b128 v[132:135], v202 offset:0
    ds_read_b128 v[136:139], v202 offset:1024
    ds_read_b64_tr_b16 v[164:165], v203 offset:0
    ds_read_b64_tr_b16 v[166:167], v203 offset:1024
    ds_read_b64_tr_b16 v[168:169], v204 offset:0
    ds_read_b64_tr_b16 v[170:171], v204 offset:1024
    s_waitcnt lgkmcnt(0)
    v_mfma_f32_16x16x32_bf16 v[4:7], v[132:135], v[164:167], 0
    ds_read_b128 v[140:143], v202 offset:2048
    v_mfma_f32_16x16x32_bf16 v[8:11], v[132:135], v[168:171], 0
    ds_read_b128 v[144:147], v202 offset:3072
    v_mfma_f32_16x16x32_bf16 v[12:15], v[136:139], v[164:167], 0
    v_mfma_f32_16x16x32_bf16 v[16:19], v[136:139], v[168:171], 0
    s_waitcnt vmcnt(12) lgkmcnt(0)
    s_barrier
    v_mfma_f32_16x16x32_bf16 v[20:23], v[140:143], v[164:167], 0
    v_add_u32 v202, s72, v200
    v_add_u32 v203, s72, v201
    v_xor_b32 v204, 32, v203
    s_add_u32 s72, s72, 16384
    s_and_b32 s72, s72, 0x1ffff
    ds_read_b128 v[132:135], v202 offset:0
    v_mfma_f32_16x16x32_bf16 v[24:27], v[140:143], v[168:171], 0
    ds_read_b64_tr_b16 v[180:181], v203 offset:0
    ds_read_b64_tr_b16 v[182:183], v203 offset:1024
    ds_read_b64_tr_b16 v[184:185], v204 offset:0
    ds_read_b64_tr_b16 v[186:187], v204 offset:1024
    v_mfma_f32_16x16x32_bf16 v[28:31], v[144:147], v[164:167], 0
    ds_read_b128 v[136:139], v202 offset:1024
    s_mov_b32 m0, s71
    s_nop 0
    buffer_load_dwordx4 v196, s[60:63], s68 offen lds
    s_add_u32 m0, s71, 8192
    v_mfma_f32_16x16x32_bf16 v[32:35], v[144:147], v[168:171], 0
    buffer_load_dwordx4 v198, s[64:67], s69 offen lds
    s_add_u32 s68, s68, 64
    s_add_u32 s69, s69, s70
    s_add_u32 s71, s71, 16384
    s_and_b32 s71, s71, 0x1ffff
    s_waitcnt lgkmcnt(0)
    v_mfma_f32_16x16x32_bf16 v[4:7], v[132:135], v[180:183], v[4:7]
    ds_read_b128 v[140:143], v202 offset:2048
    v_mfma_f32_16x16x32_bf16 v[8:11], v[132:135], v[184:187], v[8:11]
    ds_read_b128 v[144:147], v202 offset:3072
    v_mfma_f32_16x16x32_bf16 v[12:15], v[136:139], v[180:183], v[12:15]
    v_mfma_f32_16x16x32_bf16 v[16:19], v[136:139], v[184:187], v[16:19]
    s_waitcnt vmcnt(12) lgkmcnt(0)
    s_barrier
    v_mfma_f32_16x16x32_bf16 v[20:23], v[140:143], v[180:183], v[20:23]
    v_add_u32 v202, s72, v200
    v_add_u32 v203, s72, v201
    v_xor_b32 v204, 32, v203
    s_add_u32 s72, s72, 16384
    s_and_b32 s72, s72, 0x1ffff
    ds_read_b128 v[132:135], v202 offset:0
    v_mfma_f32_16x16x32_bf16 v[24:27], v[140:143], v[184:187], v[24:27]
    ds_read_b64_tr_b16 v[164:165], v203 offset:0
    ds_read_b64_tr_b16 v[166:167], v203 offset:1024
    ds_read_b64_tr_b16 v[168:169], v204 offset:0
    ds_read_b64_tr_b16 v[170:171], v204 offset:1024
    v_mfma_f32_16x16x32_bf16 v[28:31], v[144:147], v[180:183], v[28:31]
    ds_read_b128 v[136:139], v202 offset:1024
    s_mov_b32 m0, s71
    s_nop 0
    buffer_load_dwordx4 v196, s[60:63], s68 offen lds
    s_add_u32 m0, s71, 8192
    v_mfma_f32_16x16x32_bf16 v[32:35], v[144:147], v[184:187], v[32:35]
    buffer_load_dwordx4 v198, s[64:67], s69 offen lds
    s_add_u32 s68, s68, 64
    s_add_u32 s69, s69, s70
    s_add_u32 s71, s71, 16384
    s_and_b32 s71, s71, 0x1ffff
    s_mov_b32 s73, 11
gl_48:
    s_waitcnt lgkmcnt(0)
    v_mfma_f32_16x16x32_bf16 v[4:7], v[132:135], v[164:167], v[4:7]
    ds_read_b128 v[140:143], v202 offset:2048
    v_mfma_f32_16x16x32_bf16 v[8:11], v[132:135], v[168:171], v[8:11]
    ds_read_b128 v[144:147], v202 offset:3072
    v_mfma_f32_16x16x32_bf16 v[12:15], v[136:139], v[164:167], v[12:15]
    v_mfma_f32_16x16x32_bf16 v[16:19], v[136:139], v[168:171], v[16:19]
    s_waitcnt vmcnt(12) lgkmcnt(0)
    s_barrier
    v_mfma_f32_16x16x32_bf16 v[20:23], v[140:143], v[164:167], v[20:23]
    v_add_u32 v202, s72, v200
    v_add_u32 v203, s72, v201
    v_xor_b32 v204, 32, v203
    s_add_u32 s72, s72, 16384
    s_and_b32 s72, s72, 0x1ffff
    ds_read_b128 v[132:135], v202 offset:0
    v_mfma_f32_16x16x32_bf16 v[24:27], v[140:143], v[168:171], v[24:27]
    ds_read_b64_tr_b16 v[180:181], v203 offset:0
    ds_read_b64_tr_b16 v[182:183], v203 offset:1024
    ds_read_b64_tr_b16 v[184:185], v204 offset:0
    ds_read_b64_tr_b16 v[186:187], v204 offset:1024
    v_mfma_f32_16x16x32_bf16 v[28:31], v[144:147], v[164:167], v[28:31]
    ds_read_b128 v[136:139], v202 offset:1024
    s_mov_b32 m0, s71
    s_nop 0
    buffer_load_dwordx4 v196, s[60:63], s68 offen lds
    s_add_u32 m0, s71, 8192
    v_mfma_f32_16x16x32_bf16 v[32:35], v[144:147], v[168:171], v[32:35]
    buffer_load_dwordx4 v198, s[64:67], s69 offen lds
    s_add_u32 s68, s68, 64
    s_add_u32 s69, s69, s70
    s_add_u32 s71, s71, 16384
    s_and_b32 s71, s71, 0x1ffff
    s_waitcnt lgkmcnt(0)
    v_mfma_f32_16x16x32_bf16 v[4:7], v[132:135], v[180:183], v[4:7]
    ds_read_b128 v[140:143], v202 offset:2048
    v_mfma_f32_16x16x32_bf16 v[8:11], v[132:135], v[184:187], v[8:11]
    ds_read_b128 v[144:147], v202 offset:3072
    v_mfma_f32_16x16x32_bf16 v[12:15], v[136:139], v[180:183], v[12:15]
    v_mfma_f32_16x16x32_bf16 v[16:19], v[136:139], v[184:187], v[16:19]
    s_waitcnt vmcnt(12) lgkmcnt(0)
    s_barrier
    v_mfma_f32_16x16x32_bf16 v[20:23], v[140:143], v[180:183], v[20:23]
    v_add_u32 v202, s72, v200
    v_add_u32 v203, s72, v201
    v_xor_b32 v204, 32, v203
    s_add_u32 s72, s72, 16384
    s_and_b32 s72, s72, 0x1ffff
    ds_read_b128 v[132:135], v202 offset:0
    v_mfma_f32_16x16x32_bf16 v[24:27], v[140:143], v[184:187], v[24:27]
    ds_read_b64_tr_b16 v[164:165], v203 offset:0
    ds_read_b64_tr_b16 v[166:167], v203 offset:1024
    ds_read_b64_tr_b16 v[168:169], v204 offset:0
    ds_read_b64_tr_b16 v[170:171], v204 offset:1024
    v_mfma_f32_16x16x32_bf16 v[28:31], v[144:147], v[180:183], v[28:31]
    ds_read_b128 v[136:139], v202 offset:1024
    s_mov_b32 m0, s71
    s_nop 0
    buffer_load_dwordx4 v196, s[60:63], s68 offen lds
    s_add_u32 m0, s71, 8192
    v_mfma_f32_16x16x32_bf16 v[32:35], v[144:147], v[184:187], v[32:35]
    buffer_load_dwordx4 v198, s[64:67], s69 offen lds
    s_add_u32 s68, s68, 64
    s_add_u32 s69, s69, s70
    s_add_u32 s71, s71, 16384
    s_and_b32 s71, s71, 0x1ffff
    s_sub_u32 s73, s73, 1
    s_cmp_lg_u32 s73, 0
    s_cbranch_scc1 gl_48
    s_waitcnt lgkmcnt(0)
    v_mfma_f32_16x16x32_bf16 v[4:7], v[132:135], v[164:167], v[4:7]
    ds_read_b128 v[140:143], v202 offset:2048
    v_mfma_f32_16x16x32_bf16 v[8:11], v[132:135], v[168:171], v[8:11]
    ds_read_b128 v[144:147], v202 offset:3072
    v_mfma_f32_16x16x32_bf16 v[12:15], v[136:139], v[164:167], v[12:15]
    v_mfma_f32_16x16x32_bf16 v[16:19], v[136:139], v[168:171], v[16:19]
    s_waitcnt vmcnt(12) lgkmcnt(0)
    s_barrier
    v_mfma_f32_16x16x32_bf16 v[20:23], v[140:143], v[164:167], v[20:23]
    v_add_u32 v202, s72, v200
    v_add_u32 v203, s72, v201
    v_xor_b32 v204, 32, v203
    s_add_u32 s72, s72, 16384
    s_and_b32 s72, s72, 0x1ffff
    v_mfma_f32_16x16x32_bf16 v[24:27], v[140:143], v[168:171], v[24:27]
    ds_read_b128 v[132:135], v202 offset:0
    ds_read_b64_tr_b16 v[180:181], v203 offset:0
    v_mfma_f32_16x16x32_bf16 v[28:31], v[144:147], v[164:167], v[28:31]
    ds_read_b64_tr_b16 v[182:183], v203 offset:1024
    ds_read_b64_tr_b16 v[184:185], v204 offset:0
    v_mfma_f32_16x16x32_bf16 v[32:35], v[144:147], v[168:171], v[32:35]
    ds_read_b64_tr_b16 v[186:187], v204 offset:1024
    ds_read_b128 v[136:139], v202 offset:1024
    s_waitcnt lgkmcnt(0)
    v_mfma_f32_16x16x32_bf16 v[4:7], v[132:135], v[180:183], v[4:7]
    ds_read_b128 v[140:143], v202 offset:2048
    v_mfma_f32_16x16x32_bf16 v[8:11], v[132:135], v[184:187], v[8:11]
    ds_read_b128 v[144:147], v202 offset:3072
    v_mfma_f32_16x16x32_bf16 v[12:15], v[136:139], v[180:183], v[12:15]
    v_mfma_f32_16x16x32_bf16 v[16:19], v[136:139], v[184:187], v[16:19]
    s_waitcnt vmcnt(10) lgkmcnt(0)
    s_barrier
    v_mfma_f32_16x16x32_bf16 v[20:23], v[140:143], v[180:183], v[20:23]
    v_add_u32 v202, s72, v200
    v_add_u32 v203, s72, v201
    v_xor_b32 v204, 32, v203
    s_add_u32 s72, s72, 16384
    s_and_b32 s72, s72, 0x1ffff
    v_mfma_f32_16x16x32_bf16 v[24:27], v[140:143], v[184:187], v[24:27]
    ds_read_b128 v[132:135], v202 offset:0
    ds_read_b64_tr_b16 v[164:165], v203 offset:0
    v_mfma_f32_16x16x32_bf16 v[28:31], v[144:147], v[180:183], v[28:31]
    ds_read_b64_tr_b16 v[166:167], v203 offset:1024
    ds_read_b64_tr_b16 v[168:169], v204 offset:0
    v_mfma_f32_16x16x32_bf16 v[32:35], v[144:147], v[184:187], v[32:35]
    ds_read_b64_tr_b16 v[170:171], v204 offset:1024
    ds_read_b128 v[136:139], v202 offset:1024
    s_waitcnt lgkmcnt(0)
    v_mfma_f32_16x16x32_bf16 v[4:7], v[132:135], v[164:167], v[4:7]
    ds_read_b128 v[140:143], v202 offset:2048
    v_mfma_f32_16x16x32_bf16 v[8:11], v[132:135], v[168:171], v[8:11]
    ds_read_b128 v[144:147], v202 offset:3072
    v_mfma_f32_16x16x32_bf16 v[12:15], v[136:139], v[164:167], v[12:15]
    v_mfma_f32_16x16x32_bf16 v[16:19], v[136:139], v[168:171], v[16:19]
    s_waitcnt vmcnt(8) lgkmcnt(0)
    s_barrier
    v_mfma_f32_16x16x32_bf16 v[20:23], v[140:143], v[164:167], v[20:23]
    v_add_u32 v202, s72, v200
    v_add_u32 v203, s72, v201
    v_xor_b32 v204, 32, v203
    s_add_u32 s72, s72, 16384
    s_and_b32 s72, s72, 0x1ffff
    v_mfma_f32_16x16x32_bf16 v[24:27], v[140:143], v[168:171], v[24:27]
    ds_read_b128 v[132:135], v202 offset:0
    ds_read_b64_tr_b16 v[180:181], v203 offset:0
    v_mfma_f32_16x16x32_bf16 v[28:31], v[144:147], v[164:167], v[28:31]
    ds_read_b64_tr_b16 v[182:183], v203 offset:1024
    ds_read_b64_tr_b16 v[184:185], v204 offset:0
    v_mfma_f32_16x16x32_bf16 v[32:35], v[144:147], v[168:171], v[32:35]
    ds_read_b64_tr_b16 v[186:187], v204 offset:1024
    ds_read_b128 v[136:139], v202 offset:1024
    s_waitcnt lgkmcnt(0)
    v_mfma_f32_16x16x32_bf16 v[4:7], v[132:135], v[180:183], v[4:7]
    ds_read_b128 v[140:143], v202 offset:2048
    v_mfma_f32_16x16x32_bf16 v[8:11], v[132:135], v[184:187], v[8:11]
    ds_read_b128 v[144:147], v202 offset:3072
    v_mfma_f32_16x16x32_bf16 v[12:15], v[136:139], v[180:183], v[12:15]
    v_mfma_f32_16x16x32_bf16 v[16:19], v[136:139], v[184:187], v[16:19]
    s_waitcnt vmcnt(6) lgkmcnt(0)
    s_barrier
    v_mfma_f32_16x16x32_bf16 v[20:23], v[140:143], v[180:183], v[20:23]
    v_add_u32 v202, s72, v200
    v_add_u32 v203, s72, v201
    v_xor_b32 v204, 32, v203
    s_add_u32 s72, s72, 16384
    s_and_b32 s72, s72, 0x1ffff
    v_mfma_f32_16x16x32_bf16 v[24:27], v[140:143], v[184:187], v[24:27]
    ds_read_b128 v[132:135], v202 offset:0
    ds_read_b64_tr_b16 v[164:165], v203 offset:0
    v_mfma_f32_16x16x32_bf16 v[28:31], v[144:147], v[180:183], v[28:31]
    ds_read_b64_tr_b16 v[166:167], v203 offset:1024
    ds_read_b64_tr_b16 v[168:169], v204 offset:0
    v_mfma_f32_16x16x32_bf16 v[32:35], v[144:147], v[184:187], v[32:35]
    ds_read_b64_tr_b16 v[170:171], v204 offset:1024
    ds_read_b128 v[136:139], v202 offset:1024
    s_waitcnt lgkmcnt(0)
    v_mfma_f32_16x16x32_bf16 v[4:7], v[132:135], v[164:167], v[4:7]
    ds_read_b128 v[140:143], v202 offset:2048
    v_mfma_f32_16x16x32_bf16 v[8:11], v[132:135], v[168:171], v[8:11]
    ds_read_b128 v[144:147], v202 offset:3072
    v_mfma_f32_16x16x32_bf16 v[12:15], v[136:139], v[164:167], v[12:15]
    v_mfma_f32_16x16x32_bf16 v[16:19], v[136:139], v[168:171], v[16:19]
    s_waitcnt vmcnt(4) lgkmcnt(0)
    s_barrier
    v_mfma_f32_16x16x32_bf16 v[20:23], v[140:143], v[164:167], v[20:23]
    v_add_u32 v202, s72, v200
    v_add_u32 v203, s72, v201
    v_xor_b32 v204, 32, v203
    s_add_u32 s72, s72, 16384
    s_and_b32 s72, s72, 0x1ffff
    v_mfma_f32_16x16x32_bf16 v[24:27], v[140:143], v[168:171], v[24:27]
    ds_read_b128 v[132:135], v202 offset:0
    ds_read_b64_tr_b16 v[180:181], v203 offset:0
    v_mfma_f32_16x16x32_bf16 v[28:31], v[144:147], v[164:167], v[28:31]
    ds_read_b64_tr_b16 v[182:183], v203 offset:1024
    ds_read_b64_tr_b16 v[184:185], v204 offset:0
    v_mfma_f32_16x16x32_bf16 v[32:35], v[144:147], v[168:171], v[32:35]
    ds_read_b64_tr_b16 v[186:187], v204 offset:1024
    ds_read_b128 v[136:139], v202 offset:1024
    s_waitcnt lgkmcnt(0)
    v_mfma_f32_16x16x32_bf16 v[4:7], v[132:135], v[180:183], v[4:7]
    ds_read_b128 v[140:143], v202 offset:2048
    v_mfma_f32_16x16x32_bf16 v[8:11], v[132:135], v[184:187], v[8:11]
    ds_read_b128 v[144:147], v202 offset:3072
    v_mfma_f32_16x16x32_bf16 v[12:15], v[136:139], v[180:183], v[12:15]
    v_mfma_f32_16x16x32_bf16 v[16:19], v[136:139], v[184:187], v[16:19]
    s_waitcnt vmcnt(2) lgkmcnt(0)
    s_barrier
    v_mfma_f32_16x16x32_bf16 v[20:23], v[140:143], v[180:183], v[20:23]
    v_add_u32 v202, s72, v200
    v_add_u32 v203, s72, v201
    v_xor_b32 v204, 32, v203
    s_add_u32 s72, s72, 16384
    s_and_b32 s72, s72, 0x1ffff
    v_mfma_f32_16x16x32_bf16 v[24:27], v[140:143], v[184:187], v[24:27]
    ds_read_b128 v[132:135], v202 offset:0
    ds_read_b64_tr_b16 v[164:165], v203 offset:0
    v_mfma_f32_16x16x32_bf16 v[28:31], v[144:147], v[180:183], v[28:31]
    ds_read_b64_tr_b16 v[166:167], v203 offset:1024
    ds_read_b64_tr_b16 v[168:169], v204 offset:0
    v_mfma_f32_16x16x32_bf16 v[32:35], v[144:147], v[184:187], v[32:35]
    ds_read_b64_tr_b16 v[170:171], v204 offset:1024
    ds_read_b128 v[136:139], v202 offset:1024
    s_waitcnt lgkmcnt(0)
    v_mfma_f32_16x16x32_bf16 v[4:7], v[132:135], v[164:167], v[4:7]
    ds_read_b128 v[140:143], v202 offset:2048
    v_mfma_f32_16x16x32_bf16 v[8:11], v[132:135], v[168:171], v[8:11]
    ds_read_b128 v[144:147], v202 offset:3072
    v_mfma_f32_16x16x32_bf16 v[12:15], v[136:139], v[164:167], v[12:15]
    v_mfma_f32_16x16x32_bf16 v[16:19], v[136:139], v[168:171], v[16:19]
    s_waitcnt vmcnt(0) lgkmcnt(0)
    s_barrier
    v_mfma_f32_16x16x32_bf16 v[20:23], v[140:143], v[164:167], v[20:23]
    v_add_u32 v202, s72, v200
    v_add_u32 v203, s72, v201
    v_xor_b32 v204, 32, v203
    s_add_u32 s72, s72, 16384
    s_and_b32 s72, s72, 0x1ffff
    v_mfma_f32_16x16x32_bf16 v[24:27], v[140:143], v[168:171], v[24:27]
    ds_read_b128 v[132:135], v202 offset:0
    ds_read_b64_tr_b16 v[180:181], v203 offset:0
    v_mfma_f32_16x16x32_bf16 v[28:31], v[144:147], v[164:167], v[28:31]
    ds_read_b64_tr_b16 v[182:183], v203 offset:1024
    ds_read_b64_tr_b16 v[184:185], v204 offset:0
    v_mfma_f32_16x16x32_bf16 v[32:35], v[144:147], v[168:171], v[32:35]
    ds_read_b64_tr_b16 v[186:187], v204 offset:1024
    ds_read_b128 v[136:139], v202 offset:1024
    s_waitcnt lgkmcnt(0)
    v_mfma_f32_16x16x32_bf16 v[4:7], v[132:135], v[180:183], v[4:7]
    ds_read_b128 v[140:143], v202 offset:2048
    v_mfma_f32_16x16x32_bf16 v[8:11], v[132:135], v[184:187], v[8:11]
    ds_read_b128 v[144:147], v202 offset:3072
    v_mfma_f32_16x16x32_bf16 v[12:15], v[136:139], v[180:183], v[12:15]
    v_mfma_f32_16x16x32_bf16 v[16:19], v[136:139], v[184:187], v[16:19]
    s_waitcnt lgkmcnt(0)
    v_mfma_f32_16x16x32_bf16 v[20:23], v[140:143], v[180:183], v[20:23]
    v_mfma_f32_16x16x32_bf16 v[24:27], v[140:143], v[184:187], v[24:27]
    v_mfma_f32_16x16x32_bf16 v[28:31], v[144:147], v[180:183], v[28:31]
    v_mfma_f32_16x16x32_bf16 v[32:35], v[144:147], v[184:187], v[32:35]
    s_cmp_lg_u32 s78, 0
    s_cbranch_scc1 p3e_49
    v_cvt_pk_bf16_f32 v132, v4, v5
    v_cvt_pk_bf16_f32 v133, v6, v7
    v_cvt_pk_bf16_f32 v134, v12, v13
    v_cvt_pk_bf16_f32 v135, v14, v15
    buffer_store_dwordx4 v[132:135], v207, s[8:11], s81 offen offset:0 sc1
    v_cvt_pk_bf16_f32 v136, v8, v9
    v_cvt_pk_bf16_f32 v137, v10, v11
    v_cvt_pk_bf16_f32 v138, v16, v17
    v_cvt_pk_bf16_f32 v139, v18, v19
    buffer_store_dwordx4 v[136:139], v207, s[8:11], s81 offen offset:256 sc1
    s_add_u32 s81, s81, s82
    v_cvt_pk_bf16_f32 v140, v20, v21
    v_cvt_pk_bf16_f32 v141, v22, v23
    v_cvt_pk_bf16_f32 v142, v28, v29
    v_cvt_pk_bf16_f32 v143, v30, v31
    buffer_store_dwordx4 v[140:143], v207, s[8:11], s81 offen offset:0 sc1
    v_cvt_pk_bf16_f32 v144, v24, v25
    v_cvt_pk_bf16_f32 v145, v26, v27
    v_cvt_pk_bf16_f32 v146, v32, v33
    v_cvt_pk_bf16_f32 v147, v34, v35
    buffer_store_dwordx4 v[144:147], v207, s[8:11], s81 offen offset:256 sc1
    s_branch next_43
f256_41:
    s_mov_b32 s72, 0
    s_waitcnt vmcnt(12)
    s_barrier
    v_add_u32 v202, s72, v200
    v_add_u32 v203, s72, v201
    v_xor_b32 v204, 32, v203
    v_xor_b32 v205, 64, v203
    v_xor_b32 v206, 96, v203
    s_add_u32 s72, s72, 32768
    s_and_b32 s72, s72, 0x1ffff
    ds_read_b128 v[132:135], v202 offset:0
    ds_read_b128 v[136:139], v202 offset:1024
    ds_read_b128 v[140:143], v202 offset:2048
    ds_read_b128 v[144:147], v202 offset:3072
    ds_read_b64_tr_b16 v[164:165], v203 offset:0
    ds_read_b64_tr_b16 v[166:167], v203 offset:2048
    ds_read_b64_tr_b16 v[168:169], v204 offset:0
    ds_read_b64_tr_b16 v[170:171], v204 offset:2048
    ds_read_b64_tr_b16 v[172:173], v205 offset:0
    ds_read_b64_tr_b16 v[174:175], v205 offset:2048
    ds_read_b64_tr_b16 v[176:177], v206 offset:0
    ds_read_b64_tr_b16 v[178:179], v206 offset:2048
    s_waitcnt lgkmcnt(0)
    v_mfma_f32_16x16x32_bf16 v[4:7], v[164:167], v[132:135], 0
    ds_read_b128 v[148:151], v202 offset:4096
    v_mfma_f32_16x16x32_bf16 v[8:11], v[168:171], v[132:135], 0
    v_mfma_f32_16x16x32_bf16 v[12:15], v[172:175], v[132:135], 0
    ds_read_b128 v[152:155], v202 offset:5120
    v_mfma_f32_16x16x32_bf16 v[16:19], v[176:179], v[132:135], 0
    v_mfma_f32_16x16x32_bf16 v[20:23], v[164:167], v[136:139], 0
    ds_read_b128 v[156:159], v202 offset:6144
    v_mfma_f32_16x16x32_bf16 v[24:27], v[168:171], v[136:139], 0
    v_mfma_f32_16x16x32_bf16 v[28:31], v[172:175], v[136:139], 0
    ds_read_b128 v[160:163], v202 offset:7168
    v_mfma_f32_16x16x32_bf16 v[32:35], v[176:179], v[136:139], 0
    v_mfma_f32_16x16x32_bf16 v[36:39], v[164:167], v[140:143], 0
    v_mfma_f32_16x16x32_bf16 v[40:43], v[168:171], v[140:143], 0
    v_mfma_f32_16x16x32_bf16 v[44:47], v[172:175], v[140:143], 0
    v_mfma_f32_16x16x32_bf16 v[48:51], v[176:179], v[140:143], 0
    v_mfma_f32_16x16x32_bf16 v[52:55], v[164:167], v[144:147], 0
    v_mfma_f32_16x16x32_bf16 v[56:59], v[168:171], v[144:147], 0
    v_mfma_f32_16x16x32_bf16 v[60:63], v[172:175], v[144:147], 0
    v_mfma_f32_16x16x32_bf16 v[64:67], v[176:179], v[144:147], 0
    s_waitcnt vmcnt(8) lgkmcnt(0)
    s_barrier
    v_mfma_f32_16x16x32_bf16 v[68:71], v[164:167], v[148:151], 0
    v_add_u32 v202, s72, v200
    v_add_u32 v203, s72, v201
    v_xor_b32 v204, 32, v203
    v_xor_b32 v205, 64, v203
    v_xor_b32 v206, 96, v203
    v_mfma_f32_16x16x32_bf16 v[72:75], v[168:171], v[148:151], 0
    s_add_u32 s72, s72, 32768
    s_and_b32 s72, s72, 0x1ffff
    ds_read_b128 v[132:135], v202 offset:0
    v_mfma_f32_16x16x32_bf16 v[76:79], v[172:175], v[148:151], 0
    ds_read_b64_tr_b16 v[180:181], v203 offset:0
    v_mfma_f32_16x16x32_bf16 v[80:83], v[176:179], v[148:151], 0
    ds_read_b64_tr_b16 v[182:183], v203 offset:2048
    ds_read_b64_tr_b16 v[184:185], v204 offset:0
    v_mfma_f32_16x16x32_bf16 v[84:87], v[164:167], v[152:155], 0
    ds_read_b64_tr_b16 v[186:187], v204 offset:2048
    v_mfma_f32_16x16x32_bf16 v[88:91], v[168:171], v[152:155], 0
    ds_read_b64_tr_b16 v[188:189], v205 offset:0
    ds_read_b64_tr_b16 v[190:191], v205 offset:2048
    v_mfma_f32_16x16x32_bf16 v[92:95], v[172:175], v[152:155], 0
    ds_read_b64_tr_b16 v[192:193], v206 offset:0
    v_mfma_f32_16x16x32_bf16 v[96:99], v[176:179], v[152:155], 0
    ds_read_b64_tr_b16 v[194:195], v206 offset:2048
    ds_read_b128 v[136:139], v202 offset:1024
    v_mfma_f32_16x16x32_bf16 v[100:103], v[164:167], v[156:159], 0
    ds_read_b128 v[140:143], v202 offset:2048
    ds_read_b128 v[144:147], v202 offset:3072
    v_mfma_f32_16x16x32_bf16 v[104:107], v[168:171], v[156:159], 0
    s_mov_b32 m0, s71
    v_mfma_f32_16x16x32_bf16 v[108:111], v[172:175], v[156:159], 0
    buffer_load_dwordx4 v196, s[60:63], s68 offen lds
    s_add_u32 m0, s71, 1024
    v_mfma_f32_16x16x32_bf16 v[112:115], v[176:179], v[156:159], 0
    buffer_load_dwordx4 v197, s[60:63], s68 offen lds
    v_mfma_f32_16x16x32_bf16 v[116:119], v[164:167], v[160:163], 0
    s_add_u32 m0, s71, 16384
    s_nop 0
    buffer_load_dwordx4 v198, s[64:67], s69 offen lds
    v_mfma_f32_16x16x32_bf16 v[120:123], v[168:171], v[160:163], 0
    s_add_u32 m0, s71, 17408
    v_mfma_f32_16x16x32_bf16 v[124:127], v[172:175], v[160:163], 0
    buffer_load_dwordx4 v199, s[64:67], s69 offen lds
    s_add_u32 s68, s68, 64
    s_add_u32 s69, s69, s70
    v_mfma_f32_16x16x32_bf16 v[128:131], v[176:179], v[160:163], 0
    s_add_u32 s71, s71, 32768
    s_and_b32 s71, s71, 0x1ffff
    s_waitcnt lgkmcnt(0)
    v_mfma_f32_16x16x32_bf16 v[4:7], v[180:183], v[132:135], v[4:7]
    ds_read_b128 v[148:151], v202 offset:4096
    v_mfma_f32_16x16x32_bf16 v[8:11], v[184:187], v[132:135], v[8:11]
    v_mfma_f32_16x16x32_bf16 v[12:15], v[188:191], v[132:135], v[12:15]
    ds_read_b128 v[152:155], v202 offset:5120
    v_mfma_f32_16x16x32_bf16 v[16:19], v[192:195], v[132:135], v[16:19]
    v_mfma_f32_16x16x32_bf16 v[20:23], v[180:183], v[136:139], v[20:23]
    ds_read_b128 v[156:159], v202 offset:6144
    v_mfma_f32_16x16x32_bf16 v[24:27], v[184:187], v[136:139], v[24:27]
    v_mfma_f32_16x16x32_bf16 v[28:31], v[188:191], v[136:139], v[28:31]
    ds_read_b128 v[160:163], v202 offset:7168
    v_mfma_f32_16x16x32_bf16 v[32:35], v[192:195], v[136:139], v[32:35]
    v_mfma_f32_16x16x32_bf16 v[36:39], v[180:183], v[140:143], v[36:39]
    v_mfma_f32_16x16x32_bf16 v[40:43], v[184:187], v[140:143], v[40:43]
    v_mfma_f32_16x16x32_bf16 v[44:47], v[188:191], v[140:143], v[44:47]
    v_mfma_f32_16x16x32_bf16 v[48:51], v[192:195], v[140:143], v[48:51]
    v_mfma_f32_16x16x32_bf16 v[52:55], v[180:183], v[144:147], v[52:55]
    v_mfma_f32_16x16x32_bf16 v[56:59], v[184:187], v[144:147], v[56:59]
    v_mfma_f32_16x16x32_bf16 v[60:63], v[188:191], v[144:147], v[60:63]
    v_mfma_f32_16x16x32_bf16 v[64:67], v[192:195], v[144:147], v[64:67]
    s_waitcnt vmcnt(8) lgkmcnt(0)
    s_barrier
    v_mfma_f32_16x16x32_bf16 v[68:71], v[180:183], v[148:151], v[68:71]
    v_add_u32 v202, s72, v200
    v_add_u32 v203, s72, v201
    v_xor_b32 v204, 32, v203
    v_xor_b32 v205, 64, v203
    v_xor_b32 v206, 96, v203
    v_mfma_f32_16x16x32_bf16 v[72:75], v[184:187], v[148:151], v[72:75]
    s_add_u32 s72, s72, 32768
    s_and_b32 s72, s72, 0x1ffff
    ds_read_b128 v[132:135], v202 offset:0
    v_mfma_f32_16x16x32_bf16 v[76:79], v[188:191], v[148:151], v[76:79]
    ds_read_b64_tr_b16 v[164:165], v203 offset:0
    v_mfma_f32_16x16x32_bf16 v[80:83], v[192:195], v[148:151], v[80:83]
    ds_read_b64_tr_b16 v[166:167], v203 offset:2048
    ds_read_b64_tr_b16 v[168:169], v204 offset:0
    v_mfma_f32_16x16x32_bf16 v[84:87], v[180:183], v[152:155], v[84:87]
    ds_read_b64_tr_b16 v[170:171], v204 offset:2048
    v_mfma_f32_16x16x32_bf16 v[88:91], v[184:187], v[152:155], v[88:91]
    ds_read_b64_tr_b16 v[172:173], v205 offset:0
    ds_read_b64_tr_b16 v[174:175], v205 offset:2048
    v_mfma_f32_16x16x32_bf16 v[92:95], v[188:191], v[152:155], v[92:95]
    ds_read_b64_tr_b16 v[176:177], v206 offset:0
    v_mfma_f32_16x16x32_bf16 v[96:99], v[192:195], v[152:155], v[96:99]
    ds_read_b64_tr_b16 v[178:179], v206 offset:2048
    ds_read_b128 v[136:139], v202 offset:1024
    v_mfma_f32_16x16x32_bf16 v[100:103], v[180:183], v[156:159], v[100:103]
    ds_read_b128 v[140:143], v202 offset:2048
    ds_read_b128 v[144:147], v202 offset:3072
    v_mfma_f32_16x16x32_bf16 v[104:107], v[184:187], v[156:159], v[104:107]
    s_mov_b32 m0, s71
    v_mfma_f32_16x16x32_bf16 v[108:111], v[188:191], v[156:159], v[108:111]
    buffer_load_dwordx4 v196, s[60:63], s68 offen lds
    s_add_u32 m0, s71, 1024
    v_mfma_f32_16x16x32_bf16 v[112:115], v[192:195], v[156:159], v[112:115]
    buffer_load_dwordx4 v197, s[60:63], s68 offen lds
    v_mfma_f32_16x16x32_bf16 v[116:119], v[180:183], v[160:163], v[116:119]
    s_add_u32 m0, s71, 16384
    s_nop 0
    buffer_load_dwordx4 v198, s[64:67], s69 offen lds
    v_mfma_f32_16x16x32_bf16 v[120:123], v[184:187], v[160:163], v[120:123]
    s_add_u32 m0, s71, 17408
    v_mfma_f32_16x16x32_bf16 v[124:127], v[188:191], v[160:163], v[124:127]
    buffer_load_dwordx4 v199, s[64:67], s69 offen lds
    s_add_u32 s68, s68, 64
    s_add_u32 s69, s69, s70
    v_mfma_f32_16x16x32_bf16 v[128:131], v[192:195], v[160:163], v[128:131]
    s_add_u32 s71, s71, 32768
    s_and_b32 s71, s71, 0x1ffff
    s_mov_b32 s73, 13
gl_50:
    s_waitcnt lgkmcnt(0)
    v_mfma_f32_16x16x32_bf16 v[4:7], v[164:167], v[132:135], v[4:7]
    ds_read_b128 v[148:151], v202 offset:4096
    v_mfma_f32_16x16x32_bf16 v[8:11], v[168:171], v[132:135], v[8:11]
    v_mfma_f32_16x16x32_bf16 v[12:15], v[172:175], v[132:135], v[12:15]
    ds_read_b128 v[152:155], v202 offset:5120
    v_mfma_f32_16x16x32_bf16 v[16:19], v[176:179], v[132:135], v[16:19]
    v_mfma_f32_16x16x32_bf16 v[20:23], v[164:167], v[136:139], v[20:23]
    ds_read_b128 v[156:159], v202 offset:6144
    v_mfma_f32_16x16x32_bf16 v[24:27], v[168:171], v[136:139], v[24:27]
    v_mfma_f32_16x16x32_bf16 v[28:31], v[172:175], v[136:139], v[28:31]
    ds_read_b128 v[160:163], v202 offset:7168
    v_mfma_f32_16x16x32_bf16 v[32:35], v[176:179], v[136:139], v[32:35]
    v_mfma_f32_16x16x32_bf16 v[36:39], v[164:167], v[140:143], v[36:39]
    v_mfma_f32_16x16x32_bf16 v[40:43], v[168:171], v[140:143], v[40:43]
    v_mfma_f32_16x16x32_bf16 v[44:47], v[172:175], v[140:143], v[44:47]
    v_mfma_f32_16x16x32_bf16 v[48:51], v[176:179], v[140:143], v[48:51]
    v_mfma_f32_16x16x32_bf16 v[52:55], v[164:167], v[144:147], v[52:55]
    v_mfma_f32_16x16x32_bf16 v[56:59], v[168:171], v[144:147], v[56:59]
    v_mfma_f32_16x16x32_bf16 v[60:63], v[172:175], v[144:147], v[60:63]
    v_mfma_f32_16x16x32_bf16 v[64:67], v[176:179], v[144:147], v[64:67]
    s_waitcnt vmcnt(8) lgkmcnt(0)
    s_barrier
    v_mfma_f32_16x16x32_bf16 v[68:71], v[164:167], v[148:151], v[68:71]
    v_add_u32 v202, s72, v200
    v_add_u32 v203, s72, v201
    v_xor_b32 v204, 32, v203
    v_xor_b32 v205, 64, v203
    v_xor_b32 v206, 96, v203
    v_mfma_f32_16x16x32_bf16 v[72:75], v[168:171], v[148:151], v[72:75]
    s_add_u32 s72, s72, 32768
    s_and_b32 s72, s72, 0x1ffff
    ds_read_b128 v[132:135], v202 offset:0
    v_mfma_f32_16x16x32_bf16 v[76:79], v[172:175], v[148:151], v[76:79]
    ds_read_b64_tr_b16 v[180:181], v203 offset:0
    v_mfma_f32_16x16x32_bf16 v[80:83], v[176:179], v[148:151], v[80:83]
    ds_read_b64_tr_b16 v[182:183], v203 offset:2048
    ds_read_b64_tr_b16 v[184:185], v204 offset:0
    v_mfma_f32_16x16x32_bf16 v[84:87], v[164:167], v[152:155], v[84:87]
    ds_read_b64_tr_b16 v[186:187], v204 offset:2048
    v_mfma_f32_16x16x32_bf16 v[88:91], v[168:171], v[152:155], v[88:91]
    ds_read_b64_tr_b16 v[188:189], v205 offset:0
    ds_read_b64_tr_b16 v[190:191], v205 offset:2048
    v_mfma_f32_16x16x32_bf16 v[92:95], v[172:175], v[152:155], v[92:95]
    ds_read_b64_tr_b16 v[192:193], v206 offset:0
    v_mfma_f32_16x16x32_bf16 v[96:99], v[176:179], v[152:155], v[96:99]
    ds_read_b64_tr_b16 v[194:195], v206 offset:2048
    ds_read_b128 v[136:139], v202 offset:1024
    v_mfma_f32_16x16x32_bf16 v[100:103], v[164:167], v[156:159], v[100:103]
    ds_read_b128 v[140:143], v202 offset:2048
    ds_read_b128 v[144:147], v202 offset:3072
    v_mfma_f32_16x16x32_bf16 v[104:107], v[168:171], v[156:159], v[104:107]
    s_mov_b32 m0, s71
    v_mfma_f32_16x16x32_bf16 v[108:111], v[172:175], v[156:159], v[108:111]
    buffer_load_dwordx4 v196, s[60:63], s68 offen lds
    s_add_u32 m0, s71, 1024
    v_mfma_f32_16x16x32_bf16 v[112:115], v[176:179], v[156:159], v[112:115]
    buffer_load_dwordx4 v197, s[60:63], s68 offen lds
    v_mfma_f32_16x16x32_bf16 v[116:119], v[164:167], v[160:163], v[116:119]
    s_add_u32 m0, s71, 16384
    s_nop 0
    buffer_load_dwordx4 v198, s[64:67], s69 offen lds
    v_mfma_f32_16x16x32_bf16 v[120:123], v[168:171], v[160:163], v[120:123]
    s_add_u32 m0, s71, 17408
    v_mfma_f32_16x16x32_bf16 v[124:127], v[172:175], v[160:163], v[124:127]
    buffer_load_dwordx4 v199, s[64:67], s69 offen lds
    s_add_u32 s68, s68, 64
    s_add_u32 s69, s69, s70
    v_mfma_f32_16x16x32_bf16 v[128:131], v[176:179], v[160:163], v[128:131]
    s_add_u32 s71, s71, 32768
    s_and_b32 s71, s71, 0x1ffff
    s_waitcnt lgkmcnt(0)
    v_mfma_f32_16x16x32_bf16 v[4:7], v[180:183], v[132:135], v[4:7]
    ds_read_b128 v[148:151], v202 offset:4096
    v_mfma_f32_16x16x32_bf16 v[8:11], v[184:187], v[132:135], v[8:11]
    v_mfma_f32_16x16x32_bf16 v[12:15], v[188:191], v[132:135], v[12:15]
    ds_read_b128 v[152:155], v202 offset:5120
    v_mfma_f32_16x16x32_bf16 v[16:19], v[192:195], v[132:135], v[16:19]
    v_mfma_f32_16x16x32_bf16 v[20:23], v[180:183], v[136:139], v[20:23]
    ds_read_b128 v[156:159], v202 offset:6144
    v_mfma_f32_16x16x32_bf16 v[24:27], v[184:187], v[136:139], v[24:27]
    v_mfma_f32_16x16x32_bf16 v[28:31], v[188:191], v[136:139], v[28:31]
    ds_read_b128 v[160:163], v202 offset:7168
    v_mfma_f32_16x16x32_bf16 v[32:35], v[192:195], v[136:139], v[32:35]
    v_mfma_f32_16x16x32_bf16 v[36:39], v[180:183], v[140:143], v[36:39]
    v_mfma_f32_16x16x32_bf16 v[40:43], v[184:187], v[140:143], v[40:43]
    v_mfma_f32_16x16x32_bf16 v[44:47], v[188:191], v[140:143], v[44:47]
    v_mfma_f32_16x16x32_bf16 v[48:51], v[192:195], v[140:143], v[48:51]
    v_mfma_f32_16x16x32_bf16 v[52:55], v[180:183], v[144:147], v[52:55]
    v_mfma_f32_16x16x32_bf16 v[56:59], v[184:187], v[144:147], v[56:59]
    v_mfma_f32_16x16x32_bf16 v[60:63], v[188:191], v[144:147], v[60:63]
    v_mfma_f32_16x16x32_bf16 v[64:67], v[192:195], v[144:147], v[64:67]
    s_waitcnt vmcnt(8) lgkmcnt(0)
    s_barrier
    v_mfma_f32_16x16x32_bf16 v[68:71], v[180:183], v[148:151], v[68:71]
    v_add_u32 v202, s72, v200
    v_add_u32 v203, s72, v201
    v_xor_b32 v204, 32, v203
    v_xor_b32 v205, 64, v203
    v_xor_b32 v206, 96, v203
    v_mfma_f32_16x16x32_bf16 v[72:75], v[184:187], v[148:151], v[72:75]
    s_add_u32 s72, s72, 32768
    s_and_b32 s72, s72, 0x1ffff
    ds_read_b128 v[132:135], v202 offset:0
    v_mfma_f32_16x16x32_bf16 v[76:79], v[188:191], v[148:151], v[76:79]
    ds_read_b64_tr_b16 v[164:165], v203 offset:0
    v_mfma_f32_16x16x32_bf16 v[80:83], v[192:195], v[148:151], v[80:83]
    ds_read_b64_tr_b16 v[166:167], v203 offset:2048
    ds_read_b64_tr_b16 v[168:169], v204 offset:0
    v_mfma_f32_16x16x32_bf16 v[84:87], v[180:183], v[152:155], v[84:87]
    ds_read_b64_tr_b16 v[170:171], v204 offset:2048
    v_mfma_f32_16x16x32_bf16 v[88:91], v[184:187], v[152:155], v[88:91]
    ds_read_b64_tr_b16 v[172:173], v205 offset:0
    ds_read_b64_tr_b16 v[174:175], v205 offset:2048
    v_mfma_f32_16x16x32_bf16 v[92:95], v[188:191], v[152:155], v[92:95]
    ds_read_b64_tr_b16 v[176:177], v206 offset:0
    v_mfma_f32_16x16x32_bf16 v[96:99], v[192:195], v[152:155], v[96:99]
    ds_read_b64_tr_b16 v[178:179], v206 offset:2048
    ds_read_b128 v[136:139], v202 offset:1024
    v_mfma_f32_16x16x32_bf16 v[100:103], v[180:183], v[156:159], v[100:103]
    ds_read_b128 v[140:143], v202 offset:2048
    ds_read_b128 v[144:147], v202 offset:3072
    v_mfma_f32_16x16x32_bf16 v[104:107], v[184:187], v[156:159], v[104:107]
    s_mov_b32 m0, s71
    v_mfma_f32_16x16x32_bf16 v[108:111], v[188:191], v[156:159], v[108:111]
    buffer_load_dwordx4 v196, s[60:63], s68 offen lds
    s_add_u32 m0, s71, 1024
    v_mfma_f32_16x16x32_bf16 v[112:115], v[192:195], v[156:159], v[112:115]
    buffer_load_dwordx4 v197, s[60:63], s68 offen lds
    v_mfma_f32_16x16x32_bf16 v[116:119], v[180:183], v[160:163], v[116:119]
    s_add_u32 m0, s71, 16384
    s_nop 0
    buffer_load_dwordx4 v198, s[64:67], s69 offen lds
    v_mfma_f32_16x16x32_bf16 v[120:123], v[184:187], v[160:163], v[120:123]
    s_add_u32 m0, s71, 17408
    v_mfma_f32_16x16x32_bf16 v[124:127], v[188:191], v[160:163], v[124:127]
    buffer_load_dwordx4 v199, s[64:67], s69 offen lds
    s_add_u32 s68, s68, 64
    s_add_u32 s69, s69, s70
    v_mfma_f32_16x16x32_bf16 v[128:131], v[192:195], v[160:163], v[128:131]
    s_add_u32 s71, s71, 32768
    s_and_b32 s71, s71, 0x1ffff
    s_sub_u32 s73, s73, 1
    s_cmp_lg_u32 s73, 0
    s_cbranch_scc1 gl_50
    s_waitcnt lgkmcnt(0)
    v_mfma_f32_16x16x32_bf16 v[4:7], v[164:167], v[132:135], v[4:7]
    ds_read_b128 v[148:151], v202 offset:4096
    v_mfma_f32_16x16x32_bf16 v[8:11], v[168:171], v[132:135], v[8:11]
    v_mfma_f32_16x16x32_bf16 v[12:15], v[172:175], v[132:135], v[12:15]
    ds_read_b128 v[152:155], v202 offset:5120
    v_mfma_f32_16x16x32_bf16 v[16:19], v[176:179], v[132:135], v[16:19]
    v_mfma_f32_16x16x32_bf16 v[20:23], v[164:167], v[136:139], v[20:23]
    ds_read_b128 v[156:159], v202 offset:6144
    v_mfma_f32_16x16x32_bf16 v[24:27], v[168:171], v[136:139], v[24:27]
    v_mfma_f32_16x16x32_bf16 v[28:31], v[172:175], v[136:139], v[28:31]
    ds_read_b128 v[160:163], v202 offset:7168
    v_mfma_f32_16x16x32_bf16 v[32:35], v[176:179], v[136:139], v[32:35]
    v_mfma_f32_16x16x32_bf16 v[36:39], v[164:167], v[140:143], v[36:39]
    v_mfma_f32_16x16x32_bf16 v[40:43], v[168:171], v[140:143], v[40:43]
    v_mfma_f32_16x16x32_bf16 v[44:47], v[172:175], v[140:143], v[44:47]
    v_mfma_f32_16x16x32_bf16 v[48:51], v[176:179], v[140:143], v[48:51]
    v_mfma_f32_16x16x32_bf16 v[52:55], v[164:167], v[144:147], v[52:55]
    v_mfma_f32_16x16x32_bf16 v[56:59], v[168:171], v[144:147], v[56:59]
    v_mfma_f32_16x16x32_bf16 v[60:63], v[172:175], v[144:147], v[60:63]
    v_mfma_f32_16x16x32_bf16 v[64:67], v[176:179], v[144:147], v[64:67]
    s_waitcnt vmcnt(8) lgkmcnt(0)
    s_barrier
    v_mfma_f32_16x16x32_bf16 v[68:71], v[164:167], v[148:151], v[68:71]
    v_add_u32 v202, s72, v200
    v_add_u32 v203, s72, v201
    v_mfma_f32_16x16x32_bf16 v[72:75], v[168:171], v[148:151], v[72:75]
    v_xor_b32 v204, 32, v203
    v_xor_b32 v205, 64, v203
    v_xor_b32 v206, 96, v203
    v_mfma_f32_16x16x32_bf16 v[76:79], v[172:175], v[148:151], v[76:79]
    s_add_u32 s72, s72, 32768
    s_and_b32 s72, s72, 0x1ffff
    v_mfma_f32_16x16x32_bf16 v[80:83], v[176:179], v[148:151], v[80:83]
    ds_read_b128 v[132:135], v202 offset:0
    v_mfma_f32_16x16x32_bf16 v[84:87], v[164:167], v[152:155], v[84:87]
    ds_read_b64_tr_b16 v[180:181], v203 offset:0
    v_mfma_f32_16x16x32_bf16 v[88:91], v[168:171], v[152:155], v[88:91]
    ds_read_b64_tr_b16 v[182:183], v203 offset:2048
    v_mfma_f32_16x16x32_bf16 v[92:95], v[172:175], v[152:155], v[92:95]
    ds_read_b64_tr_b16 v[184:185], v204 offset:0
    v_mfma_f32_16x16x32_bf16 v[96:99], v[176:179], v[152:155], v[96:99]
    ds_read_b64_tr_b16 v[186:187], v204 offset:2048
    v_mfma_f32_16x16x32_bf16 v[100:103], v[164:167], v[156:159], v[100:103]
    ds_read_b64_tr_b16 v[188:189], v205 offset:0
    v_mfma_f32_16x16x32_bf16 v[104:107], v[168:171], v[156:159], v[104:107]
    ds_read_b64_tr_b16 v[190:191], v205 offset:2048
    v_mfma_f32_16x16x32_bf16 v[108:111], v[172:175], v[156:159], v[108:111]
    ds_read_b64_tr_b16 v[192:193], v206 offset:0
    v_mfma_f32_16x16x32_bf16 v[112:115], v[176:179], v[156:159], v[112:115]
    ds_read_b64_tr_b16 v[194:195], v206 offset:2048
    v_mfma_f32_16x16x32_bf16 v[116:119], v[164:167], v[160:163], v[116:119]
    ds_read_b128 v[136:139], v202 offset:1024
    v_mfma_f32_16x16x32_bf16 v[120:123], v[168:171], v[160:163], v[120:123]
    ds_read_b128 v[140:143], v202 offset:2048
    v_mfma_f32_16x16x32_bf16 v[124:127], v[172:175], v[160:163], v[124:127]
    ds_read_b128 v[144:147], v202 offset:3072
    v_mfma_f32_16x16x32_bf16 v[128:131], v[176:179], v[160:163], v[128:131]
    s_waitcnt lgkmcnt(0)
    v_mfma_f32_16x16x32_bf16 v[4:7], v[180:183], v[132:135], v[4:7]
    ds_read_b128 v[148:151], v202 offset:4096
    v_mfma_f32_16x16x32_bf16 v[8:11], v[184:187], v[132:135], v[8:11]
    v_mfma_f32_16x16x32_bf16 v[12:15], v[188:191], v[132:135], v[12:15]
    ds_read_b128 v[152:155], v202 offset:5120
    v_mfma_f32_16x16x32_bf16 v[16:19], v[192:195], v[132:135], v[16:19]
    v_mfma_f32_16x16x32_bf16 v[20:23], v[180:183], v[136:139], v[20:23]
    ds_read_b128 v[156:159], v202 offset:6144
    v_mfma_f32_16x16x32_bf16 v[24:27], v[184:187], v[136:139], v[24:27]
    v_mfma_f32_16x16x32_bf16 v[28:31], v[188:191], v[136:139], v[28:31]
    ds_read_b128 v[160:163], v202 offset:7168
    v_mfma_f32_16x16x32_bf16 v[32:35], v[192:195], v[136:139], v[32:35]
    v_mfma_f32_16x16x32_bf16 v[36:39], v[180:183], v[140:143], v[36:39]
    v_mfma_f32_16x16x32_bf16 v[40:43], v[184:187], v[140:143], v[40:43]
    v_mfma_f32_16x16x32_bf16 v[44:47], v[188:191], v[140:143], v[44:47]
    v_mfma_f32_16x16x32_bf16 v[48:51], v[192:195], v[140:143], v[48:51]
    v_mfma_f32_16x16x32_bf16 v[52:55], v[180:183], v[144:147], v[52:55]
    v_mfma_f32_16x16x32_bf16 v[56:59], v[184:187], v[144:147], v[56:59]
    v_mfma_f32_16x16x32_bf16 v[60:63], v[188:191], v[144:147], v[60:63]
    v_mfma_f32_16x16x32_bf16 v[64:67], v[192:195], v[144:147], v[64:67]
    s_waitcnt vmcnt(4) lgkmcnt(0)
    s_barrier
    v_mfma_f32_16x16x32_bf16 v[68:71], v[180:183], v[148:151], v[68:71]
    v_add_u32 v202, s72, v200
    v_add_u32 v203, s72, v201
    v_mfma_f32_16x16x32_bf16 v[72:75], v[184:187], v[148:151], v[72:75]
    v_xor_b32 v204, 32, v203
    v_xor_b32 v205, 64, v203
    v_xor_b32 v206, 96, v203
    v_mfma_f32_16x16x32_bf16 v[76:79], v[188:191], v[148:151], v[76:79]
    s_add_u32 s72, s72, 32768
    s_and_b32 s72, s72, 0x1ffff
    v_mfma_f32_16x16x32_bf16 v[80:83], v[192:195], v[148:151], v[80:83]
    ds_read_b128 v[132:135], v202 offset:0
    v_mfma_f32_16x16x32_bf16 v[84:87], v[180:183], v[152:155], v[84:87]
    ds_read_b64_tr_b16 v[164:165], v203 offset:0
    v_mfma_f32_16x16x32_bf16 v[88:91], v[184:187], v[152:155], v[88:91]
    ds_read_b64_tr_b16 v[166:167], v203 offset:2048
    v_mfma_f32_16x16x32_bf16 v[92:95], v[188:191], v[152:155], v[92:95]
    ds_read_b64_tr_b16 v[168:169], v204 offset:0
    v_mfma_f32_16x16x32_bf16 v[96:99], v[192:195], v[152:155], v[96:99]
    ds_read_b64_tr_b16 v[170:171], v204 offset:2048
    v_mfma_f32_16x16x32_bf16 v[100:103], v[180:183], v[156:159], v[100:103]
    ds_read_b64_tr_b16 v[172:173], v205 offset:0
    v_mfma_f32_16x16x32_bf16 v[104:107], v[184:187], v[156:159], v[104:107]
    ds_read_b64_tr_b16 v[174:175], v205 offset:2048
    v_mfma_f32_16x16x32_bf16 v[108:111], v[188:191], v[156:159], v[108:111]
    ds_read_b64_tr_b16 v[176:177], v206 offset:0
    v_mfma_f32_16x16x32_bf16 v[112:115], v[192:195], v[156:159], v[112:115]
    ds_read_b64_tr_b16 v[178:179], v206 offset:2048
    v_mfma_f32_16x16x32_bf16 v[116:119], v[180:183], v[160:163], v[116:119]
    ds_read_b128 v[136:139], v202 offset:1024
    v_mfma_f32_16x16x32_bf16 v[120:123], v[184:187], v[160:163], v[120:123]
    ds_read_b128 v[140:143], v202 offset:2048
    v_mfma_f32_16x16x32_bf16 v[124:127], v[188:191], v[160:163], v[124:127]
    ds_read_b128 v[144:147], v202 offset:3072
    v_mfma_f32_16x16x32_bf16 v[128:131], v[192:195], v[160:163], v[128:131]
    s_waitcnt lgkmcnt(0)
    v_mfma_f32_16x16x32_bf16 v[4:7], v[164:167], v[132:135], v[4:7]
    ds_read_b128 v[148:151], v202 offset:4096
    v_mfma_f32_16x16x32_bf16 v[8:11], v[168:171], v[132:135], v[8:11]
    v_mfma_f32_16x16x32_bf16 v[12:15], v[172:175], v[132:135], v[12:15]
    ds_read_b128 v[152:155], v202 offset:5120
    v_mfma_f32_16x16x32_bf16 v[16:19], v[176:179], v[132:135], v[16:19]
    v_mfma_f32_16x16x32_bf16 v[20:23], v[164:167], v[136:139], v[20:23]
    ds_read_b128 v[156:159], v202 offset:6144
    v_mfma_f32_16x16x32_bf16 v[24:27], v[168:171], v[136:139], v[24:27]
    v_mfma_f32_16x16x32_bf16 v[28:31], v[172:175], v[136:139], v[28:31]
    ds_read_b128 v[160:163], v202 offset:7168
    v_mfma_f32_16x16x32_bf16 v[32:35], v[176:179], v[136:139], v[32:35]
    v_mfma_f32_16x16x32_bf16 v[36:39], v[164:167], v[140:143], v[36:39]
    v_mfma_f32_16x16x32_bf16 v[40:43], v[168:171], v[140:143], v[40:43]
    v_mfma_f32_16x16x32_bf16 v[44:47], v[172:175], v[140:143], v[44:47]
    v_mfma_f32_16x16x32_bf16 v[48:51], v[176:179], v[140:143], v[48:51]
    v_mfma_f32_16x16x32_bf16 v[52:55], v[164:167], v[144:147], v[52:55]
    v_mfma_f32_16x16x32_bf16 v[56:59], v[168:171], v[144:147], v[56:59]
    v_mfma_f32_16x16x32_bf16 v[60:63], v[172:175], v[144:147], v[60:63]
    v_mfma_f32_16x16x32_bf16 v[64:67], v[176:179], v[144:147], v[64:67]
    s_waitcnt vmcnt(0) lgkmcnt(0)
    s_barrier
    v_mfma_f32_16x16x32_bf16 v[68:71], v[164:167], v[148:151], v[68:71]
    v_add_u32 v202, s72, v200
    v_add_u32 v203, s72, v201
    v_mfma_f32_16x16x32_bf16 v[72:75], v[168:171], v[148:151], v[72:75]
    v_xor_b32 v204, 32, v203
    v_xor_b32 v205, 64, v203
    v_xor_b32 v206, 96, v203
    v_mfma_f32_16x16x32_bf16 v[76:79], v[172:175], v[148:151], v[76:79]
    s_add_u32 s72, s72, 32768
    s_and_b32 s72, s72, 0x1ffff
    v_mfma_f32_16x16x32_bf16 v[80:83], v[176:179], v[148:151], v[80:83]
    ds_read_b128 v[132:135], v202 offset:0
    v_mfma_f32_16x16x32_bf16 v[84:87], v[164:167], v[152:155], v[84:87]
    ds_read_b64_tr_b16 v[180:181], v203 offset:0
    v_mfma_f32_16x16x32_bf16 v[88:91], v[168:171], v[152:155], v[88:91]
    ds_read_b64_tr_b16 v[182:183], v203 offset:2048
    v_mfma_f32_16x16x32_bf16 v[92:95], v[172:175], v[152:155], v[92:95]
    ds_read_b64_tr_b16 v[184:185], v204 offset:0
    v_mfma_f32_16x16x32_bf16 v[96:99], v[176:179], v[152:155], v[96:99]
    ds_read_b64_tr_b16 v[186:187], v204 offset:2048
    v_mfma_f32_16x16x32_bf16 v[100:103], v[164:167], v[156:159], v[100:103]
    ds_read_b64_tr_b16 v[188:189], v205 offset:0
    v_mfma_f32_16x16x32_bf16 v[104:107], v[168:171], v[156:159], v[104:107]
    ds_read_b64_tr_b16 v[190:191], v205 offset:2048
    v_mfma_f32_16x16x32_bf16 v[108:111], v[172:175], v[156:159], v[108:111]
    ds_read_b64_tr_b16 v[192:193], v206 offset:0
    v_mfma_f32_16x16x32_bf16 v[112:115], v[176:179], v[156:159], v[112:115]
    ds_read_b64_tr_b16 v[194:195], v206 offset:2048
    v_mfma_f32_16x16x32_bf16 v[116:119], v[164:167], v[160:163], v[116:119]
    ds_read_b128 v[136:139], v202 offset:1024
    v_mfma_f32_16x16x32_bf16 v[120:123], v[168:171], v[160:163], v[120:123]
    ds_read_b128 v[140:143], v202 offset:2048
    v_mfma_f32_16x16x32_bf16 v[124:127], v[172:175], v[160:163], v[124:127]
    ds_read_b128 v[144:147], v202 offset:3072
    v_mfma_f32_16x16x32_bf16 v[128:131], v[176:179], v[160:163], v[128:131]
    s_waitcnt lgkmcnt(0)
    v_mfma_f32_16x16x32_bf16 v[4:7], v[180:183], v[132:135], v[4:7]
    ds_read_b128 v[148:151], v202 offset:4096
    v_mfma_f32_16x16x32_bf16 v[8:11], v[184:187], v[132:135], v[8:11]
    v_mfma_f32_16x16x32_bf16 v[12:15], v[188:191], v[132:135], v[12:15]
    ds_read_b128 v[152:155], v202 offset:5120
    v_mfma_f32_16x16x32_bf16 v[16:19], v[192:195], v[132:135], v[16:19]
    v_mfma_f32_16x16x32_bf16 v[20:23], v[180:183], v[136:139], v[20:23]
    ds_read_b128 v[156:159], v202 offset:6144
    v_mfma_f32_16x16x32_bf16 v[24:27], v[184:187], v[136:139], v[24:27]
    v_mfma_f32_16x16x32_bf16 v[28:31], v[188:191], v[136:139], v[28:31]
    ds_read_b128 v[160:163], v202 offset:7168
    v_mfma_f32_16x16x32_bf16 v[32:35], v[192:195], v[136:139], v[32:35]
    v_mfma_f32_16x16x32_bf16 v[36:39], v[180:183], v[140:143], v[36:39]
    v_mfma_f32_16x16x32_bf16 v[40:43], v[184:187], v[140:143], v[40:43]
    v_mfma_f32_16x16x32_bf16 v[44:47], v[188:191], v[140:143], v[44:47]
    v_mfma_f32_16x16x32_bf16 v[48:51], v[192:195], v[140:143], v[48:51]
    v_mfma_f32_16x16x32_bf16 v[52:55], v[180:183], v[144:147], v[52:55]
    v_mfma_f32_16x16x32_bf16 v[56:59], v[184:187], v[144:147], v[56:59]
    v_mfma_f32_16x16x32_bf16 v[60:63], v[188:191], v[144:147], v[60:63]
    v_mfma_f32_16x16x32_bf16 v[64:67], v[192:195], v[144:147], v[64:67]
    s_waitcnt lgkmcnt(0)
    v_mfma_f32_16x16x32_bf16 v[68:71], v[180:183], v[148:151], v[68:71]
    v_mfma_f32_16x16x32_bf16 v[72:75], v[184:187], v[148:151], v[72:75]
    v_mfma_f32_16x16x32_bf16 v[76:79], v[188:191], v[148:151], v[76:79]
    v_mfma_f32_16x16x32_bf16 v[80:83], v[192:195], v[148:151], v[80:83]
    v_mfma_f32_16x16x32_bf16 v[84:87], v[180:183], v[152:155], v[84:87]
    v_mfma_f32_16x16x32_bf16 v[88:91], v[184:187], v[152:155], v[88:91]
    v_mfma_f32_16x16x32_bf16 v[92:95], v[188:191], v[152:155], v[92:95]
    v_mfma_f32_16x16x32_bf16 v[96:99], v[192:195], v[152:155], v[96:99]
    v_mfma_f32_16x16x32_bf16 v[100:103], v[180:183], v[156:159], v[100:103]
    v_mfma_f32_16x16x32_bf16 v[104:107], v[184:187], v[156:159], v[104:107]
    v_mfma_f32_16x16x32_bf16 v[108:111], v[188:191], v[156:159], v[108:111]
    v_mfma_f32_16x16x32_bf16 v[112:115], v[192:195], v[156:159], v[112:115]
    v_mfma_f32_16x16x32_bf16 v[116:119], v[180:183], v[160:163], v[116:119]
    v_mfma_f32_16x16x32_bf16 v[120:123], v[184:187], v[160:163], v[120:123]
    v_mfma_f32_16x16x32_bf16 v[124:127], v[188:191], v[160:163], v[124:127]
    v_mfma_f32_16x16x32_bf16 v[128:131], v[192:195], v[160:163], v[128:131]
    v_cvt_pk_bf16_f32 v132, v4, v5
    v_cvt_pk_bf16_f32 v133, v6, v7
    v_cvt_pk_bf16_f32 v134, v8, v9
    v_cvt_pk_bf16_f32 v135, v10, v11
    buffer_store_dwordx4 v[132:135], v207, s[8:11], s81 offen offset:0 sc1
    v_cvt_pk_bf16_f32 v136, v20, v21
    v_cvt_pk_bf16_f32 v137, v22, v23
    v_cvt_pk_bf16_f32 v138, v24, v25
    v_cvt_pk_bf16_f32 v139, v26, v27
    buffer_store_dwordx4 v[136:139], v207, s[8:11], s81 offen offset:256 sc1
    v_cvt_pk_bf16_f32 v140, v12, v13
    v_cvt_pk_bf16_f32 v141, v14, v15
    v_cvt_pk_bf16_f32 v142, v16, v17
    v_cvt_pk_bf16_f32 v143, v18, v19
    buffer_store_dwordx4 v[140:143], v207, s[8:11], s81 offen offset:2048 sc1
    v_cvt_pk_bf16_f32 v144, v28, v29
    v_cvt_pk_bf16_f32 v145, v30, v31
    v_cvt_pk_bf16_f32 v146, v32, v33
    v_cvt_pk_bf16_f32 v147, v34, v35
    buffer_store_dwordx4 v[144:147], v207, s[8:11], s81 offen offset:2304 sc1
    s_add_u32 s81, s81, s82
    v_cvt_pk_bf16_f32 v148, v36, v37
    v_cvt_pk_bf16_f32 v149, v38, v39
    v_cvt_pk_bf16_f32 v150, v40, v41
    v_cvt_pk_bf16_f32 v151, v42, v43
    buffer_store_dwordx4 v[148:151], v207, s[8:11], s81 offen offset:0 sc1
    v_cvt_pk_bf16_f32 v152, v52, v53
    v_cvt_pk_bf16_f32 v153, v54, v55
    v_cvt_pk_bf16_f32 v154, v56, v57
    v_cvt_pk_bf16_f32 v155, v58, v59
    buffer_store_dwordx4 v[152:155], v207, s[8:11], s81 offen offset:256 sc1
    v_cvt_pk_bf16_f32 v156, v44, v45
    v_cvt_pk_bf16_f32 v157, v46, v47
    v_cvt_pk_bf16_f32 v158, v48, v49
    v_cvt_pk_bf16_f32 v159, v50, v51
    buffer_store_dwordx4 v[156:159], v207, s[8:11], s81 offen offset:2048 sc1
    v_cvt_pk_bf16_f32 v160, v60, v61
    v_cvt_pk_bf16_f32 v161, v62, v63
    v_cvt_pk_bf16_f32 v162, v64, v65
    v_cvt_pk_bf16_f32 v163, v66, v67
    buffer_store_dwordx4 v[160:163], v207, s[8:11], s81 offen offset:2304 sc1
    s_add_u32 s81, s81, s82
    v_cvt_pk_bf16_f32 v164, v68, v69
    v_cvt_pk_bf16_f32 v165, v70, v71
    v_cvt_pk_bf16_f32 v166, v72, v73
    v_cvt_pk_bf16_f32 v167, v74, v75
    buffer_store_dwordx4 v[164:167], v207, s[8:11], s81 offen offset:0 sc1
    v_cvt_pk_bf16_f32 v168, v84, v85
    v_cvt_pk_bf16_f32 v169, v86, v87
    v_cvt_pk_bf16_f32 v170, v88, v89
    v_cvt_pk_bf16_f32 v171, v90, v91
    buffer_store_dwordx4 v[168:171], v207, s[8:11], s81 offen offset:256 sc1
    v_cvt_pk_bf16_f32 v172, v76, v77
    v_cvt_pk_bf16_f32 v173, v78, v79
    v_cvt_pk_bf16_f32 v174, v80, v81
    v_cvt_pk_bf16_f32 v175, v82, v83
    buffer_store_dwordx4 v[172:175], v207, s[8:11], s81 offen offset:2048 sc1
    v_cvt_pk_bf16_f32 v176, v92, v93
    v_cvt_pk_bf16_f32 v177, v94, v95
    v_cvt_pk_bf16_f32 v178, v96, v97
    v_cvt_pk_bf16_f32 v179, v98, v99
    buffer_store_dwordx4 v[176:179], v207, s[8:11], s81 offen offset:2304 sc1
    s_add_u32 s81, s81, s82
    v_cvt_pk_bf16_f32 v180, v100, v101
    v_cvt_pk_bf16_f32 v181, v102, v103
    v_cvt_pk_bf16_f32 v182, v104, v105
    v_cvt_pk_bf16_f32 v183, v106, v107
    buffer_store_dwordx4 v[180:183], v207, s[8:11], s81 offen offset:0 sc1
    v_cvt_pk_bf16_f32 v184, v116, v117
    v_cvt_pk_bf16_f32 v185, v118, v119
    v_cvt_pk_bf16_f32 v186, v120, v121
    v_cvt_pk_bf16_f32 v187, v122, v123
    buffer_store_dwordx4 v[184:187], v207, s[8:11], s81 offen offset:256 sc1
    v_cvt_pk_bf16_f32 v188, v108, v109
    v_cvt_pk_bf16_f32 v189, v110, v111
    v_cvt_pk_bf16_f32 v190, v112, v113
    v_cvt_pk_bf16_f32 v191, v114, v115
    buffer_store_dwordx4 v[188:191], v207, s[8:11], s81 offen offset:2048 sc1
    v_cvt_pk_bf16_f32 v192, v124, v125
    v_cvt_pk_bf16_f32 v193, v126, v127
    v_cvt_pk_bf16_f32 v194, v128, v129
    v_cvt_pk_bf16_f32 v195, v130, v131
    buffer_store_dwordx4 v[192:195], v207, s[8:11], s81 offen offset:2304 sc1
    s_branch next_43
t256_42:
    s_mov_b32 s72, 0
    s_waitcnt vmcnt(12)
    s_barrier
    v_add_u32 v202, s72, v200
    v_add_u32 v203, s72, v201
    v_xor_b32 v204, 32, v203
    v_xor_b32 v205, 64, v203
    v_xor_b32 v206, 96, v203
    s_add_u32 s72, s72, 32768
    s_and_b32 s72, s72, 0x1ffff
    ds_read_b128 v[132:135], v202 offset:0
    ds_read_b128 v[136:139], v202 offset:1024
    ds_read_b128 v[140:143], v202 offset:2048
    ds_read_b128 v[144:147], v202 offset:3072
    ds_read_b64_tr_b16 v[164:165], v203 offset:0
    ds_read_b64_tr_b16 v[166:167], v203 offset:2048
    ds_read_b64_tr_b16 v[168:169], v204 offset:0
    ds_read_b64_tr_b16 v[170:171], v204 offset:2048
    ds_read_b64_tr_b16 v[172:173], v205 offset:0
    ds_read_b64_tr_b16 v[174:175], v205 offset:2048
    ds_read_b64_tr_b16 v[176:177], v206 offset:0
    ds_read_b64_tr_b16 v[178:179], v206 offset:2048
    s_waitcnt lgkmcnt(0)
    v_mfma_f32_16x16x32_bf16 v[4:7], v[132:135], v[164:167], 0
    ds_read_b128 v[148:151], v202 offset:4096
    v_mfma_f32_16x16x32_bf16 v[8:11], v[132:135], v[168:171], 0
    v_mfma_f32_16x16x32_bf16 v[12:15], v[132:135], v[172:175], 0
    ds_read_b128 v[152:155], v202 offset:5120
    v_mfma_f32_16x16x32_bf16 v[16:19], v[132:135], v[176:179], 0
    v_mfma_f32_16x16x32_bf16 v[20:23], v[136:139], v[164:167], 0
    ds_read_b128 v[156:159], v202 offset:6144
    v_mfma_f32_16x16x32_bf16 v[24:27], v[136:139], v[168:171], 0
    v_mfma_f32_16x16x32_bf16 v[28:31], v[136:139], v[172:175], 0
    ds_read_b128 v[160:163], v202 offset:7168
    v_mfma_f32_16x16x32_bf16 v[32:35], v[136:139], v[176:179], 0
    v_mfma_f32_16x16x32_bf16 v[36:39], v[140:143], v[164:167], 0
    v_mfma_f32_16x16x32_bf16 v[40:43], v[140:143], v[168:171], 0
    v_mfma_f32_16x16x32_bf16 v[44:47], v[140:143], v[172:175], 0
    v_mfma_f32_16x16x32_bf16 v[48:51], v[140:143], v[176:179], 0
    v_mfma_f32_16x16x32_bf16 v[52:55], v[144:147], v[164:167], 0
    v_mfma_f32_16x16x32_bf16 v[56:59], v[144:147], v[168:171], 0
    v_mfma_f32_16x16x32_bf16 v[60:63], v[144:147], v[172:175], 0
    v_mfma_f32_16x16x32_bf16 v[64:67], v[144:147], v[176:179], 0
    s_waitcnt vmcnt(8) lgkmcnt(0)
    s_barrier
    v_mfma_f32_16x16x32_bf16 v[68:71], v[148:151], v[164:167], 0
    v_add_u32 v202, s72, v200
    v_add_u32 v203, s72, v201
    v_xor_b32 v204, 32, v203
    v_xor_b32 v205, 64, v203
    v_xor_b32 v206, 96, v203
    v_mfma_f32_16x16x32_bf16 v[72:75], v[148:151], v[168:171], 0
    s_add_u32 s72, s72, 32768
    s_and_b32 s72, s72, 0x1ffff
    ds_read_b128 v[132:135], v202 offset:0
    v_mfma_f32_16x16x32_bf16 v[76:79], v[148:151], v[172:175], 0
    ds_read_b64_tr_b16 v[180:181], v203 offset:0
    v_mfma_f32_16x16x32_bf16 v[80:83], v[148:151], v[176:179], 0
    ds_read_b64_tr_b16 v[182:183], v203 offset:2048
    ds_read_b64_tr_b16 v[184:185], v204 offset:0
    v_mfma_f32_16x16x32_bf16 v[84:87], v[152:155], v[164:167], 0
    ds_read_b64_tr_b16 v[186:187], v204 offset:2048
    v_mfma_f32_16x16x32_bf16 v[88:91], v[152:155], v[168:171], 0
    ds_read_b64_tr_b16 v[188:189], v205 offset:0
    ds_read_b64_tr_b16 v[190:191], v205 offset:2048
    v_mfma_f32_16x16x32_bf16 v[92:95], v[152:155], v[172:175], 0
    ds_read_b64_tr_b16 v[192:193], v206 offset:0
    v_mfma_f32_16x16x32_bf16 v[96:99], v[152:155], v[176:179], 0
    ds_read_b64_tr_b16 v[194:195], v206 offset:2048
    ds_read_b128 v[136:139], v202 offset:1024
    v_mfma_f32_16x16x32_bf16 v[100:103], v[156:159], v[164:167], 0
    ds_read_b128 v[140:143], v202 offset:2048
    ds_read_b128 v[144:147], v202 offset:3072
    v_mfma_f32_16x16x32_bf16 v[104:107], v[156:159], v[168:171], 0
    s_mov_b32 m0, s71
    v_mfma_f32_16x16x32_bf16 v[108:111], v[156:159], v[172:175], 0
    buffer_load_dwordx4 v196, s[60:63], s68 offen lds
    s_add_u32 m0, s71, 1024
    v_mfma_f32_16x16x32_bf16 v[112:115], v[156:159], v[176:179], 0
    buffer_load_dwordx4 v197, s[60:63], s68 offen lds
    v_mfma_f32_16x16x32_bf16 v[116:119], v[160:163], v[164:167], 0
    s_add_u32 m0, s71, 16384
    s_nop 0
    buffer_load_dwordx4 v198, s[64:67], s69 offen lds
    v_mfma_f32_16x16x32_bf16 v[120:123], v[160:163], v[168:171], 0
    s_add_u32 m0, s71, 17408
    v_mfma_f32_16x16x32_bf16 v[124:127], v[160:163], v[172:175], 0
    buffer_load_dwordx4 v199, s[64:67], s69 offen lds
    s_add_u32 s68, s68, 64
    s_add_u32 s69, s69, s70
    v_mfma_f32_16x16x32_bf16 v[128:131], v[160:163], v[176:179], 0
    s_add_u32 s71, s71, 32768
    s_and_b32 s71, s71, 0x1ffff
    s_waitcnt lgkmcnt(0)
    v_mfma_f32_16x16x32_bf16 v[4:7], v[132:135], v[180:183], v[4:7]
    ds_read_b128 v[148:151], v202 offset:4096
    v_mfma_f32_16x16x32_bf16 v[8:11], v[132:135], v[184:187], v[8:11]
    v_mfma_f32_16x16x32_bf16 v[12:15], v[132:135], v[188:191], v[12:15]
    ds_read_b128 v[152:155], v202 offset:5120
    v_mfma_f32_16x16x32_bf16 v[16:19], v[132:135], v[192:195], v[16:19]
    v_mfma_f32_16x16x32_bf16 v[20:23], v[136:139], v[180:183], v[20:23]
    ds_read_b128 v[156:159], v202 offset:6144
    v_mfma_f32_16x16x32_bf16 v[24:27], v[136:139], v[184:187], v[24:27]
    v_mfma_f32_16x16x32_bf16 v[28:31], v[136:139], v[188:191], v[28:31]
    ds_read_b128 v[160:163], v202 offset:7168
    v_mfma_f32_16x16x32_bf16 v[32:35], v[136:139], v[192:195], v[32:35]
    v_mfma_f32_16x16x32_bf16 v[36:39], v[140:143], v[180:183], v[36:39]
    v_mfma_f32_16x16x32_bf16 v[40:43], v[140:143], v[184:187], v[40:43]
    v_mfma_f32_16x16x32_bf16 v[44:47], v[140:143], v[188:191], v[44:47]
    v_mfma_f32_16x16x32_bf16 v[48:51], v[140:143], v[192:195], v[48:51]
    v_mfma_f32_16x16x32_bf16 v[52:55], v[144:147], v[180:183], v[52:55]
    v_mfma_f32_16x16x32_bf16 v[56:59], v[144:147], v[184:187], v[56:59]
    v_mfma_f32_16x16x32_bf16 v[60:63], v[144:147], v[188:191], v[60:63]
    v_mfma_f32_16x16x32_bf16 v[64:67], v[144:147], v[192:195], v[64:67]
    s_waitcnt vmcnt(8) lgkmcnt(0)
    s_barrier
    v_mfma_f32_16x16x32_bf16 v[68:71], v[148:151], v[180:183], v[68:71]
    v_add_u32 v202, s72, v200
    v_add_u32 v203, s72, v201
    v_xor_b32 v204, 32, v203
    v_xor_b32 v205, 64, v203
    v_xor_b32 v206, 96, v203
    v_mfma_f32_16x16x32_bf16 v[72:75], v[148:151], v[184:187], v[72:75]
    s_add_u32 s72, s72, 32768
    s_and_b32 s72, s72, 0x1ffff
    ds_read_b128 v[132:135], v202 offset:0
    v_mfma_f32_16x16x32_bf16 v[76:79], v[148:151], v[188:191], v[76:79]
    ds_read_b64_tr_b16 v[164:165], v203 offset:0
    v_mfma_f32_16x16x32_bf16 v[80:83], v[148:151], v[192:195], v[80:83]
    ds_read_b64_tr_b16 v[166:167], v203 offset:2048
    ds_read_b64_tr_b16 v[168:169], v204 offset:0
    v_mfma_f32_16x16x32_bf16 v[84:87], v[152:155], v[180:183], v[84:87]
    ds_read_b64_tr_b16 v[170:171], v204 offset:2048
    v_mfma_f32_16x16x32_bf16 v[88:91], v[152:155], v[184:187], v[88:91]
    ds_read_b64_tr_b16 v[172:173], v205 offset:0
    ds_read_b64_tr_b16 v[174:175], v205 offset:2048
    v_mfma_f32_16x16x32_bf16 v[92:95], v[152:155], v[188:191], v[92:95]
    ds_read_b64_tr_b16 v[176:177], v206 offset:0
    v_mfma_f32_16x16x32_bf16 v[96:99], v[152:155], v[192:195], v[96:99]
    ds_read_b64_tr_b16 v[178:179], v206 offset:2048
    ds_read_b128 v[136:139], v202 offset:1024
    v_mfma_f32_16x16x32_bf16 v[100:103], v[156:159], v[180:183], v[100:103]
    ds_read_b128 v[140:143], v202 offset:2048
    ds_read_b128 v[144:147], v202 offset:3072
    v_mfma_f32_16x16x32_bf16 v[104:107], v[156:159], v[184:187], v[104:107]
    s_mov_b32 m0, s71
    v_mfma_f32_16x16x32_bf16 v[108:111], v[156:159], v[188:191], v[108:111]
    buffer_load_dwordx4 v196, s[60:63], s68 offen lds
    s_add_u32 m0, s71, 1024
    v_mfma_f32_16x16x32_bf16 v[112:115], v[156:159], v[192:195], v[112:115]
    buffer_load_dwordx4 v197, s[60:63], s68 offen lds
    v_mfma_f32_16x16x32_bf16 v[116:119], v[160:163], v[180:183], v[116:119]
    s_add_u32 m0, s71, 16384
    s_nop 0
    buffer_load_dwordx4 v198, s[64:67], s69 offen lds
    v_mfma_f32_16x16x32_bf16 v[120:123], v[160:163], v[184:187], v[120:123]
    s_add_u32 m0, s71, 17408
    v_mfma_f32_16x16x32_bf16 v[124:127], v[160:163], v[188:191], v[124:127]
    buffer_load_dwordx4 v199, s[64:67], s69 offen lds
    s_add_u32 s68, s68, 64
    s_add_u32 s69, s69, s70
    v_mfma_f32_16x16x32_bf16 v[128:131], v[160:163], v[192:195], v[128:131]
    s_add_u32 s71, s71, 32768
    s_and_b32 s71, s71, 0x1ffff
    s_mov_b32 s73, 13
gl_51:
    s_waitcnt lgkmcnt(0)
    v_mfma_f32_16x16x32_bf16 v[4:7], v[132:135], v[164:167], v[4:7]
    ds_read_b128 v[148:151], v202 offset:4096
    v_mfma_f32_16x16x32_bf16 v[8:11], v[132:135], v[168:171], v[8:11]
    v_mfma_f32_16x16x32_bf16 v[12:15], v[132:135], v[172:175], v[12:15]
    ds_read_b128 v[152:155], v202 offset:5120
    v_mfma_f32_16x16x32_bf16 v[16:19], v[132:135], v[176:179], v[16:19]
    v_mfma_f32_16x16x32_bf16 v[20:23], v[136:139], v[164:167], v[20:23]
    ds_read_b128 v[156:159], v202 offset:6144
    v_mfma_f32_16x16x32_bf16 v[24:27], v[136:139], v[168:171], v[24:27]
    v_mfma_f32_16x16x32_bf16 v[28:31], v[136:139], v[172:175], v[28:31]
    ds_read_b128 v[160:163], v202 offset:7168
    v_mfma_f32_16x16x32_bf16 v[32:35], v[136:139], v[176:179], v[32:35]
    v_mfma_f32_16x16x32_bf16 v[36:39], v[140:143], v[164:167], v[36:39]
    v_mfma_f32_16x16x32_bf16 v[40:43], v[140:143], v[168:171], v[40:43]
    v_mfma_f32_16x16x32_bf16 v[44:47], v[140:143], v[172:175], v[44:47]
    v_mfma_f32_16x16x32_bf16 v[48:51], v[140:143], v[176:179], v[48:51]
    v_mfma_f32_16x16x32_bf16 v[52:55], v[144:147], v[164:167], v[52:55]
    v_mfma_f32_16x16x32_bf16 v[56:59], v[144:147], v[168:171], v[56:59]
    v_mfma_f32_16x16x32_bf16 v[60:63], v[144:147], v[172:175], v[60:63]
    v_mfma_f32_16x16x32_bf16 v[64:67], v[144:147], v[176:179], v[64:67]
    s_waitcnt vmcnt(8) lgkmcnt(0)
    s_barrier
    v_mfma_f32_16x16x32_bf16 v[68:71], v[148:151], v[164:167], v[68:71]
    v_add_u32 v202, s72, v200
    v_add_u32 v203, s72, v201
    v_xor_b32 v204, 32, v203
    v_xor_b32 v205, 64, v203
    v_xor_b32 v206, 96, v203
    v_mfma_f32_16x16x32_bf16 v[72:75], v[148:151], v[168:171], v[72:75]
    s_add_u32 s72, s72, 32768
    s_and_b32 s72, s72, 0x1ffff
    ds_read_b128 v[132:135], v202 offset:0
    v_mfma_f32_16x16x32_bf16 v[76:79], v[148:151], v[172:175], v[76:79]
    ds_read_b64_tr_b16 v[180:181], v203 offset:0
    v_mfma_f32_16x16x32_bf16 v[80:83], v[148:151], v[176:179], v[80:83]
    ds_read_b64_tr_b16 v[182:183], v203 offset:2048
    ds_read_b64_tr_b16 v[184:185], v204 offset:0
    v_mfma_f32_16x16x32_bf16 v[84:87], v[152:155], v[164:167], v[84:87]
    ds_read_b64_tr_b16 v[186:187], v204 offset:2048
    v_mfma_f32_16x16x32_bf16 v[88:91], v[152:155], v[168:171], v[88:91]
    ds_read_b64_tr_b16 v[188:189], v205 offset:0
    ds_read_b64_tr_b16 v[190:191], v205 offset:2048
    v_mfma_f32_16x16x32_bf16 v[92:95], v[152:155], v[172:175], v[92:95]
    ds_read_b64_tr_b16 v[192:193], v206 offset:0
    v_mfma_f32_16x16x32_bf16 v[96:99], v[152:155], v[176:179], v[96:99]
    ds_read_b64_tr_b16 v[194:195], v206 offset:2048
    ds_read_b128 v[136:139], v202 offset:1024
    v_mfma_f32_16x16x32_bf16 v[100:103], v[156:159], v[164:167], v[100:103]
    ds_read_b128 v[140:143], v202 offset:2048
    ds_read_b128 v[144:147], v202 offset:3072
    v_mfma_f32_16x16x32_bf16 v[104:107], v[156:159], v[168:171], v[104:107]
    s_mov_b32 m0, s71
    v_mfma_f32_16x16x32_bf16 v[108:111], v[156:159], v[172:175], v[108:111]
    buffer_load_dwordx4 v196, s[60:63], s68 offen lds
    s_add_u32 m0, s71, 1024
    v_mfma_f32_16x16x32_bf16 v[112:115], v[156:159], v[176:179], v[112:115]
    buffer_load_dwordx4 v197, s[60:63], s68 offen lds
    v_mfma_f32_16x16x32_bf16 v[116:119], v[160:163], v[164:167], v[116:119]
    s_add_u32 m0, s71, 16384
    s_nop 0
    buffer_load_dwordx4 v198, s[64:67], s69 offen lds
    v_mfma_f32_16x16x32_bf16 v[120:123], v[160:163], v[168:171], v[120:123]
    s_add_u32 m0, s71, 17408
    v_mfma_f32_16x16x32_bf16 v[124:127], v[160:163], v[172:175], v[124:127]
    buffer_load_dwordx4 v199, s[64:67], s69 offen lds
    s_add_u32 s68, s68, 64
    s_add_u32 s69, s69, s70
    v_mfma_f32_16x16x32_bf16 v[128:131], v[160:163], v[176:179], v[128:131]
    s_add_u32 s71, s71, 32768
    s_and_b32 s71, s71, 0x1ffff
    s_waitcnt lgkmcnt(0)
    v_mfma_f32_16x16x32_bf16 v[4:7], v[132:135], v[180:183], v[4:7]
    ds_read_b128 v[148:151], v202 offset:4096
    v_mfma_f32_16x16x32_bf16 v[8:11], v[132:135], v[184:187], v[8:11]
    v_mfma_f32_16x16x32_bf16 v[12:15], v[132:135], v[188:191], v[12:15]
    ds_read_b128 v[152:155], v202 offset:5120
    v_mfma_f32_16x16x32_bf16 v[16:19], v[132:135], v[192:195], v[16:19]
    v_mfma_f32_16x16x32_bf16 v[20:23], v[136:139], v[180:183], v[20:23]
    ds_read_b128 v[156:159], v202 offset:6144
    v_mfma_f32_16x16x32_bf16 v[24:27], v[136:139], v[184:187], v[24:27]
    v_mfma_f32_16x16x32_bf16 v[28:31], v[136:139], v[188:191], v[28:31]
    ds_read_b128 v[160:163], v202 offset:7168
    v_mfma_f32_16x16x32_bf16 v[32:35], v[136:139], v[192:195], v[32:35]
    v_mfma_f32_16x16x32_bf16 v[36:39], v[140:143], v[180:183], v[36:39]
    v_mfma_f32_16x16x32_bf16 v[40:43], v[140:143], v[184:187], v[40:43]
    v_mfma_f32_16x16x32_bf16 v[44:47], v[140:143], v[188:191], v[44:47]
    v_mfma_f32_16x16x32_bf16 v[48:51], v[140:143], v[192:195], v[48:51]
    v_mfma_f32_16x16x32_bf16 v[52:55], v[144:147], v[180:183], v[52:55]
    v_mfma_f32_16x16x32_bf16 v[56:59], v[144:147], v[184:187], v[56:59]
    v_mfma_f32_16x16x32_bf16 v[60:63], v[144:147], v[188:191], v[60:63]
    v_mfma_f32_16x16x32_bf16 v[64:67], v[144:147], v[192:195], v[64:67]
    s_waitcnt vmcnt(8) lgkmcnt(0)
    s_barrier
    v_mfma_f32_16x16x32_bf16 v[68:71], v[148:151], v[180:183], v[68:71]
    v_add_u32 v202, s72, v200
    v_add_u32 v203, s72, v201
    v_xor_b32 v204, 32, v203
    v_xor_b32 v205, 64, v203
    v_xor_b32 v206, 96, v203
    v_mfma_f32_16x16x32_bf16 v[72:75], v[148:151], v[184:187], v[72:75]
    s_add_u32 s72, s72, 32768
    s_and_b32 s72, s72, 0x1ffff
    ds_read_b128 v[132:135], v202 offset:0
    v_mfma_f32_16x16x32_bf16 v[76:79], v[148:151], v[188:191], v[76:79]
    ds_read_b64_tr_b16 v[164:165], v203 offset:0
    v_mfma_f32_16x16x32_bf16 v[80:83], v[148:151], v[192:195], v[80:83]
    ds_read_b64_tr_b16 v[166:167], v203 offset:2048
    ds_read_b64_tr_b16 v[168:169], v204 offset:0
    v_mfma_f32_16x16x32_bf16 v[84:87], v[152:155], v[180:183], v[84:87]
    ds_read_b64_tr_b16 v[170:171], v204 offset:2048
    v_mfma_f32_16x16x32_bf16 v[88:91], v[152:155], v[184:187], v[88:91]
    ds_read_b64_tr_b16 v[172:173], v205 offset:0
    ds_read_b64_tr_b16 v[174:175], v205 offset:2048
    v_mfma_f32_16x16x32_bf16 v[92:95], v[152:155], v[188:191], v[92:95]
    ds_read_b64_tr_b16 v[176:177], v206 offset:0
    v_mfma_f32_16x16x32_bf16 v[96:99], v[152:155], v[192:195], v[96:99]
    ds_read_b64_tr_b16 v[178:179], v206 offset:2048
    ds_read_b128 v[136:139], v202 offset:1024
    v_mfma_f32_16x16x32_bf16 v[100:103], v[156:159], v[180:183], v[100:103]
    ds_read_b128 v[140:143], v202 offset:2048
    ds_read_b128 v[144:147], v202 offset:3072
    v_mfma_f32_16x16x32_bf16 v[104:107], v[156:159], v[184:187], v[104:107]
    s_mov_b32 m0, s71
    v_mfma_f32_16x16x32_bf16 v[108:111], v[156:159], v[188:191], v[108:111]
    buffer_load_dwordx4 v196, s[60:63], s68 offen lds
    s_add_u32 m0, s71, 1024
    v_mfma_f32_16x16x32_bf16 v[112:115], v[156:159], v[192:195], v[112:115]
    buffer_load_dwordx4 v197, s[60:63], s68 offen lds
    v_mfma_f32_16x16x32_bf16 v[116:119], v[160:163], v[180:183], v[116:119]
    s_add_u32 m0, s71, 16384
    s_nop 0
    buffer_load_dwordx4 v198, s[64:67], s69 offen lds
    v_mfma_f32_16x16x32_bf16 v[120:123], v[160:163], v[184:187], v[120:123]
    s_add_u32 m0, s71, 17408
    v_mfma_f32_16x16x32_bf16 v[124:127], v[160:163], v[188:191], v[124:127]
    buffer_load_dwordx4 v199, s[64:67], s69 offen lds
    s_add_u32 s68, s68, 64
    s_add_u32 s69, s69, s70
    v_mfma_f32_16x16x32_bf16 v[128:131], v[160:163], v[192:195], v[128:131]
    s_add_u32 s71, s71, 32768
    s_and_b32 s71, s71, 0x1ffff
    s_sub_u32 s73, s73, 1
    s_cmp_lg_u32 s73, 0
    s_cbranch_scc1 gl_51
    s_waitcnt lgkmcnt(0)
    v_mfma_f32_16x16x32_bf16 v[4:7], v[132:135], v[164:167], v[4:7]
    ds_read_b128 v[148:151], v202 offset:4096
    v_mfma_f32_16x16x32_bf16 v[8:11], v[132:135], v[168:171], v[8:11]
    v_mfma_f32_16x16x32_bf16 v[12:15], v[132:135], v[172:175], v[12:15]
    ds_read_b128 v[152:155], v202 offset:5120
    v_mfma_f32_16x16x32_bf16 v[16:19], v[132:135], v[176:179], v[16:19]
    v_mfma_f32_16x16x32_bf16 v[20:23], v[136:139], v[164:167], v[20:23]
    ds_read_b128 v[156:159], v202 offset:6144
    v_mfma_f32_16x16x32_bf16 v[24:27], v[136:139], v[168:171], v[24:27]
    v_mfma_f32_16x16x32_bf16 v[28:31], v[136:139], v[172:175], v[28:31]
    ds_read_b128 v[160:163], v202 offset:7168
    v_mfma_f32_16x16x32_bf16 v[32:35], v[136:139], v[176:179], v[32:35]
    v_mfma_f32_16x16x32_bf16 v[36:39], v[140:143], v[164:167], v[36:39]
    v_mfma_f32_16x16x32_bf16 v[40:43], v[140:143], v[168:171], v[40:43]
    v_mfma_f32_16x16x32_bf16 v[44:47], v[140:143], v[172:175], v[44:47]
    v_mfma_f32_16x16x32_bf16 v[48:51], v[140:143], v[176:179], v[48:51]
    v_mfma_f32_16x16x32_bf16 v[52:55], v[144:147], v[164:167], v[52:55]
    v_mfma_f32_16x16x32_bf16 v[56:59], v[144:147], v[168:171], v[56:59]
    v_mfma_f32_16x16x32_bf16 v[60:63], v[144:147], v[172:175], v[60:63]
    v_mfma_f32_16x16x32_bf16 v[64:67], v[144:147], v[176:179], v[64:67]
    s_waitcnt vmcnt(8) lgkmcnt(0)
    s_barrier
    v_mfma_f32_16x16x32_bf16 v[68:71], v[148:151], v[164:167], v[68:71]
    v_add_u32 v202, s72, v200
    v_add_u32 v203, s72, v201
    v_mfma_f32_16x16x32_bf16 v[72:75], v[148:151], v[168:171], v[72:75]
    v_xor_b32 v204, 32, v203
    v_xor_b32 v205, 64, v203
    v_xor_b32 v206, 96, v203
    v_mfma_f32_16x16x32_bf16 v[76:79], v[148:151], v[172:175], v[76:79]
    s_add_u32 s72, s72, 32768
    s_and_b32 s72, s72, 0x1ffff
    v_mfma_f32_16x16x32_bf16 v[80:83], v[148:151], v[176:179], v[80:83]
    ds_read_b128 v[132:135], v202 offset:0
    v_mfma_f32_16x16x32_bf16 v[84:87], v[152:155], v[164:167], v[84:87]
    ds_read_b64_tr_b16 v[180:181], v203 offset:0
    v_mfma_f32_16x16x32_bf16 v[88:91], v[152:155], v[168:171], v[88:91]
    ds_read_b64_tr_b16 v[182:183], v203 offset:2048
    v_mfma_f32_16x16x32_bf16 v[92:95], v[152:155], v[172:175], v[92:95]
    ds_read_b64_tr_b16 v[184:185], v204 offset:0
    v_mfma_f32_16x16x32_bf16 v[96:99], v[152:155], v[176:179], v[96:99]
    ds_read_b64_tr_b16 v[186:187], v204 offset:2048
    v_mfma_f32_16x16x32_bf16 v[100:103], v[156:159], v[164:167], v[100:103]
    ds_read_b64_tr_b16 v[188:189], v205 offset:0
    v_mfma_f32_16x16x32_bf16 v[104:107], v[156:159], v[168:171], v[104:107]
    ds_read_b64_tr_b16 v[190:191], v205 offset:2048
    v_mfma_f32_16x16x32_bf16 v[108:111], v[156:159], v[172:175], v[108:111]
    ds_read_b64_tr_b16 v[192:193], v206 offset:0
    v_mfma_f32_16x16x32_bf16 v[112:115], v[156:159], v[176:179], v[112:115]
    ds_read_b64_tr_b16 v[194:195], v206 offset:2048
    v_mfma_f32_16x16x32_bf16 v[116:119], v[160:163], v[164:167], v[116:119]
    ds_read_b128 v[136:139], v202 offset:1024
    v_mfma_f32_16x16x32_bf16 v[120:123], v[160:163], v[168:171], v[120:123]
    ds_read_b128 v[140:143], v202 offset:2048
    v_mfma_f32_16x16x32_bf16 v[124:127], v[160:163], v[172:175], v[124:127]
    ds_read_b128 v[144:147], v202 offset:3072
    v_mfma_f32_16x16x32_bf16 v[128:131], v[160:163], v[176:179], v[128:131]
    s_waitcnt lgkmcnt(0)
    v_mfma_f32_16x16x32_bf16 v[4:7], v[132:135], v[180:183], v[4:7]
    ds_read_b128 v[148:151], v202 offset:4096
    v_mfma_f32_16x16x32_bf16 v[8:11], v[132:135], v[184:187], v[8:11]
    v_mfma_f32_16x16x32_bf16 v[12:15], v[132:135], v[188:191], v[12:15]
    ds_read_b128 v[152:155], v202 offset:5120
    v_mfma_f32_16x16x32_bf16 v[16:19], v[132:135], v[192:195], v[16:19]
    v_mfma_f32_16x16x32_bf16 v[20:23], v[136:139], v[180:183], v[20:23]
    ds_read_b128 v[156:159], v202 offset:6144
    v_mfma_f32_16x16x32_bf16 v[24:27], v[136:139], v[184:187], v[24:27]
    v_mfma_f32_16x16x32_bf16 v[28:31], v[136:139], v[188:191], v[28:31]
    ds_read_b128 v[160:163], v202 offset:7168
    v_mfma_f32_16x16x32_bf16 v[32:35], v[136:139], v[192:195], v[32:35]
    v_mfma_f32_16x16x32_bf16 v[36:39], v[140:143], v[180:183], v[36:39]
    v_mfma_f32_16x16x32_bf16 v[40:43], v[140:143], v[184:187], v[40:43]
    v_mfma_f32_16x16x32_bf16 v[44:47], v[140:143], v[188:191], v[44:47]
    v_mfma_f32_16x16x32_bf16 v[48:51], v[140:143], v[192:195], v[48:51]
    v_mfma_f32_16x16x32_bf16 v[52:55], v[144:147], v[180:183], v[52:55]
    v_mfma_f32_16x16x32_bf16 v[56:59], v[144:147], v[184:187], v[56:59]
    v_mfma_f32_16x16x32_bf16 v[60:63], v[144:147], v[188:191], v[60:63]
    v_mfma_f32_16x16x32_bf16 v[64:67], v[144:147], v[192:195], v[64:67]
    s_waitcnt vmcnt(4) lgkmcnt(0)
    s_barrier
    v_mfma_f32_16x16x32_bf16 v[68:71], v[148:151], v[180:183], v[68:71]
    v_add_u32 v202, s72, v200
    v_add_u32 v203, s72, v201
    v_mfma_f32_16x16x32_bf16 v[72:75], v[148:151], v[184:187], v[72:75]
    v_xor_b32 v204, 32, v203
    v_xor_b32 v205, 64, v203
    v_xor_b32 v206, 96, v203
    v_mfma_f32_16x16x32_bf16 v[76:79], v[148:151], v[188:191], v[76:79]
    s_add_u32 s72, s72, 32768
    s_and_b32 s72, s72, 0x1ffff
    v_mfma_f32_16x16x32_bf16 v[80:83], v[148:151], v[192:195], v[80:83]
    ds_read_b128 v[132:135], v202 offset:0
    v_mfma_f32_16x16x32_bf16 v[84:87], v[152:155], v[180:183], v[84:87]
    ds_read_b64_tr_b16 v[164:165], v203 offset:0
    v_mfma_f32_16x16x32_bf16 v[88:91], v[152:155], v[184:187], v[88:91]
    ds_read_b64_tr_b16 v[166:167], v203 offset:2048
    v_mfma_f32_16x16x32_bf16 v[92:95], v[152:155], v[188:191], v[92:95]
    ds_read_b64_tr_b16 v[168:169], v204 offset:0
    v_mfma_f32_16x16x32_bf16 v[96:99], v[152:155], v[192:195], v[96:99]
    ds_read_b64_tr_b16 v[170:171], v204 offset:2048
    v_mfma_f32_16x16x32_bf16 v[100:103], v[156:159], v[180:183], v[100:103]
    ds_read_b64_tr_b16 v[172:173], v205 offset:0
    v_mfma_f32_16x16x32_bf16 v[104:107], v[156:159], v[184:187], v[104:107]
    ds_read_b64_tr_b16 v[174:175], v205 offset:2048
    v_mfma_f32_16x16x32_bf16 v[108:111], v[156:159], v[188:191], v[108:111]
    ds_read_b64_tr_b16 v[176:177], v206 offset:0
    v_mfma_f32_16x16x32_bf16 v[112:115], v[156:159], v[192:195], v[112:115]
    ds_read_b64_tr_b16 v[178:179], v206 offset:2048
    v_mfma_f32_16x16x32_bf16 v[116:119], v[160:163], v[180:183], v[116:119]
    ds_read_b128 v[136:139], v202 offset:1024
    v_mfma_f32_16x16x32_bf16 v[120:123], v[160:163], v[184:187], v[120:123]
    ds_read_b128 v[140:143], v202 offset:2048
    v_mfma_f32_16x16x32_bf16 v[124:127], v[160:163], v[188:191], v[124:127]
    ds_read_b128 v[144:147], v202 offset:3072
    v_mfma_f32_16x16x32_bf16 v[128:131], v[160:163], v[192:195], v[128:131]
    s_waitcnt lgkmcnt(0)
    v_mfma_f32_16x16x32_bf16 v[4:7], v[132:135], v[164:167], v[4:7]
    ds_read_b128 v[148:151], v202 offset:4096
    v_mfma_f32_16x16x32_bf16 v[8:11], v[132:135], v[168:171], v[8:11]
    v_mfma_f32_16x16x32_bf16 v[12:15], v[132:135], v[172:175], v[12:15]
    ds_read_b128 v[152:155], v202 offset:5120
    v_mfma_f32_16x16x32_bf16 v[16:19], v[132:135], v[176:179], v[16:19]
    v_mfma_f32_16x16x32_bf16 v[20:23], v[136:139], v[164:167], v[20:23]
    ds_read_b128 v[156:159], v202 offset:6144
    v_mfma_f32_16x16x32_bf16 v[24:27], v[136:139], v[168:171], v[24:27]
    v_mfma_f32_16x16x32_bf16 v[28:31], v[136:139], v[172:175], v[28:31]
    ds_read_b128 v[160:163], v202 offset:7168
    v_mfma_f32_16x16x32_bf16 v[32:35], v[136:139], v[176:179], v[32:35]
    v_mfma_f32_16x16x32_bf16 v[36:39], v[140:143], v[164:167], v[36:39]
    v_mfma_f32_16x16x32_bf16 v[40:43], v[140:143], v[168:171], v[40:43]
    v_mfma_f32_16x16x32_bf16 v[44:47], v[140:143], v[172:175], v[44:47]
    v_mfma_f32_16x16x32_bf16 v[48:51], v[140:143], v[176:179], v[48:51]
    v_mfma_f32_16x16x32_bf16 v[52:55], v[144:147], v[164:167], v[52:55]
    v_mfma_f32_16x16x32_bf16 v[56:59], v[144:147], v[168:171], v[56:59]
    v_mfma_f32_16x16x32_bf16 v[60:63], v[144:147], v[172:175], v[60:63]
    v_mfma_f32_16x16x32_bf16 v[64:67], v[144:147], v[176:179], v[64:67]
    s_waitcnt vmcnt(0) lgkmcnt(0)
    s_barrier
    v_mfma_f32_16x16x32_bf16 v[68:71], v[148:151], v[164:167], v[68:71]
    v_add_u32 v202, s72, v200
    v_add_u32 v203, s72, v201
    v_mfma_f32_16x16x32_bf16 v[72:75], v[148:151], v[168:171], v[72:75]
    v_xor_b32 v204, 32, v203
    v_xor_b32 v205, 64, v203
    v_xor_b32 v206, 96, v203
    v_mfma_f32_16x16x32_bf16 v[76:79], v[148:151], v[172:175], v[76:79]
    s_add_u32 s72, s72, 32768
    s_and_b32 s72, s72, 0x1ffff
    v_mfma_f32_16x16x32_bf16 v[80:83], v[148:151], v[176:179], v[80:83]
    ds_read_b128 v[132:135], v202 offset:0
    v_mfma_f32_16x16x32_bf16 v[84:87], v[152:155], v[164:167], v[84:87]
    ds_read_b64_tr_b16 v[180:181], v203 offset:0
    v_mfma_f32_16x16x32_bf16 v[88:91], v[152:155], v[168:171], v[88:91]
    ds_read_b64_tr_b16 v[182:183], v203 offset:2048
    v_mfma_f32_16x16x32_bf16 v[92:95], v[152:155], v[172:175], v[92:95]
    ds_read_b64_tr_b16 v[184:185], v204 offset:0
    v_mfma_f32_16x16x32_bf16 v[96:99], v[152:155], v[176:179], v[96:99]
    ds_read_b64_tr_b16 v[186:187], v204 offset:2048
    v_mfma_f32_16x16x32_bf16 v[100:103], v[156:159], v[164:167], v[100:103]
    ds_read_b64_tr_b16 v[188:189], v205 offset:0
    v_mfma_f32_16x16x32_bf16 v[104:107], v[156:159], v[168:171], v[104:107]
    ds_read_b64_tr_b16 v[190:191], v205 offset:2048
    v_mfma_f32_16x16x32_bf16 v[108:111], v[156:159], v[172:175], v[108:111]
    ds_read_b64_tr_b16 v[192:193], v206 offset:0
    v_mfma_f32_16x16x32_bf16 v[112:115], v[156:159], v[176:179], v[112:115]
    ds_read_b64_tr_b16 v[194:195], v206 offset:2048
    v_mfma_f32_16x16x32_bf16 v[116:119], v[160:163], v[164:167], v[116:119]
    ds_read_b128 v[136:139], v202 offset:1024
    v_mfma_f32_16x16x32_bf16 v[120:123], v[160:163], v[168:171], v[120:123]
    ds_read_b128 v[140:143], v202 offset:2048
    v_mfma_f32_16x16x32_bf16 v[124:127], v[160:163], v[172:175], v[124:127]
    ds_read_b128 v[144:147], v202 offset:3072
    v_mfma_f32_16x16x32_bf16 v[128:131], v[160:163], v[176:179], v[128:131]
    s_waitcnt lgkmcnt(0)
    v_mfma_f32_16x16x32_bf16 v[4:7], v[132:135], v[180:183], v[4:7]
    ds_read_b128 v[148:151], v202 offset:4096
    v_mfma_f32_16x16x32_bf16 v[8:11], v[132:135], v[184:187], v[8:11]
    v_mfma_f32_16x16x32_bf16 v[12:15], v[132:135], v[188:191], v[12:15]
    ds_read_b128 v[152:155], v202 offset:5120
    v_mfma_f32_16x16x32_bf16 v[16:19], v[132:135], v[192:195], v[16:19]
    v_mfma_f32_16x16x32_bf16 v[20:23], v[136:139], v[180:183], v[20:23]
    ds_read_b128 v[156:159], v202 offset:6144
    v_mfma_f32_16x16x32_bf16 v[24:27], v[136:139], v[184:187], v[24:27]
    v_mfma_f32_16x16x32_bf16 v[28:31], v[136:139], v[188:191], v[28:31]
    ds_read_b128 v[160:163], v202 offset:7168
    v_mfma_f32_16x16x32_bf16 v[32:35], v[136:139], v[192:195], v[32:35]
    v_mfma_f32_16x16x32_bf16 v[36:39], v[140:143], v[180:183], v[36:39]
    v_mfma_f32_16x16x32_bf16 v[40:43], v[140:143], v[184:187], v[40:43]
    v_mfma_f32_16x16x32_bf16 v[44:47], v[140:143], v[188:191], v[44:47]
    v_mfma_f32_16x16x32_bf16 v[48:51], v[140:143], v[192:195], v[48:51]
    v_mfma_f32_16x16x32_bf16 v[52:55], v[144:147], v[180:183], v[52:55]
    v_mfma_f32_16x16x32_bf16 v[56:59], v[144:147], v[184:187], v[56:59]
    v_mfma_f32_16x16x32_bf16 v[60:63], v[144:147], v[188:191], v[60:63]
    v_mfma_f32_16x16x32_bf16 v[64:67], v[144:147], v[192:195], v[64:67]
    s_waitcnt lgkmcnt(0)
    v_mfma_f32_16x16x32_bf16 v[68:71], v[148:151], v[180:183], v[68:71]
    v_mfma_f32_16x16x32_bf16 v[72:75], v[148:151], v[184:187], v[72:75]
    v_mfma_f32_16x16x32_bf16 v[76:79], v[148:151], v[188:191], v[76:79]
    v_mfma_f32_16x16x32_bf16 v[80:83], v[148:151], v[192:195], v[80:83]
    v_mfma_f32_16x16x32_bf16 v[84:87], v[152:155], v[180:183], v[84:87]
    v_mfma_f32_16x16x32_bf16 v[88:91], v[152:155], v[184:187], v[88:91]
    v_mfma_f32_16x16x32_bf16 v[92:95], v[152:155], v[188:191], v[92:95]
    v_mfma_f32_16x16x32_bf16 v[96:99], v[152:155], v[192:195], v[96:99]
    v_mfma_f32_16x16x32_bf16 v[100:103], v[156:159], v[180:183], v[100:103]
    v_mfma_f32_16x16x32_bf16 v[104:107], v[156:159], v[184:187], v[104:107]
    v_mfma_f32_16x16x32_bf16 v[108:111], v[156:159], v[188:191], v[108:111]
    v_mfma_f32_16x16x32_bf16 v[112:115], v[156:159], v[192:195], v[112:115]
    v_mfma_f32_16x16x32_bf16 v[116:119], v[160:163], v[180:183], v[116:119]
    v_mfma_f32_16x16x32_bf16 v[120:123], v[160:163], v[184:187], v[120:123]
    v_mfma_f32_16x16x32_bf16 v[124:127], v[160:163], v[188:191], v[124:127]
    v_mfma_f32_16x16x32_bf16 v[128:131], v[160:163], v[192:195], v[128:131]
    v_cvt_pk_bf16_f32 v132, v4, v5
    v_cvt_pk_bf16_f32 v133, v6, v7
    v_cvt_pk_bf16_f32 v134, v20, v21
    v_cvt_pk_bf16_f32 v135, v22, v23
    buffer_store_dwordx4 v[132:135], v207, s[8:11], s81 offen offset:0 sc1
    v_cvt_pk_bf16_f32 v136, v8, v9
    v_cvt_pk_bf16_f32 v137, v10, v11
    v_cvt_pk_bf16_f32 v138, v24, v25
    v_cvt_pk_bf16_f32 v139, v26, v27
    buffer_store_dwordx4 v[136:139], v207, s[8:11], s81 offen offset:256 sc1
    v_cvt_pk_bf16_f32 v140, v12, v13
    v_cvt_pk_bf16_f32 v141, v14, v15
    v_cvt_pk_bf16_f32 v142, v28, v29
    v_cvt_pk_bf16_f32 v143, v30, v31
    buffer_store_dwordx4 v[140:143], v207, s[8:11], s81 offen offset:2048 sc1
    v_cvt_pk_bf16_f32 v144, v16, v17
    v_cvt_pk_bf16_f32 v145, v18, v19
    v_cvt_pk_bf16_f32 v146, v32, v33
    v_cvt_pk_bf16_f32 v147, v34, v35
    buffer_store_dwordx4 v[144:147], v207, s[8:11], s81 offen offset:2304 sc1
    s_add_u32 s81, s81, s82
    v_cvt_pk_bf16_f32 v148, v36, v37
    v_cvt_pk_bf16_f32 v149, v38, v39
    v_cvt_pk_bf16_f32 v150, v52, v53
    v_cvt_pk_bf16_f32 v151, v54, v55
    buffer_store_dwordx4 v[148:151], v207, s[8:11], s81 offen offset:0 sc1
    v_cvt_pk_bf16_f32 v152, v40, v41
    v_cvt_pk_bf16_f32 v153, v42, v43
    v_cvt_pk_bf16_f32 v154, v56, v57
    v_cvt_pk_bf16_f32 v155, v58, v59
    buffer_store_dwordx4 v[152:155], v207, s[8:11], s81 offen offset:256 sc1
    v_cvt_pk_bf16_f32 v156, v44, v45
    v_cvt_pk_bf16_f32 v157, v46, v47
    v_cvt_pk_bf16_f32 v158, v60, v61
    v_cvt_pk_bf16_f32 v159, v62, v63
    buffer_store_dwordx4 v[156:159], v207, s[8:11], s81 offen offset:2048 sc1
    v_cvt_pk_bf16_f32 v160, v48, v49
    v_cvt_pk_bf16_f32 v161, v50, v51
    v_cvt_pk_bf16_f32 v162, v64, v65
    v_cvt_pk_bf16_f32 v163, v66, v67
    buffer_store_dwordx4 v[160:163], v207, s[8:11], s81 offen offset:2304 sc1
    s_add_u32 s81, s81, s82
    v_cvt_pk_bf16_f32 v164, v68, v69
    v_cvt_pk_bf16_f32 v165, v70, v71
    v_cvt_pk_bf16_f32 v166, v84, v85
    v_cvt_pk_bf16_f32 v167, v86, v87
    buffer_store_dwordx4 v[164:167], v207, s[8:11], s81 offen offset:0 sc1
    v_cvt_pk_bf16_f32 v168, v72, v73
    v_cvt_pk_bf16_f32 v169, v74, v75
    v_cvt_pk_bf16_f32 v170, v88, v89
    v_cvt_pk_bf16_f32 v171, v90, v91
    buffer_store_dwordx4 v[168:171], v207, s[8:11], s81 offen offset:256 sc1
    v_cvt_pk_bf16_f32 v172, v76, v77
    v_cvt_pk_bf16_f32 v173, v78, v79
    v_cvt_pk_bf16_f32 v174, v92, v93
    v_cvt_pk_bf16_f32 v175, v94, v95
    buffer_store_dwordx4 v[172:175], v207, s[8:11], s81 offen offset:2048 sc1
    v_cvt_pk_bf16_f32 v176, v80, v81
    v_cvt_pk_bf16_f32 v177, v82, v83
    v_cvt_pk_bf16_f32 v178, v96, v97
    v_cvt_pk_bf16_f32 v179, v98, v99
    buffer_store_dwordx4 v[176:179], v207, s[8:11], s81 offen offset:2304 sc1
    s_add_u32 s81, s81, s82
    v_cvt_pk_bf16_f32 v180, v100, v101
    v_cvt_pk_bf16_f32 v181, v102, v103
    v_cvt_pk_bf16_f32 v182, v116, v117
    v_cvt_pk_bf16_f32 v183, v118, v119
    buffer_store_dwordx4 v[180:183], v207, s[8:11], s81 offen offset:0 sc1
    v_cvt_pk_bf16_f32 v184, v104, v105
    v_cvt_pk_bf16_f32 v185, v106, v107
    v_cvt_pk_bf16_f32 v186, v120, v121
    v_cvt_pk_bf16_f32 v187, v122, v123
    buffer_store_dwordx4 v[184:187], v207, s[8:11], s81 offen offset:256 sc1
    v_cvt_pk_bf16_f32 v188, v108, v109
    v_cvt_pk_bf16_f32 v189, v110, v111
    v_cvt_pk_bf16_f32 v190, v124, v125
    v_cvt_pk_bf16_f32 v191, v126, v127
    buffer_store_dwordx4 v[188:191], v207, s[8:11], s81 offen offset:2048 sc1
    v_cvt_pk_bf16_f32 v192, v112, v113
    v_cvt_pk_bf16_f32 v193, v114, v115
    v_cvt_pk_bf16_f32 v194, v128, v129
    v_cvt_pk_bf16_f32 v195, v130, v131
    buffer_store_dwordx4 v[192:195], v207, s[8:11], s81 offen offset:2304 sc1
next_43:
    s_waitcnt vmcnt(0)
    s_barrier
    s_cmp_lg_u32 s58, 0
    s_cbranch_scc1 sig_52
    v_mov_b32 v203, 0x5ffffff0
    v_mov_b32 v204, s83
    v_cmp_eq_u32 vcc, 0, v1
    s_nop 1
    v_cndmask_b32 v204, v203, v204, vcc
    v_mov_b32 v203, 1
    buffer_atomic_add v203, v204, s[12:15], 0 offen sc1
    s_waitcnt vmcnt(0)
sig_52:
    s_cmp_lg_u32 s78, 0
    s_cbranch_scc1 notr0_57
    v_bfe_u32 v204, v1, 2, 2
    v_sub_u32 v204, 0, v204
    v_lshrrev_b32 v203, 4, v1
    v_xor_b32 v204, v204, v203
    v_and_b32 v204, 3, v204
    v_bfe_u32 v200, v1, 0, 4
    v_lshlrev_b32 v200, 6, v200
    v_lshl_or_b32 v200, v204, 4, v200
    s_lshr_b32 s74, s58, 2
    s_mul_i32 s74, s74, 8192
    v_add_u32 v200, s74, v200
    v_bfe_u32 v201, v1, 0, 2
    v_lshlrev_b32 v201, 3, v201
    v_bfe_u32 v203, v1, 4, 1
    v_lshl_or_b32 v201, v203, 5, v201
    v_bfe_u32 v203, v1, 2, 2
    v_lshl_or_b32 v201, v203, 6, v201
    v_bfe_u32 v203, v1, 2, 2
    v_lshl_or_b32 v201, v203, 9, v201
    v_bfe_u32 v203, v1, 4, 2
    v_lshl_or_b32 v201, v203, 12, v201
    s_and_b32 s74, s58, 3
    s_mul_i32 s74, s74, 128
    s_or_b32 s74, s74, 16384
    v_xor_b32 v201, s74, v201
notr0_57:
    s_add_u32 s78, s78, 1
    s_cmp_eq_u32 s78, 3
    s_cbranch_scc1 q_53
    s_cmp_eq_u32 s78, 4
    s_cbranch_scc1 col_54
    s_lshl_b32 s79, s78, 2
    s_lshr_b32 s84, s57, 3
    s_add_u32 s79, s79, s84
    s_sub_u32 s79, s79, 3
    s_cmp_eq_u32 s79, 8
    s_cbranch_scc1 p1_55
    s_bfe_u32 s80, s76, 0x30000
    s_bfe_u32 s84, s76, 0x10005
    s_lshl_b32 s84, s84, 3
    s_or_b32 s80, s80, s84
    s_lshl_b32 s83, s79, 2
    s_add_u32 s83, s83, 128
    s_cmp_ge_u32 s75, 2
    s_cbranch_scc1 v1_56
    s_mov_b64 s[60:61], s[36:37]
    s_mov_b32 s62, 0x400000
    s_mov_b32 s63, 0x20000
    s_mov_b64 s[64:65], s[24:25]
    s_mov_b32 s66, 0x800000
    s_mov_b32 s67, 0x20000
    v_lshrrev_b32 v204, 4, v1
    v_sub_u32 v204, 0, v204
    v_xor_b32 v204, v204, v1
    v_and_b32 v204, 3, v204
    s_mul_i32 s74, s58, 32
    v_lshrrev_b32 v205, 2, v1
    v_add3_u32 v205, v205, s74, 0
    v_lshlrev_b32 v196, 11, v205
    v_lshl_add_u32 v196, v204, 4, v196
    v_lshrrev_b32 v205, 2, v1
    v_add3_u32 v205, v205, s74, 16
    v_lshlrev_b32 v197, 11, v205
    v_lshl_add_u32 v197, v204, 4, v197
    s_and_b32 s74, s58, 2
    v_bfe_u32 v204, v1, 0, 5
    v_bfe_u32 v205, v1, 5, 1
    v_lshlrev_b32 v205, 2, v205
    v_xor_b32 v204, v204, v205
    v_xor_b32 v204, s74, v204
    v_bfe_u32 v205, v204, 0, 1
    v_lshlrev_b32 v205, 5, v205
    v_bfe_u32 v203, v204, 1, 1
    v_lshl_or_b32 v205, v203, 4, v205
    v_bfe_u32 v203, v204, 2, 3
    v_lshl_or_b32 v205, v203, 6, v205
    v_lshrrev_b32 v204, 5, v1
    v_lshl_add_u32 v198, v204, 13, v205
    v_bfe_u32 v204, v1, 0, 5
    v_bfe_u32 v205, v1, 5, 1
    v_lshlrev_b32 v205, 2, v205
    v_xor_b32 v204, v204, v205
    v_xor_b32 v204, s74, v204
    v_xor_b32 v204, 8, v204
    v_bfe_u32 v205, v204, 0, 1
    v_lshlrev_b32 v205, 5, v205
    v_bfe_u32 v203, v204, 1, 1
    v_lshl_or_b32 v205, v203, 4, v205
    v_bfe_u32 v203, v204, 2, 3
    v_lshl_or_b32 v205, v203, 6, v205
    v_lshrrev_b32 v204, 5, v1
    v_lshl_add_u32 v199, v204, 13, v205
    v_add_u32 v199, 16384, v199
    s_lshl_b32 s74, s58, 15
    v_add_u32 v198, s74, v198
    v_add_u32 v199, s74, v199
    s_mov_b32 s70, 262144
    s_mul_i32 s68, s79, 524288
    s_mul_i32 s69, s80, 512
    s_mov_b32 s82, 0x40000
    s_lshl_b32 s81, s79, 1
    s_lshr_b32 s84, s58, 2
    s_add_u32 s81, s81, s84
    s_mul_i32 s81, s81, s82
    s_mul_i32 s81, s81, 4
    s_lshl_b32 s74, s80, 2
    s_and_b32 s84, s58, 3
    s_add_u32 s84, s84, s74
    s_mul_i32 s84, s84, 4096
    s_add_u32 s81, s81, s84
    s_add_u32 s81, s81, 0x1000000
    s_mul_i32 s71, s58, 2048
    s_mov_b32 m0, s71
    s_nop 0
    buffer_load_dwordx4 v196, s[60:63], s68 offen lds
    s_add_u32 m0, s71, 1024
    s_nop 0
    buffer_load_dwordx4 v197, s[60:63], s68 offen lds
    s_add_u32 m0, s71, 16384
    s_nop 0
    buffer_load_dwordx4 v198, s[64:67], s69 offen lds
    s_add_u32 m0, s71, 17408
    s_nop 0
    buffer_load_dwordx4 v199, s[64:67], s69 offen lds
    s_add_u32 s68, s68, 64
    s_add_u32 s69, s69, s70
    s_add_u32 s71, s71, 32768
    s_and_b32 s71, s71, 0x1ffff
    s_mov_b32 m0, s71
    s_nop 0
    buffer_load_dwordx4 v196, s[60:63], s68 offen lds
    s_add_u32 m0, s71, 1024
    s_nop 0
    buffer_load_dwordx4 v197, s[60:63], s68 offen lds
    s_add_u32 m0, s71, 16384
    s_nop 0
    buffer_load_dwordx4 v198, s[64:67], s69 offen lds
    s_add_u32 m0, s71, 17408
    s_nop 0
    buffer_load_dwordx4 v199, s[64:67], s69 offen lds
    s_add_u32 s68, s68, 64
    s_add_u32 s69, s69, s70
    s_add_u32 s71, s71, 32768
    s_and_b32 s71, s71, 0x1ffff
    s_mov_b32 m0, s71
    s_nop 0
    buffer_load_dwordx4 v196, s[60:63], s68 offen lds
    s_add_u32 m0, s71, 1024
    s_nop 0
    buffer_load_dwordx4 v197, s[60:63], s68 offen lds
    s_add_u32 m0, s71, 16384
    s_nop 0
    buffer_load_dwordx4 v198, s[64:67], s69 offen lds
    s_add_u32 m0, s71, 17408
    s_nop 0
    buffer_load_dwordx4 v199, s[64:67], s69 offen lds
    s_add_u32 s68, s68, 64
    s_add_u32 s69, s69, s70
    s_add_u32 s71, s71, 32768
    s_and_b32 s71, s71, 0x1ffff
    s_mov_b32 m0, s71
    s_nop 0
    buffer_load_dwordx4 v196, s[60:63], s68 offen lds
    s_add_u32 m0, s71, 1024
    s_nop 0
    buffer_load_dwordx4 v197, s[60:63], s68 offen lds
    s_add_u32 m0, s71, 16384
    s_nop 0
    buffer_load_dwordx4 v198, s[64:67], s69 offen lds
    s_add_u32 m0, s71, 17408
    s_nop 0
    buffer_load_dwordx4 v199, s[64:67], s69 offen lds
    s_add_u32 s68, s68, 64
    s_add_u32 s69, s69, s70
    s_add_u32 s71, s71, 32768
    s_and_b32 s71, s71, 0x1ffff
    s_branch f256_41
v1_56:
    s_mov_b64 s[60:61], s[36:37]
    s_mov_b32 s62, 0x400000
    s_mov_b32 s63, 0x20000
    s_mov_b64 s[64:65], s[28:29]
    s_mov_b32 s66, 0x800000
    s_mov_b32 s67, 0x20000
    v_lshrrev_b32 v204, 4, v1
    v_sub_u32 v204, 0, v204
    v_xor_b32 v204, v204, v1
    v_and_b32 v204, 3, v204
    s_mul_i32 s74, s58, 32
    v_lshrrev_b32 v205, 2, v1
    v_add3_u32 v205, v205, s74, 0
    v_bfe_u32 v196, v205, 0, 3
    v_lshlrev_b32 v196, 11, v196
    v_bfe_u32 v203, v205, 3, 1
    v_lshl_or_b32 v196, v203, 15, v196
    v_bfe_u32 v203, v205, 4, 1
    v_lshl_or_b32 v196, v203, 14, v196
    v_bfe_u32 v203, v205, 5, 3
    v_lshl_or_b32 v196, v203, 16, v196
    v_lshl_add_u32 v196, v204, 4, v196
    v_lshrrev_b32 v205, 2, v1
    v_add3_u32 v205, v205, s74, 16
    v_bfe_u32 v197, v205, 0, 3
    v_lshlrev_b32 v197, 11, v197
    v_bfe_u32 v203, v205, 3, 1
    v_lshl_or_b32 v197, v203, 15, v197
    v_bfe_u32 v203, v205, 4, 1
    v_lshl_or_b32 v197, v203, 14, v197
    v_bfe_u32 v203, v205, 5, 3
    v_lshl_or_b32 v197, v203, 16, v197
    v_lshl_add_u32 v197, v204, 4, v197
    s_and_b32 s74, s58, 2
    v_bfe_u32 v204, v1, 0, 5
    v_bfe_u32 v205, v1, 5, 1
    v_lshlrev_b32 v205, 2, v205
    v_xor_b32 v204, v204, v205
    v_xor_b32 v204, s74, v204
    v_lshlrev_b32 v205, 4, v204
    v_lshrrev_b32 v204, 5, v1
    v_lshl_add_u32 v198, v204, 13, v205
    v_bfe_u32 v204, v1, 0, 5
    v_bfe_u32 v205, v1, 5, 1
    v_lshlrev_b32 v205, 2, v205
    v_xor_b32 v204, v204, v205
    v_xor_b32 v204, s74, v204
    v_xor_b32 v204, 8, v204
    v_lshlrev_b32 v205, 4, v204
    v_lshrrev_b32 v204, 5, v1
    v_lshl_add_u32 v199, v204, 13, v205
    v_add_u32 v199, 16384, v199
    s_lshl_b32 s74, s58, 15
    v_add_u32 v198, s74, v198
    v_add_u32 v199, s74, v199
    s_mov_b32 s70, 262144
    s_mul_i32 s68, s79, 524288
    s_mul_i32 s69, s80, 512
    s_mov_b32 s82, 0x40000
    s_lshl_b32 s81, s79, 1
    s_lshr_b32 s84, s58, 2
    s_add_u32 s81, s81, s84
    s_mul_i32 s81, s81, s82
    s_mul_i32 s81, s81, 4
    s_lshl_b32 s74, s80, 2
    s_and_b32 s84, s58, 3
    s_add_u32 s84, s84, s74
    s_mul_i32 s84, s84, 4096
    s_add_u32 s81, s81, s84
    s_add_u32 s81, s81, 0x2000000
    s_mul_i32 s71, s58, 2048
    s_mov_b32 m0, s71
    s_nop 0
    buffer_load_dwordx4 v196, s[60:63], s68 offen lds
    s_add_u32 m0, s71, 1024
    s_nop 0
    buffer_load_dwordx4 v197, s[60:63], s68 offen lds
    s_add_u32 m0, s71, 16384
    s_nop 0
    buffer_load_dwordx4 v198, s[64:67], s69 offen lds
    s_add_u32 m0, s71, 17408
    s_nop 0
    buffer_load_dwordx4 v199, s[64:67], s69 offen lds
    s_add_u32 s68, s68, 64
    s_add_u32 s69, s69, s70
    s_add_u32 s71, s71, 32768
    s_and_b32 s71, s71, 0x1ffff
    s_mov_b32 m0, s71
    s_nop 0
    buffer_load_dwordx4 v196, s[60:63], s68 offen lds
    s_add_u32 m0, s71, 1024
    s_nop 0
    buffer_load_dwordx4 v197, s[60:63], s68 offen lds
    s_add_u32 m0, s71, 16384
    s_nop 0
    buffer_load_dwordx4 v198, s[64:67], s69 offen lds
    s_add_u32 m0, s71, 17408
    s_nop 0
    buffer_load_dwordx4 v199, s[64:67], s69 offen lds
    s_add_u32 s68, s68, 64
    s_add_u32 s69, s69, s70
    s_add_u32 s71, s71, 32768
    s_and_b32 s71, s71, 0x1ffff
    s_mov_b32 m0, s71
    s_nop 0
    buffer_load_dwordx4 v196, s[60:63], s68 offen lds
    s_add_u32 m0, s71, 1024
    s_nop 0
    buffer_load_dwordx4 v197, s[60:63], s68 offen lds
    s_add_u32 m0, s71, 16384
    s_nop 0
    buffer_load_dwordx4 v198, s[64:67], s69 offen lds
    s_add_u32 m0, s71, 17408
    s_nop 0
    buffer_load_dwordx4 v199, s[64:67], s69 offen lds
    s_add_u32 s68, s68, 64
    s_add_u32 s69, s69, s70
    s_add_u32 s71, s71, 32768
    s_and_b32 s71, s71, 0x1ffff
    s_mov_b32 m0, s71
    s_nop 0
    buffer_load_dwordx4 v196, s[60:63], s68 offen lds
    s_add_u32 m0, s71, 1024
    s_nop 0
    buffer_load_dwordx4 v197, s[60:63], s68 offen lds
    s_add_u32 m0, s71, 16384
    s_nop 0
    buffer_load_dwordx4 v198, s[64:67], s69 offen lds
    s_add_u32 m0, s71, 17408
    s_nop 0
    buffer_load_dwordx4 v199, s[64:67], s69 offen lds
    s_add_u32 s68, s68, 64
    s_add_u32 s69, s69, s70
    s_add_u32 s71, s71, 32768
    s_and_b32 s71, s71, 0x1ffff
    s_branch t256_42
q_53:
    s_lshr_b32 s79, s57, 2
    s_bfe_u32 s80, s76, 0x20000
    s_bfe_u32 s84, s76, 0x20005
    s_lshl_b32 s84, s84, 2
    s_or_b32 s80, s80, s84
    s_mov_b32 s83, 160
    s_mov_b64 s[60:61], s[36:37]
    s_mov_b32 s62, 0x400000
    s_mov_b32 s63, 0x20000
    s_mov_b64 s[64:65], s[20:21]
    s_mov_b32 s66, 0x800000
    s_mov_b32 s67, 0x20000
    v_lshrrev_b32 v204, 4, v1
    v_sub_u32 v204, 0, v204
    v_xor_b32 v204, v204, v1
    v_and_b32 v204, 3, v204
    s_mul_i32 s74, s58, 32
    v_lshrrev_b32 v205, 2, v1
    v_add3_u32 v205, v205, s74, 0
    v_lshlrev_b32 v196, 11, v205
    v_lshl_add_u32 v196, v204, 4, v196
    v_lshrrev_b32 v205, 2, v1
    v_add3_u32 v205, v205, s74, 16
    v_lshlrev_b32 v197, 11, v205
    v_lshl_add_u32 v197, v204, 4, v197
    s_and_b32 s74, s58, 2
    v_bfe_u32 v204, v1, 0, 5
    v_bfe_u32 v205, v1, 5, 1
    v_lshlrev_b32 v205, 2, v205
    v_xor_b32 v204, v204, v205
    v_xor_b32 v204, s74, v204
    v_bfe_u32 v205, v204, 0, 1
    v_lshlrev_b32 v205, 5, v205
    v_bfe_u32 v203, v204, 1, 1
    v_lshl_or_b32 v205, v203, 4, v205
    v_bfe_u32 v203, v204, 2, 3
    v_lshl_or_b32 v205, v203, 6, v205
    v_lshrrev_b32 v204, 5, v1
    v_lshl_add_u32 v198, v204, 13, v205
    v_bfe_u32 v204, v1, 0, 5
    v_bfe_u32 v205, v1, 5, 1
    v_lshlrev_b32 v205, 2, v205
    v_xor_b32 v204, v204, v205
    v_xor_b32 v204, s74, v204
    v_xor_b32 v204, 8, v204
    v_bfe_u32 v205, v204, 0, 1
    v_lshlrev_b32 v205, 5, v205
    v_bfe_u32 v203, v204, 1, 1
    v_lshl_or_b32 v205, v203, 4, v205
    v_bfe_u32 v203, v204, 2, 3
    v_lshl_or_b32 v205, v203, 6, v205
    v_lshrrev_b32 v204, 5, v1
    v_lshl_add_u32 v199, v204, 13, v205
    v_add_u32 v199, 16384, v199
    s_lshl_b32 s74, s58, 15
    v_add_u32 v198, s74, v198
    v_add_u32 v199, s74, v199
    s_mov_b32 s70, 262144
    s_mul_i32 s68, s79, 524288
    s_mul_i32 s69, s80, 512
    s_mov_b32 s82, 0x40000
    s_lshl_b32 s81, s79, 1
    s_lshr_b32 s84, s58, 2
    s_add_u32 s81, s81, s84
    s_mul_i32 s81, s81, s82
    s_mul_i32 s81, s81, 4
    s_lshl_b32 s74, s80, 2
    s_and_b32 s84, s58, 3
    s_add_u32 s84, s84, s74
    s_mul_i32 s84, s84, 4096
    s_add_u32 s81, s81, s84
    s_add_u32 s81, s81, 0x0
    s_mul_i32 s71, s58, 2048
    s_mov_b32 m0, s71
    s_nop 0
    buffer_load_dwordx4 v196, s[60:63], s68 offen lds
    s_add_u32 m0, s71, 1024
    s_nop 0
    buffer_load_dwordx4 v197, s[60:63], s68 offen lds
    s_add_u32 m0, s71, 16384
    s_nop 0
    buffer_load_dwordx4 v198, s[64:67], s69 offen lds
    s_add_u32 m0, s71, 17408
    s_nop 0
    buffer_load_dwordx4 v199, s[64:67], s69 offen lds
    s_add_u32 s68, s68, 64
    s_add_u32 s69, s69, s70
    s_add_u32 s71, s71, 32768
    s_and_b32 s71, s71, 0x1ffff
    s_mov_b32 m0, s71
    s_nop 0
    buffer_load_dwordx4 v196, s[60:63], s68 offen lds
    s_add_u32 m0, s71, 1024
    s_nop 0
    buffer_load_dwordx4 v197, s[60:63], s68 offen lds
    s_add_u32 m0, s71, 16384
    s_nop 0
    buffer_load_dwordx4 v198, s[64:67], s69 offen lds
    s_add_u32 m0, s71, 17408
    s_nop 0
    buffer_load_dwordx4 v199, s[64:67], s69 offen lds
    s_add_u32 s68, s68, 64
    s_add_u32 s69, s69, s70
    s_add_u32 s71, s71, 32768
    s_and_b32 s71, s71, 0x1ffff
    s_mov_b32 m0, s71
    s_nop 0
    buffer_load_dwordx4 v196, s[60:63], s68 offen lds
    s_add_u32 m0, s71, 1024
    s_nop 0
    buffer_load_dwordx4 v197, s[60:63], s68 offen lds
    s_add_u32 m0, s71, 16384
    s_nop 0
    buffer_load_dwordx4 v198, s[64:67], s69 offen lds
    s_add_u32 m0, s71, 17408
    s_nop 0
    buffer_load_dwordx4 v199, s[64:67], s69 offen lds
    s_add_u32 s68, s68, 64
    s_add_u32 s69, s69, s70
    s_add_u32 s71, s71, 32768
    s_and_b32 s71, s71, 0x1ffff
    s_mov_b32 m0, s71
    s_nop 0
    buffer_load_dwordx4 v196, s[60:63], s68 offen lds
    s_add_u32 m0, s71, 1024
    s_nop 0
    buffer_load_dwordx4 v197, s[60:63], s68 offen lds
    s_add_u32 m0, s71, 16384
    s_nop 0
    buffer_load_dwordx4 v198, s[64:67], s69 offen lds
    s_add_u32 m0, s71, 17408
    s_nop 0
    buffer_load_dwordx4 v199, s[64:67], s69 offen lds
    s_add_u32 s68, s68, 64
    s_add_u32 s69, s69, s70
    s_add_u32 s71, s71, 32768
    s_and_b32 s71, s71, 0x1ffff
    s_branch f256_41
p1_55:
    s_cmp_lg_u32 s58, 0
    s_cbranch_scc1 wall_58
    v_mov_b32 v204, 32
wctr_59:
    buffer_load_dword v203, v204, s[12:15], 0 offen sc1
    s_waitcnt vmcnt(0)
    v_cmp_gt_u32 vcc, 256, v203
    s_cbranch_vccz wctr_ok_60
    s_sub_u32 s77, s77, 1
    s_cbranch_scc0 wctr_59
    s_mov_b32 s77, 0
wctr_ok_60:
wall_58:
    s_barrier
    s_and_b32 s79, s57, 7
    s_mov_b32 s80, s75
    s_mov_b32 s83, 40
    s_mov_b64 s[60:61], s[44:45]
    s_mov_b32 s62, 0x400000
    s_mov_b32 s63, 0x20000
    s_mov_b64 s[64:65], s[8:9]
    s_mov_b32 s66, 0x10000000
    s_mov_b32 s67, 0x20000
    v_lshrrev_b32 v204, 4, v1
    v_sub_u32 v204, 0, v204
    v_xor_b32 v204, v204, v1
    v_and_b32 v204, 3, v204
    s_mul_i32 s74, s58, 32
    v_lshrrev_b32 v205, 2, v1
    v_add3_u32 v205, v205, s74, 0
    v_bfe_u32 v196, v205, 0, 3
    v_lshlrev_b32 v196, 17, v196
    v_bfe_u32 v203, v205, 3, 1
    v_lshl_or_b32 v196, v203, 21, v196
    v_bfe_u32 v203, v205, 4, 1
    v_lshl_or_b32 v196, v203, 20, v196
    v_bfe_u32 v203, v205, 5, 3
    v_lshl_or_b32 v196, v203, 11, v196
    v_lshl_add_u32 v196, v204, 4, v196
    v_lshrrev_b32 v205, 2, v1
    v_add3_u32 v205, v205, s74, 16
    v_bfe_u32 v197, v205, 0, 3
    v_lshlrev_b32 v197, 17, v197
    v_bfe_u32 v203, v205, 3, 1
    v_lshl_or_b32 v197, v203, 21, v197
    v_bfe_u32 v203, v205, 4, 1
    v_lshl_or_b32 v197, v203, 20, v197
    v_bfe_u32 v203, v205, 5, 3
    v_lshl_or_b32 v197, v203, 11, v197
    v_lshl_add_u32 v197, v204, 4, v197
    s_and_b32 s74, s58, 2
    v_bfe_u32 v204, v1, 0, 5
    v_bfe_u32 v205, v1, 5, 1
    v_lshlrev_b32 v205, 2, v205
    v_xor_b32 v204, v204, v205
    v_xor_b32 v204, s74, v204
    v_lshlrev_b32 v205, 4, v204
    v_lshrrev_b32 v204, 5, v1
    v_lshl_add_u32 v198, v204, 11, v205
    v_bfe_u32 v204, v1, 0, 5
    v_bfe_u32 v205, v1, 5, 1
    v_lshlrev_b32 v205, 2, v205
    v_xor_b32 v204, v204, v205
    v_xor_b32 v204, s74, v204
    v_xor_b32 v204, 8, v204
    v_lshlrev_b32 v205, 4, v204
    v_lshrrev_b32 v204, 5, v1
    v_lshl_add_u32 v199, v204, 11, v205
    v_add_u32 v199, 4096, v199
    s_lshl_b32 s74, s58, 13
    v_add_u32 v198, s74, v198
    v_add_u32 v199, s74, v199
    s_mov_b32 s70, 65536
    s_lshl_b32 s68, s79, 14
    s_lshl_b32 s69, s80, 9
    s_add_u32 s69, s69, 0x5200000
    s_mov_b32 s82, 0x10000
    s_lshl_b32 s81, s79, 1
    s_lshr_b32 s84, s58, 2
    s_add_u32 s81, s81, s84
    s_mul_i32 s81, s81, s82
    s_mul_i32 s81, s81, 4
    s_lshl_b32 s74, s80, 2
    s_and_b32 s84, s58, 3
    s_add_u32 s84, s84, s74
    s_mul_i32 s84, s84, 4096
    s_add_u32 s81, s81, s84
    s_add_u32 s81, s81, 0x5400000
    s_mul_i32 s71, s58, 2048
    s_mov_b32 m0, s71
    s_nop 0
    buffer_load_dwordx4 v196, s[60:63], s68 offen lds
    s_add_u32 m0, s71, 1024
    s_nop 0
    buffer_load_dwordx4 v197, s[60:63], s68 offen lds
    s_add_u32 m0, s71, 16384
    s_nop 0
    buffer_load_dwordx4 v198, s[64:67], s69 offen lds
    s_add_u32 m0, s71, 17408
    s_nop 0
    buffer_load_dwordx4 v199, s[64:67], s69 offen lds
    s_add_u32 s68, s68, 64
    s_add_u32 s69, s69, s70
    s_add_u32 s71, s71, 32768
    s_and_b32 s71, s71, 0x1ffff
    s_mov_b32 m0, s71
    s_nop 0
    buffer_load_dwordx4 v196, s[60:63], s68 offen lds
    s_add_u32 m0, s71, 1024
    s_nop 0
    buffer_load_dwordx4 v197, s[60:63], s68 offen lds
    s_add_u32 m0, s71, 16384
    s_nop 0
    buffer_load_dwordx4 v198, s[64:67], s69 offen lds
    s_add_u32 m0, s71, 17408
    s_nop 0
    buffer_load_dwordx4 v199, s[64:67], s69 offen lds
    s_add_u32 s68, s68, 64
    s_add_u32 s69, s69, s70
    s_add_u32 s71, s71, 32768
    s_and_b32 s71, s71, 0x1ffff
    s_mov_b32 m0, s71
    s_nop 0
    buffer_load_dwordx4 v196, s[60:63], s68 offen lds
    s_add_u32 m0, s71, 1024
    s_nop 0
    buffer_load_dwordx4 v197, s[60:63], s68 offen lds
    s_add_u32 m0, s71, 16384
    s_nop 0
    buffer_load_dwordx4 v198, s[64:67], s69 offen lds
    s_add_u32 m0, s71, 17408
    s_nop 0
    buffer_load_dwordx4 v199, s[64:67], s69 offen lds
    s_add_u32 s68, s68, 64
    s_add_u32 s69, s69, s70
    s_add_u32 s71, s71, 32768
    s_and_b32 s71, s71, 0x1ffff
    s_mov_b32 m0, s71
    s_nop 0
    buffer_load_dwordx4 v196, s[60:63], s68 offen lds
    s_add_u32 m0, s71, 1024
    s_nop 0
    buffer_load_dwordx4 v197, s[60:63], s68 offen lds
    s_add_u32 m0, s71, 16384
    s_nop 0
    buffer_load_dwordx4 v198, s[64:67], s69 offen lds
    s_add_u32 m0, s71, 17408
    s_nop 0
    buffer_load_dwordx4 v199, s[64:67], s69 offen lds
    s_add_u32 s68, s68, 64
    s_add_u32 s69, s69, s70
    s_add_u32 s71, s71, 32768
    s_and_b32 s71, s71, 0x1ffff
    s_branch t256_42
col_54:
    s_lshl_b32 s2, s76, 2
    s_add_u32 s2, s2, s58
    s_lshl_b32 s3, s2, 1
    s_cmp_lt_u32 s58, 4
    s_cbranch_scc1 colgo_62
    s_cmp_lg_u32 s2, 4
    s_cbranch_scc1 colskip_61
    s_mov_b32 s2, 512
    s_mov_b32 s3, 1
colgo_62:
    s_cmp_lt_u32 s3, 2
    s_cselect_b32 s6, 0x5ffffff0, 0
    s_mov_b32 s4, 0x35800000
    s_cselect_b32 s4, 0x35000000, s4
    v_bfe_u32 v231, v1, 0, 5
    v_bfe_u32 v234, v1, 5, 1
    v_lshl_or_b32 v231, v234, 7, v231
    v_mul_u32_u24 v231, 1026, v231
    s_lshl_b32 s5, s2, 1
    v_add_u32 v231, s5, v231
    s_mov_b32 s5, 0
    buffer_load_ushort v132, v231, s[48:51], s5 offen
    buffer_load_ushort v164, v231, s[52:55], s5 offen
    s_mov_b32 s5, 32832
    buffer_load_ushort v133, v231, s[48:51], s5 offen
    buffer_load_ushort v165, v231, s[52:55], s5 offen
    s_mov_b32 s5, 65664
    buffer_load_ushort v134, v231, s[48:51], s5 offen
    buffer_load_ushort v166, v231, s[52:55], s5 offen
    s_mov_b32 s5, 98496
    buffer_load_ushort v135, v231, s[48:51], s5 offen
    buffer_load_ushort v167, v231, s[52:55], s5 offen
    s_mov_b32 s5, 262656
    buffer_load_ushort v136, v231, s[48:51], s5 offen
    buffer_load_ushort v168, v231, s[52:55], s5 offen
    s_mov_b32 s5, 295488
    buffer_load_ushort v137, v231, s[48:51], s5 offen
    buffer_load_ushort v169, v231, s[52:55], s5 offen
    s_mov_b32 s5, 328320
    buffer_load_ushort v138, v231, s[48:51], s5 offen
    buffer_load_ushort v170, v231, s[52:55], s5 offen
    s_mov_b32 s5, 361152
    buffer_load_ushort v139, v231, s[48:51], s5 offen
    buffer_load_ushort v171, v231, s[52:55], s5 offen
    s_mov_b32 s5, 525312
    buffer_load_ushort v140, v231, s[48:51], s5 offen
    buffer_load_ushort v172, v231, s[52:55], s5 offen
    s_mov_b32 s5, 558144
    buffer_load_ushort v141, v231, s[48:51], s5 offen
    buffer_load_ushort v173, v231, s[52:55], s5 offen
    s_mov_b32 s5, 590976
    buffer_load_ushort v142, v231, s[48:51], s5 offen
    buffer_load_ushort v174, v231, s[52:55], s5 offen
    s_mov_b32 s5, 623808
    buffer_load_ushort v143, v231, s[48:51], s5 offen
    buffer_load_ushort v175, v231, s[52:55], s5 offen
    s_mov_b32 s5, 787968
    buffer_load_ushort v144, v231, s[48:51], s5 offen
    buffer_load_ushort v176, v231, s[52:55], s5 offen
    s_mov_b32 s5, 820800
    buffer_load_ushort v145, v231, s[48:51], s5 offen
    buffer_load_ushort v177, v231, s[52:55], s5 offen
    s_mov_b32 s5, 853632
    buffer_load_ushort v146, v231, s[48:51], s5 offen
    buffer_load_ushort v178, v231, s[52:55], s5 offen
    s_mov_b32 s5, 886464
    buffer_load_ushort v147, v231, s[48:51], s5 offen
    buffer_load_ushort v179, v231, s[52:55], s5 offen
    v_and_b32 v234, 31, v1
    v_cvt_f32_u32 v228, v234
    v_and_b32 v234, 32, v1
    v_cvt_f32_u32 v234, v234
    v_mul_f32 v229, v228, v234
    v_mul_f32 v229, 0x3b000000, v229
    v_and_b32 v233, 1, v1
    v_mul_u32_u24 v233, 0x8000, v233
    v_lshl_or_b32 v233, v233, 16, v233
    v_fmamk_f32 v242, v228, 0x0, v229
    v_add_f32 v243, v242, v242
    v_cos_f32 v234, v242
    v_sin_f32 v236, v242
    v_cos_f32 v238, v243
    v_sin_f32 v240, v243
    v_fmamk_f32 v242, v228, 0x3c800000, v229
    v_add_f32 v243, v242, v242
    v_cos_f32 v235, v242
    v_sin_f32 v237, v242
    v_cos_f32 v239, v243
    v_sin_f32 v241, v243
    v_cvt_pk_bf16_f32 v4, v234, v235
    v_cvt_pk_bf16_f32 v36, v236, v237
    v_cvt_pk_bf16_f32 v68, v238, v239
    v_cvt_pk_bf16_f32 v76, v240, v241
    v_fmamk_f32 v242, v228, 0x3d000000, v229
    v_add_f32 v243, v242, v242
    v_cos_f32 v234, v242
    v_sin_f32 v236, v242
    v_cos_f32 v238, v243
    v_sin_f32 v240, v243
    v_fmamk_f32 v242, v228, 0x3d400000, v229
    v_add_f32 v243, v242, v242
    v_cos_f32 v235, v242
    v_sin_f32 v237, v242
    v_cos_f32 v239, v243
    v_sin_f32 v241, v243
    v_cvt_pk_bf16_f32 v5, v234, v235
    v_cvt_pk_bf16_f32 v37, v236, v237
    v_cvt_pk_bf16_f32 v69, v238, v239
    v_cvt_pk_bf16_f32 v77, v240, v241
    v_fmamk_f32 v242, v228, 0x3e000000, v229
    v_add_f32 v243, v242, v242
    v_cos_f32 v234, v242
    v_sin_f32 v236, v242
    v_cos_f32 v238, v243
    v_sin_f32 v240, v243
    v_fmamk_f32 v242, v228, 0x3e100000, v229
    v_add_f32 v243, v242, v242
    v_cos_f32 v235, v242
    v_sin_f32 v237, v242
    v_cos_f32 v239, v243
    v_sin_f32 v241, v243
    v_cvt_pk_bf16_f32 v6, v234, v235
    v_cvt_pk_bf16_f32 v38, v236, v237
    v_cvt_pk_bf16_f32 v70, v238, v239
    v_cvt_pk_bf16_f32 v78, v240, v241
    v_fmamk_f32 v242, v228, 0x3e200000, v229
    v_add_f32 v243, v242, v242
    v_cos_f32 v234, v242
    v_sin_f32 v236, v242
    v_cos_f32 v238, v243
    v_sin_f32 v240, v243
    v_fmamk_f32 v242, v228, 0x3e300000, v229
    v_add_f32 v243, v242, v242
    v_cos_f32 v235, v242
    v_sin_f32 v237, v242
    v_cos_f32 v239, v243
    v_sin_f32 v241, v243
    v_cvt_pk_bf16_f32 v7, v234, v235
    v_cvt_pk_bf16_f32 v39, v236, v237
    v_cvt_pk_bf16_f32 v71, v238, v239
    v_cvt_pk_bf16_f32 v79, v240, v241
    v_fmamk_f32 v242, v228, 0x3e800000, v229
    v_add_f32 v243, v242, v242
    v_cos_f32 v234, v242
    v_sin_f32 v236, v242
    v_cos_f32 v238, v243
    v_sin_f32 v240, v243
    v_fmamk_f32 v242, v228, 0x3e880000, v229
    v_add_f32 v243, v242, v242
    v_cos_f32 v235, v242
    v_sin_f32 v237, v242
    v_cos_f32 v239, v243
    v_sin_f32 v241, v243
    v_cvt_pk_bf16_f32 v8, v234, v235
    v_cvt_pk_bf16_f32 v40, v236, v237
    v_cvt_pk_bf16_f32 v72, v238, v239
    v_cvt_pk_bf16_f32 v80, v240, v241
    v_fmamk_f32 v242, v228, 0x3e900000, v229
    v_add_f32 v243, v242, v242
    v_cos_f32 v234, v242
    v_sin_f32 v236, v242
    v_cos_f32 v238, v243
    v_sin_f32 v240, v243
    v_fmamk_f32 v242, v228, 0x3e980000, v229
    v_add_f32 v243, v242, v242
    v_cos_f32 v235, v242
    v_sin_f32 v237, v242
    v_cos_f32 v239, v243
    v_sin_f32 v241, v243
    v_cvt_pk_bf16_f32 v9, v234, v235
    v_cvt_pk_bf16_f32 v41, v236, v237
    v_cvt_pk_bf16_f32 v73, v238, v239
    v_cvt_pk_bf16_f32 v81, v240, v241
    v_fmamk_f32 v242, v228, 0x3ec00000, v229
    v_add_f32 v243, v242, v242
    v_cos_f32 v234, v242
    v_sin_f32 v236, v242
    v_cos_f32 v238, v243
    v_sin_f32 v240, v243
    v_fmamk_f32 v242, v228, 0x3ec80000, v229
    v_add_f32 v243, v242, v242
    v_cos_f32 v235, v242
    v_sin_f32 v237, v242
    v_cos_f32 v239, v243
    v_sin_f32 v241, v243
    v_cvt_pk_bf16_f32 v10, v234, v235
    v_cvt_pk_bf16_f32 v42, v236, v237
    v_cvt_pk_bf16_f32 v74, v238, v239
    v_cvt_pk_bf16_f32 v82, v240, v241
    v_fmamk_f32 v242, v228, 0x3ed00000, v229
    v_add_f32 v243, v242, v242
    v_cos_f32 v234, v242
    v_sin_f32 v236, v242
    v_cos_f32 v238, v243
    v_sin_f32 v240, v243
    v_fmamk_f32 v242, v228, 0x3ed80000, v229
    v_add_f32 v243, v242, v242
    v_cos_f32 v235, v242
    v_sin_f32 v237, v242
    v_cos_f32 v239, v243
    v_sin_f32 v241, v243
    v_cvt_pk_bf16_f32 v11, v234, v235
    v_cvt_pk_bf16_f32 v43, v236, v237
    v_cvt_pk_bf16_f32 v75, v238, v239
    v_cvt_pk_bf16_f32 v83, v240, v241
    v_xor_b32 v12, v233, v4
    v_xor_b32 v13, v233, v5
    v_xor_b32 v14, v233, v6
    v_xor_b32 v15, v233, v7
    v_xor_b32 v16, v233, v8
    v_xor_b32 v17, v233, v9
    v_xor_b32 v18, v233, v10
    v_xor_b32 v19, v233, v11
    v_xor_b32 v20, 0x80000000, v4
    v_xor_b32 v21, 0x80000000, v5
    v_xor_b32 v22, 0x80000000, v6
    v_xor_b32 v23, 0x80000000, v7
    v_xor_b32 v24, 0x80000000, v8
    v_xor_b32 v25, 0x80000000, v9
    v_xor_b32 v26, 0x80000000, v10
    v_xor_b32 v27, 0x80000000, v11
    v_xor_b32 v28, 0x80000000, v12
    v_xor_b32 v29, 0x80000000, v13
    v_xor_b32 v30, 0x80000000, v14
    v_xor_b32 v31, 0x80000000, v15
    v_xor_b32 v32, 0x80000000, v16
    v_xor_b32 v33, 0x80000000, v17
    v_xor_b32 v34, 0x80000000, v18
    v_xor_b32 v35, 0x80000000, v19
    v_xor_b32 v44, v233, v36
    v_xor_b32 v45, v233, v37
    v_xor_b32 v46, v233, v38
    v_xor_b32 v47, v233, v39
    v_xor_b32 v48, v233, v40
    v_xor_b32 v49, v233, v41
    v_xor_b32 v50, v233, v42
    v_xor_b32 v51, v233, v43
    v_xor_b32 v52, 0x80000000, v36
    v_xor_b32 v53, 0x80000000, v37
    v_xor_b32 v54, 0x80000000, v38
    v_xor_b32 v55, 0x80000000, v39
    v_xor_b32 v56, 0x80000000, v40
    v_xor_b32 v57, 0x80000000, v41
    v_xor_b32 v58, 0x80000000, v42
    v_xor_b32 v59, 0x80000000, v43
    v_xor_b32 v60, 0x80000000, v44
    v_xor_b32 v61, 0x80000000, v45
    v_xor_b32 v62, 0x80000000, v46
    v_xor_b32 v63, 0x80000000, v47
    v_xor_b32 v64, 0x80000000, v48
    v_xor_b32 v65, 0x80000000, v49
    v_xor_b32 v66, 0x80000000, v50
    v_xor_b32 v67, 0x80000000, v51
    s_waitcnt vmcnt(0)
    s_mov_b32 s5, 1050624
    buffer_load_ushort v148, v231, s[48:51], s5 offen
    buffer_load_ushort v180, v231, s[52:55], s5 offen
    s_mov_b32 s5, 1083456
    buffer_load_ushort v149, v231, s[48:51], s5 offen
    buffer_load_ushort v181, v231, s[52:55], s5 offen
    s_mov_b32 s5, 1116288
    buffer_load_ushort v150, v231, s[48:51], s5 offen
    buffer_load_ushort v182, v231, s[52:55], s5 offen
    s_mov_b32 s5, 1149120
    buffer_load_ushort v151, v231, s[48:51], s5 offen
    buffer_load_ushort v183, v231, s[52:55], s5 offen
    s_mov_b32 s5, 1313280
    buffer_load_ushort v152, v231, s[48:51], s5 offen
    buffer_load_ushort v184, v231, s[52:55], s5 offen
    s_mov_b32 s5, 1346112
    buffer_load_ushort v153, v231, s[48:51], s5 offen
    buffer_load_ushort v185, v231, s[52:55], s5 offen
    s_mov_b32 s5, 1378944
    buffer_load_ushort v154, v231, s[48:51], s5 offen
    buffer_load_ushort v186, v231, s[52:55], s5 offen
    s_mov_b32 s5, 1411776
    buffer_load_ushort v155, v231, s[48:51], s5 offen
    buffer_load_ushort v187, v231, s[52:55], s5 offen
    s_mov_b32 s5, 1575936
    buffer_load_ushort v156, v231, s[48:51], s5 offen
    buffer_load_ushort v188, v231, s[52:55], s5 offen
    s_mov_b32 s5, 1608768
    buffer_load_ushort v157, v231, s[48:51], s5 offen
    buffer_load_ushort v189, v231, s[52:55], s5 offen
    s_mov_b32 s5, 1641600
    buffer_load_ushort v158, v231, s[48:51], s5 offen
    buffer_load_ushort v190, v231, s[52:55], s5 offen
    s_mov_b32 s5, 1674432
    buffer_load_ushort v159, v231, s[48:51], s5 offen
    buffer_load_ushort v191, v231, s[52:55], s5 offen
    s_mov_b32 s5, 1838592
    buffer_load_ushort v160, v231, s[48:51], s5 offen
    buffer_load_ushort v192, v231, s[52:55], s5 offen
    s_mov_b32 s5, 1871424
    buffer_load_ushort v161, v231, s[48:51], s5 offen
    buffer_load_ushort v193, v231, s[52:55], s5 offen
    s_mov_b32 s5, 1904256
    buffer_load_ushort v162, v231, s[48:51], s5 offen
    buffer_load_ushort v194, v231, s[52:55], s5 offen
    s_mov_b32 s5, 1937088
    buffer_load_ushort v163, v231, s[48:51], s5 offen
    buffer_load_ushort v195, v231, s[52:55], s5 offen
    s_waitcnt vmcnt(0)
    v_lshl_or_b32 v196, v164, 16, v132
    v_lshl_or_b32 v197, v165, 16, v133
    v_lshl_or_b32 v198, v166, 16, v134
    v_lshl_or_b32 v199, v167, 16, v135
    v_lshl_or_b32 v200, v168, 16, v136
    v_lshl_or_b32 v201, v169, 16, v137
    v_lshl_or_b32 v202, v170, 16, v138
    v_lshl_or_b32 v203, v171, 16, v139
    v_lshl_or_b32 v204, v172, 16, v140
    v_lshl_or_b32 v205, v173, 16, v141
    v_lshl_or_b32 v206, v174, 16, v142
    v_lshl_or_b32 v207, v175, 16, v143
    v_lshl_or_b32 v208, v176, 16, v144
    v_lshl_or_b32 v209, v177, 16, v145
    v_lshl_or_b32 v210, v178, 16, v146
    v_lshl_or_b32 v211, v179, 16, v147
    v_lshl_or_b32 v212, v180, 16, v148
    v_lshl_or_b32 v213, v181, 16, v149
    v_lshl_or_b32 v214, v182, 16, v150
    v_lshl_or_b32 v215, v183, 16, v151
    v_lshl_or_b32 v216, v184, 16, v152
    v_lshl_or_b32 v217, v185, 16, v153
    v_lshl_or_b32 v218, v186, 16, v154
    v_lshl_or_b32 v219, v187, 16, v155
    v_lshl_or_b32 v220, v188, 16, v156
    v_lshl_or_b32 v221, v189, 16, v157
    v_lshl_or_b32 v222, v190, 16, v158
    v_lshl_or_b32 v223, v191, 16, v159
    v_lshl_or_b32 v224, v192, 16, v160
    v_lshl_or_b32 v225, v193, 16, v161
    v_lshl_or_b32 v226, v194, 16, v162
    v_lshl_or_b32 v227, v195, 16, v163
colskip_61:
    s_cmp_lg_u32 s58, 0
    s_cbranch_scc1 wall_64
    v_mov_b32 v235, 40
wctr_65:
    buffer_load_dword v234, v235, s[12:15], 0 offen sc1
    s_waitcnt vmcnt(0)
    v_cmp_gt_u32 vcc, 32, v234
    s_cbranch_vccz wctr_ok_66
    s_sub_u32 s77, s77, 1
    s_cbranch_scc0 wctr_65
    s_mov_b32 s77, 0
wctr_ok_66:
wall_64:
    s_barrier
    s_cmp_lt_u32 s58, 4
    s_cbranch_scc1 colw_63
    s_cmp_lg_u32 s3, 1
    s_cbranch_scc1 colend_67
colw_63:
    v_bfe_u32 v231, v1, 0, 5
    v_lshlrev_b32 v231, 16, v231
    v_bfe_u32 v234, v1, 5, 1
    v_lshl_or_b32 v231, v234, 9, v231
    v_add_u32 v232, s6, v231
    s_bfe_u32 s5, s3, 0x50000
    s_lshl_b32 s5, s5, 4
    s_bfe_u32 s2, s3, 0x50005
    s_lshl_b32 s2, s2, 11
    s_or_b32 s5, s5, s2
    s_add_u32 s5, s5, 0x5400000
    buffer_load_dwordx4 v[84:87], v231, s[8:11], s5 offen offset:0
    buffer_load_dwordx4 v[100:103], v232, s[8:11], s5 offen offset:16
    buffer_load_dwordx4 v[88:91], v231, s[8:11], s5 offen offset:1024
    buffer_load_dwordx4 v[104:107], v232, s[8:11], s5 offen offset:1040
    s_add_u32 s5, s5, 2097152
    buffer_load_dwordx4 v[92:95], v231, s[8:11], s5 offen offset:0
    buffer_load_dwordx4 v[108:111], v232, s[8:11], s5 offen offset:16
    buffer_load_dwordx4 v[96:99], v231, s[8:11], s5 offen offset:1024
    buffer_load_dwordx4 v[112:115], v232, s[8:11], s5 offen offset:1040
    s_add_u32 s5, s5, 2097152
    v_mul_f32 v229, 0x3d000000, v229
    s_waitcnt vmcnt(0)
    v_xor_b32 v116, 0x80008000, v84
    v_xor_b32 v117, 0x80008000, v85
    v_xor_b32 v118, 0x80008000, v86
    v_xor_b32 v119, 0x80008000, v87
    v_xor_b32 v120, 0x80008000, v88
    v_xor_b32 v121, 0x80008000, v89
    v_xor_b32 v122, 0x80008000, v90
    v_xor_b32 v123, 0x80008000, v91
    v_xor_b32 v124, 0x80008000, v92
    v_xor_b32 v125, 0x80008000, v93
    v_xor_b32 v126, 0x80008000, v94
    v_xor_b32 v127, 0x80008000, v95
    v_xor_b32 v128, 0x80008000, v96
    v_xor_b32 v129, 0x80008000, v97
    v_xor_b32 v130, 0x80008000, v98
    v_xor_b32 v131, 0x80008000, v99
    v_mfma_f32_32x32x16_bf16 v[132:147], v[84:87], v[68:71], 0
    v_mfma_f32_32x32x16_bf16 v[164:179], v[100:103], v[68:71], 0
    v_mfma_f32_32x32x16_bf16 v[132:147], v[100:103], v[76:79], v[132:147]
    v_mfma_f32_32x32x16_bf16 v[164:179], v[116:119], v[76:79], v[164:179]
    v_mfma_f32_32x32x16_bf16 v[132:147], v[88:91], v[72:75], v[132:147]
    v_mfma_f32_32x32x16_bf16 v[164:179], v[104:107], v[72:75], v[164:179]
    v_mfma_f32_32x32x16_bf16 v[132:147], v[104:107], v[80:83], v[132:147]
    v_mfma_f32_32x32x16_bf16 v[164:179], v[120:123], v[80:83], v[164:179]
    v_mfma_f32_32x32x16_bf16 v[148:163], v[92:95], v[68:71], 0
    v_mfma_f32_32x32x16_bf16 v[180:195], v[108:111], v[68:71], 0
    v_mfma_f32_32x32x16_bf16 v[148:163], v[108:111], v[76:79], v[148:163]
    v_mfma_f32_32x32x16_bf16 v[180:195], v[124:127], v[76:79], v[180:195]
    v_mfma_f32_32x32x16_bf16 v[148:163], v[96:99], v[72:75], v[148:163]
    v_mfma_f32_32x32x16_bf16 v[180:195], v[112:115], v[72:75], v[180:195]
    v_mfma_f32_32x32x16_bf16 v[148:163], v[112:115], v[80:83], v[148:163]
    v_mfma_f32_32x32x16_bf16 v[180:195], v[128:131], v[80:83], v[180:195]
    v_and_b32 v234, 32, v1
    v_cvt_f32_u32 v234, v234
    v_fmamk_f32 v230, v234, 0x3b000000, v229
    v_fmamk_f32 v242, v228, 0x0, v229
    v_cos_f32 v238, v242
    v_sin_f32 v239, v242
    v_mul_f32 v238, s4, v238
    v_mul_f32 v239, s4, v239
    v_mul_f32 v234, v132, v238
    v_mul_f32 v236, v164, v238
    v_fma_f32 v234, v164, v239, v234
    v_fma_f32 v236, -v132, v239, v236
    v_fmamk_f32 v242, v228, 0x3a000000, v229
    v_cos_f32 v240, v242
    v_sin_f32 v241, v242
    v_mul_f32 v240, s4, v240
    v_mul_f32 v241, s4, v241
    v_mul_f32 v235, v133, v240
    v_mul_f32 v237, v165, v240
    v_fma_f32 v235, v165, v241, v235
    v_fma_f32 v237, -v133, v241, v237
    v_cvt_pk_bf16_f32 v84, v234, v235
    v_cvt_pk_bf16_f32 v100, v236, v237
    v_cvt_pk_bf16_f32 v116, -v234, -v235
    v_fmamk_f32 v242, v228, 0x3a800000, v229
    v_cos_f32 v238, v242
    v_sin_f32 v239, v242
    v_mul_f32 v238, s4, v238
    v_mul_f32 v239, s4, v239
    v_mul_f32 v234, v134, v238
    v_mul_f32 v236, v166, v238
    v_fma_f32 v234, v166, v239, v234
    v_fma_f32 v236, -v134, v239, v236
    v_fmamk_f32 v242, v228, 0x3ac00000, v229
    v_cos_f32 v240, v242
    v_sin_f32 v241, v242
    v_mul_f32 v240, s4, v240
    v_mul_f32 v241, s4, v241
    v_mul_f32 v235, v135, v240
    v_mul_f32 v237, v167, v240
    v_fma_f32 v235, v167, v241, v235
    v_fma_f32 v237, -v135, v241, v237
    v_cvt_pk_bf16_f32 v85, v234, v235
    v_cvt_pk_bf16_f32 v101, v236, v237
    v_cvt_pk_bf16_f32 v117, -v234, -v235
    v_fmamk_f32 v242, v228, 0x3b800000, v229
    v_cos_f32 v238, v242
    v_sin_f32 v239, v242
    v_mul_f32 v238, s4, v238
    v_mul_f32 v239, s4, v239
    v_mul_f32 v234, v136, v238
    v_mul_f32 v236, v168, v238
    v_fma_f32 v234, v168, v239, v234
    v_fma_f32 v236, -v136, v239, v236
    v_fmamk_f32 v242, v228, 0x3b900000, v229
    v_cos_f32 v240, v242
    v_sin_f32 v241, v242
    v_mul_f32 v240, s4, v240
    v_mul_f32 v241, s4, v241
    v_mul_f32 v235, v137, v240
    v_mul_f32 v237, v169, v240
    v_fma_f32 v235, v169, v241, v235
    v_fma_f32 v237, -v137, v241, v237
    v_cvt_pk_bf16_f32 v86, v234, v235
    v_cvt_pk_bf16_f32 v102, v236, v237
    v_cvt_pk_bf16_f32 v118, -v234, -v235
    v_fmamk_f32 v242, v228, 0x3ba00000, v229
    v_cos_f32 v238, v242
    v_sin_f32 v239, v242
    v_mul_f32 v238, s4, v238
    v_mul_f32 v239, s4, v239
    v_mul_f32 v234, v138, v238
    v_mul_f32 v236, v170, v238
    v_fma_f32 v234, v170, v239, v234
    v_fma_f32 v236, -v138, v239, v236
    v_fmamk_f32 v242, v228, 0x3bb00000, v229
    v_cos_f32 v240, v242
    v_sin_f32 v241, v242
    v_mul_f32 v240, s4, v240
    v_mul_f32 v241, s4, v241
    v_mul_f32 v235, v139, v240
    v_mul_f32 v237, v171, v240
    v_fma_f32 v235, v171, v241, v235
    v_fma_f32 v237, -v139, v241, v237
    v_cvt_pk_bf16_f32 v87, v234, v235
    v_cvt_pk_bf16_f32 v103, v236, v237
    v_cvt_pk_bf16_f32 v119, -v234, -v235
    v_fmamk_f32 v242, v228, 0x3c000000, v229
    v_cos_f32 v238, v242
    v_sin_f32 v239, v242
    v_mul_f32 v238, s4, v238
    v_mul_f32 v239, s4, v239
    v_mul_f32 v234, v140, v238
    v_mul_f32 v236, v172, v238
    v_fma_f32 v234, v172, v239, v234
    v_fma_f32 v236, -v140, v239, v236
    v_fmamk_f32 v242, v228, 0x3c080000, v229
    v_cos_f32 v240, v242
    v_sin_f32 v241, v242
    v_mul_f32 v240, s4, v240
    v_mul_f32 v241, s4, v241
    v_mul_f32 v235, v141, v240
    v_mul_f32 v237, v173, v240
    v_fma_f32 v235, v173, v241, v235
    v_fma_f32 v237, -v141, v241, v237
    v_cvt_pk_bf16_f32 v88, v234, v235
    v_cvt_pk_bf16_f32 v104, v236, v237
    v_cvt_pk_bf16_f32 v120, -v234, -v235
    v_fmamk_f32 v242, v228, 0x3c100000, v229
    v_cos_f32 v238, v242
    v_sin_f32 v239, v242
    v_mul_f32 v238, s4, v238
    v_mul_f32 v239, s4, v239
    v_mul_f32 v234, v142, v238
    v_mul_f32 v236, v174, v238
    v_fma_f32 v234, v174, v239, v234
    v_fma_f32 v236, -v142, v239, v236
    v_fmamk_f32 v242, v228, 0x3c180000, v229
    v_cos_f32 v240, v242
    v_sin_f32 v241, v242
    v_mul_f32 v240, s4, v240
    v_mul_f32 v241, s4, v241
    v_mul_f32 v235, v143, v240
    v_mul_f32 v237, v175, v240
    v_fma_f32 v235, v175, v241, v235
    v_fma_f32 v237, -v143, v241, v237
    v_cvt_pk_bf16_f32 v89, v234, v235
    v_cvt_pk_bf16_f32 v105, v236, v237
    v_cvt_pk_bf16_f32 v121, -v234, -v235
    v_fmamk_f32 v242, v228, 0x3c400000, v229
    v_cos_f32 v238, v242
    v_sin_f32 v239, v242
    v_mul_f32 v238, s4, v238
    v_mul_f32 v239, s4, v239
    v_mul_f32 v234, v144, v238
    v_mul_f32 v236, v176, v238
    v_fma_f32 v234, v176, v239, v234
    v_fma_f32 v236, -v144, v239, v236
    v_fmamk_f32 v242, v228, 0x3c480000, v229
    v_cos_f32 v240, v242
    v_sin_f32 v241, v242
    v_mul_f32 v240, s4, v240
    v_mul_f32 v241, s4, v241
    v_mul_f32 v235, v145, v240
    v_mul_f32 v237, v177, v240
    v_fma_f32 v235, v177, v241, v235
    v_fma_f32 v237, -v145, v241, v237
    v_cvt_pk_bf16_f32 v90, v234, v235
    v_cvt_pk_bf16_f32 v106, v236, v237
    v_cvt_pk_bf16_f32 v122, -v234, -v235
    v_fmamk_f32 v242, v228, 0x3c500000, v229
    v_cos_f32 v238, v242
    v_sin_f32 v239, v242
    v_mul_f32 v238, s4, v238
    v_mul_f32 v239, s4, v239
    v_mul_f32 v234, v146, v238
    v_mul_f32 v236, v178, v238
    v_fma_f32 v234, v178, v239, v234
    v_fma_f32 v236, -v146, v239, v236
    v_fmamk_f32 v242, v228, 0x3c580000, v229
    v_cos_f32 v240, v242
    v_sin_f32 v241, v242
    v_mul_f32 v240, s4, v240
    v_mul_f32 v241, s4, v241
    v_mul_f32 v235, v147, v240
    v_mul_f32 v237, v179, v240
    v_fma_f32 v235, v179, v241, v235
    v_fma_f32 v237, -v147, v241, v237
    v_cvt_pk_bf16_f32 v91, v234, v235
    v_cvt_pk_bf16_f32 v107, v236, v237
    v_cvt_pk_bf16_f32 v123, -v234, -v235
    v_fmamk_f32 v242, v228, 0x3c800000, v229
    v_cos_f32 v238, v242
    v_sin_f32 v239, v242
    v_mul_f32 v238, s4, v238
    v_mul_f32 v239, s4, v239
    v_mul_f32 v234, v148, v238
    v_mul_f32 v236, v180, v238
    v_fma_f32 v234, v180, v239, v234
    v_fma_f32 v236, -v148, v239, v236
    v_fmamk_f32 v242, v228, 0x3c840000, v229
    v_cos_f32 v240, v242
    v_sin_f32 v241, v242
    v_mul_f32 v240, s4, v240
    v_mul_f32 v241, s4, v241
    v_mul_f32 v235, v149, v240
    v_mul_f32 v237, v181, v240
    v_fma_f32 v235, v181, v241, v235
    v_fma_f32 v237, -v149, v241, v237
    v_cvt_pk_bf16_f32 v92, v234, v235
    v_cvt_pk_bf16_f32 v108, v236, v237
    v_cvt_pk_bf16_f32 v124, -v234, -v235
    v_fmamk_f32 v242, v228, 0x3c880000, v229
    v_cos_f32 v238, v242
    v_sin_f32 v239, v242
    v_mul_f32 v238, s4, v238
    v_mul_f32 v239, s4, v239
    v_mul_f32 v234, v150, v238
    v_mul_f32 v236, v182, v238
    v_fma_f32 v234, v182, v239, v234
    v_fma_f32 v236, -v150, v239, v236
    v_fmamk_f32 v242, v228, 0x3c8c0000, v229
    v_cos_f32 v240, v242
    v_sin_f32 v241, v242
    v_mul_f32 v240, s4, v240
    v_mul_f32 v241, s4, v241
    v_mul_f32 v235, v151, v240
    v_mul_f32 v237, v183, v240
    v_fma_f32 v235, v183, v241, v235
    v_fma_f32 v237, -v151, v241, v237
    v_cvt_pk_bf16_f32 v93, v234, v235
    v_cvt_pk_bf16_f32 v109, v236, v237
    v_cvt_pk_bf16_f32 v125, -v234, -v235
    v_fmamk_f32 v242, v228, 0x3ca00000, v229
    v_cos_f32 v238, v242
    v_sin_f32 v239, v242
    v_mul_f32 v238, s4, v238
    v_mul_f32 v239, s4, v239
    v_mul_f32 v234, v152, v238
    v_mul_f32 v236, v184, v238
    v_fma_f32 v234, v184, v239, v234
    v_fma_f32 v236, -v152, v239, v236
    v_fmamk_f32 v242, v228, 0x3ca40000, v229
    v_cos_f32 v240, v242
    v_sin_f32 v241, v242
    v_mul_f32 v240, s4, v240
    v_mul_f32 v241, s4, v241
    v_mul_f32 v235, v153, v240
    v_mul_f32 v237, v185, v240
    v_fma_f32 v235, v185, v241, v235
    v_fma_f32 v237, -v153, v241, v237
    v_cvt_pk_bf16_f32 v94, v234, v235
    v_cvt_pk_bf16_f32 v110, v236, v237
    v_cvt_pk_bf16_f32 v126, -v234, -v235
    v_fmamk_f32 v242, v228, 0x3ca80000, v229
    v_cos_f32 v238, v242
    v_sin_f32 v239, v242
    v_mul_f32 v238, s4, v238
    v_mul_f32 v239, s4, v239
    v_mul_f32 v234, v154, v238
    v_mul_f32 v236, v186, v238
    v_fma_f32 v234, v186, v239, v234
    v_fma_f32 v236, -v154, v239, v236
    v_fmamk_f32 v242, v228, 0x3cac0000, v229
    v_cos_f32 v240, v242
    v_sin_f32 v241, v242
    v_mul_f32 v240, s4, v240
    v_mul_f32 v241, s4, v241
    v_mul_f32 v235, v155, v240
    v_mul_f32 v237, v187, v240
    v_fma_f32 v235, v187, v241, v235
    v_fma_f32 v237, -v155, v241, v237
    v_cvt_pk_bf16_f32 v95, v234, v235
    v_cvt_pk_bf16_f32 v111, v236, v237
    v_cvt_pk_bf16_f32 v127, -v234, -v235
    v_fmamk_f32 v242, v228, 0x3cc00000, v229
    v_cos_f32 v238, v242
    v_sin_f32 v239, v242
    v_mul_f32 v238, s4, v238
    v_mul_f32 v239, s4, v239
    v_mul_f32 v234, v156, v238
    v_mul_f32 v236, v188, v238
    v_fma_f32 v234, v188, v239, v234
    v_fma_f32 v236, -v156, v239, v236
    v_fmamk_f32 v242, v228, 0x3cc40000, v229
    v_cos_f32 v240, v242
    v_sin_f32 v241, v242
    v_mul_f32 v240, s4, v240
    v_mul_f32 v241, s4, v241
    v_mul_f32 v235, v157, v240
    v_mul_f32 v237, v189, v240
    v_fma_f32 v235, v189, v241, v235
    v_fma_f32 v237, -v157, v241, v237
    v_cvt_pk_bf16_f32 v96, v234, v235
    v_cvt_pk_bf16_f32 v112, v236, v237
    v_cvt_pk_bf16_f32 v128, -v234, -v235
    v_fmamk_f32 v242, v228, 0x3cc80000, v229
    v_cos_f32 v238, v242
    v_sin_f32 v239, v242
    v_mul_f32 v238, s4, v238
    v_mul_f32 v239, s4, v239
    v_mul_f32 v234, v158, v238
    v_mul_f32 v236, v190, v238
    v_fma_f32 v234, v190, v239, v234
    v_fma_f32 v236, -v158, v239, v236
    v_fmamk_f32 v242, v228, 0x3ccc0000, v229
    v_cos_f32 v240, v242
    v_sin_f32 v241, v242
    v_mul_f32 v240, s4, v240
    v_mul_f32 v241, s4, v241
    v_mul_f32 v235, v159, v240
    v_mul_f32 v237, v191, v240
    v_fma_f32 v235, v191, v241, v235
    v_fma_f32 v237, -v159, v241, v237
    v_cvt_pk_bf16_f32 v97, v234, v235
    v_cvt_pk_bf16_f32 v113, v236, v237
    v_cvt_pk_bf16_f32 v129, -v234, -v235
    v_fmamk_f32 v242, v228, 0x3ce00000, v229
    v_cos_f32 v238, v242
    v_sin_f32 v239, v242
    v_mul_f32 v238, s4, v238
    v_mul_f32 v239, s4, v239
    v_mul_f32 v234, v160, v238
    v_mul_f32 v236, v192, v238
    v_fma_f32 v234, v192, v239, v234
    v_fma_f32 v236, -v160, v239, v236
    v_fmamk_f32 v242, v228, 0x3ce40000, v229
    v_cos_f32 v240, v242
    v_sin_f32 v241, v242
    v_mul_f32 v240, s4, v240
    v_mul_f32 v241, s4, v241
    v_mul_f32 v235, v161, v240
    v_mul_f32 v237, v193, v240
    v_fma_f32 v235, v193, v241, v235
    v_fma_f32 v237, -v161, v241, v237
    v_cvt_pk_bf16_f32 v98, v234, v235
    v_cvt_pk_bf16_f32 v114, v236, v237
    v_cvt_pk_bf16_f32 v130, -v234, -v235
    v_fmamk_f32 v242, v228, 0x3ce80000, v229
    v_cos_f32 v238, v242
    v_sin_f32 v239, v242
    v_mul_f32 v238, s4, v238
    v_mul_f32 v239, s4, v239
    v_mul_f32 v234, v162, v238
    v_mul_f32 v236, v194, v238
    v_fma_f32 v234, v194, v239, v234
    v_fma_f32 v236, -v162, v239, v236
    v_fmamk_f32 v242, v228, 0x3cec0000, v229
    v_cos_f32 v240, v242
    v_sin_f32 v241, v242
    v_mul_f32 v240, s4, v240
    v_mul_f32 v241, s4, v241
    v_mul_f32 v235, v163, v240
    v_mul_f32 v237, v195, v240
    v_fma_f32 v235, v195, v241, v235
    v_fma_f32 v237, -v163, v241, v237
    v_cvt_pk_bf16_f32 v99, v234, v235
    v_cvt_pk_bf16_f32 v115, v236, v237
    v_cvt_pk_bf16_f32 v131, -v234, -v235
    v_mfma_f32_32x32x16_bf16 v[132:147], v[4:7], v[84:87], 0
    v_mfma_f32_32x32x16_bf16 v[164:179], v[4:7], v[100:103], 0
    v_mfma_f32_32x32x16_bf16 v[132:147], v[36:39], v[100:103], v[132:147]
    v_mfma_f32_32x32x16_bf16 v[164:179], v[36:39], v[116:119], v[164:179]
    v_mfma_f32_32x32x16_bf16 v[132:147], v[8:11], v[88:91], v[132:147]
    v_mfma_f32_32x32x16_bf16 v[164:179], v[8:11], v[104:107], v[164:179]
    v_mfma_f32_32x32x16_bf16 v[132:147], v[40:43], v[104:107], v[132:147]
    v_mfma_f32_32x32x16_bf16 v[164:179], v[40:43], v[120:123], v[164:179]
    v_mfma_f32_32x32x16_bf16 v[132:147], v[12:15], v[92:95], v[132:147]
    v_mfma_f32_32x32x16_bf16 v[164:179], v[12:15], v[108:111], v[164:179]
    v_mfma_f32_32x32x16_bf16 v[132:147], v[44:47], v[108:111], v[132:147]
    v_mfma_f32_32x32x16_bf16 v[164:179], v[44:47], v[124:127], v[164:179]
    v_mfma_f32_32x32x16_bf16 v[132:147], v[16:19], v[96:99], v[132:147]
    v_mfma_f32_32x32x16_bf16 v[164:179], v[16:19], v[112:115], v[164:179]
    v_mfma_f32_32x32x16_bf16 v[132:147], v[48:51], v[112:115], v[132:147]
    v_mfma_f32_32x32x16_bf16 v[164:179], v[48:51], v[128:131], v[164:179]
    v_mfma_f32_32x32x16_bf16 v[148:163], v[20:23], v[84:87], 0
    v_mfma_f32_32x32x16_bf16 v[180:195], v[20:23], v[100:103], 0
    v_mfma_f32_32x32x16_bf16 v[148:163], v[52:55], v[100:103], v[148:163]
    v_mfma_f32_32x32x16_bf16 v[180:195], v[52:55], v[116:119], v[180:195]
    v_mfma_f32_32x32x16_bf16 v[148:163], v[24:27], v[88:91], v[148:163]
    v_mfma_f32_32x32x16_bf16 v[180:195], v[24:27], v[104:107], v[180:195]
    v_mfma_f32_32x32x16_bf16 v[148:163], v[56:59], v[104:107], v[148:163]
    v_mfma_f32_32x32x16_bf16 v[180:195], v[56:59], v[120:123], v[180:195]
    v_mfma_f32_32x32x16_bf16 v[148:163], v[28:31], v[92:95], v[148:163]
    v_mfma_f32_32x32x16_bf16 v[180:195], v[28:31], v[108:111], v[180:195]
    v_mfma_f32_32x32x16_bf16 v[148:163], v[60:63], v[108:111], v[148:163]
    v_mfma_f32_32x32x16_bf16 v[180:195], v[60:63], v[124:127], v[180:195]
    v_mfma_f32_32x32x16_bf16 v[148:163], v[32:35], v[96:99], v[148:163]
    v_mfma_f32_32x32x16_bf16 v[180:195], v[32:35], v[112:115], v[180:195]
    v_mfma_f32_32x32x16_bf16 v[148:163], v[64:67], v[112:115], v[148:163]
    v_mfma_f32_32x32x16_bf16 v[180:195], v[64:67], v[128:131], v[180:195]
    v_lshlrev_b32 v238, 16, v196
    v_and_b32 v239, 0xffff0000, v196
    v_mul_f32 v234, v132, v238
    v_mul_f32 v236, v164, v238
    v_fma_f32 v234, -v164, v239, v234
    v_fma_f32 v236, v132, v239, v236
    v_lshlrev_b32 v240, 16, v197
    v_and_b32 v241, 0xffff0000, v197
    v_mul_f32 v235, v133, v240
    v_mul_f32 v237, v165, v240
    v_fma_f32 v235, -v165, v241, v235
    v_fma_f32 v237, v133, v241, v237
    v_cvt_pk_bf16_f32 v84, v234, v235
    v_cvt_pk_bf16_f32 v100, v236, v237
    v_cvt_pk_bf16_f32 v116, -v236, -v237
    v_lshlrev_b32 v238, 16, v198
    v_and_b32 v239, 0xffff0000, v198
    v_mul_f32 v234, v134, v238
    v_mul_f32 v236, v166, v238
    v_fma_f32 v234, -v166, v239, v234
    v_fma_f32 v236, v134, v239, v236
    v_lshlrev_b32 v240, 16, v199
    v_and_b32 v241, 0xffff0000, v199
    v_mul_f32 v235, v135, v240
    v_mul_f32 v237, v167, v240
    v_fma_f32 v235, -v167, v241, v235
    v_fma_f32 v237, v135, v241, v237
    v_cvt_pk_bf16_f32 v85, v234, v235
    v_cvt_pk_bf16_f32 v101, v236, v237
    v_cvt_pk_bf16_f32 v117, -v236, -v237
    v_lshlrev_b32 v238, 16, v200
    v_and_b32 v239, 0xffff0000, v200
    v_mul_f32 v234, v136, v238
    v_mul_f32 v236, v168, v238
    v_fma_f32 v234, -v168, v239, v234
    v_fma_f32 v236, v136, v239, v236
    v_lshlrev_b32 v240, 16, v201
    v_and_b32 v241, 0xffff0000, v201
    v_mul_f32 v235, v137, v240
    v_mul_f32 v237, v169, v240
    v_fma_f32 v235, -v169, v241, v235
    v_fma_f32 v237, v137, v241, v237
    v_cvt_pk_bf16_f32 v86, v234, v235
    v_cvt_pk_bf16_f32 v102, v236, v237
    v_cvt_pk_bf16_f32 v118, -v236, -v237
    v_lshlrev_b32 v238, 16, v202
    v_and_b32 v239, 0xffff0000, v202
    v_mul_f32 v234, v138, v238
    v_mul_f32 v236, v170, v238
    v_fma_f32 v234, -v170, v239, v234
    v_fma_f32 v236, v138, v239, v236
    v_lshlrev_b32 v240, 16, v203
    v_and_b32 v241, 0xffff0000, v203
    v_mul_f32 v235, v139, v240
    v_mul_f32 v237, v171, v240
    v_fma_f32 v235, -v171, v241, v235
    v_fma_f32 v237, v139, v241, v237
    v_cvt_pk_bf16_f32 v87, v234, v235
    v_cvt_pk_bf16_f32 v103, v236, v237
    v_cvt_pk_bf16_f32 v119, -v236, -v237
    v_lshlrev_b32 v238, 16, v204
    v_and_b32 v239, 0xffff0000, v204
    v_mul_f32 v234, v140, v238
    v_mul_f32 v236, v172, v238
    v_fma_f32 v234, -v172, v239, v234
    v_fma_f32 v236, v140, v239, v236
    v_lshlrev_b32 v240, 16, v205
    v_and_b32 v241, 0xffff0000, v205
    v_mul_f32 v235, v141, v240
    v_mul_f32 v237, v173, v240
    v_fma_f32 v235, -v173, v241, v235
    v_fma_f32 v237, v141, v241, v237
    v_cvt_pk_bf16_f32 v88, v234, v235
    v_cvt_pk_bf16_f32 v104, v236, v237
    v_cvt_pk_bf16_f32 v120, -v236, -v237
    v_lshlrev_b32 v238, 16, v206
    v_and_b32 v239, 0xffff0000, v206
    v_mul_f32 v234, v142, v238
    v_mul_f32 v236, v174, v238
    v_fma_f32 v234, -v174, v239, v234
    v_fma_f32 v236, v142, v239, v236
    v_lshlrev_b32 v240, 16, v207
    v_and_b32 v241, 0xffff0000, v207
    v_mul_f32 v235, v143, v240
    v_mul_f32 v237, v175, v240
    v_fma_f32 v235, -v175, v241, v235
    v_fma_f32 v237, v143, v241, v237
    v_cvt_pk_bf16_f32 v89, v234, v235
    v_cvt_pk_bf16_f32 v105, v236, v237
    v_cvt_pk_bf16_f32 v121, -v236, -v237
    v_lshlrev_b32 v238, 16, v208
    v_and_b32 v239, 0xffff0000, v208
    v_mul_f32 v234, v144, v238
    v_mul_f32 v236, v176, v238
    v_fma_f32 v234, -v176, v239, v234
    v_fma_f32 v236, v144, v239, v236
    v_lshlrev_b32 v240, 16, v209
    v_and_b32 v241, 0xffff0000, v209
    v_mul_f32 v235, v145, v240
    v_mul_f32 v237, v177, v240
    v_fma_f32 v235, -v177, v241, v235
    v_fma_f32 v237, v145, v241, v237
    v_cvt_pk_bf16_f32 v90, v234, v235
    v_cvt_pk_bf16_f32 v106, v236, v237
    v_cvt_pk_bf16_f32 v122, -v236, -v237
    v_lshlrev_b32 v238, 16, v210
    v_and_b32 v239, 0xffff0000, v210
    v_mul_f32 v234, v146, v238
    v_mul_f32 v236, v178, v238
    v_fma_f32 v234, -v178, v239, v234
    v_fma_f32 v236, v146, v239, v236
    v_lshlrev_b32 v240, 16, v211
    v_and_b32 v241, 0xffff0000, v211
    v_mul_f32 v235, v147, v240
    v_mul_f32 v237, v179, v240
    v_fma_f32 v235, -v179, v241, v235
    v_fma_f32 v237, v147, v241, v237
    v_cvt_pk_bf16_f32 v91, v234, v235
    v_cvt_pk_bf16_f32 v107, v236, v237
    v_cvt_pk_bf16_f32 v123, -v236, -v237
    v_lshlrev_b32 v238, 16, v212
    v_and_b32 v239, 0xffff0000, v212
    v_mul_f32 v234, v148, v238
    v_mul_f32 v236, v180, v238
    v_fma_f32 v234, -v180, v239, v234
    v_fma_f32 v236, v148, v239, v236
    v_lshlrev_b32 v240, 16, v213
    v_and_b32 v241, 0xffff0000, v213
    v_mul_f32 v235, v149, v240
    v_mul_f32 v237, v181, v240
    v_fma_f32 v235, -v181, v241, v235
    v_fma_f32 v237, v149, v241, v237
    v_cvt_pk_bf16_f32 v92, v234, v235
    v_cvt_pk_bf16_f32 v108, v236, v237
    v_cvt_pk_bf16_f32 v124, -v236, -v237
    v_lshlrev_b32 v238, 16, v214
    v_and_b32 v239, 0xffff0000, v214
    v_mul_f32 v234, v150, v238
    v_mul_f32 v236, v182, v238
    v_fma_f32 v234, -v182, v239, v234
    v_fma_f32 v236, v150, v239, v236
    v_lshlrev_b32 v240, 16, v215
    v_and_b32 v241, 0xffff0000, v215
    v_mul_f32 v235, v151, v240
    v_mul_f32 v237, v183, v240
    v_fma_f32 v235, -v183, v241, v235
    v_fma_f32 v237, v151, v241, v237
    v_cvt_pk_bf16_f32 v93, v234, v235
    v_cvt_pk_bf16_f32 v109, v236, v237
    v_cvt_pk_bf16_f32 v125, -v236, -v237
    v_lshlrev_b32 v238, 16, v216
    v_and_b32 v239, 0xffff0000, v216
    v_mul_f32 v234, v152, v238
    v_mul_f32 v236, v184, v238
    v_fma_f32 v234, -v184, v239, v234
    v_fma_f32 v236, v152, v239, v236
    v_lshlrev_b32 v240, 16, v217
    v_and_b32 v241, 0xffff0000, v217
    v_mul_f32 v235, v153, v240
    v_mul_f32 v237, v185, v240
    v_fma_f32 v235, -v185, v241, v235
    v_fma_f32 v237, v153, v241, v237
    v_cvt_pk_bf16_f32 v94, v234, v235
    v_cvt_pk_bf16_f32 v110, v236, v237
    v_cvt_pk_bf16_f32 v126, -v236, -v237
    v_lshlrev_b32 v238, 16, v218
    v_and_b32 v239, 0xffff0000, v218
    v_mul_f32 v234, v154, v238
    v_mul_f32 v236, v186, v238
    v_fma_f32 v234, -v186, v239, v234
    v_fma_f32 v236, v154, v239, v236
    v_lshlrev_b32 v240, 16, v219
    v_and_b32 v241, 0xffff0000, v219
    v_mul_f32 v235, v155, v240
    v_mul_f32 v237, v187, v240
    v_fma_f32 v235, -v187, v241, v235
    v_fma_f32 v237, v155, v241, v237
    v_cvt_pk_bf16_f32 v95, v234, v235
    v_cvt_pk_bf16_f32 v111, v236, v237
    v_cvt_pk_bf16_f32 v127, -v236, -v237
    v_lshlrev_b32 v238, 16, v220
    v_and_b32 v239, 0xffff0000, v220
    v_mul_f32 v234, v156, v238
    v_mul_f32 v236, v188, v238
    v_fma_f32 v234, -v188, v239, v234
    v_fma_f32 v236, v156, v239, v236
    v_lshlrev_b32 v240, 16, v221
    v_and_b32 v241, 0xffff0000, v221
    v_mul_f32 v235, v157, v240
    v_mul_f32 v237, v189, v240
    v_fma_f32 v235, -v189, v241, v235
    v_fma_f32 v237, v157, v241, v237
    v_cvt_pk_bf16_f32 v96, v234, v235
    v_cvt_pk_bf16_f32 v112, v236, v237
    v_cvt_pk_bf16_f32 v128, -v236, -v237
    v_lshlrev_b32 v238, 16, v222
    v_and_b32 v239, 0xffff0000, v222
    v_mul_f32 v234, v158, v238
    v_mul_f32 v236, v190, v238
    v_fma_f32 v234, -v190, v239, v234
    v_fma_f32 v236, v158, v239, v236
    v_lshlrev_b32 v240, 16, v223
    v_and_b32 v241, 0xffff0000, v223
    v_mul_f32 v235, v159, v240
    v_mul_f32 v237, v191, v240
    v_fma_f32 v235, -v191, v241, v235
    v_fma_f32 v237, v159, v241, v237
    v_cvt_pk_bf16_f32 v97, v234, v235
    v_cvt_pk_bf16_f32 v113, v236, v237
    v_cvt_pk_bf16_f32 v129, -v236, -v237
    v_lshlrev_b32 v238, 16, v224
    v_and_b32 v239, 0xffff0000, v224
    v_mul_f32 v234, v160, v238
    v_mul_f32 v236, v192, v238
    v_fma_f32 v234, -v192, v239, v234
    v_fma_f32 v236, v160, v239, v236
    v_lshlrev_b32 v240, 16, v225
    v_and_b32 v241, 0xffff0000, v225
    v_mul_f32 v235, v161, v240
    v_mul_f32 v237, v193, v240
    v_fma_f32 v235, -v193, v241, v235
    v_fma_f32 v237, v161, v241, v237
    v_cvt_pk_bf16_f32 v98, v234, v235
    v_cvt_pk_bf16_f32 v114, v236, v237
    v_cvt_pk_bf16_f32 v130, -v236, -v237
    v_lshlrev_b32 v238, 16, v226
    v_and_b32 v239, 0xffff0000, v226
    v_mul_f32 v234, v162, v238
    v_mul_f32 v236, v194, v238
    v_fma_f32 v234, -v194, v239, v234
    v_fma_f32 v236, v162, v239, v236
    v_lshlrev_b32 v240, 16, v227
    v_and_b32 v241, 0xffff0000, v227
    v_mul_f32 v235, v163, v240
    v_mul_f32 v237, v195, v240
    v_fma_f32 v235, -v195, v241, v235
    v_fma_f32 v237, v163, v241, v237
    v_cvt_pk_bf16_f32 v99, v234, v235
    v_cvt_pk_bf16_f32 v115, v236, v237
    v_cvt_pk_bf16_f32 v131, -v236, -v237
    v_mfma_f32_32x32x16_bf16 v[132:147], v[84:87], v[4:7], 0
    v_mfma_f32_32x32x16_bf16 v[164:179], v[100:103], v[4:7], 0
    v_mfma_f32_32x32x16_bf16 v[132:147], v[116:119], v[36:39], v[132:147]
    v_mfma_f32_32x32x16_bf16 v[164:179], v[84:87], v[36:39], v[164:179]
    v_mfma_f32_32x32x16_bf16 v[132:147], v[88:91], v[8:11], v[132:147]
    v_mfma_f32_32x32x16_bf16 v[164:179], v[104:107], v[8:11], v[164:179]
    v_mfma_f32_32x32x16_bf16 v[132:147], v[120:123], v[40:43], v[132:147]
    v_mfma_f32_32x32x16_bf16 v[164:179], v[88:91], v[40:43], v[164:179]
    v_mfma_f32_32x32x16_bf16 v[132:147], v[92:95], v[12:15], v[132:147]
    v_mfma_f32_32x32x16_bf16 v[164:179], v[108:111], v[12:15], v[164:179]
    v_mfma_f32_32x32x16_bf16 v[132:147], v[124:127], v[44:47], v[132:147]
    v_mfma_f32_32x32x16_bf16 v[164:179], v[92:95], v[44:47], v[164:179]
    v_mfma_f32_32x32x16_bf16 v[132:147], v[96:99], v[16:19], v[132:147]
    v_mfma_f32_32x32x16_bf16 v[164:179], v[112:115], v[16:19], v[164:179]
    v_mfma_f32_32x32x16_bf16 v[132:147], v[128:131], v[48:51], v[132:147]
    v_mfma_f32_32x32x16_bf16 v[164:179], v[96:99], v[48:51], v[164:179]
    v_mfma_f32_32x32x16_bf16 v[148:163], v[84:87], v[20:23], 0
    v_mfma_f32_32x32x16_bf16 v[180:195], v[100:103], v[20:23], 0
    v_mfma_f32_32x32x16_bf16 v[148:163], v[116:119], v[52:55], v[148:163]
    v_mfma_f32_32x32x16_bf16 v[180:195], v[84:87], v[52:55], v[180:195]
    v_mfma_f32_32x32x16_bf16 v[148:163], v[88:91], v[24:27], v[148:163]
    v_mfma_f32_32x32x16_bf16 v[180:195], v[104:107], v[24:27], v[180:195]
    v_mfma_f32_32x32x16_bf16 v[148:163], v[120:123], v[56:59], v[148:163]
    v_mfma_f32_32x32x16_bf16 v[180:195], v[88:91], v[56:59], v[180:195]
    v_mfma_f32_32x32x16_bf16 v[148:163], v[92:95], v[28:31], v[148:163]
    v_mfma_f32_32x32x16_bf16 v[180:195], v[108:111], v[28:31], v[180:195]
    v_mfma_f32_32x32x16_bf16 v[148:163], v[124:127], v[60:63], v[148:163]
    v_mfma_f32_32x32x16_bf16 v[180:195], v[92:95], v[60:63], v[180:195]
    v_mfma_f32_32x32x16_bf16 v[148:163], v[96:99], v[32:35], v[148:163]
    v_mfma_f32_32x32x16_bf16 v[180:195], v[112:115], v[32:35], v[180:195]
    v_mfma_f32_32x32x16_bf16 v[148:163], v[128:131], v[64:67], v[148:163]
    v_mfma_f32_32x32x16_bf16 v[180:195], v[96:99], v[64:67], v[180:195]
    v_fmamk_f32 v242, v228, 0x0, v229
    v_cos_f32 v238, v242
    v_sin_f32 v239, v242
    v_mul_f32 v234, v132, v238
    v_mul_f32 v236, v164, v238
    v_fma_f32 v234, -v164, v239, v234
    v_fma_f32 v236, v132, v239, v236
    v_fmamk_f32 v242, v228, 0x3a000000, v229
    v_cos_f32 v240, v242
    v_sin_f32 v241, v242
    v_mul_f32 v235, v133, v240
    v_mul_f32 v237, v165, v240
    v_fma_f32 v235, -v165, v241, v235
    v_fma_f32 v237, v133, v241, v237
    v_cvt_pk_bf16_f32 v84, v234, v235
    v_cvt_pk_bf16_f32 v100, v236, v237
    v_cvt_pk_bf16_f32 v116, -v236, -v237
    v_fmamk_f32 v242, v228, 0x3a800000, v229
    v_cos_f32 v238, v242
    v_sin_f32 v239, v242
    v_mul_f32 v234, v134, v238
    v_mul_f32 v236, v166, v238
    v_fma_f32 v234, -v166, v239, v234
    v_fma_f32 v236, v134, v239, v236
    v_fmamk_f32 v242, v228, 0x3ac00000, v229
    v_cos_f32 v240, v242
    v_sin_f32 v241, v242
    v_mul_f32 v235, v135, v240
    v_mul_f32 v237, v167, v240
    v_fma_f32 v235, -v167, v241, v235
    v_fma_f32 v237, v135, v241, v237
    v_cvt_pk_bf16_f32 v85, v234, v235
    v_cvt_pk_bf16_f32 v101, v236, v237
    v_cvt_pk_bf16_f32 v117, -v236, -v237
    v_fmamk_f32 v242, v228, 0x3b800000, v229
    v_cos_f32 v238, v242
    v_sin_f32 v239, v242
    v_mul_f32 v234, v136, v238
    v_mul_f32 v236, v168, v238
    v_fma_f32 v234, -v168, v239, v234
    v_fma_f32 v236, v136, v239, v236
    v_fmamk_f32 v242, v228, 0x3b900000, v229
    v_cos_f32 v240, v242
    v_sin_f32 v241, v242
    v_mul_f32 v235, v137, v240
    v_mul_f32 v237, v169, v240
    v_fma_f32 v235, -v169, v241, v235
    v_fma_f32 v237, v137, v241, v237
    v_cvt_pk_bf16_f32 v86, v234, v235
    v_cvt_pk_bf16_f32 v102, v236, v237
    v_cvt_pk_bf16_f32 v118, -v236, -v237
    v_fmamk_f32 v242, v228, 0x3ba00000, v229
    v_cos_f32 v238, v242
    v_sin_f32 v239, v242
    v_mul_f32 v234, v138, v238
    v_mul_f32 v236, v170, v238
    v_fma_f32 v234, -v170, v239, v234
    v_fma_f32 v236, v138, v239, v236
    v_fmamk_f32 v242, v228, 0x3bb00000, v229
    v_cos_f32 v240, v242
    v_sin_f32 v241, v242
    v_mul_f32 v235, v139, v240
    v_mul_f32 v237, v171, v240
    v_fma_f32 v235, -v171, v241, v235
    v_fma_f32 v237, v139, v241, v237
    v_cvt_pk_bf16_f32 v87, v234, v235
    v_cvt_pk_bf16_f32 v103, v236, v237
    v_cvt_pk_bf16_f32 v119, -v236, -v237
    v_fmamk_f32 v242, v228, 0x3c000000, v229
    v_cos_f32 v238, v242
    v_sin_f32 v239, v242
    v_mul_f32 v234, v140, v238
    v_mul_f32 v236, v172, v238
    v_fma_f32 v234, -v172, v239, v234
    v_fma_f32 v236, v140, v239, v236
    v_fmamk_f32 v242, v228, 0x3c080000, v229
    v_cos_f32 v240, v242
    v_sin_f32 v241, v242
    v_mul_f32 v235, v141, v240
    v_mul_f32 v237, v173, v240
    v_fma_f32 v235, -v173, v241, v235
    v_fma_f32 v237, v141, v241, v237
    v_cvt_pk_bf16_f32 v88, v234, v235
    v_cvt_pk_bf16_f32 v104, v236, v237
    v_cvt_pk_bf16_f32 v120, -v236, -v237
    v_fmamk_f32 v242, v228, 0x3c100000, v229
    v_cos_f32 v238, v242
    v_sin_f32 v239, v242
    v_mul_f32 v234, v142, v238
    v_mul_f32 v236, v174, v238
    v_fma_f32 v234, -v174, v239, v234
    v_fma_f32 v236, v142, v239, v236
    v_fmamk_f32 v242, v228, 0x3c180000, v229
    v_cos_f32 v240, v242
    v_sin_f32 v241, v242
    v_mul_f32 v235, v143, v240
    v_mul_f32 v237, v175, v240
    v_fma_f32 v235, -v175, v241, v235
    v_fma_f32 v237, v143, v241, v237
    v_cvt_pk_bf16_f32 v89, v234, v235
    v_cvt_pk_bf16_f32 v105, v236, v237
    v_cvt_pk_bf16_f32 v121, -v236, -v237
    v_fmamk_f32 v242, v228, 0x3c400000, v229
    v_cos_f32 v238, v242
    v_sin_f32 v239, v242
    v_mul_f32 v234, v144, v238
    v_mul_f32 v236, v176, v238
    v_fma_f32 v234, -v176, v239, v234
    v_fma_f32 v236, v144, v239, v236
    v_fmamk_f32 v242, v228, 0x3c480000, v229
    v_cos_f32 v240, v242
    v_sin_f32 v241, v242
    v_mul_f32 v235, v145, v240
    v_mul_f32 v237, v177, v240
    v_fma_f32 v235, -v177, v241, v235
    v_fma_f32 v237, v145, v241, v237
    v_cvt_pk_bf16_f32 v90, v234, v235
    v_cvt_pk_bf16_f32 v106, v236, v237
    v_cvt_pk_bf16_f32 v122, -v236, -v237
    v_fmamk_f32 v242, v228, 0x3c500000, v229
    v_cos_f32 v238, v242
    v_sin_f32 v239, v242
    v_mul_f32 v234, v146, v238
    v_mul_f32 v236, v178, v238
    v_fma_f32 v234, -v178, v239, v234
    v_fma_f32 v236, v146, v239, v236
    v_fmamk_f32 v242, v228, 0x3c580000, v229
    v_cos_f32 v240, v242
    v_sin_f32 v241, v242
    v_mul_f32 v235, v147, v240
    v_mul_f32 v237, v179, v240
    v_fma_f32 v235, -v179, v241, v235
    v_fma_f32 v237, v147, v241, v237
    v_cvt_pk_bf16_f32 v91, v234, v235
    v_cvt_pk_bf16_f32 v107, v236, v237
    v_cvt_pk_bf16_f32 v123, -v236, -v237
    v_add_f32 v228, 0x42000000, v228
    v_mov_b32 v229, v230
    v_fmamk_f32 v242, v228, 0x0, v229
    v_cos_f32 v238, v242
    v_sin_f32 v239, v242
    v_mul_f32 v234, v148, v238
    v_mul_f32 v236, v180, v238
    v_fma_f32 v234, -v180, v239, v234
    v_fma_f32 v236, v148, v239, v236
    v_fmamk_f32 v242, v228, 0x3a000000, v229
    v_cos_f32 v240, v242
    v_sin_f32 v241, v242
    v_mul_f32 v235, v149, v240
    v_mul_f32 v237, v181, v240
    v_fma_f32 v235, -v181, v241, v235
    v_fma_f32 v237, v149, v241, v237
    v_cvt_pk_bf16_f32 v92, v234, v235
    v_cvt_pk_bf16_f32 v108, v236, v237
    v_cvt_pk_bf16_f32 v124, -v236, -v237
    v_fmamk_f32 v242, v228, 0x3a800000, v229
    v_cos_f32 v238, v242
    v_sin_f32 v239, v242
    v_mul_f32 v234, v150, v238
    v_mul_f32 v236, v182, v238
    v_fma_f32 v234, -v182, v239, v234
    v_fma_f32 v236, v150, v239, v236
    v_fmamk_f32 v242, v228, 0x3ac00000, v229
    v_cos_f32 v240, v242
    v_sin_f32 v241, v242
    v_mul_f32 v235, v151, v240
    v_mul_f32 v237, v183, v240
    v_fma_f32 v235, -v183, v241, v235
    v_fma_f32 v237, v151, v241, v237
    v_cvt_pk_bf16_f32 v93, v234, v235
    v_cvt_pk_bf16_f32 v109, v236, v237
    v_cvt_pk_bf16_f32 v125, -v236, -v237
    v_fmamk_f32 v242, v228, 0x3b800000, v229
    v_cos_f32 v238, v242
    v_sin_f32 v239, v242
    v_mul_f32 v234, v152, v238
    v_mul_f32 v236, v184, v238
    v_fma_f32 v234, -v184, v239, v234
    v_fma_f32 v236, v152, v239, v236
    v_fmamk_f32 v242, v228, 0x3b900000, v229
    v_cos_f32 v240, v242
    v_sin_f32 v241, v242
    v_mul_f32 v235, v153, v240
    v_mul_f32 v237, v185, v240
    v_fma_f32 v235, -v185, v241, v235
    v_fma_f32 v237, v153, v241, v237
    v_cvt_pk_bf16_f32 v94, v234, v235
    v_cvt_pk_bf16_f32 v110, v236, v237
    v_cvt_pk_bf16_f32 v126, -v236, -v237
    v_fmamk_f32 v242, v228, 0x3ba00000, v229
    v_cos_f32 v238, v242
    v_sin_f32 v239, v242
    v_mul_f32 v234, v154, v238
    v_mul_f32 v236, v186, v238
    v_fma_f32 v234, -v186, v239, v234
    v_fma_f32 v236, v154, v239, v236
    v_fmamk_f32 v242, v228, 0x3bb00000, v229
    v_cos_f32 v240, v242
    v_sin_f32 v241, v242
    v_mul_f32 v235, v155, v240
    v_mul_f32 v237, v187, v240
    v_fma_f32 v235, -v187, v241, v235
    v_fma_f32 v237, v155, v241, v237
    v_cvt_pk_bf16_f32 v95, v234, v235
    v_cvt_pk_bf16_f32 v111, v236, v237
    v_cvt_pk_bf16_f32 v127, -v236, -v237
    v_fmamk_f32 v242, v228, 0x3c000000, v229
    v_cos_f32 v238, v242
    v_sin_f32 v239, v242
    v_mul_f32 v234, v156, v238
    v_mul_f32 v236, v188, v238
    v_fma_f32 v234, -v188, v239, v234
    v_fma_f32 v236, v156, v239, v236
    v_fmamk_f32 v242, v228, 0x3c080000, v229
    v_cos_f32 v240, v242
    v_sin_f32 v241, v242
    v_mul_f32 v235, v157, v240
    v_mul_f32 v237, v189, v240
    v_fma_f32 v235, -v189, v241, v235
    v_fma_f32 v237, v157, v241, v237
    v_cvt_pk_bf16_f32 v96, v234, v235
    v_cvt_pk_bf16_f32 v112, v236, v237
    v_cvt_pk_bf16_f32 v128, -v236, -v237
    v_fmamk_f32 v242, v228, 0x3c100000, v229
    v_cos_f32 v238, v242
    v_sin_f32 v239, v242
    v_mul_f32 v234, v158, v238
    v_mul_f32 v236, v190, v238
    v_fma_f32 v234, -v190, v239, v234
    v_fma_f32 v236, v158, v239, v236
    v_fmamk_f32 v242, v228, 0x3c180000, v229
    v_cos_f32 v240, v242
    v_sin_f32 v241, v242
    v_mul_f32 v235, v159, v240
    v_mul_f32 v237, v191, v240
    v_fma_f32 v235, -v191, v241, v235
    v_fma_f32 v237, v159, v241, v237
    v_cvt_pk_bf16_f32 v97, v234, v235
    v_cvt_pk_bf16_f32 v113, v236, v237
    v_cvt_pk_bf16_f32 v129, -v236, -v237
    v_fmamk_f32 v242, v228, 0x3c400000, v229
    v_cos_f32 v238, v242
    v_sin_f32 v239, v242
    v_mul_f32 v234, v160, v238
    v_mul_f32 v236, v192, v238
    v_fma_f32 v234, -v192, v239, v234
    v_fma_f32 v236, v160, v239, v236
    v_fmamk_f32 v242, v228, 0x3c480000, v229
    v_cos_f32 v240, v242
    v_sin_f32 v241, v242
    v_mul_f32 v235, v161, v240
    v_mul_f32 v237, v193, v240
    v_fma_f32 v235, -v193, v241, v235
    v_fma_f32 v237, v161, v241, v237
    v_cvt_pk_bf16_f32 v98, v234, v235
    v_cvt_pk_bf16_f32 v114, v236, v237
    v_cvt_pk_bf16_f32 v130, -v236, -v237
    v_fmamk_f32 v242, v228, 0x3c500000, v229
    v_cos_f32 v238, v242
    v_sin_f32 v239, v242
    v_mul_f32 v234, v162, v238
    v_mul_f32 v236, v194, v238
    v_fma_f32 v234, -v194, v239, v234
    v_fma_f32 v236, v162, v239, v236
    v_fmamk_f32 v242, v228, 0x3c580000, v229
    v_cos_f32 v240, v242
    v_sin_f32 v241, v242
    v_mul_f32 v235, v163, v240
    v_mul_f32 v237, v195, v240
    v_fma_f32 v235, -v195, v241, v235
    v_fma_f32 v237, v163, v241, v237
    v_cvt_pk_bf16_f32 v99, v234, v235
    v_cvt_pk_bf16_f32 v115, v236, v237
    v_cvt_pk_bf16_f32 v131, -v236, -v237
    v_mfma_f32_32x32x16_bf16 v[132:147], v[68:71], v[84:87], 0
    v_mfma_f32_32x32x16_bf16 v[164:179], v[68:71], v[100:103], 0
    v_mfma_f32_32x32x16_bf16 v[132:147], v[76:79], v[116:119], v[132:147]
    v_mfma_f32_32x32x16_bf16 v[164:179], v[76:79], v[84:87], v[164:179]
    v_mfma_f32_32x32x16_bf16 v[132:147], v[72:75], v[88:91], v[132:147]
    v_mfma_f32_32x32x16_bf16 v[164:179], v[72:75], v[104:107], v[164:179]
    v_mfma_f32_32x32x16_bf16 v[132:147], v[80:83], v[120:123], v[132:147]
    v_mfma_f32_32x32x16_bf16 v[164:179], v[80:83], v[88:91], v[164:179]
    v_mfma_f32_32x32x16_bf16 v[148:163], v[68:71], v[92:95], 0
    v_mfma_f32_32x32x16_bf16 v[180:195], v[68:71], v[108:111], 0
    v_mfma_f32_32x32x16_bf16 v[148:163], v[76:79], v[124:127], v[148:163]
    v_mfma_f32_32x32x16_bf16 v[180:195], v[76:79], v[92:95], v[180:195]
    v_mfma_f32_32x32x16_bf16 v[148:163], v[72:75], v[96:99], v[148:163]
    v_mfma_f32_32x32x16_bf16 v[180:195], v[72:75], v[112:115], v[180:195]
    v_mfma_f32_32x32x16_bf16 v[148:163], v[80:83], v[128:131], v[148:163]
    v_mfma_f32_32x32x16_bf16 v[180:195], v[80:83], v[96:99], v[180:195]
    v_lshlrev_b32 v231, 4, v1
    v_add_u32 v232, s6, v231
    s_lshl_b32 s5, s3, 12
    s_add_u32 s5, s5, 0x5800000
    s_add_u32 s2, s5, 4096
    v_cvt_pk_bf16_f32 v84, v132, v133
    v_cvt_pk_bf16_f32 v85, v134, v135
    v_cvt_pk_bf16_f32 v86, v136, v137
    v_cvt_pk_bf16_f32 v87, v138, v139
    buffer_store_dwordx4 v[84:87], v231, s[8:11], s5 offen offset:0 sc1
    v_cvt_pk_bf16_f32 v88, v140, v141
    v_cvt_pk_bf16_f32 v89, v142, v143
    v_cvt_pk_bf16_f32 v90, v144, v145
    v_cvt_pk_bf16_f32 v91, v146, v147
    buffer_store_dwordx4 v[88:91], v231, s[8:11], s5 offen offset:1024 sc1
    v_cvt_pk_bf16_f32 v92, v148, v149
    v_cvt_pk_bf16_f32 v93, v150, v151
    v_cvt_pk_bf16_f32 v94, v152, v153
    v_cvt_pk_bf16_f32 v95, v154, v155
    buffer_store_dwordx4 v[92:95], v231, s[8:11], s5 offen offset:2048 sc1
    v_cvt_pk_bf16_f32 v96, v156, v157
    v_cvt_pk_bf16_f32 v97, v158, v159
    v_cvt_pk_bf16_f32 v98, v160, v161
    v_cvt_pk_bf16_f32 v99, v162, v163
    buffer_store_dwordx4 v[96:99], v231, s[8:11], s5 offen offset:3072 sc1
    v_cvt_pk_bf16_f32 v100, v164, v165
    v_cvt_pk_bf16_f32 v101, v166, v167
    v_cvt_pk_bf16_f32 v102, v168, v169
    v_cvt_pk_bf16_f32 v103, v170, v171
    buffer_store_dwordx4 v[100:103], v232, s[8:11], s2 offen offset:0 sc1
    v_cvt_pk_bf16_f32 v104, v172, v173
    v_cvt_pk_bf16_f32 v105, v174, v175
    v_cvt_pk_bf16_f32 v106, v176, v177
    v_cvt_pk_bf16_f32 v107, v178, v179
    buffer_store_dwordx4 v[104:107], v232, s[8:11], s2 offen offset:1024 sc1
    v_cvt_pk_bf16_f32 v108, v180, v181
    v_cvt_pk_bf16_f32 v109, v182, v183
    v_cvt_pk_bf16_f32 v110, v184, v185
    v_cvt_pk_bf16_f32 v111, v186, v187
    buffer_store_dwordx4 v[108:111], v232, s[8:11], s2 offen offset:2048 sc1
    v_cvt_pk_bf16_f32 v112, v188, v189
    v_cvt_pk_bf16_f32 v113, v190, v191
    v_cvt_pk_bf16_f32 v114, v192, v193
    v_cvt_pk_bf16_f32 v115, v194, v195
    buffer_store_dwordx4 v[112:115], v232, s[8:11], s2 offen offset:3072 sc1
colend_67:
    s_waitcnt vmcnt(0)
    s_barrier
    s_cmp_lg_u32 s58, 0
    s_cbranch_scc1 sig_68
    v_mov_b32 v234, 0x5ffffff0
    v_mov_b32 v235, 44
    v_cmp_eq_u32 vcc, 0, v1
    s_nop 1
    v_cndmask_b32 v235, v234, v235, vcc
    v_mov_b32 v234, 1
    buffer_atomic_add v234, v235, s[12:15], 0 offen sc1
    s_waitcnt vmcnt(0)
sig_68:
    v_bfe_u32 v204, v1, 2, 2
    v_sub_u32 v204, 0, v204
    v_lshrrev_b32 v203, 4, v1
    v_xor_b32 v204, v204, v203
    v_and_b32 v204, 3, v204
    v_bfe_u32 v200, v1, 0, 4
    v_lshlrev_b32 v200, 6, v200
    v_lshl_or_b32 v200, v204, 4, v200
    s_lshr_b32 s74, s58, 2
    s_mul_i32 s74, s74, 4096
    v_add_u32 v200, s74, v200
    v_bfe_u32 v201, v1, 0, 2
    v_lshlrev_b32 v201, 3, v201
    v_bfe_u32 v203, v1, 4, 1
    v_lshl_or_b32 v201, v203, 5, v201
    v_bfe_u32 v203, v1, 2, 2
    v_lshl_or_b32 v201, v203, 6, v201
    v_bfe_u32 v203, v1, 2, 2
    v_lshl_or_b32 v201, v203, 8, v201
    v_bfe_u32 v203, v1, 4, 2
    v_lshl_or_b32 v201, v203, 11, v201
    s_and_b32 s74, s58, 3
    s_mul_i32 s74, s74, 64
    s_or_b32 s74, s74, 8192
    v_xor_b32 v201, s74, v201
    s_mov_b64 s[60:61], s[8:9]
    s_mov_b32 s62, 0x10000000
    s_mov_b32 s63, 0x20000
    s_mov_b64 s[64:65], s[8:9]
    s_mov_b32 s66, 0x10000000
    s_mov_b32 s67, 0x20000
    v_lshrrev_b32 v204, 4, v1
    v_sub_u32 v204, 0, v204
    v_xor_b32 v204, v204, v1
    v_and_b32 v204, 3, v204
    s_mul_i32 s74, s58, 16
    v_lshrrev_b32 v205, 2, v1
    v_add3_u32 v205, v205, s74, 0
    v_bfe_u32 v196, v205, 0, 2
    v_lshlrev_b32 v196, 11, v196
    v_bfe_u32 v203, v205, 4, 1
    v_lshl_or_b32 v196, v203, 13, v196
    v_bfe_u32 v203, v205, 2, 2
    v_lshl_or_b32 v196, v203, 14, v196
    v_bfe_u32 v203, v205, 5, 2
    v_lshl_or_b32 v196, v203, 16, v196
    v_lshl_add_u32 v196, v204, 4, v196
    s_and_b32 s74, s58, 2
    v_bfe_u32 v204, v1, 0, 4
    v_bfe_u32 v205, v1, 4, 2
    v_lshlrev_b32 v205, 2, v205
    v_xor_b32 v204, v204, v205
    v_xor_b32 v204, s74, v204
    v_lshlrev_b32 v205, 4, v204
    v_lshrrev_b32 v204, 4, v1
    v_lshl_add_u32 v198, v204, 12, v205
    s_lshl_b32 s74, s58, 14
    v_add_u32 v198, s74, v198
    s_mov_b32 s70, 131072
    s_and_b32 s79, s57, 7
    s_lshr_b32 s80, s76, 3
    s_lshl_b32 s68, s79, 18
    s_add_u32 s68, s68, 0x5200000
    s_lshl_b32 s69, s80, 8
    s_add_u32 s69, s69, 0x5800000
    s_cmp_lg_u32 s58, 0
    s_cbranch_scc1 wall_69
    v_mov_b32 v204, 44
wctr_70:
    buffer_load_dword v203, v204, s[12:15], 0 offen sc1
    s_waitcnt vmcnt(0)
    v_cmp_gt_u32 vcc, 128, v203
    s_cbranch_vccz wctr_ok_71
    s_sub_u32 s77, s77, 1
    s_cbranch_scc0 wctr_70
    s_mov_b32 s77, 0
wctr_ok_71:
wall_69:
    s_barrier
    s_mul_i32 s71, s58, 1024
    s_mov_b32 m0, s71
    s_nop 0
    buffer_load_dwordx4 v196, s[60:63], s68 offen lds
    s_add_u32 m0, s71, 8192
    s_nop 0
    buffer_load_dwordx4 v198, s[64:67], s69 offen lds
    s_add_u32 s68, s68, 64
    s_add_u32 s69, s69, s70
    s_add_u32 s71, s71, 16384
    s_and_b32 s71, s71, 0x1ffff
    s_mov_b32 m0, s71
    s_nop 0
    buffer_load_dwordx4 v196, s[60:63], s68 offen lds
    s_add_u32 m0, s71, 8192
    s_nop 0
    buffer_load_dwordx4 v198, s[64:67], s69 offen lds
    s_add_u32 s68, s68, 64
    s_add_u32 s69, s69, s70
    s_add_u32 s71, s71, 16384
    s_and_b32 s71, s71, 0x1ffff
    s_mov_b32 m0, s71
    s_nop 0
    buffer_load_dwordx4 v196, s[60:63], s68 offen lds
    s_add_u32 m0, s71, 8192
    s_nop 0
    buffer_load_dwordx4 v198, s[64:67], s69 offen lds
    s_add_u32 s68, s68, 64
    s_add_u32 s69, s69, s70
    s_add_u32 s71, s71, 16384
    s_and_b32 s71, s71, 0x1ffff
    s_mov_b32 m0, s71
    s_nop 0
    buffer_load_dwordx4 v196, s[60:63], s68 offen lds
    s_add_u32 m0, s71, 8192
    s_nop 0
    buffer_load_dwordx4 v198, s[64:67], s69 offen lds
    s_add_u32 s68, s68, 64
    s_add_u32 s69, s69, s70
    s_add_u32 s71, s71, 16384
    s_and_b32 s71, s71, 0x1ffff
    s_mov_b32 m0, s71
    s_nop 0
    buffer_load_dwordx4 v196, s[60:63], s68 offen lds
    s_add_u32 m0, s71, 8192
    s_nop 0
    buffer_load_dwordx4 v198, s[64:67], s69 offen lds
    s_add_u32 s68, s68, 64
    s_add_u32 s69, s69, s70
    s_add_u32 s71, s71, 16384
    s_and_b32 s71, s71, 0x1ffff
    s_mov_b32 m0, s71
    s_nop 0
    buffer_load_dwordx4 v196, s[60:63], s68 offen lds
    s_add_u32 m0, s71, 8192
    s_nop 0
    buffer_load_dwordx4 v198, s[64:67], s69 offen lds
    s_add_u32 s68, s68, 64
    s_add_u32 s69, s69, s70
    s_add_u32 s71, s71, 16384
    s_and_b32 s71, s71, 0x1ffff
    s_mov_b32 m0, s71
    s_nop 0
    buffer_load_dwordx4 v196, s[60:63], s68 offen lds
    s_add_u32 m0, s71, 8192
    s_nop 0
    buffer_load_dwordx4 v198, s[64:67], s69 offen lds
    s_add_u32 s68, s68, 64
    s_add_u32 s69, s69, s70
    s_add_u32 s71, s71, 16384
    s_and_b32 s71, s71, 0x1ffff
    s_mov_b32 m0, s71
    s_nop 0
    buffer_load_dwordx4 v196, s[60:63], s68 offen lds
    s_add_u32 m0, s71, 8192
    s_nop 0
    buffer_load_dwordx4 v198, s[64:67], s69 offen lds
    s_add_u32 s68, s68, 64
    s_add_u32 s69, s69, s70
    s_add_u32 s71, s71, 16384
    s_and_b32 s71, s71, 0x1ffff
    s_branch t128_40
p3e_49:
    s_lshl_b32 s84, s80, 2
    s_and_b32 s81, s58, 3
    s_add_u32 s84, s84, s81
    s_lshl_b32 s84, s84, 5
    v_and_b32 v205, 15, v1
    v_add_u32 v205, s84, v205
    v_bfe_u32 v204, v205, 3, 5
    v_lshlrev_b32 v204, 12, v204
    v_bfe_u32 v203, v205, 10, 1
    v_lshl_or_b32 v204, v203, 17, v204
    v_bfe_u32 v203, v205, 0, 2
    v_lshl_or_b32 v204, v203, 18, v204
    v_bfe_u32 v203, v205, 8, 1
    v_lshl_or_b32 v204, v203, 20, v204
    v_bfe_u32 v203, v205, 2, 1
    v_lshl_or_b32 v204, v203, 21, v204
    v_bfe_u32 v203, v205, 9, 1
    v_lshl_or_b32 v204, v203, 22, v204
    v_bfe_u32 v205, v1, 4, 2
    v_lshlrev_b32 v205, 4, v205
    v_add_u32 v204, v204, v205
    s_lshl_b32 s81, s79, 8
    s_lshr_b32 s84, s58, 2
    s_lshl_b32 s84, s84, 7
    s_add_u32 s81, s81, s84
    v_cvt_pk_bf16_f32 v132, v4, v5
    v_cvt_pk_bf16_f32 v133, v6, v7
    v_cvt_pk_bf16_f32 v134, v12, v13
    v_cvt_pk_bf16_f32 v135, v14, v15
    buffer_store_dwordx4 v[132:135], v204, s[16:19], s81 offen offset:0
    v_cvt_pk_bf16_f32 v136, v20, v21
    v_cvt_pk_bf16_f32 v137, v22, v23
    v_cvt_pk_bf16_f32 v138, v28, v29
    v_cvt_pk_bf16_f32 v139, v30, v31
    buffer_store_dwordx4 v[136:139], v204, s[16:19], s81 offen offset:64
    s_add_u32 s81, s81, 8192
    v_cvt_pk_bf16_f32 v140, v8, v9
    v_cvt_pk_bf16_f32 v141, v10, v11
    v_cvt_pk_bf16_f32 v142, v16, v17
    v_cvt_pk_bf16_f32 v143, v18, v19
    buffer_store_dwordx4 v[140:143], v204, s[16:19], s81 offen offset:0
    v_cvt_pk_bf16_f32 v144, v24, v25
    v_cvt_pk_bf16_f32 v145, v26, v27
    v_cvt_pk_bf16_f32 v146, v32, v33
    v_cvt_pk_bf16_f32 v147, v34, v35
    buffer_store_dwordx4 v[144:147], v204, s[16:19], s81 offen offset:64
    s_add_u32 s81, s81, 8192
    s_cmp_lg_u32 s58, 0
    s_cbranch_scc1 wall_72
    v_mov_b32 v204, 160
wctr_73:
    buffer_load_dword v203, v204, s[12:15], 0 offen sc1
    s_waitcnt vmcnt(0)
    v_cmp_gt_u32 vcc, 128, v203
    s_cbranch_vccz wctr_ok_74
    s_sub_u32 s77, s77, 1
    s_cbranch_scc0 wctr_73
    s_mov_b32 s77, 0
wctr_ok_74:
wall_72:
    s_barrier
    v_lshlrev_b32 v8, 4, v1
    v_bfe_u32 v2, v1, 0, 2
    v_lshlrev_b32 v2, 4, v2
    v_bfe_u32 v3, v1, 2, 4
    v_lshl_or_b32 v2, v3, 11, v2
    v_bfe_u32 v4, v1, 0, 2
    v_lshlrev_b32 v4, 3, v4
    v_bfe_u32 v3, v1, 4, 1
    v_lshl_or_b32 v4, v3, 5, v4
    v_bfe_u32 v3, v1, 2, 2
    v_lshl_or_b32 v4, v3, 6, v4
    v_bfe_u32 v3, v1, 5, 1
    v_lshl_or_b32 v4, v3, 8, v4
    s_lshl_b32 s5, s58, 14
    v_add_u32 v4, s5, v4
    s_lshl_b32 s4, s58, 20
    s_lshl_b32 s2, s57, 6
    s_add_u32 s4, s4, s2
    s_add_u32 m0, s5, 0
    s_nop 0
    buffer_load_dwordx4 v2, s[32:35], s4 offen lds
    s_add_u32 s4, s4, 0x8000
    s_add_u32 m0, s5, 1024
    s_nop 0
    buffer_load_dwordx4 v2, s[32:35], s4 offen lds
    s_add_u32 s4, s4, 0x8000
    s_add_u32 m0, s5, 2048
    s_nop 0
    buffer_load_dwordx4 v2, s[32:35], s4 offen lds
    s_add_u32 s4, s4, 0x8000
    s_add_u32 m0, s5, 3072
    s_nop 0
    buffer_load_dwordx4 v2, s[32:35], s4 offen lds
    s_add_u32 s4, s4, 0x8000
    s_add_u32 m0, s5, 4096
    s_nop 0
    buffer_load_dwordx4 v2, s[32:35], s4 offen lds
    s_add_u32 s4, s4, 0x8000
    s_add_u32 m0, s5, 5120
    s_nop 0
    buffer_load_dwordx4 v2, s[32:35], s4 offen lds
    s_add_u32 s4, s4, 0x8000
    s_add_u32 m0, s5, 6144
    s_nop 0
    buffer_load_dwordx4 v2, s[32:35], s4 offen lds
    s_add_u32 s4, s4, 0x8000
    s_add_u32 m0, s5, 7168
    s_nop 0
    buffer_load_dwordx4 v2, s[32:35], s4 offen lds
    s_add_u32 s4, s4, 0x8000
    s_add_u32 m0, s5, 8192
    s_nop 0
    buffer_load_dwordx4 v2, s[32:35], s4 offen lds
    s_add_u32 s4, s4, 0x8000
    s_add_u32 m0, s5, 9216
    s_nop 0
    buffer_load_dwordx4 v2, s[32:35], s4 offen lds
    s_add_u32 s4, s4, 0x8000
    s_add_u32 m0, s5, 10240
    s_nop 0
    buffer_load_dwordx4 v2, s[32:35], s4 offen lds
    s_add_u32 s4, s4, 0x8000
    s_add_u32 m0, s5, 11264
    s_nop 0
    buffer_load_dwordx4 v2, s[32:35], s4 offen lds
    s_add_u32 s4, s4, 0x8000
    s_add_u32 m0, s5, 12288
    s_nop 0
    buffer_load_dwordx4 v2, s[32:35], s4 offen lds
    s_add_u32 s4, s4, 0x8000
    s_add_u32 m0, s5, 13312
    s_nop 0
    buffer_load_dwordx4 v2, s[32:35], s4 offen lds
    s_add_u32 s4, s4, 0x8000
    s_add_u32 m0, s5, 14336
    s_nop 0
    buffer_load_dwordx4 v2, s[32:35], s4 offen lds
    s_add_u32 s4, s4, 0x8000
    s_add_u32 m0, s5, 15360
    s_nop 0
    buffer_load_dwordx4 v2, s[32:35], s4 offen lds
    s_add_u32 s4, s4, 0x8000
    s_waitcnt vmcnt(0)
    ds_read_b64_tr_b16 v[128:129], v4 offset:0
    ds_read_b64_tr_b16 v[130:131], v4 offset:512
    ds_read_b64_tr_b16 v[132:133], v4 offset:1024
    ds_read_b64_tr_b16 v[134:135], v4 offset:1536
    ds_read_b64_tr_b16 v[136:137], v4 offset:2048
    ds_read_b64_tr_b16 v[138:139], v4 offset:2560
    ds_read_b64_tr_b16 v[140:141], v4 offset:3072
    ds_read_b64_tr_b16 v[142:143], v4 offset:3584
    s_waitcnt lgkmcnt(0)
    ds_read_b64_tr_b16 v[144:145], v4 offset:4096
    ds_read_b64_tr_b16 v[146:147], v4 offset:4608
    ds_read_b64_tr_b16 v[148:149], v4 offset:5120
    ds_read_b64_tr_b16 v[150:151], v4 offset:5632
    ds_read_b64_tr_b16 v[152:153], v4 offset:6144
    ds_read_b64_tr_b16 v[154:155], v4 offset:6656
    ds_read_b64_tr_b16 v[156:157], v4 offset:7168
    ds_read_b64_tr_b16 v[158:159], v4 offset:7680
    s_waitcnt lgkmcnt(0)
    ds_read_b64_tr_b16 v[160:161], v4 offset:8192
    ds_read_b64_tr_b16 v[162:163], v4 offset:8704
    ds_read_b64_tr_b16 v[164:165], v4 offset:9216
    ds_read_b64_tr_b16 v[166:167], v4 offset:9728
    ds_read_b64_tr_b16 v[168:169], v4 offset:10240
    ds_read_b64_tr_b16 v[170:171], v4 offset:10752
    ds_read_b64_tr_b16 v[172:173], v4 offset:11264
    ds_read_b64_tr_b16 v[174:175], v4 offset:11776
    s_waitcnt lgkmcnt(0)
    ds_read_b64_tr_b16 v[176:177], v4 offset:12288
    ds_read_b64_tr_b16 v[178:179], v4 offset:12800
    ds_read_b64_tr_b16 v[180:181], v4 offset:13312
    ds_read_b64_tr_b16 v[182:183], v4 offset:13824
    ds_read_b64_tr_b16 v[184:185], v4 offset:14336
    ds_read_b64_tr_b16 v[186:187], v4 offset:14848
    ds_read_b64_tr_b16 v[188:189], v4 offset:15360
    ds_read_b64_tr_b16 v[190:191], v4 offset:15872
    s_waitcnt lgkmcnt(0)
    s_add_u32 m0, s5, 0
    s_nop 0
    buffer_load_dwordx4 v2, s[32:35], s4 offen lds
    s_add_u32 s4, s4, 0x8000
    s_add_u32 m0, s5, 1024
    s_nop 0
    buffer_load_dwordx4 v2, s[32:35], s4 offen lds
    s_add_u32 s4, s4, 0x8000
    s_add_u32 m0, s5, 2048
    s_nop 0
    buffer_load_dwordx4 v2, s[32:35], s4 offen lds
    s_add_u32 s4, s4, 0x8000
    s_add_u32 m0, s5, 3072
    s_nop 0
    buffer_load_dwordx4 v2, s[32:35], s4 offen lds
    s_add_u32 s4, s4, 0x8000
    s_add_u32 m0, s5, 4096
    s_nop 0
    buffer_load_dwordx4 v2, s[32:35], s4 offen lds
    s_add_u32 s4, s4, 0x8000
    s_add_u32 m0, s5, 5120
    s_nop 0
    buffer_load_dwordx4 v2, s[32:35], s4 offen lds
    s_add_u32 s4, s4, 0x8000
    s_add_u32 m0, s5, 6144
    s_nop 0
    buffer_load_dwordx4 v2, s[32:35], s4 offen lds
    s_add_u32 s4, s4, 0x8000
    s_add_u32 m0, s5, 7168
    s_nop 0
    buffer_load_dwordx4 v2, s[32:35], s4 offen lds
    s_add_u32 s4, s4, 0x8000
    s_add_u32 m0, s5, 8192
    s_nop 0
    buffer_load_dwordx4 v2, s[32:35], s4 offen lds
    s_add_u32 s4, s4, 0x8000
    s_add_u32 m0, s5, 9216
    s_nop 0
    buffer_load_dwordx4 v2, s[32:35], s4 offen lds
    s_add_u32 s4, s4, 0x8000
    s_add_u32 m0, s5, 10240
    s_nop 0
    buffer_load_dwordx4 v2, s[32:35], s4 offen lds
    s_add_u32 s4, s4, 0x8000
    s_add_u32 m0, s5, 11264
    s_nop 0
    buffer_load_dwordx4 v2, s[32:35], s4 offen lds
    s_add_u32 s4, s4, 0x8000
    s_add_u32 m0, s5, 12288
    s_nop 0
    buffer_load_dwordx4 v2, s[32:35], s4 offen lds
    s_add_u32 s4, s4, 0x8000
    s_add_u32 m0, s5, 13312
    s_nop 0
    buffer_load_dwordx4 v2, s[32:35], s4 offen lds
    s_add_u32 s4, s4, 0x8000
    s_add_u32 m0, s5, 14336
    s_nop 0
    buffer_load_dwordx4 v2, s[32:35], s4 offen lds
    s_add_u32 s4, s4, 0x8000
    s_add_u32 m0, s5, 15360
    s_nop 0
    buffer_load_dwordx4 v2, s[32:35], s4 offen lds
    s_add_u32 s4, s4, 0x8000
    s_waitcnt vmcnt(0)
    ds_read_b64_tr_b16 v[192:193], v4 offset:0
    ds_read_b64_tr_b16 v[194:195], v4 offset:512
    ds_read_b64_tr_b16 v[196:197], v4 offset:1024
    ds_read_b64_tr_b16 v[198:199], v4 offset:1536
    ds_read_b64_tr_b16 v[200:201], v4 offset:2048
    ds_read_b64_tr_b16 v[202:203], v4 offset:2560
    ds_read_b64_tr_b16 v[204:205], v4 offset:3072
    ds_read_b64_tr_b16 v[206:207], v4 offset:3584
    s_waitcnt lgkmcnt(0)
    ds_read_b64_tr_b16 v[208:209], v4 offset:4096
    ds_read_b64_tr_b16 v[210:211], v4 offset:4608
    ds_read_b64_tr_b16 v[212:213], v4 offset:5120
    ds_read_b64_tr_b16 v[214:215], v4 offset:5632
    ds_read_b64_tr_b16 v[216:217], v4 offset:6144
    ds_read_b64_tr_b16 v[218:219], v4 offset:6656
    ds_read_b64_tr_b16 v[220:221], v4 offset:7168
    ds_read_b64_tr_b16 v[222:223], v4 offset:7680
    s_waitcnt lgkmcnt(0)
    ds_read_b64_tr_b16 v[224:225], v4 offset:8192
    ds_read_b64_tr_b16 v[226:227], v4 offset:8704
    ds_read_b64_tr_b16 v[228:229], v4 offset:9216
    ds_read_b64_tr_b16 v[230:231], v4 offset:9728
    ds_read_b64_tr_b16 v[232:233], v4 offset:10240
    ds_read_b64_tr_b16 v[234:235], v4 offset:10752
    ds_read_b64_tr_b16 v[236:237], v4 offset:11264
    ds_read_b64_tr_b16 v[238:239], v4 offset:11776
    s_waitcnt lgkmcnt(0)
    ds_read_b64_tr_b16 v[240:241], v4 offset:12288
    ds_read_b64_tr_b16 v[242:243], v4 offset:12800
    ds_read_b64_tr_b16 v[244:245], v4 offset:13312
    ds_read_b64_tr_b16 v[246:247], v4 offset:13824
    ds_read_b64_tr_b16 v[248:249], v4 offset:14336
    ds_read_b64_tr_b16 v[250:251], v4 offset:14848
    ds_read_b64_tr_b16 v[252:253], v4 offset:15360
    ds_read_b64_tr_b16 v[254:255], v4 offset:15872
    s_waitcnt lgkmcnt(0)
    v_bfe_u32 v9, v1, 0, 3
    v_lshlrev_b32 v9, 4, v9
    v_bfe_u32 v3, v1, 5, 1
    v_lshl_or_b32 v9, v3, 7, v9
    v_lshlrev_b32 v10, 3, v1
    s_lshl_b32 s4, s58, 4
    v_mov_b32 v11, s4
    s_lshl_b32 s4, s58, 12
    v_add_u32 v12, s4, v8
    v_bfe_u32 v13, v1, 0, 5
    v_lshlrev_b32 v13, 4, v13
    v_bfe_u32 v3, v1, 5, 1
    v_lshl_or_b32 v13, v3, 3, v13
    s_lshl_b32 s4, s58, 9
    v_add_u32 v13, s4, v13
    v_bfe_u32 v14, v1, 0, 5
    v_lshlrev_b32 v14, 12, v14
    v_bfe_u32 v3, v1, 5, 1
    v_lshl_or_b32 v14, v3, 2, v14
    s_lshl_b32 s4, s58, 3
    s_add_u32 s4, s4, s2
    s_add_u32 s4, s4, 2048
    v_add_u32 v14, s4, v14
    v_bfe_u32 v2, v1, 5, 1
    v_lshlrev_b32 v2, 2, v2
    v_and_b32 v15, 31, v1
    v_sub_u32 v15, v15, v2
    s_mov_b32 s6, 0x3e0293ee
    s_mov_b32 s2, 0
    s_mov_b32 s3, s58
    s_barrier
aw_loop_75:
    s_cmp_ge_u32 s3, 16
    s_cbranch_scc1 aw_wo_76
    s_lshl_b32 s4, s3, 2
    s_add_u32 s4, s4, s75
    s_lshl_b32 s4, s4, 5
    s_add_u32 s4, s4, s57
    s_lshl_b32 s5, s4, 11
    s_add_u32 s5, s5, 0x4400000
aw_poll_78:
    buffer_load_dwordx2 v[16:17], v10, s[8:11], s5 offen offset:0 sc1
    buffer_load_dwordx2 v[18:19], v10, s[8:11], s5 offen offset:512 sc1
    buffer_load_dwordx2 v[20:21], v10, s[8:11], s5 offen offset:1024 sc1
    buffer_load_dwordx2 v[22:23], v10, s[8:11], s5 offen offset:1536 sc1
    s_waitcnt vmcnt(0)
    v_max3_u32 v2, v16, v18, v20
    v_max_u32 v2, v2, v22
    v_cmp_eq_u32 vcc, -1, v2
    s_cbranch_vccz aw_att_77
    s_cmp_lg_u32 s3, s2
    s_cbranch_scc1 aw_wo_76
    s_sub_u32 s77, s77, 1
    s_cbranch_scc0 aw_poll_78
    s_mov_b32 s77, 0
aw_att_77:
    s_sub_u32 s5, s5, 0x400000
    s_lshl_b32 s7, s4, 13
    buffer_load_dwordx4 v[96:99], v9, s[8:11], s5 offen offset:0 sc1
    buffer_load_dwordx4 v[100:103], v9, s[8:11], s5 offen offset:256 sc1
    buffer_load_dwordx4 v[104:107], v9, s[8:11], s5 offen offset:512 sc1
    buffer_load_dwordx4 v[108:111], v9, s[8:11], s5 offen offset:768 sc1
    buffer_load_dwordx4 v[112:115], v9, s[8:11], s5 offen offset:1024 sc1
    buffer_load_dwordx4 v[116:119], v9, s[8:11], s5 offen offset:1280 sc1
    buffer_load_dwordx4 v[120:123], v9, s[8:11], s5 offen offset:1536 sc1
    buffer_load_dwordx4 v[124:127], v9, s[8:11], s5 offen offset:1792 sc1
    s_add_u32 s4, s7, 0x0
    buffer_load_dwordx4 v[32:35], v8, s[8:11], s4 offen offset:0 sc1
    buffer_load_dwordx4 v[36:39], v8, s[8:11], s4 offen offset:1024 sc1
    buffer_load_dwordx4 v[40:43], v8, s[8:11], s4 offen offset:2048 sc1
    buffer_load_dwordx4 v[44:47], v8, s[8:11], s4 offen offset:3072 sc1
    s_add_u32 s4, s4, 4096
    buffer_load_dwordx4 v[48:51], v8, s[8:11], s4 offen offset:0 sc1
    buffer_load_dwordx4 v[52:55], v8, s[8:11], s4 offen offset:1024 sc1
    buffer_load_dwordx4 v[56:59], v8, s[8:11], s4 offen offset:2048 sc1
    buffer_load_dwordx4 v[60:63], v8, s[8:11], s4 offen offset:3072 sc1
    s_add_u32 s4, s7, 0x1000000
    buffer_load_dwordx4 v[64:67], v8, s[8:11], s4 offen offset:0 sc1
    buffer_load_dwordx4 v[68:71], v8, s[8:11], s4 offen offset:1024 sc1
    buffer_load_dwordx4 v[72:75], v8, s[8:11], s4 offen offset:2048 sc1
    buffer_load_dwordx4 v[76:79], v8, s[8:11], s4 offen offset:3072 sc1
    s_add_u32 s4, s4, 4096
    buffer_load_dwordx4 v[80:83], v8, s[8:11], s4 offen offset:0 sc1
    buffer_load_dwordx4 v[84:87], v8, s[8:11], s4 offen offset:1024 sc1
    buffer_load_dwordx4 v[88:91], v8, s[8:11], s4 offen offset:2048 sc1
    buffer_load_dwordx4 v[92:95], v8, s[8:11], s4 offen offset:3072 sc1
    s_waitcnt vmcnt(0)
    v_max3_u32 v2, v96, v100, v104
    v_max3_u32 v2, v2, v108, v112
    v_max3_u32 v2, v2, v116, v120
    v_max_u32 v2, v2, v124
    v_cmp_eq_u32 vcc, -1, v2
    s_cbranch_vccz pollkm_ok_80
pollkm_79:
    buffer_load_dwordx4 v[96:99], v9, s[8:11], s5 offen offset:0 sc1
    buffer_load_dwordx4 v[100:103], v9, s[8:11], s5 offen offset:256 sc1
    buffer_load_dwordx4 v[104:107], v9, s[8:11], s5 offen offset:512 sc1
    buffer_load_dwordx4 v[108:111], v9, s[8:11], s5 offen offset:768 sc1
    buffer_load_dwordx4 v[112:115], v9, s[8:11], s5 offen offset:1024 sc1
    buffer_load_dwordx4 v[116:119], v9, s[8:11], s5 offen offset:1280 sc1
    buffer_load_dwordx4 v[120:123], v9, s[8:11], s5 offen offset:1536 sc1
    buffer_load_dwordx4 v[124:127], v9, s[8:11], s5 offen offset:1792 sc1
    s_waitcnt vmcnt(0)
    v_max3_u32 v2, v96, v100, v104
    v_max3_u32 v2, v2, v108, v112
    v_max3_u32 v2, v2, v116, v120
    v_max_u32 v2, v2, v124
    v_cmp_eq_u32 vcc, -1, v2
    s_cbranch_vccz pollkm_ok_80
    s_sub_u32 s77, s77, 1
    s_cbranch_scc0 pollkm_79
    s_mov_b32 s77, 0
pollkm_ok_80:
    v_mfma_f32_32x32x16_bf16 v[16:31], v[96:99], v[32:35], 0
    v_mfma_f32_32x32x16_bf16 v[16:31], v[100:103], v[36:39], v[16:31]
    v_mfma_f32_32x32x16_bf16 v[16:31], v[104:107], v[40:43], v[16:31]
    v_mfma_f32_32x32x16_bf16 v[16:31], v[108:111], v[44:47], v[16:31]
    v_mfma_f32_32x32x16_bf16 v[16:31], v[112:115], v[48:51], v[16:31]
    v_mfma_f32_32x32x16_bf16 v[16:31], v[116:119], v[52:55], v[16:31]
    v_mfma_f32_32x32x16_bf16 v[16:31], v[120:123], v[56:59], v[16:31]
    v_mfma_f32_32x32x16_bf16 v[16:31], v[124:127], v[60:63], v[16:31]
    s_nop 11
    v_mov_b32 v4, v16
    v_mov_b32 v5, v17
    v_mov_b32 v6, v18
    v_mov_b32 v7, v19
    s_add_u32 s4, s7, 0x2000000
    buffer_load_dwordx4 v[96:99], v8, s[8:11], s4 offen offset:0 sc1
    buffer_load_dwordx4 v[100:103], v8, s[8:11], s4 offen offset:1024 sc1
    buffer_load_dwordx4 v[104:107], v8, s[8:11], s4 offen offset:2048 sc1
    buffer_load_dwordx4 v[108:111], v8, s[8:11], s4 offen offset:3072 sc1
    s_add_u32 s4, s4, 4096
    buffer_load_dwordx4 v[112:115], v8, s[8:11], s4 offen offset:0 sc1
    buffer_load_dwordx4 v[116:119], v8, s[8:11], s4 offen offset:1024 sc1
    buffer_load_dwordx4 v[120:123], v8, s[8:11], s4 offen offset:2048 sc1
    buffer_load_dwordx4 v[124:127], v8, s[8:11], s4 offen offset:3072 sc1
    v_mfma_f32_32x32x16_bf16 v[16:31], v[64:67], v[32:35], 0
    v_mfma_f32_32x32x16_bf16 v[16:31], v[68:71], v[36:39], v[16:31]
    v_mfma_f32_32x32x16_bf16 v[16:31], v[72:75], v[40:43], v[16:31]
    v_mfma_f32_32x32x16_bf16 v[16:31], v[76:79], v[44:47], v[16:31]
    v_mfma_f32_32x32x16_bf16 v[16:31], v[80:83], v[48:51], v[16:31]
    v_mfma_f32_32x32x16_bf16 v[16:31], v[84:87], v[52:55], v[16:31]
    v_mfma_f32_32x32x16_bf16 v[16:31], v[88:91], v[56:59], v[16:31]
    v_mfma_f32_32x32x16_bf16 v[16:31], v[92:95], v[60:63], v[16:31]
    v_mov_b32 v3, 0xff800000
    v_cmp_le_i32 vcc, 0, v15
    s_nop 9
    v_cndmask_b32 v16, v3, v16, vcc
    v_cmp_le_i32 vcc, 1, v15
    s_nop 1
    v_cndmask_b32 v17, v3, v17, vcc
    v_cmp_le_i32 vcc, 2, v15
    s_nop 1
    v_cndmask_b32 v18, v3, v18, vcc
    v_cmp_le_i32 vcc, 3, v15
    s_nop 1
    v_cndmask_b32 v19, v3, v19, vcc
    v_cmp_le_i32 vcc, 8, v15
    s_nop 1
    v_cndmask_b32 v20, v3, v20, vcc
    v_cmp_le_i32 vcc, 9, v15
    s_nop 1
    v_cndmask_b32 v21, v3, v21, vcc
    v_cmp_le_i32 vcc, 10, v15
    s_nop 1
    v_cndmask_b32 v22, v3, v22, vcc
    v_cmp_le_i32 vcc, 11, v15
    s_nop 1
    v_cndmask_b32 v23, v3, v23, vcc
    v_cmp_le_i32 vcc, 16, v15
    s_nop 1
    v_cndmask_b32 v24, v3, v24, vcc
    v_cmp_le_i32 vcc, 17, v15
    s_nop 1
    v_cndmask_b32 v25, v3, v25, vcc
    v_cmp_le_i32 vcc, 18, v15
    s_nop 1
    v_cndmask_b32 v26, v3, v26, vcc
    v_cmp_le_i32 vcc, 19, v15
    s_nop 1
    v_cndmask_b32 v27, v3, v27, vcc
    v_cmp_le_i32 vcc, 24, v15
    s_nop 1
    v_cndmask_b32 v28, v3, v28, vcc
    v_cmp_le_i32 vcc, 25, v15
    s_nop 1
    v_cndmask_b32 v29, v3, v29, vcc
    v_cmp_le_i32 vcc, 26, v15
    s_nop 1
    v_cndmask_b32 v30, v3, v30, vcc
    v_cmp_le_i32 vcc, 27, v15
    s_nop 1
    v_cndmask_b32 v31, v3, v31, vcc
    s_add_u32 s5, s5, 0x400000
    buffer_load_dwordx2 v[64:65], v10, s[8:11], s5 offen offset:0 sc1
    buffer_load_dwordx2 v[66:67], v10, s[8:11], s5 offen offset:512 sc1
    buffer_load_dwordx2 v[68:69], v10, s[8:11], s5 offen offset:1024 sc1
    buffer_load_dwordx2 v[70:71], v10, s[8:11], s5 offen offset:1536 sc1
    v_max3_f32 v2, v16, v17, v18
    v_max3_f32 v2, v2, v19, v20
    v_max3_f32 v2, v2, v21, v22
    v_max3_f32 v2, v2, v23, v24
    v_max3_f32 v2, v2, v25, v26
    v_max3_f32 v2, v2, v27, v28
    v_max3_f32 v2, v2, v29, v30
    v_max3_f32 v2, v2, v31, v4
    v_max3_f32 v2, v2, v5, v6
    v_max_f32 v2, v2, v7
    v_mov_b32 v3, v2
    s_nop 1
    v_permlane32_swap_b32 v2, v3
    v_max_f32 v2, v2, v3
    v_mul_f32 v2, s6, v2
    v_fma_f32 v16, v16, s6, -v2
    v_fma_f32 v17, v17, s6, -v2
    v_fma_f32 v18, v18, s6, -v2
    v_fma_f32 v19, v19, s6, -v2
    v_fma_f32 v20, v20, s6, -v2
    v_fma_f32 v21, v21, s6, -v2
    v_fma_f32 v22, v22, s6, -v2
    v_fma_f32 v23, v23, s6, -v2
    v_fma_f32 v24, v24, s6, -v2
    v_fma_f32 v25, v25, s6, -v2
    v_fma_f32 v26, v26, s6, -v2
    v_fma_f32 v27, v27, s6, -v2
    v_fma_f32 v28, v28, s6, -v2
    v_fma_f32 v29, v29, s6, -v2
    v_fma_f32 v30, v30, s6, -v2
    v_fma_f32 v31, v31, s6, -v2
    v_fma_f32 v4, v4, s6, -v2
    v_fma_f32 v5, v5, s6, -v2
    v_fma_f32 v6, v6, s6, -v2
    v_fma_f32 v7, v7, s6, -v2
    v_exp_f32 v16, v16
    v_exp_f32 v17, v17
    v_exp_f32 v18, v18
    v_exp_f32 v19, v19
    v_exp_f32 v20, v20
    v_exp_f32 v21, v21
    v_exp_f32 v22, v22
    v_exp_f32 v23, v23
    v_exp_f32 v24, v24
    v_exp_f32 v25, v25
    v_exp_f32 v26, v26
    v_exp_f32 v27, v27
    v_exp_f32 v28, v28
    v_exp_f32 v29, v29
    v_exp_f32 v30, v30
    v_exp_f32 v31, v31
    v_exp_f32 v4, v4
    v_exp_f32 v5, v5
    v_exp_f32 v6, v6
    v_exp_f32 v7, v7
    v_cvt_pk_bf16_f32 v32, v16, v17
    v_cvt_pk_bf16_f32 v33, v18, v19
    v_cvt_pk_bf16_f32 v34, v20, v21
    v_cvt_pk_bf16_f32 v35, v22, v23
    v_cvt_pk_bf16_f32 v36, v24, v25
    v_cvt_pk_bf16_f32 v37, v26, v27
    v_cvt_pk_bf16_f32 v38, v28, v29
    v_cvt_pk_bf16_f32 v39, v30, v31
    v_cvt_pk_bf16_f32 v40, v4, v5
    v_cvt_pk_bf16_f32 v41, v6, v7
    v_add_f32 v2, v16, v17
    v_add_f32 v2, v2, v18
    v_add_f32 v2, v2, v19
    v_add_f32 v2, v2, v20
    v_add_f32 v2, v2, v21
    v_add_f32 v2, v2, v22
    v_add_f32 v2, v2, v23
    v_add_f32 v2, v2, v24
    v_add_f32 v2, v2, v25
    v_add_f32 v2, v2, v26
    v_add_f32 v2, v2, v27
    v_add_f32 v2, v2, v28
    v_add_f32 v2, v2, v29
    v_add_f32 v2, v2, v30
    v_add_f32 v2, v2, v31
    v_add_f32 v2, v2, v4
    v_add_f32 v2, v2, v5
    v_add_f32 v2, v2, v6
    v_add_f32 v2, v2, v7
    v_mov_b32 v3, v2
    s_nop 1
    v_permlane32_swap_b32 v2, v3
    v_add_f32 v2, v2, v3
    v_rcp_f32 v2, v2
    s_waitcnt vmcnt(0)
    s_add_u32 s4, s7, 0x3000000
    v_mfma_f32_32x32x8_bf16 v[48:63], v[64:65], v[40:41], 0
    s_nop 9
    v_mfma_f32_32x32x16_bf16 v[48:63], v[96:99], v[32:35], v[48:63]
    v_mfma_f32_32x32x16_bf16 v[48:63], v[100:103], v[36:39], v[48:63]
    v_mfma_f32_32x32x8_bf16 v[80:95], v[66:67], v[40:41], 0
    s_nop 9
    v_mfma_f32_32x32x16_bf16 v[80:95], v[104:107], v[32:35], v[80:95]
    v_mfma_f32_32x32x16_bf16 v[80:95], v[108:111], v[36:39], v[80:95]
    v_mfma_f32_32x32x8_bf16 v[16:31], v[68:69], v[40:41], 0
    s_nop 9
    v_mfma_f32_32x32x16_bf16 v[16:31], v[112:115], v[32:35], v[16:31]
    v_mfma_f32_32x32x16_bf16 v[16:31], v[116:119], v[36:39], v[16:31]
    v_mul_f32 v48, v2, v48
    v_mul_f32 v49, v2, v49
    v_mul_f32 v50, v2, v50
    v_mul_f32 v51, v2, v51
    v_mul_f32 v52, v2, v52
    v_mul_f32 v53, v2, v53
    v_mul_f32 v54, v2, v54
    v_mul_f32 v55, v2, v55
    v_mul_f32 v56, v2, v56
    v_mul_f32 v57, v2, v57
    v_mul_f32 v58, v2, v58
    v_mul_f32 v59, v2, v59
    v_mul_f32 v60, v2, v60
    v_mul_f32 v61, v2, v61
    v_mul_f32 v62, v2, v62
    v_mul_f32 v63, v2, v63
    v_cvt_pk_bf16_f32 v72, v48, v49
    v_cvt_pk_bf16_f32 v73, v50, v51
    v_cvt_pk_bf16_f32 v74, v52, v53
    v_cvt_pk_bf16_f32 v75, v54, v55
    buffer_store_dwordx4 v[72:75], v8, s[8:11], s4 offen offset:0
    v_cvt_pk_bf16_f32 v76, v56, v57
    v_cvt_pk_bf16_f32 v77, v58, v59
    v_cvt_pk_bf16_f32 v78, v60, v61
    v_cvt_pk_bf16_f32 v79, v62, v63
    buffer_store_dwordx4 v[76:79], v8, s[8:11], s4 offen offset:1024
    v_mfma_f32_32x32x8_bf16 v[48:63], v[70:71], v[40:41], 0
    s_nop 9
    v_mfma_f32_32x32x16_bf16 v[48:63], v[120:123], v[32:35], v[48:63]
    v_mfma_f32_32x32x16_bf16 v[48:63], v[124:127], v[36:39], v[48:63]
    v_mul_f32 v80, v2, v80
    v_mul_f32 v81, v2, v81
    v_mul_f32 v82, v2, v82
    v_mul_f32 v83, v2, v83
    v_mul_f32 v84, v2, v84
    v_mul_f32 v85, v2, v85
    v_mul_f32 v86, v2, v86
    v_mul_f32 v87, v2, v87
    v_mul_f32 v88, v2, v88
    v_mul_f32 v89, v2, v89
    v_mul_f32 v90, v2, v90
    v_mul_f32 v91, v2, v91
    v_mul_f32 v92, v2, v92
    v_mul_f32 v93, v2, v93
    v_mul_f32 v94, v2, v94
    v_mul_f32 v95, v2, v95
    v_cvt_pk_bf16_f32 v72, v80, v81
    v_cvt_pk_bf16_f32 v73, v82, v83
    v_cvt_pk_bf16_f32 v74, v84, v85
    v_cvt_pk_bf16_f32 v75, v86, v87
    buffer_store_dwordx4 v[72:75], v8, s[8:11], s4 offen offset:2048
    v_cvt_pk_bf16_f32 v76, v88, v89
    v_cvt_pk_bf16_f32 v77, v90, v91
    v_cvt_pk_bf16_f32 v78, v92, v93
    v_cvt_pk_bf16_f32 v79, v94, v95
    buffer_store_dwordx4 v[76:79], v8, s[8:11], s4 offen offset:3072
    s_add_u32 s4, s4, 4096
    v_mul_f32 v16, v2, v16
    v_mul_f32 v17, v2, v17
    v_mul_f32 v18, v2, v18
    v_mul_f32 v19, v2, v19
    v_mul_f32 v20, v2, v20
    v_mul_f32 v21, v2, v21
    v_mul_f32 v22, v2, v22
    v_mul_f32 v23, v2, v23
    v_mul_f32 v24, v2, v24
    v_mul_f32 v25, v2, v25
    v_mul_f32 v26, v2, v26
    v_mul_f32 v27, v2, v27
    v_mul_f32 v28, v2, v28
    v_mul_f32 v29, v2, v29
    v_mul_f32 v30, v2, v30
    v_mul_f32 v31, v2, v31
    v_cvt_pk_bf16_f32 v72, v16, v17
    v_cvt_pk_bf16_f32 v73, v18, v19
    v_cvt_pk_bf16_f32 v74, v20, v21
    v_cvt_pk_bf16_f32 v75, v22, v23
    buffer_store_dwordx4 v[72:75], v8, s[8:11], s4 offen offset:0
    v_cvt_pk_bf16_f32 v76, v24, v25
    v_cvt_pk_bf16_f32 v77, v26, v27
    v_cvt_pk_bf16_f32 v78, v28, v29
    v_cvt_pk_bf16_f32 v79, v30, v31
    buffer_store_dwordx4 v[76:79], v8, s[8:11], s4 offen offset:1024
    v_mul_f32 v48, v2, v48
    v_mul_f32 v49, v2, v49
    v_mul_f32 v50, v2, v50
    v_mul_f32 v51, v2, v51
    v_mul_f32 v52, v2, v52
    v_mul_f32 v53, v2, v53
    v_mul_f32 v54, v2, v54
    v_mul_f32 v55, v2, v55
    v_mul_f32 v56, v2, v56
    v_mul_f32 v57, v2, v57
    v_mul_f32 v58, v2, v58
    v_mul_f32 v59, v2, v59
    v_mul_f32 v60, v2, v60
    v_mul_f32 v61, v2, v61
    v_mul_f32 v62, v2, v62
    v_mul_f32 v63, v2, v63
    v_cvt_pk_bf16_f32 v72, v48, v49
    v_cvt_pk_bf16_f32 v73, v50, v51
    v_cvt_pk_bf16_f32 v74, v52, v53
    v_cvt_pk_bf16_f32 v75, v54, v55
    buffer_store_dwordx4 v[72:75], v8, s[8:11], s4 offen offset:2048
    v_cvt_pk_bf16_f32 v76, v56, v57
    v_cvt_pk_bf16_f32 v77, v58, v59
    v_cvt_pk_bf16_f32 v78, v60, v61
    v_cvt_pk_bf16_f32 v79, v62, v63
    buffer_store_dwordx4 v[76:79], v8, s[8:11], s4 offen offset:3072
    s_lshr_b32 s4, s7, 11
    s_add_u32 s4, s4, 0x5100000
    v_mov_b32 v2, 1
    v_mov_b32 v3, 0
    s_waitcnt vmcnt(0)
    buffer_store_dword v2, v3, s[8:11], s4 offen
    s_add_u32 s3, s3, 8
aw_wo_76:
    s_lshl_b32 s4, s2, 2
    s_add_u32 s4, s4, s75
    s_lshl_b32 s5, s4, 7
    s_add_u32 s5, s5, 0x5100000
pollfl_81:
    buffer_load_dwordx4 v[4:7], v11, s[8:11], s5 offen sc1
    s_waitcnt vmcnt(0)
    v_min3_u32 v2, v4, v5, v6
    v_min_u32 v2, v2, v7
    v_cmp_eq_u32 vcc, 0, v2
    s_cbranch_vccz pollfl_ok_82
    s_sub_u32 s77, s77, 1
    s_cbranch_scc0 pollfl_81
    s_mov_b32 s77, 0
pollfl_ok_82:
    s_lshl_b32 s7, s4, 18
    s_lshl_b32 s5, s58, 15
    s_add_u32 s7, s7, s5
    s_add_u32 s7, s7, 0x3000000
    buffer_load_dwordx4 v[32:35], v8, s[8:11], s7 offen offset:0 sc1
    buffer_load_dwordx4 v[36:39], v8, s[8:11], s7 offen offset:1024 sc1
    buffer_load_dwordx4 v[40:43], v8, s[8:11], s7 offen offset:2048 sc1
    buffer_load_dwordx4 v[44:47], v8, s[8:11], s7 offen offset:3072 sc1
    s_add_u32 s7, s7, 4096
    buffer_load_dwordx4 v[48:51], v8, s[8:11], s7 offen offset:0 sc1
    buffer_load_dwordx4 v[52:55], v8, s[8:11], s7 offen offset:1024 sc1
    buffer_load_dwordx4 v[56:59], v8, s[8:11], s7 offen offset:2048 sc1
    buffer_load_dwordx4 v[60:63], v8, s[8:11], s7 offen offset:3072 sc1
    s_add_u32 s7, s7, 4096
    buffer_load_dwordx4 v[64:67], v8, s[8:11], s7 offen offset:0 sc1
    buffer_load_dwordx4 v[68:71], v8, s[8:11], s7 offen offset:1024 sc1
    buffer_load_dwordx4 v[72:75], v8, s[8:11], s7 offen offset:2048 sc1
    buffer_load_dwordx4 v[76:79], v8, s[8:11], s7 offen offset:3072 sc1
    s_add_u32 s7, s7, 4096
    buffer_load_dwordx4 v[80:83], v8, s[8:11], s7 offen offset:0 sc1
    buffer_load_dwordx4 v[84:87], v8, s[8:11], s7 offen offset:1024 sc1
    buffer_load_dwordx4 v[88:91], v8, s[8:11], s7 offen offset:2048 sc1
    buffer_load_dwordx4 v[92:95], v8, s[8:11], s7 offen offset:3072 sc1
    s_add_u32 s7, s7, 4096
    buffer_load_dwordx4 v[96:99], v8, s[8:11], s7 offen offset:0 sc1
    buffer_load_dwordx4 v[100:103], v8, s[8:11], s7 offen offset:1024 sc1
    buffer_load_dwordx4 v[104:107], v8, s[8:11], s7 offen offset:2048 sc1
    buffer_load_dwordx4 v[108:111], v8, s[8:11], s7 offen offset:3072 sc1
    s_add_u32 s7, s7, 4096
    buffer_load_dwordx4 v[112:115], v8, s[8:11], s7 offen offset:0 sc1
    buffer_load_dwordx4 v[116:119], v8, s[8:11], s7 offen offset:1024 sc1
    buffer_load_dwordx4 v[120:123], v8, s[8:11], s7 offen offset:2048 sc1
    buffer_load_dwordx4 v[124:127], v8, s[8:11], s7 offen offset:3072 sc1
    s_waitcnt vmcnt(23)
    v_mfma_f32_32x32x16_bf16 v[16:31], v[128:131], v[32:35], 0
    s_waitcnt vmcnt(22)
    v_mfma_f32_32x32x16_bf16 v[16:31], v[132:135], v[36:39], v[16:31]
    s_add_u32 s7, s7, 4096
    buffer_load_dwordx4 v[32:35], v8, s[8:11], s7 offen offset:0 sc1
    s_waitcnt vmcnt(22)
    v_mfma_f32_32x32x16_bf16 v[16:31], v[136:139], v[40:43], v[16:31]
    buffer_load_dwordx4 v[36:39], v8, s[8:11], s7 offen offset:1024 sc1
    s_waitcnt vmcnt(22)
    v_mfma_f32_32x32x16_bf16 v[16:31], v[140:143], v[44:47], v[16:31]
    buffer_load_dwordx4 v[40:43], v8, s[8:11], s7 offen offset:2048 sc1
    s_waitcnt vmcnt(22)
    v_mfma_f32_32x32x16_bf16 v[16:31], v[144:147], v[48:51], v[16:31]
    buffer_load_dwordx4 v[44:47], v8, s[8:11], s7 offen offset:3072 sc1
    s_waitcnt vmcnt(22)
    v_mfma_f32_32x32x16_bf16 v[16:31], v[148:151], v[52:55], v[16:31]
    s_add_u32 s7, s7, 4096
    buffer_load_dwordx4 v[48:51], v8, s[8:11], s7 offen offset:0 sc1
    s_waitcnt vmcnt(22)
    v_mfma_f32_32x32x16_bf16 v[16:31], v[152:155], v[56:59], v[16:31]
    buffer_load_dwordx4 v[52:55], v8, s[8:11], s7 offen offset:1024 sc1
    s_waitcnt vmcnt(22)
    v_mfma_f32_32x32x16_bf16 v[16:31], v[156:159], v[60:63], v[16:31]
    buffer_load_dwordx4 v[56:59], v8, s[8:11], s7 offen offset:2048 sc1
    s_waitcnt vmcnt(22)
    v_mfma_f32_32x32x16_bf16 v[16:31], v[160:163], v[64:67], v[16:31]
    buffer_load_dwordx4 v[60:63], v8, s[8:11], s7 offen offset:3072 sc1
    s_waitcnt vmcnt(22)
    v_mfma_f32_32x32x16_bf16 v[16:31], v[164:167], v[68:71], v[16:31]
    s_waitcnt vmcnt(21)
    v_mfma_f32_32x32x16_bf16 v[16:31], v[168:171], v[72:75], v[16:31]
    s_waitcnt vmcnt(20)
    v_mfma_f32_32x32x16_bf16 v[16:31], v[172:175], v[76:79], v[16:31]
    s_waitcnt vmcnt(19)
    v_mfma_f32_32x32x16_bf16 v[16:31], v[176:179], v[80:83], v[16:31]
    s_waitcnt vmcnt(18)
    v_mfma_f32_32x32x16_bf16 v[16:31], v[180:183], v[84:87], v[16:31]
    s_waitcnt vmcnt(17)
    v_mfma_f32_32x32x16_bf16 v[16:31], v[184:187], v[88:91], v[16:31]
    s_waitcnt vmcnt(16)
    v_mfma_f32_32x32x16_bf16 v[16:31], v[188:191], v[92:95], v[16:31]
    s_waitcnt vmcnt(15)
    v_mfma_f32_32x32x16_bf16 v[16:31], v[192:195], v[96:99], v[16:31]
    s_waitcnt vmcnt(14)
    v_mfma_f32_32x32x16_bf16 v[16:31], v[196:199], v[100:103], v[16:31]
    s_waitcnt vmcnt(13)
    v_mfma_f32_32x32x16_bf16 v[16:31], v[200:203], v[104:107], v[16:31]
    s_waitcnt vmcnt(12)
    v_mfma_f32_32x32x16_bf16 v[16:31], v[204:207], v[108:111], v[16:31]
    s_waitcnt vmcnt(11)
    v_mfma_f32_32x32x16_bf16 v[16:31], v[208:211], v[112:115], v[16:31]
    s_waitcnt vmcnt(10)
    v_mfma_f32_32x32x16_bf16 v[16:31], v[212:215], v[116:119], v[16:31]
    s_waitcnt vmcnt(9)
    v_mfma_f32_32x32x16_bf16 v[16:31], v[216:219], v[120:123], v[16:31]
    s_waitcnt vmcnt(8)
    v_mfma_f32_32x32x16_bf16 v[16:31], v[220:223], v[124:127], v[16:31]
    s_waitcnt vmcnt(7)
    v_mfma_f32_32x32x16_bf16 v[16:31], v[224:227], v[32:35], v[16:31]
    s_waitcnt vmcnt(6)
    v_mfma_f32_32x32x16_bf16 v[16:31], v[228:231], v[36:39], v[16:31]
    s_waitcnt vmcnt(5)
    v_mfma_f32_32x32x16_bf16 v[16:31], v[232:235], v[40:43], v[16:31]
    s_waitcnt vmcnt(4)
    v_mfma_f32_32x32x16_bf16 v[16:31], v[236:239], v[44:47], v[16:31]
    s_waitcnt vmcnt(3)
    v_mfma_f32_32x32x16_bf16 v[16:31], v[240:243], v[48:51], v[16:31]
    s_waitcnt vmcnt(2)
    v_mfma_f32_32x32x16_bf16 v[16:31], v[244:247], v[52:55], v[16:31]
    s_waitcnt vmcnt(1)
    v_mfma_f32_32x32x16_bf16 v[16:31], v[248:251], v[56:59], v[16:31]
    s_waitcnt vmcnt(0)
    v_mfma_f32_32x32x16_bf16 v[16:31], v[252:255], v[60:63], v[16:31]
    s_and_b32 s5, s2, 1
    s_lshl_b32 s5, s5, 15
    v_add_u32 v2, s5, v12
    v_add_u32 v3, s5, v13
    s_nop 7
    ds_write_b128 v2, v[16:19] offset:0
    ds_write_b128 v2, v[20:23] offset:1024
    ds_write_b128 v2, v[24:27] offset:2048
    ds_write_b128 v2, v[28:31] offset:3072
    s_waitcnt lgkmcnt(0)
    s_barrier
    ds_read_b64 v[16:17], v3 offset:0
    ds_read_b64 v[18:19], v3 offset:4096
    ds_read_b64 v[20:21], v3 offset:8192
    ds_read_b64 v[22:23], v3 offset:12288
    ds_read_b64 v[24:25], v3 offset:16384
    ds_read_b64 v[26:27], v3 offset:20480
    ds_read_b64 v[28:29], v3 offset:24576
    ds_read_b64 v[30:31], v3 offset:28672
    s_lshl_b32 s4, s4, 17
    s_waitcnt lgkmcnt(0)
    v_pk_add_f32 v[16:17], v[16:17], v[24:25]
    v_pk_add_f32 v[18:19], v[18:19], v[26:27]
    v_pk_add_f32 v[20:21], v[20:21], v[28:29]
    v_pk_add_f32 v[22:23], v[22:23], v[30:31]
    v_pk_add_f32 v[16:17], v[16:17], v[20:21]
    v_pk_add_f32 v[18:19], v[18:19], v[22:23]
    v_pk_add_f32 v[16:17], v[16:17], v[18:19]
    v_cvt_pk_bf16_f32 v2, v16, v17
    buffer_store_dword v2, v14, s[16:19], s4 offen
    s_add_u32 s2, s2, 1
    s_cmp_lt_u32 s2, 16
    s_cbranch_scc1 aw_loop_75
    s_waitcnt vmcnt(0)
    s_endpgm
.section .rodata,"a"
.p2align 6
.amdhsa_kernel concat_heads__spectral_gfnet__memory_aug_recurrent_mem_tr__prompt_kernel
  .amdhsa_next_free_vgpr 256
  .amdhsa_next_free_sgpr 102
  .amdhsa_accum_offset 256
  .amdhsa_group_segment_fixed_size 0
  .amdhsa_kernarg_size 104
  .amdhsa_user_sgpr_count 2
  .amdhsa_user_sgpr_kernarg_segment_ptr 1
  .amdhsa_system_sgpr_workgroup_id_x 1
  .amdhsa_float_denorm_mode_32 3
  .amdhsa_float_denorm_mode_16_64 3
.end_amdhsa_kernel
```

```asm
; @launch grid=(256,1,1) block=(512,1,1) lds=163840
.amdgcn_target "amdgcn-amd-amdhsa--gfx950"
.text
.globl concat_heads__spectral_gfnet__memory_aug_recurrent_mem_tr__prompt_kernel
.p2align 8
.type concat_heads__spectral_gfnet__memory_aug_recurrent_mem_tr__prompt_kernel,@function
concat_heads__spectral_gfnet__memory_aug_recurrent_mem_tr__prompt_kernel:
    s_load_dwordx2 s[8:9], s[0:1], 96
    s_load_dwordx2 s[12:13], s[0:1], 88
    s_load_dwordx2 s[16:17], s[0:1], 80
    s_load_dwordx2 s[20:21], s[0:1], 40
    s_load_dwordx2 s[24:25], s[0:1], 48
    s_load_dwordx2 s[28:29], s[0:1], 56
    s_load_dwordx2 s[32:33], s[0:1], 64
    s_load_dwordx2 s[36:37], s[0:1], 24
    s_load_dwordx2 s[40:41], s[0:1], 32
    s_load_dwordx2 s[44:45], s[0:1], 0
    s_load_dwordx2 s[48:49], s[0:1], 8
    s_load_dwordx2 s[52:53], s[0:1], 16
    s_mov_b32 s10, 0x10000000
    s_mov_b32 s11, 0x20000
    s_mov_b32 s14, 0x100
    s_mov_b32 s15, 0x20000
    s_mov_b32 s18, 0x800000
    s_mov_b32 s19, 0x20000
    s_mov_b32 s22, 0x800000
    s_mov_b32 s23, 0x20000
    s_mov_b32 s26, 0x800000
    s_mov_b32 s27, 0x20000
    s_mov_b32 s30, 0x800000
    s_mov_b32 s31, 0x20000
    s_mov_b32 s34, 0x800000
    s_mov_b32 s35, 0x20000
    s_mov_b32 s38, 0x400000
    s_mov_b32 s39, 0x20000
    s_mov_b32 s42, 0x4000
    s_mov_b32 s43, 0x20000
    s_mov_b32 s46, 0x400000
    s_mov_b32 s47, 0x20000
    s_mov_b32 s50, 0x201000
    s_mov_b32 s51, 0x20000
    s_mov_b32 s54, 0x201000
    s_mov_b32 s55, 0x20000
    s_waitcnt lgkmcnt(0)
    s_getreg_b32 s56, hwreg(HW_REG_XCC_ID, 0, 3)
    v_lshrrev_b32 v2, 6, v0
    v_and_b32 v1, 63, v0
    v_readfirstlane_b32 s58, v2
    s_nop 0
    s_cmp_lg_u32 s58, 0
    s_cbranch_scc1 notw0_1
    s_lshl_b32 s57, s56, 5
    s_add_u32 s57, s57, 28
    v_mov_b32 v2, s57
    v_mov_b32 v3, 0x5ffffff0
    v_cmp_eq_u32 vcc, 0, v1
    s_nop 1
    v_cndmask_b32 v2, v3, v2, vcc
    v_mov_b32 v3, 1
    buffer_atomic_add v3, v2, s[12:15], 0 offen sc0 sc1
    v_mov_b32 v4, 0x27ff0
    s_waitcnt vmcnt(0)
    v_readfirstlane_b32 s3, v3
    s_nop 1
    v_mov_b32 v3, s3
    ds_write_b32 v4, v3
    s_waitcnt lgkmcnt(0)
notw0_1:
    s_barrier
    v_mov_b32 v4, 0x27ff0
    ds_read_b32 v3, v4
    s_waitcnt lgkmcnt(0)
    v_readfirstlane_b32 s57, v3
    s_nop 0
    s_cmp_lt_u32 s57, 32
    s_cbranch_scc1 go_3
    s_endpgm
go_3:
    s_cmp_ge_u32 s56, 4
    s_cbranch_scc1 bulk_2
    s_and_b32 s64, s57, 3
    s_lshr_b32 s65, s57, 2
    s_lshl_b32 s66, s56, 3
    s_add_u32 s66, s66, s65
    s_and_b32 s67, s58, 3
    s_mov_b32 s69, 0x40000
    v_and_b32 v6, 15, v1
    v_lshrrev_b32 v7, 4, v1
    v_lshlrev_b32 v8, 4, v1
    v_mov_b32 v34, -1
    v_mov_b32 v35, -1
    v_mov_b32 v36, -1
    v_mov_b32 v37, -1
    s_mov_b32 s86, 0
    s_mov_b32 s87, 0
    s_mov_b32 s88, 0
    s_mov_b32 s89, 0
    s_mov_b32 s90, 0
    s_mov_b32 s91, 0
    s_mov_b32 s92, 0
    s_mov_b32 s93, 0
    s_mov_b32 s94, 0
    s_mov_b32 s95, 0
    s_mov_b32 s96, 0
    s_mov_b32 s97, 0
    s_mov_b32 s98, 0
    v_and_b32 v2, 1, v1
    v_lshlrev_b32 v2, 4, v2
    v_mov_b32 v3, 0x3f80
    v_lshlrev_b32 v2, v2, v3
    v_lshrrev_b32 v3, 1, v6
    v_cmp_eq_u32 vcc, 0, v3
    s_nop 1
    v_cndmask_b32 v26, 0, v2, vcc
    v_cmp_eq_u32 vcc, 1, v3
    s_nop 1
    v_cndmask_b32 v27, 0, v2, vcc
    v_cmp_eq_u32 vcc, 2, v3
    s_nop 1
    v_cndmask_b32 v28, 0, v2, vcc
    v_cmp_eq_u32 vcc, 3, v3
    s_nop 1
    v_cndmask_b32 v29, 0, v2, vcc
    v_cmp_eq_u32 vcc, 4, v3
    s_nop 1
    v_cndmask_b32 v30, 0, v2, vcc
    v_cmp_eq_u32 vcc, 5, v3
    s_nop 1
    v_cndmask_b32 v31, 0, v2, vcc
    v_cmp_eq_u32 vcc, 6, v3
    s_nop 1
    v_cndmask_b32 v32, 0, v2, vcc
    v_cmp_eq_u32 vcc, 7, v3
    s_nop 1
    v_cndmask_b32 v33, 0, v2, vcc
    v_bfe_u32 v9, v1, 0, 4
    v_lshlrev_b32 v9, 4, v9
    v_bfe_u32 v2, v1, 4, 1
    v_lshl_or_b32 v9, v2, 3, v9
    v_bfe_u32 v2, v1, 5, 1
    v_lshl_or_b32 v9, v2, 8, v9
    s_lshl_b32 s70, s58, 9
    v_add_u32 v9, s70, v9
    v_mov_b32 v5, 0x5ffffff0
    v_bfe_u32 v3, v1, 0, 3
    v_lshlrev_b32 v3, 4, v3
    v_bfe_u32 v2, v1, 4, 1
    v_lshl_or_b32 v3, v2, 3, v3
    v_and_b32 v2, 0x28, v1
    v_cmp_eq_u32 vcc, 0, v2
    s_nop 1
    v_cndmask_b32 v47, v5, v3, vcc
    v_bfe_u32 v3, v1, 0, 4
    v_lshlrev_b32 v3, 4, v3
    v_bfe_u32 v2, v1, 4, 2
    v_lshl_or_b32 v3, v2, 10, v3
    v_cmp_gt_u32 vcc, 8, v6
    s_nop 1
    v_cndmask_b32 v48, v5, v3, vcc
    s_lshl_b32 s70, s56, 2
    s_add_u32 s70, s70, s64
    s_lshl_b32 s70, s70, 15
    s_add_u32 s70, s70, 0x4a00000
    s_lshl_b32 s71, s65, 2
    s_add_u32 s71, s71, s67
    s_lshl_b32 s72, s71, 10
    s_add_u32 s79, s70, s72
    s_lshl_b32 s72, s67, 13
    s_add_u32 s80, s70, s72
    s_lshl_b32 s72, s65, 7
    s_add_u32 s80, s80, s72
    s_bfe_u32 s78, s71, 0x30000
    s_lshl_b32 s78, s78, 10
    s_bfe_u32 s72, s71, 0x10003
    s_lshl_b32 s72, s72, 14
    s_or_b32 s78, s78, s72
    s_bfe_u32 s72, s71, 0x10004
    s_lshl_b32 s72, s72, 7
    s_or_b32 s78, s78, s72
    s_lshl_b32 s72, s56, 8
    s_add_u32 s78, s78, s72
    s_bfe_u32 s77, s58, 0x20000
    s_lshl_b32 s77, s77, 11
    s_bfe_u32 s72, s58, 0x10002
    s_lshl_b32 s72, s72, 14
    s_or_b32 s77, s77, s72
    s_lshl_b32 s72, s64, 15
    s_add_u32 s72, s72, 0x20000
    s_add_u32 s78, s78, s72
    s_add_u32 s77, s77, s72
    s_sub_u32 s7, 0, s8
    s_and_b32 s7, s7, 0x1fffff
    s_add_u32 s7, s7, 0x4c00000
    v_add_u32 v49, s7, v8
    v_add_u32 v47, s7, v47
    s_lshl_b32 s70, s66, 2
    s_add_u32 s70, s70, s67
    s_lshl_b32 s75, s70, 11
    s_add_u32 s75, s75, 0x4900000
    s_cmp_ge_u32 s58, 4
    s_cbranch_scc1 vo_arm_4
    s_lshl_b32 s73, s70, 12
    s_add_u32 s73, s73, 0x4800000
    v_bfe_u32 v46, v1, 0, 4
    v_lshlrev_b32 v46, 4, v46
    v_bfe_u32 v2, v1, 4, 2
    v_lshl_or_b32 v46, v2, 10, v46
    s_lshl_b32 s71, s64, 8
    v_add_u32 v46, s71, v46
    s_add_u32 s71, s73, 0x80000
    buffer_store_dwordx4 v[34:37], v46, s[8:11], s73 offen
    buffer_store_dwordx4 v[34:37], v46, s[8:11], s71 offen
    v_bfe_u32 v2, v1, 0, 3
    v_lshlrev_b32 v2, 4, v2
    v_bfe_u32 v3, v1, 3, 1
    v_lshl_or_b32 v2, v3, 13, v2
    v_bfe_u32 v3, v1, 4, 2
    v_lshl_or_b32 v2, v3, 17, v2
    v_add_u32 v2, s7, v2
    buffer_store_dwordx4 v[34:37], v2, s[8:11], s78 offen sc1
    s_add_u32 s78, s78, 0x80000
    v_cmp_gt_u32 vcc, 8, v1
    s_nop 1
    v_cndmask_b32 v47, v5, v49, vcc
    s_branch arm_done_5
vo_arm_4:
    s_mov_b32 s73, s75
    v_bfe_u32 v46, v1, 0, 4
    v_lshlrev_b32 v46, 4, v46
    v_bfe_u32 v2, v1, 4, 1
    v_lshl_or_b32 v46, v2, 8, v46
    v_bfe_u32 v2, v1, 5, 1
    v_lshl_or_b32 v46, v2, 10, v46
    s_bfe_u32 s71, s64, 0x10000
    s_lshl_b32 s71, s71, 3
    s_bfe_u32 s72, s64, 0x10001
    s_lshl_b32 s72, s72, 9
    s_or_b32 s71, s71, s72
    v_add_u32 v46, s71, v46
    s_add_u32 s71, s73, 0x40000
    buffer_store_dwordx2 v[34:35], v46, s[8:11], s73 offen
    buffer_store_dwordx2 v[34:35], v46, s[8:11], s71 offen
    s_add_u32 s71, s80, 0x0
    buffer_store_dwordx4 v[34:37], v48, s[8:11], s71 offen
    s_add_u32 s71, s80, 0x1000
    buffer_store_dwordx4 v[34:37], v48, s[8:11], s71 offen
    s_add_u32 s71, s80, 0x80000
    buffer_store_dwordx4 v[34:37], v48, s[8:11], s71 offen
    s_add_u32 s71, s80, 0x81000
    buffer_store_dwordx4 v[34:37], v48, s[8:11], s71 offen
    s_lshl_b32 s71, s56, 5
    s_add_u32 s71, s71, s57
    s_bfe_u32 s2, s71, 0x40000
    s_lshl_b32 s2, s2, 9
    s_bfe_u32 s72, s71, 0x30004
    s_lshl_b32 s72, s72, 14
    s_or_b32 s2, s2, s72
    s_add_u32 s2, s2, s7
    s_add_u32 s2, s2, 0x100000
    v_bfe_u32 v2, v1, 0, 2
    v_lshlrev_b32 v2, 7, v2
    v_bfe_u32 v3, v1, 2, 1
    v_lshl_or_b32 v2, v3, 13, v2
    s_cmp_lg_u32 s58, 4
    s_cbranch_scc1 arm_done_5
    buffer_store_dword v34, v2, s[8:11], s2 offen sc1
arm_done_5:
    v_bfe_u32 v2, v1, 0, 3
    v_lshlrev_b32 v2, 11, v2
    v_bfe_u32 v3, v1, 3, 1
    v_lshl_or_b32 v2, v3, 8, v2
    v_bfe_u32 v3, v1, 4, 1
    v_lshl_or_b32 v2, v3, 3, v2
    v_bfe_u32 v3, v1, 5, 1
    v_lshl_or_b32 v2, v3, 4, v2
    s_lshl_b32 s70, s64, 9
    s_lshl_b32 s71, s58, 5
    s_add_u32 s70, s70, s71
    buffer_load_dwordx2 v[42:43], v2, s[40:43], s70 offen
    v_bfe_u32 v2, v1, 4, 1
    v_bfe_u32 v3, v1, 5, 1
    v_lshl_or_b32 v2, v3, 2, v2
    v_xor_b32 v2, v2, v6
    v_lshlrev_b32 v2, 4, v2
    v_lshl_add_u32 v50, v7, 13, v2
    v_xor_b32 v51, 0x80, v50
    v_lshrrev_b32 v3, 5, v1
    v_and_b32 v2, 31, v1
    v_lshlrev_b32 v4, 1, v3
    v_xor_b32 v2, v2, v4
    v_lshlrev_b32 v2, 4, v2
    v_lshl_add_u32 v52, v3, 11, v2
    v_bfe_u32 v4, v1, 2, 1
    v_lshlrev_b32 v4, 4, v4
    v_bfe_u32 v2, v1, 3, 1
    v_lshl_or_b32 v4, v2, 6, v4
    v_bfe_u32 v2, v1, 4, 1
    v_lshl_or_b32 v4, v2, 7, v4
    v_bfe_u32 v2, v1, 2, 2
    v_lshl_or_b32 v4, v2, 8, v4
    v_bfe_u32 v2, v1, 4, 2
    v_lshl_or_b32 v4, v2, 11, v4
    s_lshl_b32 s71, s67, 6
    v_xor_b32 v4, s71, v4
    v_bfe_u32 v3, v1, 0, 1
    v_lshlrev_b32 v3, 5, v3
    v_bfe_u32 v2, v1, 1, 1
    v_lshl_or_b32 v3, v2, 4, v3
    v_xor_b32 v53, v3, v4
    v_bfe_u32 v3, v1, 0, 1
    v_lshlrev_b32 v3, 3, v3
    v_bfe_u32 v2, v1, 1, 1
    v_lshl_or_b32 v3, v2, 5, v3
    v_xor_b32 v54, v3, v4
    v_bfe_u32 v4, v1, 2, 3
    v_lshlrev_b32 v4, 5, v4
    v_bfe_u32 v2, v1, 2, 3
    v_lshl_or_b32 v4, v2, 9, v4
    v_bfe_u32 v2, v1, 5, 1
    v_lshl_or_b32 v4, v2, 13, v4
    v_bfe_u32 v3, v1, 0, 2
    v_lshlrev_b32 v3, 4, v3
    v_xor_b32 v4, v3, v4
    s_lshl_b32 s71, s67, 7
    s_or_b32 s71, s71, 0x10000
    v_xor_b32 v55, s71, v4
    s_lshl_b32 s70, s64, 21
    s_lshl_b32 s71, s58, 18
    s_add_u32 s70, s70, s71
    s_lshl_b32 s71, s66, 8
    s_add_u32 s70, s70, s71
    s_lshl_b32 s71, s58, 13
    s_add_u32 s71, s71, 0
    s_mov_b32 m0, s71
    s_nop 0
    buffer_load_dwordx4 v50, s[24:27], s70 offen  lds
    s_add_u32 s70, s70, 0x8000
    s_add_u32 s71, s71, 0x400
    s_mov_b32 m0, s71
    s_nop 0
    buffer_load_dwordx4 v50, s[24:27], s70 offen  lds
    s_add_u32 s70, s70, 0x8000
    s_add_u32 s71, s71, 0x400
    s_mov_b32 m0, s71
    s_nop 0
    buffer_load_dwordx4 v51, s[24:27], s70 offen  lds
    s_add_u32 s70, s70, 0x8000
    s_add_u32 s71, s71, 0x400
    s_mov_b32 m0, s71
    s_nop 0
    buffer_load_dwordx4 v51, s[24:27], s70 offen  lds
    s_add_u32 s70, s70, 0x8000
    s_add_u32 s71, s71, 0x400
    s_mov_b32 m0, s71
    s_nop 0
    buffer_load_dwordx4 v50, s[24:27], s70 offen  lds
    s_add_u32 s70, s70, 0x8000
    s_add_u32 s71, s71, 0x400
    s_mov_b32 m0, s71
    s_nop 0
    buffer_load_dwordx4 v50, s[24:27], s70 offen  lds
    s_add_u32 s70, s70, 0x8000
    s_add_u32 s71, s71, 0x400
    s_mov_b32 m0, s71
    s_nop 0
    buffer_load_dwordx4 v51, s[24:27], s70 offen  lds
    s_add_u32 s70, s70, 0x8000
    s_add_u32 s71, s71, 0x400
    s_mov_b32 m0, s71
    s_nop 0
    buffer_load_dwordx4 v51, s[24:27], s70 offen  lds
    s_add_u32 s70, s70, 0x8000
    s_add_u32 s71, s71, 0x400
    s_lshl_b32 s70, s64, 21
    s_lshl_b32 s71, s58, 18
    s_add_u32 s70, s70, s71
    s_lshl_b32 s71, s66, 8
    s_add_u32 s70, s70, s71
    s_lshl_b32 s71, s58, 13
    s_add_u32 s71, s71, 65536
    s_mov_b32 m0, s71
    s_nop 0
    buffer_load_dwordx4 v50, s[28:31], s70 offen  lds
    s_add_u32 s70, s70, 0x8000
    s_add_u32 s71, s71, 0x400
    s_mov_b32 m0, s71
    s_nop 0
    buffer_load_dwordx4 v50, s[28:31], s70 offen  lds
    s_add_u32 s70, s70, 0x8000
    s_add_u32 s71, s71, 0x400
    s_mov_b32 m0, s71
    s_nop 0
    buffer_load_dwordx4 v51, s[28:31], s70 offen  lds
    s_add_u32 s70, s70, 0x8000
    s_add_u32 s71, s71, 0x400
    s_mov_b32 m0, s71
    s_nop 0
    buffer_load_dwordx4 v51, s[28:31], s70 offen  lds
    s_add_u32 s70, s70, 0x8000
    s_add_u32 s71, s71, 0x400
    s_mov_b32 m0, s71
    s_nop 0
    buffer_load_dwordx4 v50, s[28:31], s70 offen  lds
    s_add_u32 s70, s70, 0x8000
    s_add_u32 s71, s71, 0x400
    s_mov_b32 m0, s71
    s_nop 0
    buffer_load_dwordx4 v50, s[28:31], s70 offen  lds
    s_add_u32 s70, s70, 0x8000
    s_add_u32 s71, s71, 0x400
    s_mov_b32 m0, s71
    s_nop 0
    buffer_load_dwordx4 v51, s[28:31], s70 offen  lds
    s_add_u32 s70, s70, 0x8000
    s_add_u32 s71, s71, 0x400
    s_mov_b32 m0, s71
    s_nop 0
    buffer_load_dwordx4 v51, s[28:31], s70 offen  lds
    s_add_u32 s70, s70, 0x8000
    s_add_u32 s71, s71, 0x400
    s_cmp_lg_u32 s58, 4
    s_cbranch_scc1 novote_6
    s_waitcnt vmcnt(16)
    s_mov_b32 s3, 4
    s_add_u32 s70, s2, 0
    s_add_u32 s71, s2, 8192
    s_mov_b64 s[4:5], 0
    s_buffer_load_dword s4, s[8:11], s70
    s_buffer_load_dword s5, s[8:11], s71
    s_waitcnt lgkmcnt(1)
    s_sub_u32 s72, s4, s5
    s_add_u32 s3, s3, s72
    s_waitcnt lgkmcnt(0)
    s_add_u32 s70, s2, 128
    s_add_u32 s71, s2, 8320
    s_mov_b64 s[4:5], 0
    s_buffer_load_dword s5, s[8:11], s71
    s_buffer_load_dword s4, s[8:11], s70
    s_waitcnt lgkmcnt(1)
    s_sub_u32 s72, s4, s5
    s_add_u32 s3, s3, s72
    s_waitcnt lgkmcnt(0)
    s_add_u32 s70, s2, 256
    s_add_u32 s71, s2, 8448
    s_mov_b64 s[4:5], 0
    s_buffer_load_dword s4, s[8:11], s70
    s_buffer_load_dword s5, s[8:11], s71
    s_waitcnt lgkmcnt(1)
    s_sub_u32 s72, s4, s5
    s_add_u32 s3, s3, s72
    s_waitcnt lgkmcnt(0)
    s_add_u32 s70, s2, 384
    s_add_u32 s71, s2, 8576
    s_mov_b64 s[4:5], 0
    s_buffer_load_dword s5, s[8:11], s71
    s_buffer_load_dword s4, s[8:11], s70
    s_waitcnt lgkmcnt(1)
    s_sub_u32 s72, s4, s5
    s_add_u32 s3, s3, s72
    s_waitcnt lgkmcnt(0)
    s_and_b32 s3, s3, 15
    s_lshl_b32 s3, s3, 16
    s_add_u32 s3, s3, 1
novote_6:
    s_waitcnt vmcnt(0)
    s_barrier
    s_cmp_ge_u32 s58, 4
    s_cbranch_scc1 skip_7
    v_add_u32 v2, 0, v53
    v_xor_b32 v3, 8, v2
    ds_read_b64_tr_b16 v[192:193], v2 offset:0
    ds_read_b64_tr_b16 v[194:195], v2 offset:1024
    ds_read_b64_tr_b16 v[196:197], v2 offset:8192
    ds_read_b64_tr_b16 v[198:199], v2 offset:9216
    ds_read_b64_tr_b16 v[200:201], v2 offset:16384
    ds_read_b64_tr_b16 v[202:203], v2 offset:17408
    ds_read_b64_tr_b16 v[204:205], v2 offset:24576
    ds_read_b64_tr_b16 v[206:207], v2 offset:25600
    ds_read_b64_tr_b16 v[208:209], v2 offset:32768
    ds_read_b64_tr_b16 v[210:211], v2 offset:33792
    ds_read_b64_tr_b16 v[212:213], v2 offset:40960
    ds_read_b64_tr_b16 v[214:215], v2 offset:41984
    ds_read_b64_tr_b16 v[216:217], v2 offset:49152
    ds_read_b64_tr_b16 v[218:219], v2 offset:50176
    ds_read_b64_tr_b16 v[220:221], v2 offset:57344
    ds_read_b64_tr_b16 v[222:223], v2 offset:58368
    s_waitcnt lgkmcnt(0)
    ds_read_b64_tr_b16 v[224:225], v3 offset:0
    ds_read_b64_tr_b16 v[226:227], v3 offset:1024
    ds_read_b64_tr_b16 v[228:229], v3 offset:8192
    ds_read_b64_tr_b16 v[230:231], v3 offset:9216
    ds_read_b64_tr_b16 v[232:233], v3 offset:16384
    ds_read_b64_tr_b16 v[234:235], v3 offset:17408
    ds_read_b64_tr_b16 v[236:237], v3 offset:24576
    ds_read_b64_tr_b16 v[238:239], v3 offset:25600
    ds_read_b64_tr_b16 v[240:241], v3 offset:32768
    ds_read_b64_tr_b16 v[242:243], v3 offset:33792
    ds_read_b64_tr_b16 v[244:245], v3 offset:40960
    ds_read_b64_tr_b16 v[246:247], v3 offset:41984
    ds_read_b64_tr_b16 v[248:249], v3 offset:49152
    ds_read_b64_tr_b16 v[250:251], v3 offset:50176
    ds_read_b64_tr_b16 v[252:253], v3 offset:57344
    ds_read_b64_tr_b16 v[254:255], v3 offset:58368
    s_waitcnt lgkmcnt(0)
skip_7:
    s_cmp_ge_u32 s58, 4
    s_cbranch_scc0 skip_8
    v_add_u32 v2, 65536, v54
    v_xor_b32 v3, 16, v2
    ds_read_b64_tr_b16 v[128:129], v2 offset:0
    ds_read_b64_tr_b16 v[130:131], v2 offset:1024
    ds_read_b64_tr_b16 v[132:133], v2 offset:8192
    ds_read_b64_tr_b16 v[134:135], v2 offset:9216
    ds_read_b64_tr_b16 v[136:137], v2 offset:16384
    ds_read_b64_tr_b16 v[138:139], v2 offset:17408
    ds_read_b64_tr_b16 v[140:141], v2 offset:24576
    ds_read_b64_tr_b16 v[142:143], v2 offset:25600
    ds_read_b64_tr_b16 v[144:145], v2 offset:32768
    ds_read_b64_tr_b16 v[146:147], v2 offset:33792
    ds_read_b64_tr_b16 v[148:149], v2 offset:40960
    ds_read_b64_tr_b16 v[150:151], v2 offset:41984
    ds_read_b64_tr_b16 v[152:153], v2 offset:49152
    ds_read_b64_tr_b16 v[154:155], v2 offset:50176
    ds_read_b64_tr_b16 v[156:157], v2 offset:57344
    ds_read_b64_tr_b16 v[158:159], v2 offset:58368
    s_waitcnt lgkmcnt(0)
    ds_read_b64_tr_b16 v[160:161], v3 offset:0
    ds_read_b64_tr_b16 v[162:163], v3 offset:1024
    ds_read_b64_tr_b16 v[164:165], v3 offset:8192
    ds_read_b64_tr_b16 v[166:167], v3 offset:9216
    ds_read_b64_tr_b16 v[168:169], v3 offset:16384
    ds_read_b64_tr_b16 v[170:171], v3 offset:17408
    ds_read_b64_tr_b16 v[172:173], v3 offset:24576
    ds_read_b64_tr_b16 v[174:175], v3 offset:25600
    ds_read_b64_tr_b16 v[176:177], v3 offset:32768
    ds_read_b64_tr_b16 v[178:179], v3 offset:33792
    ds_read_b64_tr_b16 v[180:181], v3 offset:40960
    ds_read_b64_tr_b16 v[182:183], v3 offset:41984
    ds_read_b64_tr_b16 v[184:185], v3 offset:49152
    ds_read_b64_tr_b16 v[186:187], v3 offset:50176
    ds_read_b64_tr_b16 v[188:189], v3 offset:57344
    ds_read_b64_tr_b16 v[190:191], v3 offset:58368
    s_waitcnt lgkmcnt(0)
skip_8:
    s_barrier
    s_lshl_b32 s70, s64, 21
    s_lshl_b32 s71, s58, 18
    s_add_u32 s70, s70, s71
    s_lshl_b32 s71, s66, 8
    s_add_u32 s70, s70, s71
    s_lshl_b32 s71, s58, 13
    s_add_u32 s71, s71, 0
    s_mov_b32 m0, s71
    s_nop 0
    buffer_load_dwordx4 v50, s[20:23], s70 offen  lds
    s_add_u32 s70, s70, 0x8000
    s_add_u32 s71, s71, 0x400
    s_mov_b32 m0, s71
    s_nop 0
    buffer_load_dwordx4 v50, s[20:23], s70 offen  lds
    s_add_u32 s70, s70, 0x8000
    s_add_u32 s71, s71, 0x400
    s_mov_b32 m0, s71
    s_nop 0
    buffer_load_dwordx4 v51, s[20:23], s70 offen  lds
    s_add_u32 s70, s70, 0x8000
    s_add_u32 s71, s71, 0x400
    s_mov_b32 m0, s71
    s_nop 0
    buffer_load_dwordx4 v51, s[20:23], s70 offen  lds
    s_add_u32 s70, s70, 0x8000
    s_add_u32 s71, s71, 0x400
    s_mov_b32 m0, s71
    s_nop 0
    buffer_load_dwordx4 v50, s[20:23], s70 offen  lds
    s_add_u32 s70, s70, 0x8000
    s_add_u32 s71, s71, 0x400
    s_mov_b32 m0, s71
    s_nop 0
    buffer_load_dwordx4 v50, s[20:23], s70 offen  lds
    s_add_u32 s70, s70, 0x8000
    s_add_u32 s71, s71, 0x400
    s_mov_b32 m0, s71
    s_nop 0
    buffer_load_dwordx4 v51, s[20:23], s70 offen  lds
    s_add_u32 s70, s70, 0x8000
    s_add_u32 s71, s71, 0x400
    s_mov_b32 m0, s71
    s_nop 0
    buffer_load_dwordx4 v51, s[20:23], s70 offen  lds
    s_add_u32 s70, s70, 0x8000
    s_add_u32 s71, s71, 0x400
    s_lshl_b32 s70, s66, 18
    s_lshl_b32 s71, s58, 15
    s_add_u32 s70, s70, s71
    s_lshl_b32 s71, s64, 9
    s_add_u32 s70, s70, s71
    s_lshl_b32 s71, s58, 13
    s_add_u32 s71, s71, 65536
    s_mov_b32 m0, s71
    v_xor_b32 v2, 0, v52
    buffer_load_dwordx4 v2, s[32:35], s70 offen  lds
    s_add_u32 s70, s70, 0x1000
    s_add_u32 s71, s71, 0x400
    s_mov_b32 m0, s71
    v_xor_b32 v2, 64, v52
    buffer_load_dwordx4 v2, s[32:35], s70 offen  lds
    s_add_u32 s70, s70, 0x1000
    s_add_u32 s71, s71, 0x400
    s_mov_b32 m0, s71
    v_xor_b32 v2, 128, v52
    buffer_load_dwordx4 v2, s[32:35], s70 offen  lds
    s_add_u32 s70, s70, 0x1000
    s_add_u32 s71, s71, 0x400
    s_mov_b32 m0, s71
    v_xor_b32 v2, 192, v52
    buffer_load_dwordx4 v2, s[32:35], s70 offen  lds
    s_add_u32 s70, s70, 0x1000
    s_add_u32 s71, s71, 0x400
    s_mov_b32 m0, s71
    v_xor_b32 v2, 0, v52
    buffer_load_dwordx4 v2, s[32:35], s70 offen  lds
    s_add_u32 s70, s70, 0x1000
    s_add_u32 s71, s71, 0x400
    s_mov_b32 m0, s71
    v_xor_b32 v2, 64, v52
    buffer_load_dwordx4 v2, s[32:35], s70 offen  lds
    s_add_u32 s70, s70, 0x1000
    s_add_u32 s71, s71, 0x400
    s_mov_b32 m0, s71
    v_xor_b32 v2, 128, v52
    buffer_load_dwordx4 v2, s[32:35], s70 offen  lds
    s_add_u32 s70, s70, 0x1000
    s_add_u32 s71, s71, 0x400
    s_mov_b32 m0, s71
    v_xor_b32 v2, 192, v52
    buffer_load_dwordx4 v2, s[32:35], s70 offen  lds
    s_add_u32 s70, s70, 0x1000
    s_add_u32 s71, s71, 0x400
    s_cmp_lg_u32 s58, 4
    s_cbranch_scc1 nosig_9
    v_mov_b32 v2, s3
    v_cmp_eq_u32 vcc, 0, v1
    v_mov_b32 v3, 32
    v_mov_b32 v4, 0x5ffffff0
    v_cndmask_b32 v3, v4, v3, vcc
    buffer_atomic_add v2, v3, s[12:15], 0 offen sc1
nosig_9:
    s_waitcnt vmcnt(0)
    s_barrier
    s_cmp_ge_u32 s58, 4
    s_cbranch_scc1 skip_10
    v_add_u32 v2, 0, v53
    v_xor_b32 v3, 8, v2
    ds_read_b64_tr_b16 v[128:129], v2 offset:0
    ds_read_b64_tr_b16 v[130:131], v2 offset:1024
    ds_read_b64_tr_b16 v[132:133], v2 offset:8192
    ds_read_b64_tr_b16 v[134:135], v2 offset:9216
    ds_read_b64_tr_b16 v[136:137], v2 offset:16384
    ds_read_b64_tr_b16 v[138:139], v2 offset:17408
    ds_read_b64_tr_b16 v[140:141], v2 offset:24576
    ds_read_b64_tr_b16 v[142:143], v2 offset:25600
    ds_read_b64_tr_b16 v[144:145], v2 offset:32768
    ds_read_b64_tr_b16 v[146:147], v2 offset:33792
    ds_read_b64_tr_b16 v[148:149], v2 offset:40960
    ds_read_b64_tr_b16 v[150:151], v2 offset:41984
    ds_read_b64_tr_b16 v[152:153], v2 offset:49152
    ds_read_b64_tr_b16 v[154:155], v2 offset:50176
    ds_read_b64_tr_b16 v[156:157], v2 offset:57344
    ds_read_b64_tr_b16 v[158:159], v2 offset:58368
    s_waitcnt lgkmcnt(0)
    ds_read_b64_tr_b16 v[160:161], v3 offset:0
    ds_read_b64_tr_b16 v[162:163], v3 offset:1024
    ds_read_b64_tr_b16 v[164:165], v3 offset:8192
    ds_read_b64_tr_b16 v[166:167], v3 offset:9216
    ds_read_b64_tr_b16 v[168:169], v3 offset:16384
    ds_read_b64_tr_b16 v[170:171], v3 offset:17408
    ds_read_b64_tr_b16 v[172:173], v3 offset:24576
    ds_read_b64_tr_b16 v[174:175], v3 offset:25600
    ds_read_b64_tr_b16 v[176:177], v3 offset:32768
    ds_read_b64_tr_b16 v[178:179], v3 offset:33792
    ds_read_b64_tr_b16 v[180:181], v3 offset:40960
    ds_read_b64_tr_b16 v[182:183], v3 offset:41984
    ds_read_b64_tr_b16 v[184:185], v3 offset:49152
    ds_read_b64_tr_b16 v[186:187], v3 offset:50176
    ds_read_b64_tr_b16 v[188:189], v3 offset:57344
    ds_read_b64_tr_b16 v[190:191], v3 offset:58368
    s_waitcnt lgkmcnt(0)
skip_10:
    s_cmp_ge_u32 s58, 4
    s_cbranch_scc0 skip_11
    v_xor_b32 v2, 0, v55
    ds_read_b64_tr_b16 v[192:193], v2 offset:0
    ds_read_b64_tr_b16 v[194:195], v2 offset:4096
    ds_read_b64_tr_b16 v[196:197], v2 offset:16384
    ds_read_b64_tr_b16 v[198:199], v2 offset:20480
    ds_read_b64_tr_b16 v[200:201], v2 offset:32768
    ds_read_b64_tr_b16 v[202:203], v2 offset:36864
    ds_read_b64_tr_b16 v[204:205], v2 offset:49152
    ds_read_b64_tr_b16 v[206:207], v2 offset:53248
    s_waitcnt lgkmcnt(0)
    v_xor_b32 v2, 8, v55
    ds_read_b64_tr_b16 v[208:209], v2 offset:0
    ds_read_b64_tr_b16 v[210:211], v2 offset:4096
    ds_read_b64_tr_b16 v[212:213], v2 offset:16384
    ds_read_b64_tr_b16 v[214:215], v2 offset:20480
    ds_read_b64_tr_b16 v[216:217], v2 offset:32768
    ds_read_b64_tr_b16 v[218:219], v2 offset:36864
    ds_read_b64_tr_b16 v[220:221], v2 offset:49152
    ds_read_b64_tr_b16 v[222:223], v2 offset:53248
    s_waitcnt lgkmcnt(0)
    v_xor_b32 v2, 64, v55
    ds_read_b64_tr_b16 v[224:225], v2 offset:0
    ds_read_b64_tr_b16 v[226:227], v2 offset:4096
    ds_read_b64_tr_b16 v[228:229], v2 offset:16384
    ds_read_b64_tr_b16 v[230:231], v2 offset:20480
    ds_read_b64_tr_b16 v[232:233], v2 offset:32768
    ds_read_b64_tr_b16 v[234:235], v2 offset:36864
    ds_read_b64_tr_b16 v[236:237], v2 offset:49152
    ds_read_b64_tr_b16 v[238:239], v2 offset:53248
    s_waitcnt lgkmcnt(0)
    v_xor_b32 v2, 72, v55
    ds_read_b64_tr_b16 v[240:241], v2 offset:0
    ds_read_b64_tr_b16 v[242:243], v2 offset:4096
    ds_read_b64_tr_b16 v[244:245], v2 offset:16384
    ds_read_b64_tr_b16 v[246:247], v2 offset:20480
    ds_read_b64_tr_b16 v[248:249], v2 offset:32768
    ds_read_b64_tr_b16 v[250:251], v2 offset:36864
    ds_read_b64_tr_b16 v[252:253], v2 offset:49152
    ds_read_b64_tr_b16 v[254:255], v2 offset:53248
    s_waitcnt lgkmcnt(0)
skip_11:
    v_mov_b32 v4, 0x27ff0
    s_cmp_lg_u32 s58, 0
    s_cbranch_scc1 armw_12
armwait_13:
    buffer_load_dword v2, off, s[12:15], 0 offset:32 sc1
    s_waitcnt vmcnt(0)
    v_and_b32 v3, 0xffff, v2
    v_cmp_gt_u32 vcc, 128, v3
    s_cbranch_vccz armwait_ok_14
    s_sub_u32 s69, s69, 1
    s_cbranch_scc0 armwait_13
    s_mov_b32 s69, 0
armwait_ok_14:
    ds_write_b32 v4, v2
    s_waitcnt lgkmcnt(0)
armw_12:
    s_barrier
    ds_read_b32 v2, v4
    s_waitcnt lgkmcnt(0)
    v_readfirstlane_b32 s70, v2
    s_nop 0
    s_cmp_gt_u32 s70, 0x200ffff
    s_cselect_b32 s70, 0x2000, 0x0
    s_add_u32 s78, s78, s70
    s_add_u32 s77, s77, s70
    s_cmp_ge_u32 s58, 4
    s_cbranch_scc0 skip_15
    v_bfe_u32 v2, v1, 0, 2
    v_lshlrev_b32 v2, 4, v2
    v_bfe_u32 v3, v1, 2, 2
    v_lshl_or_b32 v2, v3, 7, v2
    v_bfe_u32 v3, v1, 4, 2
    v_lshl_or_b32 v2, v3, 9, v2
    s_lshl_b32 s70, s64, 2
    s_add_u32 s70, s70, s67
    s_lshl_b32 s70, s70, 19
    s_lshl_b32 s71, s66, 13
    s_add_u32 s70, s70, s71
    s_add_u32 s71, s70, 0x6000000
    buffer_store_dwordx4 v[192:195], v2, s[8:11], s71 offen offset:0 sc1
    buffer_store_dwordx4 v[196:199], v2, s[8:11], s71 offen offset:2048 sc1
    s_add_u32 s71, s70, 0x6001000
    buffer_store_dwordx4 v[200:203], v2, s[8:11], s71 offen offset:0 sc1
    buffer_store_dwordx4 v[204:207], v2, s[8:11], s71 offen offset:2048 sc1
    s_add_u32 s71, s70, 0x6000000
    buffer_store_dwordx4 v[208:211], v2, s[8:11], s71 offen offset:64 sc1
    buffer_store_dwordx4 v[212:215], v2, s[8:11], s71 offen offset:2112 sc1
    s_add_u32 s71, s70, 0x6001000
    buffer_store_dwordx4 v[216:219], v2, s[8:11], s71 offen offset:64 sc1
    buffer_store_dwordx4 v[220:223], v2, s[8:11], s71 offen offset:2112 sc1
    s_add_u32 s71, s70, 0x6040000
    buffer_store_dwordx4 v[224:227], v2, s[8:11], s71 offen offset:0 sc1
    buffer_store_dwordx4 v[228:231], v2, s[8:11], s71 offen offset:2048 sc1
    s_add_u32 s71, s70, 0x6041000
    buffer_store_dwordx4 v[232:235], v2, s[8:11], s71 offen offset:0 sc1
    buffer_store_dwordx4 v[236:239], v2, s[8:11], s71 offen offset:2048 sc1
    s_add_u32 s71, s70, 0x6040000
    buffer_store_dwordx4 v[240:243], v2, s[8:11], s71 offen offset:64 sc1
    buffer_store_dwordx4 v[244:247], v2, s[8:11], s71 offen offset:2112 sc1
    s_add_u32 s71, s70, 0x6041000
    buffer_store_dwordx4 v[248:251], v2, s[8:11], s71 offen offset:64 sc1
    buffer_store_dwordx4 v[252:255], v2, s[8:11], s71 offen offset:2112 sc1
skip_15:
    s_mov_b32 s68, 0
    s_mov_b32 s83, 0
    s_mov_b32 s74, s73
    s_cmp_ge_u32 s58, 4
    s_cbranch_scc1 vo_main_16
    s_setprio 3
    v_bfe_u32 v121, v1, 0, 3
    v_lshlrev_b32 v121, 4, v121
    v_bfe_u32 v2, v1, 3, 1
    v_lshl_or_b32 v121, v2, 8, v121
    v_bfe_u32 v2, v1, 4, 2
    v_lshl_or_b32 v121, v2, 9, v121
    s_lshl_b32 s76, s66, 13
    s_lshl_b32 s70, s67, 11
    s_add_u32 s76, s76, s70
    s_add_u32 s76, s76, 0x1000000
    s_add_u32 s70, s70, 20992
    v_add_u32 v122, s70, v8
    v_mov_b32 v124, 128
    s_mov_b32 s2, 128
kv0_18:
    buffer_load_dword v123, v124, s[12:15], 0 offen sc1
    s_waitcnt vmcnt(0)
    v_cmp_gt_u32 vcc, s2, v123
    s_cbranch_vccz kv0_ok_19
    s_sub_u32 s69, s69, 1
    s_cbranch_scc0 kv0_18
    s_mov_b32 s69, 0
kv0_ok_19:
    s_lshl_b32 s70, s66, 4
    s_lshl_b32 s71, s64, 2
    s_add_u32 s70, s70, s71
    s_add_u32 s3, s70, s67
    v_mov_b32 v125, 64
    s_add_u32 s70, s76, 0x1000000
    buffer_load_dwordx4 v[94:97], v121, s[8:11], s76 offen sc1
    buffer_load_dwordx4 v[98:101], v121, s[8:11], s76 offen offset:128 sc1
    buffer_load_dwordx4 v[102:105], v121, s[8:11], s70 offen sc1
    buffer_load_dwordx4 v[106:109], v121, s[8:11], s70 offen offset:128 sc1
    s_add_u32 s76, s76, 0x40000
    s_lshl_b32 s81, s66, 11
    s_lshl_b32 s70, s67, 9
    s_add_u32 s81, s81, s70
    s_add_u32 s81, s81, 0x4000000
    s_mul_i32 s70, s67, 3136
    s_add_u32 s70, s70, 4096
    v_add_u32 v118, s70, v8
    v_bfe_u32 v2, v1, 0, 3
    v_lshlrev_b32 v2, 4, v2
    v_bfe_u32 v3, v1, 4, 2
    v_lshl_or_b32 v2, v3, 7, v2
    v_mov_b32 v3, 0x5ffffff0
    v_cmp_le_u32 vcc, 8, v6
    s_nop 1
    v_cndmask_b32 v119, v3, v2, vcc
    v_bfe_u32 v120, v1, 0, 3
    v_lshlrev_b32 v120, 3, v120
    v_bfe_u32 v2, v1, 3, 1
    v_lshl_or_b32 v120, v2, 7, v120
    v_bfe_u32 v2, v1, 5, 1
    v_lshl_or_b32 v120, v2, 6, v120
    v_bfe_u32 v2, v1, 4, 1
    v_lshl_or_b32 v120, v2, 8, v120
    v_and_b32 v2, 1, v1
    v_lshlrev_b32 v2, 4, v2
    v_mov_b32 v3, 0x3f80
    v_lshlrev_b32 v2, v2, v3
    v_bfe_u32 v3, v1, 1, 3
    v_bfe_u32 v4, v1, 4, 1
    v_lshlrev_b32 v4, 1, v4
    v_xor_b32 v3, v3, v4
    v_cmp_eq_u32 vcc, 0, v3
    s_nop 1
    v_cndmask_b32 v110, 0, v2, vcc
    v_cndmask_b32 v112, 0, v2, vcc
    v_cmp_eq_u32 vcc, 1, v3
    s_nop 1
    v_cndmask_b32 v111, 0, v2, vcc
    v_cndmask_b32 v113, 0, v2, vcc
    v_cmp_eq_u32 vcc, 4, v3
    s_nop 1
    v_cndmask_b32 v114, 0, v2, vcc
    v_cndmask_b32 v116, 0, v2, vcc
    v_cmp_eq_u32 vcc, 5, v3
    s_nop 1
    v_cndmask_b32 v115, 0, v2, vcc
    v_cndmask_b32 v117, 0, v2, vcc
    s_waitcnt vmcnt(0)
    ds_write_b128 v122, v[102:105]
    ds_write_b128 v122, v[106:109] offset:1024
qk_loop_20:
    s_nop 2
    ds_write_b64 v9, v[42:43] offset:0
    s_waitcnt lgkmcnt(0)
    s_barrier
    ds_read_b128 v[10:13], v8 offset:0
    ds_read_b128 v[14:17], v8 offset:1024
    ds_read_b128 v[18:21], v8 offset:2048
    ds_read_b128 v[22:25], v8 offset:3072
    s_waitcnt lgkmcnt(3)
    v_mfma_f32_16x16x32_bf16 v[50:53], v[128:131], v[10:13], 0
    v_mfma_f32_16x16x32_bf16 v[54:57], v[144:147], v[10:13], 0
    v_mfma_f32_16x16x32_bf16 v[58:61], v[160:163], v[10:13], 0
    v_mfma_f32_16x16x32_bf16 v[62:65], v[176:179], v[10:13], 0
    v_mfma_f32_16x16x32_bf16 v[66:69], v[192:195], v[10:13], 0
    v_mfma_f32_16x16x32_bf16 v[70:73], v[208:211], v[10:13], 0
    v_mfma_f32_16x16x32_bf16 v[74:77], v[224:227], v[10:13], 0
    v_mfma_f32_16x16x32_bf16 v[78:81], v[240:243], v[10:13], 0
    s_waitcnt lgkmcnt(2)
    v_mfma_f32_16x16x32_bf16 v[50:53], v[132:135], v[14:17], v[50:53]
    v_mfma_f32_16x16x32_bf16 v[54:57], v[148:151], v[14:17], v[54:57]
    v_mfma_f32_16x16x32_bf16 v[58:61], v[164:167], v[14:17], v[58:61]
    v_mfma_f32_16x16x32_bf16 v[62:65], v[180:183], v[14:17], v[62:65]
    v_mfma_f32_16x16x32_bf16 v[66:69], v[196:199], v[14:17], v[66:69]
    v_mfma_f32_16x16x32_bf16 v[70:73], v[212:215], v[14:17], v[70:73]
    v_mfma_f32_16x16x32_bf16 v[74:77], v[228:231], v[14:17], v[74:77]
    v_mfma_f32_16x16x32_bf16 v[78:81], v[244:247], v[14:17], v[78:81]
    s_waitcnt lgkmcnt(1)
    v_mfma_f32_16x16x32_bf16 v[50:53], v[136:139], v[18:21], v[50:53]
    v_mfma_f32_16x16x32_bf16 v[54:57], v[152:155], v[18:21], v[54:57]
    v_mfma_f32_16x16x32_bf16 v[58:61], v[168:171], v[18:21], v[58:61]
    v_mfma_f32_16x16x32_bf16 v[62:65], v[184:187], v[18:21], v[62:65]
    v_mfma_f32_16x16x32_bf16 v[66:69], v[200:203], v[18:21], v[66:69]
    v_mfma_f32_16x16x32_bf16 v[70:73], v[216:219], v[18:21], v[70:73]
    v_mfma_f32_16x16x32_bf16 v[74:77], v[232:235], v[18:21], v[74:77]
    v_mfma_f32_16x16x32_bf16 v[78:81], v[248:251], v[18:21], v[78:81]
    s_waitcnt lgkmcnt(0)
    v_mfma_f32_16x16x32_bf16 v[50:53], v[140:143], v[22:25], v[50:53]
    v_mfma_f32_16x16x32_bf16 v[54:57], v[156:159], v[22:25], v[54:57]
    v_mfma_f32_16x16x32_bf16 v[58:61], v[172:175], v[22:25], v[58:61]
    v_mfma_f32_16x16x32_bf16 v[62:65], v[188:191], v[22:25], v[62:65]
    v_mfma_f32_16x16x32_bf16 v[66:69], v[204:207], v[22:25], v[66:69]
    v_mfma_f32_16x16x32_bf16 v[70:73], v[220:223], v[22:25], v[70:73]
    v_mfma_f32_16x16x32_bf16 v[74:77], v[236:239], v[22:25], v[74:77]
    v_mfma_f32_16x16x32_bf16 v[78:81], v[252:255], v[22:25], v[78:81]
    s_nop 1
    v_add_f32_dpp v82, v54, v50 row_ror:8 row_mask:0xf bank_mask:0x3
    v_add_f32_dpp v83, v55, v51 row_ror:8 row_mask:0xf bank_mask:0x3
    v_add_f32_dpp v84, v56, v52 row_ror:8 row_mask:0xf bank_mask:0x3
    v_add_f32_dpp v85, v57, v53 row_ror:8 row_mask:0xf bank_mask:0x3
    v_add_f32_dpp v86, v62, v58 row_ror:8 row_mask:0xf bank_mask:0x3
    v_add_f32_dpp v87, v63, v59 row_ror:8 row_mask:0xf bank_mask:0x3
    v_add_f32_dpp v88, v64, v60 row_ror:8 row_mask:0xf bank_mask:0x3
    v_add_f32_dpp v89, v65, v61 row_ror:8 row_mask:0xf bank_mask:0x3
    v_add_f32_dpp v82, v66, v70 row_ror:8 row_mask:0xf bank_mask:0xc
    v_add_f32_dpp v83, v67, v71 row_ror:8 row_mask:0xf bank_mask:0xc
    v_add_f32_dpp v84, v68, v72 row_ror:8 row_mask:0xf bank_mask:0xc
    v_add_f32_dpp v85, v69, v73 row_ror:8 row_mask:0xf bank_mask:0xc
    v_add_f32_dpp v86, v74, v78 row_ror:8 row_mask:0xf bank_mask:0xc
    v_add_f32_dpp v87, v75, v79 row_ror:8 row_mask:0xf bank_mask:0xc
    v_add_f32_dpp v88, v76, v80 row_ror:8 row_mask:0xf bank_mask:0xc
    v_add_f32_dpp v89, v77, v81 row_ror:8 row_mask:0xf bank_mask:0xc
    v_cvt_pk_bf16_f32 v90, v82, v83
    v_cvt_pk_bf16_f32 v91, v84, v85
    v_cvt_pk_bf16_f32 v92, v86, v87
    v_cvt_pk_bf16_f32 v93, v88, v89
    v_bfi_b32 v90, 1, s83, v90
    buffer_store_dwordx4 v[90:93], v46, s[8:11], s74 offen
    s_waitcnt vmcnt(0)
pollxqk_21:
    buffer_load_dwordx4 v[66:69], v8, s[8:11], s74 offen offset:0 sc1
    buffer_load_dwordx4 v[70:73], v8, s[8:11], s74 offen offset:1024 sc1
    buffer_load_dwordx4 v[74:77], v8, s[8:11], s74 offen offset:2048 sc1
    buffer_load_dwordx4 v[78:81], v8, s[8:11], s74 offen offset:3072 sc1
    s_waitcnt vmcnt(0)
    v_bitop3_b32 v2, v66, v70, s83 bitop3:0x7e
    v_bitop3_b32 v3, v74, v78, s83 bitop3:0x7e
    v_bitop3_b32 v2, v2, v3, 1 bitop3:0xa8
    v_cmp_ne_u32 vcc, 0, v2
    s_cbranch_vccz pollxqk_ok_22
    s_sub_u32 s69, s69, 1
    s_cbranch_scc0 pollxqk_21
    s_mov_b32 s69, 0
pollxqk_ok_22:
    v_mfma_f32_16x16x32_bf16 v[82:85], v[26:29], v[66:69], 0
    v_mfma_f32_16x16x32_bf16 v[86:89], v[26:29], v[74:77], 0
    v_mfma_f32_16x16x32_bf16 v[82:85], v[30:33], v[70:73], v[82:85]
    v_mfma_f32_16x16x32_bf16 v[86:89], v[30:33], v[78:81], v[86:89]
    s_nop 6
    v_cvt_pk_bf16_f32 v90, v82, v83
    v_cvt_pk_bf16_f32 v91, v84, v85
    v_cvt_pk_bf16_f32 v92, v86, v87
    v_cvt_pk_bf16_f32 v93, v88, v89
    s_nop 1
    v_mfma_f32_16x16x32_bf16 v[50:53], v[94:97], v[90:93], 0
    v_mfma_f32_16x16x32_bf16 v[54:57], v[98:101], v[90:93], 0
    v_mfma_f32_16x16x32_bf16 v[58:61], v[90:93], v[90:93], 0
    s_nop 5
    ds_write_b128 v118, v[50:53] offset:0
    ds_write_b128 v118, v[54:57] offset:1024
    ds_write_b128 v118, v[58:61] offset:2048
    s_waitcnt lgkmcnt(0)
    s_barrier
    s_setprio 0
    s_and_b32 s72, s68, 3
    s_cmp_lg_u32 s72, s64
    s_cbranch_scc1 nokm_23
    s_andn2_b32 s71, 1, s68
    s_lshl_b32 s71, s71, 18
    s_add_u32 s71, s71, s75
    buffer_load_dwordx4 v[66:69], v8, s[8:11], s71 offen offset:0 sc1
    buffer_load_dwordx4 v[70:73], v8, s[8:11], s71 offen offset:1024 sc1
    v_min_u32 v90, -2, v90
    buffer_store_dwordx4 v[90:93], v119, s[8:11], s81 offen sc1
    s_waitcnt vmcnt(1)
    s_cmp_eq_u32 s68, 0
    s_cbranch_scc1 nokm_23
    v_mfma_f32_16x16x32_bf16 v[82:85], v[110:113], v[66:69], 0
    v_mfma_f32_16x16x32_bf16 v[82:85], v[114:117], v[70:73], v[82:85]
    s_add_u32 s70, s81, 0x3f0000
    s_nop 6
    v_cvt_pk_bf16_f32 v82, v82, v83
    v_cvt_pk_bf16_f32 v83, v84, v85
    v_min_u32 v82, -2, v82
    buffer_store_dwordx2 v[82:83], v120, s[8:11], s70 offen sc1
nokm_23:
    s_cmp_lg_u32 s68, 63
    s_cbranch_scc1 tob2_24
    s_cmp_lg_u32 s64, 0
    s_cbranch_scc1 chain_end_17
    s_add_u32 s71, s75, 262144
pollvm_27:
    buffer_load_dwordx4 v[66:69], v8, s[8:11], s71 offen offset:0 sc1
    buffer_load_dwordx4 v[70:73], v8, s[8:11], s71 offen offset:1024 sc1
    s_waitcnt vmcnt(0)
    v_bitop3_b32 v2, v66, v68, s83 bitop3:0x7e
    v_bitop3_b32 v3, v70, v72, s83 bitop3:0x7e
    v_bitop3_b32 v2, v2, v3, 1 bitop3:0xa8
    v_cmp_ne_u32 vcc, 0, v2
    s_cbranch_vccz pollvm_ok_28
    s_sub_u32 s69, s69, 1
    s_cbranch_scc0 pollvm_27
    s_mov_b32 s69, 0
pollvm_ok_28:
    v_mfma_f32_16x16x32_bf16 v[82:85], v[110:113], v[66:69], 0
    v_mfma_f32_16x16x32_bf16 v[82:85], v[114:117], v[70:73], v[82:85]
    s_add_u32 s70, s81, 0x400000
    s_nop 6
    v_cvt_pk_bf16_f32 v82, v82, v83
    v_cvt_pk_bf16_f32 v83, v84, v85
    v_min_u32 v82, -2, v82
    buffer_store_dwordx2 v[82:83], v120, s[8:11], s70 offen sc1
    s_branch chain_end_17
tob2_24:
    s_and_b32 s72, s68, 7
    s_cmp_lg_u32 s72, 7
    s_cbranch_scc1 kv7_29
    v_cmp_gt_u32 vcc, s2, v123
    s_cbranch_vccz kv8_31
kvw_32:
    buffer_load_dword v123, v124, s[12:15], 0 offen sc1
    s_waitcnt vmcnt(0)
    v_cmp_gt_u32 vcc, s2, v123
    s_cbranch_vccz kvw_ok_33
    s_sub_u32 s69, s69, 1
    s_cbranch_scc0 kvw_32
    s_mov_b32 s69, 0
kvw_ok_33:
kv8_31:
    s_mov_b32 s2, 32
kv7_29:
    s_add_u32 s70, s76, 0x1000000
    buffer_load_dwordx4 v[94:97], v121, s[8:11], s76 offen sc1
    buffer_load_dwordx4 v[98:101], v121, s[8:11], s76 offen offset:128 sc1
    buffer_load_dwordx4 v[102:105], v121, s[8:11], s70 offen sc1
    buffer_load_dwordx4 v[106:109], v121, s[8:11], s70 offen offset:128 sc1
    s_add_u32 s76, s76, 0x40000
    v_mov_b32 v10, -1
    v_mov_b32 v11, -1
    v_mov_b32 v12, -1
    v_mov_b32 v13, -1
    buffer_store_dwordx4 v[10:13], v47, s[8:11], s78 offen sc1
    s_add_u32 s78, s78, 0x20000
    s_and_b32 s78, s78, 0xfffff
    s_cmp_lg_u32 s3, 1
    s_cbranch_scc1 noprog_34
    v_mov_b32 v2, s68
    buffer_store_dword v2, v125, s[12:15], 0 offen sc1
noprog_34:
    s_cmp_lg_u32 s72, 6
    s_cbranch_scc1 kv6_30
    v_add_u32 v124, 8, v124
    buffer_load_dword v123, v124, s[12:15], 0 offen sc1
kv6_30:
    s_barrier
    s_waitcnt vmcnt(0)
    ds_write_b128 v122, v[102:105]
    ds_write_b128 v122, v[106:109] offset:1024
    s_add_u32 s81, s81, 0x10000
    s_add_u32 s68, s68, 1
    s_bfe_u32 s83, s68, 0x10001
    s_xor_b32 s74, s74, 0x80000
    s_setprio 3
    s_barrier
pollc_35:
    buffer_load_dwordx4 v[34:37], v49, s[8:11], s77 offen sc1
    buffer_load_dwordx4 v[38:41], v49, s[8:11], s77 offen offset:1024 sc1
    s_waitcnt vmcnt(0)
    v_max3_u32 v2, v34, v36, v38
    v_max_u32 v2, v2, v40
    v_cmp_eq_u32 vcc, -1, v2
    s_cbranch_vccz pollc_ok_36
    s_sub_u32 s69, s69, 1
    s_cbranch_scc0 pollc_35
    s_mov_b32 s69, 0
pollc_ok_36:
    v_mfma_f32_16x16x32_bf16 v[42:45], v[26:29], v[34:37], 0
    v_mfma_f32_16x16x32_bf16 v[42:45], v[30:33], v[38:41], v[42:45]
    s_add_u32 s77, s77, 0x20000
    s_and_b32 s77, s77, 0xfffff
    s_nop 5
    v_cvt_pk_bf16_f32 v42, v42, v43
    v_cvt_pk_bf16_f32 v43, v44, v45
    s_branch qk_loop_20
vo_main_16:
    s_setprio 1
    v_mov_b32 v114, 0x3f803f80
    v_mov_b32 v118, 0x3e803e80
    v_mov_b32 v115, 0x3f803f80
    v_mov_b32 v119, 0x3e803e80
    v_mov_b32 v116, 0x3f803f80
    v_mov_b32 v120, 0x3e803e80
    v_mov_b32 v117, 0x3f803f80
    v_mov_b32 v121, 0x3e803e80
    s_mov_b32 s82, 0x3e0293ee
    v_lshrrev_b32 v2, 3, v6
    v_mul_u32_u24 v2, 6272, v2
    v_and_b32 v3, 7, v6
    v_lshl_add_u32 v2, v3, 4, v2
    v_add_u32 v2, 4096, v2
    v_lshl_add_u32 v122, v7, 8, v2
    v_or_b32 v3, 2, v7
    v_lshl_add_u32 v123, v3, 8, v2
    s_lshl_b32 s70, s67, 10
    v_add_u32 v124, s70, v8
    v_add_u32 v125, s70, v124
vo_loop_37:
    s_nop 2
    ds_write_b64 v9, v[42:43] offset:0
    s_waitcnt lgkmcnt(0)
    s_barrier
    ds_read_b128 v[10:13], v8 offset:0
    ds_read_b128 v[14:17], v8 offset:1024
    ds_read_b128 v[18:21], v8 offset:2048
    ds_read_b128 v[22:25], v8 offset:3072
    ds_read_b128 v[74:77], v125 offset:20992
    ds_read_b128 v[78:81], v125 offset:22016
    s_waitcnt lgkmcnt(5)
    v_mfma_f32_16x16x32_bf16 v[50:53], v[10:13], v[128:131], 0
    v_mfma_f32_16x16x32_bf16 v[54:57], v[10:13], v[144:147], 0
    v_mfma_f32_16x16x32_bf16 v[58:61], v[10:13], v[160:163], 0
    v_mfma_f32_16x16x32_bf16 v[62:65], v[10:13], v[176:179], 0
    s_waitcnt lgkmcnt(4)
    v_mfma_f32_16x16x32_bf16 v[50:53], v[14:17], v[132:135], v[50:53]
    v_mfma_f32_16x16x32_bf16 v[54:57], v[14:17], v[148:151], v[54:57]
    v_mfma_f32_16x16x32_bf16 v[58:61], v[14:17], v[164:167], v[58:61]
    v_mfma_f32_16x16x32_bf16 v[62:65], v[14:17], v[180:183], v[62:65]
    s_waitcnt lgkmcnt(3)
    v_mfma_f32_16x16x32_bf16 v[50:53], v[18:21], v[136:139], v[50:53]
    v_mfma_f32_16x16x32_bf16 v[54:57], v[18:21], v[152:155], v[54:57]
    v_mfma_f32_16x16x32_bf16 v[58:61], v[18:21], v[168:171], v[58:61]
    v_mfma_f32_16x16x32_bf16 v[62:65], v[18:21], v[184:187], v[62:65]
    s_waitcnt lgkmcnt(2)
    v_mfma_f32_16x16x32_bf16 v[50:53], v[22:25], v[140:143], v[50:53]
    v_mfma_f32_16x16x32_bf16 v[54:57], v[22:25], v[156:159], v[54:57]
    v_mfma_f32_16x16x32_bf16 v[58:61], v[22:25], v[172:175], v[58:61]
    v_mfma_f32_16x16x32_bf16 v[62:65], v[22:25], v[188:191], v[62:65]
    s_nop 6
    v_permlane32_swap_b32 v50, v58
    v_permlane32_swap_b32 v54, v62
    v_permlane32_swap_b32 v51, v59
    v_permlane32_swap_b32 v55, v63
    v_permlane32_swap_b32 v52, v60
    v_permlane32_swap_b32 v56, v64
    v_permlane32_swap_b32 v53, v61
    v_permlane32_swap_b32 v57, v65
    v_add_f32 v50, v50, v62
    v_add_f32 v51, v51, v63
    v_add_f32 v52, v52, v64
    v_add_f32 v53, v53, v65
    v_cvt_pk_bf16_f32 v50, v50, v51
    v_cvt_pk_bf16_f32 v51, v52, v53
    v_bfi_b32 v50, 1, s83, v50
    buffer_store_dwordx2 v[50:51], v46, s[8:11], s74 offen
    s_and_b32 s70, s68, 1
    s_lshl_b32 s70, s70, 19
    s_add_u32 s71, s70, s80
    s_add_u32 s72, s71, 0x1000
    s_add_u32 s70, s70, s79
    s_waitcnt lgkmcnt(0)
    s_barrier
    s_cmp_eq_u32 s68, 63
    s_cbranch_scc1 chain_end_17
    ds_read_b128 v[82:85], v122 offset:0
    ds_read_b128 v[86:89], v122 offset:1024
    ds_read_b128 v[90:93], v123 offset:2048
    ds_read_b128 v[94:97], v122 offset:3136
    ds_read_b128 v[98:101], v122 offset:4160
    ds_read_b128 v[102:105], v123 offset:5184
    buffer_load_dwordx4 v[66:69], v8, s[8:11], s74 offen offset:0 sc1
    buffer_load_dwordx4 v[70:73], v8, s[8:11], s74 offen offset:1024 sc1
    s_waitcnt lgkmcnt(0)
    v_pk_add_f32 v[82:83], v[82:83], v[94:95]
    v_pk_add_f32 v[84:85], v[84:85], v[96:97]
    v_pk_add_f32 v[86:87], v[86:87], v[98:99]
    v_pk_add_f32 v[88:89], v[88:89], v[100:101]
    v_pk_add_f32 v[90:91], v[90:91], v[102:103]
    v_pk_add_f32 v[92:93], v[92:93], v[104:105]
    v_add_f32_dpp v82, v82, v82 row_ror:8 row_mask:0xf bank_mask:0xf
    v_add_f32_dpp v83, v83, v83 row_ror:8 row_mask:0xf bank_mask:0xf
    v_add_f32_dpp v84, v84, v84 row_ror:8 row_mask:0xf bank_mask:0xf
    v_add_f32_dpp v85, v85, v85 row_ror:8 row_mask:0xf bank_mask:0xf
    v_add_f32_dpp v86, v86, v86 row_ror:8 row_mask:0xf bank_mask:0xf
    v_add_f32_dpp v87, v87, v87 row_ror:8 row_mask:0xf bank_mask:0xf
    v_add_f32_dpp v88, v88, v88 row_ror:8 row_mask:0xf bank_mask:0xf
    v_add_f32_dpp v89, v89, v89 row_ror:8 row_mask:0xf bank_mask:0xf
    v_add_f32_dpp v90, v90, v90 row_ror:8 row_mask:0xf bank_mask:0xf
    v_add_f32_dpp v91, v91, v91 row_ror:8 row_mask:0xf bank_mask:0xf
    v_add_f32_dpp v92, v92, v92 row_ror:8 row_mask:0xf bank_mask:0xf
    v_add_f32_dpp v93, v93, v93 row_ror:8 row_mask:0xf bank_mask:0xf
    v_max3_f32 v2, v82, v83, v84
    v_max3_f32 v3, v85, v86, v87
    v_max3_f32 v2, v2, v88, v89
    v_max3_f32 v3, v3, v90, v91
    v_max3_f32 v2, v2, v92, v93
    v_max_f32 v2, v2, v3
    v_mov_b32 v3, v2
    s_nop 1
    v_permlane32_swap_b32 v2, v3
    v_max_f32 v2, v2, v3
    v_mov_b32 v3, v2
    s_nop 1
    v_permlane16_swap_b32 v2, v3
    v_max_f32 v2, v2, v3
    v_mul_f32 v2, s82, v2
    v_fma_f32 v82, v82, s82, -v2
    v_fma_f32 v83, v83, s82, -v2
    v_fma_f32 v84, v84, s82, -v2
    v_fma_f32 v85, v85, s82, -v2
    v_fma_f32 v86, v86, s82, -v2
    v_fma_f32 v87, v87, s82, -v2
    v_fma_f32 v88, v88, s82, -v2
    v_fma_f32 v89, v89, s82, -v2
    v_fma_f32 v90, v90, s82, -v2
    v_fma_f32 v91, v91, s82, -v2
    v_fma_f32 v92, v92, s82, -v2
    v_fma_f32 v93, v93, s82, -v2
    v_exp_f32 v82, v82
    v_exp_f32 v83, v83
    v_exp_f32 v84, v84
    v_exp_f32 v85, v85
    v_exp_f32 v86, v86
    v_exp_f32 v87, v87
    v_exp_f32 v88, v88
    v_exp_f32 v89, v89
    v_exp_f32 v90, v90
    v_exp_f32 v91, v91
    v_exp_f32 v92, v92
    v_exp_f32 v93, v93
    v_cvt_pk_bf16_f32 v106, v82, v83
    v_cvt_pk_bf16_f32 v107, v84, v85
    v_cvt_pk_bf16_f32 v108, v86, v87
    v_cvt_pk_bf16_f32 v109, v88, v89
    v_cvt_pk_bf16_f32 v110, v90, v91
    v_cvt_pk_bf16_f32 v111, v92, v93
    v_cvt_pk_bf16_f32 v112, v90, v91
    v_cvt_pk_bf16_f32 v113, v92, v93
    v_mfma_f32_16x16x32_bf16 v[102:105], v[114:117], v[106:109], 0
    v_mfma_f32_16x16x32_bf16 v[94:97], v[74:77], v[106:109], 0
    v_mfma_f32_16x16x32_bf16 v[102:105], v[118:121], v[110:113], v[102:105]
    v_mfma_f32_16x16x32_bf16 v[98:101], v[78:81], v[106:109], 0
    s_waitcnt vmcnt(0)
    v_bitop3_b32 v2, v66, v68, s83 bitop3:0x7e
    v_bitop3_b32 v3, v70, v72, s83 bitop3:0x7e
    v_bitop3_b32 v2, v2, v3, 1 bitop3:0xa8
    v_cmp_ne_u32 vcc, 0, v2
    s_cbranch_vccz pollxv_ok_39
pollxv_38:
    buffer_load_dwordx4 v[66:69], v8, s[8:11], s74 offen offset:0 sc1
    buffer_load_dwordx4 v[70:73], v8, s[8:11], s74 offen offset:1024 sc1
    s_waitcnt vmcnt(0)
    v_bitop3_b32 v2, v66, v68, s83 bitop3:0x7e
    v_bitop3_b32 v3, v70, v72, s83 bitop3:0x7e
    v_bitop3_b32 v2, v2, v3, 1 bitop3:0xa8
    v_cmp_ne_u32 vcc, 0, v2
    s_cbranch_vccz pollxv_ok_39
    s_sub_u32 s69, s69, 1
    s_cbranch_scc0 pollxv_38
    s_mov_b32 s69, 0
pollxv_ok_39:
    v_mfma_f32_16x16x32_bf16 v[94:97], v[66:69], v[110:113], v[94:97]
    v_mfma_f32_16x16x32_bf16 v[98:101], v[70:73], v[110:113], v[98:101]
    v_rcp_f32 v2, v102
    s_nop 5
    v_mul_f32 v94, v2, v94
    v_mul_f32 v95, v2, v95
    v_mul_f32 v96, v2, v96
    v_mul_f32 v97, v2, v97
    v_mul_f32 v98, v2, v98
    v_mul_f32 v99, v2, v99
    v_mul_f32 v100, v2, v100
    v_mul_f32 v101, v2, v101
    v_cvt_pk_bf16_f32 v106, v94, v95
    v_cvt_pk_bf16_f32 v107, v96, v97
    v_cvt_pk_bf16_f32 v108, v98, v99
    v_cvt_pk_bf16_f32 v109, v100, v101
    ds_write_b128 v124, v[106:109] offset:16896
    s_waitcnt lgkmcnt(0)
    s_barrier
    ds_read_b128 v[10:13], v8 offset:16896
    ds_read_b128 v[14:17], v8 offset:17920
    ds_read_b128 v[18:21], v8 offset:18944
    ds_read_b128 v[22:25], v8 offset:19968
    s_waitcnt lgkmcnt(3)
    v_mfma_f32_16x16x32_bf16 v[50:53], v[192:195], v[10:13], 0
    v_mfma_f32_16x16x32_bf16 v[54:57], v[208:211], v[10:13], 0
    s_waitcnt lgkmcnt(2)
    v_mfma_f32_16x16x32_bf16 v[50:53], v[196:199], v[14:17], v[50:53]
    v_mfma_f32_16x16x32_bf16 v[54:57], v[212:215], v[14:17], v[54:57]
    s_waitcnt lgkmcnt(1)
    v_mfma_f32_16x16x32_bf16 v[50:53], v[200:203], v[18:21], v[50:53]
    v_mfma_f32_16x16x32_bf16 v[54:57], v[216:219], v[18:21], v[54:57]
    s_waitcnt lgkmcnt(0)
    v_mfma_f32_16x16x32_bf16 v[50:53], v[204:207], v[22:25], v[50:53]
    v_mfma_f32_16x16x32_bf16 v[54:57], v[220:223], v[22:25], v[54:57]
    v_mfma_f32_16x16x32_bf16 v[58:61], v[224:227], v[10:13], 0
    v_mfma_f32_16x16x32_bf16 v[58:61], v[228:231], v[14:17], v[58:61]
    v_mfma_f32_16x16x32_bf16 v[58:61], v[232:235], v[18:21], v[58:61]
    v_mfma_f32_16x16x32_bf16 v[58:61], v[236:239], v[22:25], v[58:61]
    v_mfma_f32_16x16x32_bf16 v[62:65], v[240:243], v[10:13], 0
    s_nop 1
    v_cvt_pk_bf16_f32 v82, v50, v51
    v_cvt_pk_bf16_f32 v83, v52, v53
    v_mfma_f32_16x16x32_bf16 v[62:65], v[244:247], v[14:17], v[62:65]
    v_cvt_pk_bf16_f32 v84, v54, v55
    v_cvt_pk_bf16_f32 v85, v56, v57
    v_mfma_f32_16x16x32_bf16 v[62:65], v[248:251], v[18:21], v[62:65]
    v_bfi_b32 v82, 1, s83, v82
    buffer_store_dwordx4 v[82:85], v48, s[8:11], s71 offen
    v_mfma_f32_16x16x32_bf16 v[62:65], v[252:255], v[22:25], v[62:65]
    v_cvt_pk_bf16_f32 v86, v58, v59
    v_cvt_pk_bf16_f32 v87, v60, v61
    v_bfi_b32 v86, 1, s83, v86
    s_nop 4
    v_cvt_pk_bf16_f32 v88, v62, v63
    v_cvt_pk_bf16_f32 v89, v64, v65
    buffer_store_dwordx4 v[86:89], v48, s[8:11], s72 offen
    s_waitcnt vmcnt(0)
pollb_40:
    buffer_load_dwordx4 v[66:69], v8, s[8:11], s70 offen sc1
    s_waitcnt vmcnt(0)
    v_bitop3_b32 v2, v66, s83, 1 bitop3:0x28
    v_cmp_ne_u32 vcc, 0, v2
    s_cbranch_vccz pollb_ok_41
    s_sub_u32 s69, s69, 1
    s_cbranch_scc0 pollb_40
    s_mov_b32 s69, 0
pollb_ok_41:
    v_mfma_f32_16x16x32_bf16 v[42:45], v[26:29], v[66:69], 0
    s_add_u32 s68, s68, 1
    s_bfe_u32 s83, s68, 0x10001
    s_xor_b32 s74, s74, 0x40000
    s_nop 4
    v_add_f32_dpp v42, v42, v42 row_ror:8 row_mask:0xf bank_mask:0xf
    v_add_f32_dpp v43, v43, v43 row_ror:8 row_mask:0xf bank_mask:0xf
    v_add_f32_dpp v44, v44, v44 row_ror:8 row_mask:0xf bank_mask:0xf
    v_add_f32_dpp v45, v45, v45 row_ror:8 row_mask:0xf bank_mask:0xf
    v_cvt_pk_bf16_f32 v42, v42, v43
    v_cvt_pk_bf16_f32 v43, v44, v45
    v_min_u32 v42, -2, v42
    buffer_store_dwordx2 v[42:43], v47, s[8:11], s78 offen sc1
    s_add_u32 s78, s78, 0x20000
    s_and_b32 s78, s78, 0xfffff
    s_waitcnt vmcnt(0)
    s_barrier
pollc_42:
    buffer_load_dwordx4 v[34:37], v49, s[8:11], s77 offen sc1
    buffer_load_dwordx4 v[38:41], v49, s[8:11], s77 offen offset:1024 sc1
    s_waitcnt vmcnt(0)
    v_max3_u32 v2, v34, v36, v38
    v_max_u32 v2, v2, v40
    v_cmp_eq_u32 vcc, -1, v2
    s_cbranch_vccz pollc_ok_43
    s_sub_u32 s69, s69, 1
    s_cbranch_scc0 pollc_42
    s_mov_b32 s69, 0
pollc_ok_43:
    v_mfma_f32_16x16x32_bf16 v[42:45], v[26:29], v[34:37], 0
    v_mfma_f32_16x16x32_bf16 v[42:45], v[30:33], v[38:41], v[42:45]
    s_add_u32 s77, s77, 0x20000
    s_and_b32 s77, s77, 0xfffff
    s_nop 5
    v_cvt_pk_bf16_f32 v42, v42, v43
    v_cvt_pk_bf16_f32 v43, v44, v45
    s_branch vo_loop_37
chain_end_17:
    s_waitcnt vmcnt(0)
    s_endpgm
bulk_2:
    s_and_b32 s75, s56, 3
    s_lshl_b32 s76, s75, 5
    s_add_u32 s76, s76, s57
    s_mov_b32 s77, 0x40000
    v_bfe_u32 v79, v1, 0, 4
    v_lshlrev_b32 v79, 4, v79
    v_bfe_u32 v75, v1, 4, 2
    v_lshl_or_b32 v79, v75, 9, v79
    s_mov_b32 s78, 0
    v_bfe_u32 v76, v1, 2, 2
    v_sub_u32 v76, 0, v76
    v_lshrrev_b32 v75, 4, v1
    v_xor_b32 v76, v76, v75
    v_and_b32 v76, 3, v76
    v_bfe_u32 v72, v1, 0, 4
    v_lshlrev_b32 v72, 6, v72
    v_lshl_or_b32 v72, v76, 4, v72
    s_lshr_b32 s74, s58, 2
    s_mul_i32 s74, s74, 4096
    v_add_u32 v72, s74, v72
    v_bfe_u32 v73, v1, 0, 2
    v_lshlrev_b32 v73, 3, v73
    v_bfe_u32 v75, v1, 4, 1
    v_lshl_or_b32 v73, v75, 5, v73
    v_bfe_u32 v75, v1, 2, 2
    v_lshl_or_b32 v73, v75, 6, v73
    v_bfe_u32 v75, v1, 2, 2
    v_lshl_or_b32 v73, v75, 8, v73
    v_bfe_u32 v75, v1, 4, 2
    v_lshl_or_b32 v73, v75, 11, v73
    s_and_b32 s74, s58, 3
    s_mul_i32 s74, s74, 64
    s_or_b32 s74, s74, 8192
    v_xor_b32 v73, s74, v73
r01_51:
    s_and_b32 s79, s57, 1
    s_lshl_b32 s84, s78, 1
    s_add_u32 s79, s79, s84
    s_bfe_u32 s80, s76, 0x50001
    s_lshl_b32 s83, s78, 3
    s_add_u32 s83, s83, 128
    s_cmp_ge_u32 s75, 2
    s_cbranch_scc1 v0_49
    s_mov_b64 s[60:61], s[36:37]
    s_mov_b32 s62, 0x400000
    s_mov_b32 s63, 0x20000
    s_mov_b64 s[64:65], s[24:25]
    s_mov_b32 s66, 0x800000
    s_mov_b32 s67, 0x20000
    v_lshrrev_b32 v76, 4, v1
    v_sub_u32 v76, 0, v76
    v_xor_b32 v76, v76, v1
    v_and_b32 v76, 3, v76
    s_mul_i32 s74, s58, 16
    v_lshrrev_b32 v77, 2, v1
    v_add3_u32 v77, v77, s74, 0
    v_lshlrev_b32 v68, 11, v77
    v_lshl_add_u32 v68, v76, 4, v68
    s_and_b32 s74, s58, 2
    v_bfe_u32 v76, v1, 0, 4
    v_bfe_u32 v77, v1, 4, 2
    v_lshlrev_b32 v77, 2, v77
    v_xor_b32 v76, v76, v77
    v_xor_b32 v76, s74, v76
    v_bfe_u32 v77, v76, 0, 1
    v_lshlrev_b32 v77, 5, v77
    v_bfe_u32 v75, v76, 1, 1
    v_lshl_or_b32 v77, v75, 4, v77
    v_bfe_u32 v75, v76, 2, 3
    v_lshl_or_b32 v77, v75, 6, v77
    v_lshrrev_b32 v76, 4, v1
    v_lshl_add_u32 v70, v76, 13, v77
    s_lshl_b32 s74, s58, 15
    v_add_u32 v70, s74, v70
    s_mov_b32 s70, 262144
    s_mul_i32 s68, s79, 262144
    s_mul_i32 s69, s80, 256
    s_mov_b32 s82, 0x40000
    s_lshl_b32 s81, s79, 1
    s_lshr_b32 s84, s58, 2
    s_add_u32 s81, s81, s84
    s_mul_i32 s81, s81, s82
    s_mul_i32 s81, s81, 2
    s_lshl_b32 s74, s80, 2
    s_and_b32 s84, s58, 3
    s_add_u32 s84, s84, s74
    s_mul_i32 s84, s84, 2048
    s_add_u32 s81, s81, s84
    s_add_u32 s81, s81, 0x1000000
    s_mul_i32 s71, s58, 1024
    s_mov_b32 m0, s71
    s_nop 0
    buffer_load_dwordx4 v68, s[60:63], s68 offen lds
    s_add_u32 m0, s71, 8192
    s_nop 0
    buffer_load_dwordx4 v70, s[64:67], s69 offen lds
    s_add_u32 s68, s68, 64
    s_add_u32 s69, s69, s70
    s_add_u32 s71, s71, 16384
    s_and_b32 s71, s71, 0x1ffff
    s_mov_b32 m0, s71
    s_nop 0
    buffer_load_dwordx4 v68, s[60:63], s68 offen lds
    s_add_u32 m0, s71, 8192
    s_nop 0
    buffer_load_dwordx4 v70, s[64:67], s69 offen lds
    s_add_u32 s68, s68, 64
    s_add_u32 s69, s69, s70
    s_add_u32 s71, s71, 16384
    s_and_b32 s71, s71, 0x1ffff
    s_mov_b32 m0, s71
    s_nop 0
    buffer_load_dwordx4 v68, s[60:63], s68 offen lds
    s_add_u32 m0, s71, 8192
    s_nop 0
    buffer_load_dwordx4 v70, s[64:67], s69 offen lds
    s_add_u32 s68, s68, 64
    s_add_u32 s69, s69, s70
    s_add_u32 s71, s71, 16384
    s_and_b32 s71, s71, 0x1ffff
    s_mov_b32 m0, s71
    s_nop 0
    buffer_load_dwordx4 v68, s[60:63], s68 offen lds
    s_add_u32 m0, s71, 8192
    s_nop 0
    buffer_load_dwordx4 v70, s[64:67], s69 offen lds
    s_add_u32 s68, s68, 64
    s_add_u32 s69, s69, s70
    s_add_u32 s71, s71, 16384
    s_and_b32 s71, s71, 0x1ffff
    s_mov_b32 m0, s71
    s_nop 0
    buffer_load_dwordx4 v68, s[60:63], s68 offen lds
    s_add_u32 m0, s71, 8192
    s_nop 0
    buffer_load_dwordx4 v70, s[64:67], s69 offen lds
    s_add_u32 s68, s68, 64
    s_add_u32 s69, s69, s70
    s_add_u32 s71, s71, 16384
    s_and_b32 s71, s71, 0x1ffff
    s_mov_b32 m0, s71
    s_nop 0
    buffer_load_dwordx4 v68, s[60:63], s68 offen lds
    s_add_u32 m0, s71, 8192
    s_nop 0
    buffer_load_dwordx4 v70, s[64:67], s69 offen lds
    s_add_u32 s68, s68, 64
    s_add_u32 s69, s69, s70
    s_add_u32 s71, s71, 16384
    s_and_b32 s71, s71, 0x1ffff
    s_mov_b32 m0, s71
    s_nop 0
    buffer_load_dwordx4 v68, s[60:63], s68 offen lds
    s_add_u32 m0, s71, 8192
    s_nop 0
    buffer_load_dwordx4 v70, s[64:67], s69 offen lds
    s_add_u32 s68, s68, 64
    s_add_u32 s69, s69, s70
    s_add_u32 s71, s71, 16384
    s_and_b32 s71, s71, 0x1ffff
    s_mov_b32 m0, s71
    s_nop 0
    buffer_load_dwordx4 v68, s[60:63], s68 offen lds
    s_add_u32 m0, s71, 8192
    s_nop 0
    buffer_load_dwordx4 v70, s[64:67], s69 offen lds
    s_add_u32 s68, s68, 64
    s_add_u32 s69, s69, s70
    s_add_u32 s71, s71, 16384
    s_and_b32 s71, s71, 0x1ffff
    s_branch f128_44
v0_49:
    s_mov_b64 s[60:61], s[36:37]
    s_mov_b32 s62, 0x400000
    s_mov_b32 s63, 0x20000
    s_mov_b64 s[64:65], s[28:29]
    s_mov_b32 s66, 0x800000
    s_mov_b32 s67, 0x20000
    v_lshrrev_b32 v76, 4, v1
    v_sub_u32 v76, 0, v76
    v_xor_b32 v76, v76, v1
    v_and_b32 v76, 3, v76
    s_mul_i32 s74, s58, 16
    v_lshrrev_b32 v77, 2, v1
    v_add3_u32 v77, v77, s74, 0
    v_bfe_u32 v68, v77, 0, 3
    v_lshlrev_b32 v68, 11, v68
    v_bfe_u32 v75, v77, 3, 1
    v_lshl_or_b32 v68, v75, 15, v68
    v_bfe_u32 v75, v77, 4, 1
    v_lshl_or_b32 v68, v75, 14, v68
    v_bfe_u32 v75, v77, 5, 3
    v_lshl_or_b32 v68, v75, 16, v68
    v_lshl_add_u32 v68, v76, 4, v68
    s_and_b32 s74, s58, 2
    v_bfe_u32 v76, v1, 0, 4
    v_bfe_u32 v77, v1, 4, 2
    v_lshlrev_b32 v77, 2, v77
    v_xor_b32 v76, v76, v77
    v_xor_b32 v76, s74, v76
    v_lshlrev_b32 v77, 4, v76
    v_lshrrev_b32 v76, 4, v1
    v_lshl_add_u32 v70, v76, 13, v77
    s_lshl_b32 s74, s58, 15
    v_add_u32 v70, s74, v70
    s_mov_b32 s70, 262144
    s_mul_i32 s68, s79, 262144
    s_mul_i32 s69, s80, 256
    s_mov_b32 s82, 0x40000
    s_lshl_b32 s81, s79, 1
    s_lshr_b32 s84, s58, 2
    s_add_u32 s81, s81, s84
    s_mul_i32 s81, s81, s82
    s_mul_i32 s81, s81, 2
    s_lshl_b32 s74, s80, 2
    s_and_b32 s84, s58, 3
    s_add_u32 s84, s84, s74
    s_mul_i32 s84, s84, 2048
    s_add_u32 s81, s81, s84
    s_add_u32 s81, s81, 0x2000000
    s_mul_i32 s71, s58, 1024
    s_mov_b32 m0, s71
    s_nop 0
    buffer_load_dwordx4 v68, s[60:63], s68 offen lds
    s_add_u32 m0, s71, 8192
    s_nop 0
    buffer_load_dwordx4 v70, s[64:67], s69 offen lds
    s_add_u32 s68, s68, 64
    s_add_u32 s69, s69, s70
    s_add_u32 s71, s71, 16384
    s_and_b32 s71, s71, 0x1ffff
    s_mov_b32 m0, s71
    s_nop 0
    buffer_load_dwordx4 v68, s[60:63], s68 offen lds
    s_add_u32 m0, s71, 8192
    s_nop 0
    buffer_load_dwordx4 v70, s[64:67], s69 offen lds
    s_add_u32 s68, s68, 64
    s_add_u32 s69, s69, s70
    s_add_u32 s71, s71, 16384
    s_and_b32 s71, s71, 0x1ffff
    s_mov_b32 m0, s71
    s_nop 0
    buffer_load_dwordx4 v68, s[60:63], s68 offen lds
    s_add_u32 m0, s71, 8192
    s_nop 0
    buffer_load_dwordx4 v70, s[64:67], s69 offen lds
    s_add_u32 s68, s68, 64
    s_add_u32 s69, s69, s70
    s_add_u32 s71, s71, 16384
    s_and_b32 s71, s71, 0x1ffff
    s_mov_b32 m0, s71
    s_nop 0
    buffer_load_dwordx4 v68, s[60:63], s68 offen lds
    s_add_u32 m0, s71, 8192
    s_nop 0
    buffer_load_dwordx4 v70, s[64:67], s69 offen lds
    s_add_u32 s68, s68, 64
    s_add_u32 s69, s69, s70
    s_add_u32 s71, s71, 16384
    s_and_b32 s71, s71, 0x1ffff
    s_mov_b32 m0, s71
    s_nop 0
    buffer_load_dwordx4 v68, s[60:63], s68 offen lds
    s_add_u32 m0, s71, 8192
    s_nop 0
    buffer_load_dwordx4 v70, s[64:67], s69 offen lds
    s_add_u32 s68, s68, 64
    s_add_u32 s69, s69, s70
    s_add_u32 s71, s71, 16384
    s_and_b32 s71, s71, 0x1ffff
    s_mov_b32 m0, s71
    s_nop 0
    buffer_load_dwordx4 v68, s[60:63], s68 offen lds
    s_add_u32 m0, s71, 8192
    s_nop 0
    buffer_load_dwordx4 v70, s[64:67], s69 offen lds
    s_add_u32 s68, s68, 64
    s_add_u32 s69, s69, s70
    s_add_u32 s71, s71, 16384
    s_and_b32 s71, s71, 0x1ffff
    s_mov_b32 m0, s71
    s_nop 0
    buffer_load_dwordx4 v68, s[60:63], s68 offen lds
    s_add_u32 m0, s71, 8192
    s_nop 0
    buffer_load_dwordx4 v70, s[64:67], s69 offen lds
    s_add_u32 s68, s68, 64
    s_add_u32 s69, s69, s70
    s_add_u32 s71, s71, 16384
    s_and_b32 s71, s71, 0x1ffff
    s_mov_b32 m0, s71
    s_nop 0
    buffer_load_dwordx4 v68, s[60:63], s68 offen lds
    s_add_u32 m0, s71, 8192
    s_nop 0
    buffer_load_dwordx4 v70, s[64:67], s69 offen lds
    s_add_u32 s68, s68, 64
    s_add_u32 s69, s69, s70
    s_add_u32 s71, s71, 16384
    s_and_b32 s71, s71, 0x1ffff
    s_mov_b32 s72, 0
    s_waitcnt vmcnt(14)
    s_barrier
    v_add_u32 v74, s72, v72
    v_add_u32 v75, s72, v73
    v_xor_b32 v76, 32, v75
    s_add_u32 s72, s72, 16384
    s_and_b32 s72, s72, 0x1ffff
    ds_read_b128 v[4:7], v74 offset:0
    ds_read_b128 v[8:11], v74 offset:1024
    ds_read_b64_tr_b16 v[36:37], v75 offset:0
    ds_read_b64_tr_b16 v[38:39], v75 offset:1024
    ds_read_b64_tr_b16 v[40:41], v76 offset:0
    ds_read_b64_tr_b16 v[42:43], v76 offset:1024
    s_waitcnt lgkmcnt(0)
    v_mfma_f32_16x16x32_bf16 v[80:83], v[4:7], v[36:39], 0
    ds_read_b128 v[12:15], v74 offset:2048
    v_mfma_f32_16x16x32_bf16 v[84:87], v[4:7], v[40:43], 0
    ds_read_b128 v[16:19], v74 offset:3072
    v_mfma_f32_16x16x32_bf16 v[88:91], v[8:11], v[36:39], 0
    v_mfma_f32_16x16x32_bf16 v[92:95], v[8:11], v[40:43], 0
    s_waitcnt vmcnt(12) lgkmcnt(0)
    s_barrier
    v_mfma_f32_16x16x32_bf16 v[96:99], v[12:15], v[36:39], 0
    v_add_u32 v74, s72, v72
    v_add_u32 v75, s72, v73
    v_xor_b32 v76, 32, v75
    s_add_u32 s72, s72, 16384
    s_and_b32 s72, s72, 0x1ffff
    ds_read_b128 v[4:7], v74 offset:0
    v_mfma_f32_16x16x32_bf16 v[100:103], v[12:15], v[40:43], 0
    ds_read_b64_tr_b16 v[52:53], v75 offset:0
    ds_read_b64_tr_b16 v[54:55], v75 offset:1024
    ds_read_b64_tr_b16 v[56:57], v76 offset:0
    ds_read_b64_tr_b16 v[58:59], v76 offset:1024
    v_mfma_f32_16x16x32_bf16 v[104:107], v[16:19], v[36:39], 0
    ds_read_b128 v[8:11], v74 offset:1024
    s_mov_b32 m0, s71
    s_nop 0
    buffer_load_dwordx4 v68, s[60:63], s68 offen lds
    s_add_u32 m0, s71, 8192
    v_mfma_f32_16x16x32_bf16 v[108:111], v[16:19], v[40:43], 0
    buffer_load_dwordx4 v70, s[64:67], s69 offen lds
    s_add_u32 s68, s68, 64
    s_add_u32 s69, s69, s70
    s_add_u32 s71, s71, 16384
    s_and_b32 s71, s71, 0x1ffff
    s_waitcnt lgkmcnt(0)
    v_mfma_f32_16x16x32_bf16 v[80:83], v[4:7], v[52:55], v[80:83]
    ds_read_b128 v[12:15], v74 offset:2048
    v_mfma_f32_16x16x32_bf16 v[84:87], v[4:7], v[56:59], v[84:87]
    ds_read_b128 v[16:19], v74 offset:3072
    v_mfma_f32_16x16x32_bf16 v[88:91], v[8:11], v[52:55], v[88:91]
    v_mfma_f32_16x16x32_bf16 v[92:95], v[8:11], v[56:59], v[92:95]
    s_waitcnt vmcnt(12) lgkmcnt(0)
    s_barrier
    v_mfma_f32_16x16x32_bf16 v[96:99], v[12:15], v[52:55], v[96:99]
    v_add_u32 v74, s72, v72
    v_add_u32 v75, s72, v73
    v_xor_b32 v76, 32, v75
    s_add_u32 s72, s72, 16384
    s_and_b32 s72, s72, 0x1ffff
    ds_read_b128 v[4:7], v74 offset:0
    v_mfma_f32_16x16x32_bf16 v[100:103], v[12:15], v[56:59], v[100:103]
    ds_read_b64_tr_b16 v[36:37], v75 offset:0
    ds_read_b64_tr_b16 v[38:39], v75 offset:1024
    ds_read_b64_tr_b16 v[40:41], v76 offset:0
    ds_read_b64_tr_b16 v[42:43], v76 offset:1024
    v_mfma_f32_16x16x32_bf16 v[104:107], v[16:19], v[52:55], v[104:107]
    ds_read_b128 v[8:11], v74 offset:1024
    s_mov_b32 m0, s71
    s_nop 0
    buffer_load_dwordx4 v68, s[60:63], s68 offen lds
    s_add_u32 m0, s71, 8192
    v_mfma_f32_16x16x32_bf16 v[108:111], v[16:19], v[56:59], v[108:111]
    buffer_load_dwordx4 v70, s[64:67], s69 offen lds
    s_add_u32 s68, s68, 64
    s_add_u32 s69, s69, s70
    s_add_u32 s71, s71, 16384
    s_and_b32 s71, s71, 0x1ffff
    s_mov_b32 s73, 11
gl_53:
    s_waitcnt lgkmcnt(0)
    v_mfma_f32_16x16x32_bf16 v[80:83], v[4:7], v[36:39], v[80:83]
    ds_read_b128 v[12:15], v74 offset:2048
    v_mfma_f32_16x16x32_bf16 v[84:87], v[4:7], v[40:43], v[84:87]
    ds_read_b128 v[16:19], v74 offset:3072
    v_mfma_f32_16x16x32_bf16 v[88:91], v[8:11], v[36:39], v[88:91]
    v_mfma_f32_16x16x32_bf16 v[92:95], v[8:11], v[40:43], v[92:95]
    s_waitcnt vmcnt(12) lgkmcnt(0)
    s_barrier
    v_mfma_f32_16x16x32_bf16 v[96:99], v[12:15], v[36:39], v[96:99]
    v_add_u32 v74, s72, v72
    v_add_u32 v75, s72, v73
    v_xor_b32 v76, 32, v75
    s_add_u32 s72, s72, 16384
    s_and_b32 s72, s72, 0x1ffff
    ds_read_b128 v[4:7], v74 offset:0
    v_mfma_f32_16x16x32_bf16 v[100:103], v[12:15], v[40:43], v[100:103]
    ds_read_b64_tr_b16 v[52:53], v75 offset:0
    ds_read_b64_tr_b16 v[54:55], v75 offset:1024
    ds_read_b64_tr_b16 v[56:57], v76 offset:0
    ds_read_b64_tr_b16 v[58:59], v76 offset:1024
    v_mfma_f32_16x16x32_bf16 v[104:107], v[16:19], v[36:39], v[104:107]
    ds_read_b128 v[8:11], v74 offset:1024
    s_mov_b32 m0, s71
    s_nop 0
    buffer_load_dwordx4 v68, s[60:63], s68 offen lds
    s_add_u32 m0, s71, 8192
    v_mfma_f32_16x16x32_bf16 v[108:111], v[16:19], v[40:43], v[108:111]
    buffer_load_dwordx4 v70, s[64:67], s69 offen lds
    s_add_u32 s68, s68, 64
    s_add_u32 s69, s69, s70
    s_add_u32 s71, s71, 16384
    s_and_b32 s71, s71, 0x1ffff
    s_waitcnt lgkmcnt(0)
    v_mfma_f32_16x16x32_bf16 v[80:83], v[4:7], v[52:55], v[80:83]
    ds_read_b128 v[12:15], v74 offset:2048
    v_mfma_f32_16x16x32_bf16 v[84:87], v[4:7], v[56:59], v[84:87]
    ds_read_b128 v[16:19], v74 offset:3072
    v_mfma_f32_16x16x32_bf16 v[88:91], v[8:11], v[52:55], v[88:91]
    v_mfma_f32_16x16x32_bf16 v[92:95], v[8:11], v[56:59], v[92:95]
    s_waitcnt vmcnt(12) lgkmcnt(0)
    s_barrier
    v_mfma_f32_16x16x32_bf16 v[96:99], v[12:15], v[52:55], v[96:99]
    v_add_u32 v74, s72, v72
    v_add_u32 v75, s72, v73
    v_xor_b32 v76, 32, v75
    s_add_u32 s72, s72, 16384
    s_and_b32 s72, s72, 0x1ffff
    ds_read_b128 v[4:7], v74 offset:0
    v_mfma_f32_16x16x32_bf16 v[100:103], v[12:15], v[56:59], v[100:103]
    ds_read_b64_tr_b16 v[36:37], v75 offset:0
    ds_read_b64_tr_b16 v[38:39], v75 offset:1024
    ds_read_b64_tr_b16 v[40:41], v76 offset:0
    ds_read_b64_tr_b16 v[42:43], v76 offset:1024
    v_mfma_f32_16x16x32_bf16 v[104:107], v[16:19], v[52:55], v[104:107]
    ds_read_b128 v[8:11], v74 offset:1024
    s_mov_b32 m0, s71
    s_nop 0
    buffer_load_dwordx4 v68, s[60:63], s68 offen lds
    s_add_u32 m0, s71, 8192
    v_mfma_f32_16x16x32_bf16 v[108:111], v[16:19], v[56:59], v[108:111]
    buffer_load_dwordx4 v70, s[64:67], s69 offen lds
    s_add_u32 s68, s68, 64
    s_add_u32 s69, s69, s70
    s_add_u32 s71, s71, 16384
    s_and_b32 s71, s71, 0x1ffff
    s_sub_u32 s73, s73, 1
    s_cmp_lg_u32 s73, 0
    s_cbranch_scc1 gl_53
    s_waitcnt lgkmcnt(0)
    v_mfma_f32_16x16x32_bf16 v[80:83], v[4:7], v[36:39], v[80:83]
    ds_read_b128 v[12:15], v74 offset:2048
    v_mfma_f32_16x16x32_bf16 v[84:87], v[4:7], v[40:43], v[84:87]
    ds_read_b128 v[16:19], v74 offset:3072
    v_mfma_f32_16x16x32_bf16 v[88:91], v[8:11], v[36:39], v[88:91]
    v_mfma_f32_16x16x32_bf16 v[92:95], v[8:11], v[40:43], v[92:95]
    s_waitcnt vmcnt(12) lgkmcnt(0)
    s_barrier
    v_mfma_f32_16x16x32_bf16 v[96:99], v[12:15], v[36:39], v[96:99]
    v_add_u32 v74, s72, v72
    v_add_u32 v75, s72, v73
    v_xor_b32 v76, 32, v75
    s_add_u32 s72, s72, 16384
    s_and_b32 s72, s72, 0x1ffff
    v_mfma_f32_16x16x32_bf16 v[100:103], v[12:15], v[40:43], v[100:103]
    ds_read_b128 v[4:7], v74 offset:0
    ds_read_b64_tr_b16 v[52:53], v75 offset:0
    v_mfma_f32_16x16x32_bf16 v[104:107], v[16:19], v[36:39], v[104:107]
    ds_read_b64_tr_b16 v[54:55], v75 offset:1024
    ds_read_b64_tr_b16 v[56:57], v76 offset:0
    v_mfma_f32_16x16x32_bf16 v[108:111], v[16:19], v[40:43], v[108:111]
    ds_read_b64_tr_b16 v[58:59], v76 offset:1024
    ds_read_b128 v[8:11], v74 offset:1024
    s_waitcnt lgkmcnt(0)
    v_mfma_f32_16x16x32_bf16 v[80:83], v[4:7], v[52:55], v[80:83]
    ds_read_b128 v[12:15], v74 offset:2048
    v_mfma_f32_16x16x32_bf16 v[84:87], v[4:7], v[56:59], v[84:87]
    ds_read_b128 v[16:19], v74 offset:3072
    v_mfma_f32_16x16x32_bf16 v[88:91], v[8:11], v[52:55], v[88:91]
    v_mfma_f32_16x16x32_bf16 v[92:95], v[8:11], v[56:59], v[92:95]
    s_waitcnt vmcnt(10) lgkmcnt(0)
    s_barrier
    v_mfma_f32_16x16x32_bf16 v[96:99], v[12:15], v[52:55], v[96:99]
    v_add_u32 v74, s72, v72
    v_add_u32 v75, s72, v73
    v_xor_b32 v76, 32, v75
    s_add_u32 s72, s72, 16384
    s_and_b32 s72, s72, 0x1ffff
    v_mfma_f32_16x16x32_bf16 v[100:103], v[12:15], v[56:59], v[100:103]
    ds_read_b128 v[4:7], v74 offset:0
    ds_read_b64_tr_b16 v[36:37], v75 offset:0
    v_mfma_f32_16x16x32_bf16 v[104:107], v[16:19], v[52:55], v[104:107]
    ds_read_b64_tr_b16 v[38:39], v75 offset:1024
    ds_read_b64_tr_b16 v[40:41], v76 offset:0
    v_mfma_f32_16x16x32_bf16 v[108:111], v[16:19], v[56:59], v[108:111]
    ds_read_b64_tr_b16 v[42:43], v76 offset:1024
    ds_read_b128 v[8:11], v74 offset:1024
    s_waitcnt lgkmcnt(0)
    v_mfma_f32_16x16x32_bf16 v[80:83], v[4:7], v[36:39], v[80:83]
    ds_read_b128 v[12:15], v74 offset:2048
    v_mfma_f32_16x16x32_bf16 v[84:87], v[4:7], v[40:43], v[84:87]
    ds_read_b128 v[16:19], v74 offset:3072
    v_mfma_f32_16x16x32_bf16 v[88:91], v[8:11], v[36:39], v[88:91]
    v_mfma_f32_16x16x32_bf16 v[92:95], v[8:11], v[40:43], v[92:95]
    s_waitcnt vmcnt(8) lgkmcnt(0)
    s_barrier
    v_mfma_f32_16x16x32_bf16 v[96:99], v[12:15], v[36:39], v[96:99]
    v_add_u32 v74, s72, v72
    v_add_u32 v75, s72, v73
    v_xor_b32 v76, 32, v75
    s_add_u32 s72, s72, 16384
    s_and_b32 s72, s72, 0x1ffff
    v_mfma_f32_16x16x32_bf16 v[100:103], v[12:15], v[40:43], v[100:103]
    ds_read_b128 v[4:7], v74 offset:0
    ds_read_b64_tr_b16 v[52:53], v75 offset:0
    v_mfma_f32_16x16x32_bf16 v[104:107], v[16:19], v[36:39], v[104:107]
    ds_read_b64_tr_b16 v[54:55], v75 offset:1024
    ds_read_b64_tr_b16 v[56:57], v76 offset:0
    v_mfma_f32_16x16x32_bf16 v[108:111], v[16:19], v[40:43], v[108:111]
    ds_read_b64_tr_b16 v[58:59], v76 offset:1024
    ds_read_b128 v[8:11], v74 offset:1024
    s_waitcnt lgkmcnt(0)
    v_mfma_f32_16x16x32_bf16 v[80:83], v[4:7], v[52:55], v[80:83]
    ds_read_b128 v[12:15], v74 offset:2048
    v_mfma_f32_16x16x32_bf16 v[84:87], v[4:7], v[56:59], v[84:87]
    ds_read_b128 v[16:19], v74 offset:3072
    v_mfma_f32_16x16x32_bf16 v[88:91], v[8:11], v[52:55], v[88:91]
    v_mfma_f32_16x16x32_bf16 v[92:95], v[8:11], v[56:59], v[92:95]
    s_waitcnt vmcnt(6) lgkmcnt(0)
    s_barrier
    v_mfma_f32_16x16x32_bf16 v[96:99], v[12:15], v[52:55], v[96:99]
    v_add_u32 v74, s72, v72
    v_add_u32 v75, s72, v73
    v_xor_b32 v76, 32, v75
    s_add_u32 s72, s72, 16384
    s_and_b32 s72, s72, 0x1ffff
    v_mfma_f32_16x16x32_bf16 v[100:103], v[12:15], v[56:59], v[100:103]
    ds_read_b128 v[4:7], v74 offset:0
    ds_read_b64_tr_b16 v[36:37], v75 offset:0
    v_mfma_f32_16x16x32_bf16 v[104:107], v[16:19], v[52:55], v[104:107]
    ds_read_b64_tr_b16 v[38:39], v75 offset:1024
    ds_read_b64_tr_b16 v[40:41], v76 offset:0
    v_mfma_f32_16x16x32_bf16 v[108:111], v[16:19], v[56:59], v[108:111]
    ds_read_b64_tr_b16 v[42:43], v76 offset:1024
    ds_read_b128 v[8:11], v74 offset:1024
    s_waitcnt lgkmcnt(0)
    v_mfma_f32_16x16x32_bf16 v[80:83], v[4:7], v[36:39], v[80:83]
    ds_read_b128 v[12:15], v74 offset:2048
    v_mfma_f32_16x16x32_bf16 v[84:87], v[4:7], v[40:43], v[84:87]
    ds_read_b128 v[16:19], v74 offset:3072
    v_mfma_f32_16x16x32_bf16 v[88:91], v[8:11], v[36:39], v[88:91]
    v_mfma_f32_16x16x32_bf16 v[92:95], v[8:11], v[40:43], v[92:95]
    s_waitcnt vmcnt(4) lgkmcnt(0)
    s_barrier
    v_mfma_f32_16x16x32_bf16 v[96:99], v[12:15], v[36:39], v[96:99]
    v_add_u32 v74, s72, v72
    v_add_u32 v75, s72, v73
    v_xor_b32 v76, 32, v75
    s_add_u32 s72, s72, 16384
    s_and_b32 s72, s72, 0x1ffff
    v_mfma_f32_16x16x32_bf16 v[100:103], v[12:15], v[40:43], v[100:103]
    ds_read_b128 v[4:7], v74 offset:0
    ds_read_b64_tr_b16 v[52:53], v75 offset:0
    v_mfma_f32_16x16x32_bf16 v[104:107], v[16:19], v[36:39], v[104:107]
    ds_read_b64_tr_b16 v[54:55], v75 offset:1024
    ds_read_b64_tr_b16 v[56:57], v76 offset:0
    v_mfma_f32_16x16x32_bf16 v[108:111], v[16:19], v[40:43], v[108:111]
    ds_read_b64_tr_b16 v[58:59], v76 offset:1024
    ds_read_b128 v[8:11], v74 offset:1024
    s_waitcnt lgkmcnt(0)
    v_mfma_f32_16x16x32_bf16 v[80:83], v[4:7], v[52:55], v[80:83]
    ds_read_b128 v[12:15], v74 offset:2048
    v_mfma_f32_16x16x32_bf16 v[84:87], v[4:7], v[56:59], v[84:87]
    ds_read_b128 v[16:19], v74 offset:3072
    v_mfma_f32_16x16x32_bf16 v[88:91], v[8:11], v[52:55], v[88:91]
    v_mfma_f32_16x16x32_bf16 v[92:95], v[8:11], v[56:59], v[92:95]
    s_waitcnt vmcnt(2) lgkmcnt(0)
    s_barrier
    v_mfma_f32_16x16x32_bf16 v[96:99], v[12:15], v[52:55], v[96:99]
    v_add_u32 v74, s72, v72
    v_add_u32 v75, s72, v73
    v_xor_b32 v76, 32, v75
    s_add_u32 s72, s72, 16384
    s_and_b32 s72, s72, 0x1ffff
    v_mfma_f32_16x16x32_bf16 v[100:103], v[12:15], v[56:59], v[100:103]
    ds_read_b128 v[4:7], v74 offset:0
    ds_read_b64_tr_b16 v[36:37], v75 offset:0
    v_mfma_f32_16x16x32_bf16 v[104:107], v[16:19], v[52:55], v[104:107]
    ds_read_b64_tr_b16 v[38:39], v75 offset:1024
    ds_read_b64_tr_b16 v[40:41], v76 offset:0
    v_mfma_f32_16x16x32_bf16 v[108:111], v[16:19], v[56:59], v[108:111]
    ds_read_b64_tr_b16 v[42:43], v76 offset:1024
    ds_read_b128 v[8:11], v74 offset:1024
    s_waitcnt lgkmcnt(0)
    v_mfma_f32_16x16x32_bf16 v[80:83], v[4:7], v[36:39], v[80:83]
    ds_read_b128 v[12:15], v74 offset:2048
    v_mfma_f32_16x16x32_bf16 v[84:87], v[4:7], v[40:43], v[84:87]
    ds_read_b128 v[16:19], v74 offset:3072
    v_mfma_f32_16x16x32_bf16 v[88:91], v[8:11], v[36:39], v[88:91]
    v_mfma_f32_16x16x32_bf16 v[92:95], v[8:11], v[40:43], v[92:95]
    s_waitcnt vmcnt(0) lgkmcnt(0)
    s_barrier
    v_mfma_f32_16x16x32_bf16 v[96:99], v[12:15], v[36:39], v[96:99]
    v_add_u32 v74, s72, v72
    v_add_u32 v75, s72, v73
    v_xor_b32 v76, 32, v75
    s_add_u32 s72, s72, 16384
    s_and_b32 s72, s72, 0x1ffff
    v_mfma_f32_16x16x32_bf16 v[100:103], v[12:15], v[40:43], v[100:103]
    ds_read_b128 v[4:7], v74 offset:0
    ds_read_b64_tr_b16 v[52:53], v75 offset:0
    v_mfma_f32_16x16x32_bf16 v[104:107], v[16:19], v[36:39], v[104:107]
    ds_read_b64_tr_b16 v[54:55], v75 offset:1024
    ds_read_b64_tr_b16 v[56:57], v76 offset:0
    v_mfma_f32_16x16x32_bf16 v[108:111], v[16:19], v[40:43], v[108:111]
    ds_read_b64_tr_b16 v[58:59], v76 offset:1024
    ds_read_b128 v[8:11], v74 offset:1024
    s_waitcnt lgkmcnt(0)
    v_mfma_f32_16x16x32_bf16 v[80:83], v[4:7], v[52:55], v[80:83]
    ds_read_b128 v[12:15], v74 offset:2048
    v_mfma_f32_16x16x32_bf16 v[84:87], v[4:7], v[56:59], v[84:87]
    ds_read_b128 v[16:19], v74 offset:3072
    v_mfma_f32_16x16x32_bf16 v[88:91], v[8:11], v[52:55], v[88:91]
    v_mfma_f32_16x16x32_bf16 v[92:95], v[8:11], v[56:59], v[92:95]
    s_waitcnt lgkmcnt(0)
    v_mfma_f32_16x16x32_bf16 v[96:99], v[12:15], v[52:55], v[96:99]
    v_mfma_f32_16x16x32_bf16 v[100:103], v[12:15], v[56:59], v[100:103]
    v_mfma_f32_16x16x32_bf16 v[104:107], v[16:19], v[52:55], v[104:107]
    v_mfma_f32_16x16x32_bf16 v[108:111], v[16:19], v[56:59], v[108:111]
    v_cvt_pk_bf16_f32 v4, v80, v81
    v_cvt_pk_bf16_f32 v5, v82, v83
    v_cvt_pk_bf16_f32 v6, v88, v89
    v_cvt_pk_bf16_f32 v7, v90, v91
    buffer_store_dwordx4 v[4:7], v79, s[8:11], s81 offen offset:0 sc1
    v_cvt_pk_bf16_f32 v8, v84, v85
    v_cvt_pk_bf16_f32 v9, v86, v87
    v_cvt_pk_bf16_f32 v10, v92, v93
    v_cvt_pk_bf16_f32 v11, v94, v95
    buffer_store_dwordx4 v[8:11], v79, s[8:11], s81 offen offset:256 sc1
    s_add_u32 s81, s81, s82
    v_cvt_pk_bf16_f32 v12, v96, v97
    v_cvt_pk_bf16_f32 v13, v98, v99
    v_cvt_pk_bf16_f32 v14, v104, v105
    v_cvt_pk_bf16_f32 v15, v106, v107
    buffer_store_dwordx4 v[12:15], v79, s[8:11], s81 offen offset:0 sc1
    v_cvt_pk_bf16_f32 v16, v100, v101
    v_cvt_pk_bf16_f32 v17, v102, v103
    v_cvt_pk_bf16_f32 v18, v108, v109
    v_cvt_pk_bf16_f32 v19, v110, v111
    buffer_store_dwordx4 v[16:19], v79, s[8:11], s81 offen offset:256 sc1
    s_branch arm_50
f128_44:
    s_mov_b32 s72, 0
    s_waitcnt vmcnt(14)
    s_barrier
    v_add_u32 v74, s72, v72
    v_add_u32 v75, s72, v73
    v_xor_b32 v76, 32, v75
    s_add_u32 s72, s72, 16384
    s_and_b32 s72, s72, 0x1ffff
    ds_read_b128 v[4:7], v74 offset:0
    ds_read_b128 v[8:11], v74 offset:1024
    ds_read_b64_tr_b16 v[36:37], v75 offset:0
    ds_read_b64_tr_b16 v[38:39], v75 offset:1024
    ds_read_b64_tr_b16 v[40:41], v76 offset:0
    ds_read_b64_tr_b16 v[42:43], v76 offset:1024
    s_waitcnt lgkmcnt(0)
    v_mfma_f32_16x16x32_bf16 v[80:83], v[36:39], v[4:7], 0
    ds_read_b128 v[12:15], v74 offset:2048
    v_mfma_f32_16x16x32_bf16 v[84:87], v[40:43], v[4:7], 0
    ds_read_b128 v[16:19], v74 offset:3072
    v_mfma_f32_16x16x32_bf16 v[88:91], v[36:39], v[8:11], 0
    v_mfma_f32_16x16x32_bf16 v[92:95], v[40:43], v[8:11], 0
    s_waitcnt vmcnt(12) lgkmcnt(0)
    s_barrier
    v_mfma_f32_16x16x32_bf16 v[96:99], v[36:39], v[12:15], 0
    v_add_u32 v74, s72, v72
    v_add_u32 v75, s72, v73
    v_xor_b32 v76, 32, v75
    s_add_u32 s72, s72, 16384
    s_and_b32 s72, s72, 0x1ffff
    ds_read_b128 v[4:7], v74 offset:0
    v_mfma_f32_16x16x32_bf16 v[100:103], v[40:43], v[12:15], 0
    ds_read_b64_tr_b16 v[52:53], v75 offset:0
    ds_read_b64_tr_b16 v[54:55], v75 offset:1024
    ds_read_b64_tr_b16 v[56:57], v76 offset:0
    ds_read_b64_tr_b16 v[58:59], v76 offset:1024
    v_mfma_f32_16x16x32_bf16 v[104:107], v[36:39], v[16:19], 0
    ds_read_b128 v[8:11], v74 offset:1024
    s_mov_b32 m0, s71
    s_nop 0
    buffer_load_dwordx4 v68, s[60:63], s68 offen lds
    s_add_u32 m0, s71, 8192
    v_mfma_f32_16x16x32_bf16 v[108:111], v[40:43], v[16:19], 0
    buffer_load_dwordx4 v70, s[64:67], s69 offen lds
    s_add_u32 s68, s68, 64
    s_add_u32 s69, s69, s70
    s_add_u32 s71, s71, 16384
    s_and_b32 s71, s71, 0x1ffff
    s_waitcnt lgkmcnt(0)
    v_mfma_f32_16x16x32_bf16 v[80:83], v[52:55], v[4:7], v[80:83]
    ds_read_b128 v[12:15], v74 offset:2048
    v_mfma_f32_16x16x32_bf16 v[84:87], v[56:59], v[4:7], v[84:87]
    ds_read_b128 v[16:19], v74 offset:3072
    v_mfma_f32_16x16x32_bf16 v[88:91], v[52:55], v[8:11], v[88:91]
    v_mfma_f32_16x16x32_bf16 v[92:95], v[56:59], v[8:11], v[92:95]
    s_waitcnt vmcnt(12) lgkmcnt(0)
    s_barrier
    v_mfma_f32_16x16x32_bf16 v[96:99], v[52:55], v[12:15], v[96:99]
    v_add_u32 v74, s72, v72
    v_add_u32 v75, s72, v73
    v_xor_b32 v76, 32, v75
    s_add_u32 s72, s72, 16384
    s_and_b32 s72, s72, 0x1ffff
    ds_read_b128 v[4:7], v74 offset:0
    v_mfma_f32_16x16x32_bf16 v[100:103], v[56:59], v[12:15], v[100:103]
    ds_read_b64_tr_b16 v[36:37], v75 offset:0
    ds_read_b64_tr_b16 v[38:39], v75 offset:1024
    ds_read_b64_tr_b16 v[40:41], v76 offset:0
    ds_read_b64_tr_b16 v[42:43], v76 offset:1024
    v_mfma_f32_16x16x32_bf16 v[104:107], v[52:55], v[16:19], v[104:107]
    ds_read_b128 v[8:11], v74 offset:1024
    s_mov_b32 m0, s71
    s_nop 0
    buffer_load_dwordx4 v68, s[60:63], s68 offen lds
    s_add_u32 m0, s71, 8192
    v_mfma_f32_16x16x32_bf16 v[108:111], v[56:59], v[16:19], v[108:111]
    buffer_load_dwordx4 v70, s[64:67], s69 offen lds
    s_add_u32 s68, s68, 64
    s_add_u32 s69, s69, s70
    s_add_u32 s71, s71, 16384
    s_and_b32 s71, s71, 0x1ffff
    s_mov_b32 s73, 11
gl_54:
    s_waitcnt lgkmcnt(0)
    v_mfma_f32_16x16x32_bf16 v[80:83], v[36:39], v[4:7], v[80:83]
    ds_read_b128 v[12:15], v74 offset:2048
    v_mfma_f32_16x16x32_bf16 v[84:87], v[40:43], v[4:7], v[84:87]
    ds_read_b128 v[16:19], v74 offset:3072
    v_mfma_f32_16x16x32_bf16 v[88:91], v[36:39], v[8:11], v[88:91]
    v_mfma_f32_16x16x32_bf16 v[92:95], v[40:43], v[8:11], v[92:95]
    s_waitcnt vmcnt(12) lgkmcnt(0)
    s_barrier
    v_mfma_f32_16x16x32_bf16 v[96:99], v[36:39], v[12:15], v[96:99]
    v_add_u32 v74, s72, v72
    v_add_u32 v75, s72, v73
    v_xor_b32 v76, 32, v75
    s_add_u32 s72, s72, 16384
    s_and_b32 s72, s72, 0x1ffff
    ds_read_b128 v[4:7], v74 offset:0
    v_mfma_f32_16x16x32_bf16 v[100:103], v[40:43], v[12:15], v[100:103]
    ds_read_b64_tr_b16 v[52:53], v75 offset:0
    ds_read_b64_tr_b16 v[54:55], v75 offset:1024
    ds_read_b64_tr_b16 v[56:57], v76 offset:0
    ds_read_b64_tr_b16 v[58:59], v76 offset:1024
    v_mfma_f32_16x16x32_bf16 v[104:107], v[36:39], v[16:19], v[104:107]
    ds_read_b128 v[8:11], v74 offset:1024
    s_mov_b32 m0, s71
    s_nop 0
    buffer_load_dwordx4 v68, s[60:63], s68 offen lds
    s_add_u32 m0, s71, 8192
    v_mfma_f32_16x16x32_bf16 v[108:111], v[40:43], v[16:19], v[108:111]
    buffer_load_dwordx4 v70, s[64:67], s69 offen lds
    s_add_u32 s68, s68, 64
    s_add_u32 s69, s69, s70
    s_add_u32 s71, s71, 16384
    s_and_b32 s71, s71, 0x1ffff
    s_waitcnt lgkmcnt(0)
    v_mfma_f32_16x16x32_bf16 v[80:83], v[52:55], v[4:7], v[80:83]
    ds_read_b128 v[12:15], v74 offset:2048
    v_mfma_f32_16x16x32_bf16 v[84:87], v[56:59], v[4:7], v[84:87]
    ds_read_b128 v[16:19], v74 offset:3072
    v_mfma_f32_16x16x32_bf16 v[88:91], v[52:55], v[8:11], v[88:91]
    v_mfma_f32_16x16x32_bf16 v[92:95], v[56:59], v[8:11], v[92:95]
    s_waitcnt vmcnt(12) lgkmcnt(0)
    s_barrier
    v_mfma_f32_16x16x32_bf16 v[96:99], v[52:55], v[12:15], v[96:99]
    v_add_u32 v74, s72, v72
    v_add_u32 v75, s72, v73
    v_xor_b32 v76, 32, v75
    s_add_u32 s72, s72, 16384
    s_and_b32 s72, s72, 0x1ffff
    ds_read_b128 v[4:7], v74 offset:0
    v_mfma_f32_16x16x32_bf16 v[100:103], v[56:59], v[12:15], v[100:103]
    ds_read_b64_tr_b16 v[36:37], v75 offset:0
    ds_read_b64_tr_b16 v[38:39], v75 offset:1024
    ds_read_b64_tr_b16 v[40:41], v76 offset:0
    ds_read_b64_tr_b16 v[42:43], v76 offset:1024
    v_mfma_f32_16x16x32_bf16 v[104:107], v[52:55], v[16:19], v[104:107]
    ds_read_b128 v[8:11], v74 offset:1024
    s_mov_b32 m0, s71
    s_nop 0
    buffer_load_dwordx4 v68, s[60:63], s68 offen lds
    s_add_u32 m0, s71, 8192
    v_mfma_f32_16x16x32_bf16 v[108:111], v[56:59], v[16:19], v[108:111]
    buffer_load_dwordx4 v70, s[64:67], s69 offen lds
    s_add_u32 s68, s68, 64
    s_add_u32 s69, s69, s70
    s_add_u32 s71, s71, 16384
    s_and_b32 s71, s71, 0x1ffff
    s_sub_u32 s73, s73, 1
    s_cmp_lg_u32 s73, 0
    s_cbranch_scc1 gl_54
    s_waitcnt lgkmcnt(0)
    v_mfma_f32_16x16x32_bf16 v[80:83], v[36:39], v[4:7], v[80:83]
    ds_read_b128 v[12:15], v74 offset:2048
    v_mfma_f32_16x16x32_bf16 v[84:87], v[40:43], v[4:7], v[84:87]
    ds_read_b128 v[16:19], v74 offset:3072
    v_mfma_f32_16x16x32_bf16 v[88:91], v[36:39], v[8:11], v[88:91]
    v_mfma_f32_16x16x32_bf16 v[92:95], v[40:43], v[8:11], v[92:95]
    s_waitcnt vmcnt(12) lgkmcnt(0)
    s_barrier
    v_mfma_f32_16x16x32_bf16 v[96:99], v[36:39], v[12:15], v[96:99]
    v_add_u32 v74, s72, v72
    v_add_u32 v75, s72, v73
    v_xor_b32 v76, 32, v75
    s_add_u32 s72, s72, 16384
    s_and_b32 s72, s72, 0x1ffff
    v_mfma_f32_16x16x32_bf16 v[100:103], v[40:43], v[12:15], v[100:103]
    ds_read_b128 v[4:7], v74 offset:0
    ds_read_b64_tr_b16 v[52:53], v75 offset:0
    v_mfma_f32_16x16x32_bf16 v[104:107], v[36:39], v[16:19], v[104:107]
    ds_read_b64_tr_b16 v[54:55], v75 offset:1024
    ds_read_b64_tr_b16 v[56:57], v76 offset:0
    v_mfma_f32_16x16x32_bf16 v[108:111], v[40:43], v[16:19], v[108:111]
    ds_read_b64_tr_b16 v[58:59], v76 offset:1024
    ds_read_b128 v[8:11], v74 offset:1024
    s_waitcnt lgkmcnt(0)
    v_mfma_f32_16x16x32_bf16 v[80:83], v[52:55], v[4:7], v[80:83]
    ds_read_b128 v[12:15], v74 offset:2048
    v_mfma_f32_16x16x32_bf16 v[84:87], v[56:59], v[4:7], v[84:87]
    ds_read_b128 v[16:19], v74 offset:3072
    v_mfma_f32_16x16x32_bf16 v[88:91], v[52:55], v[8:11], v[88:91]
    v_mfma_f32_16x16x32_bf16 v[92:95], v[56:59], v[8:11], v[92:95]
    s_waitcnt vmcnt(10) lgkmcnt(0)
    s_barrier
    v_mfma_f32_16x16x32_bf16 v[96:99], v[52:55], v[12:15], v[96:99]
    v_add_u32 v74, s72, v72
    v_add_u32 v75, s72, v73
    v_xor_b32 v76, 32, v75
    s_add_u32 s72, s72, 16384
    s_and_b32 s72, s72, 0x1ffff
    v_mfma_f32_16x16x32_bf16 v[100:103], v[56:59], v[12:15], v[100:103]
    ds_read_b128 v[4:7], v74 offset:0
    ds_read_b64_tr_b16 v[36:37], v75 offset:0
    v_mfma_f32_16x16x32_bf16 v[104:107], v[52:55], v[16:19], v[104:107]
    ds_read_b64_tr_b16 v[38:39], v75 offset:1024
    ds_read_b64_tr_b16 v[40:41], v76 offset:0
    v_mfma_f32_16x16x32_bf16 v[108:111], v[56:59], v[16:19], v[108:111]
    ds_read_b64_tr_b16 v[42:43], v76 offset:1024
    ds_read_b128 v[8:11], v74 offset:1024
    s_waitcnt lgkmcnt(0)
    v_mfma_f32_16x16x32_bf16 v[80:83], v[36:39], v[4:7], v[80:83]
    ds_read_b128 v[12:15], v74 offset:2048
    v_mfma_f32_16x16x32_bf16 v[84:87], v[40:43], v[4:7], v[84:87]
    ds_read_b128 v[16:19], v74 offset:3072
    v_mfma_f32_16x16x32_bf16 v[88:91], v[36:39], v[8:11], v[88:91]
    v_mfma_f32_16x16x32_bf16 v[92:95], v[40:43], v[8:11], v[92:95]
    s_waitcnt vmcnt(8) lgkmcnt(0)
    s_barrier
    v_mfma_f32_16x16x32_bf16 v[96:99], v[36:39], v[12:15], v[96:99]
    v_add_u32 v74, s72, v72
    v_add_u32 v75, s72, v73
    v_xor_b32 v76, 32, v75
    s_add_u32 s72, s72, 16384
    s_and_b32 s72, s72, 0x1ffff
    v_mfma_f32_16x16x32_bf16 v[100:103], v[40:43], v[12:15], v[100:103]
    ds_read_b128 v[4:7], v74 offset:0
    ds_read_b64_tr_b16 v[52:53], v75 offset:0
    v_mfma_f32_16x16x32_bf16 v[104:107], v[36:39], v[16:19], v[104:107]
    ds_read_b64_tr_b16 v[54:55], v75 offset:1024
    ds_read_b64_tr_b16 v[56:57], v76 offset:0
    v_mfma_f32_16x16x32_bf16 v[108:111], v[40:43], v[16:19], v[108:111]
    ds_read_b64_tr_b16 v[58:59], v76 offset:1024
    ds_read_b128 v[8:11], v74 offset:1024
    s_waitcnt lgkmcnt(0)
    v_mfma_f32_16x16x32_bf16 v[80:83], v[52:55], v[4:7], v[80:83]
    ds_read_b128 v[12:15], v74 offset:2048
    v_mfma_f32_16x16x32_bf16 v[84:87], v[56:59], v[4:7], v[84:87]
    ds_read_b128 v[16:19], v74 offset:3072
    v_mfma_f32_16x16x32_bf16 v[88:91], v[52:55], v[8:11], v[88:91]
    v_mfma_f32_16x16x32_bf16 v[92:95], v[56:59], v[8:11], v[92:95]
    s_waitcnt vmcnt(6) lgkmcnt(0)
    s_barrier
    v_mfma_f32_16x16x32_bf16 v[96:99], v[52:55], v[12:15], v[96:99]
    v_add_u32 v74, s72, v72
    v_add_u32 v75, s72, v73
    v_xor_b32 v76, 32, v75
    s_add_u32 s72, s72, 16384
    s_and_b32 s72, s72, 0x1ffff
    v_mfma_f32_16x16x32_bf16 v[100:103], v[56:59], v[12:15], v[100:103]
    ds_read_b128 v[4:7], v74 offset:0
    ds_read_b64_tr_b16 v[36:37], v75 offset:0
    v_mfma_f32_16x16x32_bf16 v[104:107], v[52:55], v[16:19], v[104:107]
    ds_read_b64_tr_b16 v[38:39], v75 offset:1024
    ds_read_b64_tr_b16 v[40:41], v76 offset:0
    v_mfma_f32_16x16x32_bf16 v[108:111], v[56:59], v[16:19], v[108:111]
    ds_read_b64_tr_b16 v[42:43], v76 offset:1024
    ds_read_b128 v[8:11], v74 offset:1024
    s_waitcnt lgkmcnt(0)
    v_mfma_f32_16x16x32_bf16 v[80:83], v[36:39], v[4:7], v[80:83]
    ds_read_b128 v[12:15], v74 offset:2048
    v_mfma_f32_16x16x32_bf16 v[84:87], v[40:43], v[4:7], v[84:87]
    ds_read_b128 v[16:19], v74 offset:3072
    v_mfma_f32_16x16x32_bf16 v[88:91], v[36:39], v[8:11], v[88:91]
    v_mfma_f32_16x16x32_bf16 v[92:95], v[40:43], v[8:11], v[92:95]
    s_waitcnt vmcnt(4) lgkmcnt(0)
    s_barrier
    v_mfma_f32_16x16x32_bf16 v[96:99], v[36:39], v[12:15], v[96:99]
    v_add_u32 v74, s72, v72
    v_add_u32 v75, s72, v73
    v_xor_b32 v76, 32, v75
    s_add_u32 s72, s72, 16384
    s_and_b32 s72, s72, 0x1ffff
    v_mfma_f32_16x16x32_bf16 v[100:103], v[40:43], v[12:15], v[100:103]
    ds_read_b128 v[4:7], v74 offset:0
    ds_read_b64_tr_b16 v[52:53], v75 offset:0
    v_mfma_f32_16x16x32_bf16 v[104:107], v[36:39], v[16:19], v[104:107]
    ds_read_b64_tr_b16 v[54:55], v75 offset:1024
    ds_read_b64_tr_b16 v[56:57], v76 offset:0
    v_mfma_f32_16x16x32_bf16 v[108:111], v[40:43], v[16:19], v[108:111]
    ds_read_b64_tr_b16 v[58:59], v76 offset:1024
    ds_read_b128 v[8:11], v74 offset:1024
    s_waitcnt lgkmcnt(0)
    v_mfma_f32_16x16x32_bf16 v[80:83], v[52:55], v[4:7], v[80:83]
    ds_read_b128 v[12:15], v74 offset:2048
    v_mfma_f32_16x16x32_bf16 v[84:87], v[56:59], v[4:7], v[84:87]
    ds_read_b128 v[16:19], v74 offset:3072
    v_mfma_f32_16x16x32_bf16 v[88:91], v[52:55], v[8:11], v[88:91]
    v_mfma_f32_16x16x32_bf16 v[92:95], v[56:59], v[8:11], v[92:95]
    s_waitcnt vmcnt(2) lgkmcnt(0)
    s_barrier
    v_mfma_f32_16x16x32_bf16 v[96:99], v[52:55], v[12:15], v[96:99]
    v_add_u32 v74, s72, v72
    v_add_u32 v75, s72, v73
    v_xor_b32 v76, 32, v75
    s_add_u32 s72, s72, 16384
    s_and_b32 s72, s72, 0x1ffff
    v_mfma_f32_16x16x32_bf16 v[100:103], v[56:59], v[12:15], v[100:103]
    ds_read_b128 v[4:7], v74 offset:0
    ds_read_b64_tr_b16 v[36:37], v75 offset:0
    v_mfma_f32_16x16x32_bf16 v[104:107], v[52:55], v[16:19], v[104:107]
    ds_read_b64_tr_b16 v[38:39], v75 offset:1024
    ds_read_b64_tr_b16 v[40:41], v76 offset:0
    v_mfma_f32_16x16x32_bf16 v[108:111], v[56:59], v[16:19], v[108:111]
    ds_read_b64_tr_b16 v[42:43], v76 offset:1024
    ds_read_b128 v[8:11], v74 offset:1024
    s_waitcnt lgkmcnt(0)
    v_mfma_f32_16x16x32_bf16 v[80:83], v[36:39], v[4:7], v[80:83]
    ds_read_b128 v[12:15], v74 offset:2048
    v_mfma_f32_16x16x32_bf16 v[84:87], v[40:43], v[4:7], v[84:87]
    ds_read_b128 v[16:19], v74 offset:3072
    v_mfma_f32_16x16x32_bf16 v[88:91], v[36:39], v[8:11], v[88:91]
    v_mfma_f32_16x16x32_bf16 v[92:95], v[40:43], v[8:11], v[92:95]
    s_waitcnt vmcnt(0) lgkmcnt(0)
    s_barrier
    v_mfma_f32_16x16x32_bf16 v[96:99], v[36:39], v[12:15], v[96:99]
    v_add_u32 v74, s72, v72
    v_add_u32 v75, s72, v73
    v_xor_b32 v76, 32, v75
    s_add_u32 s72, s72, 16384
    s_and_b32 s72, s72, 0x1ffff
    v_mfma_f32_16x16x32_bf16 v[100:103], v[40:43], v[12:15], v[100:103]
    ds_read_b128 v[4:7], v74 offset:0
    ds_read_b64_tr_b16 v[52:53], v75 offset:0
    v_mfma_f32_16x16x32_bf16 v[104:107], v[36:39], v[16:19], v[104:107]
    ds_read_b64_tr_b16 v[54:55], v75 offset:1024
    ds_read_b64_tr_b16 v[56:57], v76 offset:0
    v_mfma_f32_16x16x32_bf16 v[108:111], v[40:43], v[16:19], v[108:111]
    ds_read_b64_tr_b16 v[58:59], v76 offset:1024
    ds_read_b128 v[8:11], v74 offset:1024
    s_waitcnt lgkmcnt(0)
    v_mfma_f32_16x16x32_bf16 v[80:83], v[52:55], v[4:7], v[80:83]
    ds_read_b128 v[12:15], v74 offset:2048
    v_mfma_f32_16x16x32_bf16 v[84:87], v[56:59], v[4:7], v[84:87]
    ds_read_b128 v[16:19], v74 offset:3072
    v_mfma_f32_16x16x32_bf16 v[88:91], v[52:55], v[8:11], v[88:91]
    v_mfma_f32_16x16x32_bf16 v[92:95], v[56:59], v[8:11], v[92:95]
    s_waitcnt lgkmcnt(0)
    v_mfma_f32_16x16x32_bf16 v[96:99], v[52:55], v[12:15], v[96:99]
    v_mfma_f32_16x16x32_bf16 v[100:103], v[56:59], v[12:15], v[100:103]
    v_mfma_f32_16x16x32_bf16 v[104:107], v[52:55], v[16:19], v[104:107]
    v_mfma_f32_16x16x32_bf16 v[108:111], v[56:59], v[16:19], v[108:111]
    v_cvt_pk_bf16_f32 v4, v80, v81
    v_cvt_pk_bf16_f32 v5, v82, v83
    v_cvt_pk_bf16_f32 v6, v84, v85
    v_cvt_pk_bf16_f32 v7, v86, v87
    buffer_store_dwordx4 v[4:7], v79, s[8:11], s81 offen offset:0 sc1
    v_cvt_pk_bf16_f32 v8, v88, v89
    v_cvt_pk_bf16_f32 v9, v90, v91
    v_cvt_pk_bf16_f32 v10, v92, v93
    v_cvt_pk_bf16_f32 v11, v94, v95
    buffer_store_dwordx4 v[8:11], v79, s[8:11], s81 offen offset:256 sc1
    s_add_u32 s81, s81, s82
    v_cvt_pk_bf16_f32 v12, v96, v97
    v_cvt_pk_bf16_f32 v13, v98, v99
    v_cvt_pk_bf16_f32 v14, v100, v101
    v_cvt_pk_bf16_f32 v15, v102, v103
    buffer_store_dwordx4 v[12:15], v79, s[8:11], s81 offen offset:0 sc1
    v_cvt_pk_bf16_f32 v16, v104, v105
    v_cvt_pk_bf16_f32 v17, v106, v107
    v_cvt_pk_bf16_f32 v18, v108, v109
    v_cvt_pk_bf16_f32 v19, v110, v111
    buffer_store_dwordx4 v[16:19], v79, s[8:11], s81 offen offset:256 sc1
arm_50:
    s_cmp_eq_u32 s78, 0
    s_cbranch_scc1 next_48
    v_mov_b32 v132, -1
    v_mov_b32 v136, 0
    v_mov_b32 v133, -1
    v_mov_b32 v137, 0
    v_mov_b32 v134, -1
    v_mov_b32 v138, 0
    v_mov_b32 v135, -1
    v_mov_b32 v139, 0
    v_bfe_u32 v112, v1, 0, 4
    v_lshlrev_b32 v112, 4, v112
    v_bfe_u32 v113, v1, 4, 1
    v_lshl_or_b32 v112, v113, 18, v112
    v_bfe_u32 v113, v1, 5, 1
    v_lshl_or_b32 v112, v113, 22, v112
    s_lshl_b32 s84, s76, 3
    s_add_u32 s84, s84, s58
    s_lshl_b32 s81, s84, 13
    s_lshl_b32 s84, s84, 8
    s_add_u32 s84, s84, 0x4380000
    buffer_store_dwordx4 v[132:135], v112, s[8:11], s84 offen sc1
    v_lshlrev_b32 v113, 4, v1
    buffer_store_dwordx4 v[136:139], v113, s[16:19], s81 offen offset:2048 sc1
    buffer_store_dwordx4 v[136:139], v113, s[16:19], s81 offen offset:3072 sc1
    s_add_u32 s81, s81, 4096
    buffer_store_dwordx4 v[136:139], v113, s[16:19], s81 offen offset:2048 sc1
    buffer_store_dwordx4 v[136:139], v113, s[16:19], s81 offen offset:3072 sc1
    v_bfe_u32 v114, v1, 0, 4
    v_lshlrev_b32 v114, 9, v114
    s_lshl_b32 s84, s76, 2
    s_add_u32 s84, s84, 0x5100000
    v_mov_b32 v115, 0
    buffer_store_dword v115, v114, s[8:11], s84 offen
    s_lshl_b32 s84, s76, 3
    s_add_u32 s84, s84, s58
    v_lshlrev_b32 v116, 3, v1
    v_mul_u32_u24 v116, s84, v116
    v_and_b32 v117, 0x3ff, v116
    v_cvt_f32_u32 v117, v117
    v_mul_f32 v117, 0x3a800000, v117
    v_cos_f32 v118, v117
    v_sin_f32 v119, -v117
    v_add_u32 v116, s84, v116
    v_cvt_pk_bf16_f32 v122, v118, v119
    v_and_b32 v117, 0x3ff, v116
    v_cvt_f32_u32 v117, v117
    v_mul_f32 v117, 0x3a800000, v117
    v_cos_f32 v118, v117
    v_sin_f32 v119, -v117
    v_add_u32 v116, s84, v116
    v_cvt_pk_bf16_f32 v123, v118, v119
    v_and_b32 v117, 0x3ff, v116
    v_cvt_f32_u32 v117, v117
    v_mul_f32 v117, 0x3a800000, v117
    v_cos_f32 v118, v117
    v_sin_f32 v119, -v117
    v_add_u32 v116, s84, v116
    v_cvt_pk_bf16_f32 v124, v118, v119
    v_and_b32 v117, 0x3ff, v116
    v_cvt_f32_u32 v117, v117
    v_mul_f32 v117, 0x3a800000, v117
    v_cos_f32 v118, v117
    v_sin_f32 v119, -v117
    v_add_u32 v116, s84, v116
    v_cvt_pk_bf16_f32 v125, v118, v119
    v_and_b32 v117, 0x3ff, v116
    v_cvt_f32_u32 v117, v117
    v_mul_f32 v117, 0x3a800000, v117
    v_cos_f32 v118, v117
    v_sin_f32 v119, -v117
    v_add_u32 v116, s84, v116
    v_cvt_pk_bf16_f32 v126, v118, v119
    v_and_b32 v117, 0x3ff, v116
    v_cvt_f32_u32 v117, v117
    v_mul_f32 v117, 0x3a800000, v117
    v_cos_f32 v118, v117
    v_sin_f32 v119, -v117
    v_add_u32 v116, s84, v116
    v_cvt_pk_bf16_f32 v127, v118, v119
    v_and_b32 v117, 0x3ff, v116
    v_cvt_f32_u32 v117, v117
    v_mul_f32 v117, 0x3a800000, v117
    v_cos_f32 v118, v117
    v_sin_f32 v119, -v117
    v_add_u32 v116, s84, v116
    v_cvt_pk_bf16_f32 v128, v118, v119
    v_and_b32 v117, 0x3ff, v116
    v_cvt_f32_u32 v117, v117
    v_mul_f32 v117, 0x3a800000, v117
    v_cos_f32 v118, v117
    v_sin_f32 v119, -v117
    v_add_u32 v116, s84, v116
    v_cvt_pk_bf16_f32 v129, v118, v119
    v_mov_b32 v117, s84
    v_lshlrev_b32 v117, 31, v117
    v_or_b32 v117, 0x3f803f80, v117
    v_cmp_eq_u32 vcc, 0, v1
    s_nop 1
    v_cndmask_b32 v122, v122, v117, vcc
    v_lshlrev_b32 v120, 5, v1
    s_lshl_b32 s84, s84, 11
    s_add_u32 s84, s84, 0x5200000
    buffer_store_dwordx4 v[122:125], v120, s[8:11], s84 offen sc1
    buffer_store_dwordx4 v[126:129], v120, s[8:11], s84 offen offset:16 sc1
    s_branch next_48
f256_46:
    s_mov_b32 s72, 0
    s_waitcnt vmcnt(12)
    s_barrier
    v_add_u32 v74, s72, v72
    v_add_u32 v75, s72, v73
    v_xor_b32 v76, 32, v75
    v_xor_b32 v77, 64, v75
    v_xor_b32 v78, 96, v75
    s_add_u32 s72, s72, 32768
    s_and_b32 s72, s72, 0x1ffff
    ds_read_b128 v[4:7], v74 offset:0
    ds_read_b128 v[8:11], v74 offset:1024
    ds_read_b128 v[12:15], v74 offset:2048
    ds_read_b128 v[16:19], v74 offset:3072
    ds_read_b64_tr_b16 v[36:37], v75 offset:0
    ds_read_b64_tr_b16 v[38:39], v75 offset:2048
    ds_read_b64_tr_b16 v[40:41], v76 offset:0
    ds_read_b64_tr_b16 v[42:43], v76 offset:2048
    ds_read_b64_tr_b16 v[44:45], v77 offset:0
    ds_read_b64_tr_b16 v[46:47], v77 offset:2048
    ds_read_b64_tr_b16 v[48:49], v78 offset:0
    ds_read_b64_tr_b16 v[50:51], v78 offset:2048
    s_waitcnt lgkmcnt(0)
    v_mfma_f32_16x16x32_bf16 v[80:83], v[36:39], v[4:7], 0
    ds_read_b128 v[20:23], v74 offset:4096
    v_mfma_f32_16x16x32_bf16 v[84:87], v[40:43], v[4:7], 0
    v_mfma_f32_16x16x32_bf16 v[88:91], v[44:47], v[4:7], 0
    ds_read_b128 v[24:27], v74 offset:5120
    v_mfma_f32_16x16x32_bf16 v[92:95], v[48:51], v[4:7], 0
    v_mfma_f32_16x16x32_bf16 v[96:99], v[36:39], v[8:11], 0
    ds_read_b128 v[28:31], v74 offset:6144
    v_mfma_f32_16x16x32_bf16 v[100:103], v[40:43], v[8:11], 0
    v_mfma_f32_16x16x32_bf16 v[104:107], v[44:47], v[8:11], 0
    ds_read_b128 v[32:35], v74 offset:7168
    v_mfma_f32_16x16x32_bf16 v[108:111], v[48:51], v[8:11], 0
    v_mfma_f32_16x16x32_bf16 v[112:115], v[36:39], v[12:15], 0
    v_mfma_f32_16x16x32_bf16 v[116:119], v[40:43], v[12:15], 0
    v_mfma_f32_16x16x32_bf16 v[120:123], v[44:47], v[12:15], 0
    v_mfma_f32_16x16x32_bf16 v[124:127], v[48:51], v[12:15], 0
    v_mfma_f32_16x16x32_bf16 v[128:131], v[36:39], v[16:19], 0
    v_mfma_f32_16x16x32_bf16 v[132:135], v[40:43], v[16:19], 0
    v_mfma_f32_16x16x32_bf16 v[136:139], v[44:47], v[16:19], 0
    v_mfma_f32_16x16x32_bf16 v[140:143], v[48:51], v[16:19], 0
    s_waitcnt vmcnt(8) lgkmcnt(0)
    s_barrier
    v_mfma_f32_16x16x32_bf16 v[144:147], v[36:39], v[20:23], 0
    v_add_u32 v74, s72, v72
    v_add_u32 v75, s72, v73
    v_xor_b32 v76, 32, v75
    v_xor_b32 v77, 64, v75
    v_xor_b32 v78, 96, v75
    v_mfma_f32_16x16x32_bf16 v[148:151], v[40:43], v[20:23], 0
    s_add_u32 s72, s72, 32768
    s_and_b32 s72, s72, 0x1ffff
    ds_read_b128 v[4:7], v74 offset:0
    v_mfma_f32_16x16x32_bf16 v[152:155], v[44:47], v[20:23], 0
    ds_read_b64_tr_b16 v[52:53], v75 offset:0
    v_mfma_f32_16x16x32_bf16 v[156:159], v[48:51], v[20:23], 0
    ds_read_b64_tr_b16 v[54:55], v75 offset:2048
    ds_read_b64_tr_b16 v[56:57], v76 offset:0
    v_mfma_f32_16x16x32_bf16 v[160:163], v[36:39], v[24:27], 0
    ds_read_b64_tr_b16 v[58:59], v76 offset:2048
    v_mfma_f32_16x16x32_bf16 v[164:167], v[40:43], v[24:27], 0
    ds_read_b64_tr_b16 v[60:61], v77 offset:0
    ds_read_b64_tr_b16 v[62:63], v77 offset:2048
    v_mfma_f32_16x16x32_bf16 v[168:171], v[44:47], v[24:27], 0
    ds_read_b64_tr_b16 v[64:65], v78 offset:0
    v_mfma_f32_16x16x32_bf16 v[172:175], v[48:51], v[24:27], 0
    ds_read_b64_tr_b16 v[66:67], v78 offset:2048
    ds_read_b128 v[8:11], v74 offset:1024
    v_mfma_f32_16x16x32_bf16 v[176:179], v[36:39], v[28:31], 0
    ds_read_b128 v[12:15], v74 offset:2048
    ds_read_b128 v[16:19], v74 offset:3072
    v_mfma_f32_16x16x32_bf16 v[180:183], v[40:43], v[28:31], 0
    s_mov_b32 m0, s71
    v_mfma_f32_16x16x32_bf16 v[184:187], v[44:47], v[28:31], 0
    buffer_load_dwordx4 v68, s[60:63], s68 offen lds
    s_add_u32 m0, s71, 1024
    v_mfma_f32_16x16x32_bf16 v[188:191], v[48:51], v[28:31], 0
    buffer_load_dwordx4 v69, s[60:63], s68 offen lds
    v_mfma_f32_16x16x32_bf16 v[192:195], v[36:39], v[32:35], 0
    s_add_u32 m0, s71, 16384
    s_nop 0
    buffer_load_dwordx4 v70, s[64:67], s69 offen lds
    v_mfma_f32_16x16x32_bf16 v[196:199], v[40:43], v[32:35], 0
    s_add_u32 m0, s71, 17408
    v_mfma_f32_16x16x32_bf16 v[200:203], v[44:47], v[32:35], 0
    buffer_load_dwordx4 v71, s[64:67], s69 offen lds
    s_add_u32 s68, s68, 64
    s_add_u32 s69, s69, s70
    v_mfma_f32_16x16x32_bf16 v[204:207], v[48:51], v[32:35], 0
    s_add_u32 s71, s71, 32768
    s_and_b32 s71, s71, 0x1ffff
    s_waitcnt lgkmcnt(0)
    v_mfma_f32_16x16x32_bf16 v[80:83], v[52:55], v[4:7], v[80:83]
    ds_read_b128 v[20:23], v74 offset:4096
    v_mfma_f32_16x16x32_bf16 v[84:87], v[56:59], v[4:7], v[84:87]
    v_mfma_f32_16x16x32_bf16 v[88:91], v[60:63], v[4:7], v[88:91]
    ds_read_b128 v[24:27], v74 offset:5120
    v_mfma_f32_16x16x32_bf16 v[92:95], v[64:67], v[4:7], v[92:95]
    v_mfma_f32_16x16x32_bf16 v[96:99], v[52:55], v[8:11], v[96:99]
    ds_read_b128 v[28:31], v74 offset:6144
    v_mfma_f32_16x16x32_bf16 v[100:103], v[56:59], v[8:11], v[100:103]
    v_mfma_f32_16x16x32_bf16 v[104:107], v[60:63], v[8:11], v[104:107]
    ds_read_b128 v[32:35], v74 offset:7168
    v_mfma_f32_16x16x32_bf16 v[108:111], v[64:67], v[8:11], v[108:111]
    v_mfma_f32_16x16x32_bf16 v[112:115], v[52:55], v[12:15], v[112:115]
    v_mfma_f32_16x16x32_bf16 v[116:119], v[56:59], v[12:15], v[116:119]
    v_mfma_f32_16x16x32_bf16 v[120:123], v[60:63], v[12:15], v[120:123]
    v_mfma_f32_16x16x32_bf16 v[124:127], v[64:67], v[12:15], v[124:127]
    v_mfma_f32_16x16x32_bf16 v[128:131], v[52:55], v[16:19], v[128:131]
    v_mfma_f32_16x16x32_bf16 v[132:135], v[56:59], v[16:19], v[132:135]
    v_mfma_f32_16x16x32_bf16 v[136:139], v[60:63], v[16:19], v[136:139]
    v_mfma_f32_16x16x32_bf16 v[140:143], v[64:67], v[16:19], v[140:143]
    s_waitcnt vmcnt(8) lgkmcnt(0)
    s_barrier
    v_mfma_f32_16x16x32_bf16 v[144:147], v[52:55], v[20:23], v[144:147]
    v_add_u32 v74, s72, v72
    v_add_u32 v75, s72, v73
    v_xor_b32 v76, 32, v75
    v_xor_b32 v77, 64, v75
    v_xor_b32 v78, 96, v75
    v_mfma_f32_16x16x32_bf16 v[148:151], v[56:59], v[20:23], v[148:151]
    s_add_u32 s72, s72, 32768
    s_and_b32 s72, s72, 0x1ffff
    ds_read_b128 v[4:7], v74 offset:0
    v_mfma_f32_16x16x32_bf16 v[152:155], v[60:63], v[20:23], v[152:155]
    ds_read_b64_tr_b16 v[36:37], v75 offset:0
    v_mfma_f32_16x16x32_bf16 v[156:159], v[64:67], v[20:23], v[156:159]
    ds_read_b64_tr_b16 v[38:39], v75 offset:2048
    ds_read_b64_tr_b16 v[40:41], v76 offset:0
    v_mfma_f32_16x16x32_bf16 v[160:163], v[52:55], v[24:27], v[160:163]
    ds_read_b64_tr_b16 v[42:43], v76 offset:2048
    v_mfma_f32_16x16x32_bf16 v[164:167], v[56:59], v[24:27], v[164:167]
    ds_read_b64_tr_b16 v[44:45], v77 offset:0
    ds_read_b64_tr_b16 v[46:47], v77 offset:2048
    v_mfma_f32_16x16x32_bf16 v[168:171], v[60:63], v[24:27], v[168:171]
    ds_read_b64_tr_b16 v[48:49], v78 offset:0
    v_mfma_f32_16x16x32_bf16 v[172:175], v[64:67], v[24:27], v[172:175]
    ds_read_b64_tr_b16 v[50:51], v78 offset:2048
    ds_read_b128 v[8:11], v74 offset:1024
    v_mfma_f32_16x16x32_bf16 v[176:179], v[52:55], v[28:31], v[176:179]
    ds_read_b128 v[12:15], v74 offset:2048
    ds_read_b128 v[16:19], v74 offset:3072
    v_mfma_f32_16x16x32_bf16 v[180:183], v[56:59], v[28:31], v[180:183]
    s_mov_b32 m0, s71
    v_mfma_f32_16x16x32_bf16 v[184:187], v[60:63], v[28:31], v[184:187]
    buffer_load_dwordx4 v68, s[60:63], s68 offen lds
    s_add_u32 m0, s71, 1024
    v_mfma_f32_16x16x32_bf16 v[188:191], v[64:67], v[28:31], v[188:191]
    buffer_load_dwordx4 v69, s[60:63], s68 offen lds
    v_mfma_f32_16x16x32_bf16 v[192:195], v[52:55], v[32:35], v[192:195]
    s_add_u32 m0, s71, 16384
    s_nop 0
    buffer_load_dwordx4 v70, s[64:67], s69 offen lds
    v_mfma_f32_16x16x32_bf16 v[196:199], v[56:59], v[32:35], v[196:199]
    s_add_u32 m0, s71, 17408
    v_mfma_f32_16x16x32_bf16 v[200:203], v[60:63], v[32:35], v[200:203]
    buffer_load_dwordx4 v71, s[64:67], s69 offen lds
    s_add_u32 s68, s68, 64
    s_add_u32 s69, s69, s70
    v_mfma_f32_16x16x32_bf16 v[204:207], v[64:67], v[32:35], v[204:207]
    s_add_u32 s71, s71, 32768
    s_and_b32 s71, s71, 0x1ffff
    s_mov_b32 s73, 13
gl_55:
    s_waitcnt lgkmcnt(0)
    v_mfma_f32_16x16x32_bf16 v[80:83], v[36:39], v[4:7], v[80:83]
    ds_read_b128 v[20:23], v74 offset:4096
    v_mfma_f32_16x16x32_bf16 v[84:87], v[40:43], v[4:7], v[84:87]
    v_mfma_f32_16x16x32_bf16 v[88:91], v[44:47], v[4:7], v[88:91]
    ds_read_b128 v[24:27], v74 offset:5120
    v_mfma_f32_16x16x32_bf16 v[92:95], v[48:51], v[4:7], v[92:95]
    v_mfma_f32_16x16x32_bf16 v[96:99], v[36:39], v[8:11], v[96:99]
    ds_read_b128 v[28:31], v74 offset:6144
    v_mfma_f32_16x16x32_bf16 v[100:103], v[40:43], v[8:11], v[100:103]
    v_mfma_f32_16x16x32_bf16 v[104:107], v[44:47], v[8:11], v[104:107]
    ds_read_b128 v[32:35], v74 offset:7168
    v_mfma_f32_16x16x32_bf16 v[108:111], v[48:51], v[8:11], v[108:111]
    v_mfma_f32_16x16x32_bf16 v[112:115], v[36:39], v[12:15], v[112:115]
    v_mfma_f32_16x16x32_bf16 v[116:119], v[40:43], v[12:15], v[116:119]
    v_mfma_f32_16x16x32_bf16 v[120:123], v[44:47], v[12:15], v[120:123]
    v_mfma_f32_16x16x32_bf16 v[124:127], v[48:51], v[12:15], v[124:127]
    v_mfma_f32_16x16x32_bf16 v[128:131], v[36:39], v[16:19], v[128:131]
    v_mfma_f32_16x16x32_bf16 v[132:135], v[40:43], v[16:19], v[132:135]
    v_mfma_f32_16x16x32_bf16 v[136:139], v[44:47], v[16:19], v[136:139]
    v_mfma_f32_16x16x32_bf16 v[140:143], v[48:51], v[16:19], v[140:143]
    s_waitcnt vmcnt(8) lgkmcnt(0)
    s_barrier
    v_mfma_f32_16x16x32_bf16 v[144:147], v[36:39], v[20:23], v[144:147]
    v_add_u32 v74, s72, v72
    v_add_u32 v75, s72, v73
    v_xor_b32 v76, 32, v75
    v_xor_b32 v77, 64, v75
    v_xor_b32 v78, 96, v75
    v_mfma_f32_16x16x32_bf16 v[148:151], v[40:43], v[20:23], v[148:151]
    s_add_u32 s72, s72, 32768
    s_and_b32 s72, s72, 0x1ffff
    ds_read_b128 v[4:7], v74 offset:0
    v_mfma_f32_16x16x32_bf16 v[152:155], v[44:47], v[20:23], v[152:155]
    ds_read_b64_tr_b16 v[52:53], v75 offset:0
    v_mfma_f32_16x16x32_bf16 v[156:159], v[48:51], v[20:23], v[156:159]
    ds_read_b64_tr_b16 v[54:55], v75 offset:2048
    ds_read_b64_tr_b16 v[56:57], v76 offset:0
    v_mfma_f32_16x16x32_bf16 v[160:163], v[36:39], v[24:27], v[160:163]
    ds_read_b64_tr_b16 v[58:59], v76 offset:2048
    v_mfma_f32_16x16x32_bf16 v[164:167], v[40:43], v[24:27], v[164:167]
    ds_read_b64_tr_b16 v[60:61], v77 offset:0
    ds_read_b64_tr_b16 v[62:63], v77 offset:2048
    v_mfma_f32_16x16x32_bf16 v[168:171], v[44:47], v[24:27], v[168:171]
    ds_read_b64_tr_b16 v[64:65], v78 offset:0
    v_mfma_f32_16x16x32_bf16 v[172:175], v[48:51], v[24:27], v[172:175]
    ds_read_b64_tr_b16 v[66:67], v78 offset:2048
    ds_read_b128 v[8:11], v74 offset:1024
    v_mfma_f32_16x16x32_bf16 v[176:179], v[36:39], v[28:31], v[176:179]
    ds_read_b128 v[12:15], v74 offset:2048
    ds_read_b128 v[16:19], v74 offset:3072
    v_mfma_f32_16x16x32_bf16 v[180:183], v[40:43], v[28:31], v[180:183]
    s_mov_b32 m0, s71
    v_mfma_f32_16x16x32_bf16 v[184:187], v[44:47], v[28:31], v[184:187]
    buffer_load_dwordx4 v68, s[60:63], s68 offen lds
    s_add_u32 m0, s71, 1024
    v_mfma_f32_16x16x32_bf16 v[188:191], v[48:51], v[28:31], v[188:191]
    buffer_load_dwordx4 v69, s[60:63], s68 offen lds
    v_mfma_f32_16x16x32_bf16 v[192:195], v[36:39], v[32:35], v[192:195]
    s_add_u32 m0, s71, 16384
    s_nop 0
    buffer_load_dwordx4 v70, s[64:67], s69 offen lds
    v_mfma_f32_16x16x32_bf16 v[196:199], v[40:43], v[32:35], v[196:199]
    s_add_u32 m0, s71, 17408
    v_mfma_f32_16x16x32_bf16 v[200:203], v[44:47], v[32:35], v[200:203]
    buffer_load_dwordx4 v71, s[64:67], s69 offen lds
    s_add_u32 s68, s68, 64
    s_add_u32 s69, s69, s70
    v_mfma_f32_16x16x32_bf16 v[204:207], v[48:51], v[32:35], v[204:207]
    s_add_u32 s71, s71, 32768
    s_and_b32 s71, s71, 0x1ffff
    s_waitcnt lgkmcnt(0)
    v_mfma_f32_16x16x32_bf16 v[80:83], v[52:55], v[4:7], v[80:83]
    ds_read_b128 v[20:23], v74 offset:4096
    v_mfma_f32_16x16x32_bf16 v[84:87], v[56:59], v[4:7], v[84:87]
    v_mfma_f32_16x16x32_bf16 v[88:91], v[60:63], v[4:7], v[88:91]
    ds_read_b128 v[24:27], v74 offset:5120
    v_mfma_f32_16x16x32_bf16 v[92:95], v[64:67], v[4:7], v[92:95]
    v_mfma_f32_16x16x32_bf16 v[96:99], v[52:55], v[8:11], v[96:99]
    ds_read_b128 v[28:31], v74 offset:6144
    v_mfma_f32_16x16x32_bf16 v[100:103], v[56:59], v[8:11], v[100:103]
    v_mfma_f32_16x16x32_bf16 v[104:107], v[60:63], v[8:11], v[104:107]
    ds_read_b128 v[32:35], v74 offset:7168
    v_mfma_f32_16x16x32_bf16 v[108:111], v[64:67], v[8:11], v[108:111]
    v_mfma_f32_16x16x32_bf16 v[112:115], v[52:55], v[12:15], v[112:115]
    v_mfma_f32_16x16x32_bf16 v[116:119], v[56:59], v[12:15], v[116:119]
    v_mfma_f32_16x16x32_bf16 v[120:123], v[60:63], v[12:15], v[120:123]
    v_mfma_f32_16x16x32_bf16 v[124:127], v[64:67], v[12:15], v[124:127]
    v_mfma_f32_16x16x32_bf16 v[128:131], v[52:55], v[16:19], v[128:131]
    v_mfma_f32_16x16x32_bf16 v[132:135], v[56:59], v[16:19], v[132:135]
    v_mfma_f32_16x16x32_bf16 v[136:139], v[60:63], v[16:19], v[136:139]
    v_mfma_f32_16x16x32_bf16 v[140:143], v[64:67], v[16:19], v[140:143]
    s_waitcnt vmcnt(8) lgkmcnt(0)
    s_barrier
    v_mfma_f32_16x16x32_bf16 v[144:147], v[52:55], v[20:23], v[144:147]
    v_add_u32 v74, s72, v72
    v_add_u32 v75, s72, v73
    v_xor_b32 v76, 32, v75
    v_xor_b32 v77, 64, v75
    v_xor_b32 v78, 96, v75
    v_mfma_f32_16x16x32_bf16 v[148:151], v[56:59], v[20:23], v[148:151]
    s_add_u32 s72, s72, 32768
    s_and_b32 s72, s72, 0x1ffff
    ds_read_b128 v[4:7], v74 offset:0
    v_mfma_f32_16x16x32_bf16 v[152:155], v[60:63], v[20:23], v[152:155]
    ds_read_b64_tr_b16 v[36:37], v75 offset:0
    v_mfma_f32_16x16x32_bf16 v[156:159], v[64:67], v[20:23], v[156:159]
    ds_read_b64_tr_b16 v[38:39], v75 offset:2048
    ds_read_b64_tr_b16 v[40:41], v76 offset:0
    v_mfma_f32_16x16x32_bf16 v[160:163], v[52:55], v[24:27], v[160:163]
    ds_read_b64_tr_b16 v[42:43], v76 offset:2048
    v_mfma_f32_16x16x32_bf16 v[164:167], v[56:59], v[24:27], v[164:167]
    ds_read_b64_tr_b16 v[44:45], v77 offset:0
    ds_read_b64_tr_b16 v[46:47], v77 offset:2048
    v_mfma_f32_16x16x32_bf16 v[168:171], v[60:63], v[24:27], v[168:171]
    ds_read_b64_tr_b16 v[48:49], v78 offset:0
    v_mfma_f32_16x16x32_bf16 v[172:175], v[64:67], v[24:27], v[172:175]
    ds_read_b64_tr_b16 v[50:51], v78 offset:2048
    ds_read_b128 v[8:11], v74 offset:1024
    v_mfma_f32_16x16x32_bf16 v[176:179], v[52:55], v[28:31], v[176:179]
    ds_read_b128 v[12:15], v74 offset:2048
    ds_read_b128 v[16:19], v74 offset:3072
    v_mfma_f32_16x16x32_bf16 v[180:183], v[56:59], v[28:31], v[180:183]
    s_mov_b32 m0, s71
    v_mfma_f32_16x16x32_bf16 v[184:187], v[60:63], v[28:31], v[184:187]
    buffer_load_dwordx4 v68, s[60:63], s68 offen lds
    s_add_u32 m0, s71, 1024
    v_mfma_f32_16x16x32_bf16 v[188:191], v[64:67], v[28:31], v[188:191]
    buffer_load_dwordx4 v69, s[60:63], s68 offen lds
    v_mfma_f32_16x16x32_bf16 v[192:195], v[52:55], v[32:35], v[192:195]
    s_add_u32 m0, s71, 16384
    s_nop 0
    buffer_load_dwordx4 v70, s[64:67], s69 offen lds
    v_mfma_f32_16x16x32_bf16 v[196:199], v[56:59], v[32:35], v[196:199]
    s_add_u32 m0, s71, 17408
    v_mfma_f32_16x16x32_bf16 v[200:203], v[60:63], v[32:35], v[200:203]
    buffer_load_dwordx4 v71, s[64:67], s69 offen lds
    s_add_u32 s68, s68, 64
    s_add_u32 s69, s69, s70
    v_mfma_f32_16x16x32_bf16 v[204:207], v[64:67], v[32:35], v[204:207]
    s_add_u32 s71, s71, 32768
    s_and_b32 s71, s71, 0x1ffff
    s_sub_u32 s73, s73, 1
    s_cmp_lg_u32 s73, 0
    s_cbranch_scc1 gl_55
    s_waitcnt lgkmcnt(0)
    v_mfma_f32_16x16x32_bf16 v[80:83], v[36:39], v[4:7], v[80:83]
    ds_read_b128 v[20:23], v74 offset:4096
    v_mfma_f32_16x16x32_bf16 v[84:87], v[40:43], v[4:7], v[84:87]
    v_mfma_f32_16x16x32_bf16 v[88:91], v[44:47], v[4:7], v[88:91]
    ds_read_b128 v[24:27], v74 offset:5120
    v_mfma_f32_16x16x32_bf16 v[92:95], v[48:51], v[4:7], v[92:95]
    v_mfma_f32_16x16x32_bf16 v[96:99], v[36:39], v[8:11], v[96:99]
    ds_read_b128 v[28:31], v74 offset:6144
    v_mfma_f32_16x16x32_bf16 v[100:103], v[40:43], v[8:11], v[100:103]
    v_mfma_f32_16x16x32_bf16 v[104:107], v[44:47], v[8:11], v[104:107]
    ds_read_b128 v[32:35], v74 offset:7168
    v_mfma_f32_16x16x32_bf16 v[108:111], v[48:51], v[8:11], v[108:111]
    v_mfma_f32_16x16x32_bf16 v[112:115], v[36:39], v[12:15], v[112:115]
    v_mfma_f32_16x16x32_bf16 v[116:119], v[40:43], v[12:15], v[116:119]
    v_mfma_f32_16x16x32_bf16 v[120:123], v[44:47], v[12:15], v[120:123]
    v_mfma_f32_16x16x32_bf16 v[124:127], v[48:51], v[12:15], v[124:127]
    v_mfma_f32_16x16x32_bf16 v[128:131], v[36:39], v[16:19], v[128:131]
    v_mfma_f32_16x16x32_bf16 v[132:135], v[40:43], v[16:19], v[132:135]
    v_mfma_f32_16x16x32_bf16 v[136:139], v[44:47], v[16:19], v[136:139]
    v_mfma_f32_16x16x32_bf16 v[140:143], v[48:51], v[16:19], v[140:143]
    s_waitcnt vmcnt(8) lgkmcnt(0)
    s_barrier
    v_mfma_f32_16x16x32_bf16 v[144:147], v[36:39], v[20:23], v[144:147]
    v_add_u32 v74, s72, v72
    v_add_u32 v75, s72, v73
    v_mfma_f32_16x16x32_bf16 v[148:151], v[40:43], v[20:23], v[148:151]
    v_xor_b32 v76, 32, v75
    v_xor_b32 v77, 64, v75
    v_xor_b32 v78, 96, v75
    v_mfma_f32_16x16x32_bf16 v[152:155], v[44:47], v[20:23], v[152:155]
    s_add_u32 s72, s72, 32768
    s_and_b32 s72, s72, 0x1ffff
    v_mfma_f32_16x16x32_bf16 v[156:159], v[48:51], v[20:23], v[156:159]
    ds_read_b128 v[4:7], v74 offset:0
    v_mfma_f32_16x16x32_bf16 v[160:163], v[36:39], v[24:27], v[160:163]
    ds_read_b64_tr_b16 v[52:53], v75 offset:0
    v_mfma_f32_16x16x32_bf16 v[164:167], v[40:43], v[24:27], v[164:167]
    ds_read_b64_tr_b16 v[54:55], v75 offset:2048
    v_mfma_f32_16x16x32_bf16 v[168:171], v[44:47], v[24:27], v[168:171]
    ds_read_b64_tr_b16 v[56:57], v76 offset:0
    v_mfma_f32_16x16x32_bf16 v[172:175], v[48:51], v[24:27], v[172:175]
    ds_read_b64_tr_b16 v[58:59], v76 offset:2048
    v_mfma_f32_16x16x32_bf16 v[176:179], v[36:39], v[28:31], v[176:179]
    ds_read_b64_tr_b16 v[60:61], v77 offset:0
    v_mfma_f32_16x16x32_bf16 v[180:183], v[40:43], v[28:31], v[180:183]
    ds_read_b64_tr_b16 v[62:63], v77 offset:2048
    v_mfma_f32_16x16x32_bf16 v[184:187], v[44:47], v[28:31], v[184:187]
    ds_read_b64_tr_b16 v[64:65], v78 offset:0
    v_mfma_f32_16x16x32_bf16 v[188:191], v[48:51], v[28:31], v[188:191]
    ds_read_b64_tr_b16 v[66:67], v78 offset:2048
    v_mfma_f32_16x16x32_bf16 v[192:195], v[36:39], v[32:35], v[192:195]
    ds_read_b128 v[8:11], v74 offset:1024
    v_mfma_f32_16x16x32_bf16 v[196:199], v[40:43], v[32:35], v[196:199]
    ds_read_b128 v[12:15], v74 offset:2048
    v_mfma_f32_16x16x32_bf16 v[200:203], v[44:47], v[32:35], v[200:203]
    ds_read_b128 v[16:19], v74 offset:3072
    v_mfma_f32_16x16x32_bf16 v[204:207], v[48:51], v[32:35], v[204:207]
    s_waitcnt lgkmcnt(0)
    v_mfma_f32_16x16x32_bf16 v[80:83], v[52:55], v[4:7], v[80:83]
    ds_read_b128 v[20:23], v74 offset:4096
    v_mfma_f32_16x16x32_bf16 v[84:87], v[56:59], v[4:7], v[84:87]
    v_mfma_f32_16x16x32_bf16 v[88:91], v[60:63], v[4:7], v[88:91]
    ds_read_b128 v[24:27], v74 offset:5120
    v_mfma_f32_16x16x32_bf16 v[92:95], v[64:67], v[4:7], v[92:95]
    v_mfma_f32_16x16x32_bf16 v[96:99], v[52:55], v[8:11], v[96:99]
    ds_read_b128 v[28:31], v74 offset:6144
    v_mfma_f32_16x16x32_bf16 v[100:103], v[56:59], v[8:11], v[100:103]
    v_mfma_f32_16x16x32_bf16 v[104:107], v[60:63], v[8:11], v[104:107]
    ds_read_b128 v[32:35], v74 offset:7168
    v_mfma_f32_16x16x32_bf16 v[108:111], v[64:67], v[8:11], v[108:111]
    v_mfma_f32_16x16x32_bf16 v[112:115], v[52:55], v[12:15], v[112:115]
    v_mfma_f32_16x16x32_bf16 v[116:119], v[56:59], v[12:15], v[116:119]
    v_mfma_f32_16x16x32_bf16 v[120:123], v[60:63], v[12:15], v[120:123]
    v_mfma_f32_16x16x32_bf16 v[124:127], v[64:67], v[12:15], v[124:127]
    v_mfma_f32_16x16x32_bf16 v[128:131], v[52:55], v[16:19], v[128:131]
    v_mfma_f32_16x16x32_bf16 v[132:135], v[56:59], v[16:19], v[132:135]
    v_mfma_f32_16x16x32_bf16 v[136:139], v[60:63], v[16:19], v[136:139]
    v_mfma_f32_16x16x32_bf16 v[140:143], v[64:67], v[16:19], v[140:143]
    s_waitcnt vmcnt(4) lgkmcnt(0)
    s_barrier
    v_mfma_f32_16x16x32_bf16 v[144:147], v[52:55], v[20:23], v[144:147]
    v_add_u32 v74, s72, v72
    v_add_u32 v75, s72, v73
    v_mfma_f32_16x16x32_bf16 v[148:151], v[56:59], v[20:23], v[148:151]
    v_xor_b32 v76, 32, v75
    v_xor_b32 v77, 64, v75
    v_xor_b32 v78, 96, v75
    v_mfma_f32_16x16x32_bf16 v[152:155], v[60:63], v[20:23], v[152:155]
    s_add_u32 s72, s72, 32768
    s_and_b32 s72, s72, 0x1ffff
    v_mfma_f32_16x16x32_bf16 v[156:159], v[64:67], v[20:23], v[156:159]
    ds_read_b128 v[4:7], v74 offset:0
    v_mfma_f32_16x16x32_bf16 v[160:163], v[52:55], v[24:27], v[160:163]
    ds_read_b64_tr_b16 v[36:37], v75 offset:0
    v_mfma_f32_16x16x32_bf16 v[164:167], v[56:59], v[24:27], v[164:167]
    ds_read_b64_tr_b16 v[38:39], v75 offset:2048
    v_mfma_f32_16x16x32_bf16 v[168:171], v[60:63], v[24:27], v[168:171]
    ds_read_b64_tr_b16 v[40:41], v76 offset:0
    v_mfma_f32_16x16x32_bf16 v[172:175], v[64:67], v[24:27], v[172:175]
    ds_read_b64_tr_b16 v[42:43], v76 offset:2048
    v_mfma_f32_16x16x32_bf16 v[176:179], v[52:55], v[28:31], v[176:179]
    ds_read_b64_tr_b16 v[44:45], v77 offset:0
    v_mfma_f32_16x16x32_bf16 v[180:183], v[56:59], v[28:31], v[180:183]
    ds_read_b64_tr_b16 v[46:47], v77 offset:2048
    v_mfma_f32_16x16x32_bf16 v[184:187], v[60:63], v[28:31], v[184:187]
    ds_read_b64_tr_b16 v[48:49], v78 offset:0
    v_mfma_f32_16x16x32_bf16 v[188:191], v[64:67], v[28:31], v[188:191]
    ds_read_b64_tr_b16 v[50:51], v78 offset:2048
    v_mfma_f32_16x16x32_bf16 v[192:195], v[52:55], v[32:35], v[192:195]
    ds_read_b128 v[8:11], v74 offset:1024
    v_mfma_f32_16x16x32_bf16 v[196:199], v[56:59], v[32:35], v[196:199]
    ds_read_b128 v[12:15], v74 offset:2048
    v_mfma_f32_16x16x32_bf16 v[200:203], v[60:63], v[32:35], v[200:203]
    ds_read_b128 v[16:19], v74 offset:3072
    v_mfma_f32_16x16x32_bf16 v[204:207], v[64:67], v[32:35], v[204:207]
    s_waitcnt lgkmcnt(0)
    v_mfma_f32_16x16x32_bf16 v[80:83], v[36:39], v[4:7], v[80:83]
    ds_read_b128 v[20:23], v74 offset:4096
    v_mfma_f32_16x16x32_bf16 v[84:87], v[40:43], v[4:7], v[84:87]
    v_mfma_f32_16x16x32_bf16 v[88:91], v[44:47], v[4:7], v[88:91]
    ds_read_b128 v[24:27], v74 offset:5120
    v_mfma_f32_16x16x32_bf16 v[92:95], v[48:51], v[4:7], v[92:95]
    v_mfma_f32_16x16x32_bf16 v[96:99], v[36:39], v[8:11], v[96:99]
    ds_read_b128 v[28:31], v74 offset:6144
    v_mfma_f32_16x16x32_bf16 v[100:103], v[40:43], v[8:11], v[100:103]
    v_mfma_f32_16x16x32_bf16 v[104:107], v[44:47], v[8:11], v[104:107]
    ds_read_b128 v[32:35], v74 offset:7168
    v_mfma_f32_16x16x32_bf16 v[108:111], v[48:51], v[8:11], v[108:111]
    v_mfma_f32_16x16x32_bf16 v[112:115], v[36:39], v[12:15], v[112:115]
    v_mfma_f32_16x16x32_bf16 v[116:119], v[40:43], v[12:15], v[116:119]
    v_mfma_f32_16x16x32_bf16 v[120:123], v[44:47], v[12:15], v[120:123]
    v_mfma_f32_16x16x32_bf16 v[124:127], v[48:51], v[12:15], v[124:127]
    v_mfma_f32_16x16x32_bf16 v[128:131], v[36:39], v[16:19], v[128:131]
    v_mfma_f32_16x16x32_bf16 v[132:135], v[40:43], v[16:19], v[132:135]
    v_mfma_f32_16x16x32_bf16 v[136:139], v[44:47], v[16:19], v[136:139]
    v_mfma_f32_16x16x32_bf16 v[140:143], v[48:51], v[16:19], v[140:143]
    s_waitcnt vmcnt(0) lgkmcnt(0)
    s_barrier
    v_mfma_f32_16x16x32_bf16 v[144:147], v[36:39], v[20:23], v[144:147]
    v_add_u32 v74, s72, v72
    v_add_u32 v75, s72, v73
    v_mfma_f32_16x16x32_bf16 v[148:151], v[40:43], v[20:23], v[148:151]
    v_xor_b32 v76, 32, v75
    v_xor_b32 v77, 64, v75
    v_xor_b32 v78, 96, v75
    v_mfma_f32_16x16x32_bf16 v[152:155], v[44:47], v[20:23], v[152:155]
    s_add_u32 s72, s72, 32768
    s_and_b32 s72, s72, 0x1ffff
    v_mfma_f32_16x16x32_bf16 v[156:159], v[48:51], v[20:23], v[156:159]
    ds_read_b128 v[4:7], v74 offset:0
    v_mfma_f32_16x16x32_bf16 v[160:163], v[36:39], v[24:27], v[160:163]
    ds_read_b64_tr_b16 v[52:53], v75 offset:0
    v_mfma_f32_16x16x32_bf16 v[164:167], v[40:43], v[24:27], v[164:167]
    ds_read_b64_tr_b16 v[54:55], v75 offset:2048
    v_mfma_f32_16x16x32_bf16 v[168:171], v[44:47], v[24:27], v[168:171]
    ds_read_b64_tr_b16 v[56:57], v76 offset:0
    v_mfma_f32_16x16x32_bf16 v[172:175], v[48:51], v[24:27], v[172:175]
    ds_read_b64_tr_b16 v[58:59], v76 offset:2048
    v_mfma_f32_16x16x32_bf16 v[176:179], v[36:39], v[28:31], v[176:179]
    ds_read_b64_tr_b16 v[60:61], v77 offset:0
    v_mfma_f32_16x16x32_bf16 v[180:183], v[40:43], v[28:31], v[180:183]
    ds_read_b64_tr_b16 v[62:63], v77 offset:2048
    v_mfma_f32_16x16x32_bf16 v[184:187], v[44:47], v[28:31], v[184:187]
    ds_read_b64_tr_b16 v[64:65], v78 offset:0
    v_mfma_f32_16x16x32_bf16 v[188:191], v[48:51], v[28:31], v[188:191]
    ds_read_b64_tr_b16 v[66:67], v78 offset:2048
    v_mfma_f32_16x16x32_bf16 v[192:195], v[36:39], v[32:35], v[192:195]
    ds_read_b128 v[8:11], v74 offset:1024
    v_mfma_f32_16x16x32_bf16 v[196:199], v[40:43], v[32:35], v[196:199]
    ds_read_b128 v[12:15], v74 offset:2048
    v_mfma_f32_16x16x32_bf16 v[200:203], v[44:47], v[32:35], v[200:203]
    ds_read_b128 v[16:19], v74 offset:3072
    v_mfma_f32_16x16x32_bf16 v[204:207], v[48:51], v[32:35], v[204:207]
    s_waitcnt lgkmcnt(0)
    v_mfma_f32_16x16x32_bf16 v[80:83], v[52:55], v[4:7], v[80:83]
    ds_read_b128 v[20:23], v74 offset:4096
    v_mfma_f32_16x16x32_bf16 v[84:87], v[56:59], v[4:7], v[84:87]
    v_mfma_f32_16x16x32_bf16 v[88:91], v[60:63], v[4:7], v[88:91]
    ds_read_b128 v[24:27], v74 offset:5120
    v_mfma_f32_16x16x32_bf16 v[92:95], v[64:67], v[4:7], v[92:95]
    v_mfma_f32_16x16x32_bf16 v[96:99], v[52:55], v[8:11], v[96:99]
    ds_read_b128 v[28:31], v74 offset:6144
    v_mfma_f32_16x16x32_bf16 v[100:103], v[56:59], v[8:11], v[100:103]
    v_mfma_f32_16x16x32_bf16 v[104:107], v[60:63], v[8:11], v[104:107]
    ds_read_b128 v[32:35], v74 offset:7168
    v_mfma_f32_16x16x32_bf16 v[108:111], v[64:67], v[8:11], v[108:111]
    v_mfma_f32_16x16x32_bf16 v[112:115], v[52:55], v[12:15], v[112:115]
    v_mfma_f32_16x16x32_bf16 v[116:119], v[56:59], v[12:15], v[116:119]
    v_mfma_f32_16x16x32_bf16 v[120:123], v[60:63], v[12:15], v[120:123]
    v_mfma_f32_16x16x32_bf16 v[124:127], v[64:67], v[12:15], v[124:127]
    v_mfma_f32_16x16x32_bf16 v[128:131], v[52:55], v[16:19], v[128:131]
    v_mfma_f32_16x16x32_bf16 v[132:135], v[56:59], v[16:19], v[132:135]
    v_mfma_f32_16x16x32_bf16 v[136:139], v[60:63], v[16:19], v[136:139]
    v_mfma_f32_16x16x32_bf16 v[140:143], v[64:67], v[16:19], v[140:143]
    s_waitcnt lgkmcnt(0)
    v_mfma_f32_16x16x32_bf16 v[144:147], v[52:55], v[20:23], v[144:147]
    v_mfma_f32_16x16x32_bf16 v[148:151], v[56:59], v[20:23], v[148:151]
    v_mfma_f32_16x16x32_bf16 v[152:155], v[60:63], v[20:23], v[152:155]
    v_mfma_f32_16x16x32_bf16 v[156:159], v[64:67], v[20:23], v[156:159]
    v_mfma_f32_16x16x32_bf16 v[160:163], v[52:55], v[24:27], v[160:163]
    v_mfma_f32_16x16x32_bf16 v[164:167], v[56:59], v[24:27], v[164:167]
    v_mfma_f32_16x16x32_bf16 v[168:171], v[60:63], v[24:27], v[168:171]
    v_mfma_f32_16x16x32_bf16 v[172:175], v[64:67], v[24:27], v[172:175]
    v_mfma_f32_16x16x32_bf16 v[176:179], v[52:55], v[28:31], v[176:179]
    v_mfma_f32_16x16x32_bf16 v[180:183], v[56:59], v[28:31], v[180:183]
    v_mfma_f32_16x16x32_bf16 v[184:187], v[60:63], v[28:31], v[184:187]
    v_mfma_f32_16x16x32_bf16 v[188:191], v[64:67], v[28:31], v[188:191]
    v_mfma_f32_16x16x32_bf16 v[192:195], v[52:55], v[32:35], v[192:195]
    v_mfma_f32_16x16x32_bf16 v[196:199], v[56:59], v[32:35], v[196:199]
    v_mfma_f32_16x16x32_bf16 v[200:203], v[60:63], v[32:35], v[200:203]
    v_mfma_f32_16x16x32_bf16 v[204:207], v[64:67], v[32:35], v[204:207]
    v_cvt_pk_bf16_f32 v4, v80, v81
    v_cvt_pk_bf16_f32 v5, v82, v83
    v_cvt_pk_bf16_f32 v6, v84, v85
    v_cvt_pk_bf16_f32 v7, v86, v87
    buffer_store_dwordx4 v[4:7], v79, s[8:11], s81 offen offset:0 sc1
    v_cvt_pk_bf16_f32 v8, v96, v97
    v_cvt_pk_bf16_f32 v9, v98, v99
    v_cvt_pk_bf16_f32 v10, v100, v101
    v_cvt_pk_bf16_f32 v11, v102, v103
    buffer_store_dwordx4 v[8:11], v79, s[8:11], s81 offen offset:256 sc1
    v_cvt_pk_bf16_f32 v12, v88, v89
    v_cvt_pk_bf16_f32 v13, v90, v91
    v_cvt_pk_bf16_f32 v14, v92, v93
    v_cvt_pk_bf16_f32 v15, v94, v95
    buffer_store_dwordx4 v[12:15], v79, s[8:11], s81 offen offset:2048 sc1
    v_cvt_pk_bf16_f32 v16, v104, v105
    v_cvt_pk_bf16_f32 v17, v106, v107
    v_cvt_pk_bf16_f32 v18, v108, v109
    v_cvt_pk_bf16_f32 v19, v110, v111
    buffer_store_dwordx4 v[16:19], v79, s[8:11], s81 offen offset:2304 sc1
    s_add_u32 s81, s81, s82
    v_cvt_pk_bf16_f32 v20, v112, v113
    v_cvt_pk_bf16_f32 v21, v114, v115
    v_cvt_pk_bf16_f32 v22, v116, v117
    v_cvt_pk_bf16_f32 v23, v118, v119
    buffer_store_dwordx4 v[20:23], v79, s[8:11], s81 offen offset:0 sc1
    v_cvt_pk_bf16_f32 v24, v128, v129
    v_cvt_pk_bf16_f32 v25, v130, v131
    v_cvt_pk_bf16_f32 v26, v132, v133
    v_cvt_pk_bf16_f32 v27, v134, v135
    buffer_store_dwordx4 v[24:27], v79, s[8:11], s81 offen offset:256 sc1
    v_cvt_pk_bf16_f32 v28, v120, v121
    v_cvt_pk_bf16_f32 v29, v122, v123
    v_cvt_pk_bf16_f32 v30, v124, v125
    v_cvt_pk_bf16_f32 v31, v126, v127
    buffer_store_dwordx4 v[28:31], v79, s[8:11], s81 offen offset:2048 sc1
    v_cvt_pk_bf16_f32 v32, v136, v137
    v_cvt_pk_bf16_f32 v33, v138, v139
    v_cvt_pk_bf16_f32 v34, v140, v141
    v_cvt_pk_bf16_f32 v35, v142, v143
    buffer_store_dwordx4 v[32:35], v79, s[8:11], s81 offen offset:2304 sc1
    s_add_u32 s81, s81, s82
    v_cvt_pk_bf16_f32 v36, v144, v145
    v_cvt_pk_bf16_f32 v37, v146, v147
    v_cvt_pk_bf16_f32 v38, v148, v149
    v_cvt_pk_bf16_f32 v39, v150, v151
    buffer_store_dwordx4 v[36:39], v79, s[8:11], s81 offen offset:0 sc1
    v_cvt_pk_bf16_f32 v40, v160, v161
    v_cvt_pk_bf16_f32 v41, v162, v163
    v_cvt_pk_bf16_f32 v42, v164, v165
    v_cvt_pk_bf16_f32 v43, v166, v167
    buffer_store_dwordx4 v[40:43], v79, s[8:11], s81 offen offset:256 sc1
    v_cvt_pk_bf16_f32 v44, v152, v153
    v_cvt_pk_bf16_f32 v45, v154, v155
    v_cvt_pk_bf16_f32 v46, v156, v157
    v_cvt_pk_bf16_f32 v47, v158, v159
    buffer_store_dwordx4 v[44:47], v79, s[8:11], s81 offen offset:2048 sc1
    v_cvt_pk_bf16_f32 v48, v168, v169
    v_cvt_pk_bf16_f32 v49, v170, v171
    v_cvt_pk_bf16_f32 v50, v172, v173
    v_cvt_pk_bf16_f32 v51, v174, v175
    buffer_store_dwordx4 v[48:51], v79, s[8:11], s81 offen offset:2304 sc1
    s_add_u32 s81, s81, s82
    v_cvt_pk_bf16_f32 v52, v176, v177
    v_cvt_pk_bf16_f32 v53, v178, v179
    v_cvt_pk_bf16_f32 v54, v180, v181
    v_cvt_pk_bf16_f32 v55, v182, v183
    buffer_store_dwordx4 v[52:55], v79, s[8:11], s81 offen offset:0 sc1
    v_cvt_pk_bf16_f32 v56, v192, v193
    v_cvt_pk_bf16_f32 v57, v194, v195
    v_cvt_pk_bf16_f32 v58, v196, v197
    v_cvt_pk_bf16_f32 v59, v198, v199
    buffer_store_dwordx4 v[56:59], v79, s[8:11], s81 offen offset:256 sc1
    v_cvt_pk_bf16_f32 v60, v184, v185
    v_cvt_pk_bf16_f32 v61, v186, v187
    v_cvt_pk_bf16_f32 v62, v188, v189
    v_cvt_pk_bf16_f32 v63, v190, v191
    buffer_store_dwordx4 v[60:63], v79, s[8:11], s81 offen offset:2048 sc1
    v_cvt_pk_bf16_f32 v64, v200, v201
    v_cvt_pk_bf16_f32 v65, v202, v203
    v_cvt_pk_bf16_f32 v66, v204, v205
    v_cvt_pk_bf16_f32 v67, v206, v207
    buffer_store_dwordx4 v[64:67], v79, s[8:11], s81 offen offset:2304 sc1
    s_branch next_48
t256_47:
    s_mov_b32 s72, 0
    s_waitcnt vmcnt(12)
    s_barrier
    v_add_u32 v74, s72, v72
    v_add_u32 v75, s72, v73
    v_xor_b32 v76, 32, v75
    v_xor_b32 v77, 64, v75
    v_xor_b32 v78, 96, v75
    s_add_u32 s72, s72, 32768
    s_and_b32 s72, s72, 0x1ffff
    ds_read_b128 v[4:7], v74 offset:0
    ds_read_b128 v[8:11], v74 offset:1024
    ds_read_b128 v[12:15], v74 offset:2048
    ds_read_b128 v[16:19], v74 offset:3072
    ds_read_b64_tr_b16 v[36:37], v75 offset:0
    ds_read_b64_tr_b16 v[38:39], v75 offset:2048
    ds_read_b64_tr_b16 v[40:41], v76 offset:0
    ds_read_b64_tr_b16 v[42:43], v76 offset:2048
    ds_read_b64_tr_b16 v[44:45], v77 offset:0
    ds_read_b64_tr_b16 v[46:47], v77 offset:2048
    ds_read_b64_tr_b16 v[48:49], v78 offset:0
    ds_read_b64_tr_b16 v[50:51], v78 offset:2048
    s_waitcnt lgkmcnt(0)
    v_mfma_f32_16x16x32_bf16 v[80:83], v[4:7], v[36:39], 0
    ds_read_b128 v[20:23], v74 offset:4096
    v_mfma_f32_16x16x32_bf16 v[84:87], v[4:7], v[40:43], 0
    v_mfma_f32_16x16x32_bf16 v[88:91], v[4:7], v[44:47], 0
    ds_read_b128 v[24:27], v74 offset:5120
    v_mfma_f32_16x16x32_bf16 v[92:95], v[4:7], v[48:51], 0
    v_mfma_f32_16x16x32_bf16 v[96:99], v[8:11], v[36:39], 0
    ds_read_b128 v[28:31], v74 offset:6144
    v_mfma_f32_16x16x32_bf16 v[100:103], v[8:11], v[40:43], 0
    v_mfma_f32_16x16x32_bf16 v[104:107], v[8:11], v[44:47], 0
    ds_read_b128 v[32:35], v74 offset:7168
    v_mfma_f32_16x16x32_bf16 v[108:111], v[8:11], v[48:51], 0
    v_mfma_f32_16x16x32_bf16 v[112:115], v[12:15], v[36:39], 0
    v_mfma_f32_16x16x32_bf16 v[116:119], v[12:15], v[40:43], 0
    v_mfma_f32_16x16x32_bf16 v[120:123], v[12:15], v[44:47], 0
    v_mfma_f32_16x16x32_bf16 v[124:127], v[12:15], v[48:51], 0
    v_mfma_f32_16x16x32_bf16 v[128:131], v[16:19], v[36:39], 0
    v_mfma_f32_16x16x32_bf16 v[132:135], v[16:19], v[40:43], 0
    v_mfma_f32_16x16x32_bf16 v[136:139], v[16:19], v[44:47], 0
    v_mfma_f32_16x16x32_bf16 v[140:143], v[16:19], v[48:51], 0
    s_waitcnt vmcnt(8) lgkmcnt(0)
    s_barrier
    v_mfma_f32_16x16x32_bf16 v[144:147], v[20:23], v[36:39], 0
    v_add_u32 v74, s72, v72
    v_add_u32 v75, s72, v73
    v_xor_b32 v76, 32, v75
    v_xor_b32 v77, 64, v75
    v_xor_b32 v78, 96, v75
    v_mfma_f32_16x16x32_bf16 v[148:151], v[20:23], v[40:43], 0
    s_add_u32 s72, s72, 32768
    s_and_b32 s72, s72, 0x1ffff
    ds_read_b128 v[4:7], v74 offset:0
    v_mfma_f32_16x16x32_bf16 v[152:155], v[20:23], v[44:47], 0
    ds_read_b64_tr_b16 v[52:53], v75 offset:0
    v_mfma_f32_16x16x32_bf16 v[156:159], v[20:23], v[48:51], 0
    ds_read_b64_tr_b16 v[54:55], v75 offset:2048
    ds_read_b64_tr_b16 v[56:57], v76 offset:0
    v_mfma_f32_16x16x32_bf16 v[160:163], v[24:27], v[36:39], 0
    ds_read_b64_tr_b16 v[58:59], v76 offset:2048
    v_mfma_f32_16x16x32_bf16 v[164:167], v[24:27], v[40:43], 0
    ds_read_b64_tr_b16 v[60:61], v77 offset:0
    ds_read_b64_tr_b16 v[62:63], v77 offset:2048
    v_mfma_f32_16x16x32_bf16 v[168:171], v[24:27], v[44:47], 0
    ds_read_b64_tr_b16 v[64:65], v78 offset:0
    v_mfma_f32_16x16x32_bf16 v[172:175], v[24:27], v[48:51], 0
    ds_read_b64_tr_b16 v[66:67], v78 offset:2048
    ds_read_b128 v[8:11], v74 offset:1024
    v_mfma_f32_16x16x32_bf16 v[176:179], v[28:31], v[36:39], 0
    ds_read_b128 v[12:15], v74 offset:2048
    ds_read_b128 v[16:19], v74 offset:3072
    v_mfma_f32_16x16x32_bf16 v[180:183], v[28:31], v[40:43], 0
    s_mov_b32 m0, s71
    v_mfma_f32_16x16x32_bf16 v[184:187], v[28:31], v[44:47], 0
    buffer_load_dwordx4 v68, s[60:63], s68 offen lds
    s_add_u32 m0, s71, 1024
    v_mfma_f32_16x16x32_bf16 v[188:191], v[28:31], v[48:51], 0
    buffer_load_dwordx4 v69, s[60:63], s68 offen lds
    v_mfma_f32_16x16x32_bf16 v[192:195], v[32:35], v[36:39], 0
    s_add_u32 m0, s71, 16384
    s_nop 0
    buffer_load_dwordx4 v70, s[64:67], s69 offen lds
    v_mfma_f32_16x16x32_bf16 v[196:199], v[32:35], v[40:43], 0
    s_add_u32 m0, s71, 17408
    v_mfma_f32_16x16x32_bf16 v[200:203], v[32:35], v[44:47], 0
    buffer_load_dwordx4 v71, s[64:67], s69 offen lds
    s_add_u32 s68, s68, 64
    s_add_u32 s69, s69, s70
    v_mfma_f32_16x16x32_bf16 v[204:207], v[32:35], v[48:51], 0
    s_add_u32 s71, s71, 32768
    s_and_b32 s71, s71, 0x1ffff
    s_waitcnt lgkmcnt(0)
    v_mfma_f32_16x16x32_bf16 v[80:83], v[4:7], v[52:55], v[80:83]
    ds_read_b128 v[20:23], v74 offset:4096
    v_mfma_f32_16x16x32_bf16 v[84:87], v[4:7], v[56:59], v[84:87]
    v_mfma_f32_16x16x32_bf16 v[88:91], v[4:7], v[60:63], v[88:91]
    ds_read_b128 v[24:27], v74 offset:5120
    v_mfma_f32_16x16x32_bf16 v[92:95], v[4:7], v[64:67], v[92:95]
    v_mfma_f32_16x16x32_bf16 v[96:99], v[8:11], v[52:55], v[96:99]
    ds_read_b128 v[28:31], v74 offset:6144
    v_mfma_f32_16x16x32_bf16 v[100:103], v[8:11], v[56:59], v[100:103]
    v_mfma_f32_16x16x32_bf16 v[104:107], v[8:11], v[60:63], v[104:107]
    ds_read_b128 v[32:35], v74 offset:7168
    v_mfma_f32_16x16x32_bf16 v[108:111], v[8:11], v[64:67], v[108:111]
    v_mfma_f32_16x16x32_bf16 v[112:115], v[12:15], v[52:55], v[112:115]
    v_mfma_f32_16x16x32_bf16 v[116:119], v[12:15], v[56:59], v[116:119]
    v_mfma_f32_16x16x32_bf16 v[120:123], v[12:15], v[60:63], v[120:123]
    v_mfma_f32_16x16x32_bf16 v[124:127], v[12:15], v[64:67], v[124:127]
    v_mfma_f32_16x16x32_bf16 v[128:131], v[16:19], v[52:55], v[128:131]
    v_mfma_f32_16x16x32_bf16 v[132:135], v[16:19], v[56:59], v[132:135]
    v_mfma_f32_16x16x32_bf16 v[136:139], v[16:19], v[60:63], v[136:139]
    v_mfma_f32_16x16x32_bf16 v[140:143], v[16:19], v[64:67], v[140:143]
    s_waitcnt vmcnt(8) lgkmcnt(0)
    s_barrier
    v_mfma_f32_16x16x32_bf16 v[144:147], v[20:23], v[52:55], v[144:147]
    v_add_u32 v74, s72, v72
    v_add_u32 v75, s72, v73
    v_xor_b32 v76, 32, v75
    v_xor_b32 v77, 64, v75
    v_xor_b32 v78, 96, v75
    v_mfma_f32_16x16x32_bf16 v[148:151], v[20:23], v[56:59], v[148:151]
    s_add_u32 s72, s72, 32768
    s_and_b32 s72, s72, 0x1ffff
    ds_read_b128 v[4:7], v74 offset:0
    v_mfma_f32_16x16x32_bf16 v[152:155], v[20:23], v[60:63], v[152:155]
    ds_read_b64_tr_b16 v[36:37], v75 offset:0
    v_mfma_f32_16x16x32_bf16 v[156:159], v[20:23], v[64:67], v[156:159]
    ds_read_b64_tr_b16 v[38:39], v75 offset:2048
    ds_read_b64_tr_b16 v[40:41], v76 offset:0
    v_mfma_f32_16x16x32_bf16 v[160:163], v[24:27], v[52:55], v[160:163]
    ds_read_b64_tr_b16 v[42:43], v76 offset:2048
    v_mfma_f32_16x16x32_bf16 v[164:167], v[24:27], v[56:59], v[164:167]
    ds_read_b64_tr_b16 v[44:45], v77 offset:0
    ds_read_b64_tr_b16 v[46:47], v77 offset:2048
    v_mfma_f32_16x16x32_bf16 v[168:171], v[24:27], v[60:63], v[168:171]
    ds_read_b64_tr_b16 v[48:49], v78 offset:0
    v_mfma_f32_16x16x32_bf16 v[172:175], v[24:27], v[64:67], v[172:175]
    ds_read_b64_tr_b16 v[50:51], v78 offset:2048
    ds_read_b128 v[8:11], v74 offset:1024
    v_mfma_f32_16x16x32_bf16 v[176:179], v[28:31], v[52:55], v[176:179]
    ds_read_b128 v[12:15], v74 offset:2048
    ds_read_b128 v[16:19], v74 offset:3072
    v_mfma_f32_16x16x32_bf16 v[180:183], v[28:31], v[56:59], v[180:183]
    s_mov_b32 m0, s71
    v_mfma_f32_16x16x32_bf16 v[184:187], v[28:31], v[60:63], v[184:187]
    buffer_load_dwordx4 v68, s[60:63], s68 offen lds
    s_add_u32 m0, s71, 1024
    v_mfma_f32_16x16x32_bf16 v[188:191], v[28:31], v[64:67], v[188:191]
    buffer_load_dwordx4 v69, s[60:63], s68 offen lds
    v_mfma_f32_16x16x32_bf16 v[192:195], v[32:35], v[52:55], v[192:195]
    s_add_u32 m0, s71, 16384
    s_nop 0
    buffer_load_dwordx4 v70, s[64:67], s69 offen lds
    v_mfma_f32_16x16x32_bf16 v[196:199], v[32:35], v[56:59], v[196:199]
    s_add_u32 m0, s71, 17408
    v_mfma_f32_16x16x32_bf16 v[200:203], v[32:35], v[60:63], v[200:203]
    buffer_load_dwordx4 v71, s[64:67], s69 offen lds
    s_add_u32 s68, s68, 64
    s_add_u32 s69, s69, s70
    v_mfma_f32_16x16x32_bf16 v[204:207], v[32:35], v[64:67], v[204:207]
    s_add_u32 s71, s71, 32768
    s_and_b32 s71, s71, 0x1ffff
    s_mov_b32 s73, 13
gl_56:
    s_waitcnt lgkmcnt(0)
    v_mfma_f32_16x16x32_bf16 v[80:83], v[4:7], v[36:39], v[80:83]
    ds_read_b128 v[20:23], v74 offset:4096
    v_mfma_f32_16x16x32_bf16 v[84:87], v[4:7], v[40:43], v[84:87]
    v_mfma_f32_16x16x32_bf16 v[88:91], v[4:7], v[44:47], v[88:91]
    ds_read_b128 v[24:27], v74 offset:5120
    v_mfma_f32_16x16x32_bf16 v[92:95], v[4:7], v[48:51], v[92:95]
    v_mfma_f32_16x16x32_bf16 v[96:99], v[8:11], v[36:39], v[96:99]
    ds_read_b128 v[28:31], v74 offset:6144
    v_mfma_f32_16x16x32_bf16 v[100:103], v[8:11], v[40:43], v[100:103]
    v_mfma_f32_16x16x32_bf16 v[104:107], v[8:11], v[44:47], v[104:107]
    ds_read_b128 v[32:35], v74 offset:7168
    v_mfma_f32_16x16x32_bf16 v[108:111], v[8:11], v[48:51], v[108:111]
    v_mfma_f32_16x16x32_bf16 v[112:115], v[12:15], v[36:39], v[112:115]
    v_mfma_f32_16x16x32_bf16 v[116:119], v[12:15], v[40:43], v[116:119]
    v_mfma_f32_16x16x32_bf16 v[120:123], v[12:15], v[44:47], v[120:123]
    v_mfma_f32_16x16x32_bf16 v[124:127], v[12:15], v[48:51], v[124:127]
    v_mfma_f32_16x16x32_bf16 v[128:131], v[16:19], v[36:39], v[128:131]
    v_mfma_f32_16x16x32_bf16 v[132:135], v[16:19], v[40:43], v[132:135]
    v_mfma_f32_16x16x32_bf16 v[136:139], v[16:19], v[44:47], v[136:139]
    v_mfma_f32_16x16x32_bf16 v[140:143], v[16:19], v[48:51], v[140:143]
    s_waitcnt vmcnt(8) lgkmcnt(0)
    s_barrier
    v_mfma_f32_16x16x32_bf16 v[144:147], v[20:23], v[36:39], v[144:147]
    v_add_u32 v74, s72, v72
    v_add_u32 v75, s72, v73
    v_xor_b32 v76, 32, v75
    v_xor_b32 v77, 64, v75
    v_xor_b32 v78, 96, v75
    v_mfma_f32_16x16x32_bf16 v[148:151], v[20:23], v[40:43], v[148:151]
    s_add_u32 s72, s72, 32768
    s_and_b32 s72, s72, 0x1ffff
    ds_read_b128 v[4:7], v74 offset:0
    v_mfma_f32_16x16x32_bf16 v[152:155], v[20:23], v[44:47], v[152:155]
    ds_read_b64_tr_b16 v[52:53], v75 offset:0
    v_mfma_f32_16x16x32_bf16 v[156:159], v[20:23], v[48:51], v[156:159]
    ds_read_b64_tr_b16 v[54:55], v75 offset:2048
    ds_read_b64_tr_b16 v[56:57], v76 offset:0
    v_mfma_f32_16x16x32_bf16 v[160:163], v[24:27], v[36:39], v[160:163]
    ds_read_b64_tr_b16 v[58:59], v76 offset:2048
    v_mfma_f32_16x16x32_bf16 v[164:167], v[24:27], v[40:43], v[164:167]
    ds_read_b64_tr_b16 v[60:61], v77 offset:0
    ds_read_b64_tr_b16 v[62:63], v77 offset:2048
    v_mfma_f32_16x16x32_bf16 v[168:171], v[24:27], v[44:47], v[168:171]
    ds_read_b64_tr_b16 v[64:65], v78 offset:0
    v_mfma_f32_16x16x32_bf16 v[172:175], v[24:27], v[48:51], v[172:175]
    ds_read_b64_tr_b16 v[66:67], v78 offset:2048
    ds_read_b128 v[8:11], v74 offset:1024
    v_mfma_f32_16x16x32_bf16 v[176:179], v[28:31], v[36:39], v[176:179]
    ds_read_b128 v[12:15], v74 offset:2048
    ds_read_b128 v[16:19], v74 offset:3072
    v_mfma_f32_16x16x32_bf16 v[180:183], v[28:31], v[40:43], v[180:183]
    s_mov_b32 m0, s71
    v_mfma_f32_16x16x32_bf16 v[184:187], v[28:31], v[44:47], v[184:187]
    buffer_load_dwordx4 v68, s[60:63], s68 offen lds
    s_add_u32 m0, s71, 1024
    v_mfma_f32_16x16x32_bf16 v[188:191], v[28:31], v[48:51], v[188:191]
    buffer_load_dwordx4 v69, s[60:63], s68 offen lds
    v_mfma_f32_16x16x32_bf16 v[192:195], v[32:35], v[36:39], v[192:195]
    s_add_u32 m0, s71, 16384
    s_nop 0
    buffer_load_dwordx4 v70, s[64:67], s69 offen lds
    v_mfma_f32_16x16x32_bf16 v[196:199], v[32:35], v[40:43], v[196:199]
    s_add_u32 m0, s71, 17408
    v_mfma_f32_16x16x32_bf16 v[200:203], v[32:35], v[44:47], v[200:203]
    buffer_load_dwordx4 v71, s[64:67], s69 offen lds
    s_add_u32 s68, s68, 64
    s_add_u32 s69, s69, s70
    v_mfma_f32_16x16x32_bf16 v[204:207], v[32:35], v[48:51], v[204:207]
    s_add_u32 s71, s71, 32768
    s_and_b32 s71, s71, 0x1ffff
    s_waitcnt lgkmcnt(0)
    v_mfma_f32_16x16x32_bf16 v[80:83], v[4:7], v[52:55], v[80:83]
    ds_read_b128 v[20:23], v74 offset:4096
    v_mfma_f32_16x16x32_bf16 v[84:87], v[4:7], v[56:59], v[84:87]
    v_mfma_f32_16x16x32_bf16 v[88:91], v[4:7], v[60:63], v[88:91]
    ds_read_b128 v[24:27], v74 offset:5120
    v_mfma_f32_16x16x32_bf16 v[92:95], v[4:7], v[64:67], v[92:95]
    v_mfma_f32_16x16x32_bf16 v[96:99], v[8:11], v[52:55], v[96:99]
    ds_read_b128 v[28:31], v74 offset:6144
    v_mfma_f32_16x16x32_bf16 v[100:103], v[8:11], v[56:59], v[100:103]
    v_mfma_f32_16x16x32_bf16 v[104:107], v[8:11], v[60:63], v[104:107]
    ds_read_b128 v[32:35], v74 offset:7168
    v_mfma_f32_16x16x32_bf16 v[108:111], v[8:11], v[64:67], v[108:111]
    v_mfma_f32_16x16x32_bf16 v[112:115], v[12:15], v[52:55], v[112:115]
    v_mfma_f32_16x16x32_bf16 v[116:119], v[12:15], v[56:59], v[116:119]
    v_mfma_f32_16x16x32_bf16 v[120:123], v[12:15], v[60:63], v[120:123]
    v_mfma_f32_16x16x32_bf16 v[124:127], v[12:15], v[64:67], v[124:127]
    v_mfma_f32_16x16x32_bf16 v[128:131], v[16:19], v[52:55], v[128:131]
    v_mfma_f32_16x16x32_bf16 v[132:135], v[16:19], v[56:59], v[132:135]
    v_mfma_f32_16x16x32_bf16 v[136:139], v[16:19], v[60:63], v[136:139]
    v_mfma_f32_16x16x32_bf16 v[140:143], v[16:19], v[64:67], v[140:143]
    s_waitcnt vmcnt(8) lgkmcnt(0)
    s_barrier
    v_mfma_f32_16x16x32_bf16 v[144:147], v[20:23], v[52:55], v[144:147]
    v_add_u32 v74, s72, v72
    v_add_u32 v75, s72, v73
    v_xor_b32 v76, 32, v75
    v_xor_b32 v77, 64, v75
    v_xor_b32 v78, 96, v75
    v_mfma_f32_16x16x32_bf16 v[148:151], v[20:23], v[56:59], v[148:151]
    s_add_u32 s72, s72, 32768
    s_and_b32 s72, s72, 0x1ffff
    ds_read_b128 v[4:7], v74 offset:0
    v_mfma_f32_16x16x32_bf16 v[152:155], v[20:23], v[60:63], v[152:155]
    ds_read_b64_tr_b16 v[36:37], v75 offset:0
    v_mfma_f32_16x16x32_bf16 v[156:159], v[20:23], v[64:67], v[156:159]
    ds_read_b64_tr_b16 v[38:39], v75 offset:2048
    ds_read_b64_tr_b16 v[40:41], v76 offset:0
    v_mfma_f32_16x16x32_bf16 v[160:163], v[24:27], v[52:55], v[160:163]
    ds_read_b64_tr_b16 v[42:43], v76 offset:2048
    v_mfma_f32_16x16x32_bf16 v[164:167], v[24:27], v[56:59], v[164:167]
    ds_read_b64_tr_b16 v[44:45], v77 offset:0
    ds_read_b64_tr_b16 v[46:47], v77 offset:2048
    v_mfma_f32_16x16x32_bf16 v[168:171], v[24:27], v[60:63], v[168:171]
    ds_read_b64_tr_b16 v[48:49], v78 offset:0
    v_mfma_f32_16x16x32_bf16 v[172:175], v[24:27], v[64:67], v[172:175]
    ds_read_b64_tr_b16 v[50:51], v78 offset:2048
    ds_read_b128 v[8:11], v74 offset:1024
    v_mfma_f32_16x16x32_bf16 v[176:179], v[28:31], v[52:55], v[176:179]
    ds_read_b128 v[12:15], v74 offset:2048
    ds_read_b128 v[16:19], v74 offset:3072
    v_mfma_f32_16x16x32_bf16 v[180:183], v[28:31], v[56:59], v[180:183]
    s_mov_b32 m0, s71
    v_mfma_f32_16x16x32_bf16 v[184:187], v[28:31], v[60:63], v[184:187]
    buffer_load_dwordx4 v68, s[60:63], s68 offen lds
    s_add_u32 m0, s71, 1024
    v_mfma_f32_16x16x32_bf16 v[188:191], v[28:31], v[64:67], v[188:191]
    buffer_load_dwordx4 v69, s[60:63], s68 offen lds
    v_mfma_f32_16x16x32_bf16 v[192:195], v[32:35], v[52:55], v[192:195]
    s_add_u32 m0, s71, 16384
    s_nop 0
    buffer_load_dwordx4 v70, s[64:67], s69 offen lds
    v_mfma_f32_16x16x32_bf16 v[196:199], v[32:35], v[56:59], v[196:199]
    s_add_u32 m0, s71, 17408
    v_mfma_f32_16x16x32_bf16 v[200:203], v[32:35], v[60:63], v[200:203]
    buffer_load_dwordx4 v71, s[64:67], s69 offen lds
    s_add_u32 s68, s68, 64
    s_add_u32 s69, s69, s70
    v_mfma_f32_16x16x32_bf16 v[204:207], v[32:35], v[64:67], v[204:207]
    s_add_u32 s71, s71, 32768
    s_and_b32 s71, s71, 0x1ffff
    s_sub_u32 s73, s73, 1
    s_cmp_lg_u32 s73, 0
    s_cbranch_scc1 gl_56
    s_waitcnt lgkmcnt(0)
    v_mfma_f32_16x16x32_bf16 v[80:83], v[4:7], v[36:39], v[80:83]
    ds_read_b128 v[20:23], v74 offset:4096
    v_mfma_f32_16x16x32_bf16 v[84:87], v[4:7], v[40:43], v[84:87]
    v_mfma_f32_16x16x32_bf16 v[88:91], v[4:7], v[44:47], v[88:91]
    ds_read_b128 v[24:27], v74 offset:5120
    v_mfma_f32_16x16x32_bf16 v[92:95], v[4:7], v[48:51], v[92:95]
    v_mfma_f32_16x16x32_bf16 v[96:99], v[8:11], v[36:39], v[96:99]
    ds_read_b128 v[28:31], v74 offset:6144
    v_mfma_f32_16x16x32_bf16 v[100:103], v[8:11], v[40:43], v[100:103]
    v_mfma_f32_16x16x32_bf16 v[104:107], v[8:11], v[44:47], v[104:107]
    ds_read_b128 v[32:35], v74 offset:7168
    v_mfma_f32_16x16x32_bf16 v[108:111], v[8:11], v[48:51], v[108:111]
    v_mfma_f32_16x16x32_bf16 v[112:115], v[12:15], v[36:39], v[112:115]
    v_mfma_f32_16x16x32_bf16 v[116:119], v[12:15], v[40:43], v[116:119]
    v_mfma_f32_16x16x32_bf16 v[120:123], v[12:15], v[44:47], v[120:123]
    v_mfma_f32_16x16x32_bf16 v[124:127], v[12:15], v[48:51], v[124:127]
    v_mfma_f32_16x16x32_bf16 v[128:131], v[16:19], v[36:39], v[128:131]
    v_mfma_f32_16x16x32_bf16 v[132:135], v[16:19], v[40:43], v[132:135]
    v_mfma_f32_16x16x32_bf16 v[136:139], v[16:19], v[44:47], v[136:139]
    v_mfma_f32_16x16x32_bf16 v[140:143], v[16:19], v[48:51], v[140:143]
    s_waitcnt vmcnt(8) lgkmcnt(0)
    s_barrier
    v_mfma_f32_16x16x32_bf16 v[144:147], v[20:23], v[36:39], v[144:147]
    v_add_u32 v74, s72, v72
    v_add_u32 v75, s72, v73
    v_mfma_f32_16x16x32_bf16 v[148:151], v[20:23], v[40:43], v[148:151]
    v_xor_b32 v76, 32, v75
    v_xor_b32 v77, 64, v75
    v_xor_b32 v78, 96, v75
    v_mfma_f32_16x16x32_bf16 v[152:155], v[20:23], v[44:47], v[152:155]
    s_add_u32 s72, s72, 32768
    s_and_b32 s72, s72, 0x1ffff
    v_mfma_f32_16x16x32_bf16 v[156:159], v[20:23], v[48:51], v[156:159]
    ds_read_b128 v[4:7], v74 offset:0
    v_mfma_f32_16x16x32_bf16 v[160:163], v[24:27], v[36:39], v[160:163]
    ds_read_b64_tr_b16 v[52:53], v75 offset:0
    v_mfma_f32_16x16x32_bf16 v[164:167], v[24:27], v[40:43], v[164:167]
    ds_read_b64_tr_b16 v[54:55], v75 offset:2048
    v_mfma_f32_16x16x32_bf16 v[168:171], v[24:27], v[44:47], v[168:171]
    ds_read_b64_tr_b16 v[56:57], v76 offset:0
    v_mfma_f32_16x16x32_bf16 v[172:175], v[24:27], v[48:51], v[172:175]
    ds_read_b64_tr_b16 v[58:59], v76 offset:2048
    v_mfma_f32_16x16x32_bf16 v[176:179], v[28:31], v[36:39], v[176:179]
    ds_read_b64_tr_b16 v[60:61], v77 offset:0
    v_mfma_f32_16x16x32_bf16 v[180:183], v[28:31], v[40:43], v[180:183]
    ds_read_b64_tr_b16 v[62:63], v77 offset:2048
    v_mfma_f32_16x16x32_bf16 v[184:187], v[28:31], v[44:47], v[184:187]
    ds_read_b64_tr_b16 v[64:65], v78 offset:0
    v_mfma_f32_16x16x32_bf16 v[188:191], v[28:31], v[48:51], v[188:191]
    ds_read_b64_tr_b16 v[66:67], v78 offset:2048
    v_mfma_f32_16x16x32_bf16 v[192:195], v[32:35], v[36:39], v[192:195]
    ds_read_b128 v[8:11], v74 offset:1024
    v_mfma_f32_16x16x32_bf16 v[196:199], v[32:35], v[40:43], v[196:199]
    ds_read_b128 v[12:15], v74 offset:2048
    v_mfma_f32_16x16x32_bf16 v[200:203], v[32:35], v[44:47], v[200:203]
    ds_read_b128 v[16:19], v74 offset:3072
    v_mfma_f32_16x16x32_bf16 v[204:207], v[32:35], v[48:51], v[204:207]
    s_waitcnt lgkmcnt(0)
    v_mfma_f32_16x16x32_bf16 v[80:83], v[4:7], v[52:55], v[80:83]
    ds_read_b128 v[20:23], v74 offset:4096
    v_mfma_f32_16x16x32_bf16 v[84:87], v[4:7], v[56:59], v[84:87]
    v_mfma_f32_16x16x32_bf16 v[88:91], v[4:7], v[60:63], v[88:91]
    ds_read_b128 v[24:27], v74 offset:5120
    v_mfma_f32_16x16x32_bf16 v[92:95], v[4:7], v[64:67], v[92:95]
    v_mfma_f32_16x16x32_bf16 v[96:99], v[8:11], v[52:55], v[96:99]
    ds_read_b128 v[28:31], v74 offset:6144
    v_mfma_f32_16x16x32_bf16 v[100:103], v[8:11], v[56:59], v[100:103]
    v_mfma_f32_16x16x32_bf16 v[104:107], v[8:11], v[60:63], v[104:107]
    ds_read_b128 v[32:35], v74 offset:7168
    v_mfma_f32_16x16x32_bf16 v[108:111], v[8:11], v[64:67], v[108:111]
    v_mfma_f32_16x16x32_bf16 v[112:115], v[12:15], v[52:55], v[112:115]
    v_mfma_f32_16x16x32_bf16 v[116:119], v[12:15], v[56:59], v[116:119]
    v_mfma_f32_16x16x32_bf16 v[120:123], v[12:15], v[60:63], v[120:123]
    v_mfma_f32_16x16x32_bf16 v[124:127], v[12:15], v[64:67], v[124:127]
    v_mfma_f32_16x16x32_bf16 v[128:131], v[16:19], v[52:55], v[128:131]
    v_mfma_f32_16x16x32_bf16 v[132:135], v[16:19], v[56:59], v[132:135]
    v_mfma_f32_16x16x32_bf16 v[136:139], v[16:19], v[60:63], v[136:139]
    v_mfma_f32_16x16x32_bf16 v[140:143], v[16:19], v[64:67], v[140:143]
    s_waitcnt vmcnt(4) lgkmcnt(0)
    s_barrier
    v_mfma_f32_16x16x32_bf16 v[144:147], v[20:23], v[52:55], v[144:147]
    v_add_u32 v74, s72, v72
    v_add_u32 v75, s72, v73
    v_mfma_f32_16x16x32_bf16 v[148:151], v[20:23], v[56:59], v[148:151]
    v_xor_b32 v76, 32, v75
    v_xor_b32 v77, 64, v75
    v_xor_b32 v78, 96, v75
    v_mfma_f32_16x16x32_bf16 v[152:155], v[20:23], v[60:63], v[152:155]
    s_add_u32 s72, s72, 32768
    s_and_b32 s72, s72, 0x1ffff
    v_mfma_f32_16x16x32_bf16 v[156:159], v[20:23], v[64:67], v[156:159]
    ds_read_b128 v[4:7], v74 offset:0
    v_mfma_f32_16x16x32_bf16 v[160:163], v[24:27], v[52:55], v[160:163]
    ds_read_b64_tr_b16 v[36:37], v75 offset:0
    v_mfma_f32_16x16x32_bf16 v[164:167], v[24:27], v[56:59], v[164:167]
    ds_read_b64_tr_b16 v[38:39], v75 offset:2048
    v_mfma_f32_16x16x32_bf16 v[168:171], v[24:27], v[60:63], v[168:171]
    ds_read_b64_tr_b16 v[40:41], v76 offset:0
    v_mfma_f32_16x16x32_bf16 v[172:175], v[24:27], v[64:67], v[172:175]
    ds_read_b64_tr_b16 v[42:43], v76 offset:2048
    v_mfma_f32_16x16x32_bf16 v[176:179], v[28:31], v[52:55], v[176:179]
    ds_read_b64_tr_b16 v[44:45], v77 offset:0
    v_mfma_f32_16x16x32_bf16 v[180:183], v[28:31], v[56:59], v[180:183]
    ds_read_b64_tr_b16 v[46:47], v77 offset:2048
    v_mfma_f32_16x16x32_bf16 v[184:187], v[28:31], v[60:63], v[184:187]
    ds_read_b64_tr_b16 v[48:49], v78 offset:0
    v_mfma_f32_16x16x32_bf16 v[188:191], v[28:31], v[64:67], v[188:191]
    ds_read_b64_tr_b16 v[50:51], v78 offset:2048
    v_mfma_f32_16x16x32_bf16 v[192:195], v[32:35], v[52:55], v[192:195]
    ds_read_b128 v[8:11], v74 offset:1024
    v_mfma_f32_16x16x32_bf16 v[196:199], v[32:35], v[56:59], v[196:199]
    ds_read_b128 v[12:15], v74 offset:2048
    v_mfma_f32_16x16x32_bf16 v[200:203], v[32:35], v[60:63], v[200:203]
    ds_read_b128 v[16:19], v74 offset:3072
    v_mfma_f32_16x16x32_bf16 v[204:207], v[32:35], v[64:67], v[204:207]
    s_waitcnt lgkmcnt(0)
    v_mfma_f32_16x16x32_bf16 v[80:83], v[4:7], v[36:39], v[80:83]
    ds_read_b128 v[20:23], v74 offset:4096
    v_mfma_f32_16x16x32_bf16 v[84:87], v[4:7], v[40:43], v[84:87]
    v_mfma_f32_16x16x32_bf16 v[88:91], v[4:7], v[44:47], v[88:91]
    ds_read_b128 v[24:27], v74 offset:5120
    v_mfma_f32_16x16x32_bf16 v[92:95], v[4:7], v[48:51], v[92:95]
    v_mfma_f32_16x16x32_bf16 v[96:99], v[8:11], v[36:39], v[96:99]
    ds_read_b128 v[28:31], v74 offset:6144
    v_mfma_f32_16x16x32_bf16 v[100:103], v[8:11], v[40:43], v[100:103]
    v_mfma_f32_16x16x32_bf16 v[104:107], v[8:11], v[44:47], v[104:107]
    ds_read_b128 v[32:35], v74 offset:7168
    v_mfma_f32_16x16x32_bf16 v[108:111], v[8:11], v[48:51], v[108:111]
    v_mfma_f32_16x16x32_bf16 v[112:115], v[12:15], v[36:39], v[112:115]
    v_mfma_f32_16x16x32_bf16 v[116:119], v[12:15], v[40:43], v[116:119]
    v_mfma_f32_16x16x32_bf16 v[120:123], v[12:15], v[44:47], v[120:123]
    v_mfma_f32_16x16x32_bf16 v[124:127], v[12:15], v[48:51], v[124:127]
    v_mfma_f32_16x16x32_bf16 v[128:131], v[16:19], v[36:39], v[128:131]
    v_mfma_f32_16x16x32_bf16 v[132:135], v[16:19], v[40:43], v[132:135]
    v_mfma_f32_16x16x32_bf16 v[136:139], v[16:19], v[44:47], v[136:139]
    v_mfma_f32_16x16x32_bf16 v[140:143], v[16:19], v[48:51], v[140:143]
    s_waitcnt vmcnt(0) lgkmcnt(0)
    s_barrier
    v_mfma_f32_16x16x32_bf16 v[144:147], v[20:23], v[36:39], v[144:147]
    v_add_u32 v74, s72, v72
    v_add_u32 v75, s72, v73
    v_mfma_f32_16x16x32_bf16 v[148:151], v[20:23], v[40:43], v[148:151]
    v_xor_b32 v76, 32, v75
    v_xor_b32 v77, 64, v75
    v_xor_b32 v78, 96, v75
    v_mfma_f32_16x16x32_bf16 v[152:155], v[20:23], v[44:47], v[152:155]
    s_add_u32 s72, s72, 32768
    s_and_b32 s72, s72, 0x1ffff
    v_mfma_f32_16x16x32_bf16 v[156:159], v[20:23], v[48:51], v[156:159]
    ds_read_b128 v[4:7], v74 offset:0
    v_mfma_f32_16x16x32_bf16 v[160:163], v[24:27], v[36:39], v[160:163]
    ds_read_b64_tr_b16 v[52:53], v75 offset:0
    v_mfma_f32_16x16x32_bf16 v[164:167], v[24:27], v[40:43], v[164:167]
    ds_read_b64_tr_b16 v[54:55], v75 offset:2048
    v_mfma_f32_16x16x32_bf16 v[168:171], v[24:27], v[44:47], v[168:171]
    ds_read_b64_tr_b16 v[56:57], v76 offset:0
    v_mfma_f32_16x16x32_bf16 v[172:175], v[24:27], v[48:51], v[172:175]
    ds_read_b64_tr_b16 v[58:59], v76 offset:2048
    v_mfma_f32_16x16x32_bf16 v[176:179], v[28:31], v[36:39], v[176:179]
    ds_read_b64_tr_b16 v[60:61], v77 offset:0
    v_mfma_f32_16x16x32_bf16 v[180:183], v[28:31], v[40:43], v[180:183]
    ds_read_b64_tr_b16 v[62:63], v77 offset:2048
    v_mfma_f32_16x16x32_bf16 v[184:187], v[28:31], v[44:47], v[184:187]
    ds_read_b64_tr_b16 v[64:65], v78 offset:0
    v_mfma_f32_16x16x32_bf16 v[188:191], v[28:31], v[48:51], v[188:191]
    ds_read_b64_tr_b16 v[66:67], v78 offset:2048
    v_mfma_f32_16x16x32_bf16 v[192:195], v[32:35], v[36:39], v[192:195]
    ds_read_b128 v[8:11], v74 offset:1024
    v_mfma_f32_16x16x32_bf16 v[196:199], v[32:35], v[40:43], v[196:199]
    ds_read_b128 v[12:15], v74 offset:2048
    v_mfma_f32_16x16x32_bf16 v[200:203], v[32:35], v[44:47], v[200:203]
    ds_read_b128 v[16:19], v74 offset:3072
    v_mfma_f32_16x16x32_bf16 v[204:207], v[32:35], v[48:51], v[204:207]
    s_waitcnt lgkmcnt(0)
    v_mfma_f32_16x16x32_bf16 v[80:83], v[4:7], v[52:55], v[80:83]
    ds_read_b128 v[20:23], v74 offset:4096
    v_mfma_f32_16x16x32_bf16 v[84:87], v[4:7], v[56:59], v[84:87]
    v_mfma_f32_16x16x32_bf16 v[88:91], v[4:7], v[60:63], v[88:91]
    ds_read_b128 v[24:27], v74 offset:5120
    v_mfma_f32_16x16x32_bf16 v[92:95], v[4:7], v[64:67], v[92:95]
    v_mfma_f32_16x16x32_bf16 v[96:99], v[8:11], v[52:55], v[96:99]
    ds_read_b128 v[28:31], v74 offset:6144
    v_mfma_f32_16x16x32_bf16 v[100:103], v[8:11], v[56:59], v[100:103]
    v_mfma_f32_16x16x32_bf16 v[104:107], v[8:11], v[60:63], v[104:107]
    ds_read_b128 v[32:35], v74 offset:7168
    v_mfma_f32_16x16x32_bf16 v[108:111], v[8:11], v[64:67], v[108:111]
    v_mfma_f32_16x16x32_bf16 v[112:115], v[12:15], v[52:55], v[112:115]
    v_mfma_f32_16x16x32_bf16 v[116:119], v[12:15], v[56:59], v[116:119]
    v_mfma_f32_16x16x32_bf16 v[120:123], v[12:15], v[60:63], v[120:123]
    v_mfma_f32_16x16x32_bf16 v[124:127], v[12:15], v[64:67], v[124:127]
    v_mfma_f32_16x16x32_bf16 v[128:131], v[16:19], v[52:55], v[128:131]
    v_mfma_f32_16x16x32_bf16 v[132:135], v[16:19], v[56:59], v[132:135]
    v_mfma_f32_16x16x32_bf16 v[136:139], v[16:19], v[60:63], v[136:139]
    v_mfma_f32_16x16x32_bf16 v[140:143], v[16:19], v[64:67], v[140:143]
    s_waitcnt lgkmcnt(0)
    v_mfma_f32_16x16x32_bf16 v[144:147], v[20:23], v[52:55], v[144:147]
    v_mfma_f32_16x16x32_bf16 v[148:151], v[20:23], v[56:59], v[148:151]
    v_mfma_f32_16x16x32_bf16 v[152:155], v[20:23], v[60:63], v[152:155]
    v_mfma_f32_16x16x32_bf16 v[156:159], v[20:23], v[64:67], v[156:159]
    v_mfma_f32_16x16x32_bf16 v[160:163], v[24:27], v[52:55], v[160:163]
    v_mfma_f32_16x16x32_bf16 v[164:167], v[24:27], v[56:59], v[164:167]
    v_mfma_f32_16x16x32_bf16 v[168:171], v[24:27], v[60:63], v[168:171]
    v_mfma_f32_16x16x32_bf16 v[172:175], v[24:27], v[64:67], v[172:175]
    v_mfma_f32_16x16x32_bf16 v[176:179], v[28:31], v[52:55], v[176:179]
    v_mfma_f32_16x16x32_bf16 v[180:183], v[28:31], v[56:59], v[180:183]
    v_mfma_f32_16x16x32_bf16 v[184:187], v[28:31], v[60:63], v[184:187]
    v_mfma_f32_16x16x32_bf16 v[188:191], v[28:31], v[64:67], v[188:191]
    v_mfma_f32_16x16x32_bf16 v[192:195], v[32:35], v[52:55], v[192:195]
    v_mfma_f32_16x16x32_bf16 v[196:199], v[32:35], v[56:59], v[196:199]
    v_mfma_f32_16x16x32_bf16 v[200:203], v[32:35], v[60:63], v[200:203]
    v_mfma_f32_16x16x32_bf16 v[204:207], v[32:35], v[64:67], v[204:207]
    v_cvt_pk_bf16_f32 v4, v80, v81
    v_cvt_pk_bf16_f32 v5, v82, v83
    v_cvt_pk_bf16_f32 v6, v96, v97
    v_cvt_pk_bf16_f32 v7, v98, v99
    buffer_store_dwordx4 v[4:7], v79, s[8:11], s81 offen offset:0 sc1
    v_cvt_pk_bf16_f32 v8, v84, v85
    v_cvt_pk_bf16_f32 v9, v86, v87
    v_cvt_pk_bf16_f32 v10, v100, v101
    v_cvt_pk_bf16_f32 v11, v102, v103
    buffer_store_dwordx4 v[8:11], v79, s[8:11], s81 offen offset:256 sc1
    v_cvt_pk_bf16_f32 v12, v88, v89
    v_cvt_pk_bf16_f32 v13, v90, v91
    v_cvt_pk_bf16_f32 v14, v104, v105
    v_cvt_pk_bf16_f32 v15, v106, v107
    buffer_store_dwordx4 v[12:15], v79, s[8:11], s81 offen offset:2048 sc1
    v_cvt_pk_bf16_f32 v16, v92, v93
    v_cvt_pk_bf16_f32 v17, v94, v95
    v_cvt_pk_bf16_f32 v18, v108, v109
    v_cvt_pk_bf16_f32 v19, v110, v111
    buffer_store_dwordx4 v[16:19], v79, s[8:11], s81 offen offset:2304 sc1
    s_add_u32 s81, s81, s82
    v_cvt_pk_bf16_f32 v20, v112, v113
    v_cvt_pk_bf16_f32 v21, v114, v115
    v_cvt_pk_bf16_f32 v22, v128, v129
    v_cvt_pk_bf16_f32 v23, v130, v131
    buffer_store_dwordx4 v[20:23], v79, s[8:11], s81 offen offset:0 sc1
    v_cvt_pk_bf16_f32 v24, v116, v117
    v_cvt_pk_bf16_f32 v25, v118, v119
    v_cvt_pk_bf16_f32 v26, v132, v133
    v_cvt_pk_bf16_f32 v27, v134, v135
    buffer_store_dwordx4 v[24:27], v79, s[8:11], s81 offen offset:256 sc1
    v_cvt_pk_bf16_f32 v28, v120, v121
    v_cvt_pk_bf16_f32 v29, v122, v123
    v_cvt_pk_bf16_f32 v30, v136, v137
    v_cvt_pk_bf16_f32 v31, v138, v139
    buffer_store_dwordx4 v[28:31], v79, s[8:11], s81 offen offset:2048 sc1
    v_cvt_pk_bf16_f32 v32, v124, v125
    v_cvt_pk_bf16_f32 v33, v126, v127
    v_cvt_pk_bf16_f32 v34, v140, v141
    v_cvt_pk_bf16_f32 v35, v142, v143
    buffer_store_dwordx4 v[32:35], v79, s[8:11], s81 offen offset:2304 sc1
    s_add_u32 s81, s81, s82
    v_cvt_pk_bf16_f32 v36, v144, v145
    v_cvt_pk_bf16_f32 v37, v146, v147
    v_cvt_pk_bf16_f32 v38, v160, v161
    v_cvt_pk_bf16_f32 v39, v162, v163
    buffer_store_dwordx4 v[36:39], v79, s[8:11], s81 offen offset:0 sc1
    v_cvt_pk_bf16_f32 v40, v148, v149
    v_cvt_pk_bf16_f32 v41, v150, v151
    v_cvt_pk_bf16_f32 v42, v164, v165
    v_cvt_pk_bf16_f32 v43, v166, v167
    buffer_store_dwordx4 v[40:43], v79, s[8:11], s81 offen offset:256 sc1
    v_cvt_pk_bf16_f32 v44, v152, v153
    v_cvt_pk_bf16_f32 v45, v154, v155
    v_cvt_pk_bf16_f32 v46, v168, v169
    v_cvt_pk_bf16_f32 v47, v170, v171
    buffer_store_dwordx4 v[44:47], v79, s[8:11], s81 offen offset:2048 sc1
    v_cvt_pk_bf16_f32 v48, v156, v157
    v_cvt_pk_bf16_f32 v49, v158, v159
    v_cvt_pk_bf16_f32 v50, v172, v173
    v_cvt_pk_bf16_f32 v51, v174, v175
    buffer_store_dwordx4 v[48:51], v79, s[8:11], s81 offen offset:2304 sc1
    s_add_u32 s81, s81, s82
    v_cvt_pk_bf16_f32 v52, v176, v177
    v_cvt_pk_bf16_f32 v53, v178, v179
    v_cvt_pk_bf16_f32 v54, v192, v193
    v_cvt_pk_bf16_f32 v55, v194, v195
    buffer_store_dwordx4 v[52:55], v79, s[8:11], s81 offen offset:0 sc1
    v_cvt_pk_bf16_f32 v56, v180, v181
    v_cvt_pk_bf16_f32 v57, v182, v183
    v_cvt_pk_bf16_f32 v58, v196, v197
    v_cvt_pk_bf16_f32 v59, v198, v199
    buffer_store_dwordx4 v[56:59], v79, s[8:11], s81 offen offset:256 sc1
    v_cvt_pk_bf16_f32 v60, v184, v185
    v_cvt_pk_bf16_f32 v61, v186, v187
    v_cvt_pk_bf16_f32 v62, v200, v201
    v_cvt_pk_bf16_f32 v63, v202, v203
    buffer_store_dwordx4 v[60:63], v79, s[8:11], s81 offen offset:2048 sc1
    v_cvt_pk_bf16_f32 v64, v188, v189
    v_cvt_pk_bf16_f32 v65, v190, v191
    v_cvt_pk_bf16_f32 v66, v204, v205
    v_cvt_pk_bf16_f32 v67, v206, v207
    buffer_store_dwordx4 v[64:67], v79, s[8:11], s81 offen offset:2304 sc1
next_48:
    s_waitcnt vmcnt(0)
    s_barrier
    s_cmp_lg_u32 s58, 0
    s_cbranch_scc1 sig_57
    v_mov_b32 v75, 0x5ffffff0
    v_mov_b32 v76, s83
    v_cmp_eq_u32 vcc, 0, v1
    s_nop 1
    v_cndmask_b32 v76, v75, v76, vcc
    v_mov_b32 v75, 1
    buffer_atomic_add v75, v76, s[12:15], 0 offen sc1
    s_waitcnt vmcnt(0)
sig_57:
    s_add_u32 s78, s78, 1
    s_cmp_eq_u32 s78, 1
    s_cbranch_scc1 r01_51
    s_cmp_eq_u32 s78, 5
    s_cbranch_scc1 p3_62
    v_bfe_u32 v79, v1, 0, 4
    v_lshlrev_b32 v79, 4, v79
    v_bfe_u32 v75, v1, 4, 2
    v_lshl_or_b32 v79, v75, 9, v79
    v_bfe_u32 v76, v1, 2, 2
    v_sub_u32 v76, 0, v76
    v_lshrrev_b32 v75, 4, v1
    v_xor_b32 v76, v76, v75
    v_and_b32 v76, 3, v76
    v_bfe_u32 v72, v1, 0, 4
    v_lshlrev_b32 v72, 6, v72
    v_lshl_or_b32 v72, v76, 4, v72
    s_lshr_b32 s74, s58, 2
    s_mul_i32 s74, s74, 8192
    v_add_u32 v72, s74, v72
    v_bfe_u32 v73, v1, 0, 2
    v_lshlrev_b32 v73, 3, v73
    v_bfe_u32 v75, v1, 4, 1
    v_lshl_or_b32 v73, v75, 5, v73
    v_bfe_u32 v75, v1, 2, 2
    v_lshl_or_b32 v73, v75, 6, v73
    v_bfe_u32 v75, v1, 2, 2
    v_lshl_or_b32 v73, v75, 9, v73
    v_bfe_u32 v75, v1, 4, 2
    v_lshl_or_b32 v73, v75, 12, v73
    s_and_b32 s74, s58, 3
    s_mul_i32 s74, s74, 128
    s_or_b32 s74, s74, 16384
    v_xor_b32 v73, s74, v73
    s_cmp_eq_u32 s78, 4
    s_cbranch_scc1 q_58
    s_cmp_ge_u32 s57, 24
    s_cbranch_scc1 fft_63
    s_mul_i32 s79, s78, 3
    s_lshr_b32 s84, s57, 3
    s_add_u32 s79, s79, s84
    s_sub_u32 s79, s79, 4
    s_bfe_u32 s80, s76, 0x30000
    s_bfe_u32 s84, s76, 0x10005
    s_lshl_b32 s84, s84, 3
    s_or_b32 s80, s80, s84
    s_lshl_b32 s83, s79, 3
    s_add_u32 s83, s83, 128
    s_cmp_ge_u32 s75, 2
    s_cbranch_scc1 v1_61
    s_mov_b64 s[60:61], s[36:37]
    s_mov_b32 s62, 0x400000
    s_mov_b32 s63, 0x20000
    s_mov_b64 s[64:65], s[24:25]
    s_mov_b32 s66, 0x800000
    s_mov_b32 s67, 0x20000
    v_lshrrev_b32 v76, 4, v1
    v_sub_u32 v76, 0, v76
    v_xor_b32 v76, v76, v1
    v_and_b32 v76, 3, v76
    s_mul_i32 s74, s58, 32
    v_lshrrev_b32 v77, 2, v1
    v_add3_u32 v77, v77, s74, 0
    v_lshlrev_b32 v68, 11, v77
    v_lshl_add_u32 v68, v76, 4, v68
    v_lshrrev_b32 v77, 2, v1
    v_add3_u32 v77, v77, s74, 16
    v_lshlrev_b32 v69, 11, v77
    v_lshl_add_u32 v69, v76, 4, v69
    s_and_b32 s74, s58, 2
    v_bfe_u32 v76, v1, 0, 5
    v_bfe_u32 v77, v1, 5, 1
    v_lshlrev_b32 v77, 2, v77
    v_xor_b32 v76, v76, v77
    v_xor_b32 v76, s74, v76
    v_bfe_u32 v77, v76, 0, 1
    v_lshlrev_b32 v77, 5, v77
    v_bfe_u32 v75, v76, 1, 1
    v_lshl_or_b32 v77, v75, 4, v77
    v_bfe_u32 v75, v76, 2, 3
    v_lshl_or_b32 v77, v75, 6, v77
    v_lshrrev_b32 v76, 5, v1
    v_lshl_add_u32 v70, v76, 13, v77
    v_bfe_u32 v76, v1, 0, 5
    v_bfe_u32 v77, v1, 5, 1
    v_lshlrev_b32 v77, 2, v77
    v_xor_b32 v76, v76, v77
    v_xor_b32 v76, s74, v76
    v_xor_b32 v76, 8, v76
    v_bfe_u32 v77, v76, 0, 1
    v_lshlrev_b32 v77, 5, v77
    v_bfe_u32 v75, v76, 1, 1
    v_lshl_or_b32 v77, v75, 4, v77
    v_bfe_u32 v75, v76, 2, 3
    v_lshl_or_b32 v77, v75, 6, v77
    v_lshrrev_b32 v76, 5, v1
    v_lshl_add_u32 v71, v76, 13, v77
    v_add_u32 v71, 16384, v71
    s_lshl_b32 s74, s58, 15
    v_add_u32 v70, s74, v70
    v_add_u32 v71, s74, v71
    s_mov_b32 s70, 262144
    s_mul_i32 s68, s79, 524288
    s_mul_i32 s69, s80, 512
    s_mov_b32 s82, 0x40000
    s_lshl_b32 s81, s79, 1
    s_lshr_b32 s84, s58, 2
    s_add_u32 s81, s81, s84
    s_mul_i32 s81, s81, s82
    s_mul_i32 s81, s81, 4
    s_lshl_b32 s74, s80, 2
    s_and_b32 s84, s58, 3
    s_add_u32 s84, s84, s74
    s_mul_i32 s84, s84, 4096
    s_add_u32 s81, s81, s84
    s_add_u32 s81, s81, 0x1000000
    s_mul_i32 s71, s58, 2048
    s_mov_b32 m0, s71
    s_nop 0
    buffer_load_dwordx4 v68, s[60:63], s68 offen lds
    s_add_u32 m0, s71, 1024
    s_nop 0
    buffer_load_dwordx4 v69, s[60:63], s68 offen lds
    s_add_u32 m0, s71, 16384
    s_nop 0
    buffer_load_dwordx4 v70, s[64:67], s69 offen lds
    s_add_u32 m0, s71, 17408
    s_nop 0
    buffer_load_dwordx4 v71, s[64:67], s69 offen lds
    s_add_u32 s68, s68, 64
    s_add_u32 s69, s69, s70
    s_add_u32 s71, s71, 32768
    s_and_b32 s71, s71, 0x1ffff
    s_mov_b32 m0, s71
    s_nop 0
    buffer_load_dwordx4 v68, s[60:63], s68 offen lds
    s_add_u32 m0, s71, 1024
    s_nop 0
    buffer_load_dwordx4 v69, s[60:63], s68 offen lds
    s_add_u32 m0, s71, 16384
    s_nop 0
    buffer_load_dwordx4 v70, s[64:67], s69 offen lds
    s_add_u32 m0, s71, 17408
    s_nop 0
    buffer_load_dwordx4 v71, s[64:67], s69 offen lds
    s_add_u32 s68, s68, 64
    s_add_u32 s69, s69, s70
    s_add_u32 s71, s71, 32768
    s_and_b32 s71, s71, 0x1ffff
    s_mov_b32 m0, s71
    s_nop 0
    buffer_load_dwordx4 v68, s[60:63], s68 offen lds
    s_add_u32 m0, s71, 1024
    s_nop 0
    buffer_load_dwordx4 v69, s[60:63], s68 offen lds
    s_add_u32 m0, s71, 16384
    s_nop 0
    buffer_load_dwordx4 v70, s[64:67], s69 offen lds
    s_add_u32 m0, s71, 17408
    s_nop 0
    buffer_load_dwordx4 v71, s[64:67], s69 offen lds
    s_add_u32 s68, s68, 64
    s_add_u32 s69, s69, s70
    s_add_u32 s71, s71, 32768
    s_and_b32 s71, s71, 0x1ffff
    s_mov_b32 m0, s71
    s_nop 0
    buffer_load_dwordx4 v68, s[60:63], s68 offen lds
    s_add_u32 m0, s71, 1024
    s_nop 0
    buffer_load_dwordx4 v69, s[60:63], s68 offen lds
    s_add_u32 m0, s71, 16384
    s_nop 0
    buffer_load_dwordx4 v70, s[64:67], s69 offen lds
    s_add_u32 m0, s71, 17408
    s_nop 0
    buffer_load_dwordx4 v71, s[64:67], s69 offen lds
    s_add_u32 s68, s68, 64
    s_add_u32 s69, s69, s70
    s_add_u32 s71, s71, 32768
    s_and_b32 s71, s71, 0x1ffff
    s_branch f256_46
v1_61:
    s_mov_b64 s[60:61], s[36:37]
    s_mov_b32 s62, 0x400000
    s_mov_b32 s63, 0x20000
    s_mov_b64 s[64:65], s[28:29]
    s_mov_b32 s66, 0x800000
    s_mov_b32 s67, 0x20000
    v_lshrrev_b32 v76, 4, v1
    v_sub_u32 v76, 0, v76
    v_xor_b32 v76, v76, v1
    v_and_b32 v76, 3, v76
    s_mul_i32 s74, s58, 32
    v_lshrrev_b32 v77, 2, v1
    v_add3_u32 v77, v77, s74, 0
    v_bfe_u32 v68, v77, 0, 3
    v_lshlrev_b32 v68, 11, v68
    v_bfe_u32 v75, v77, 3, 1
    v_lshl_or_b32 v68, v75, 15, v68
    v_bfe_u32 v75, v77, 4, 1
    v_lshl_or_b32 v68, v75, 14, v68
    v_bfe_u32 v75, v77, 5, 3
    v_lshl_or_b32 v68, v75, 16, v68
    v_lshl_add_u32 v68, v76, 4, v68
    v_lshrrev_b32 v77, 2, v1
    v_add3_u32 v77, v77, s74, 16
    v_bfe_u32 v69, v77, 0, 3
    v_lshlrev_b32 v69, 11, v69
    v_bfe_u32 v75, v77, 3, 1
    v_lshl_or_b32 v69, v75, 15, v69
    v_bfe_u32 v75, v77, 4, 1
    v_lshl_or_b32 v69, v75, 14, v69
    v_bfe_u32 v75, v77, 5, 3
    v_lshl_or_b32 v69, v75, 16, v69
    v_lshl_add_u32 v69, v76, 4, v69
    s_and_b32 s74, s58, 2
    v_bfe_u32 v76, v1, 0, 5
    v_bfe_u32 v77, v1, 5, 1
    v_lshlrev_b32 v77, 2, v77
    v_xor_b32 v76, v76, v77
    v_xor_b32 v76, s74, v76
    v_lshlrev_b32 v77, 4, v76
    v_lshrrev_b32 v76, 5, v1
    v_lshl_add_u32 v70, v76, 13, v77
    v_bfe_u32 v76, v1, 0, 5
    v_bfe_u32 v77, v1, 5, 1
    v_lshlrev_b32 v77, 2, v77
    v_xor_b32 v76, v76, v77
    v_xor_b32 v76, s74, v76
    v_xor_b32 v76, 8, v76
    v_lshlrev_b32 v77, 4, v76
    v_lshrrev_b32 v76, 5, v1
    v_lshl_add_u32 v71, v76, 13, v77
    v_add_u32 v71, 16384, v71
    s_lshl_b32 s74, s58, 15
    v_add_u32 v70, s74, v70
    v_add_u32 v71, s74, v71
    s_mov_b32 s70, 262144
    s_mul_i32 s68, s79, 524288
    s_mul_i32 s69, s80, 512
    s_mov_b32 s82, 0x40000
    s_lshl_b32 s81, s79, 1
    s_lshr_b32 s84, s58, 2
    s_add_u32 s81, s81, s84
    s_mul_i32 s81, s81, s82
    s_mul_i32 s81, s81, 4
    s_lshl_b32 s74, s80, 2
    s_and_b32 s84, s58, 3
    s_add_u32 s84, s84, s74
    s_mul_i32 s84, s84, 4096
    s_add_u32 s81, s81, s84
    s_add_u32 s81, s81, 0x2000000
    s_mul_i32 s71, s58, 2048
    s_mov_b32 m0, s71
    s_nop 0
    buffer_load_dwordx4 v68, s[60:63], s68 offen lds
    s_add_u32 m0, s71, 1024
    s_nop 0
    buffer_load_dwordx4 v69, s[60:63], s68 offen lds
    s_add_u32 m0, s71, 16384
    s_nop 0
    buffer_load_dwordx4 v70, s[64:67], s69 offen lds
    s_add_u32 m0, s71, 17408
    s_nop 0
    buffer_load_dwordx4 v71, s[64:67], s69 offen lds
    s_add_u32 s68, s68, 64
    s_add_u32 s69, s69, s70
    s_add_u32 s71, s71, 32768
    s_and_b32 s71, s71, 0x1ffff
    s_mov_b32 m0, s71
    s_nop 0
    buffer_load_dwordx4 v68, s[60:63], s68 offen lds
    s_add_u32 m0, s71, 1024
    s_nop 0
    buffer_load_dwordx4 v69, s[60:63], s68 offen lds
    s_add_u32 m0, s71, 16384
    s_nop 0
    buffer_load_dwordx4 v70, s[64:67], s69 offen lds
    s_add_u32 m0, s71, 17408
    s_nop 0
    buffer_load_dwordx4 v71, s[64:67], s69 offen lds
    s_add_u32 s68, s68, 64
    s_add_u32 s69, s69, s70
    s_add_u32 s71, s71, 32768
    s_and_b32 s71, s71, 0x1ffff
    s_mov_b32 m0, s71
    s_nop 0
    buffer_load_dwordx4 v68, s[60:63], s68 offen lds
    s_add_u32 m0, s71, 1024
    s_nop 0
    buffer_load_dwordx4 v69, s[60:63], s68 offen lds
    s_add_u32 m0, s71, 16384
    s_nop 0
    buffer_load_dwordx4 v70, s[64:67], s69 offen lds
    s_add_u32 m0, s71, 17408
    s_nop 0
    buffer_load_dwordx4 v71, s[64:67], s69 offen lds
    s_add_u32 s68, s68, 64
    s_add_u32 s69, s69, s70
    s_add_u32 s71, s71, 32768
    s_and_b32 s71, s71, 0x1ffff
    s_mov_b32 m0, s71
    s_nop 0
    buffer_load_dwordx4 v68, s[60:63], s68 offen lds
    s_add_u32 m0, s71, 1024
    s_nop 0
    buffer_load_dwordx4 v69, s[60:63], s68 offen lds
    s_add_u32 m0, s71, 16384
    s_nop 0
    buffer_load_dwordx4 v70, s[64:67], s69 offen lds
    s_add_u32 m0, s71, 17408
    s_nop 0
    buffer_load_dwordx4 v71, s[64:67], s69 offen lds
    s_add_u32 s68, s68, 64
    s_add_u32 s69, s69, s70
    s_add_u32 s71, s71, 32768
    s_and_b32 s71, s71, 0x1ffff
    s_branch t256_47
q_58:
    s_lshr_b32 s79, s57, 2
    s_bfe_u32 s80, s76, 0x20000
    s_bfe_u32 s84, s76, 0x20005
    s_lshl_b32 s84, s84, 2
    s_or_b32 s80, s80, s84
    s_mov_b32 s83, 48
    s_mov_b64 s[60:61], s[36:37]
    s_mov_b32 s62, 0x400000
    s_mov_b32 s63, 0x20000
    s_mov_b64 s[64:65], s[20:21]
    s_mov_b32 s66, 0x800000
    s_mov_b32 s67, 0x20000
    v_lshrrev_b32 v76, 4, v1
    v_sub_u32 v76, 0, v76
    v_xor_b32 v76, v76, v1
    v_and_b32 v76, 3, v76
    s_mul_i32 s74, s58, 32
    v_lshrrev_b32 v77, 2, v1
    v_add3_u32 v77, v77, s74, 0
    v_lshlrev_b32 v68, 11, v77
    v_lshl_add_u32 v68, v76, 4, v68
    v_lshrrev_b32 v77, 2, v1
    v_add3_u32 v77, v77, s74, 16
    v_lshlrev_b32 v69, 11, v77
    v_lshl_add_u32 v69, v76, 4, v69
    s_and_b32 s74, s58, 2
    v_bfe_u32 v76, v1, 0, 5
    v_bfe_u32 v77, v1, 5, 1
    v_lshlrev_b32 v77, 2, v77
    v_xor_b32 v76, v76, v77
    v_xor_b32 v76, s74, v76
    v_bfe_u32 v77, v76, 0, 1
    v_lshlrev_b32 v77, 5, v77
    v_bfe_u32 v75, v76, 1, 1
    v_lshl_or_b32 v77, v75, 4, v77
    v_bfe_u32 v75, v76, 2, 3
    v_lshl_or_b32 v77, v75, 6, v77
    v_lshrrev_b32 v76, 5, v1
    v_lshl_add_u32 v70, v76, 13, v77
    v_bfe_u32 v76, v1, 0, 5
    v_bfe_u32 v77, v1, 5, 1
    v_lshlrev_b32 v77, 2, v77
    v_xor_b32 v76, v76, v77
    v_xor_b32 v76, s74, v76
    v_xor_b32 v76, 8, v76
    v_bfe_u32 v77, v76, 0, 1
    v_lshlrev_b32 v77, 5, v77
    v_bfe_u32 v75, v76, 1, 1
    v_lshl_or_b32 v77, v75, 4, v77
    v_bfe_u32 v75, v76, 2, 3
    v_lshl_or_b32 v77, v75, 6, v77
    v_lshrrev_b32 v76, 5, v1
    v_lshl_add_u32 v71, v76, 13, v77
    v_add_u32 v71, 16384, v71
    s_lshl_b32 s74, s58, 15
    v_add_u32 v70, s74, v70
    v_add_u32 v71, s74, v71
    s_mov_b32 s70, 262144
    s_mul_i32 s68, s79, 524288
    s_mul_i32 s69, s80, 512
    s_mov_b32 s82, 0x40000
    s_lshl_b32 s81, s79, 1
    s_lshr_b32 s84, s58, 2
    s_add_u32 s81, s81, s84
    s_mul_i32 s81, s81, s82
    s_mul_i32 s81, s81, 4
    s_lshl_b32 s74, s80, 2
    s_and_b32 s84, s58, 3
    s_add_u32 s84, s84, s74
    s_mul_i32 s84, s84, 4096
    s_add_u32 s81, s81, s84
    s_add_u32 s81, s81, 0x0
    s_mul_i32 s71, s58, 2048
    s_mov_b32 m0, s71
    s_nop 0
    buffer_load_dwordx4 v68, s[60:63], s68 offen lds
    s_add_u32 m0, s71, 1024
    s_nop 0
    buffer_load_dwordx4 v69, s[60:63], s68 offen lds
    s_add_u32 m0, s71, 16384
    s_nop 0
    buffer_load_dwordx4 v70, s[64:67], s69 offen lds
    s_add_u32 m0, s71, 17408
    s_nop 0
    buffer_load_dwordx4 v71, s[64:67], s69 offen lds
    s_add_u32 s68, s68, 64
    s_add_u32 s69, s69, s70
    s_add_u32 s71, s71, 32768
    s_and_b32 s71, s71, 0x1ffff
    s_mov_b32 m0, s71
    s_nop 0
    buffer_load_dwordx4 v68, s[60:63], s68 offen lds
    s_add_u32 m0, s71, 1024
    s_nop 0
    buffer_load_dwordx4 v69, s[60:63], s68 offen lds
    s_add_u32 m0, s71, 16384
    s_nop 0
    buffer_load_dwordx4 v70, s[64:67], s69 offen lds
    s_add_u32 m0, s71, 17408
    s_nop 0
    buffer_load_dwordx4 v71, s[64:67], s69 offen lds
    s_add_u32 s68, s68, 64
    s_add_u32 s69, s69, s70
    s_add_u32 s71, s71, 32768
    s_and_b32 s71, s71, 0x1ffff
    s_mov_b32 m0, s71
    s_nop 0
    buffer_load_dwordx4 v68, s[60:63], s68 offen lds
    s_add_u32 m0, s71, 1024
    s_nop 0
    buffer_load_dwordx4 v69, s[60:63], s68 offen lds
    s_add_u32 m0, s71, 16384
    s_nop 0
    buffer_load_dwordx4 v70, s[64:67], s69 offen lds
    s_add_u32 m0, s71, 17408
    s_nop 0
    buffer_load_dwordx4 v71, s[64:67], s69 offen lds
    s_add_u32 s68, s68, 64
    s_add_u32 s69, s69, s70
    s_add_u32 s71, s71, 32768
    s_and_b32 s71, s71, 0x1ffff
    s_mov_b32 m0, s71
    s_nop 0
    buffer_load_dwordx4 v68, s[60:63], s68 offen lds
    s_add_u32 m0, s71, 1024
    s_nop 0
    buffer_load_dwordx4 v69, s[60:63], s68 offen lds
    s_add_u32 m0, s71, 16384
    s_nop 0
    buffer_load_dwordx4 v70, s[64:67], s69 offen lds
    s_add_u32 m0, s71, 17408
    s_nop 0
    buffer_load_dwordx4 v71, s[64:67], s69 offen lds
    s_add_u32 s68, s68, 64
    s_add_u32 s69, s69, s70
    s_add_u32 s71, s71, 32768
    s_and_b32 s71, s71, 0x1ffff
    s_branch f256_46
fft_63:
    s_cmp_eq_u32 s78, 3
    s_cbranch_scc1 col_59
    s_cmp_lg_u32 s58, 0
    s_cbranch_scc1 wall_64
    v_mov_b32 v76, 136
wctr_65:
    buffer_load_dword v75, v76, s[12:15], 0 offen sc1
    s_waitcnt vmcnt(0)
    v_cmp_gt_u32 vcc, 128, v75
    s_cbranch_vccz wctr_ok_66
    s_sub_u32 s77, s77, 1
    s_cbranch_scc0 wctr_65
    s_mov_b32 s77, 0
wctr_ok_66:
wall_64:
    s_barrier
    s_and_b32 s79, s57, 7
    s_mov_b32 s80, s75
    s_mov_b32 s83, 40
    s_mov_b64 s[60:61], s[44:45]
    s_mov_b32 s62, 0x400000
    s_mov_b32 s63, 0x20000
    s_mov_b64 s[64:65], s[8:9]
    s_mov_b32 s66, 0x10000000
    s_mov_b32 s67, 0x20000
    v_lshrrev_b32 v76, 4, v1
    v_sub_u32 v76, 0, v76
    v_xor_b32 v76, v76, v1
    v_and_b32 v76, 3, v76
    s_mul_i32 s74, s58, 32
    v_lshrrev_b32 v77, 2, v1
    v_add3_u32 v77, v77, s74, 0
    v_bfe_u32 v68, v77, 0, 3
    v_lshlrev_b32 v68, 17, v68
    v_bfe_u32 v75, v77, 3, 1
    v_lshl_or_b32 v68, v75, 21, v68
    v_bfe_u32 v75, v77, 4, 1
    v_lshl_or_b32 v68, v75, 20, v68
    v_bfe_u32 v75, v77, 5, 3
    v_lshl_or_b32 v68, v75, 11, v68
    v_lshl_add_u32 v68, v76, 4, v68
    v_lshrrev_b32 v77, 2, v1
    v_add3_u32 v77, v77, s74, 16
    v_bfe_u32 v69, v77, 0, 3
    v_lshlrev_b32 v69, 17, v69
    v_bfe_u32 v75, v77, 3, 1
    v_lshl_or_b32 v69, v75, 21, v69
    v_bfe_u32 v75, v77, 4, 1
    v_lshl_or_b32 v69, v75, 20, v69
    v_bfe_u32 v75, v77, 5, 3
    v_lshl_or_b32 v69, v75, 11, v69
    v_lshl_add_u32 v69, v76, 4, v69
    s_and_b32 s74, s58, 2
    v_bfe_u32 v76, v1, 0, 5
    v_bfe_u32 v77, v1, 5, 1
    v_lshlrev_b32 v77, 2, v77
    v_xor_b32 v76, v76, v77
    v_xor_b32 v76, s74, v76
    v_lshlrev_b32 v77, 4, v76
    v_lshrrev_b32 v76, 5, v1
    v_lshl_add_u32 v70, v76, 11, v77
    v_bfe_u32 v76, v1, 0, 5
    v_bfe_u32 v77, v1, 5, 1
    v_lshlrev_b32 v77, 2, v77
    v_xor_b32 v76, v76, v77
    v_xor_b32 v76, s74, v76
    v_xor_b32 v76, 8, v76
    v_lshlrev_b32 v77, 4, v76
    v_lshrrev_b32 v76, 5, v1
    v_lshl_add_u32 v71, v76, 11, v77
    v_add_u32 v71, 4096, v71
    s_lshl_b32 s74, s58, 13
    v_add_u32 v70, s74, v70
    v_add_u32 v71, s74, v71
    s_mov_b32 s70, 65536
    s_lshl_b32 s68, s79, 14
    s_lshl_b32 s69, s80, 9
    s_add_u32 s69, s69, 0x5200000
    s_mov_b32 s82, 0x10000
    s_lshl_b32 s81, s79, 1
    s_lshr_b32 s84, s58, 2
    s_add_u32 s81, s81, s84
    s_mul_i32 s81, s81, s82
    s_mul_i32 s81, s81, 4
    s_lshl_b32 s74, s80, 2
    s_and_b32 s84, s58, 3
    s_add_u32 s84, s84, s74
    s_mul_i32 s84, s84, 4096
    s_add_u32 s81, s81, s84
    s_add_u32 s81, s81, 0x5400000
    s_mul_i32 s71, s58, 2048
    s_mov_b32 m0, s71
    s_nop 0
    buffer_load_dwordx4 v68, s[60:63], s68 offen lds
    s_add_u32 m0, s71, 1024
    s_nop 0
    buffer_load_dwordx4 v69, s[60:63], s68 offen lds
    s_add_u32 m0, s71, 16384
    s_nop 0
    buffer_load_dwordx4 v70, s[64:67], s69 offen lds
    s_add_u32 m0, s71, 17408
    s_nop 0
    buffer_load_dwordx4 v71, s[64:67], s69 offen lds
    s_add_u32 s68, s68, 64
    s_add_u32 s69, s69, s70
    s_add_u32 s71, s71, 32768
    s_and_b32 s71, s71, 0x1ffff
    s_mov_b32 m0, s71
    s_nop 0
    buffer_load_dwordx4 v68, s[60:63], s68 offen lds
    s_add_u32 m0, s71, 1024
    s_nop 0
    buffer_load_dwordx4 v69, s[60:63], s68 offen lds
    s_add_u32 m0, s71, 16384
    s_nop 0
    buffer_load_dwordx4 v70, s[64:67], s69 offen lds
    s_add_u32 m0, s71, 17408
    s_nop 0
    buffer_load_dwordx4 v71, s[64:67], s69 offen lds
    s_add_u32 s68, s68, 64
    s_add_u32 s69, s69, s70
    s_add_u32 s71, s71, 32768
    s_and_b32 s71, s71, 0x1ffff
    s_mov_b32 m0, s71
    s_nop 0
    buffer_load_dwordx4 v68, s[60:63], s68 offen lds
    s_add_u32 m0, s71, 1024
    s_nop 0
    buffer_load_dwordx4 v69, s[60:63], s68 offen lds
    s_add_u32 m0, s71, 16384
    s_nop 0
    buffer_load_dwordx4 v70, s[64:67], s69 offen lds
    s_add_u32 m0, s71, 17408
    s_nop 0
    buffer_load_dwordx4 v71, s[64:67], s69 offen lds
    s_add_u32 s68, s68, 64
    s_add_u32 s69, s69, s70
    s_add_u32 s71, s71, 32768
    s_and_b32 s71, s71, 0x1ffff
    s_mov_b32 m0, s71
    s_nop 0
    buffer_load_dwordx4 v68, s[60:63], s68 offen lds
    s_add_u32 m0, s71, 1024
    s_nop 0
    buffer_load_dwordx4 v69, s[60:63], s68 offen lds
    s_add_u32 m0, s71, 16384
    s_nop 0
    buffer_load_dwordx4 v70, s[64:67], s69 offen lds
    s_add_u32 m0, s71, 17408
    s_nop 0
    buffer_load_dwordx4 v71, s[64:67], s69 offen lds
    s_add_u32 s68, s68, 64
    s_add_u32 s69, s69, s70
    s_add_u32 s71, s71, 32768
    s_and_b32 s71, s71, 0x1ffff
    s_branch t256_47
col_59:
    s_bfe_u32 s79, s76, 0x30000
    s_bfe_u32 s84, s76, 0x20005
    s_lshl_b32 s84, s84, 3
    s_or_b32 s79, s79, s84
    v_bfe_u32 v231, v1, 0, 5
    v_bfe_u32 v235, v1, 5, 1
    v_lshl_or_b32 v231, v235, 7, v231
    v_mul_u32_u24 v231, 1026, v231
    v_and_b32 v231, -4, v231
    s_mul_i32 s5, s58, 262656
    s_lshl_b32 s2, s79, 5
    s_add_u32 s5, s5, s2
    buffer_load_dwordx4 v[84:87], v231, s[48:51], s5 offen
    buffer_load_dwordx4 v[88:91], v231, s[48:51], s5 offen offset:16
    buffer_load_dword v92, v231, s[48:51], s5 offen offset:32
    buffer_load_dwordx4 v[94:97], v231, s[52:55], s5 offen
    buffer_load_dwordx4 v[98:101], v231, s[52:55], s5 offen offset:16
    buffer_load_dword v102, v231, s[52:55], s5 offen offset:32
    s_add_u32 s5, s5, 32832
    buffer_load_dwordx4 v[104:107], v231, s[48:51], s5 offen
    buffer_load_dwordx4 v[108:111], v231, s[48:51], s5 offen offset:16
    buffer_load_dword v112, v231, s[48:51], s5 offen offset:32
    buffer_load_dwordx4 v[114:117], v231, s[52:55], s5 offen
    buffer_load_dwordx4 v[118:121], v231, s[52:55], s5 offen offset:16
    buffer_load_dword v122, v231, s[52:55], s5 offen offset:32
    s_add_u32 s5, s5, 32832
    buffer_load_dwordx4 v[124:127], v231, s[48:51], s5 offen
    buffer_load_dwordx4 v[128:131], v231, s[48:51], s5 offen offset:16
    buffer_load_dword v132, v231, s[48:51], s5 offen offset:32
    buffer_load_dwordx4 v[134:137], v231, s[52:55], s5 offen
    buffer_load_dwordx4 v[138:141], v231, s[52:55], s5 offen offset:16
    buffer_load_dword v142, v231, s[52:55], s5 offen offset:32
    s_add_u32 s5, s5, 32832
    buffer_load_dwordx4 v[144:147], v231, s[48:51], s5 offen
    buffer_load_dwordx4 v[148:151], v231, s[48:51], s5 offen offset:16
    buffer_load_dword v152, v231, s[48:51], s5 offen offset:32
    buffer_load_dwordx4 v[154:157], v231, s[52:55], s5 offen
    buffer_load_dwordx4 v[158:161], v231, s[52:55], s5 offen offset:16
    buffer_load_dword v162, v231, s[52:55], s5 offen offset:32
    s_add_u32 s5, s5, 32832
    v_and_b32 v235, 31, v1
    v_cvt_f32_u32 v228, v235
    v_and_b32 v235, 32, v1
    v_cvt_f32_u32 v235, v235
    v_mul_f32 v229, v228, v235
    v_mul_f32 v229, 0x3b000000, v229
    v_mul_f32 v234, 0x3d000000, v229
    v_fmamk_f32 v230, v235, 0x3b000000, v234
    v_and_b32 v233, 1, v1
    v_lshlrev_b32 v232, 4, v233
    v_mul_u32_u24 v233, 0x8000, v233
    v_lshl_or_b32 v233, v233, 16, v233
    v_fmamk_f32 v243, v228, 0x0, v229
    v_add_f32 v244, v243, v243
    v_cos_f32 v235, v243
    v_sin_f32 v237, v243
    v_cos_f32 v239, v244
    v_sin_f32 v241, v244
    v_fmamk_f32 v243, v228, 0x3c800000, v229
    v_add_f32 v244, v243, v243
    v_cos_f32 v236, v243
    v_sin_f32 v238, v243
    v_cos_f32 v240, v244
    v_sin_f32 v242, v244
    v_cvt_pk_bf16_f32 v4, v235, v236
    v_cvt_pk_bf16_f32 v36, v237, v238
    v_cvt_pk_bf16_f32 v68, v239, v240
    v_cvt_pk_bf16_f32 v76, v241, v242
    v_fmamk_f32 v243, v228, 0x3d000000, v229
    v_add_f32 v244, v243, v243
    v_cos_f32 v235, v243
    v_sin_f32 v237, v243
    v_cos_f32 v239, v244
    v_sin_f32 v241, v244
    v_fmamk_f32 v243, v228, 0x3d400000, v229
    v_add_f32 v244, v243, v243
    v_cos_f32 v236, v243
    v_sin_f32 v238, v243
    v_cos_f32 v240, v244
    v_sin_f32 v242, v244
    v_cvt_pk_bf16_f32 v5, v235, v236
    v_cvt_pk_bf16_f32 v37, v237, v238
    v_cvt_pk_bf16_f32 v69, v239, v240
    v_cvt_pk_bf16_f32 v77, v241, v242
    v_fmamk_f32 v243, v228, 0x3e000000, v229
    v_add_f32 v244, v243, v243
    v_cos_f32 v235, v243
    v_sin_f32 v237, v243
    v_cos_f32 v239, v244
    v_sin_f32 v241, v244
    v_fmamk_f32 v243, v228, 0x3e100000, v229
    v_add_f32 v244, v243, v243
    v_cos_f32 v236, v243
    v_sin_f32 v238, v243
    v_cos_f32 v240, v244
    v_sin_f32 v242, v244
    v_cvt_pk_bf16_f32 v6, v235, v236
    v_cvt_pk_bf16_f32 v38, v237, v238
    v_cvt_pk_bf16_f32 v70, v239, v240
    v_cvt_pk_bf16_f32 v78, v241, v242
    v_fmamk_f32 v243, v228, 0x3e200000, v229
    v_add_f32 v244, v243, v243
    v_cos_f32 v235, v243
    v_sin_f32 v237, v243
    v_cos_f32 v239, v244
    v_sin_f32 v241, v244
    v_fmamk_f32 v243, v228, 0x3e300000, v229
    v_add_f32 v244, v243, v243
    v_cos_f32 v236, v243
    v_sin_f32 v238, v243
    v_cos_f32 v240, v244
    v_sin_f32 v242, v244
    v_cvt_pk_bf16_f32 v7, v235, v236
    v_cvt_pk_bf16_f32 v39, v237, v238
    v_cvt_pk_bf16_f32 v71, v239, v240
    v_cvt_pk_bf16_f32 v79, v241, v242
    v_fmamk_f32 v243, v228, 0x3e800000, v229
    v_add_f32 v244, v243, v243
    v_cos_f32 v235, v243
    v_sin_f32 v237, v243
    v_cos_f32 v239, v244
    v_sin_f32 v241, v244
    v_fmamk_f32 v243, v228, 0x3e880000, v229
    v_add_f32 v244, v243, v243
    v_cos_f32 v236, v243
    v_sin_f32 v238, v243
    v_cos_f32 v240, v244
    v_sin_f32 v242, v244
    v_cvt_pk_bf16_f32 v8, v235, v236
    v_cvt_pk_bf16_f32 v40, v237, v238
    v_cvt_pk_bf16_f32 v72, v239, v240
    v_cvt_pk_bf16_f32 v80, v241, v242
    v_fmamk_f32 v243, v228, 0x3e900000, v229
    v_add_f32 v244, v243, v243
    v_cos_f32 v235, v243
    v_sin_f32 v237, v243
    v_cos_f32 v239, v244
    v_sin_f32 v241, v244
    v_fmamk_f32 v243, v228, 0x3e980000, v229
    v_add_f32 v244, v243, v243
    v_cos_f32 v236, v243
    v_sin_f32 v238, v243
    v_cos_f32 v240, v244
    v_sin_f32 v242, v244
    v_cvt_pk_bf16_f32 v9, v235, v236
    v_cvt_pk_bf16_f32 v41, v237, v238
    v_cvt_pk_bf16_f32 v73, v239, v240
    v_cvt_pk_bf16_f32 v81, v241, v242
    v_fmamk_f32 v243, v228, 0x3ec00000, v229
    v_add_f32 v244, v243, v243
    v_cos_f32 v235, v243
    v_sin_f32 v237, v243
    v_cos_f32 v239, v244
    v_sin_f32 v241, v244
    v_fmamk_f32 v243, v228, 0x3ec80000, v229
    v_add_f32 v244, v243, v243
    v_cos_f32 v236, v243
    v_sin_f32 v238, v243
    v_cos_f32 v240, v244
    v_sin_f32 v242, v244
    v_cvt_pk_bf16_f32 v10, v235, v236
    v_cvt_pk_bf16_f32 v42, v237, v238
    v_cvt_pk_bf16_f32 v74, v239, v240
    v_cvt_pk_bf16_f32 v82, v241, v242
    v_fmamk_f32 v243, v228, 0x3ed00000, v229
    v_add_f32 v244, v243, v243
    v_cos_f32 v235, v243
    v_sin_f32 v237, v243
    v_cos_f32 v239, v244
    v_sin_f32 v241, v244
    v_fmamk_f32 v243, v228, 0x3ed80000, v229
    v_add_f32 v244, v243, v243
    v_cos_f32 v236, v243
    v_sin_f32 v238, v243
    v_cos_f32 v240, v244
    v_sin_f32 v242, v244
    v_cvt_pk_bf16_f32 v11, v235, v236
    v_cvt_pk_bf16_f32 v43, v237, v238
    v_cvt_pk_bf16_f32 v75, v239, v240
    v_cvt_pk_bf16_f32 v83, v241, v242
    v_xor_b32 v12, v233, v4
    v_xor_b32 v13, v233, v5
    v_xor_b32 v14, v233, v6
    v_xor_b32 v15, v233, v7
    v_xor_b32 v16, v233, v8
    v_xor_b32 v17, v233, v9
    v_xor_b32 v18, v233, v10
    v_xor_b32 v19, v233, v11
    v_xor_b32 v20, 0x80000000, v4
    v_xor_b32 v21, 0x80000000, v5
    v_xor_b32 v22, 0x80000000, v6
    v_xor_b32 v23, 0x80000000, v7
    v_xor_b32 v24, 0x80000000, v8
    v_xor_b32 v25, 0x80000000, v9
    v_xor_b32 v26, 0x80000000, v10
    v_xor_b32 v27, 0x80000000, v11
    v_xor_b32 v28, 0x80000000, v12
    v_xor_b32 v29, 0x80000000, v13
    v_xor_b32 v30, 0x80000000, v14
    v_xor_b32 v31, 0x80000000, v15
    v_xor_b32 v32, 0x80000000, v16
    v_xor_b32 v33, 0x80000000, v17
    v_xor_b32 v34, 0x80000000, v18
    v_xor_b32 v35, 0x80000000, v19
    v_xor_b32 v44, v233, v36
    v_xor_b32 v45, v233, v37
    v_xor_b32 v46, v233, v38
    v_xor_b32 v47, v233, v39
    v_xor_b32 v48, v233, v40
    v_xor_b32 v49, v233, v41
    v_xor_b32 v50, v233, v42
    v_xor_b32 v51, v233, v43
    v_xor_b32 v52, 0x80000000, v36
    v_xor_b32 v53, 0x80000000, v37
    v_xor_b32 v54, 0x80000000, v38
    v_xor_b32 v55, 0x80000000, v39
    v_xor_b32 v56, 0x80000000, v40
    v_xor_b32 v57, 0x80000000, v41
    v_xor_b32 v58, 0x80000000, v42
    v_xor_b32 v59, 0x80000000, v43
    v_xor_b32 v60, 0x80000000, v44
    v_xor_b32 v61, 0x80000000, v45
    v_xor_b32 v62, 0x80000000, v46
    v_xor_b32 v63, 0x80000000, v47
    v_xor_b32 v64, 0x80000000, v48
    v_xor_b32 v65, 0x80000000, v49
    v_xor_b32 v66, 0x80000000, v50
    v_xor_b32 v67, 0x80000000, v51
    s_mov_b32 s2, 0x05040100
    s_mov_b32 s3, 0x07060302
    s_lshl_b32 s5, s58, 10
    v_lshl_add_u32 v231, v1, 4, s5
    v_add_u32 v233, 0x10000, v231
    v_add_u32 v235, 0x20000, v231
    s_waitcnt vmcnt(0)
    v_alignbit_b32 v84, v85, v84, v232
    v_alignbit_b32 v94, v95, v94, v232
    v_alignbit_b32 v104, v105, v104, v232
    v_alignbit_b32 v114, v115, v114, v232
    v_alignbit_b32 v124, v125, v124, v232
    v_alignbit_b32 v134, v135, v134, v232
    v_alignbit_b32 v144, v145, v144, v232
    v_alignbit_b32 v154, v155, v154, v232
    v_perm_b32 v196, v94, v84, s2
    v_perm_b32 v197, v114, v104, s2
    v_perm_b32 v198, v134, v124, s2
    v_perm_b32 v199, v154, v144, s2
    ds_write_b128 v231, v[196:199] offset:0
    v_perm_b32 v200, v94, v84, s3
    v_perm_b32 v201, v114, v104, s3
    v_perm_b32 v202, v134, v124, s3
    v_perm_b32 v203, v154, v144, s3
    ds_write_b128 v231, v[200:203] offset:8192
    v_alignbit_b32 v85, v86, v85, v232
    v_alignbit_b32 v95, v96, v95, v232
    v_alignbit_b32 v105, v106, v105, v232
    v_alignbit_b32 v115, v116, v115, v232
    v_alignbit_b32 v125, v126, v125, v232
    v_alignbit_b32 v135, v136, v135, v232
    v_alignbit_b32 v145, v146, v145, v232
    v_alignbit_b32 v155, v156, v155, v232
    v_perm_b32 v204, v95, v85, s2
    v_perm_b32 v205, v115, v105, s2
    v_perm_b32 v206, v135, v125, s2
    v_perm_b32 v207, v155, v145, s2
    ds_write_b128 v231, v[204:207] offset:16384
    v_perm_b32 v208, v95, v85, s3
    v_perm_b32 v209, v115, v105, s3
    v_perm_b32 v210, v135, v125, s3
    v_perm_b32 v211, v155, v145, s3
    ds_write_b128 v231, v[208:211] offset:24576
    v_alignbit_b32 v86, v87, v86, v232
    v_alignbit_b32 v96, v97, v96, v232
    v_alignbit_b32 v106, v107, v106, v232
    v_alignbit_b32 v116, v117, v116, v232
    v_alignbit_b32 v126, v127, v126, v232
    v_alignbit_b32 v136, v137, v136, v232
    v_alignbit_b32 v146, v147, v146, v232
    v_alignbit_b32 v156, v157, v156, v232
    v_perm_b32 v212, v96, v86, s2
    v_perm_b32 v213, v116, v106, s2
    v_perm_b32 v214, v136, v126, s2
    v_perm_b32 v215, v156, v146, s2
    ds_write_b128 v231, v[212:215] offset:32768
    v_perm_b32 v216, v96, v86, s3
    v_perm_b32 v217, v116, v106, s3
    v_perm_b32 v218, v136, v126, s3
    v_perm_b32 v219, v156, v146, s3
    ds_write_b128 v231, v[216:219] offset:40960
    v_alignbit_b32 v87, v88, v87, v232
    v_alignbit_b32 v97, v98, v97, v232
    v_alignbit_b32 v107, v108, v107, v232
    v_alignbit_b32 v117, v118, v117, v232
    v_alignbit_b32 v127, v128, v127, v232
    v_alignbit_b32 v137, v138, v137, v232
    v_alignbit_b32 v147, v148, v147, v232
    v_alignbit_b32 v157, v158, v157, v232
    v_perm_b32 v220, v97, v87, s2
    v_perm_b32 v221, v117, v107, s2
    v_perm_b32 v222, v137, v127, s2
    v_perm_b32 v223, v157, v147, s2
    ds_write_b128 v231, v[220:223] offset:49152
    v_perm_b32 v224, v97, v87, s3
    v_perm_b32 v225, v117, v107, s3
    v_perm_b32 v226, v137, v127, s3
    v_perm_b32 v227, v157, v147, s3
    ds_write_b128 v231, v[224:227] offset:57344
    v_alignbit_b32 v88, v89, v88, v232
    v_alignbit_b32 v98, v99, v98, v232
    v_alignbit_b32 v108, v109, v108, v232
    v_alignbit_b32 v118, v119, v118, v232
    v_alignbit_b32 v128, v129, v128, v232
    v_alignbit_b32 v138, v139, v138, v232
    v_alignbit_b32 v148, v149, v148, v232
    v_alignbit_b32 v158, v159, v158, v232
    v_perm_b32 v196, v98, v88, s2
    v_perm_b32 v197, v118, v108, s2
    v_perm_b32 v198, v138, v128, s2
    v_perm_b32 v199, v158, v148, s2
    ds_write_b128 v233, v[196:199] offset:0
    v_perm_b32 v200, v98, v88, s3
    v_perm_b32 v201, v118, v108, s3
    v_perm_b32 v202, v138, v128, s3
    v_perm_b32 v203, v158, v148, s3
    ds_write_b128 v233, v[200:203] offset:8192
    v_alignbit_b32 v89, v90, v89, v232
    v_alignbit_b32 v99, v100, v99, v232
    v_alignbit_b32 v109, v110, v109, v232
    v_alignbit_b32 v119, v120, v119, v232
    v_alignbit_b32 v129, v130, v129, v232
    v_alignbit_b32 v139, v140, v139, v232
    v_alignbit_b32 v149, v150, v149, v232
    v_alignbit_b32 v159, v160, v159, v232
    v_perm_b32 v204, v99, v89, s2
    v_perm_b32 v205, v119, v109, s2
    v_perm_b32 v206, v139, v129, s2
    v_perm_b32 v207, v159, v149, s2
    ds_write_b128 v233, v[204:207] offset:16384
    v_perm_b32 v208, v99, v89, s3
    v_perm_b32 v209, v119, v109, s3
    v_perm_b32 v210, v139, v129, s3
    v_perm_b32 v211, v159, v149, s3
    ds_write_b128 v233, v[208:211] offset:24576
    v_alignbit_b32 v90, v91, v90, v232
    v_alignbit_b32 v100, v101, v100, v232
    v_alignbit_b32 v110, v111, v110, v232
    v_alignbit_b32 v120, v121, v120, v232
    v_alignbit_b32 v130, v131, v130, v232
    v_alignbit_b32 v140, v141, v140, v232
    v_alignbit_b32 v150, v151, v150, v232
    v_alignbit_b32 v160, v161, v160, v232
    v_perm_b32 v212, v100, v90, s2
    v_perm_b32 v213, v120, v110, s2
    v_perm_b32 v214, v140, v130, s2
    v_perm_b32 v215, v160, v150, s2
    ds_write_b128 v233, v[212:215] offset:32768
    v_perm_b32 v216, v100, v90, s3
    v_perm_b32 v217, v120, v110, s3
    v_perm_b32 v218, v140, v130, s3
    v_perm_b32 v219, v160, v150, s3
    ds_write_b128 v233, v[216:219] offset:40960
    v_alignbit_b32 v91, v92, v91, v232
    v_alignbit_b32 v101, v102, v101, v232
    v_alignbit_b32 v111, v112, v111, v232
    v_alignbit_b32 v121, v122, v121, v232
    v_alignbit_b32 v131, v132, v131, v232
    v_alignbit_b32 v141, v142, v141, v232
    v_alignbit_b32 v151, v152, v151, v232
    v_alignbit_b32 v161, v162, v161, v232
    v_perm_b32 v220, v101, v91, s2
    v_perm_b32 v221, v121, v111, s2
    v_perm_b32 v222, v141, v131, s2
    v_perm_b32 v223, v161, v151, s2
    ds_write_b128 v233, v[220:223] offset:49152
    v_perm_b32 v224, v101, v91, s3
    v_perm_b32 v225, v121, v111, s3
    v_perm_b32 v226, v141, v131, s3
    v_perm_b32 v227, v161, v151, s3
    ds_write_b128 v233, v[224:227] offset:57344
    v_alignbit_b32 v92, v92, v92, v232
    v_alignbit_b32 v102, v102, v102, v232
    v_alignbit_b32 v112, v112, v112, v232
    v_alignbit_b32 v122, v122, v122, v232
    v_alignbit_b32 v132, v132, v132, v232
    v_alignbit_b32 v142, v142, v142, v232
    v_alignbit_b32 v152, v152, v152, v232
    v_alignbit_b32 v162, v162, v162, v232
    v_perm_b32 v196, v102, v92, s2
    v_perm_b32 v197, v122, v112, s2
    v_perm_b32 v198, v142, v132, s2
    v_perm_b32 v199, v162, v152, s2
    ds_write_b128 v235, v[196:199] offset:0
    s_waitcnt lgkmcnt(0)
    s_cmp_lg_u32 s58, 0
    s_cbranch_scc1 wall_67
    v_mov_b32 v236, 40
wctr_68:
    buffer_load_dword v235, v236, s[12:15], 0 offen sc1
    s_waitcnt vmcnt(0)
    v_cmp_gt_u32 vcc, 32, v235
    s_cbranch_vccz wctr_ok_69
    s_sub_u32 s77, s77, 1
    s_cbranch_scc0 wctr_68
    s_mov_b32 s77, 0
wctr_ok_69:
wall_67:
    s_barrier
    s_mov_b32 s7, s58
colloop_70:
    s_lshl_b32 s3, s79, 4
    s_add_u32 s3, s3, s7
    s_lshl_b32 s3, s3, 1
    s_cmp_eq_u32 s3, 1024
    s_cselect_b32 s3, 1, s3
    s_cmp_lt_u32 s3, 2
    s_cselect_b32 s6, 0x5ffffff0, 0
    s_mov_b32 s4, 0x35800000
    s_cselect_b32 s4, 0x35000000, s4
    v_bfe_u32 v231, v1, 0, 5
    v_lshlrev_b32 v231, 16, v231
    v_bfe_u32 v235, v1, 5, 1
    v_lshl_or_b32 v231, v235, 9, v231
    v_add_u32 v232, s6, v231
    s_bfe_u32 s5, s3, 0x50000
    s_lshl_b32 s5, s5, 4
    s_bfe_u32 s2, s3, 0x50005
    s_lshl_b32 s2, s2, 11
    s_or_b32 s5, s5, s2
    s_add_u32 s5, s5, 0x5400000
    buffer_load_dwordx4 v[84:87], v231, s[8:11], s5 offen offset:0
    buffer_load_dwordx4 v[100:103], v232, s[8:11], s5 offen offset:16
    buffer_load_dwordx4 v[88:91], v231, s[8:11], s5 offen offset:1024
    buffer_load_dwordx4 v[104:107], v232, s[8:11], s5 offen offset:1040
    s_add_u32 s5, s5, 2097152
    buffer_load_dwordx4 v[92:95], v231, s[8:11], s5 offen offset:0
    buffer_load_dwordx4 v[108:111], v232, s[8:11], s5 offen offset:16
    buffer_load_dwordx4 v[96:99], v231, s[8:11], s5 offen offset:1024
    buffer_load_dwordx4 v[112:115], v232, s[8:11], s5 offen offset:1040
    s_add_u32 s5, s5, 2097152
    s_lshl_b32 s5, s7, 13
    v_lshl_add_u32 v235, v1, 4, s5
    ds_read_b128 v[196:199], v235 offset:0
    ds_read_b128 v[200:203], v235 offset:1024
    ds_read_b128 v[204:207], v235 offset:2048
    ds_read_b128 v[208:211], v235 offset:3072
    ds_read_b128 v[212:215], v235 offset:4096
    ds_read_b128 v[216:219], v235 offset:5120
    ds_read_b128 v[220:223], v235 offset:6144
    ds_read_b128 v[224:227], v235 offset:7168
    v_and_b32 v236, 31, v1
    v_cvt_f32_u32 v228, v236
    v_mov_b32 v229, v234
    s_waitcnt vmcnt(0) lgkmcnt(0)
    v_xor_b32 v116, 0x80008000, v84
    v_xor_b32 v117, 0x80008000, v85
    v_xor_b32 v118, 0x80008000, v86
    v_xor_b32 v119, 0x80008000, v87
    v_xor_b32 v120, 0x80008000, v88
    v_xor_b32 v121, 0x80008000, v89
    v_xor_b32 v122, 0x80008000, v90
    v_xor_b32 v123, 0x80008000, v91
    v_xor_b32 v124, 0x80008000, v92
    v_xor_b32 v125, 0x80008000, v93
    v_xor_b32 v126, 0x80008000, v94
    v_xor_b32 v127, 0x80008000, v95
    v_xor_b32 v128, 0x80008000, v96
    v_xor_b32 v129, 0x80008000, v97
    v_xor_b32 v130, 0x80008000, v98
    v_xor_b32 v131, 0x80008000, v99
    v_mfma_f32_32x32x16_bf16 v[132:147], v[84:87], v[68:71], 0
    v_mfma_f32_32x32x16_bf16 v[164:179], v[100:103], v[68:71], 0
    v_mfma_f32_32x32x16_bf16 v[132:147], v[100:103], v[76:79], v[132:147]
    v_mfma_f32_32x32x16_bf16 v[164:179], v[116:119], v[76:79], v[164:179]
    v_mfma_f32_32x32x16_bf16 v[132:147], v[88:91], v[72:75], v[132:147]
    v_mfma_f32_32x32x16_bf16 v[164:179], v[104:107], v[72:75], v[164:179]
    v_mfma_f32_32x32x16_bf16 v[132:147], v[104:107], v[80:83], v[132:147]
    v_mfma_f32_32x32x16_bf16 v[164:179], v[120:123], v[80:83], v[164:179]
    v_mfma_f32_32x32x16_bf16 v[148:163], v[92:95], v[68:71], 0
    v_mfma_f32_32x32x16_bf16 v[180:195], v[108:111], v[68:71], 0
    v_mfma_f32_32x32x16_bf16 v[148:163], v[108:111], v[76:79], v[148:163]
    v_mfma_f32_32x32x16_bf16 v[180:195], v[124:127], v[76:79], v[180:195]
    v_mfma_f32_32x32x16_bf16 v[148:163], v[96:99], v[72:75], v[148:163]
    v_mfma_f32_32x32x16_bf16 v[180:195], v[112:115], v[72:75], v[180:195]
    v_mfma_f32_32x32x16_bf16 v[148:163], v[112:115], v[80:83], v[148:163]
    v_mfma_f32_32x32x16_bf16 v[180:195], v[128:131], v[80:83], v[180:195]
    v_fmamk_f32 v243, v228, 0x0, v229
    v_cos_f32 v239, v243
    v_sin_f32 v240, v243
    v_mul_f32 v239, s4, v239
    v_mul_f32 v240, s4, v240
    v_mul_f32 v235, v132, v239
    v_mul_f32 v237, v164, v239
    v_fma_f32 v235, v164, v240, v235
    v_fma_f32 v237, -v132, v240, v237
    v_fmamk_f32 v243, v228, 0x3a000000, v229
    v_cos_f32 v241, v243
    v_sin_f32 v242, v243
    v_mul_f32 v241, s4, v241
    v_mul_f32 v242, s4, v242
    v_mul_f32 v236, v133, v241
    v_mul_f32 v238, v165, v241
    v_fma_f32 v236, v165, v242, v236
    v_fma_f32 v238, -v133, v242, v238
    v_cvt_pk_bf16_f32 v84, v235, v236
    v_cvt_pk_bf16_f32 v100, v237, v238
    v_cvt_pk_bf16_f32 v116, -v235, -v236
    v_fmamk_f32 v243, v228, 0x3a800000, v229
    v_cos_f32 v239, v243
    v_sin_f32 v240, v243
    v_mul_f32 v239, s4, v239
    v_mul_f32 v240, s4, v240
    v_mul_f32 v235, v134, v239
    v_mul_f32 v237, v166, v239
    v_fma_f32 v235, v166, v240, v235
    v_fma_f32 v237, -v134, v240, v237
    v_fmamk_f32 v243, v228, 0x3ac00000, v229
    v_cos_f32 v241, v243
    v_sin_f32 v242, v243
    v_mul_f32 v241, s4, v241
    v_mul_f32 v242, s4, v242
    v_mul_f32 v236, v135, v241
    v_mul_f32 v238, v167, v241
    v_fma_f32 v236, v167, v242, v236
    v_fma_f32 v238, -v135, v242, v238
    v_cvt_pk_bf16_f32 v85, v235, v236
    v_cvt_pk_bf16_f32 v101, v237, v238
    v_cvt_pk_bf16_f32 v117, -v235, -v236
    v_fmamk_f32 v243, v228, 0x3b800000, v229
    v_cos_f32 v239, v243
    v_sin_f32 v240, v243
    v_mul_f32 v239, s4, v239
    v_mul_f32 v240, s4, v240
    v_mul_f32 v235, v136, v239
    v_mul_f32 v237, v168, v239
    v_fma_f32 v235, v168, v240, v235
    v_fma_f32 v237, -v136, v240, v237
    v_fmamk_f32 v243, v228, 0x3b900000, v229
    v_cos_f32 v241, v243
    v_sin_f32 v242, v243
    v_mul_f32 v241, s4, v241
    v_mul_f32 v242, s4, v242
    v_mul_f32 v236, v137, v241
    v_mul_f32 v238, v169, v241
    v_fma_f32 v236, v169, v242, v236
    v_fma_f32 v238, -v137, v242, v238
    v_cvt_pk_bf16_f32 v86, v235, v236
    v_cvt_pk_bf16_f32 v102, v237, v238
    v_cvt_pk_bf16_f32 v118, -v235, -v236
    v_fmamk_f32 v243, v228, 0x3ba00000, v229
    v_cos_f32 v239, v243
    v_sin_f32 v240, v243
    v_mul_f32 v239, s4, v239
    v_mul_f32 v240, s4, v240
    v_mul_f32 v235, v138, v239
    v_mul_f32 v237, v170, v239
    v_fma_f32 v235, v170, v240, v235
    v_fma_f32 v237, -v138, v240, v237
    v_fmamk_f32 v243, v228, 0x3bb00000, v229
    v_cos_f32 v241, v243
    v_sin_f32 v242, v243
    v_mul_f32 v241, s4, v241
    v_mul_f32 v242, s4, v242
    v_mul_f32 v236, v139, v241
    v_mul_f32 v238, v171, v241
    v_fma_f32 v236, v171, v242, v236
    v_fma_f32 v238, -v139, v242, v238
    v_cvt_pk_bf16_f32 v87, v235, v236
    v_cvt_pk_bf16_f32 v103, v237, v238
    v_cvt_pk_bf16_f32 v119, -v235, -v236
    v_fmamk_f32 v243, v228, 0x3c000000, v229
    v_cos_f32 v239, v243
    v_sin_f32 v240, v243
    v_mul_f32 v239, s4, v239
    v_mul_f32 v240, s4, v240
    v_mul_f32 v235, v140, v239
    v_mul_f32 v237, v172, v239
    v_fma_f32 v235, v172, v240, v235
    v_fma_f32 v237, -v140, v240, v237
    v_fmamk_f32 v243, v228, 0x3c080000, v229
    v_cos_f32 v241, v243
    v_sin_f32 v242, v243
    v_mul_f32 v241, s4, v241
    v_mul_f32 v242, s4, v242
    v_mul_f32 v236, v141, v241
    v_mul_f32 v238, v173, v241
    v_fma_f32 v236, v173, v242, v236
    v_fma_f32 v238, -v141, v242, v238
    v_cvt_pk_bf16_f32 v88, v235, v236
    v_cvt_pk_bf16_f32 v104, v237, v238
    v_cvt_pk_bf16_f32 v120, -v235, -v236
    v_fmamk_f32 v243, v228, 0x3c100000, v229
    v_cos_f32 v239, v243
    v_sin_f32 v240, v243
    v_mul_f32 v239, s4, v239
    v_mul_f32 v240, s4, v240
    v_mul_f32 v235, v142, v239
    v_mul_f32 v237, v174, v239
    v_fma_f32 v235, v174, v240, v235
    v_fma_f32 v237, -v142, v240, v237
    v_fmamk_f32 v243, v228, 0x3c180000, v229
    v_cos_f32 v241, v243
    v_sin_f32 v242, v243
    v_mul_f32 v241, s4, v241
    v_mul_f32 v242, s4, v242
    v_mul_f32 v236, v143, v241
    v_mul_f32 v238, v175, v241
    v_fma_f32 v236, v175, v242, v236
    v_fma_f32 v238, -v143, v242, v238
    v_cvt_pk_bf16_f32 v89, v235, v236
    v_cvt_pk_bf16_f32 v105, v237, v238
    v_cvt_pk_bf16_f32 v121, -v235, -v236
    v_fmamk_f32 v243, v228, 0x3c400000, v229
    v_cos_f32 v239, v243
    v_sin_f32 v240, v243
    v_mul_f32 v239, s4, v239
    v_mul_f32 v240, s4, v240
    v_mul_f32 v235, v144, v239
    v_mul_f32 v237, v176, v239
    v_fma_f32 v235, v176, v240, v235
    v_fma_f32 v237, -v144, v240, v237
    v_fmamk_f32 v243, v228, 0x3c480000, v229
    v_cos_f32 v241, v243
    v_sin_f32 v242, v243
    v_mul_f32 v241, s4, v241
    v_mul_f32 v242, s4, v242
    v_mul_f32 v236, v145, v241
    v_mul_f32 v238, v177, v241
    v_fma_f32 v236, v177, v242, v236
    v_fma_f32 v238, -v145, v242, v238
    v_cvt_pk_bf16_f32 v90, v235, v236
    v_cvt_pk_bf16_f32 v106, v237, v238
    v_cvt_pk_bf16_f32 v122, -v235, -v236
    v_fmamk_f32 v243, v228, 0x3c500000, v229
    v_cos_f32 v239, v243
    v_sin_f32 v240, v243
    v_mul_f32 v239, s4, v239
    v_mul_f32 v240, s4, v240
    v_mul_f32 v235, v146, v239
    v_mul_f32 v237, v178, v239
    v_fma_f32 v235, v178, v240, v235
    v_fma_f32 v237, -v146, v240, v237
    v_fmamk_f32 v243, v228, 0x3c580000, v229
    v_cos_f32 v241, v243
    v_sin_f32 v242, v243
    v_mul_f32 v241, s4, v241
    v_mul_f32 v242, s4, v242
    v_mul_f32 v236, v147, v241
    v_mul_f32 v238, v179, v241
    v_fma_f32 v236, v179, v242, v236
    v_fma_f32 v238, -v147, v242, v238
    v_cvt_pk_bf16_f32 v91, v235, v236
    v_cvt_pk_bf16_f32 v107, v237, v238
    v_cvt_pk_bf16_f32 v123, -v235, -v236
    v_fmamk_f32 v243, v228, 0x3c800000, v229
    v_cos_f32 v239, v243
    v_sin_f32 v240, v243
    v_mul_f32 v239, s4, v239
    v_mul_f32 v240, s4, v240
    v_mul_f32 v235, v148, v239
    v_mul_f32 v237, v180, v239
    v_fma_f32 v235, v180, v240, v235
    v_fma_f32 v237, -v148, v240, v237
    v_fmamk_f32 v243, v228, 0x3c840000, v229
    v_cos_f32 v241, v243
    v_sin_f32 v242, v243
    v_mul_f32 v241, s4, v241
    v_mul_f32 v242, s4, v242
    v_mul_f32 v236, v149, v241
    v_mul_f32 v238, v181, v241
    v_fma_f32 v236, v181, v242, v236
    v_fma_f32 v238, -v149, v242, v238
    v_cvt_pk_bf16_f32 v92, v235, v236
    v_cvt_pk_bf16_f32 v108, v237, v238
    v_cvt_pk_bf16_f32 v124, -v235, -v236
    v_fmamk_f32 v243, v228, 0x3c880000, v229
    v_cos_f32 v239, v243
    v_sin_f32 v240, v243
    v_mul_f32 v239, s4, v239
    v_mul_f32 v240, s4, v240
    v_mul_f32 v235, v150, v239
    v_mul_f32 v237, v182, v239
    v_fma_f32 v235, v182, v240, v235
    v_fma_f32 v237, -v150, v240, v237
    v_fmamk_f32 v243, v228, 0x3c8c0000, v229
    v_cos_f32 v241, v243
    v_sin_f32 v242, v243
    v_mul_f32 v241, s4, v241
    v_mul_f32 v242, s4, v242
    v_mul_f32 v236, v151, v241
    v_mul_f32 v238, v183, v241
    v_fma_f32 v236, v183, v242, v236
    v_fma_f32 v238, -v151, v242, v238
    v_cvt_pk_bf16_f32 v93, v235, v236
    v_cvt_pk_bf16_f32 v109, v237, v238
    v_cvt_pk_bf16_f32 v125, -v235, -v236
    v_fmamk_f32 v243, v228, 0x3ca00000, v229
    v_cos_f32 v239, v243
    v_sin_f32 v240, v243
    v_mul_f32 v239, s4, v239
    v_mul_f32 v240, s4, v240
    v_mul_f32 v235, v152, v239
    v_mul_f32 v237, v184, v239
    v_fma_f32 v235, v184, v240, v235
    v_fma_f32 v237, -v152, v240, v237
    v_fmamk_f32 v243, v228, 0x3ca40000, v229
    v_cos_f32 v241, v243
    v_sin_f32 v242, v243
    v_mul_f32 v241, s4, v241
    v_mul_f32 v242, s4, v242
    v_mul_f32 v236, v153, v241
    v_mul_f32 v238, v185, v241
    v_fma_f32 v236, v185, v242, v236
    v_fma_f32 v238, -v153, v242, v238
    v_cvt_pk_bf16_f32 v94, v235, v236
    v_cvt_pk_bf16_f32 v110, v237, v238
    v_cvt_pk_bf16_f32 v126, -v235, -v236
    v_fmamk_f32 v243, v228, 0x3ca80000, v229
    v_cos_f32 v239, v243
    v_sin_f32 v240, v243
    v_mul_f32 v239, s4, v239
    v_mul_f32 v240, s4, v240
    v_mul_f32 v235, v154, v239
    v_mul_f32 v237, v186, v239
    v_fma_f32 v235, v186, v240, v235
    v_fma_f32 v237, -v154, v240, v237
    v_fmamk_f32 v243, v228, 0x3cac0000, v229
    v_cos_f32 v241, v243
    v_sin_f32 v242, v243
    v_mul_f32 v241, s4, v241
    v_mul_f32 v242, s4, v242
    v_mul_f32 v236, v155, v241
    v_mul_f32 v238, v187, v241
    v_fma_f32 v236, v187, v242, v236
    v_fma_f32 v238, -v155, v242, v238
    v_cvt_pk_bf16_f32 v95, v235, v236
    v_cvt_pk_bf16_f32 v111, v237, v238
    v_cvt_pk_bf16_f32 v127, -v235, -v236
    v_fmamk_f32 v243, v228, 0x3cc00000, v229
    v_cos_f32 v239, v243
    v_sin_f32 v240, v243
    v_mul_f32 v239, s4, v239
    v_mul_f32 v240, s4, v240
    v_mul_f32 v235, v156, v239
    v_mul_f32 v237, v188, v239
    v_fma_f32 v235, v188, v240, v235
    v_fma_f32 v237, -v156, v240, v237
    v_fmamk_f32 v243, v228, 0x3cc40000, v229
    v_cos_f32 v241, v243
    v_sin_f32 v242, v243
    v_mul_f32 v241, s4, v241
    v_mul_f32 v242, s4, v242
    v_mul_f32 v236, v157, v241
    v_mul_f32 v238, v189, v241
    v_fma_f32 v236, v189, v242, v236
    v_fma_f32 v238, -v157, v242, v238
    v_cvt_pk_bf16_f32 v96, v235, v236
    v_cvt_pk_bf16_f32 v112, v237, v238
    v_cvt_pk_bf16_f32 v128, -v235, -v236
    v_fmamk_f32 v243, v228, 0x3cc80000, v229
    v_cos_f32 v239, v243
    v_sin_f32 v240, v243
    v_mul_f32 v239, s4, v239
    v_mul_f32 v240, s4, v240
    v_mul_f32 v235, v158, v239
    v_mul_f32 v237, v190, v239
    v_fma_f32 v235, v190, v240, v235
    v_fma_f32 v237, -v158, v240, v237
    v_fmamk_f32 v243, v228, 0x3ccc0000, v229
    v_cos_f32 v241, v243
    v_sin_f32 v242, v243
    v_mul_f32 v241, s4, v241
    v_mul_f32 v242, s4, v242
    v_mul_f32 v236, v159, v241
    v_mul_f32 v238, v191, v241
    v_fma_f32 v236, v191, v242, v236
    v_fma_f32 v238, -v159, v242, v238
    v_cvt_pk_bf16_f32 v97, v235, v236
    v_cvt_pk_bf16_f32 v113, v237, v238
    v_cvt_pk_bf16_f32 v129, -v235, -v236
    v_fmamk_f32 v243, v228, 0x3ce00000, v229
    v_cos_f32 v239, v243
    v_sin_f32 v240, v243
    v_mul_f32 v239, s4, v239
    v_mul_f32 v240, s4, v240
    v_mul_f32 v235, v160, v239
    v_mul_f32 v237, v192, v239
    v_fma_f32 v235, v192, v240, v235
    v_fma_f32 v237, -v160, v240, v237
    v_fmamk_f32 v243, v228, 0x3ce40000, v229
    v_cos_f32 v241, v243
    v_sin_f32 v242, v243
    v_mul_f32 v241, s4, v241
    v_mul_f32 v242, s4, v242
    v_mul_f32 v236, v161, v241
    v_mul_f32 v238, v193, v241
    v_fma_f32 v236, v193, v242, v236
    v_fma_f32 v238, -v161, v242, v238
    v_cvt_pk_bf16_f32 v98, v235, v236
    v_cvt_pk_bf16_f32 v114, v237, v238
    v_cvt_pk_bf16_f32 v130, -v235, -v236
    v_fmamk_f32 v243, v228, 0x3ce80000, v229
    v_cos_f32 v239, v243
    v_sin_f32 v240, v243
    v_mul_f32 v239, s4, v239
    v_mul_f32 v240, s4, v240
    v_mul_f32 v235, v162, v239
    v_mul_f32 v237, v194, v239
    v_fma_f32 v235, v194, v240, v235
    v_fma_f32 v237, -v162, v240, v237
    v_fmamk_f32 v243, v228, 0x3cec0000, v229
    v_cos_f32 v241, v243
    v_sin_f32 v242, v243
    v_mul_f32 v241, s4, v241
    v_mul_f32 v242, s4, v242
    v_mul_f32 v236, v163, v241
    v_mul_f32 v238, v195, v241
    v_fma_f32 v236, v195, v242, v236
    v_fma_f32 v238, -v163, v242, v238
    v_cvt_pk_bf16_f32 v99, v235, v236
    v_cvt_pk_bf16_f32 v115, v237, v238
    v_cvt_pk_bf16_f32 v131, -v235, -v236
    v_mfma_f32_32x32x16_bf16 v[132:147], v[4:7], v[84:87], 0
    v_mfma_f32_32x32x16_bf16 v[164:179], v[4:7], v[100:103], 0
    v_mfma_f32_32x32x16_bf16 v[132:147], v[36:39], v[100:103], v[132:147]
    v_mfma_f32_32x32x16_bf16 v[164:179], v[36:39], v[116:119], v[164:179]
    v_mfma_f32_32x32x16_bf16 v[132:147], v[8:11], v[88:91], v[132:147]
    v_mfma_f32_32x32x16_bf16 v[164:179], v[8:11], v[104:107], v[164:179]
    v_mfma_f32_32x32x16_bf16 v[132:147], v[40:43], v[104:107], v[132:147]
    v_mfma_f32_32x32x16_bf16 v[164:179], v[40:43], v[120:123], v[164:179]
    v_mfma_f32_32x32x16_bf16 v[132:147], v[12:15], v[92:95], v[132:147]
    v_mfma_f32_32x32x16_bf16 v[164:179], v[12:15], v[108:111], v[164:179]
    v_mfma_f32_32x32x16_bf16 v[132:147], v[44:47], v[108:111], v[132:147]
    v_mfma_f32_32x32x16_bf16 v[164:179], v[44:47], v[124:127], v[164:179]
    v_mfma_f32_32x32x16_bf16 v[132:147], v[16:19], v[96:99], v[132:147]
    v_mfma_f32_32x32x16_bf16 v[164:179], v[16:19], v[112:115], v[164:179]
    v_mfma_f32_32x32x16_bf16 v[132:147], v[48:51], v[112:115], v[132:147]
    v_mfma_f32_32x32x16_bf16 v[164:179], v[48:51], v[128:131], v[164:179]
    v_mfma_f32_32x32x16_bf16 v[148:163], v[20:23], v[84:87], 0
    v_mfma_f32_32x32x16_bf16 v[180:195], v[20:23], v[100:103], 0
    v_mfma_f32_32x32x16_bf16 v[148:163], v[52:55], v[100:103], v[148:163]
    v_mfma_f32_32x32x16_bf16 v[180:195], v[52:55], v[116:119], v[180:195]
    v_mfma_f32_32x32x16_bf16 v[148:163], v[24:27], v[88:91], v[148:163]
    v_mfma_f32_32x32x16_bf16 v[180:195], v[24:27], v[104:107], v[180:195]
    v_mfma_f32_32x32x16_bf16 v[148:163], v[56:59], v[104:107], v[148:163]
    v_mfma_f32_32x32x16_bf16 v[180:195], v[56:59], v[120:123], v[180:195]
    v_mfma_f32_32x32x16_bf16 v[148:163], v[28:31], v[92:95], v[148:163]
    v_mfma_f32_32x32x16_bf16 v[180:195], v[28:31], v[108:111], v[180:195]
    v_mfma_f32_32x32x16_bf16 v[148:163], v[60:63], v[108:111], v[148:163]
    v_mfma_f32_32x32x16_bf16 v[180:195], v[60:63], v[124:127], v[180:195]
    v_mfma_f32_32x32x16_bf16 v[148:163], v[32:35], v[96:99], v[148:163]
    v_mfma_f32_32x32x16_bf16 v[180:195], v[32:35], v[112:115], v[180:195]
    v_mfma_f32_32x32x16_bf16 v[148:163], v[64:67], v[112:115], v[148:163]
    v_mfma_f32_32x32x16_bf16 v[180:195], v[64:67], v[128:131], v[180:195]
    v_lshlrev_b32 v239, 16, v196
    v_and_b32 v240, 0xffff0000, v196
    v_mul_f32 v235, v132, v239
    v_mul_f32 v237, v164, v239
    v_fma_f32 v235, -v164, v240, v235
    v_fma_f32 v237, v132, v240, v237
    v_lshlrev_b32 v241, 16, v197
    v_and_b32 v242, 0xffff0000, v197
    v_mul_f32 v236, v133, v241
    v_mul_f32 v238, v165, v241
    v_fma_f32 v236, -v165, v242, v236
    v_fma_f32 v238, v133, v242, v238
    v_cvt_pk_bf16_f32 v84, v235, v236
    v_cvt_pk_bf16_f32 v100, v237, v238
    v_cvt_pk_bf16_f32 v116, -v237, -v238
    v_lshlrev_b32 v239, 16, v198
    v_and_b32 v240, 0xffff0000, v198
    v_mul_f32 v235, v134, v239
    v_mul_f32 v237, v166, v239
    v_fma_f32 v235, -v166, v240, v235
    v_fma_f32 v237, v134, v240, v237
    v_lshlrev_b32 v241, 16, v199
    v_and_b32 v242, 0xffff0000, v199
    v_mul_f32 v236, v135, v241
    v_mul_f32 v238, v167, v241
    v_fma_f32 v236, -v167, v242, v236
    v_fma_f32 v238, v135, v242, v238
    v_cvt_pk_bf16_f32 v85, v235, v236
    v_cvt_pk_bf16_f32 v101, v237, v238
    v_cvt_pk_bf16_f32 v117, -v237, -v238
    v_lshlrev_b32 v239, 16, v200
    v_and_b32 v240, 0xffff0000, v200
    v_mul_f32 v235, v136, v239
    v_mul_f32 v237, v168, v239
    v_fma_f32 v235, -v168, v240, v235
    v_fma_f32 v237, v136, v240, v237
    v_lshlrev_b32 v241, 16, v201
    v_and_b32 v242, 0xffff0000, v201
    v_mul_f32 v236, v137, v241
    v_mul_f32 v238, v169, v241
    v_fma_f32 v236, -v169, v242, v236
    v_fma_f32 v238, v137, v242, v238
    v_cvt_pk_bf16_f32 v86, v235, v236
    v_cvt_pk_bf16_f32 v102, v237, v238
    v_cvt_pk_bf16_f32 v118, -v237, -v238
    v_lshlrev_b32 v239, 16, v202
    v_and_b32 v240, 0xffff0000, v202
    v_mul_f32 v235, v138, v239
    v_mul_f32 v237, v170, v239
    v_fma_f32 v235, -v170, v240, v235
    v_fma_f32 v237, v138, v240, v237
    v_lshlrev_b32 v241, 16, v203
    v_and_b32 v242, 0xffff0000, v203
    v_mul_f32 v236, v139, v241
    v_mul_f32 v238, v171, v241
    v_fma_f32 v236, -v171, v242, v236
    v_fma_f32 v238, v139, v242, v238
    v_cvt_pk_bf16_f32 v87, v235, v236
    v_cvt_pk_bf16_f32 v103, v237, v238
    v_cvt_pk_bf16_f32 v119, -v237, -v238
    v_lshlrev_b32 v239, 16, v204
    v_and_b32 v240, 0xffff0000, v204
    v_mul_f32 v235, v140, v239
    v_mul_f32 v237, v172, v239
    v_fma_f32 v235, -v172, v240, v235
    v_fma_f32 v237, v140, v240, v237
    v_lshlrev_b32 v241, 16, v205
    v_and_b32 v242, 0xffff0000, v205
    v_mul_f32 v236, v141, v241
    v_mul_f32 v238, v173, v241
    v_fma_f32 v236, -v173, v242, v236
    v_fma_f32 v238, v141, v242, v238
    v_cvt_pk_bf16_f32 v88, v235, v236
    v_cvt_pk_bf16_f32 v104, v237, v238
    v_cvt_pk_bf16_f32 v120, -v237, -v238
    v_lshlrev_b32 v239, 16, v206
    v_and_b32 v240, 0xffff0000, v206
    v_mul_f32 v235, v142, v239
    v_mul_f32 v237, v174, v239
    v_fma_f32 v235, -v174, v240, v235
    v_fma_f32 v237, v142, v240, v237
    v_lshlrev_b32 v241, 16, v207
    v_and_b32 v242, 0xffff0000, v207
    v_mul_f32 v236, v143, v241
    v_mul_f32 v238, v175, v241
    v_fma_f32 v236, -v175, v242, v236
    v_fma_f32 v238, v143, v242, v238
    v_cvt_pk_bf16_f32 v89, v235, v236
    v_cvt_pk_bf16_f32 v105, v237, v238
    v_cvt_pk_bf16_f32 v121, -v237, -v238
    v_lshlrev_b32 v239, 16, v208
    v_and_b32 v240, 0xffff0000, v208
    v_mul_f32 v235, v144, v239
    v_mul_f32 v237, v176, v239
    v_fma_f32 v235, -v176, v240, v235
    v_fma_f32 v237, v144, v240, v237
    v_lshlrev_b32 v241, 16, v209
    v_and_b32 v242, 0xffff0000, v209
    v_mul_f32 v236, v145, v241
    v_mul_f32 v238, v177, v241
    v_fma_f32 v236, -v177, v242, v236
    v_fma_f32 v238, v145, v242, v238
    v_cvt_pk_bf16_f32 v90, v235, v236
    v_cvt_pk_bf16_f32 v106, v237, v238
    v_cvt_pk_bf16_f32 v122, -v237, -v238
    v_lshlrev_b32 v239, 16, v210
    v_and_b32 v240, 0xffff0000, v210
    v_mul_f32 v235, v146, v239
    v_mul_f32 v237, v178, v239
    v_fma_f32 v235, -v178, v240, v235
    v_fma_f32 v237, v146, v240, v237
    v_lshlrev_b32 v241, 16, v211
    v_and_b32 v242, 0xffff0000, v211
    v_mul_f32 v236, v147, v241
    v_mul_f32 v238, v179, v241
    v_fma_f32 v236, -v179, v242, v236
    v_fma_f32 v238, v147, v242, v238
    v_cvt_pk_bf16_f32 v91, v235, v236
    v_cvt_pk_bf16_f32 v107, v237, v238
    v_cvt_pk_bf16_f32 v123, -v237, -v238
    v_lshlrev_b32 v239, 16, v212
    v_and_b32 v240, 0xffff0000, v212
    v_mul_f32 v235, v148, v239
    v_mul_f32 v237, v180, v239
    v_fma_f32 v235, -v180, v240, v235
    v_fma_f32 v237, v148, v240, v237
    v_lshlrev_b32 v241, 16, v213
    v_and_b32 v242, 0xffff0000, v213
    v_mul_f32 v236, v149, v241
    v_mul_f32 v238, v181, v241
    v_fma_f32 v236, -v181, v242, v236
    v_fma_f32 v238, v149, v242, v238
    v_cvt_pk_bf16_f32 v92, v235, v236
    v_cvt_pk_bf16_f32 v108, v237, v238
    v_cvt_pk_bf16_f32 v124, -v237, -v238
    v_lshlrev_b32 v239, 16, v214
    v_and_b32 v240, 0xffff0000, v214
    v_mul_f32 v235, v150, v239
    v_mul_f32 v237, v182, v239
    v_fma_f32 v235, -v182, v240, v235
    v_fma_f32 v237, v150, v240, v237
    v_lshlrev_b32 v241, 16, v215
    v_and_b32 v242, 0xffff0000, v215
    v_mul_f32 v236, v151, v241
    v_mul_f32 v238, v183, v241
    v_fma_f32 v236, -v183, v242, v236
    v_fma_f32 v238, v151, v242, v238
    v_cvt_pk_bf16_f32 v93, v235, v236
    v_cvt_pk_bf16_f32 v109, v237, v238
    v_cvt_pk_bf16_f32 v125, -v237, -v238
    v_lshlrev_b32 v239, 16, v216
    v_and_b32 v240, 0xffff0000, v216
    v_mul_f32 v235, v152, v239
    v_mul_f32 v237, v184, v239
    v_fma_f32 v235, -v184, v240, v235
    v_fma_f32 v237, v152, v240, v237
    v_lshlrev_b32 v241, 16, v217
    v_and_b32 v242, 0xffff0000, v217
    v_mul_f32 v236, v153, v241
    v_mul_f32 v238, v185, v241
    v_fma_f32 v236, -v185, v242, v236
    v_fma_f32 v238, v153, v242, v238
    v_cvt_pk_bf16_f32 v94, v235, v236
    v_cvt_pk_bf16_f32 v110, v237, v238
    v_cvt_pk_bf16_f32 v126, -v237, -v238
    v_lshlrev_b32 v239, 16, v218
    v_and_b32 v240, 0xffff0000, v218
    v_mul_f32 v235, v154, v239
    v_mul_f32 v237, v186, v239
    v_fma_f32 v235, -v186, v240, v235
    v_fma_f32 v237, v154, v240, v237
    v_lshlrev_b32 v241, 16, v219
    v_and_b32 v242, 0xffff0000, v219
    v_mul_f32 v236, v155, v241
    v_mul_f32 v238, v187, v241
    v_fma_f32 v236, -v187, v242, v236
    v_fma_f32 v238, v155, v242, v238
    v_cvt_pk_bf16_f32 v95, v235, v236
    v_cvt_pk_bf16_f32 v111, v237, v238
    v_cvt_pk_bf16_f32 v127, -v237, -v238
    v_lshlrev_b32 v239, 16, v220
    v_and_b32 v240, 0xffff0000, v220
    v_mul_f32 v235, v156, v239
    v_mul_f32 v237, v188, v239
    v_fma_f32 v235, -v188, v240, v235
    v_fma_f32 v237, v156, v240, v237
    v_lshlrev_b32 v241, 16, v221
    v_and_b32 v242, 0xffff0000, v221
    v_mul_f32 v236, v157, v241
    v_mul_f32 v238, v189, v241
    v_fma_f32 v236, -v189, v242, v236
    v_fma_f32 v238, v157, v242, v238
    v_cvt_pk_bf16_f32 v96, v235, v236
    v_cvt_pk_bf16_f32 v112, v237, v238
    v_cvt_pk_bf16_f32 v128, -v237, -v238
    v_lshlrev_b32 v239, 16, v222
    v_and_b32 v240, 0xffff0000, v222
    v_mul_f32 v235, v158, v239
    v_mul_f32 v237, v190, v239
    v_fma_f32 v235, -v190, v240, v235
    v_fma_f32 v237, v158, v240, v237
    v_lshlrev_b32 v241, 16, v223
    v_and_b32 v242, 0xffff0000, v223
    v_mul_f32 v236, v159, v241
    v_mul_f32 v238, v191, v241
    v_fma_f32 v236, -v191, v242, v236
    v_fma_f32 v238, v159, v242, v238
    v_cvt_pk_bf16_f32 v97, v235, v236
    v_cvt_pk_bf16_f32 v113, v237, v238
    v_cvt_pk_bf16_f32 v129, -v237, -v238
    v_lshlrev_b32 v239, 16, v224
    v_and_b32 v240, 0xffff0000, v224
    v_mul_f32 v235, v160, v239
    v_mul_f32 v237, v192, v239
    v_fma_f32 v235, -v192, v240, v235
    v_fma_f32 v237, v160, v240, v237
    v_lshlrev_b32 v241, 16, v225
    v_and_b32 v242, 0xffff0000, v225
    v_mul_f32 v236, v161, v241
    v_mul_f32 v238, v193, v241
    v_fma_f32 v236, -v193, v242, v236
    v_fma_f32 v238, v161, v242, v238
    v_cvt_pk_bf16_f32 v98, v235, v236
    v_cvt_pk_bf16_f32 v114, v237, v238
    v_cvt_pk_bf16_f32 v130, -v237, -v238
    v_lshlrev_b32 v239, 16, v226
    v_and_b32 v240, 0xffff0000, v226
    v_mul_f32 v235, v162, v239
    v_mul_f32 v237, v194, v239
    v_fma_f32 v235, -v194, v240, v235
    v_fma_f32 v237, v162, v240, v237
    v_lshlrev_b32 v241, 16, v227
    v_and_b32 v242, 0xffff0000, v227
    v_mul_f32 v236, v163, v241
    v_mul_f32 v238, v195, v241
    v_fma_f32 v236, -v195, v242, v236
    v_fma_f32 v238, v163, v242, v238
    v_cvt_pk_bf16_f32 v99, v235, v236
    v_cvt_pk_bf16_f32 v115, v237, v238
    v_cvt_pk_bf16_f32 v131, -v237, -v238
    v_mfma_f32_32x32x16_bf16 v[132:147], v[84:87], v[4:7], 0
    v_mfma_f32_32x32x16_bf16 v[164:179], v[100:103], v[4:7], 0
    v_mfma_f32_32x32x16_bf16 v[132:147], v[116:119], v[36:39], v[132:147]
    v_mfma_f32_32x32x16_bf16 v[164:179], v[84:87], v[36:39], v[164:179]
    v_mfma_f32_32x32x16_bf16 v[132:147], v[88:91], v[8:11], v[132:147]
    v_mfma_f32_32x32x16_bf16 v[164:179], v[104:107], v[8:11], v[164:179]
    v_mfma_f32_32x32x16_bf16 v[132:147], v[120:123], v[40:43], v[132:147]
    v_mfma_f32_32x32x16_bf16 v[164:179], v[88:91], v[40:43], v[164:179]
    v_mfma_f32_32x32x16_bf16 v[132:147], v[92:95], v[12:15], v[132:147]
    v_mfma_f32_32x32x16_bf16 v[164:179], v[108:111], v[12:15], v[164:179]
    v_mfma_f32_32x32x16_bf16 v[132:147], v[124:127], v[44:47], v[132:147]
    v_mfma_f32_32x32x16_bf16 v[164:179], v[92:95], v[44:47], v[164:179]
    v_mfma_f32_32x32x16_bf16 v[132:147], v[96:99], v[16:19], v[132:147]
    v_mfma_f32_32x32x16_bf16 v[164:179], v[112:115], v[16:19], v[164:179]
    v_mfma_f32_32x32x16_bf16 v[132:147], v[128:131], v[48:51], v[132:147]
    v_mfma_f32_32x32x16_bf16 v[164:179], v[96:99], v[48:51], v[164:179]
    v_mfma_f32_32x32x16_bf16 v[148:163], v[84:87], v[20:23], 0
    v_mfma_f32_32x32x16_bf16 v[180:195], v[100:103], v[20:23], 0
    v_mfma_f32_32x32x16_bf16 v[148:163], v[116:119], v[52:55], v[148:163]
    v_mfma_f32_32x32x16_bf16 v[180:195], v[84:87], v[52:55], v[180:195]
    v_mfma_f32_32x32x16_bf16 v[148:163], v[88:91], v[24:27], v[148:163]
    v_mfma_f32_32x32x16_bf16 v[180:195], v[104:107], v[24:27], v[180:195]
    v_mfma_f32_32x32x16_bf16 v[148:163], v[120:123], v[56:59], v[148:163]
    v_mfma_f32_32x32x16_bf16 v[180:195], v[88:91], v[56:59], v[180:195]
    v_mfma_f32_32x32x16_bf16 v[148:163], v[92:95], v[28:31], v[148:163]
    v_mfma_f32_32x32x16_bf16 v[180:195], v[108:111], v[28:31], v[180:195]
    v_mfma_f32_32x32x16_bf16 v[148:163], v[124:127], v[60:63], v[148:163]
    v_mfma_f32_32x32x16_bf16 v[180:195], v[92:95], v[60:63], v[180:195]
    v_mfma_f32_32x32x16_bf16 v[148:163], v[96:99], v[32:35], v[148:163]
    v_mfma_f32_32x32x16_bf16 v[180:195], v[112:115], v[32:35], v[180:195]
    v_mfma_f32_32x32x16_bf16 v[148:163], v[128:131], v[64:67], v[148:163]
    v_mfma_f32_32x32x16_bf16 v[180:195], v[96:99], v[64:67], v[180:195]
    v_fmamk_f32 v243, v228, 0x0, v229
    v_cos_f32 v239, v243
    v_sin_f32 v240, v243
    v_mul_f32 v235, v132, v239
    v_mul_f32 v237, v164, v239
    v_fma_f32 v235, -v164, v240, v235
    v_fma_f32 v237, v132, v240, v237
    v_fmamk_f32 v243, v228, 0x3a000000, v229
    v_cos_f32 v241, v243
    v_sin_f32 v242, v243
    v_mul_f32 v236, v133, v241
    v_mul_f32 v238, v165, v241
    v_fma_f32 v236, -v165, v242, v236
    v_fma_f32 v238, v133, v242, v238
    v_cvt_pk_bf16_f32 v84, v235, v236
    v_cvt_pk_bf16_f32 v100, v237, v238
    v_cvt_pk_bf16_f32 v116, -v237, -v238
    v_fmamk_f32 v243, v228, 0x3a800000, v229
    v_cos_f32 v239, v243
    v_sin_f32 v240, v243
    v_mul_f32 v235, v134, v239
    v_mul_f32 v237, v166, v239
    v_fma_f32 v235, -v166, v240, v235
    v_fma_f32 v237, v134, v240, v237
    v_fmamk_f32 v243, v228, 0x3ac00000, v229
    v_cos_f32 v241, v243
    v_sin_f32 v242, v243
    v_mul_f32 v236, v135, v241
    v_mul_f32 v238, v167, v241
    v_fma_f32 v236, -v167, v242, v236
    v_fma_f32 v238, v135, v242, v238
    v_cvt_pk_bf16_f32 v85, v235, v236
    v_cvt_pk_bf16_f32 v101, v237, v238
    v_cvt_pk_bf16_f32 v117, -v237, -v238
    v_fmamk_f32 v243, v228, 0x3b800000, v229
    v_cos_f32 v239, v243
    v_sin_f32 v240, v243
    v_mul_f32 v235, v136, v239
    v_mul_f32 v237, v168, v239
    v_fma_f32 v235, -v168, v240, v235
    v_fma_f32 v237, v136, v240, v237
    v_fmamk_f32 v243, v228, 0x3b900000, v229
    v_cos_f32 v241, v243
    v_sin_f32 v242, v243
    v_mul_f32 v236, v137, v241
    v_mul_f32 v238, v169, v241
    v_fma_f32 v236, -v169, v242, v236
    v_fma_f32 v238, v137, v242, v238
    v_cvt_pk_bf16_f32 v86, v235, v236
    v_cvt_pk_bf16_f32 v102, v237, v238
    v_cvt_pk_bf16_f32 v118, -v237, -v238
    v_fmamk_f32 v243, v228, 0x3ba00000, v229
    v_cos_f32 v239, v243
    v_sin_f32 v240, v243
    v_mul_f32 v235, v138, v239
    v_mul_f32 v237, v170, v239
    v_fma_f32 v235, -v170, v240, v235
    v_fma_f32 v237, v138, v240, v237
    v_fmamk_f32 v243, v228, 0x3bb00000, v229
    v_cos_f32 v241, v243
    v_sin_f32 v242, v243
    v_mul_f32 v236, v139, v241
    v_mul_f32 v238, v171, v241
    v_fma_f32 v236, -v171, v242, v236
    v_fma_f32 v238, v139, v242, v238
    v_cvt_pk_bf16_f32 v87, v235, v236
    v_cvt_pk_bf16_f32 v103, v237, v238
    v_cvt_pk_bf16_f32 v119, -v237, -v238
    v_fmamk_f32 v243, v228, 0x3c000000, v229
    v_cos_f32 v239, v243
    v_sin_f32 v240, v243
    v_mul_f32 v235, v140, v239
    v_mul_f32 v237, v172, v239
    v_fma_f32 v235, -v172, v240, v235
    v_fma_f32 v237, v140, v240, v237
    v_fmamk_f32 v243, v228, 0x3c080000, v229
    v_cos_f32 v241, v243
    v_sin_f32 v242, v243
    v_mul_f32 v236, v141, v241
    v_mul_f32 v238, v173, v241
    v_fma_f32 v236, -v173, v242, v236
    v_fma_f32 v238, v141, v242, v238
    v_cvt_pk_bf16_f32 v88, v235, v236
    v_cvt_pk_bf16_f32 v104, v237, v238
    v_cvt_pk_bf16_f32 v120, -v237, -v238
    v_fmamk_f32 v243, v228, 0x3c100000, v229
    v_cos_f32 v239, v243
    v_sin_f32 v240, v243
    v_mul_f32 v235, v142, v239
    v_mul_f32 v237, v174, v239
    v_fma_f32 v235, -v174, v240, v235
    v_fma_f32 v237, v142, v240, v237
    v_fmamk_f32 v243, v228, 0x3c180000, v229
    v_cos_f32 v241, v243
    v_sin_f32 v242, v243
    v_mul_f32 v236, v143, v241
    v_mul_f32 v238, v175, v241
    v_fma_f32 v236, -v175, v242, v236
    v_fma_f32 v238, v143, v242, v238
    v_cvt_pk_bf16_f32 v89, v235, v236
    v_cvt_pk_bf16_f32 v105, v237, v238
    v_cvt_pk_bf16_f32 v121, -v237, -v238
    v_fmamk_f32 v243, v228, 0x3c400000, v229
    v_cos_f32 v239, v243
    v_sin_f32 v240, v243
    v_mul_f32 v235, v144, v239
    v_mul_f32 v237, v176, v239
    v_fma_f32 v235, -v176, v240, v235
    v_fma_f32 v237, v144, v240, v237
    v_fmamk_f32 v243, v228, 0x3c480000, v229
    v_cos_f32 v241, v243
    v_sin_f32 v242, v243
    v_mul_f32 v236, v145, v241
    v_mul_f32 v238, v177, v241
    v_fma_f32 v236, -v177, v242, v236
    v_fma_f32 v238, v145, v242, v238
    v_cvt_pk_bf16_f32 v90, v235, v236
    v_cvt_pk_bf16_f32 v106, v237, v238
    v_cvt_pk_bf16_f32 v122, -v237, -v238
    v_fmamk_f32 v243, v228, 0x3c500000, v229
    v_cos_f32 v239, v243
    v_sin_f32 v240, v243
    v_mul_f32 v235, v146, v239
    v_mul_f32 v237, v178, v239
    v_fma_f32 v235, -v178, v240, v235
    v_fma_f32 v237, v146, v240, v237
    v_fmamk_f32 v243, v228, 0x3c580000, v229
    v_cos_f32 v241, v243
    v_sin_f32 v242, v243
    v_mul_f32 v236, v147, v241
    v_mul_f32 v238, v179, v241
    v_fma_f32 v236, -v179, v242, v236
    v_fma_f32 v238, v147, v242, v238
    v_cvt_pk_bf16_f32 v91, v235, v236
    v_cvt_pk_bf16_f32 v107, v237, v238
    v_cvt_pk_bf16_f32 v123, -v237, -v238
    v_add_f32 v228, 0x42000000, v228
    v_mov_b32 v229, v230
    v_fmamk_f32 v243, v228, 0x0, v229
    v_cos_f32 v239, v243
    v_sin_f32 v240, v243
    v_mul_f32 v235, v148, v239
    v_mul_f32 v237, v180, v239
    v_fma_f32 v235, -v180, v240, v235
    v_fma_f32 v237, v148, v240, v237
    v_fmamk_f32 v243, v228, 0x3a000000, v229
    v_cos_f32 v241, v243
    v_sin_f32 v242, v243
    v_mul_f32 v236, v149, v241
    v_mul_f32 v238, v181, v241
    v_fma_f32 v236, -v181, v242, v236
    v_fma_f32 v238, v149, v242, v238
    v_cvt_pk_bf16_f32 v92, v235, v236
    v_cvt_pk_bf16_f32 v108, v237, v238
    v_cvt_pk_bf16_f32 v124, -v237, -v238
    v_fmamk_f32 v243, v228, 0x3a800000, v229
    v_cos_f32 v239, v243
    v_sin_f32 v240, v243
    v_mul_f32 v235, v150, v239
    v_mul_f32 v237, v182, v239
    v_fma_f32 v235, -v182, v240, v235
    v_fma_f32 v237, v150, v240, v237
    v_fmamk_f32 v243, v228, 0x3ac00000, v229
    v_cos_f32 v241, v243
    v_sin_f32 v242, v243
    v_mul_f32 v236, v151, v241
    v_mul_f32 v238, v183, v241
    v_fma_f32 v236, -v183, v242, v236
    v_fma_f32 v238, v151, v242, v238
    v_cvt_pk_bf16_f32 v93, v235, v236
    v_cvt_pk_bf16_f32 v109, v237, v238
    v_cvt_pk_bf16_f32 v125, -v237, -v238
    v_fmamk_f32 v243, v228, 0x3b800000, v229
    v_cos_f32 v239, v243
    v_sin_f32 v240, v243
    v_mul_f32 v235, v152, v239
    v_mul_f32 v237, v184, v239
    v_fma_f32 v235, -v184, v240, v235
    v_fma_f32 v237, v152, v240, v237
    v_fmamk_f32 v243, v228, 0x3b900000, v229
    v_cos_f32 v241, v243
    v_sin_f32 v242, v243
    v_mul_f32 v236, v153, v241
    v_mul_f32 v238, v185, v241
    v_fma_f32 v236, -v185, v242, v236
    v_fma_f32 v238, v153, v242, v238
    v_cvt_pk_bf16_f32 v94, v235, v236
    v_cvt_pk_bf16_f32 v110, v237, v238
    v_cvt_pk_bf16_f32 v126, -v237, -v238
    v_fmamk_f32 v243, v228, 0x3ba00000, v229
    v_cos_f32 v239, v243
    v_sin_f32 v240, v243
    v_mul_f32 v235, v154, v239
    v_mul_f32 v237, v186, v239
    v_fma_f32 v235, -v186, v240, v235
    v_fma_f32 v237, v154, v240, v237
    v_fmamk_f32 v243, v228, 0x3bb00000, v229
    v_cos_f32 v241, v243
    v_sin_f32 v242, v243
    v_mul_f32 v236, v155, v241
    v_mul_f32 v238, v187, v241
    v_fma_f32 v236, -v187, v242, v236
    v_fma_f32 v238, v155, v242, v238
    v_cvt_pk_bf16_f32 v95, v235, v236
    v_cvt_pk_bf16_f32 v111, v237, v238
    v_cvt_pk_bf16_f32 v127, -v237, -v238
    v_fmamk_f32 v243, v228, 0x3c000000, v229
    v_cos_f32 v239, v243
    v_sin_f32 v240, v243
    v_mul_f32 v235, v156, v239
    v_mul_f32 v237, v188, v239
    v_fma_f32 v235, -v188, v240, v235
    v_fma_f32 v237, v156, v240, v237
    v_fmamk_f32 v243, v228, 0x3c080000, v229
    v_cos_f32 v241, v243
    v_sin_f32 v242, v243
    v_mul_f32 v236, v157, v241
    v_mul_f32 v238, v189, v241
    v_fma_f32 v236, -v189, v242, v236
    v_fma_f32 v238, v157, v242, v238
    v_cvt_pk_bf16_f32 v96, v235, v236
    v_cvt_pk_bf16_f32 v112, v237, v238
    v_cvt_pk_bf16_f32 v128, -v237, -v238
    v_fmamk_f32 v243, v228, 0x3c100000, v229
    v_cos_f32 v239, v243
    v_sin_f32 v240, v243
    v_mul_f32 v235, v158, v239
    v_mul_f32 v237, v190, v239
    v_fma_f32 v235, -v190, v240, v235
    v_fma_f32 v237, v158, v240, v237
    v_fmamk_f32 v243, v228, 0x3c180000, v229
    v_cos_f32 v241, v243
    v_sin_f32 v242, v243
    v_mul_f32 v236, v159, v241
    v_mul_f32 v238, v191, v241
    v_fma_f32 v236, -v191, v242, v236
    v_fma_f32 v238, v159, v242, v238
    v_cvt_pk_bf16_f32 v97, v235, v236
    v_cvt_pk_bf16_f32 v113, v237, v238
    v_cvt_pk_bf16_f32 v129, -v237, -v238
    v_fmamk_f32 v243, v228, 0x3c400000, v229
    v_cos_f32 v239, v243
    v_sin_f32 v240, v243
    v_mul_f32 v235, v160, v239
    v_mul_f32 v237, v192, v239
    v_fma_f32 v235, -v192, v240, v235
    v_fma_f32 v237, v160, v240, v237
    v_fmamk_f32 v243, v228, 0x3c480000, v229
    v_cos_f32 v241, v243
    v_sin_f32 v242, v243
    v_mul_f32 v236, v161, v241
    v_mul_f32 v238, v193, v241
    v_fma_f32 v236, -v193, v242, v236
    v_fma_f32 v238, v161, v242, v238
    v_cvt_pk_bf16_f32 v98, v235, v236
    v_cvt_pk_bf16_f32 v114, v237, v238
    v_cvt_pk_bf16_f32 v130, -v237, -v238
    v_fmamk_f32 v243, v228, 0x3c500000, v229
    v_cos_f32 v239, v243
    v_sin_f32 v240, v243
    v_mul_f32 v235, v162, v239
    v_mul_f32 v237, v194, v239
    v_fma_f32 v235, -v194, v240, v235
    v_fma_f32 v237, v162, v240, v237
    v_fmamk_f32 v243, v228, 0x3c580000, v229
    v_cos_f32 v241, v243
    v_sin_f32 v242, v243
    v_mul_f32 v236, v163, v241
    v_mul_f32 v238, v195, v241
    v_fma_f32 v236, -v195, v242, v236
    v_fma_f32 v238, v163, v242, v238
    v_cvt_pk_bf16_f32 v99, v235, v236
    v_cvt_pk_bf16_f32 v115, v237, v238
    v_cvt_pk_bf16_f32 v131, -v237, -v238
    v_mfma_f32_32x32x16_bf16 v[132:147], v[68:71], v[84:87], 0
    v_mfma_f32_32x32x16_bf16 v[164:179], v[68:71], v[100:103], 0
    v_mfma_f32_32x32x16_bf16 v[132:147], v[76:79], v[116:119], v[132:147]
    v_mfma_f32_32x32x16_bf16 v[164:179], v[76:79], v[84:87], v[164:179]
    v_mfma_f32_32x32x16_bf16 v[132:147], v[72:75], v[88:91], v[132:147]
    v_mfma_f32_32x32x16_bf16 v[164:179], v[72:75], v[104:107], v[164:179]
    v_mfma_f32_32x32x16_bf16 v[132:147], v[80:83], v[120:123], v[132:147]
    v_mfma_f32_32x32x16_bf16 v[164:179], v[80:83], v[88:91], v[164:179]
    v_mfma_f32_32x32x16_bf16 v[148:163], v[68:71], v[92:95], 0
    v_mfma_f32_32x32x16_bf16 v[180:195], v[68:71], v[108:111], 0
    v_mfma_f32_32x32x16_bf16 v[148:163], v[76:79], v[124:127], v[148:163]
    v_mfma_f32_32x32x16_bf16 v[180:195], v[76:79], v[92:95], v[180:195]
    v_mfma_f32_32x32x16_bf16 v[148:163], v[72:75], v[96:99], v[148:163]
    v_mfma_f32_32x32x16_bf16 v[180:195], v[72:75], v[112:115], v[180:195]
    v_mfma_f32_32x32x16_bf16 v[148:163], v[80:83], v[128:131], v[148:163]
    v_mfma_f32_32x32x16_bf16 v[180:195], v[80:83], v[96:99], v[180:195]
    v_lshlrev_b32 v231, 4, v1
    v_add_u32 v232, s6, v231
    s_lshl_b32 s5, s3, 12
    s_add_u32 s5, s5, 0x5800000
    s_add_u32 s2, s5, 4096
    v_cvt_pk_bf16_f32 v84, v132, v133
    v_cvt_pk_bf16_f32 v85, v134, v135
    v_cvt_pk_bf16_f32 v86, v136, v137
    v_cvt_pk_bf16_f32 v87, v138, v139
    buffer_store_dwordx4 v[84:87], v231, s[8:11], s5 offen offset:0 sc1
    v_cvt_pk_bf16_f32 v88, v140, v141
    v_cvt_pk_bf16_f32 v89, v142, v143
    v_cvt_pk_bf16_f32 v90, v144, v145
    v_cvt_pk_bf16_f32 v91, v146, v147
    buffer_store_dwordx4 v[88:91], v231, s[8:11], s5 offen offset:1024 sc1
    v_cvt_pk_bf16_f32 v92, v148, v149
    v_cvt_pk_bf16_f32 v93, v150, v151
    v_cvt_pk_bf16_f32 v94, v152, v153
    v_cvt_pk_bf16_f32 v95, v154, v155
    buffer_store_dwordx4 v[92:95], v231, s[8:11], s5 offen offset:2048 sc1
    v_cvt_pk_bf16_f32 v96, v156, v157
    v_cvt_pk_bf16_f32 v97, v158, v159
    v_cvt_pk_bf16_f32 v98, v160, v161
    v_cvt_pk_bf16_f32 v99, v162, v163
    buffer_store_dwordx4 v[96:99], v231, s[8:11], s5 offen offset:3072 sc1
    v_cvt_pk_bf16_f32 v100, v164, v165
    v_cvt_pk_bf16_f32 v101, v166, v167
    v_cvt_pk_bf16_f32 v102, v168, v169
    v_cvt_pk_bf16_f32 v103, v170, v171
    buffer_store_dwordx4 v[100:103], v232, s[8:11], s2 offen offset:0 sc1
    v_cvt_pk_bf16_f32 v104, v172, v173
    v_cvt_pk_bf16_f32 v105, v174, v175
    v_cvt_pk_bf16_f32 v106, v176, v177
    v_cvt_pk_bf16_f32 v107, v178, v179
    buffer_store_dwordx4 v[104:107], v232, s[8:11], s2 offen offset:1024 sc1
    v_cvt_pk_bf16_f32 v108, v180, v181
    v_cvt_pk_bf16_f32 v109, v182, v183
    v_cvt_pk_bf16_f32 v110, v184, v185
    v_cvt_pk_bf16_f32 v111, v186, v187
    buffer_store_dwordx4 v[108:111], v232, s[8:11], s2 offen offset:2048 sc1
    v_cvt_pk_bf16_f32 v112, v188, v189
    v_cvt_pk_bf16_f32 v113, v190, v191
    v_cvt_pk_bf16_f32 v114, v192, v193
    v_cvt_pk_bf16_f32 v115, v194, v195
    buffer_store_dwordx4 v[112:115], v232, s[8:11], s2 offen offset:3072 sc1
    s_add_u32 s7, s7, 8
    s_cmp_lt_u32 s7, 16
    s_cbranch_scc1 colloop_70
    s_cmp_eq_u32 s3, 1008
    s_cbranch_scc1 colloop_70
    s_mov_b32 s83, 44
    s_branch next_48
p3_62:
    v_bfe_u32 v76, v1, 2, 2
    v_sub_u32 v76, 0, v76
    v_lshrrev_b32 v75, 4, v1
    v_xor_b32 v76, v76, v75
    v_and_b32 v76, 3, v76
    v_bfe_u32 v72, v1, 0, 4
    v_lshlrev_b32 v72, 6, v72
    v_lshl_or_b32 v72, v76, 4, v72
    s_lshr_b32 s74, s58, 2
    s_mul_i32 s74, s74, 4096
    v_add_u32 v72, s74, v72
    v_bfe_u32 v73, v1, 0, 2
    v_lshlrev_b32 v73, 3, v73
    v_bfe_u32 v75, v1, 4, 1
    v_lshl_or_b32 v73, v75, 5, v73
    v_bfe_u32 v75, v1, 2, 2
    v_lshl_or_b32 v73, v75, 6, v73
    v_bfe_u32 v75, v1, 2, 2
    v_lshl_or_b32 v73, v75, 8, v73
    v_bfe_u32 v75, v1, 4, 2
    v_lshl_or_b32 v73, v75, 11, v73
    s_and_b32 s74, s58, 3
    s_mul_i32 s74, s74, 64
    s_or_b32 s74, s74, 8192
    v_xor_b32 v73, s74, v73
    s_mov_b64 s[60:61], s[8:9]
    s_mov_b32 s62, 0x10000000
    s_mov_b32 s63, 0x20000
    s_mov_b64 s[64:65], s[8:9]
    s_mov_b32 s66, 0x10000000
    s_mov_b32 s67, 0x20000
    v_lshrrev_b32 v76, 4, v1
    v_sub_u32 v76, 0, v76
    v_xor_b32 v76, v76, v1
    v_and_b32 v76, 3, v76
    s_mul_i32 s74, s58, 16
    v_lshrrev_b32 v77, 2, v1
    v_add3_u32 v77, v77, s74, 0
    v_bfe_u32 v68, v77, 0, 2
    v_lshlrev_b32 v68, 11, v68
    v_bfe_u32 v75, v77, 4, 1
    v_lshl_or_b32 v68, v75, 13, v68
    v_bfe_u32 v75, v77, 2, 2
    v_lshl_or_b32 v68, v75, 14, v68
    v_bfe_u32 v75, v77, 5, 2
    v_lshl_or_b32 v68, v75, 16, v68
    v_lshl_add_u32 v68, v76, 4, v68
    s_and_b32 s74, s58, 2
    v_bfe_u32 v76, v1, 0, 4
    v_bfe_u32 v77, v1, 4, 2
    v_lshlrev_b32 v77, 2, v77
    v_xor_b32 v76, v76, v77
    v_xor_b32 v76, s74, v76
    v_lshlrev_b32 v77, 4, v76
    v_lshrrev_b32 v76, 4, v1
    v_lshl_add_u32 v70, v76, 12, v77
    s_lshl_b32 s74, s58, 14
    v_add_u32 v70, s74, v70
    s_mov_b32 s70, 131072
    s_and_b32 s79, s57, 7
    s_lshr_b32 s80, s76, 3
    s_lshl_b32 s68, s79, 18
    s_add_u32 s68, s68, 0x5200000
    s_lshl_b32 s69, s80, 8
    s_add_u32 s69, s69, 0x5800000
    s_cmp_lg_u32 s58, 0
    s_cbranch_scc1 wall_72
    v_mov_b32 v76, 64
wctr_73:
    buffer_load_dword v75, v76, s[12:15], 0 offen sc1
    s_waitcnt vmcnt(0)
    v_cmp_gt_u32 vcc, 3, v75
    s_cbranch_vccz wctr_ok_74
    s_sub_u32 s77, s77, 1
    s_cbranch_scc0 wctr_73
    s_mov_b32 s77, 0
wctr_ok_74:
wall_72:
    s_cmp_lg_u32 s58, 0
    s_cbranch_scc1 wall_75
    v_mov_b32 v76, 44
wctr_76:
    buffer_load_dword v75, v76, s[12:15], 0 offen sc1
    s_waitcnt vmcnt(0)
    v_cmp_gt_u32 vcc, 32, v75
    s_cbranch_vccz wctr_ok_77
    s_sub_u32 s77, s77, 1
    s_cbranch_scc0 wctr_76
    s_mov_b32 s77, 0
wctr_ok_77:
wall_75:
    s_barrier
    s_mul_i32 s71, s58, 1024
    s_mov_b32 m0, s71
    s_nop 0
    buffer_load_dwordx4 v68, s[60:63], s68 offen lds
    s_add_u32 m0, s71, 8192
    s_nop 0
    buffer_load_dwordx4 v70, s[64:67], s69 offen lds
    s_add_u32 s68, s68, 64
    s_add_u32 s69, s69, s70
    s_add_u32 s71, s71, 16384
    s_and_b32 s71, s71, 0x1ffff
    s_mov_b32 m0, s71
    s_nop 0
    buffer_load_dwordx4 v68, s[60:63], s68 offen lds
    s_add_u32 m0, s71, 8192
    s_nop 0
    buffer_load_dwordx4 v70, s[64:67], s69 offen lds
    s_add_u32 s68, s68, 64
    s_add_u32 s69, s69, s70
    s_add_u32 s71, s71, 16384
    s_and_b32 s71, s71, 0x1ffff
    s_mov_b32 m0, s71
    s_nop 0
    buffer_load_dwordx4 v68, s[60:63], s68 offen lds
    s_add_u32 m0, s71, 8192
    s_nop 0
    buffer_load_dwordx4 v70, s[64:67], s69 offen lds
    s_add_u32 s68, s68, 64
    s_add_u32 s69, s69, s70
    s_add_u32 s71, s71, 16384
    s_and_b32 s71, s71, 0x1ffff
    s_mov_b32 m0, s71
    s_nop 0
    buffer_load_dwordx4 v68, s[60:63], s68 offen lds
    s_add_u32 m0, s71, 8192
    s_nop 0
    buffer_load_dwordx4 v70, s[64:67], s69 offen lds
    s_add_u32 s68, s68, 64
    s_add_u32 s69, s69, s70
    s_add_u32 s71, s71, 16384
    s_and_b32 s71, s71, 0x1ffff
    s_mov_b32 m0, s71
    s_nop 0
    buffer_load_dwordx4 v68, s[60:63], s68 offen lds
    s_add_u32 m0, s71, 8192
    s_nop 0
    buffer_load_dwordx4 v70, s[64:67], s69 offen lds
    s_add_u32 s68, s68, 64
    s_add_u32 s69, s69, s70
    s_add_u32 s71, s71, 16384
    s_and_b32 s71, s71, 0x1ffff
    s_mov_b32 m0, s71
    s_nop 0
    buffer_load_dwordx4 v68, s[60:63], s68 offen lds
    s_add_u32 m0, s71, 8192
    s_nop 0
    buffer_load_dwordx4 v70, s[64:67], s69 offen lds
    s_add_u32 s68, s68, 64
    s_add_u32 s69, s69, s70
    s_add_u32 s71, s71, 16384
    s_and_b32 s71, s71, 0x1ffff
    s_mov_b32 m0, s71
    s_nop 0
    buffer_load_dwordx4 v68, s[60:63], s68 offen lds
    s_add_u32 m0, s71, 8192
    s_nop 0
    buffer_load_dwordx4 v70, s[64:67], s69 offen lds
    s_add_u32 s68, s68, 64
    s_add_u32 s69, s69, s70
    s_add_u32 s71, s71, 16384
    s_and_b32 s71, s71, 0x1ffff
    s_mov_b32 m0, s71
    s_nop 0
    buffer_load_dwordx4 v68, s[60:63], s68 offen lds
    s_add_u32 m0, s71, 8192
    s_nop 0
    buffer_load_dwordx4 v70, s[64:67], s69 offen lds
    s_add_u32 s68, s68, 64
    s_add_u32 s69, s69, s70
    s_add_u32 s71, s71, 16384
    s_and_b32 s71, s71, 0x1ffff
    v_lshlrev_b32 v75, 4, v1
    s_bfe_u32 s84, s57, 0x10000
    s_lshl_b32 s84, s84, 17
    s_bfe_u32 s74, s57, 0x40001
    s_lshl_b32 s74, s74, 19
    s_or_b32 s84, s84, s74
    s_lshl_b32 s74, s58, 14
    s_add_u32 s84, s84, s74
    s_add_u32 s84, s84, 0x6000000
    buffer_load_dwordx4 v[128:131], v75, s[8:11], s84 offen offset:0
    buffer_load_dwordx4 v[132:135], v75, s[8:11], s84 offen offset:1024
    buffer_load_dwordx4 v[136:139], v75, s[8:11], s84 offen offset:2048
    buffer_load_dwordx4 v[140:143], v75, s[8:11], s84 offen offset:3072
    s_add_u32 s84, s84, 4096
    buffer_load_dwordx4 v[144:147], v75, s[8:11], s84 offen offset:0
    buffer_load_dwordx4 v[148:151], v75, s[8:11], s84 offen offset:1024
    buffer_load_dwordx4 v[152:155], v75, s[8:11], s84 offen offset:2048
    buffer_load_dwordx4 v[156:159], v75, s[8:11], s84 offen offset:3072
    s_add_u32 s84, s84, 4096
    buffer_load_dwordx4 v[160:163], v75, s[8:11], s84 offen offset:0
    buffer_load_dwordx4 v[164:167], v75, s[8:11], s84 offen offset:1024
    buffer_load_dwordx4 v[168:171], v75, s[8:11], s84 offen offset:2048
    buffer_load_dwordx4 v[172:175], v75, s[8:11], s84 offen offset:3072
    s_add_u32 s84, s84, 4096
    buffer_load_dwordx4 v[176:179], v75, s[8:11], s84 offen offset:0
    buffer_load_dwordx4 v[180:183], v75, s[8:11], s84 offen offset:1024
    buffer_load_dwordx4 v[184:187], v75, s[8:11], s84 offen offset:2048
    buffer_load_dwordx4 v[188:191], v75, s[8:11], s84 offen offset:3072
    s_add_u32 s84, s84, 249856
    buffer_load_dwordx4 v[192:195], v75, s[8:11], s84 offen offset:0
    buffer_load_dwordx4 v[196:199], v75, s[8:11], s84 offen offset:1024
    buffer_load_dwordx4 v[200:203], v75, s[8:11], s84 offen offset:2048
    buffer_load_dwordx4 v[204:207], v75, s[8:11], s84 offen offset:3072
    s_add_u32 s84, s84, 4096
    buffer_load_dwordx4 v[208:211], v75, s[8:11], s84 offen offset:0
    buffer_load_dwordx4 v[212:215], v75, s[8:11], s84 offen offset:1024
    buffer_load_dwordx4 v[216:219], v75, s[8:11], s84 offen offset:2048
    buffer_load_dwordx4 v[220:223], v75, s[8:11], s84 offen offset:3072
    s_add_u32 s84, s84, 4096
    buffer_load_dwordx4 v[224:227], v75, s[8:11], s84 offen offset:0
    buffer_load_dwordx4 v[228:231], v75, s[8:11], s84 offen offset:1024
    buffer_load_dwordx4 v[232:235], v75, s[8:11], s84 offen offset:2048
    buffer_load_dwordx4 v[236:239], v75, s[8:11], s84 offen offset:3072
    s_add_u32 s84, s84, 4096
    buffer_load_dwordx4 v[240:243], v75, s[8:11], s84 offen offset:0
    buffer_load_dwordx4 v[244:247], v75, s[8:11], s84 offen offset:1024
    buffer_load_dwordx4 v[248:251], v75, s[8:11], s84 offen offset:2048
    buffer_load_dwordx4 v[252:255], v75, s[8:11], s84 offen offset:3072
    s_mov_b32 s72, 0
    s_waitcnt vmcnt(46)
    s_barrier
    v_add_u32 v74, s72, v72
    v_add_u32 v75, s72, v73
    v_xor_b32 v76, 32, v75
    s_add_u32 s72, s72, 16384
    s_and_b32 s72, s72, 0x1ffff
    ds_read_b128 v[4:7], v74 offset:0
    ds_read_b128 v[8:11], v74 offset:1024
    ds_read_b64_tr_b16 v[36:37], v75 offset:0
    ds_read_b64_tr_b16 v[38:39], v75 offset:1024
    ds_read_b64_tr_b16 v[40:41], v76 offset:0
    ds_read_b64_tr_b16 v[42:43], v76 offset:1024
    s_waitcnt lgkmcnt(0)
    v_mfma_f32_16x16x32_bf16 v[80:83], v[4:7], v[36:39], 0
    ds_read_b128 v[12:15], v74 offset:2048
    v_mfma_f32_16x16x32_bf16 v[84:87], v[4:7], v[40:43], 0
    ds_read_b128 v[16:19], v74 offset:3072
    v_mfma_f32_16x16x32_bf16 v[88:91], v[8:11], v[36:39], 0
    v_mfma_f32_16x16x32_bf16 v[92:95], v[8:11], v[40:43], 0
    s_waitcnt vmcnt(44) lgkmcnt(0)
    s_barrier
    v_mfma_f32_16x16x32_bf16 v[96:99], v[12:15], v[36:39], 0
    v_add_u32 v74, s72, v72
    v_add_u32 v75, s72, v73
    v_xor_b32 v76, 32, v75
    s_add_u32 s72, s72, 16384
    s_and_b32 s72, s72, 0x1ffff
    ds_read_b128 v[4:7], v74 offset:0
    v_mfma_f32_16x16x32_bf16 v[100:103], v[12:15], v[40:43], 0
    ds_read_b64_tr_b16 v[52:53], v75 offset:0
    ds_read_b64_tr_b16 v[54:55], v75 offset:1024
    ds_read_b64_tr_b16 v[56:57], v76 offset:0
    ds_read_b64_tr_b16 v[58:59], v76 offset:1024
    v_mfma_f32_16x16x32_bf16 v[104:107], v[16:19], v[36:39], 0
    ds_read_b128 v[8:11], v74 offset:1024
    s_mov_b32 m0, s71
    s_nop 0
    buffer_load_dwordx4 v68, s[60:63], s68 offen lds
    s_add_u32 m0, s71, 8192
    v_mfma_f32_16x16x32_bf16 v[108:111], v[16:19], v[40:43], 0
    buffer_load_dwordx4 v70, s[64:67], s69 offen lds
    s_add_u32 s68, s68, 64
    s_add_u32 s69, s69, s70
    s_add_u32 s71, s71, 16384
    s_and_b32 s71, s71, 0x1ffff
    s_waitcnt lgkmcnt(0)
    v_mfma_f32_16x16x32_bf16 v[80:83], v[4:7], v[52:55], v[80:83]
    ds_read_b128 v[12:15], v74 offset:2048
    v_mfma_f32_16x16x32_bf16 v[84:87], v[4:7], v[56:59], v[84:87]
    ds_read_b128 v[16:19], v74 offset:3072
    v_mfma_f32_16x16x32_bf16 v[88:91], v[8:11], v[52:55], v[88:91]
    v_mfma_f32_16x16x32_bf16 v[92:95], v[8:11], v[56:59], v[92:95]
    s_waitcnt vmcnt(44) lgkmcnt(0)
    s_barrier
    v_mfma_f32_16x16x32_bf16 v[96:99], v[12:15], v[52:55], v[96:99]
    v_add_u32 v74, s72, v72
    v_add_u32 v75, s72, v73
    v_xor_b32 v76, 32, v75
    s_add_u32 s72, s72, 16384
    s_and_b32 s72, s72, 0x1ffff
    ds_read_b128 v[4:7], v74 offset:0
    v_mfma_f32_16x16x32_bf16 v[100:103], v[12:15], v[56:59], v[100:103]
    ds_read_b64_tr_b16 v[36:37], v75 offset:0
    ds_read_b64_tr_b16 v[38:39], v75 offset:1024
    ds_read_b64_tr_b16 v[40:41], v76 offset:0
    ds_read_b64_tr_b16 v[42:43], v76 offset:1024
    v_mfma_f32_16x16x32_bf16 v[104:107], v[16:19], v[52:55], v[104:107]
    ds_read_b128 v[8:11], v74 offset:1024
    s_mov_b32 m0, s71
    s_nop 0
    buffer_load_dwordx4 v68, s[60:63], s68 offen lds
    s_add_u32 m0, s71, 8192
    v_mfma_f32_16x16x32_bf16 v[108:111], v[16:19], v[56:59], v[108:111]
    buffer_load_dwordx4 v70, s[64:67], s69 offen lds
    s_add_u32 s68, s68, 64
    s_add_u32 s69, s69, s70
    s_add_u32 s71, s71, 16384
    s_and_b32 s71, s71, 0x1ffff
    s_waitcnt lgkmcnt(0)
    v_mfma_f32_16x16x32_bf16 v[80:83], v[4:7], v[36:39], v[80:83]
    ds_read_b128 v[12:15], v74 offset:2048
    v_mfma_f32_16x16x32_bf16 v[84:87], v[4:7], v[40:43], v[84:87]
    ds_read_b128 v[16:19], v74 offset:3072
    v_mfma_f32_16x16x32_bf16 v[88:91], v[8:11], v[36:39], v[88:91]
    v_mfma_f32_16x16x32_bf16 v[92:95], v[8:11], v[40:43], v[92:95]
    s_waitcnt vmcnt(44) lgkmcnt(0)
    s_barrier
    v_mfma_f32_16x16x32_bf16 v[96:99], v[12:15], v[36:39], v[96:99]
    v_add_u32 v74, s72, v72
    v_add_u32 v75, s72, v73
    v_xor_b32 v76, 32, v75
    s_add_u32 s72, s72, 16384
    s_and_b32 s72, s72, 0x1ffff
    ds_read_b128 v[4:7], v74 offset:0
    v_mfma_f32_16x16x32_bf16 v[100:103], v[12:15], v[40:43], v[100:103]
    ds_read_b64_tr_b16 v[52:53], v75 offset:0
    ds_read_b64_tr_b16 v[54:55], v75 offset:1024
    ds_read_b64_tr_b16 v[56:57], v76 offset:0
    ds_read_b64_tr_b16 v[58:59], v76 offset:1024
    v_mfma_f32_16x16x32_bf16 v[104:107], v[16:19], v[36:39], v[104:107]
    ds_read_b128 v[8:11], v74 offset:1024
    s_mov_b32 m0, s71
    s_nop 0
    buffer_load_dwordx4 v68, s[60:63], s68 offen lds
    s_add_u32 m0, s71, 8192
    v_mfma_f32_16x16x32_bf16 v[108:111], v[16:19], v[40:43], v[108:111]
    buffer_load_dwordx4 v70, s[64:67], s69 offen lds
    s_add_u32 s68, s68, 64
    s_add_u32 s69, s69, s70
    s_add_u32 s71, s71, 16384
    s_and_b32 s71, s71, 0x1ffff
    s_waitcnt lgkmcnt(0)
    v_mfma_f32_16x16x32_bf16 v[80:83], v[4:7], v[52:55], v[80:83]
    ds_read_b128 v[12:15], v74 offset:2048
    v_mfma_f32_16x16x32_bf16 v[84:87], v[4:7], v[56:59], v[84:87]
    ds_read_b128 v[16:19], v74 offset:3072
    v_mfma_f32_16x16x32_bf16 v[88:91], v[8:11], v[52:55], v[88:91]
    v_mfma_f32_16x16x32_bf16 v[92:95], v[8:11], v[56:59], v[92:95]
    s_waitcnt vmcnt(44) lgkmcnt(0)
    s_barrier
    v_mfma_f32_16x16x32_bf16 v[96:99], v[12:15], v[52:55], v[96:99]
    v_add_u32 v74, s72, v72
    v_add_u32 v75, s72, v73
    v_xor_b32 v76, 32, v75
    s_add_u32 s72, s72, 16384
    s_and_b32 s72, s72, 0x1ffff
    ds_read_b128 v[4:7], v74 offset:0
    v_mfma_f32_16x16x32_bf16 v[100:103], v[12:15], v[56:59], v[100:103]
    ds_read_b64_tr_b16 v[36:37], v75 offset:0
    ds_read_b64_tr_b16 v[38:39], v75 offset:1024
    ds_read_b64_tr_b16 v[40:41], v76 offset:0
    ds_read_b64_tr_b16 v[42:43], v76 offset:1024
    v_mfma_f32_16x16x32_bf16 v[104:107], v[16:19], v[52:55], v[104:107]
    ds_read_b128 v[8:11], v74 offset:1024
    s_mov_b32 m0, s71
    s_nop 0
    buffer_load_dwordx4 v68, s[60:63], s68 offen lds
    s_add_u32 m0, s71, 8192
    v_mfma_f32_16x16x32_bf16 v[108:111], v[16:19], v[56:59], v[108:111]
    buffer_load_dwordx4 v70, s[64:67], s69 offen lds
    s_add_u32 s68, s68, 64
    s_add_u32 s69, s69, s70
    s_add_u32 s71, s71, 16384
    s_and_b32 s71, s71, 0x1ffff
    s_waitcnt lgkmcnt(0)
    v_mfma_f32_16x16x32_bf16 v[80:83], v[4:7], v[36:39], v[80:83]
    ds_read_b128 v[12:15], v74 offset:2048
    v_mfma_f32_16x16x32_bf16 v[84:87], v[4:7], v[40:43], v[84:87]
    ds_read_b128 v[16:19], v74 offset:3072
    v_mfma_f32_16x16x32_bf16 v[88:91], v[8:11], v[36:39], v[88:91]
    v_mfma_f32_16x16x32_bf16 v[92:95], v[8:11], v[40:43], v[92:95]
    s_waitcnt vmcnt(44) lgkmcnt(0)
    s_barrier
    v_mfma_f32_16x16x32_bf16 v[96:99], v[12:15], v[36:39], v[96:99]
    v_add_u32 v74, s72, v72
    v_add_u32 v75, s72, v73
    v_xor_b32 v76, 32, v75
    s_add_u32 s72, s72, 16384
    s_and_b32 s72, s72, 0x1ffff
    ds_read_b128 v[4:7], v74 offset:0
    v_mfma_f32_16x16x32_bf16 v[100:103], v[12:15], v[40:43], v[100:103]
    ds_read_b64_tr_b16 v[52:53], v75 offset:0
    ds_read_b64_tr_b16 v[54:55], v75 offset:1024
    ds_read_b64_tr_b16 v[56:57], v76 offset:0
    ds_read_b64_tr_b16 v[58:59], v76 offset:1024
    v_mfma_f32_16x16x32_bf16 v[104:107], v[16:19], v[36:39], v[104:107]
    ds_read_b128 v[8:11], v74 offset:1024
    s_mov_b32 m0, s71
    s_nop 0
    buffer_load_dwordx4 v68, s[60:63], s68 offen lds
    s_add_u32 m0, s71, 8192
    v_mfma_f32_16x16x32_bf16 v[108:111], v[16:19], v[40:43], v[108:111]
    buffer_load_dwordx4 v70, s[64:67], s69 offen lds
    s_add_u32 s68, s68, 64
    s_add_u32 s69, s69, s70
    s_add_u32 s71, s71, 16384
    s_and_b32 s71, s71, 0x1ffff
    s_waitcnt lgkmcnt(0)
    v_mfma_f32_16x16x32_bf16 v[80:83], v[4:7], v[52:55], v[80:83]
    ds_read_b128 v[12:15], v74 offset:2048
    v_mfma_f32_16x16x32_bf16 v[84:87], v[4:7], v[56:59], v[84:87]
    ds_read_b128 v[16:19], v74 offset:3072
    v_mfma_f32_16x16x32_bf16 v[88:91], v[8:11], v[52:55], v[88:91]
    v_mfma_f32_16x16x32_bf16 v[92:95], v[8:11], v[56:59], v[92:95]
    s_waitcnt vmcnt(44) lgkmcnt(0)
    s_barrier
    v_mfma_f32_16x16x32_bf16 v[96:99], v[12:15], v[52:55], v[96:99]
    v_add_u32 v74, s72, v72
    v_add_u32 v75, s72, v73
    v_xor_b32 v76, 32, v75
    s_add_u32 s72, s72, 16384
    s_and_b32 s72, s72, 0x1ffff
    ds_read_b128 v[4:7], v74 offset:0
    v_mfma_f32_16x16x32_bf16 v[100:103], v[12:15], v[56:59], v[100:103]
    ds_read_b64_tr_b16 v[36:37], v75 offset:0
    ds_read_b64_tr_b16 v[38:39], v75 offset:1024
    ds_read_b64_tr_b16 v[40:41], v76 offset:0
    ds_read_b64_tr_b16 v[42:43], v76 offset:1024
    v_mfma_f32_16x16x32_bf16 v[104:107], v[16:19], v[52:55], v[104:107]
    ds_read_b128 v[8:11], v74 offset:1024
    s_mov_b32 m0, s71
    s_nop 0
    buffer_load_dwordx4 v68, s[60:63], s68 offen lds
    s_add_u32 m0, s71, 8192
    v_mfma_f32_16x16x32_bf16 v[108:111], v[16:19], v[56:59], v[108:111]
    buffer_load_dwordx4 v70, s[64:67], s69 offen lds
    s_add_u32 s68, s68, 64
    s_add_u32 s69, s69, s70
    s_add_u32 s71, s71, 16384
    s_and_b32 s71, s71, 0x1ffff
    s_waitcnt lgkmcnt(0)
    v_mfma_f32_16x16x32_bf16 v[80:83], v[4:7], v[36:39], v[80:83]
    ds_read_b128 v[12:15], v74 offset:2048
    v_mfma_f32_16x16x32_bf16 v[84:87], v[4:7], v[40:43], v[84:87]
    ds_read_b128 v[16:19], v74 offset:3072
    v_mfma_f32_16x16x32_bf16 v[88:91], v[8:11], v[36:39], v[88:91]
    v_mfma_f32_16x16x32_bf16 v[92:95], v[8:11], v[40:43], v[92:95]
    s_waitcnt vmcnt(44) lgkmcnt(0)
    s_barrier
    v_mfma_f32_16x16x32_bf16 v[96:99], v[12:15], v[36:39], v[96:99]
    v_add_u32 v74, s72, v72
    v_add_u32 v75, s72, v73
    v_xor_b32 v76, 32, v75
    s_add_u32 s72, s72, 16384
    s_and_b32 s72, s72, 0x1ffff
    ds_read_b128 v[4:7], v74 offset:0
    v_mfma_f32_16x16x32_bf16 v[100:103], v[12:15], v[40:43], v[100:103]
    ds_read_b64_tr_b16 v[52:53], v75 offset:0
    ds_read_b64_tr_b16 v[54:55], v75 offset:1024
    ds_read_b64_tr_b16 v[56:57], v76 offset:0
    ds_read_b64_tr_b16 v[58:59], v76 offset:1024
    v_mfma_f32_16x16x32_bf16 v[104:107], v[16:19], v[36:39], v[104:107]
    ds_read_b128 v[8:11], v74 offset:1024
    s_mov_b32 m0, s71
    s_nop 0
    buffer_load_dwordx4 v68, s[60:63], s68 offen lds
    s_add_u32 m0, s71, 8192
    v_mfma_f32_16x16x32_bf16 v[108:111], v[16:19], v[40:43], v[108:111]
    buffer_load_dwordx4 v70, s[64:67], s69 offen lds
    s_add_u32 s68, s68, 64
    s_add_u32 s69, s69, s70
    s_add_u32 s71, s71, 16384
    s_and_b32 s71, s71, 0x1ffff
    s_waitcnt lgkmcnt(0)
    v_mfma_f32_16x16x32_bf16 v[80:83], v[4:7], v[52:55], v[80:83]
    ds_read_b128 v[12:15], v74 offset:2048
    v_mfma_f32_16x16x32_bf16 v[84:87], v[4:7], v[56:59], v[84:87]
    ds_read_b128 v[16:19], v74 offset:3072
    v_mfma_f32_16x16x32_bf16 v[88:91], v[8:11], v[52:55], v[88:91]
    v_mfma_f32_16x16x32_bf16 v[92:95], v[8:11], v[56:59], v[92:95]
    s_waitcnt vmcnt(12) lgkmcnt(0)
    s_barrier
    v_mfma_f32_16x16x32_bf16 v[96:99], v[12:15], v[52:55], v[96:99]
    v_add_u32 v74, s72, v72
    v_add_u32 v75, s72, v73
    v_xor_b32 v76, 32, v75
    s_add_u32 s72, s72, 16384
    s_and_b32 s72, s72, 0x1ffff
    ds_read_b128 v[4:7], v74 offset:0
    v_mfma_f32_16x16x32_bf16 v[100:103], v[12:15], v[56:59], v[100:103]
    ds_read_b64_tr_b16 v[36:37], v75 offset:0
    ds_read_b64_tr_b16 v[38:39], v75 offset:1024
    ds_read_b64_tr_b16 v[40:41], v76 offset:0
    ds_read_b64_tr_b16 v[42:43], v76 offset:1024
    v_mfma_f32_16x16x32_bf16 v[104:107], v[16:19], v[52:55], v[104:107]
    ds_read_b128 v[8:11], v74 offset:1024
    s_mov_b32 m0, s71
    s_nop 0
    buffer_load_dwordx4 v68, s[60:63], s68 offen lds
    s_add_u32 m0, s71, 8192
    v_mfma_f32_16x16x32_bf16 v[108:111], v[16:19], v[56:59], v[108:111]
    buffer_load_dwordx4 v70, s[64:67], s69 offen lds
    s_add_u32 s68, s68, 64
    s_add_u32 s69, s69, s70
    s_add_u32 s71, s71, 16384
    s_and_b32 s71, s71, 0x1ffff
    s_mov_b32 s73, 8
gl_78:
    s_waitcnt lgkmcnt(0)
    v_mfma_f32_16x16x32_bf16 v[80:83], v[4:7], v[36:39], v[80:83]
    ds_read_b128 v[12:15], v74 offset:2048
    v_mfma_f32_16x16x32_bf16 v[84:87], v[4:7], v[40:43], v[84:87]
    ds_read_b128 v[16:19], v74 offset:3072
    v_mfma_f32_16x16x32_bf16 v[88:91], v[8:11], v[36:39], v[88:91]
    v_mfma_f32_16x16x32_bf16 v[92:95], v[8:11], v[40:43], v[92:95]
    s_waitcnt vmcnt(12) lgkmcnt(0)
    s_barrier
    v_mfma_f32_16x16x32_bf16 v[96:99], v[12:15], v[36:39], v[96:99]
    v_add_u32 v74, s72, v72
    v_add_u32 v75, s72, v73
    v_xor_b32 v76, 32, v75
    s_add_u32 s72, s72, 16384
    s_and_b32 s72, s72, 0x1ffff
    ds_read_b128 v[4:7], v74 offset:0
    v_mfma_f32_16x16x32_bf16 v[100:103], v[12:15], v[40:43], v[100:103]
    ds_read_b64_tr_b16 v[52:53], v75 offset:0
    ds_read_b64_tr_b16 v[54:55], v75 offset:1024
    ds_read_b64_tr_b16 v[56:57], v76 offset:0
    ds_read_b64_tr_b16 v[58:59], v76 offset:1024
    v_mfma_f32_16x16x32_bf16 v[104:107], v[16:19], v[36:39], v[104:107]
    ds_read_b128 v[8:11], v74 offset:1024
    s_mov_b32 m0, s71
    s_nop 0
    buffer_load_dwordx4 v68, s[60:63], s68 offen lds
    s_add_u32 m0, s71, 8192
    v_mfma_f32_16x16x32_bf16 v[108:111], v[16:19], v[40:43], v[108:111]
    buffer_load_dwordx4 v70, s[64:67], s69 offen lds
    s_add_u32 s68, s68, 64
    s_add_u32 s69, s69, s70
    s_add_u32 s71, s71, 16384
    s_and_b32 s71, s71, 0x1ffff
    s_waitcnt lgkmcnt(0)
    v_mfma_f32_16x16x32_bf16 v[80:83], v[4:7], v[52:55], v[80:83]
    ds_read_b128 v[12:15], v74 offset:2048
    v_mfma_f32_16x16x32_bf16 v[84:87], v[4:7], v[56:59], v[84:87]
    ds_read_b128 v[16:19], v74 offset:3072
    v_mfma_f32_16x16x32_bf16 v[88:91], v[8:11], v[52:55], v[88:91]
    v_mfma_f32_16x16x32_bf16 v[92:95], v[8:11], v[56:59], v[92:95]
    s_waitcnt vmcnt(12) lgkmcnt(0)
    s_barrier
    v_mfma_f32_16x16x32_bf16 v[96:99], v[12:15], v[52:55], v[96:99]
    v_add_u32 v74, s72, v72
    v_add_u32 v75, s72, v73
    v_xor_b32 v76, 32, v75
    s_add_u32 s72, s72, 16384
    s_and_b32 s72, s72, 0x1ffff
    ds_read_b128 v[4:7], v74 offset:0
    v_mfma_f32_16x16x32_bf16 v[100:103], v[12:15], v[56:59], v[100:103]
    ds_read_b64_tr_b16 v[36:37], v75 offset:0
    ds_read_b64_tr_b16 v[38:39], v75 offset:1024
    ds_read_b64_tr_b16 v[40:41], v76 offset:0
    ds_read_b64_tr_b16 v[42:43], v76 offset:1024
    v_mfma_f32_16x16x32_bf16 v[104:107], v[16:19], v[52:55], v[104:107]
    ds_read_b128 v[8:11], v74 offset:1024
    s_mov_b32 m0, s71
    s_nop 0
    buffer_load_dwordx4 v68, s[60:63], s68 offen lds
    s_add_u32 m0, s71, 8192
    v_mfma_f32_16x16x32_bf16 v[108:111], v[16:19], v[56:59], v[108:111]
    buffer_load_dwordx4 v70, s[64:67], s69 offen lds
    s_add_u32 s68, s68, 64
    s_add_u32 s69, s69, s70
    s_add_u32 s71, s71, 16384
    s_and_b32 s71, s71, 0x1ffff
    s_sub_u32 s73, s73, 1
    s_cmp_lg_u32 s73, 0
    s_cbranch_scc1 gl_78
    s_waitcnt lgkmcnt(0)
    v_mfma_f32_16x16x32_bf16 v[80:83], v[4:7], v[36:39], v[80:83]
    ds_read_b128 v[12:15], v74 offset:2048
    v_mfma_f32_16x16x32_bf16 v[84:87], v[4:7], v[40:43], v[84:87]
    ds_read_b128 v[16:19], v74 offset:3072
    v_mfma_f32_16x16x32_bf16 v[88:91], v[8:11], v[36:39], v[88:91]
    v_mfma_f32_16x16x32_bf16 v[92:95], v[8:11], v[40:43], v[92:95]
    s_waitcnt vmcnt(12) lgkmcnt(0)
    s_barrier
    v_mfma_f32_16x16x32_bf16 v[96:99], v[12:15], v[36:39], v[96:99]
    v_add_u32 v74, s72, v72
    v_add_u32 v75, s72, v73
    v_xor_b32 v76, 32, v75
    s_add_u32 s72, s72, 16384
    s_and_b32 s72, s72, 0x1ffff
    v_mfma_f32_16x16x32_bf16 v[100:103], v[12:15], v[40:43], v[100:103]
    ds_read_b128 v[4:7], v74 offset:0
    ds_read_b64_tr_b16 v[52:53], v75 offset:0
    v_mfma_f32_16x16x32_bf16 v[104:107], v[16:19], v[36:39], v[104:107]
    ds_read_b64_tr_b16 v[54:55], v75 offset:1024
    ds_read_b64_tr_b16 v[56:57], v76 offset:0
    v_mfma_f32_16x16x32_bf16 v[108:111], v[16:19], v[40:43], v[108:111]
    ds_read_b64_tr_b16 v[58:59], v76 offset:1024
    ds_read_b128 v[8:11], v74 offset:1024
    s_waitcnt lgkmcnt(0)
    v_mfma_f32_16x16x32_bf16 v[80:83], v[4:7], v[52:55], v[80:83]
    ds_read_b128 v[12:15], v74 offset:2048
    v_mfma_f32_16x16x32_bf16 v[84:87], v[4:7], v[56:59], v[84:87]
    ds_read_b128 v[16:19], v74 offset:3072
    v_mfma_f32_16x16x32_bf16 v[88:91], v[8:11], v[52:55], v[88:91]
    v_mfma_f32_16x16x32_bf16 v[92:95], v[8:11], v[56:59], v[92:95]
    s_waitcnt vmcnt(10) lgkmcnt(0)
    s_barrier
    v_mfma_f32_16x16x32_bf16 v[96:99], v[12:15], v[52:55], v[96:99]
    v_add_u32 v74, s72, v72
    v_add_u32 v75, s72, v73
    v_xor_b32 v76, 32, v75
    s_add_u32 s72, s72, 16384
    s_and_b32 s72, s72, 0x1ffff
    v_mfma_f32_16x16x32_bf16 v[100:103], v[12:15], v[56:59], v[100:103]
    ds_read_b128 v[4:7], v74 offset:0
    ds_read_b64_tr_b16 v[36:37], v75 offset:0
    v_mfma_f32_16x16x32_bf16 v[104:107], v[16:19], v[52:55], v[104:107]
    ds_read_b64_tr_b16 v[38:39], v75 offset:1024
    ds_read_b64_tr_b16 v[40:41], v76 offset:0
    v_mfma_f32_16x16x32_bf16 v[108:111], v[16:19], v[56:59], v[108:111]
    ds_read_b64_tr_b16 v[42:43], v76 offset:1024
    ds_read_b128 v[8:11], v74 offset:1024
    s_waitcnt lgkmcnt(0)
    v_mfma_f32_16x16x32_bf16 v[80:83], v[4:7], v[36:39], v[80:83]
    ds_read_b128 v[12:15], v74 offset:2048
    v_mfma_f32_16x16x32_bf16 v[84:87], v[4:7], v[40:43], v[84:87]
    ds_read_b128 v[16:19], v74 offset:3072
    v_mfma_f32_16x16x32_bf16 v[88:91], v[8:11], v[36:39], v[88:91]
    v_mfma_f32_16x16x32_bf16 v[92:95], v[8:11], v[40:43], v[92:95]
    s_waitcnt vmcnt(8) lgkmcnt(0)
    s_barrier
    v_mfma_f32_16x16x32_bf16 v[96:99], v[12:15], v[36:39], v[96:99]
    v_add_u32 v74, s72, v72
    v_add_u32 v75, s72, v73
    v_xor_b32 v76, 32, v75
    s_add_u32 s72, s72, 16384
    s_and_b32 s72, s72, 0x1ffff
    v_mfma_f32_16x16x32_bf16 v[100:103], v[12:15], v[40:43], v[100:103]
    ds_read_b128 v[4:7], v74 offset:0
    ds_read_b64_tr_b16 v[52:53], v75 offset:0
    v_mfma_f32_16x16x32_bf16 v[104:107], v[16:19], v[36:39], v[104:107]
    ds_read_b64_tr_b16 v[54:55], v75 offset:1024
    ds_read_b64_tr_b16 v[56:57], v76 offset:0
    v_mfma_f32_16x16x32_bf16 v[108:111], v[16:19], v[40:43], v[108:111]
    ds_read_b64_tr_b16 v[58:59], v76 offset:1024
    ds_read_b128 v[8:11], v74 offset:1024
    s_waitcnt lgkmcnt(0)
    v_mfma_f32_16x16x32_bf16 v[80:83], v[4:7], v[52:55], v[80:83]
    ds_read_b128 v[12:15], v74 offset:2048
    v_mfma_f32_16x16x32_bf16 v[84:87], v[4:7], v[56:59], v[84:87]
    ds_read_b128 v[16:19], v74 offset:3072
    v_mfma_f32_16x16x32_bf16 v[88:91], v[8:11], v[52:55], v[88:91]
    v_mfma_f32_16x16x32_bf16 v[92:95], v[8:11], v[56:59], v[92:95]
    s_waitcnt vmcnt(6) lgkmcnt(0)
    s_barrier
    v_mfma_f32_16x16x32_bf16 v[96:99], v[12:15], v[52:55], v[96:99]
    v_add_u32 v74, s72, v72
    v_add_u32 v75, s72, v73
    v_xor_b32 v76, 32, v75
    s_add_u32 s72, s72, 16384
    s_and_b32 s72, s72, 0x1ffff
    v_mfma_f32_16x16x32_bf16 v[100:103], v[12:15], v[56:59], v[100:103]
    ds_read_b128 v[4:7], v74 offset:0
    ds_read_b64_tr_b16 v[36:37], v75 offset:0
    v_mfma_f32_16x16x32_bf16 v[104:107], v[16:19], v[52:55], v[104:107]
    ds_read_b64_tr_b16 v[38:39], v75 offset:1024
    ds_read_b64_tr_b16 v[40:41], v76 offset:0
    v_mfma_f32_16x16x32_bf16 v[108:111], v[16:19], v[56:59], v[108:111]
    ds_read_b64_tr_b16 v[42:43], v76 offset:1024
    ds_read_b128 v[8:11], v74 offset:1024
    s_waitcnt lgkmcnt(0)
    v_mfma_f32_16x16x32_bf16 v[80:83], v[4:7], v[36:39], v[80:83]
    ds_read_b128 v[12:15], v74 offset:2048
    v_mfma_f32_16x16x32_bf16 v[84:87], v[4:7], v[40:43], v[84:87]
    ds_read_b128 v[16:19], v74 offset:3072
    v_mfma_f32_16x16x32_bf16 v[88:91], v[8:11], v[36:39], v[88:91]
    v_mfma_f32_16x16x32_bf16 v[92:95], v[8:11], v[40:43], v[92:95]
    s_waitcnt vmcnt(4) lgkmcnt(0)
    s_barrier
    v_mfma_f32_16x16x32_bf16 v[96:99], v[12:15], v[36:39], v[96:99]
    v_add_u32 v74, s72, v72
    v_add_u32 v75, s72, v73
    v_xor_b32 v76, 32, v75
    s_add_u32 s72, s72, 16384
    s_and_b32 s72, s72, 0x1ffff
    v_mfma_f32_16x16x32_bf16 v[100:103], v[12:15], v[40:43], v[100:103]
    ds_read_b128 v[4:7], v74 offset:0
    ds_read_b64_tr_b16 v[52:53], v75 offset:0
    v_mfma_f32_16x16x32_bf16 v[104:107], v[16:19], v[36:39], v[104:107]
    ds_read_b64_tr_b16 v[54:55], v75 offset:1024
    ds_read_b64_tr_b16 v[56:57], v76 offset:0
    v_mfma_f32_16x16x32_bf16 v[108:111], v[16:19], v[40:43], v[108:111]
    ds_read_b64_tr_b16 v[58:59], v76 offset:1024
    ds_read_b128 v[8:11], v74 offset:1024
    s_waitcnt lgkmcnt(0)
    v_mfma_f32_16x16x32_bf16 v[80:83], v[4:7], v[52:55], v[80:83]
    ds_read_b128 v[12:15], v74 offset:2048
    v_mfma_f32_16x16x32_bf16 v[84:87], v[4:7], v[56:59], v[84:87]
    ds_read_b128 v[16:19], v74 offset:3072
    v_mfma_f32_16x16x32_bf16 v[88:91], v[8:11], v[52:55], v[88:91]
    v_mfma_f32_16x16x32_bf16 v[92:95], v[8:11], v[56:59], v[92:95]
    s_waitcnt vmcnt(2) lgkmcnt(0)
    s_barrier
    v_mfma_f32_16x16x32_bf16 v[96:99], v[12:15], v[52:55], v[96:99]
    v_add_u32 v74, s72, v72
    v_add_u32 v75, s72, v73
    v_xor_b32 v76, 32, v75
    s_add_u32 s72, s72, 16384
    s_and_b32 s72, s72, 0x1ffff
    v_mfma_f32_16x16x32_bf16 v[100:103], v[12:15], v[56:59], v[100:103]
    ds_read_b128 v[4:7], v74 offset:0
    ds_read_b64_tr_b16 v[36:37], v75 offset:0
    v_mfma_f32_16x16x32_bf16 v[104:107], v[16:19], v[52:55], v[104:107]
    ds_read_b64_tr_b16 v[38:39], v75 offset:1024
    ds_read_b64_tr_b16 v[40:41], v76 offset:0
    v_mfma_f32_16x16x32_bf16 v[108:111], v[16:19], v[56:59], v[108:111]
    ds_read_b64_tr_b16 v[42:43], v76 offset:1024
    ds_read_b128 v[8:11], v74 offset:1024
    s_waitcnt lgkmcnt(0)
    v_mfma_f32_16x16x32_bf16 v[80:83], v[4:7], v[36:39], v[80:83]
    ds_read_b128 v[12:15], v74 offset:2048
    v_mfma_f32_16x16x32_bf16 v[84:87], v[4:7], v[40:43], v[84:87]
    ds_read_b128 v[16:19], v74 offset:3072
    v_mfma_f32_16x16x32_bf16 v[88:91], v[8:11], v[36:39], v[88:91]
    v_mfma_f32_16x16x32_bf16 v[92:95], v[8:11], v[40:43], v[92:95]
    s_waitcnt vmcnt(0) lgkmcnt(0)
    s_barrier
    v_mfma_f32_16x16x32_bf16 v[96:99], v[12:15], v[36:39], v[96:99]
    v_add_u32 v74, s72, v72
    v_add_u32 v75, s72, v73
    v_xor_b32 v76, 32, v75
    s_add_u32 s72, s72, 16384
    s_and_b32 s72, s72, 0x1ffff
    v_mfma_f32_16x16x32_bf16 v[100:103], v[12:15], v[40:43], v[100:103]
    ds_read_b128 v[4:7], v74 offset:0
    ds_read_b64_tr_b16 v[52:53], v75 offset:0
    v_mfma_f32_16x16x32_bf16 v[104:107], v[16:19], v[36:39], v[104:107]
    ds_read_b64_tr_b16 v[54:55], v75 offset:1024
    ds_read_b64_tr_b16 v[56:57], v76 offset:0
    v_mfma_f32_16x16x32_bf16 v[108:111], v[16:19], v[40:43], v[108:111]
    ds_read_b64_tr_b16 v[58:59], v76 offset:1024
    ds_read_b128 v[8:11], v74 offset:1024
    s_waitcnt lgkmcnt(0)
    v_mfma_f32_16x16x32_bf16 v[80:83], v[4:7], v[52:55], v[80:83]
    ds_read_b128 v[12:15], v74 offset:2048
    v_mfma_f32_16x16x32_bf16 v[84:87], v[4:7], v[56:59], v[84:87]
    ds_read_b128 v[16:19], v74 offset:3072
    v_mfma_f32_16x16x32_bf16 v[88:91], v[8:11], v[52:55], v[88:91]
    v_mfma_f32_16x16x32_bf16 v[92:95], v[8:11], v[56:59], v[92:95]
    s_waitcnt lgkmcnt(0)
    v_mfma_f32_16x16x32_bf16 v[96:99], v[12:15], v[52:55], v[96:99]
    v_mfma_f32_16x16x32_bf16 v[100:103], v[12:15], v[56:59], v[100:103]
    v_mfma_f32_16x16x32_bf16 v[104:107], v[16:19], v[52:55], v[104:107]
    v_mfma_f32_16x16x32_bf16 v[108:111], v[16:19], v[56:59], v[108:111]
    s_lshl_b32 s84, s80, 2
    s_and_b32 s81, s58, 3
    s_add_u32 s84, s84, s81
    s_lshl_b32 s84, s84, 5
    v_and_b32 v77, 15, v1
    v_add_u32 v77, s84, v77
    v_bfe_u32 v76, v77, 3, 5
    v_lshlrev_b32 v76, 12, v76
    v_bfe_u32 v75, v77, 10, 1
    v_lshl_or_b32 v76, v75, 17, v76
    v_bfe_u32 v75, v77, 0, 2
    v_lshl_or_b32 v76, v75, 18, v76
    v_bfe_u32 v75, v77, 8, 1
    v_lshl_or_b32 v76, v75, 20, v76
    v_bfe_u32 v75, v77, 2, 1
    v_lshl_or_b32 v76, v75, 21, v76
    v_bfe_u32 v75, v77, 9, 1
    v_lshl_or_b32 v76, v75, 22, v76
    v_bfe_u32 v77, v1, 4, 2
    v_lshlrev_b32 v77, 4, v77
    v_add_u32 v76, v76, v77
    s_lshl_b32 s81, s79, 8
    s_lshr_b32 s84, s58, 2
    s_lshl_b32 s84, s84, 7
    s_add_u32 s81, s81, s84
    v_cvt_pk_bf16_f32 v4, v80, v81
    v_cvt_pk_bf16_f32 v5, v82, v83
    v_cvt_pk_bf16_f32 v6, v88, v89
    v_cvt_pk_bf16_f32 v7, v90, v91
    buffer_store_dwordx4 v[4:7], v76, s[16:19], s81 offen offset:0
    v_cvt_pk_bf16_f32 v8, v96, v97
    v_cvt_pk_bf16_f32 v9, v98, v99
    v_cvt_pk_bf16_f32 v10, v104, v105
    v_cvt_pk_bf16_f32 v11, v106, v107
    buffer_store_dwordx4 v[8:11], v76, s[16:19], s81 offen offset:64
    s_add_u32 s81, s81, 8192
    v_cvt_pk_bf16_f32 v12, v84, v85
    v_cvt_pk_bf16_f32 v13, v86, v87
    v_cvt_pk_bf16_f32 v14, v92, v93
    v_cvt_pk_bf16_f32 v15, v94, v95
    buffer_store_dwordx4 v[12:15], v76, s[16:19], s81 offen offset:0
    v_cvt_pk_bf16_f32 v16, v100, v101
    v_cvt_pk_bf16_f32 v17, v102, v103
    v_cvt_pk_bf16_f32 v18, v108, v109
    v_cvt_pk_bf16_f32 v19, v110, v111
    buffer_store_dwordx4 v[16:19], v76, s[16:19], s81 offen offset:64
    s_add_u32 s81, s81, 8192
    s_cmp_lg_u32 s58, 0
    s_cbranch_scc1 wall_79
    v_mov_b32 v76, 48
wctr_80:
    buffer_load_dword v75, v76, s[12:15], 0 offen sc1
    s_waitcnt vmcnt(0)
    v_cmp_gt_u32 vcc, 128, v75
    s_cbranch_vccz wctr_ok_81
    s_sub_u32 s77, s77, 1
    s_cbranch_scc0 wctr_80
    s_mov_b32 s77, 0
wctr_ok_81:
wall_79:
    s_barrier
    v_lshlrev_b32 v8, 4, v1
    v_bfe_u32 v9, v1, 0, 3
    v_lshlrev_b32 v9, 4, v9
    v_bfe_u32 v3, v1, 5, 1
    v_lshl_or_b32 v9, v3, 7, v9
    v_lshlrev_b32 v10, 3, v1
    s_and_b32 s93, s57, 1
    s_lshl_b32 s93, s93, 3
    s_add_u32 s93, s93, s58
    s_lshl_b32 s87, s93, 3
    v_mov_b32 v11, s87
    s_lshl_b32 s93, s93, 14
    s_add_u32 s93, s93, 0x3000000
    s_mul_i32 s87, s58, 8448
    v_bfe_u32 v2, v1, 5, 1
    v_lshlrev_b32 v2, 4, v2
    v_add3_u32 v12, s87, v8, v2
    v_bfe_u32 v2, v1, 1, 4
    v_mul_u32_u24 v2, 528, v2
    v_bfe_u32 v13, v1, 0, 1
    v_lshlrev_b32 v13, 3, v13
    v_bfe_u32 v3, v1, 5, 1
    v_lshl_or_b32 v13, v3, 4, v13
    s_lshl_b32 s87, s58, 6
    v_add3_u32 v13, s87, v13, v2
    v_bfe_u32 v14, v1, 0, 5
    v_lshlrev_b32 v14, 2, v14
    v_bfe_u32 v3, v1, 5, 1
    v_lshl_or_b32 v14, v3, 12, v14
    s_lshl_b32 s87, s58, 14
    s_bfe_u32 s88, s57, 0x40001
    s_lshl_b32 s88, s88, 7
    s_add_u32 s87, s87, s88
    s_add_u32 s87, s87, 2048
    v_add_u32 v14, s87, v14
    v_bfe_u32 v2, v1, 5, 1
    v_lshlrev_b32 v2, 2, v2
    v_and_b32 v15, 31, v1
    v_sub_u32 v15, v15, v2
    s_mov_b32 s89, 0x3e0293ee
    s_mov_b32 s85, 0
    s_mov_b32 s86, s58
    s_mov_b32 s92, 0
    buffer_load_dword v3, off, s[12:15], 0 offset:64 sc1
    s_waitcnt vmcnt(0)
    v_readfirstlane_b32 s91, v3
aw_loop_82:
    s_cmp_lg_u32 s92, 0
    s_cbranch_scc1 aw_stream_85
    s_lshl_b32 s87, s86, 2
    s_add_u32 s87, s87, s75
    s_cmp_ge_u32 s86, 14
    s_cselect_b32 s88, 1, 3
    s_add_u32 s88, s88, s87
    s_cmp_ge_u32 s91, s88
    s_cbranch_scc1 aw_att_84
    s_cmp_lg_u32 s86, s85
    s_cbranch_scc1 aw_wo_83
    s_lshl_b32 s87, s86, 2
    s_add_u32 s87, s87, s75
    s_cmp_ge_u32 s86, 14
    s_cselect_b32 s88, -1, 3
    s_add_u32 s88, s88, s87
pollprog_86:
    buffer_load_dword v3, off, s[12:15], 0 offset:64 sc1
    s_waitcnt vmcnt(0)
    v_cmp_gt_u32 vcc, s88, v3
    s_cbranch_vccz pollprog_ok_87
    s_sub_u32 s77, s77, 1
    s_cbranch_scc0 pollprog_86
    s_mov_b32 s77, 0
pollprog_ok_87:
aw_att_84:
    s_lshl_b32 s87, s87, 5
    s_add_u32 s87, s87, s57
    s_lshl_b32 s88, s87, 11
    s_add_u32 s88, s88, 0x4000000
    s_lshl_b32 s90, s87, 13
    buffer_load_dwordx4 v[96:99], v9, s[8:11], s88 offen offset:0 sc1
    buffer_load_dwordx4 v[100:103], v9, s[8:11], s88 offen offset:256 sc1
    buffer_load_dwordx4 v[104:107], v9, s[8:11], s88 offen offset:512 sc1
    buffer_load_dwordx4 v[108:111], v9, s[8:11], s88 offen offset:768 sc1
    buffer_load_dwordx4 v[112:115], v9, s[8:11], s88 offen offset:1024 sc1
    buffer_load_dwordx4 v[116:119], v9, s[8:11], s88 offen offset:1280 sc1
    buffer_load_dwordx4 v[120:123], v9, s[8:11], s88 offen offset:1536 sc1
    buffer_load_dwordx4 v[124:127], v9, s[8:11], s88 offen offset:1792 sc1
    s_add_u32 s87, s90, 0x0
    buffer_load_dwordx4 v[32:35], v8, s[8:11], s87 offen offset:0 sc1
    buffer_load_dwordx4 v[36:39], v8, s[8:11], s87 offen offset:1024 sc1
    buffer_load_dwordx4 v[40:43], v8, s[8:11], s87 offen offset:2048 sc1
    buffer_load_dwordx4 v[44:47], v8, s[8:11], s87 offen offset:3072 sc1
    s_add_u32 s87, s87, 4096
    buffer_load_dwordx4 v[48:51], v8, s[8:11], s87 offen offset:0 sc1
    buffer_load_dwordx4 v[52:55], v8, s[8:11], s87 offen offset:1024 sc1
    buffer_load_dwordx4 v[56:59], v8, s[8:11], s87 offen offset:2048 sc1
    buffer_load_dwordx4 v[60:63], v8, s[8:11], s87 offen offset:3072 sc1
    s_add_u32 s87, s90, 0x1000000
    buffer_load_dwordx4 v[64:67], v8, s[8:11], s87 offen offset:0 sc1
    buffer_load_dwordx4 v[68:71], v8, s[8:11], s87 offen offset:1024 sc1
    buffer_load_dwordx4 v[72:75], v8, s[8:11], s87 offen offset:2048 sc1
    buffer_load_dwordx4 v[76:79], v8, s[8:11], s87 offen offset:3072 sc1
    s_add_u32 s87, s87, 4096
    buffer_load_dwordx4 v[80:83], v8, s[8:11], s87 offen offset:0 sc1
    buffer_load_dwordx4 v[84:87], v8, s[8:11], s87 offen offset:1024 sc1
    buffer_load_dwordx4 v[88:91], v8, s[8:11], s87 offen offset:2048 sc1
    buffer_load_dwordx4 v[92:95], v8, s[8:11], s87 offen offset:3072 sc1
    s_waitcnt vmcnt(0)
    v_max3_u32 v2, v96, v100, v104
    v_max3_u32 v2, v2, v108, v112
    v_max3_u32 v2, v2, v116, v120
    v_max_u32 v2, v2, v124
    v_cmp_eq_u32 vcc, -1, v2
    s_cbranch_vccz pollkm_ok_89
pollkm_88:
    buffer_load_dwordx4 v[96:99], v9, s[8:11], s88 offen offset:0 sc1
    buffer_load_dwordx4 v[100:103], v9, s[8:11], s88 offen offset:256 sc1
    buffer_load_dwordx4 v[104:107], v9, s[8:11], s88 offen offset:512 sc1
    buffer_load_dwordx4 v[108:111], v9, s[8:11], s88 offen offset:768 sc1
    buffer_load_dwordx4 v[112:115], v9, s[8:11], s88 offen offset:1024 sc1
    buffer_load_dwordx4 v[116:119], v9, s[8:11], s88 offen offset:1280 sc1
    buffer_load_dwordx4 v[120:123], v9, s[8:11], s88 offen offset:1536 sc1
    buffer_load_dwordx4 v[124:127], v9, s[8:11], s88 offen offset:1792 sc1
    s_waitcnt vmcnt(0)
    v_max3_u32 v2, v96, v100, v104
    v_max3_u32 v2, v2, v108, v112
    v_max3_u32 v2, v2, v116, v120
    v_max_u32 v2, v2, v124
    v_cmp_eq_u32 vcc, -1, v2
    s_cbranch_vccz pollkm_ok_89
    s_sub_u32 s77, s77, 1
    s_cbranch_scc0 pollkm_88
    s_mov_b32 s77, 0
pollkm_ok_89:
    v_mfma_f32_32x32x16_bf16 v[16:31], v[96:99], v[32:35], 0
    v_mfma_f32_32x32x16_bf16 v[16:31], v[100:103], v[36:39], v[16:31]
    v_mfma_f32_32x32x16_bf16 v[16:31], v[104:107], v[40:43], v[16:31]
    v_mfma_f32_32x32x16_bf16 v[16:31], v[108:111], v[44:47], v[16:31]
    v_mfma_f32_32x32x16_bf16 v[16:31], v[112:115], v[48:51], v[16:31]
    v_mfma_f32_32x32x16_bf16 v[16:31], v[116:119], v[52:55], v[16:31]
    v_mfma_f32_32x32x16_bf16 v[16:31], v[120:123], v[56:59], v[16:31]
    v_mfma_f32_32x32x16_bf16 v[16:31], v[124:127], v[60:63], v[16:31]
    s_nop 11
    v_mov_b32 v4, v16
    v_mov_b32 v5, v17
    v_mov_b32 v6, v18
    v_mov_b32 v7, v19
    s_add_u32 s87, s90, 0x2000000
    buffer_load_dwordx4 v[96:99], v8, s[8:11], s87 offen offset:0 sc1
    buffer_load_dwordx4 v[100:103], v8, s[8:11], s87 offen offset:1024 sc1
    buffer_load_dwordx4 v[104:107], v8, s[8:11], s87 offen offset:2048 sc1
    buffer_load_dwordx4 v[108:111], v8, s[8:11], s87 offen offset:3072 sc1
    s_add_u32 s87, s87, 4096
    buffer_load_dwordx4 v[112:115], v8, s[8:11], s87 offen offset:0 sc1
    buffer_load_dwordx4 v[116:119], v8, s[8:11], s87 offen offset:1024 sc1
    buffer_load_dwordx4 v[120:123], v8, s[8:11], s87 offen offset:2048 sc1
    buffer_load_dwordx4 v[124:127], v8, s[8:11], s87 offen offset:3072 sc1
    v_mfma_f32_32x32x16_bf16 v[16:31], v[64:67], v[32:35], 0
    v_mfma_f32_32x32x16_bf16 v[16:31], v[68:71], v[36:39], v[16:31]
    v_mfma_f32_32x32x16_bf16 v[16:31], v[72:75], v[40:43], v[16:31]
    v_mfma_f32_32x32x16_bf16 v[16:31], v[76:79], v[44:47], v[16:31]
    v_mfma_f32_32x32x16_bf16 v[16:31], v[80:83], v[48:51], v[16:31]
    v_mfma_f32_32x32x16_bf16 v[16:31], v[84:87], v[52:55], v[16:31]
    v_mfma_f32_32x32x16_bf16 v[16:31], v[88:91], v[56:59], v[16:31]
    v_mfma_f32_32x32x16_bf16 v[16:31], v[92:95], v[60:63], v[16:31]
    v_mov_b32 v3, 0xff800000
    v_cmp_le_i32 vcc, 0, v15
    s_nop 9
    v_cndmask_b32 v16, v3, v16, vcc
    v_cmp_le_i32 vcc, 1, v15
    s_nop 1
    v_cndmask_b32 v17, v3, v17, vcc
    v_cmp_le_i32 vcc, 2, v15
    s_nop 1
    v_cndmask_b32 v18, v3, v18, vcc
    v_cmp_le_i32 vcc, 3, v15
    s_nop 1
    v_cndmask_b32 v19, v3, v19, vcc
    v_cmp_le_i32 vcc, 8, v15
    s_nop 1
    v_cndmask_b32 v20, v3, v20, vcc
    v_cmp_le_i32 vcc, 9, v15
    s_nop 1
    v_cndmask_b32 v21, v3, v21, vcc
    v_cmp_le_i32 vcc, 10, v15
    s_nop 1
    v_cndmask_b32 v22, v3, v22, vcc
    v_cmp_le_i32 vcc, 11, v15
    s_nop 1
    v_cndmask_b32 v23, v3, v23, vcc
    v_cmp_le_i32 vcc, 16, v15
    s_nop 1
    v_cndmask_b32 v24, v3, v24, vcc
    v_cmp_le_i32 vcc, 17, v15
    s_nop 1
    v_cndmask_b32 v25, v3, v25, vcc
    v_cmp_le_i32 vcc, 18, v15
    s_nop 1
    v_cndmask_b32 v26, v3, v26, vcc
    v_cmp_le_i32 vcc, 19, v15
    s_nop 1
    v_cndmask_b32 v27, v3, v27, vcc
    v_cmp_le_i32 vcc, 24, v15
    s_nop 1
    v_cndmask_b32 v28, v3, v28, vcc
    v_cmp_le_i32 vcc, 25, v15
    s_nop 1
    v_cndmask_b32 v29, v3, v29, vcc
    v_cmp_le_i32 vcc, 26, v15
    s_nop 1
    v_cndmask_b32 v30, v3, v30, vcc
    v_cmp_le_i32 vcc, 27, v15
    s_nop 1
    v_cndmask_b32 v31, v3, v31, vcc
    s_add_u32 s88, s88, 0x400000
    buffer_load_dwordx2 v[64:65], v10, s[8:11], s88 offen offset:0 sc1
    buffer_load_dwordx2 v[66:67], v10, s[8:11], s88 offen offset:512 sc1
    buffer_load_dwordx2 v[68:69], v10, s[8:11], s88 offen offset:1024 sc1
    buffer_load_dwordx2 v[70:71], v10, s[8:11], s88 offen offset:1536 sc1
    v_max3_f32 v2, v16, v17, v18
    v_max3_f32 v2, v2, v19, v20
    v_max3_f32 v2, v2, v21, v22
    v_max3_f32 v2, v2, v23, v24
    v_max3_f32 v2, v2, v25, v26
    v_max3_f32 v2, v2, v27, v28
    v_max3_f32 v2, v2, v29, v30
    v_max3_f32 v2, v2, v31, v4
    v_max3_f32 v2, v2, v5, v6
    v_max_f32 v2, v2, v7
    v_mov_b32 v3, v2
    s_nop 1
    v_permlane32_swap_b32 v2, v3
    v_max_f32 v2, v2, v3
    v_mul_f32 v2, s89, v2
    v_fma_f32 v16, v16, s89, -v2
    v_fma_f32 v17, v17, s89, -v2
    v_fma_f32 v18, v18, s89, -v2
    v_fma_f32 v19, v19, s89, -v2
    v_fma_f32 v20, v20, s89, -v2
    v_fma_f32 v21, v21, s89, -v2
    v_fma_f32 v22, v22, s89, -v2
    v_fma_f32 v23, v23, s89, -v2
    v_fma_f32 v24, v24, s89, -v2
    v_fma_f32 v25, v25, s89, -v2
    v_fma_f32 v26, v26, s89, -v2
    v_fma_f32 v27, v27, s89, -v2
    v_fma_f32 v28, v28, s89, -v2
    v_fma_f32 v29, v29, s89, -v2
    v_fma_f32 v30, v30, s89, -v2
    v_fma_f32 v31, v31, s89, -v2
    v_fma_f32 v4, v4, s89, -v2
    v_fma_f32 v5, v5, s89, -v2
    v_fma_f32 v6, v6, s89, -v2
    v_fma_f32 v7, v7, s89, -v2
    v_exp_f32 v16, v16
    v_exp_f32 v17, v17
    v_exp_f32 v18, v18
    v_exp_f32 v19, v19
    v_exp_f32 v20, v20
    v_exp_f32 v21, v21
    v_exp_f32 v22, v22
    v_exp_f32 v23, v23
    v_exp_f32 v24, v24
    v_exp_f32 v25, v25
    v_exp_f32 v26, v26
    v_exp_f32 v27, v27
    v_exp_f32 v28, v28
    v_exp_f32 v29, v29
    v_exp_f32 v30, v30
    v_exp_f32 v31, v31
    v_exp_f32 v4, v4
    v_exp_f32 v5, v5
    v_exp_f32 v6, v6
    v_exp_f32 v7, v7
    v_cvt_pk_bf16_f32 v32, v16, v17
    v_cvt_pk_bf16_f32 v33, v18, v19
    v_cvt_pk_bf16_f32 v34, v20, v21
    v_cvt_pk_bf16_f32 v35, v22, v23
    v_cvt_pk_bf16_f32 v36, v24, v25
    v_cvt_pk_bf16_f32 v37, v26, v27
    v_cvt_pk_bf16_f32 v38, v28, v29
    v_cvt_pk_bf16_f32 v39, v30, v31
    v_cvt_pk_bf16_f32 v40, v4, v5
    v_cvt_pk_bf16_f32 v41, v6, v7
    v_add_f32 v2, v16, v17
    v_add_f32 v2, v2, v18
    v_add_f32 v2, v2, v19
    v_add_f32 v2, v2, v20
    v_add_f32 v2, v2, v21
    v_add_f32 v2, v2, v22
    v_add_f32 v2, v2, v23
    v_add_f32 v2, v2, v24
    v_add_f32 v2, v2, v25
    v_add_f32 v2, v2, v26
    v_add_f32 v2, v2, v27
    v_add_f32 v2, v2, v28
    v_add_f32 v2, v2, v29
    v_add_f32 v2, v2, v30
    v_add_f32 v2, v2, v31
    v_add_f32 v2, v2, v4
    v_add_f32 v2, v2, v5
    v_add_f32 v2, v2, v6
    v_add_f32 v2, v2, v7
    v_mov_b32 v3, v2
    s_nop 1
    v_permlane32_swap_b32 v2, v3
    v_add_f32 v2, v2, v3
    v_rcp_f32 v2, v2
    s_waitcnt vmcnt(0)
    v_max3_u32 v3, v64, v66, v68
    v_max_u32 v3, v3, v70
    v_cmp_eq_u32 vcc, -1, v3
    s_cbranch_vccz pollvm_ok_91
pollvm_90:
    buffer_load_dwordx2 v[64:65], v10, s[8:11], s88 offen offset:0 sc1
    buffer_load_dwordx2 v[66:67], v10, s[8:11], s88 offen offset:512 sc1
    buffer_load_dwordx2 v[68:69], v10, s[8:11], s88 offen offset:1024 sc1
    buffer_load_dwordx2 v[70:71], v10, s[8:11], s88 offen offset:1536 sc1
    s_waitcnt vmcnt(0)
    v_max3_u32 v3, v64, v66, v68
    v_max_u32 v3, v3, v70
    v_cmp_eq_u32 vcc, -1, v3
    s_cbranch_vccz pollvm_ok_91
    s_sub_u32 s77, s77, 1
    s_cbranch_scc0 pollvm_90
    s_mov_b32 s77, 0
pollvm_ok_91:
    s_add_u32 s87, s90, 0x3000000
    v_mfma_f32_32x32x8_bf16 v[48:63], v[64:65], v[40:41], 0
    s_nop 9
    v_mfma_f32_32x32x16_bf16 v[48:63], v[96:99], v[32:35], v[48:63]
    v_mfma_f32_32x32x16_bf16 v[48:63], v[100:103], v[36:39], v[48:63]
    v_mfma_f32_32x32x8_bf16 v[80:95], v[66:67], v[40:41], 0
    s_nop 9
    v_mfma_f32_32x32x16_bf16 v[80:95], v[104:107], v[32:35], v[80:95]
    v_mfma_f32_32x32x16_bf16 v[80:95], v[108:111], v[36:39], v[80:95]
    v_mfma_f32_32x32x8_bf16 v[16:31], v[68:69], v[40:41], 0
    s_nop 9
    v_mfma_f32_32x32x16_bf16 v[16:31], v[112:115], v[32:35], v[16:31]
    v_mfma_f32_32x32x16_bf16 v[16:31], v[116:119], v[36:39], v[16:31]
    v_mul_f32 v48, v2, v48
    v_mul_f32 v49, v2, v49
    v_mul_f32 v50, v2, v50
    v_mul_f32 v51, v2, v51
    v_mul_f32 v52, v2, v52
    v_mul_f32 v53, v2, v53
    v_mul_f32 v54, v2, v54
    v_mul_f32 v55, v2, v55
    v_mul_f32 v56, v2, v56
    v_mul_f32 v57, v2, v57
    v_mul_f32 v58, v2, v58
    v_mul_f32 v59, v2, v59
    v_mul_f32 v60, v2, v60
    v_mul_f32 v61, v2, v61
    v_mul_f32 v62, v2, v62
    v_mul_f32 v63, v2, v63
    v_cvt_pk_bf16_f32 v72, v48, v49
    v_cvt_pk_bf16_f32 v73, v50, v51
    v_cvt_pk_bf16_f32 v74, v52, v53
    v_cvt_pk_bf16_f32 v75, v54, v55
    buffer_store_dwordx4 v[72:75], v8, s[8:11], s87 offen offset:0
    v_cvt_pk_bf16_f32 v76, v56, v57
    v_cvt_pk_bf16_f32 v77, v58, v59
    v_cvt_pk_bf16_f32 v78, v60, v61
    v_cvt_pk_bf16_f32 v79, v62, v63
    buffer_store_dwordx4 v[76:79], v8, s[8:11], s87 offen offset:1024
    v_mfma_f32_32x32x8_bf16 v[48:63], v[70:71], v[40:41], 0
    s_nop 9
    v_mfma_f32_32x32x16_bf16 v[48:63], v[120:123], v[32:35], v[48:63]
    v_mfma_f32_32x32x16_bf16 v[48:63], v[124:127], v[36:39], v[48:63]
    v_mul_f32 v80, v2, v80
    v_mul_f32 v81, v2, v81
    v_mul_f32 v82, v2, v82
    v_mul_f32 v83, v2, v83
    v_mul_f32 v84, v2, v84
    v_mul_f32 v85, v2, v85
    v_mul_f32 v86, v2, v86
    v_mul_f32 v87, v2, v87
    v_mul_f32 v88, v2, v88
    v_mul_f32 v89, v2, v89
    v_mul_f32 v90, v2, v90
    v_mul_f32 v91, v2, v91
    v_mul_f32 v92, v2, v92
    v_mul_f32 v93, v2, v93
    v_mul_f32 v94, v2, v94
    v_mul_f32 v95, v2, v95
    v_cvt_pk_bf16_f32 v72, v80, v81
    v_cvt_pk_bf16_f32 v73, v82, v83
    v_cvt_pk_bf16_f32 v74, v84, v85
    v_cvt_pk_bf16_f32 v75, v86, v87
    buffer_store_dwordx4 v[72:75], v8, s[8:11], s87 offen offset:2048
    v_cvt_pk_bf16_f32 v76, v88, v89
    v_cvt_pk_bf16_f32 v77, v90, v91
    v_cvt_pk_bf16_f32 v78, v92, v93
    v_cvt_pk_bf16_f32 v79, v94, v95
    buffer_store_dwordx4 v[76:79], v8, s[8:11], s87 offen offset:3072
    s_add_u32 s87, s87, 4096
    v_mul_f32 v16, v2, v16
    v_mul_f32 v17, v2, v17
    v_mul_f32 v18, v2, v18
    v_mul_f32 v19, v2, v19
    v_mul_f32 v20, v2, v20
    v_mul_f32 v21, v2, v21
    v_mul_f32 v22, v2, v22
    v_mul_f32 v23, v2, v23
    v_mul_f32 v24, v2, v24
    v_mul_f32 v25, v2, v25
    v_mul_f32 v26, v2, v26
    v_mul_f32 v27, v2, v27
    v_mul_f32 v28, v2, v28
    v_mul_f32 v29, v2, v29
    v_mul_f32 v30, v2, v30
    v_mul_f32 v31, v2, v31
    v_cvt_pk_bf16_f32 v72, v16, v17
    v_cvt_pk_bf16_f32 v73, v18, v19
    v_cvt_pk_bf16_f32 v74, v20, v21
    v_cvt_pk_bf16_f32 v75, v22, v23
    buffer_store_dwordx4 v[72:75], v8, s[8:11], s87 offen offset:0
    v_cvt_pk_bf16_f32 v76, v24, v25
    v_cvt_pk_bf16_f32 v77, v26, v27
    v_cvt_pk_bf16_f32 v78, v28, v29
    v_cvt_pk_bf16_f32 v79, v30, v31
    buffer_store_dwordx4 v[76:79], v8, s[8:11], s87 offen offset:1024
    v_mul_f32 v48, v2, v48
    v_mul_f32 v49, v2, v49
    v_mul_f32 v50, v2, v50
    v_mul_f32 v51, v2, v51
    v_mul_f32 v52, v2, v52
    v_mul_f32 v53, v2, v53
    v_mul_f32 v54, v2, v54
    v_mul_f32 v55, v2, v55
    v_mul_f32 v56, v2, v56
    v_mul_f32 v57, v2, v57
    v_mul_f32 v58, v2, v58
    v_mul_f32 v59, v2, v59
    v_mul_f32 v60, v2, v60
    v_mul_f32 v61, v2, v61
    v_mul_f32 v62, v2, v62
    v_mul_f32 v63, v2, v63
    v_cvt_pk_bf16_f32 v72, v48, v49
    v_cvt_pk_bf16_f32 v73, v50, v51
    v_cvt_pk_bf16_f32 v74, v52, v53
    v_cvt_pk_bf16_f32 v75, v54, v55
    buffer_store_dwordx4 v[72:75], v8, s[8:11], s87 offen offset:2048
    v_cvt_pk_bf16_f32 v76, v56, v57
    v_cvt_pk_bf16_f32 v77, v58, v59
    v_cvt_pk_bf16_f32 v78, v60, v61
    v_cvt_pk_bf16_f32 v79, v62, v63
    buffer_store_dwordx4 v[76:79], v8, s[8:11], s87 offen offset:3072
    s_lshr_b32 s87, s90, 11
    s_add_u32 s87, s87, 0x5100000
    v_mov_b32 v2, 1
    v_mov_b32 v3, 0
    s_waitcnt vmcnt(0)
    buffer_store_dword v2, v3, s[8:11], s87 offen
    s_add_u32 s86, s86, 8
aw_wo_83:
    s_lshl_b32 s88, s85, 2
    s_add_u32 s88, s88, s75
    s_lshl_b32 s88, s88, 7
    s_add_u32 s88, s88, 0x5100000
pollfl_92:
    buffer_load_dwordx2 v[4:5], v11, s[8:11], s88 offen sc1
    s_waitcnt vmcnt(0)
    v_min_u32 v4, v4, v5
    v_cmp_eq_u32 vcc, 0, v4
    s_cbranch_vccz pollfl_ok_93
    s_sub_u32 s77, s77, 1
    s_cbranch_scc0 pollfl_92
    s_mov_b32 s77, 0
pollfl_ok_93:
    s_lshl_b32 s88, s85, 2
    s_add_u32 s88, s88, s75
    s_lshl_b32 s88, s88, 7
    s_add_u32 s88, s88, 0x5100200
    buffer_load_dwordx2 v[4:5], v11, s[8:11], s88 offen sc1
    buffer_load_dword v6, off, s[12:15], 0 offset:64 sc1
    s_lshl_b32 s90, s85, 2
    s_add_u32 s90, s90, s75
    s_add_u32 s90, s90, 0
    s_lshl_b32 s90, s90, 18
    s_add_u32 s90, s90, s93
    buffer_load_dwordx4 v[48:51], v8, s[8:11], s90 offen offset:0 sc1
    buffer_load_dwordx4 v[52:55], v8, s[8:11], s90 offen offset:1024 sc1
    buffer_load_dwordx4 v[56:59], v8, s[8:11], s90 offen offset:2048 sc1
    buffer_load_dwordx4 v[60:63], v8, s[8:11], s90 offen offset:3072 sc1
    s_add_u32 s90, s90, 4096
    buffer_load_dwordx4 v[64:67], v8, s[8:11], s90 offen offset:0 sc1
    buffer_load_dwordx4 v[68:71], v8, s[8:11], s90 offen offset:1024 sc1
    buffer_load_dwordx4 v[72:75], v8, s[8:11], s90 offen offset:2048 sc1
    buffer_load_dwordx4 v[76:79], v8, s[8:11], s90 offen offset:3072 sc1
    s_add_u32 s90, s90, 4096
    buffer_load_dwordx4 v[80:83], v8, s[8:11], s90 offen offset:0 sc1
    buffer_load_dwordx4 v[84:87], v8, s[8:11], s90 offen offset:1024 sc1
    buffer_load_dwordx4 v[88:91], v8, s[8:11], s90 offen offset:2048 sc1
    buffer_load_dwordx4 v[92:95], v8, s[8:11], s90 offen offset:3072 sc1
    s_add_u32 s90, s90, 4096
    buffer_load_dwordx4 v[96:99], v8, s[8:11], s90 offen offset:0 sc1
    buffer_load_dwordx4 v[100:103], v8, s[8:11], s90 offen offset:1024 sc1
    buffer_load_dwordx4 v[104:107], v8, s[8:11], s90 offen offset:2048 sc1
    buffer_load_dwordx4 v[108:111], v8, s[8:11], s90 offen offset:3072 sc1
    v_mov_b32 v2, 0x5ffffff0
    buffer_load_dword v7, v2, s[8:11], 0 offen
    buffer_load_dword v7, v2, s[8:11], 0 offen
aw_stream_85:
    s_waitcnt vmcnt(18)
    v_readfirstlane_b32 s91, v6
    v_min_u32 v4, v4, v5
    v_cmp_eq_u32 vcc, 0, v4
    s_lshl_b32 s88, s85, 2
    s_add_u32 s88, s88, s75
    s_lshl_b32 s88, s88, 7
    s_add_u32 s88, s88, 0x5100400
    buffer_load_dwordx2 v[4:5], v11, s[8:11], s88 offen sc1
    buffer_load_dword v6, off, s[12:15], 0 offset:64 sc1
    s_mov_b32 s92, 0
    s_cbranch_vccnz aw_b_94
    s_cmp_ge_u32 s85, 15
    s_cbranch_scc1 aw_b_94
    s_lshl_b32 s87, s86, 2
    s_add_u32 s87, s87, s75
    s_cmp_ge_u32 s86, 14
    s_cselect_b32 s88, 1, 3
    s_add_u32 s88, s88, s87
    s_cmp_ge_u32 s91, s88
    s_cbranch_scc1 aw_b_94
    s_add_u32 s87, s85, 1
    s_cmp_eq_u32 s86, s87
    s_cbranch_scc1 aw_b_94
    s_mov_b32 s92, 1
    s_lshl_b32 s90, s85, 2
    s_add_u32 s90, s90, s75
    s_add_u32 s90, s90, 4
    s_lshl_b32 s90, s90, 18
    s_add_u32 s90, s90, s93
    s_waitcnt vmcnt(19)
    v_mfma_f32_32x32x16_bf16 v[16:31], v[128:131], v[48:51], 0
    v_mfma_f32_32x32x16_bf16 v[32:47], v[192:195], v[48:51], 0
    buffer_load_dwordx4 v[48:51], v8, s[8:11], s90 offen offset:0 sc1
    s_waitcnt vmcnt(19)
    v_mfma_f32_32x32x16_bf16 v[16:31], v[132:135], v[52:55], v[16:31]
    v_mfma_f32_32x32x16_bf16 v[32:47], v[196:199], v[52:55], v[32:47]
    buffer_load_dwordx4 v[52:55], v8, s[8:11], s90 offen offset:1024 sc1
    s_waitcnt vmcnt(19)
    v_mfma_f32_32x32x16_bf16 v[16:31], v[136:139], v[56:59], v[16:31]
    v_mfma_f32_32x32x16_bf16 v[32:47], v[200:203], v[56:59], v[32:47]
    buffer_load_dwordx4 v[56:59], v8, s[8:11], s90 offen offset:2048 sc1
    s_waitcnt vmcnt(19)
    v_mfma_f32_32x32x16_bf16 v[16:31], v[140:143], v[60:63], v[16:31]
    v_mfma_f32_32x32x16_bf16 v[32:47], v[204:207], v[60:63], v[32:47]
    buffer_load_dwordx4 v[60:63], v8, s[8:11], s90 offen offset:3072 sc1
    s_waitcnt vmcnt(19)
    v_mfma_f32_32x32x16_bf16 v[16:31], v[144:147], v[64:67], v[16:31]
    v_mfma_f32_32x32x16_bf16 v[32:47], v[208:211], v[64:67], v[32:47]
    s_add_u32 s90, s90, 4096
    buffer_load_dwordx4 v[64:67], v8, s[8:11], s90 offen offset:0 sc1
    s_waitcnt vmcnt(19)
    v_mfma_f32_32x32x16_bf16 v[16:31], v[148:151], v[68:71], v[16:31]
    v_mfma_f32_32x32x16_bf16 v[32:47], v[212:215], v[68:71], v[32:47]
    buffer_load_dwordx4 v[68:71], v8, s[8:11], s90 offen offset:1024 sc1
    s_waitcnt vmcnt(19)
    v_mfma_f32_32x32x16_bf16 v[16:31], v[152:155], v[72:75], v[16:31]
    v_mfma_f32_32x32x16_bf16 v[32:47], v[216:219], v[72:75], v[32:47]
    buffer_load_dwordx4 v[72:75], v8, s[8:11], s90 offen offset:2048 sc1
    s_waitcnt vmcnt(19)
    v_mfma_f32_32x32x16_bf16 v[16:31], v[156:159], v[76:79], v[16:31]
    v_mfma_f32_32x32x16_bf16 v[32:47], v[220:223], v[76:79], v[32:47]
    buffer_load_dwordx4 v[76:79], v8, s[8:11], s90 offen offset:3072 sc1
    s_waitcnt vmcnt(19)
    v_mfma_f32_32x32x16_bf16 v[16:31], v[160:163], v[80:83], v[16:31]
    v_mfma_f32_32x32x16_bf16 v[32:47], v[224:227], v[80:83], v[32:47]
    s_add_u32 s90, s90, 4096
    buffer_load_dwordx4 v[80:83], v8, s[8:11], s90 offen offset:0 sc1
    s_waitcnt vmcnt(19)
    v_mfma_f32_32x32x16_bf16 v[16:31], v[164:167], v[84:87], v[16:31]
    v_mfma_f32_32x32x16_bf16 v[32:47], v[228:231], v[84:87], v[32:47]
    buffer_load_dwordx4 v[84:87], v8, s[8:11], s90 offen offset:1024 sc1
    s_waitcnt vmcnt(19)
    v_mfma_f32_32x32x16_bf16 v[16:31], v[168:171], v[88:91], v[16:31]
    v_mfma_f32_32x32x16_bf16 v[32:47], v[232:235], v[88:91], v[32:47]
    buffer_load_dwordx4 v[88:91], v8, s[8:11], s90 offen offset:2048 sc1
    s_waitcnt vmcnt(19)
    v_mfma_f32_32x32x16_bf16 v[16:31], v[172:175], v[92:95], v[16:31]
    v_mfma_f32_32x32x16_bf16 v[32:47], v[236:239], v[92:95], v[32:47]
    buffer_load_dwordx4 v[92:95], v8, s[8:11], s90 offen offset:3072 sc1
    s_waitcnt vmcnt(19)
    v_mfma_f32_32x32x16_bf16 v[16:31], v[176:179], v[96:99], v[16:31]
    v_mfma_f32_32x32x16_bf16 v[32:47], v[240:243], v[96:99], v[32:47]
    s_add_u32 s90, s90, 4096
    buffer_load_dwordx4 v[96:99], v8, s[8:11], s90 offen offset:0 sc1
    s_waitcnt vmcnt(19)
    v_mfma_f32_32x32x16_bf16 v[16:31], v[180:183], v[100:103], v[16:31]
    v_mfma_f32_32x32x16_bf16 v[32:47], v[244:247], v[100:103], v[32:47]
    buffer_load_dwordx4 v[100:103], v8, s[8:11], s90 offen offset:1024 sc1
    s_waitcnt vmcnt(19)
    v_mfma_f32_32x32x16_bf16 v[16:31], v[184:187], v[104:107], v[16:31]
    v_mfma_f32_32x32x16_bf16 v[32:47], v[248:251], v[104:107], v[32:47]
    buffer_load_dwordx4 v[104:107], v8, s[8:11], s90 offen offset:2048 sc1
    s_waitcnt vmcnt(19)
    v_mfma_f32_32x32x16_bf16 v[16:31], v[188:191], v[108:111], v[16:31]
    v_mfma_f32_32x32x16_bf16 v[32:47], v[252:255], v[108:111], v[32:47]
    buffer_load_dwordx4 v[108:111], v8, s[8:11], s90 offen offset:3072 sc1
    s_branch aw_red_95
aw_b_94:
    s_waitcnt vmcnt(19)
    v_mfma_f32_32x32x16_bf16 v[16:31], v[128:131], v[48:51], 0
    v_mfma_f32_32x32x16_bf16 v[32:47], v[192:195], v[48:51], 0
    s_waitcnt vmcnt(18)
    v_mfma_f32_32x32x16_bf16 v[16:31], v[132:135], v[52:55], v[16:31]
    v_mfma_f32_32x32x16_bf16 v[32:47], v[196:199], v[52:55], v[32:47]
    s_waitcnt vmcnt(17)
    v_mfma_f32_32x32x16_bf16 v[16:31], v[136:139], v[56:59], v[16:31]
    v_mfma_f32_32x32x16_bf16 v[32:47], v[200:203], v[56:59], v[32:47]
    s_waitcnt vmcnt(16)
    v_mfma_f32_32x32x16_bf16 v[16:31], v[140:143], v[60:63], v[16:31]
    v_mfma_f32_32x32x16_bf16 v[32:47], v[204:207], v[60:63], v[32:47]
    s_waitcnt vmcnt(15)
    v_mfma_f32_32x32x16_bf16 v[16:31], v[144:147], v[64:67], v[16:31]
    v_mfma_f32_32x32x16_bf16 v[32:47], v[208:211], v[64:67], v[32:47]
    s_waitcnt vmcnt(14)
    v_mfma_f32_32x32x16_bf16 v[16:31], v[148:151], v[68:71], v[16:31]
    v_mfma_f32_32x32x16_bf16 v[32:47], v[212:215], v[68:71], v[32:47]
    s_waitcnt vmcnt(13)
    v_mfma_f32_32x32x16_bf16 v[16:31], v[152:155], v[72:75], v[16:31]
    v_mfma_f32_32x32x16_bf16 v[32:47], v[216:219], v[72:75], v[32:47]
    s_waitcnt vmcnt(12)
    v_mfma_f32_32x32x16_bf16 v[16:31], v[156:159], v[76:79], v[16:31]
    v_mfma_f32_32x32x16_bf16 v[32:47], v[220:223], v[76:79], v[32:47]
    s_waitcnt vmcnt(11)
    v_mfma_f32_32x32x16_bf16 v[16:31], v[160:163], v[80:83], v[16:31]
    v_mfma_f32_32x32x16_bf16 v[32:47], v[224:227], v[80:83], v[32:47]
    s_waitcnt vmcnt(10)
    v_mfma_f32_32x32x16_bf16 v[16:31], v[164:167], v[84:87], v[16:31]
    v_mfma_f32_32x32x16_bf16 v[32:47], v[228:231], v[84:87], v[32:47]
    s_waitcnt vmcnt(9)
    v_mfma_f32_32x32x16_bf16 v[16:31], v[168:171], v[88:91], v[16:31]
    v_mfma_f32_32x32x16_bf16 v[32:47], v[232:235], v[88:91], v[32:47]
    s_waitcnt vmcnt(8)
    v_mfma_f32_32x32x16_bf16 v[16:31], v[172:175], v[92:95], v[16:31]
    v_mfma_f32_32x32x16_bf16 v[32:47], v[236:239], v[92:95], v[32:47]
    s_waitcnt vmcnt(7)
    v_mfma_f32_32x32x16_bf16 v[16:31], v[176:179], v[96:99], v[16:31]
    v_mfma_f32_32x32x16_bf16 v[32:47], v[240:243], v[96:99], v[32:47]
    s_waitcnt vmcnt(6)
    v_mfma_f32_32x32x16_bf16 v[16:31], v[180:183], v[100:103], v[16:31]
    v_mfma_f32_32x32x16_bf16 v[32:47], v[244:247], v[100:103], v[32:47]
    s_waitcnt vmcnt(5)
    v_mfma_f32_32x32x16_bf16 v[16:31], v[184:187], v[104:107], v[16:31]
    v_mfma_f32_32x32x16_bf16 v[32:47], v[248:251], v[104:107], v[32:47]
    s_waitcnt vmcnt(4)
    v_mfma_f32_32x32x16_bf16 v[16:31], v[188:191], v[108:111], v[16:31]
    v_mfma_f32_32x32x16_bf16 v[32:47], v[252:255], v[108:111], v[32:47]
    s_waitcnt vmcnt(0)
    v_readfirstlane_b32 s91, v6
aw_red_95:
    s_and_b32 s88, s85, 1
    s_mul_i32 s88, s88, 67584
    v_add_u32 v2, s88, v12
    v_add_u32 v3, s88, v13
    s_nop 4
    ds_write_b128 v2, v[16:19] offset:0
    ds_write_b128 v2, v[20:23] offset:1056
    ds_write_b128 v2, v[24:27] offset:2112
    ds_write_b128 v2, v[28:31] offset:3168
    ds_write_b128 v2, v[32:35] offset:4224
    ds_write_b128 v2, v[36:39] offset:5280
    ds_write_b128 v2, v[40:43] offset:6336
    ds_write_b128 v2, v[44:47] offset:7392
    s_waitcnt lgkmcnt(0)
    s_barrier
    ds_read_b64 v[16:17], v3 offset:0
    ds_read_b64 v[18:19], v3 offset:8448
    ds_read_b64 v[20:21], v3 offset:16896
    ds_read_b64 v[22:23], v3 offset:25344
    ds_read_b64 v[24:25], v3 offset:33792
    ds_read_b64 v[26:27], v3 offset:42240
    ds_read_b64 v[28:29], v3 offset:50688
    ds_read_b64 v[30:31], v3 offset:59136
    ds_read_b64 v[32:33], v3 offset:32
    ds_read_b64 v[34:35], v3 offset:8480
    ds_read_b64 v[36:37], v3 offset:16928
    ds_read_b64 v[38:39], v3 offset:25376
    ds_read_b64 v[40:41], v3 offset:33824
    ds_read_b64 v[42:43], v3 offset:42272
    ds_read_b64 v[44:45], v3 offset:50720
    ds_read_b64 v[46:47], v3 offset:59168
    s_lshl_b32 s87, s85, 2
    s_add_u32 s87, s87, s75
    s_lshl_b32 s87, s87, 17
    s_add_u32 s88, s87, 8192
    s_waitcnt lgkmcnt(8)
    v_pk_add_f32 v[16:17], v[16:17], v[24:25]
    v_pk_add_f32 v[18:19], v[18:19], v[26:27]
    v_pk_add_f32 v[20:21], v[20:21], v[28:29]
    v_pk_add_f32 v[22:23], v[22:23], v[30:31]
    v_pk_add_f32 v[16:17], v[16:17], v[20:21]
    v_pk_add_f32 v[18:19], v[18:19], v[22:23]
    v_pk_add_f32 v[16:17], v[16:17], v[18:19]
    v_cvt_pk_bf16_f32 v2, v16, v17
    buffer_atomic_pk_add_bf16 v2, v14, s[16:19], s87 offen
    s_waitcnt lgkmcnt(0)
    v_pk_add_f32 v[32:33], v[32:33], v[40:41]
    v_pk_add_f32 v[34:35], v[34:35], v[42:43]
    v_pk_add_f32 v[36:37], v[36:37], v[44:45]
    v_pk_add_f32 v[38:39], v[38:39], v[46:47]
    v_pk_add_f32 v[32:33], v[32:33], v[36:37]
    v_pk_add_f32 v[34:35], v[34:35], v[38:39]
    v_pk_add_f32 v[32:33], v[32:33], v[34:35]
    v_cvt_pk_bf16_f32 v3, v32, v33
    buffer_atomic_pk_add_bf16 v3, v14, s[16:19], s88 offen
    s_add_u32 s85, s85, 1
    s_cmp_lt_u32 s85, 16
    s_cbranch_scc1 aw_loop_82
    s_waitcnt vmcnt(0)
    s_endpgm
.section .rodata,"a"
.p2align 6
.amdhsa_kernel concat_heads__spectral_gfnet__memory_aug_recurrent_mem_tr__prompt_kernel
  .amdhsa_next_free_vgpr 256
  .amdhsa_next_free_sgpr 102
  .amdhsa_accum_offset 256
  .amdhsa_group_segment_fixed_size 0
  .amdhsa_kernarg_size 104
  .amdhsa_user_sgpr_count 2
  .amdhsa_user_sgpr_kernarg_segment_ptr 1
  .amdhsa_system_sgpr_workgroup_id_x 1
  .amdhsa_float_denorm_mode_32 3
  .amdhsa_float_denorm_mode_16_64 3
.end_amdhsa_kernel
```

```asm
; @launch grid=(256,1,1) block=(512,1,1) lds=163840
.amdgcn_target "amdgcn-amd-amdhsa--gfx950"
.text
.globl concat_heads__spectral_gfnet__memory_aug_recurrent_mem_tr__prompt_kernel
.p2align 8
.type concat_heads__spectral_gfnet__memory_aug_recurrent_mem_tr__prompt_kernel,@function
concat_heads__spectral_gfnet__memory_aug_recurrent_mem_tr__prompt_kernel:
    s_load_dwordx2 s[8:9], s[0:1], 96
    s_load_dwordx2 s[12:13], s[0:1], 88
    s_load_dwordx2 s[16:17], s[0:1], 80
    s_load_dwordx2 s[20:21], s[0:1], 40
    s_load_dwordx2 s[24:25], s[0:1], 48
    s_load_dwordx2 s[28:29], s[0:1], 56
    s_load_dwordx2 s[32:33], s[0:1], 64
    s_load_dwordx2 s[36:37], s[0:1], 24
    s_load_dwordx2 s[40:41], s[0:1], 32
    s_load_dwordx2 s[44:45], s[0:1], 0
    s_load_dwordx2 s[48:49], s[0:1], 8
    s_load_dwordx2 s[52:53], s[0:1], 16
    s_mov_b32 s10, 0x10000000
    s_mov_b32 s11, 0x20000
    s_mov_b32 s14, 0x100
    s_mov_b32 s15, 0x20000
    s_mov_b32 s18, 0x800000
    s_mov_b32 s19, 0x20000
    s_mov_b32 s22, 0x800000
    s_mov_b32 s23, 0x20000
    s_mov_b32 s26, 0x800000
    s_mov_b32 s27, 0x20000
    s_mov_b32 s30, 0x800000
    s_mov_b32 s31, 0x20000
    s_mov_b32 s34, 0x800000
    s_mov_b32 s35, 0x20000
    s_mov_b32 s38, 0x400000
    s_mov_b32 s39, 0x20000
    s_mov_b32 s42, 0x4000
    s_mov_b32 s43, 0x20000
    s_mov_b32 s46, 0x400000
    s_mov_b32 s47, 0x20000
    s_mov_b32 s50, 0x201000
    s_mov_b32 s51, 0x20000
    s_mov_b32 s54, 0x201000
    s_mov_b32 s55, 0x20000
    s_waitcnt lgkmcnt(0)
    s_getreg_b32 s56, hwreg(HW_REG_XCC_ID, 0, 3)
    v_lshrrev_b32 v2, 6, v0
    v_and_b32 v1, 63, v0
    v_readfirstlane_b32 s58, v2
    s_nop 0
    s_cmp_lg_u32 s58, 0
    s_cbranch_scc1 notw0_1
    s_lshl_b32 s57, s56, 5
    s_add_u32 s57, s57, 28
    v_mov_b32 v2, s57
    v_mov_b32 v3, 0x5ffffff0
    v_cmp_eq_u32 vcc, 0, v1
    s_nop 1
    v_cndmask_b32 v2, v3, v2, vcc
    v_mov_b32 v3, 1
    buffer_atomic_add v3, v2, s[12:15], 0 offen sc0 sc1
    v_mov_b32 v4, 0x27ff0
    s_waitcnt vmcnt(0)
    v_readfirstlane_b32 s3, v3
    s_nop 1
    v_mov_b32 v3, s3
    ds_write_b32 v4, v3
    s_waitcnt lgkmcnt(0)
notw0_1:
    s_barrier
    v_mov_b32 v4, 0x27ff0
    ds_read_b32 v3, v4
    s_waitcnt lgkmcnt(0)
    v_readfirstlane_b32 s57, v3
    s_nop 0
    s_cmp_lt_u32 s57, 32
    s_cbranch_scc1 go_3
    s_endpgm
go_3:
    s_cmp_ge_u32 s56, 4
    s_cbranch_scc1 bulk_2
    s_and_b32 s64, s57, 3
    s_lshr_b32 s65, s57, 2
    s_lshl_b32 s66, s56, 3
    s_add_u32 s66, s66, s65
    s_and_b32 s67, s58, 3
    s_mov_b32 s69, 0x40000
    v_and_b32 v6, 15, v1
    v_lshlrev_b32 v8, 4, v1
    v_mov_b32 v14, -1
    v_mov_b32 v15, -1
    v_mov_b32 v16, -1
    v_mov_b32 v17, -1
    s_mov_b32 s86, 0
    s_mov_b32 s87, 0
    s_mov_b32 s88, 0
    s_mov_b32 s89, 0
    s_mov_b32 s90, 0
    s_mov_b32 s91, 0
    s_mov_b32 s92, 0
    s_mov_b32 s93, 0
    s_mov_b32 s94, 0
    s_mov_b32 s95, 0
    s_mov_b32 s96, 0
    s_mov_b32 s97, 0
    s_mov_b32 s98, 0
    v_mov_b32 v2, 0x4444
    v_mov_b32 v3, 0xeeee
    v_and_b32 v4, 2, v1
    v_cmp_eq_u32 vcc, 0, v4
    s_nop 1
    v_cndmask_b32 v7, v3, v2, vcc
    v_bfe_u32 v36, v1, 0, 2
    v_lshlrev_b32 v36, 4, v36
    v_bfe_u32 v2, v1, 5, 1
    v_lshl_or_b32 v36, v2, 6, v36
    v_bfe_u32 v2, v1, 2, 2
    v_lshl_or_b32 v36, v2, 10, v36
    v_bfe_u32 v2, v1, 4, 1
    v_lshl_or_b32 v36, v2, 12, v36
    s_lshl_b32 s70, s56, 2
    s_add_u32 s70, s70, s64
    s_lshl_b32 s70, s70, 15
    s_add_u32 s70, s70, 0x4a00000
    s_lshl_b32 s71, s65, 2
    s_add_u32 s71, s71, s67
    s_lshl_b32 s72, s71, 10
    s_add_u32 s78, s70, s72
    s_lshl_b32 s72, s67, 13
    s_add_u32 s79, s70, s72
    s_lshl_b32 s72, s65, 7
    s_add_u32 s79, s79, s72
    s_bfe_u32 s77, s71, 0x20001
    s_lshl_b32 s77, s77, 7
    s_bfe_u32 s72, s71, 0x10000
    s_lshl_b32 s72, s72, 11
    s_or_b32 s77, s77, s72
    s_bfe_u32 s72, s71, 0x10003
    s_lshl_b32 s72, s72, 12
    s_or_b32 s77, s77, s72
    s_bfe_u32 s72, s71, 0x10004
    s_lshl_b32 s72, s72, 14
    s_or_b32 s77, s77, s72
    s_lshl_b32 s72, s56, 9
    s_add_u32 s77, s77, s72
    s_bfe_u32 s76, s58, 0x10000
    s_lshl_b32 s76, s76, 12
    s_bfe_u32 s72, s58, 0x10001
    s_lshl_b32 s72, s72, 14
    s_or_b32 s76, s76, s72
    s_lshl_b32 s72, s64, 15
    s_add_u32 s76, s76, s72
    s_add_u32 s72, s72, 0x20000
    s_add_u32 s77, s77, s72
    s_sub_u32 s7, 0, s8
    s_and_b32 s7, s7, 0x1fffff
    s_add_u32 s7, s7, 0x6c00000
    v_bfe_u32 v37, v1, 0, 2
    v_lshlrev_b32 v37, 4, v37
    v_bfe_u32 v2, v1, 4, 1
    v_lshl_or_b32 v37, v2, 6, v37
    v_bfe_u32 v2, v1, 2, 2
    v_lshl_or_b32 v37, v2, 7, v37
    v_bfe_u32 v2, v1, 5, 1
    v_lshl_or_b32 v37, v2, 9, v37
    v_add_u32 v37, s7, v37
    v_mov_b32 v5, 0x5ffffff0
    v_add_u32 v3, s7, v8
    v_cmp_gt_u32 vcc, 8, v1
    s_nop 1
    v_cndmask_b32 v35, v5, v3, vcc
    s_lshl_b32 s70, s66, 2
    s_add_u32 s70, s70, s67
    s_lshl_b32 s74, s70, 11
    s_add_u32 s74, s74, 0x4900000
    s_cmp_ge_u32 s58, 4
    s_cbranch_scc1 vo_arm_4
    s_lshl_b32 s73, s70, 12
    s_add_u32 s73, s73, 0x4800000
    s_lshl_b32 s71, s64, 10
    v_add_u32 v34, s71, v8
    s_add_u32 s71, s73, 0x80000
    buffer_store_dwordx4 v[14:17], v34, s[8:11], s73 offen
    buffer_store_dwordx4 v[14:17], v34, s[8:11], s71 offen
    v_bfe_u32 v2, v1, 0, 3
    v_lshlrev_b32 v2, 4, v2
    v_bfe_u32 v3, v1, 3, 1
    v_lshl_or_b32 v2, v3, 13, v2
    v_bfe_u32 v3, v1, 4, 2
    v_lshl_or_b32 v2, v3, 17, v2
    v_add_u32 v2, s7, v2
    buffer_store_dwordx4 v[14:17], v2, s[8:11], s77 offen sc1
    s_add_u32 s77, s77, 0x80000
    s_branch arm_done_5
vo_arm_4:
    s_mov_b32 s73, s74
    v_bfe_u32 v34, v1, 0, 4
    v_lshlrev_b32 v34, 4, v34
    v_bfe_u32 v2, v1, 5, 1
    v_lshl_or_b32 v34, v2, 8, v34
    v_bfe_u32 v2, v1, 4, 1
    v_lshl_or_b32 v34, v2, 10, v34
    s_bfe_u32 s71, s64, 0x10000
    s_lshl_b32 s71, s71, 3
    s_bfe_u32 s72, s64, 0x10001
    s_lshl_b32 s72, s72, 9
    s_or_b32 s71, s71, s72
    v_add_u32 v34, s71, v34
    s_add_u32 s71, s73, 0x40000
    buffer_store_dwordx2 v[14:15], v34, s[8:11], s73 offen
    buffer_store_dwordx2 v[14:15], v34, s[8:11], s71 offen
    s_add_u32 s71, s79, 0x80000
    buffer_store_dwordx4 v[14:17], v36, s[8:11], s79 offen
    buffer_store_dwordx4 v[14:17], v36, s[8:11], s71 offen
    s_add_u32 s2, s77, s7
    s_add_u32 s2, s2, 0x1c0000
    v_bfe_u32 v2, v1, 0, 2
    v_lshlrev_b32 v2, 21, v2
    v_bfe_u32 v3, v1, 2, 1
    v_lshl_or_b32 v2, v3, 13, v2
    s_cmp_lg_u32 s58, 4
    s_cbranch_scc1 arm_done_5
    buffer_store_dword v14, v2, s[8:11], s2 offen sc1
arm_done_5:
    v_bfe_u32 v2, v1, 0, 1
    v_lshlrev_b32 v2, 11, v2
    v_bfe_u32 v3, v1, 2, 2
    v_lshl_or_b32 v2, v3, 12, v2
    v_bfe_u32 v3, v1, 1, 1
    v_lshl_or_b32 v2, v3, 8, v2
    v_bfe_u32 v3, v1, 4, 2
    v_lshl_or_b32 v2, v3, 4, v2
    s_lshl_b32 s70, s64, 9
    s_lshl_b32 s71, s67, 6
    s_add_u32 s70, s70, s71
    buffer_load_dwordx4 v[10:13], v2, s[40:43], s70 offen
    v_bfe_u32 v2, v1, 4, 1
    v_lshlrev_b32 v2, 4, v2
    v_bfe_u32 v3, v1, 5, 1
    v_lshl_or_b32 v2, v3, 6, v2
    v_bfe_u32 v3, v1, 4, 2
    v_lshl_or_b32 v2, v3, 13, v2
    v_lshlrev_b32 v3, 4, v6
    v_xor_b32 v38, v2, v3
    v_xor_b32 v39, 0x80, v38
    v_bfe_u32 v2, v1, 5, 1
    v_lshlrev_b32 v2, 5, v2
    v_bfe_u32 v3, v1, 5, 1
    v_lshl_or_b32 v2, v3, 11, v2
    v_bfe_u32 v3, v1, 0, 5
    v_lshlrev_b32 v3, 4, v3
    v_xor_b32 v40, v2, v3
    s_lshl_b32 s71, s67, 6
    v_bfe_u32 v4, v1, 0, 1
    v_lshlrev_b32 v4, 3, v4
    v_bfe_u32 v2, v1, 2, 1
    v_lshl_or_b32 v4, v2, 4, v4
    v_bfe_u32 v2, v1, 1, 1
    v_lshl_or_b32 v4, v2, 5, v4
    v_bfe_u32 v2, v1, 5, 1
    v_lshl_or_b32 v4, v2, 7, v4
    v_bfe_u32 v2, v1, 2, 1
    v_lshl_or_b32 v4, v2, 8, v4
    v_bfe_u32 v2, v1, 4, 2
    v_lshl_or_b32 v4, v2, 10, v4
    v_bfe_u32 v2, v1, 3, 1
    v_lshl_or_b32 v4, v2, 15, v4
    s_lshl_b32 s70, s58, 13
    s_cmp_ge_u32 s58, 4
    s_cselect_b32 s70, 0, s70
    s_or_b32 s70, s70, s71
    v_xor_b32 v41, s70, v4
    v_bfe_u32 v4, v1, 0, 1
    v_lshlrev_b32 v4, 3, v4
    v_bfe_u32 v2, v1, 1, 1
    v_lshl_or_b32 v4, v2, 4, v4
    v_bfe_u32 v2, v1, 2, 1
    v_lshl_or_b32 v4, v2, 5, v4
    v_bfe_u32 v2, v1, 5, 1
    v_lshl_or_b32 v4, v2, 7, v4
    v_bfe_u32 v2, v1, 2, 1
    v_lshl_or_b32 v4, v2, 9, v4
    v_bfe_u32 v2, v1, 5, 1
    v_lshl_or_b32 v4, v2, 11, v4
    v_bfe_u32 v2, v1, 4, 1
    v_lshl_or_b32 v4, v2, 12, v4
    v_bfe_u32 v2, v1, 3, 1
    v_lshl_or_b32 v4, v2, 14, v4
    s_or_b32 s71, s71, 0x10000
    v_xor_b32 v42, s71, v4
    s_lshl_b32 s70, s64, 21
    s_lshl_b32 s71, s58, 18
    s_add_u32 s70, s70, s71
    s_lshl_b32 s71, s66, 8
    s_add_u32 s70, s70, s71
    s_lshl_b32 s71, s58, 13
    s_add_u32 s71, s71, 0
    s_mov_b32 m0, s71
    s_nop 0
    buffer_load_dwordx4 v38, s[24:27], s70 offen lds
    s_add_u32 s70, s70, 0x8000
    s_add_u32 s71, s71, 0x400
    s_mov_b32 m0, s71
    s_nop 0
    buffer_load_dwordx4 v38, s[24:27], s70 offen lds
    s_add_u32 s70, s70, 0x8000
    s_add_u32 s71, s71, 0x400
    s_mov_b32 m0, s71
    s_nop 0
    buffer_load_dwordx4 v39, s[24:27], s70 offen lds
    s_add_u32 s70, s70, 0x8000
    s_add_u32 s71, s71, 0x400
    s_mov_b32 m0, s71
    s_nop 0
    buffer_load_dwordx4 v39, s[24:27], s70 offen lds
    s_add_u32 s70, s70, 0x8000
    s_add_u32 s71, s71, 0x400
    s_mov_b32 m0, s71
    s_nop 0
    buffer_load_dwordx4 v38, s[24:27], s70 offen lds
    s_add_u32 s70, s70, 0x8000
    s_add_u32 s71, s71, 0x400
    s_mov_b32 m0, s71
    s_nop 0
    buffer_load_dwordx4 v38, s[24:27], s70 offen lds
    s_add_u32 s70, s70, 0x8000
    s_add_u32 s71, s71, 0x400
    s_mov_b32 m0, s71
    s_nop 0
    buffer_load_dwordx4 v39, s[24:27], s70 offen lds
    s_add_u32 s70, s70, 0x8000
    s_add_u32 s71, s71, 0x400
    s_mov_b32 m0, s71
    s_nop 0
    buffer_load_dwordx4 v39, s[24:27], s70 offen lds
    s_add_u32 s70, s70, 0x8000
    s_add_u32 s71, s71, 0x400
    s_lshl_b32 s70, s64, 21
    s_lshl_b32 s71, s58, 18
    s_add_u32 s70, s70, s71
    s_lshl_b32 s71, s66, 8
    s_add_u32 s70, s70, s71
    s_lshl_b32 s71, s58, 13
    s_add_u32 s71, s71, 65536
    s_mov_b32 m0, s71
    s_nop 0
    buffer_load_dwordx4 v38, s[28:31], s70 offen lds
    s_add_u32 s70, s70, 0x8000
    s_add_u32 s71, s71, 0x400
    s_mov_b32 m0, s71
    s_nop 0
    buffer_load_dwordx4 v38, s[28:31], s70 offen lds
    s_add_u32 s70, s70, 0x8000
    s_add_u32 s71, s71, 0x400
    s_mov_b32 m0, s71
    s_nop 0
    buffer_load_dwordx4 v39, s[28:31], s70 offen lds
    s_add_u32 s70, s70, 0x8000
    s_add_u32 s71, s71, 0x400
    s_mov_b32 m0, s71
    s_nop 0
    buffer_load_dwordx4 v39, s[28:31], s70 offen lds
    s_add_u32 s70, s70, 0x8000
    s_add_u32 s71, s71, 0x400
    s_mov_b32 m0, s71
    s_nop 0
    buffer_load_dwordx4 v38, s[28:31], s70 offen lds
    s_add_u32 s70, s70, 0x8000
    s_add_u32 s71, s71, 0x400
    s_mov_b32 m0, s71
    s_nop 0
    buffer_load_dwordx4 v38, s[28:31], s70 offen lds
    s_add_u32 s70, s70, 0x8000
    s_add_u32 s71, s71, 0x400
    s_mov_b32 m0, s71
    s_nop 0
    buffer_load_dwordx4 v39, s[28:31], s70 offen lds
    s_add_u32 s70, s70, 0x8000
    s_add_u32 s71, s71, 0x400
    s_mov_b32 m0, s71
    s_nop 0
    buffer_load_dwordx4 v39, s[28:31], s70 offen lds
    s_add_u32 s70, s70, 0x8000
    s_add_u32 s71, s71, 0x400
    s_cmp_lg_u32 s58, 4
    s_cbranch_scc1 novote_6
    s_waitcnt vmcnt(16)
    s_mov_b32 s3, 1
    s_mov_b32 s59, 0
    s_bitcmp1_b32 s57, 0
    s_cselect_b32 s60, -1, 1
    s_cselect_b32 s70, 0x2000, 0
    s_cselect_b32 s71, 0, 0x2000
    s_add_u32 s70, s70, s2
    s_add_u32 s71, s71, s2
    s_mov_b64 s[4:5], 0
    s_buffer_load_dword s4, s[8:11], s70
    s_buffer_load_dword s5, s[8:11], s71
    s_waitcnt lgkmcnt(1)
    s_sub_u32 s72, s4, s5
    s_waitcnt lgkmcnt(0)
    s_mul_i32 s72, s72, s60
    s_add_u32 s72, s72, 1
    s_min_u32 s72, s72, 2
    s_lshl_b32 s72, s72, 10
    s_add_u32 s3, s3, s72
    s_add_u32 s70, s70, 0x200000
    s_add_u32 s71, s71, 0x200000
    s_mov_b64 s[4:5], 0
    s_buffer_load_dword s4, s[8:11], s70
    s_buffer_load_dword s5, s[8:11], s71
    s_waitcnt lgkmcnt(1)
    s_sub_u32 s72, s4, s5
    s_waitcnt lgkmcnt(0)
    s_mul_i32 s72, s72, s60
    s_add_u32 s72, s72, 1
    s_min_u32 s72, s72, 2
    s_lshl_b32 s72, s72, 20
    s_add_u32 s3, s3, s72
    s_add_u32 s70, s70, 0x200000
    s_add_u32 s71, s71, 0x200000
    s_mov_b64 s[4:5], 0
    s_buffer_load_dword s4, s[8:11], s70
    s_buffer_load_dword s5, s[8:11], s71
    s_waitcnt lgkmcnt(1)
    s_sub_u32 s72, s4, s5
    s_waitcnt lgkmcnt(0)
    s_mul_i32 s72, s72, s60
    s_add_u32 s72, s72, 1
    s_min_u32 s72, s72, 2
    s_lshl_b32 s72, s72, 10
    s_add_u32 s59, s59, s72
    s_add_u32 s70, s70, 0x200000
    s_add_u32 s71, s71, 0x200000
    s_mov_b64 s[4:5], 0
    s_buffer_load_dword s4, s[8:11], s70
    s_buffer_load_dword s5, s[8:11], s71
    s_waitcnt lgkmcnt(1)
    s_sub_u32 s72, s4, s5
    s_waitcnt lgkmcnt(0)
    s_mul_i32 s72, s72, s60
    s_add_u32 s72, s72, 1
    s_min_u32 s72, s72, 2
    s_lshl_b32 s72, s72, 20
    s_add_u32 s59, s59, s72
    s_add_u32 s70, s70, 0x200000
    s_add_u32 s71, s71, 0x200000
novote_6:
    s_waitcnt vmcnt(0)
    s_barrier
    s_cmp_lg_u32 s58, 4
    s_cbranch_scc1 nosig_7
    v_mov_b32 v2, s3
    v_mov_b32 v3, s59
    v_cmp_eq_u32 vcc, 0, v1
    v_mov_b32 v5, 32
    v_mov_b32 v4, 0x5ffffff0
    v_cndmask_b32 v4, v4, v5, vcc
    buffer_atomic_add_x2 v[2:3], v4, s[12:15], 0 offen sc1
    s_waitcnt vmcnt(0)
nosig_7:
    s_cmp_ge_u32 s58, 4
    s_cbranch_scc1 skip_8
    v_xor_b32 v2, 0x0, v41
    v_xor_b32 v3, 0x40, v41
    ds_read_b64_tr_b16 v[192:193], v2 offset:0
    ds_read_b64_tr_b16 v[194:195], v3 offset:512
    ds_read_b64_tr_b16 v[196:197], v2 offset:4096
    ds_read_b64_tr_b16 v[198:199], v3 offset:4608
    v_xor_b32 v2, 0x2000, v41
    v_xor_b32 v3, 0x2040, v41
    ds_read_b64_tr_b16 v[200:201], v2 offset:0
    ds_read_b64_tr_b16 v[202:203], v3 offset:512
    ds_read_b64_tr_b16 v[204:205], v2 offset:4096
    ds_read_b64_tr_b16 v[206:207], v3 offset:4608
    v_xor_b32 v2, 0x4000, v41
    v_xor_b32 v3, 0x4040, v41
    ds_read_b64_tr_b16 v[208:209], v2 offset:0
    ds_read_b64_tr_b16 v[210:211], v3 offset:512
    ds_read_b64_tr_b16 v[212:213], v2 offset:4096
    ds_read_b64_tr_b16 v[214:215], v3 offset:4608
    v_xor_b32 v2, 0x6000, v41
    v_xor_b32 v3, 0x6040, v41
    ds_read_b64_tr_b16 v[216:217], v2 offset:0
    ds_read_b64_tr_b16 v[218:219], v3 offset:512
    ds_read_b64_tr_b16 v[220:221], v2 offset:4096
    ds_read_b64_tr_b16 v[222:223], v3 offset:4608
    s_waitcnt lgkmcnt(0)
    v_xor_b32 v2, 0x10, v41
    v_xor_b32 v3, 0x50, v41
    ds_read_b64_tr_b16 v[224:225], v2 offset:0
    ds_read_b64_tr_b16 v[226:227], v3 offset:512
    ds_read_b64_tr_b16 v[228:229], v2 offset:4096
    ds_read_b64_tr_b16 v[230:231], v3 offset:4608
    v_xor_b32 v2, 0x2010, v41
    v_xor_b32 v3, 0x2050, v41
    ds_read_b64_tr_b16 v[232:233], v2 offset:0
    ds_read_b64_tr_b16 v[234:235], v3 offset:512
    ds_read_b64_tr_b16 v[236:237], v2 offset:4096
    ds_read_b64_tr_b16 v[238:239], v3 offset:4608
    v_xor_b32 v2, 0x4010, v41
    v_xor_b32 v3, 0x4050, v41
    ds_read_b64_tr_b16 v[240:241], v2 offset:0
    ds_read_b64_tr_b16 v[242:243], v3 offset:512
    ds_read_b64_tr_b16 v[244:245], v2 offset:4096
    ds_read_b64_tr_b16 v[246:247], v3 offset:4608
    v_xor_b32 v2, 0x6010, v41
    v_xor_b32 v3, 0x6050, v41
    ds_read_b64_tr_b16 v[248:249], v2 offset:0
    ds_read_b64_tr_b16 v[250:251], v3 offset:512
    ds_read_b64_tr_b16 v[252:253], v2 offset:4096
    ds_read_b64_tr_b16 v[254:255], v3 offset:4608
    s_waitcnt lgkmcnt(0)
skip_8:
    s_cmp_ge_u32 s58, 4
    s_cbranch_scc0 skip_9
    v_xor_b32 v2, 0x10000, v41
    v_xor_b32 v3, 0x10040, v41
    ds_read_b64_tr_b16 v[128:129], v2 offset:0
    ds_read_b64_tr_b16 v[130:131], v3 offset:512
    ds_read_b64_tr_b16 v[132:133], v2 offset:4096
    ds_read_b64_tr_b16 v[134:135], v3 offset:4608
    v_xor_b32 v2, 0x12000, v41
    v_xor_b32 v3, 0x12040, v41
    ds_read_b64_tr_b16 v[136:137], v2 offset:0
    ds_read_b64_tr_b16 v[138:139], v3 offset:512
    ds_read_b64_tr_b16 v[140:141], v2 offset:4096
    ds_read_b64_tr_b16 v[142:143], v3 offset:4608
    v_xor_b32 v2, 0x14000, v41
    v_xor_b32 v3, 0x14040, v41
    ds_read_b64_tr_b16 v[144:145], v2 offset:0
    ds_read_b64_tr_b16 v[146:147], v3 offset:512
    ds_read_b64_tr_b16 v[148:149], v2 offset:4096
    ds_read_b64_tr_b16 v[150:151], v3 offset:4608
    v_xor_b32 v2, 0x16000, v41
    v_xor_b32 v3, 0x16040, v41
    ds_read_b64_tr_b16 v[152:153], v2 offset:0
    ds_read_b64_tr_b16 v[154:155], v3 offset:512
    ds_read_b64_tr_b16 v[156:157], v2 offset:4096
    ds_read_b64_tr_b16 v[158:159], v3 offset:4608
    s_waitcnt lgkmcnt(0)
    v_xor_b32 v2, 0x10010, v41
    v_xor_b32 v3, 0x10050, v41
    ds_read_b64_tr_b16 v[160:161], v2 offset:0
    ds_read_b64_tr_b16 v[162:163], v3 offset:512
    ds_read_b64_tr_b16 v[164:165], v2 offset:4096
    ds_read_b64_tr_b16 v[166:167], v3 offset:4608
    v_xor_b32 v2, 0x12010, v41
    v_xor_b32 v3, 0x12050, v41
    ds_read_b64_tr_b16 v[168:169], v2 offset:0
    ds_read_b64_tr_b16 v[170:171], v3 offset:512
    ds_read_b64_tr_b16 v[172:173], v2 offset:4096
    ds_read_b64_tr_b16 v[174:175], v3 offset:4608
    v_xor_b32 v2, 0x14010, v41
    v_xor_b32 v3, 0x14050, v41
    ds_read_b64_tr_b16 v[176:177], v2 offset:0
    ds_read_b64_tr_b16 v[178:179], v3 offset:512
    ds_read_b64_tr_b16 v[180:181], v2 offset:4096
    ds_read_b64_tr_b16 v[182:183], v3 offset:4608
    v_xor_b32 v2, 0x16010, v41
    v_xor_b32 v3, 0x16050, v41
    ds_read_b64_tr_b16 v[184:185], v2 offset:0
    ds_read_b64_tr_b16 v[186:187], v3 offset:512
    ds_read_b64_tr_b16 v[188:189], v2 offset:4096
    ds_read_b64_tr_b16 v[190:191], v3 offset:4608
    s_waitcnt lgkmcnt(0)
skip_9:
    s_barrier
    s_lshl_b32 s70, s64, 21
    s_lshl_b32 s71, s58, 18
    s_add_u32 s70, s70, s71
    s_lshl_b32 s71, s66, 8
    s_add_u32 s70, s70, s71
    s_lshl_b32 s71, s58, 13
    s_add_u32 s71, s71, 0
    s_mov_b32 m0, s71
    s_nop 0
    buffer_load_dwordx4 v38, s[20:23], s70 offen lds
    s_add_u32 s70, s70, 0x8000
    s_add_u32 s71, s71, 0x400
    s_mov_b32 m0, s71
    s_nop 0
    buffer_load_dwordx4 v38, s[20:23], s70 offen lds
    s_add_u32 s70, s70, 0x8000
    s_add_u32 s71, s71, 0x400
    s_mov_b32 m0, s71
    s_nop 0
    buffer_load_dwordx4 v39, s[20:23], s70 offen lds
    s_add_u32 s70, s70, 0x8000
    s_add_u32 s71, s71, 0x400
    s_mov_b32 m0, s71
    s_nop 0
    buffer_load_dwordx4 v39, s[20:23], s70 offen lds
    s_add_u32 s70, s70, 0x8000
    s_add_u32 s71, s71, 0x400
    s_mov_b32 m0, s71
    s_nop 0
    buffer_load_dwordx4 v38, s[20:23], s70 offen lds
    s_add_u32 s70, s70, 0x8000
    s_add_u32 s71, s71, 0x400
    s_mov_b32 m0, s71
    s_nop 0
    buffer_load_dwordx4 v38, s[20:23], s70 offen lds
    s_add_u32 s70, s70, 0x8000
    s_add_u32 s71, s71, 0x400
    s_mov_b32 m0, s71
    s_nop 0
    buffer_load_dwordx4 v39, s[20:23], s70 offen lds
    s_add_u32 s70, s70, 0x8000
    s_add_u32 s71, s71, 0x400
    s_mov_b32 m0, s71
    s_nop 0
    buffer_load_dwordx4 v39, s[20:23], s70 offen lds
    s_add_u32 s70, s70, 0x8000
    s_add_u32 s71, s71, 0x400
    s_lshl_b32 s70, s66, 18
    s_lshl_b32 s71, s58, 15
    s_add_u32 s70, s70, s71
    s_lshl_b32 s71, s64, 9
    s_add_u32 s70, s70, s71
    s_lshl_b32 s71, s58, 13
    s_add_u32 s71, s71, 65536
    s_mov_b32 m0, s71
    v_xor_b32 v2, 0, v40
    buffer_load_dwordx4 v2, s[32:35], s70 offen nt lds
    s_add_u32 s70, s70, 0x1000
    s_add_u32 s71, s71, 0x400
    s_mov_b32 m0, s71
    v_xor_b32 v2, 64, v40
    buffer_load_dwordx4 v2, s[32:35], s70 offen nt lds
    s_add_u32 s70, s70, 0x1000
    s_add_u32 s71, s71, 0x400
    s_mov_b32 m0, s71
    v_xor_b32 v2, 128, v40
    buffer_load_dwordx4 v2, s[32:35], s70 offen nt lds
    s_add_u32 s70, s70, 0x1000
    s_add_u32 s71, s71, 0x400
    s_mov_b32 m0, s71
    v_xor_b32 v2, 192, v40
    buffer_load_dwordx4 v2, s[32:35], s70 offen nt lds
    s_add_u32 s70, s70, 0x1000
    s_add_u32 s71, s71, 0x400
    s_mov_b32 m0, s71
    v_xor_b32 v2, 0, v40
    buffer_load_dwordx4 v2, s[32:35], s70 offen nt lds
    s_add_u32 s70, s70, 0x1000
    s_add_u32 s71, s71, 0x400
    s_mov_b32 m0, s71
    v_xor_b32 v2, 64, v40
    buffer_load_dwordx4 v2, s[32:35], s70 offen nt lds
    s_add_u32 s70, s70, 0x1000
    s_add_u32 s71, s71, 0x400
    s_mov_b32 m0, s71
    v_xor_b32 v2, 128, v40
    buffer_load_dwordx4 v2, s[32:35], s70 offen nt lds
    s_add_u32 s70, s70, 0x1000
    s_add_u32 s71, s71, 0x400
    s_mov_b32 m0, s71
    v_xor_b32 v2, 192, v40
    buffer_load_dwordx4 v2, s[32:35], s70 offen nt lds
    s_add_u32 s70, s70, 0x1000
    s_add_u32 s71, s71, 0x400
    s_waitcnt vmcnt(0)
    s_barrier
    s_cmp_ge_u32 s58, 4
    s_cbranch_scc1 skip_10
    v_xor_b32 v2, 0x0, v41
    v_xor_b32 v3, 0x40, v41
    ds_read_b64_tr_b16 v[128:129], v2 offset:0
    ds_read_b64_tr_b16 v[130:131], v3 offset:512
    ds_read_b64_tr_b16 v[132:133], v2 offset:4096
    ds_read_b64_tr_b16 v[134:135], v3 offset:4608
    v_xor_b32 v2, 0x2000, v41
    v_xor_b32 v3, 0x2040, v41
    ds_read_b64_tr_b16 v[136:137], v2 offset:0
    ds_read_b64_tr_b16 v[138:139], v3 offset:512
    ds_read_b64_tr_b16 v[140:141], v2 offset:4096
    ds_read_b64_tr_b16 v[142:143], v3 offset:4608
    v_xor_b32 v2, 0x4000, v41
    v_xor_b32 v3, 0x4040, v41
    ds_read_b64_tr_b16 v[144:145], v2 offset:0
    ds_read_b64_tr_b16 v[146:147], v3 offset:512
    ds_read_b64_tr_b16 v[148:149], v2 offset:4096
    ds_read_b64_tr_b16 v[150:151], v3 offset:4608
    v_xor_b32 v2, 0x6000, v41
    v_xor_b32 v3, 0x6040, v41
    ds_read_b64_tr_b16 v[152:153], v2 offset:0
    ds_read_b64_tr_b16 v[154:155], v3 offset:512
    ds_read_b64_tr_b16 v[156:157], v2 offset:4096
    ds_read_b64_tr_b16 v[158:159], v3 offset:4608
    s_waitcnt lgkmcnt(0)
    v_xor_b32 v2, 0x10, v41
    v_xor_b32 v3, 0x50, v41
    ds_read_b64_tr_b16 v[160:161], v2 offset:0
    ds_read_b64_tr_b16 v[162:163], v3 offset:512
    ds_read_b64_tr_b16 v[164:165], v2 offset:4096
    ds_read_b64_tr_b16 v[166:167], v3 offset:4608
    v_xor_b32 v2, 0x2010, v41
    v_xor_b32 v3, 0x2050, v41
    ds_read_b64_tr_b16 v[168:169], v2 offset:0
    ds_read_b64_tr_b16 v[170:171], v3 offset:512
    ds_read_b64_tr_b16 v[172:173], v2 offset:4096
    ds_read_b64_tr_b16 v[174:175], v3 offset:4608
    v_xor_b32 v2, 0x4010, v41
    v_xor_b32 v3, 0x4050, v41
    ds_read_b64_tr_b16 v[176:177], v2 offset:0
    ds_read_b64_tr_b16 v[178:179], v3 offset:512
    ds_read_b64_tr_b16 v[180:181], v2 offset:4096
    ds_read_b64_tr_b16 v[182:183], v3 offset:4608
    v_xor_b32 v2, 0x6010, v41
    v_xor_b32 v3, 0x6050, v41
    ds_read_b64_tr_b16 v[184:185], v2 offset:0
    ds_read_b64_tr_b16 v[186:187], v3 offset:512
    ds_read_b64_tr_b16 v[188:189], v2 offset:4096
    ds_read_b64_tr_b16 v[190:191], v3 offset:4608
    s_waitcnt lgkmcnt(0)
skip_10:
    s_cmp_ge_u32 s58, 4
    s_cbranch_scc0 skip_11
    v_xor_b32 v2, 0, v42
    v_xor_b32 v3, 64, v42
    ds_read_b64_tr_b16 v[192:193], v2 offset:0
    ds_read_b64_tr_b16 v[194:195], v3 offset:1024
    ds_read_b64_tr_b16 v[196:197], v2 offset:8192
    ds_read_b64_tr_b16 v[198:199], v3 offset:9216
    ds_read_b64_tr_b16 v[200:201], v2 offset:32768
    ds_read_b64_tr_b16 v[202:203], v3 offset:33792
    ds_read_b64_tr_b16 v[204:205], v2 offset:40960
    ds_read_b64_tr_b16 v[206:207], v3 offset:41984
    ds_read_b64_tr_b16 v[224:225], v2 offset:256
    ds_read_b64_tr_b16 v[226:227], v3 offset:1280
    ds_read_b64_tr_b16 v[228:229], v2 offset:8448
    ds_read_b64_tr_b16 v[230:231], v3 offset:9472
    ds_read_b64_tr_b16 v[232:233], v2 offset:33024
    ds_read_b64_tr_b16 v[234:235], v3 offset:34048
    ds_read_b64_tr_b16 v[236:237], v2 offset:41216
    ds_read_b64_tr_b16 v[238:239], v3 offset:42240
    s_waitcnt lgkmcnt(0)
    v_xor_b32 v2, 32, v42
    v_xor_b32 v3, 96, v42
    ds_read_b64_tr_b16 v[208:209], v2 offset:0
    ds_read_b64_tr_b16 v[210:211], v3 offset:1024
    ds_read_b64_tr_b16 v[212:213], v2 offset:8192
    ds_read_b64_tr_b16 v[214:215], v3 offset:9216
    ds_read_b64_tr_b16 v[216:217], v2 offset:32768
    ds_read_b64_tr_b16 v[218:219], v3 offset:33792
    ds_read_b64_tr_b16 v[220:221], v2 offset:40960
    ds_read_b64_tr_b16 v[222:223], v3 offset:41984
    ds_read_b64_tr_b16 v[240:241], v2 offset:256
    ds_read_b64_tr_b16 v[242:243], v3 offset:1280
    ds_read_b64_tr_b16 v[244:245], v2 offset:8448
    ds_read_b64_tr_b16 v[246:247], v3 offset:9472
    ds_read_b64_tr_b16 v[248:249], v2 offset:33024
    ds_read_b64_tr_b16 v[250:251], v3 offset:34048
    ds_read_b64_tr_b16 v[252:253], v2 offset:41216
    ds_read_b64_tr_b16 v[254:255], v3 offset:42240
    s_waitcnt lgkmcnt(0)
skip_11:
    v_mov_b32 v4, 0x27ff0
    s_cmp_lg_u32 s58, 4
    s_cbranch_scc1 armw_12
armwait_13:
    buffer_load_dwordx2 v[2:3], off, s[12:15], 0 offset:32 sc1
    s_waitcnt vmcnt(0)
    v_and_b32 v5, 0x3ff, v2
    v_cmp_gt_u32 vcc, 128, v5
    s_cbranch_vccz armwait_ok_14
    s_sub_u32 s69, s69, 1
    s_cbranch_scc0 armwait_13
    s_mov_b32 s69, 0
armwait_ok_14:
    ds_write_b64 v4, v[2:3]
    s_waitcnt lgkmcnt(0)
armw_12:
    s_barrier
    ds_read_b64 v[2:3], v4
    s_mov_b32 s59, 0
    s_waitcnt lgkmcnt(0)
    v_readfirstlane_b32 s70, v2
    v_readfirstlane_b32 s71, v3
    s_bfe_u32 s72, s70, 0xa000a
    s_cmp_gt_u32 s72, 128
    s_cselect_b32 s72, 1, 0
    s_or_b32 s59, s59, s72
    s_bfe_u32 s72, s70, 0xa0014
    s_cmp_gt_u32 s72, 128
    s_cselect_b32 s72, 2, 0
    s_or_b32 s59, s59, s72
    s_bfe_u32 s72, s71, 0xa000a
    s_cmp_gt_u32 s72, 128
    s_cselect_b32 s72, 4, 0
    s_or_b32 s59, s59, s72
    s_bfe_u32 s72, s71, 0xa0014
    s_cmp_gt_u32 s72, 128
    s_cselect_b32 s72, 8, 0
    s_or_b32 s59, s59, s72
    s_and_b32 s70, s59, 1
    s_lshl_b32 s70, s70, 13
    s_add_u32 s77, s77, s70
    s_add_u32 s76, s76, s70
    s_mov_b32 s68, 0
    s_mov_b32 s82, 0
    s_lshl_b32 s80, s66, 11
    s_lshl_b32 s70, s67, 9
    s_add_u32 s80, s80, s70
    s_cmp_ge_u32 s58, 4
    s_cbranch_scc1 vo_main_15
    s_setprio 3
    v_bfe_u32 v111, v1, 0, 3
    v_lshlrev_b32 v111, 4, v111
    v_bfe_u32 v2, v1, 3, 1
    v_lshl_or_b32 v111, v2, 8, v111
    v_bfe_u32 v2, v1, 4, 2
    v_lshl_or_b32 v111, v2, 9, v111
    s_lshl_b32 s75, s66, 13
    s_lshl_b32 s70, s67, 11
    s_add_u32 s75, s75, s70
    s_add_u32 s75, s75, 0x1000000
    s_add_u32 s78, s70, 13312
    v_mov_b32 v113, 128
    s_mov_b32 s2, 128
    s_lshl_b32 s70, s66, 4
    s_lshl_b32 s71, s64, 2
    s_add_u32 s71, s71, s67
    s_add_u32 s3, s70, s71
    s_lshl_b32 s6, s71, 19
    s_lshl_b32 s70, s66, 13
    s_add_u32 s6, s6, s70
    s_add_u32 s6, s6, 0x6000000
    v_bfe_u32 v114, v1, 2, 2
    v_lshlrev_b32 v114, 5, v114
    v_bfe_u32 v2, v1, 5, 1
    v_lshl_or_b32 v114, v2, 7, v114
    v_bfe_u32 v2, v1, 2, 2
    v_lshl_or_b32 v114, v2, 9, v114
    v_bfe_u32 v2, v1, 5, 1
    v_lshl_or_b32 v114, v2, 11, v114
    v_bfe_u32 v3, v1, 0, 1
    v_lshlrev_b32 v3, 3, v3
    v_bfe_u32 v2, v1, 1, 1
    v_lshl_or_b32 v3, v2, 4, v3
    v_bfe_u32 v2, v1, 4, 1
    v_lshl_or_b32 v3, v2, 5, v3
    v_xor_b32 v114, v114, v3
    s_lshl_b32 s70, s67, 7
    s_or_b32 s70, s70, 0x10000
    v_xor_b32 v114, s70, v114
    s_add_u32 s80, s80, 0x4000000
    s_lshl_b32 s70, s67, 10
    v_add_u32 v108, s70, v8
    v_lshrrev_b32 v109, 2, v108
    v_bfe_u32 v2, v1, 0, 3
    v_lshlrev_b32 v2, 4, v2
    v_bfe_u32 v3, v1, 4, 2
    v_lshl_or_b32 v2, v3, 7, v2
    v_mov_b32 v3, 0x5ffffff0
    v_cmp_le_u32 vcc, 8, v6
    s_nop 1
    v_cndmask_b32 v110, v3, v2, vcc
    v_xor_b32 v106, 1024, v108
    v_xor_b32 v107, 2048, v108
    v_xor_b32 v36, 3072, v108
    v_xor_b32 v116, 0x400, v34
    v_bfe_u32 v115, v1, 0, 4
    v_lshlrev_b32 v115, 4, v115
    v_bfe_u32 v2, v1, 4, 2
    v_lshl_or_b32 v115, v2, 9, v115
    s_lshl_b32 s70, s64, 10
    s_xor_b32 s70, s70, 0x800
    v_xor_b32 v115, s70, v115
    v_and_b32 v2, 1, v1
    v_lshlrev_b32 v2, 4, v2
    v_mov_b32 v3, 0x3f80
    v_lshlrev_b32 v2, v2, v3
    v_bfe_u32 v3, v1, 1, 1
    v_bfe_u32 v4, v1, 3, 1
    v_lshl_or_b32 v3, v4, 1, v3
    v_bfe_u32 v4, v1, 2, 1
    v_lshl_or_b32 v3, v4, 2, v3
    v_bfe_u32 v4, v1, 4, 1
    v_lshlrev_b32 v4, 2, v4
    v_xor_b32 v3, v3, v4
    v_cmp_eq_u32 vcc, 0, v3
    s_nop 1
    v_cndmask_b32 v26, 0, v2, vcc
    v_cmp_eq_u32 vcc, 1, v3
    s_nop 1
    v_cndmask_b32 v27, 0, v2, vcc
    v_cmp_eq_u32 vcc, 2, v3
    s_nop 1
    v_cndmask_b32 v28, 0, v2, vcc
    v_cmp_eq_u32 vcc, 3, v3
    s_nop 1
    v_cndmask_b32 v29, 0, v2, vcc
    v_bfe_u32 v3, v1, 1, 1
    v_bfe_u32 v4, v1, 3, 1
    v_lshl_or_b32 v3, v4, 1, v3
    v_bfe_u32 v4, v1, 4, 1
    v_lshl_or_b32 v3, v4, 2, v3
    v_bfe_u32 v4, v1, 2, 1
    v_lshl_or_b32 v3, v4, 3, v3
    v_bfe_u32 v4, v1, 5, 1
    v_lshlrev_b32 v4, 3, v4
    v_xor_b32 v3, v3, v4
    v_cmp_eq_u32 vcc, 0, v3
    s_nop 1
    v_cndmask_b32 v98, 0, v2, vcc
    v_cmp_eq_u32 vcc, 1, v3
    s_nop 1
    v_cndmask_b32 v99, 0, v2, vcc
    v_cmp_eq_u32 vcc, 2, v3
    s_nop 1
    v_cndmask_b32 v100, 0, v2, vcc
    v_cmp_eq_u32 vcc, 3, v3
    s_nop 1
    v_cndmask_b32 v101, 0, v2, vcc
    v_cmp_eq_u32 vcc, 4, v3
    s_nop 1
    v_cndmask_b32 v102, 0, v2, vcc
    v_cmp_eq_u32 vcc, 5, v3
    s_nop 1
    v_cndmask_b32 v103, 0, v2, vcc
    v_cmp_eq_u32 vcc, 6, v3
    s_nop 1
    v_cndmask_b32 v104, 0, v2, vcc
    v_cmp_eq_u32 vcc, 7, v3
    s_nop 1
    v_cndmask_b32 v105, 0, v2, vcc
    v_bfe_u32 v3, v1, 2, 1
    v_bfe_u32 v4, v1, 1, 1
    v_lshl_or_b32 v3, v4, 1, v3
    v_bfe_u32 v4, v1, 3, 1
    v_lshl_or_b32 v3, v4, 2, v3
    v_bfe_u32 v4, v1, 4, 1
    v_lshlrev_b32 v4, 2, v4
    v_xor_b32 v3, v3, v4
    v_cmp_eq_u32 vcc, 0, v3
    s_nop 1
    v_cndmask_b32 v30, 0, v2, vcc
    v_cmp_eq_u32 vcc, 1, v3
    s_nop 1
    v_cndmask_b32 v31, 0, v2, vcc
    v_cmp_eq_u32 vcc, 2, v3
    s_nop 1
    v_cndmask_b32 v32, 0, v2, vcc
    v_cmp_eq_u32 vcc, 3, v3
    s_nop 1
    v_cndmask_b32 v33, 0, v2, vcc
    v_mov_b32 v38, 0
    v_mov_b32 v39, 0
    v_mov_b32 v40, 0
    v_mov_b32 v41, 0
    v_mov_b32 v42, 0
    v_mov_b32 v43, 0
    v_mov_b32 v44, 0
    v_mov_b32 v45, 0
    v_mov_b32 v46, 0
    v_mov_b32 v47, 0
    v_mov_b32 v48, 0
    v_mov_b32 v49, 0
    v_mov_b32 v50, 0
    v_mov_b32 v51, 0
    v_mov_b32 v52, 0
    v_mov_b32 v53, 0
kv0_17:
    buffer_load_dword v112, v113, s[12:15], 0 offen sc1
    s_waitcnt vmcnt(0)
    v_cmp_gt_u32 vcc, s2, v112
    s_cbranch_vccz kv0_ok_18
    s_sub_u32 s69, s69, 1
    s_cbranch_scc0 kv0_17
    s_mov_b32 s69, 0
kv0_ok_18:
    s_add_u32 s70, s75, 0x1000000
    s_mov_b32 m0, s78
    buffer_load_dwordx4 v[90:93], v111, s[8:11], s75 offen
    buffer_load_dwordx4 v111, s[8:11], s70 offen lds
    s_add_u32 m0, s78, 896
    buffer_load_dwordx4 v[94:97], v111, s[8:11], s75 offen offset:128
    buffer_load_dwordx4 v111, s[8:11], s70 offen offset:128 lds
    s_add_u32 s75, s75, 0x40000
    s_lshl_b32 s70, s64, 9
    s_add_u32 s70, s70, s75
    s_add_u32 s71, s70, 0x1000000
    s_buffer_load_dword s4, s[8:11], s70 offset:0
    s_buffer_load_dword s5, s[8:11], s71 offset:0
    s_buffer_load_dword s4, s[8:11], s70 offset:128
    s_buffer_load_dword s5, s[8:11], s71 offset:128
    s_buffer_load_dword s4, s[8:11], s70 offset:256
    s_buffer_load_dword s5, s[8:11], s71 offset:256
    s_buffer_load_dword s4, s[8:11], s70 offset:384
    s_buffer_load_dword s5, s[8:11], s71 offset:384
    s_waitcnt vmcnt(0)
qk_loop_19:
    ds_write_b128 v108, v[10:13] offset:0
    s_waitcnt lgkmcnt(0)
    s_barrier
    ds_read_b128 v[14:17], v106 offset:0
    ds_read_b128 v[18:21], v107 offset:0
    ds_read_b128 v[22:25], v36 offset:0
    v_smfmac_f32_16x16x64_bf16 v[38:41], v[10:13], v[128:135], v7
    v_smfmac_f32_16x16x64_bf16 v[42:45], v[10:13], v[160:167], v7
    v_smfmac_f32_16x16x64_bf16 v[46:49], v[10:13], v[192:199], v7
    v_smfmac_f32_16x16x64_bf16 v[50:53], v[10:13], v[224:231], v7
    s_waitcnt lgkmcnt(2)
    v_smfmac_f32_16x16x64_bf16 v[38:41], v[14:17], v[136:143], v7
    v_smfmac_f32_16x16x64_bf16 v[42:45], v[14:17], v[168:175], v7
    s_waitcnt lgkmcnt(1)
    v_smfmac_f32_16x16x64_bf16 v[38:41], v[18:21], v[144:151], v7
    v_smfmac_f32_16x16x64_bf16 v[42:45], v[18:21], v[176:183], v7
    s_waitcnt lgkmcnt(0)
    v_smfmac_f32_16x16x64_bf16 v[38:41], v[22:25], v[152:159], v7
    v_smfmac_f32_16x16x64_bf16 v[42:45], v[22:25], v[184:191], v7
    v_smfmac_f32_16x16x64_bf16 v[46:49], v[14:17], v[200:207], v7
    v_smfmac_f32_16x16x64_bf16 v[46:49], v[18:21], v[208:215], v7
    v_smfmac_f32_16x16x64_bf16 v[46:49], v[22:25], v[216:223], v7
    v_smfmac_f32_16x16x64_bf16 v[50:53], v[14:17], v[232:239], v7
    s_nop 1
    v_smfmac_f32_16x16x64_bf16 v[50:53], v[18:21], v[240:247], v7
    v_pk_add_f32 v[38:39], v[38:39], v[40:41]
    v_cvt_pk_bf16_f32 v86, v38, v39
    v_smfmac_f32_16x16x64_bf16 v[50:53], v[22:25], v[248:255], v7
    v_pk_add_f32 v[42:43], v[42:43], v[44:45]
    v_cvt_pk_bf16_f32 v87, v42, v43
    v_pk_add_f32 v[46:47], v[46:47], v[48:49]
    v_cvt_pk_bf16_f32 v88, v46, v47
    v_permlane16_swap_b32 v86, v87
    v_bfi_b32 v86, 1, s82, v86
    s_nop 1
    v_pk_add_f32 v[50:51], v[50:51], v[52:53]
    v_cvt_pk_bf16_f32 v89, v50, v51
    s_nop 1
    v_permlane16_swap_b32 v88, v89
    buffer_store_dwordx4 v[86:89], v34, s[8:11], s73 offen
    s_nop 15
    buffer_load_dwordx4 v[54:57], v116, s[8:11], s73 offen sc1
    buffer_load_dwordx4 v[58:61], v115, s[8:11], s73 offen sc1
    buffer_load_dwordx4 v[62:65], v115, s[8:11], s73 offen offset:256 sc1
    v_mfma_f32_16x16x32_bf16 v[78:81], v[86:89], v[98:101], 0
    v_mfma_f32_16x16x32_bf16 v[82:85], v[86:89], v[102:105], 0
    v_mov_b32 v38, 0
    v_mov_b32 v39, 0
    v_mov_b32 v40, 0
    v_mov_b32 v41, 0
    v_mov_b32 v42, 0
    v_mov_b32 v43, 0
    v_mov_b32 v44, 0
    v_mov_b32 v45, 0
    v_mov_b32 v46, 0
    v_mov_b32 v47, 0
    v_mov_b32 v48, 0
    v_mov_b32 v49, 0
    v_mov_b32 v50, 0
    v_mov_b32 v51, 0
    v_mov_b32 v52, 0
    v_mov_b32 v53, 0
    s_nop 15
    buffer_load_dwordx4 v[66:69], v116, s[8:11], s73 offen sc1
    buffer_load_dwordx4 v[70:73], v115, s[8:11], s73 offen sc1
    buffer_load_dwordx4 v[74:77], v115, s[8:11], s73 offen offset:256 sc1
    s_waitcnt vmcnt(5)
    v_mfma_f32_16x16x32_bf16 v[18:21], v[54:57], v[98:101], v[78:81]
    v_mfma_f32_16x16x32_bf16 v[22:25], v[54:57], v[102:105], v[82:85]
    s_waitcnt vmcnt(4)
    v_mfma_f32_16x16x32_bf16 v[18:21], v[58:61], v[26:29], v[18:21]
    s_waitcnt vmcnt(3)
    v_mfma_f32_16x16x32_bf16 v[22:25], v[62:65], v[26:29], v[22:25]
    v_bitop3_b32 v2, v54, v58, s82 bitop3:0x7e
    v_xor_b32 v3, s82, v62
    v_bitop3_b32 v2, v2, v3, 1 bitop3:0xa8
    v_cmp_ne_u32 vcc, 0, v2
    s_cbranch_vccnz x_s_20
x_j_21:
    s_nop 1
    v_cvt_pk_bf16_f32 v86, v18, v19
    v_cvt_pk_bf16_f32 v87, v20, v21
    v_cvt_pk_bf16_f32 v88, v22, v23
    v_cvt_pk_bf16_f32 v89, v24, v25
    s_nop 1
    v_mfma_f32_16x16x32_bf16 v[18:21], v[86:89], v[86:89], 0
    s_nop 1
    v_mfma_f32_16x16x32_bf16 v[14:17], v[94:97], v[86:89], 0
    s_nop 1
    v_mfma_f32_16x16x32_bf16 v[10:13], v[90:93], v[86:89], 0
    s_nop 1
    v_mov_b32_dpp v18, v20 row_shr:8 row_mask:0xf bank_mask:0xc
    v_mov_b32_dpp v19, v21 row_shr:8 row_mask:0xf bank_mask:0xc
    s_nop 1
    v_permlane32_swap_b32 v18, v19
    ds_write_b32 v109, v19 offset:8192
    v_mov_b32_dpp v10, v14 row_shr:8 row_mask:0xf bank_mask:0xc
    v_mov_b32_dpp v11, v15 row_shr:8 row_mask:0xf bank_mask:0xc
    v_mov_b32_dpp v12, v16 row_shr:8 row_mask:0xf bank_mask:0xc
    v_mov_b32_dpp v13, v17 row_shr:8 row_mask:0xf bank_mask:0xc
    ds_write_b128 v108, v[10:13] offset:4096
    s_and_b32 s72, s68, 3
    s_waitcnt lgkmcnt(0)
    s_barrier
    s_setprio 0
    s_cmp_lg_u32 s72, s64
    s_cbranch_scc1 nokm_22
    v_min_u32 v86, -2, v86
    buffer_store_dwordx4 v[86:89], v110, s[8:11], s80 offen sc1
nokm_22:
    s_cmp_eq_u32 s68, 63
    s_cbranch_scc1 chain_end_16
    s_and_b32 s72, s68, 7
    s_cmp_lg_u32 s72, 7
    s_cbranch_scc1 kv7_24
    v_cmp_gt_u32 vcc, s2, v112
    s_cbranch_vccz kv8_25
kvw_28:
    buffer_load_dword v112, v113, s[12:15], 0 offen sc1
    s_waitcnt vmcnt(0)
    v_cmp_gt_u32 vcc, s2, v112
    s_cbranch_vccz kvw_ok_29
    s_sub_u32 s69, s69, 1
    s_cbranch_scc0 kvw_28
    s_mov_b32 s69, 0
kvw_ok_29:
kv8_25:
    s_min_u32 s2, s2, 32
kv7_24:
    s_add_u32 s70, s75, 0x1000000
    s_mov_b32 m0, s78
    buffer_load_dwordx4 v[90:93], v111, s[8:11], s75 offen
    buffer_load_dwordx4 v111, s[8:11], s70 offen lds
    s_add_u32 m0, s78, 896
    buffer_load_dwordx4 v[94:97], v111, s[8:11], s75 offen offset:128
    buffer_load_dwordx4 v111, s[8:11], s70 offen offset:128 lds
    s_add_u32 s75, s75, 0x40000
    v_mov_b32 v10, -1
    v_mov_b32 v11, -1
    v_mov_b32 v12, -1
    v_mov_b32 v13, -1
    buffer_store_dwordx4 v[10:13], v35, s[8:11], s77 offen sc1
    s_add_u32 s77, s77, 0x20000
    s_lshr_b32 s60, s77, 21
    s_bitcmp1_b32 s59, s60
    s_cselect_b32 s60, 0x2000, 0
    s_bitset0_b32 s77, 13
    s_or_b32 s77, s77, s60
    s_cmp_lg_u32 s3, 1
    s_cbranch_scc1 noprog_26
    v_mov_b32 v2, s68
    buffer_store_dword v2, off, s[12:15], 0 offset:64 sc1
noprog_26:
    s_cmp_lg_u32 s72, 6
    s_cbranch_scc1 kv6_23
    v_add_u32 v113, 8, v113
    buffer_load_dword v112, v113, s[12:15], 0 offen sc1
kv6_23:
    s_cmp_ge_u32 s68, 16
    s_cbranch_scc1 nodump_27
    s_bfe_u32 s70, s68, 0x30000
    s_lshl_b32 s70, s70, 13
    s_bfe_u32 s71, s68, 0x10003
    s_lshl_b32 s71, s71, 6
    s_or_b32 s70, s70, s71
    v_xor_b32 v2, s70, v114
    ds_read_b64_tr_b16 v[14:15], v2
    ds_read_b64_tr_b16 v[16:17], v2 offset:4096
    s_bfe_u32 s70, s68, 0x30000
    s_lshl_b32 s70, s70, 10
    s_bfe_u32 s71, s68, 0x10003
    s_lshl_b32 s71, s71, 18
    s_or_b32 s70, s70, s71
    s_add_u32 s70, s70, s6
    s_waitcnt lgkmcnt(0)
    buffer_store_dwordx4 v[14:17], v8, s[8:11], s70 offen sc1
nodump_27:
    s_barrier
    s_add_u32 s80, s80, 0x10000
    s_lshl_b32 s70, s64, 9
    s_add_u32 s70, s70, s75
    s_add_u32 s71, s70, 0x1000000
    s_buffer_load_dword s4, s[8:11], s70 offset:0
    s_buffer_load_dword s5, s[8:11], s71 offset:0
    s_buffer_load_dword s4, s[8:11], s70 offset:128
    s_buffer_load_dword s5, s[8:11], s71 offset:128
    s_buffer_load_dword s4, s[8:11], s70 offset:256
    s_buffer_load_dword s5, s[8:11], s71 offset:256
    s_buffer_load_dword s4, s[8:11], s70 offset:384
    s_buffer_load_dword s5, s[8:11], s71 offset:384
    s_add_u32 s76, s76, 0x20000
    s_lshr_b32 s60, s76, 21
    s_bitcmp1_b32 s59, s60
    s_cselect_b32 s60, 0x2000, 0
    s_bitset0_b32 s76, 13
    s_or_b32 s76, s76, s60
    s_add_u32 s68, s68, 1
    s_bfe_u32 s82, s68, 0x10001
    s_xor_b32 s73, s73, 0x80000
    s_setprio 3
    s_barrier
    s_nop 15
    s_nop 15
    s_nop 15
    s_nop 15
    s_nop 15
    s_nop 15
    s_nop 15
    buffer_load_dwordx4 v[54:57], v37, s[8:11], s76 offen offset:0 sc1
    buffer_load_dwordx4 v[58:61], v37, s[8:11], s76 offen offset:1024 sc1
    buffer_load_dwordx4 v[62:65], v37, s[8:11], s76 offen offset:2048 sc1
    buffer_load_dwordx4 v[66:69], v37, s[8:11], s76 offen offset:3072 sc1
    s_waitcnt vmcnt(3)
    v_mfma_f32_16x16x32_bf16 v[78:81], v[54:57], v[30:33], 0
    s_waitcnt vmcnt(2)
    v_mfma_f32_16x16x32_bf16 v[78:81], v[58:61], v[30:33], v[78:81]
    s_waitcnt vmcnt(1)
    v_mfma_f32_16x16x32_bf16 v[82:85], v[62:65], v[30:33], 0
    s_waitcnt vmcnt(0)
    v_mfma_f32_16x16x32_bf16 v[82:85], v[66:69], v[30:33], v[82:85]
    v_max3_u32 v2, v54, v58, v62
    v_max_u32 v2, v2, v66
    v_cmp_eq_u32 vcc, -1, v2
    s_cbranch_vccnz c_s_30
c_j_31:
    s_nop 1
    v_cvt_pk_bf16_f32 v10, v78, v79
    v_cvt_pk_bf16_f32 v11, v80, v81
    v_cvt_pk_bf16_f32 v12, v82, v83
    v_cvt_pk_bf16_f32 v13, v84, v85
    s_branch qk_loop_19
x_s_20:
    buffer_load_dwordx4 v[54:57], v116, s[8:11], s73 offen sc1
    buffer_load_dwordx4 v[58:61], v115, s[8:11], s73 offen sc1
    buffer_load_dwordx4 v[62:65], v115, s[8:11], s73 offen offset:256 sc1
    s_waitcnt vmcnt(3)
    v_mfma_f32_16x16x32_bf16 v[18:21], v[66:69], v[98:101], v[78:81]
    v_mfma_f32_16x16x32_bf16 v[22:25], v[66:69], v[102:105], v[82:85]
    v_mfma_f32_16x16x32_bf16 v[18:21], v[70:73], v[26:29], v[18:21]
    v_mfma_f32_16x16x32_bf16 v[22:25], v[74:77], v[26:29], v[22:25]
    v_bitop3_b32 v2, v66, v70, s82 bitop3:0x7e
    v_xor_b32 v3, s82, v74
    v_bitop3_b32 v2, v2, v3, 1 bitop3:0xa8
    v_cmp_ne_u32 vcc, 0, v2
    s_cbranch_vccz x_j_21
    buffer_load_dwordx4 v[66:69], v116, s[8:11], s73 offen sc1
    buffer_load_dwordx4 v[70:73], v115, s[8:11], s73 offen sc1
    buffer_load_dwordx4 v[74:77], v115, s[8:11], s73 offen offset:256 sc1
    s_waitcnt vmcnt(3)
    v_mfma_f32_16x16x32_bf16 v[18:21], v[54:57], v[98:101], v[78:81]
    v_mfma_f32_16x16x32_bf16 v[22:25], v[54:57], v[102:105], v[82:85]
    v_mfma_f32_16x16x32_bf16 v[18:21], v[58:61], v[26:29], v[18:21]
    v_mfma_f32_16x16x32_bf16 v[22:25], v[62:65], v[26:29], v[22:25]
    v_bitop3_b32 v2, v54, v58, s82 bitop3:0x7e
    v_xor_b32 v3, s82, v62
    v_bitop3_b32 v2, v2, v3, 1 bitop3:0xa8
    v_cmp_ne_u32 vcc, 0, v2
    s_cbranch_vccz x_j_21
    s_sub_u32 s69, s69, 1
    s_cbranch_scc0 x_s_20
    s_mov_b32 s69, 0
    s_branch x_j_21
c_s_30:
    buffer_load_dwordx4 v[54:57], v37, s[8:11], s76 offen offset:0 sc1
    buffer_load_dwordx4 v[58:61], v37, s[8:11], s76 offen offset:1024 sc1
    buffer_load_dwordx4 v[62:65], v37, s[8:11], s76 offen offset:2048 sc1
    buffer_load_dwordx4 v[66:69], v37, s[8:11], s76 offen offset:3072 sc1
    s_waitcnt vmcnt(0)
    v_mfma_f32_16x16x32_bf16 v[78:81], v[54:57], v[30:33], 0
    v_mfma_f32_16x16x32_bf16 v[78:81], v[58:61], v[30:33], v[78:81]
    v_mfma_f32_16x16x32_bf16 v[82:85], v[62:65], v[30:33], 0
    v_mfma_f32_16x16x32_bf16 v[82:85], v[66:69], v[30:33], v[82:85]
    v_max3_u32 v2, v54, v58, v62
    v_max_u32 v2, v2, v66
    v_cmp_eq_u32 vcc, -1, v2
    s_cbranch_vccz c_j_31
    s_sub_u32 s69, s69, 1
    s_cbranch_scc0 c_s_30
    s_mov_b32 s69, 0
    s_branch c_j_31
vo_main_15:
    s_setprio 1
    v_mov_b32 v86, 0x3f803f80
    v_mov_b32 v90, 0x3e803e80
    v_mov_b32 v87, 0x3f803f80
    v_mov_b32 v91, 0x3e803e80
    v_mov_b32 v88, 0x3f803f80
    v_mov_b32 v92, 0x3e803e80
    v_mov_b32 v89, 0x3f803f80
    v_mov_b32 v93, 0x3e803e80
    v_and_b32 v2, 1, v1
    v_lshlrev_b32 v2, 4, v2
    v_mov_b32 v3, 0x3f80
    v_lshlrev_b32 v2, v2, v3
    v_lshrrev_b32 v3, 1, v6
    v_cmp_eq_u32 vcc, 0, v3
    s_nop 1
    v_cndmask_b32 v26, 0, v2, vcc
    v_cmp_eq_u32 vcc, 1, v3
    s_nop 1
    v_cndmask_b32 v27, 0, v2, vcc
    v_cmp_eq_u32 vcc, 2, v3
    s_nop 1
    v_cndmask_b32 v28, 0, v2, vcc
    v_cmp_eq_u32 vcc, 3, v3
    s_nop 1
    v_cndmask_b32 v29, 0, v2, vcc
    v_bfe_u32 v118, v1, 0, 3
    v_lshlrev_b32 v118, 3, v118
    v_bfe_u32 v3, v1, 3, 1
    v_lshl_or_b32 v118, v3, 7, v118
    v_bfe_u32 v3, v1, 5, 1
    v_lshl_or_b32 v118, v3, 6, v118
    v_bfe_u32 v3, v1, 4, 1
    v_lshl_or_b32 v118, v3, 8, v118
    v_bfe_u32 v3, v1, 1, 3
    v_bfe_u32 v4, v1, 4, 1
    v_lshlrev_b32 v4, 1, v4
    v_xor_b32 v3, v3, v4
    v_cmp_eq_u32 vcc, 0, v3
    s_nop 1
    v_cndmask_b32 v98, 0, v2, vcc
    v_cndmask_b32 v100, 0, v2, vcc
    v_cmp_eq_u32 vcc, 1, v3
    s_nop 1
    v_cndmask_b32 v99, 0, v2, vcc
    v_cndmask_b32 v101, 0, v2, vcc
    v_cmp_eq_u32 vcc, 4, v3
    s_nop 1
    v_cndmask_b32 v102, 0, v2, vcc
    v_cndmask_b32 v104, 0, v2, vcc
    v_cmp_eq_u32 vcc, 5, v3
    s_nop 1
    v_cndmask_b32 v103, 0, v2, vcc
    v_cndmask_b32 v105, 0, v2, vcc
    s_add_u32 s80, s80, 0x4400000
    s_mov_b32 s81, 0x3e0293ee
    v_lshlrev_b32 v114, 2, v1
    v_add_u32 v114, 8192, v114
    v_bfe_u32 v117, v1, 0, 1
    v_lshlrev_b32 v117, 4, v117
    v_bfe_u32 v2, v1, 2, 2
    v_lshl_or_b32 v117, v2, 5, v117
    v_bfe_u32 v2, v1, 1, 1
    v_lshl_or_b32 v117, v2, 7, v117
    v_bfe_u32 v2, v1, 4, 2
    v_lshl_or_b32 v117, v2, 8, v117
    v_bfe_u32 v2, v1, 1, 1
    v_lshl_or_b32 v117, v2, 10, v117
    v_bfe_u32 v119, v1, 4, 2
    v_lshlrev_b32 v119, 3, v119
    s_lshl_b32 s70, s67, 11
    v_add_u32 v116, s70, v8
    s_bfe_u32 s70, s67, 0x10000
    s_lshl_b32 s70, s70, 7
    s_bfe_u32 s71, s67, 0x20000
    s_lshl_b32 s71, s71, 10
    s_or_b32 s70, s70, s71
    v_xor_b32 v115, s70, v8
vo_loop_32:
    v_mov_b32 v38, 0
    v_mov_b32 v39, 0
    v_mov_b32 v40, 0
    v_mov_b32 v41, 0
    v_mov_b32 v42, 0
    v_mov_b32 v43, 0
    v_mov_b32 v44, 0
    v_mov_b32 v45, 0
    s_barrier
    v_mov_b32 v46, 0
    v_mov_b32 v47, 0
    v_mov_b32 v48, 0
    v_mov_b32 v49, 0
    v_mov_b32 v50, 0
    v_mov_b32 v51, 0
    v_mov_b32 v52, 0
    v_mov_b32 v53, 0
    v_mov_b32 v54, 0
    v_mov_b32 v55, 0
    v_mov_b32 v56, 0
    v_mov_b32 v57, 0
    v_mov_b32 v58, 0
    v_mov_b32 v59, 0
    v_mov_b32 v60, 0
    v_mov_b32 v61, 0
    ds_read_b128 v[10:13], v8 offset:0
    ds_read_b128 v[14:17], v8 offset:1024
    ds_read_b128 v[18:21], v8 offset:2048
    ds_read_b128 v[22:25], v8 offset:3072
    ds_read_b128 v[70:73], v116 offset:13312
    ds_read_b128 v[74:77], v116 offset:14336
    s_waitcnt lgkmcnt(5)
    v_smfmac_f32_16x16x64_bf16 v[38:41], v[10:13], v[128:135], v7
    v_smfmac_f32_16x16x64_bf16 v[42:45], v[10:13], v[160:167], v7
    s_waitcnt lgkmcnt(4)
    v_smfmac_f32_16x16x64_bf16 v[38:41], v[14:17], v[136:143], v7
    v_smfmac_f32_16x16x64_bf16 v[42:45], v[14:17], v[168:175], v7
    s_waitcnt lgkmcnt(3)
    v_smfmac_f32_16x16x64_bf16 v[38:41], v[18:21], v[144:151], v7
    v_smfmac_f32_16x16x64_bf16 v[42:45], v[18:21], v[176:183], v7
    s_waitcnt lgkmcnt(2)
    v_smfmac_f32_16x16x64_bf16 v[38:41], v[22:25], v[152:159], v7
    v_smfmac_f32_16x16x64_bf16 v[42:45], v[22:25], v[184:191], v7
    s_nop 6
    v_pk_add_f32 v[38:39], v[38:39], v[40:41]
    v_cvt_pk_bf16_f32 v78, v38, v39
    v_pk_add_f32 v[42:43], v[42:43], v[44:45]
    v_cvt_pk_bf16_f32 v79, v42, v43
    s_nop 1
    v_permlane16_swap_b32 v78, v79
    v_bfi_b32 v78, 1, s82, v78
    buffer_store_dwordx2 v[78:79], v34, s[8:11], s73 offen
    s_and_b32 s70, s68, 1
    s_lshl_b32 s70, s70, 19
    s_add_u32 s71, s70, s79
    s_add_u32 s70, s70, s78
    s_cmp_eq_u32 s68, 63
    s_cbranch_scc1 vo_last_33
    s_waitcnt lgkmcnt(0)
    s_barrier
    ds_read_b128 v[10:13], v8 offset:4096
    ds_read_b128 v[14:17], v8 offset:5120
    ds_read2st64_b32 v[30:31], v114 offset0:0 offset1:1
    ds_read_b128 v[18:21], v8 offset:6144
    ds_read_b128 v[22:25], v8 offset:7168
    ds_read2st64_b32 v[32:33], v114 offset0:2 offset1:3
    buffer_load_dwordx4 v[62:65], v8, s[8:11], s73 offen offset:0 sc1
    buffer_load_dwordx4 v[66:69], v8, s[8:11], s73 offen offset:1024 sc1
    s_waitcnt lgkmcnt(4)
    v_pk_add_f32 v[10:11], v[10:11], v[14:15]
    v_pk_add_f32 v[12:13], v[12:13], v[16:17]
    s_waitcnt lgkmcnt(2)
    v_pk_add_f32 v[10:11], v[10:11], v[18:19]
    v_pk_add_f32 v[12:13], v[12:13], v[20:21]
    s_waitcnt lgkmcnt(0)
    v_pk_add_f32 v[30:31], v[30:31], v[32:33]
    v_pk_add_f32 v[10:11], v[10:11], v[22:23]
    v_pk_add_f32 v[12:13], v[12:13], v[24:25]
    v_add_f32 v14, v30, v31
    v_max3_f32 v2, v10, v11, v12
    v_max3_f32 v3, v2, v13, v14
    v_max3_f32 v2, v2, v13, v14
    s_nop 1
    v_permlane32_swap_b32 v2, v3
    v_max_f32 v4, v2, v3
    v_max_f32 v3, v2, v3
    s_nop 1
    v_permlane16_swap_b32 v4, v3
    v_max_f32 v2, v4, v3
    v_mul_f32 v2, s81, v2
    s_nop 1
    v_max_f32_dpp v2, v2, v2 row_ror:8 row_mask:0xf bank_mask:0xf
    v_fma_f32 v10, v10, s81, -v2
    v_fma_f32 v11, v11, s81, -v2
    v_fma_f32 v12, v12, s81, -v2
    v_fma_f32 v13, v13, s81, -v2
    v_fma_f32 v14, v14, s81, -v2
    v_exp_f32 v10, v10
    v_exp_f32 v11, v11
    v_exp_f32 v12, v12
    v_exp_f32 v13, v13
    v_exp_f32 v15, v14
    v_cvt_pk_bf16_f32 v78, v10, v11
    v_cvt_pk_bf16_f32 v79, v12, v13
    v_mov_b32 v14, v15
    v_mov_b32_dpp v80, v78 row_ror:8 row_mask:0xf bank_mask:0xf
    v_mov_b32_dpp v81, v79 row_ror:8 row_mask:0xf bank_mask:0xf
    v_permlane32_swap_b32 v14, v15
    v_cvt_pk_bf16_f32 v82, v14, v15
    v_mfma_f32_16x16x32_bf16 v[106:109], v[70:73], v[78:81], 0
    v_mov_b32 v84, v82
    v_mov_b32_dpp v83, v82 row_ror:8 row_mask:0xf bank_mask:0xf
    v_mov_b32_dpp v85, v82 row_ror:8 row_mask:0xf bank_mask:0xf
    v_mfma_f32_16x16x32_bf16 v[110:113], v[74:77], v[78:81], 0
    s_waitcnt vmcnt(0)
    v_mfma_f32_16x16x32_bf16 v[18:21], v[62:65], v[82:85], v[106:109]
    v_bitop3_b32 v2, v62, v64, s82 bitop3:0x7e
    v_bitop3_b32 v3, v66, v68, s82 bitop3:0x7e
    v_mfma_f32_16x16x32_bf16 v[22:25], v[66:69], v[82:85], v[110:113]
    v_bitop3_b32 v2, v2, v3, 1 bitop3:0xa8
    v_cmp_ne_u32 vcc, 0, v2
    s_cbranch_vccnz xv_s_34
xv_j_35:
    v_mfma_f32_16x16x32_bf16 v[94:97], v[86:89], v[78:81], 0
    s_nop 0
    v_cvt_pk_bf16_f32 v106, v18, v19
    v_cvt_pk_bf16_f32 v107, v20, v21
    s_nop 0
    v_cvt_pk_bf16_f32 v108, v22, v23
    v_cvt_pk_bf16_f32 v109, v24, v25
    ds_write_b128 v115, v[106:109] offset:9216
    v_mfma_f32_16x16x32_bf16 v[94:97], v[90:93], v[82:85], v[94:97]
    s_nop 3
    s_waitcnt lgkmcnt(0)
    s_barrier
    ds_read_b128 v[10:13], v117 offset:9216
    ds_read_b128 v[14:17], v117 offset:11264
    v_rcp_f32 v96, v94
    s_nop 0
    ds_bpermute_b32 v94, v119, v96 offset:0
    ds_bpermute_b32 v95, v119, v96 offset:4
    s_waitcnt lgkmcnt(3)
    v_smfmac_f32_16x16x64_bf16 v[46:49], v[10:13], v[192:199], v7
    v_smfmac_f32_16x16x64_bf16 v[50:53], v[10:13], v[208:215], v7
    s_waitcnt lgkmcnt(2)
    v_smfmac_f32_16x16x64_bf16 v[46:49], v[14:17], v[200:207], v7
    s_nop 1
    v_smfmac_f32_16x16x64_bf16 v[50:53], v[14:17], v[216:223], v7
    s_nop 1
    v_smfmac_f32_16x16x64_bf16 v[54:57], v[10:13], v[224:231], v7
    s_waitcnt lgkmcnt(0)
    v_smfmac_f32_16x16x64_bf16 v[54:57], v[14:17], v[232:239], v7
    v_pk_add_f32 v[46:47], v[46:47], v[48:49]
    v_smfmac_f32_16x16x64_bf16 v[58:61], v[10:13], v[240:247], v7
    v_pk_mul_f32 v[46:47], v[46:47], v[94:95]
    v_cvt_pk_bf16_f32 v78, v46, v47
    v_smfmac_f32_16x16x64_bf16 v[58:61], v[14:17], v[248:255], v7
    v_pk_add_f32 v[50:51], v[50:51], v[52:53]
    v_pk_mul_f32 v[50:51], v[50:51], v[94:95]
    v_cvt_pk_bf16_f32 v79, v50, v51
    v_pk_add_f32 v[54:55], v[54:55], v[56:57]
    v_pk_mul_f32 v[54:55], v[54:55], v[94:95]
    v_cvt_pk_bf16_f32 v80, v54, v55
    v_permlane16_swap_b32 v78, v79
    v_bfi_b32 v78, 1, s82, v78
    v_pk_add_f32 v[58:59], v[58:59], v[60:61]
    v_pk_mul_f32 v[58:59], v[58:59], v[94:95]
    v_cvt_pk_bf16_f32 v81, v58, v59
    s_nop 1
    v_permlane16_swap_b32 v80, v81
    buffer_store_dwordx4 v[78:81], v36, s[8:11], s71 offen
    s_nop 15
    s_nop 15
    buffer_load_dwordx4 v[10:13], v8, s[8:11], s70 offen sc1
    s_nop 15
    buffer_load_dwordx4 v[14:17], v8, s[8:11], s70 offen sc1
    s_nop 15
    buffer_load_dwordx4 v[18:21], v8, s[8:11], s70 offen sc1
    s_waitcnt vmcnt(2)
    v_mfma_f32_16x16x32_bf16 v[30:33], v[26:29], v[10:13], 0
    v_bitop3_b32 v2, v10, s82, 1 bitop3:0x28
    v_cmp_ne_u32 vcc, 0, v2
    s_cbranch_vccnz b_s_36
b_j_37:
    s_nop 4
    v_add_f32_dpp v30, v30, v30 row_ror:8 row_mask:0xf bank_mask:0xf
    v_add_f32_dpp v31, v31, v31 row_ror:8 row_mask:0xf bank_mask:0xf
    v_add_f32_dpp v32, v32, v32 row_ror:8 row_mask:0xf bank_mask:0xf
    v_add_f32_dpp v33, v33, v33 row_ror:8 row_mask:0xf bank_mask:0xf
    v_cvt_pk_bf16_f32 v30, v30, v31
    v_cvt_pk_bf16_f32 v31, v32, v33
    v_min_u32 v30, -2, v30
    s_nop 0
    v_permlane16_swap_b32 v31, v33
    v_permlane16_swap_b32 v30, v32
    buffer_store_dwordx4 v[30:33], v35, s[8:11], s77 offen sc1
    s_barrier
    s_add_u32 s68, s68, 1
    s_bfe_u32 s82, s68, 0x10001
    s_xor_b32 s73, s73, 0x40000
    s_add_u32 s77, s77, 0x20000
    s_lshr_b32 s60, s77, 21
    s_bitcmp1_b32 s59, s60
    s_cselect_b32 s60, 0x2000, 0
    s_bitset0_b32 s77, 13
    s_or_b32 s77, s77, s60
    s_waitcnt vmcnt(1)
    s_and_b32 s72, s68, 3
    s_cmp_lg_u32 s72, s64
    s_cbranch_scc1 novm_38
    v_mfma_f32_16x16x32_bf16 v[106:109], v[98:101], v[62:65], 0
    v_mfma_f32_16x16x32_bf16 v[106:109], v[102:105], v[66:69], v[106:109]
    s_nop 7
    v_cvt_pk_bf16_f32 v106, v106, v107
    v_cvt_pk_bf16_f32 v107, v108, v109
    v_min_u32 v106, -2, v106
    buffer_store_dwordx2 v[106:107], v118, s[8:11], s80 offen sc1
novm_38:
    s_add_u32 s80, s80, 0x10000
    s_branch vo_loop_32
xv_s_34:
    buffer_load_dwordx4 v[62:65], v8, s[8:11], s73 offen offset:0 sc1
    buffer_load_dwordx4 v[66:69], v8, s[8:11], s73 offen offset:1024 sc1
    s_waitcnt vmcnt(0)
    v_mfma_f32_16x16x32_bf16 v[18:21], v[62:65], v[82:85], v[106:109]
    v_bitop3_b32 v2, v62, v64, s82 bitop3:0x7e
    v_bitop3_b32 v3, v66, v68, s82 bitop3:0x7e
    v_mfma_f32_16x16x32_bf16 v[22:25], v[66:69], v[82:85], v[110:113]
    v_bitop3_b32 v2, v2, v3, 1 bitop3:0xa8
    v_cmp_ne_u32 vcc, 0, v2
    s_cbranch_vccz xv_j_35
    s_sub_u32 s69, s69, 1
    s_cbranch_scc0 xv_s_34
    s_mov_b32 s69, 0
    s_branch xv_j_35
b_s_36:
    buffer_load_dwordx4 v[10:13], v8, s[8:11], s70 offen sc1
    s_waitcnt vmcnt(2)
    s_nop 0
    v_mfma_f32_16x16x32_bf16 v[30:33], v[26:29], v[14:17], 0
    v_bitop3_b32 v2, v14, s82, 1 bitop3:0x28
    v_cmp_ne_u32 vcc, 0, v2
    s_cbranch_vccz b_j_37
    buffer_load_dwordx4 v[14:17], v8, s[8:11], s70 offen sc1
    s_waitcnt vmcnt(2)
    s_nop 0
    v_mfma_f32_16x16x32_bf16 v[30:33], v[26:29], v[18:21], 0
    v_bitop3_b32 v2, v18, s82, 1 bitop3:0x28
    v_cmp_ne_u32 vcc, 0, v2
    s_cbranch_vccz b_j_37
    buffer_load_dwordx4 v[18:21], v8, s[8:11], s70 offen sc1
    s_waitcnt vmcnt(2)
    s_nop 0
    v_mfma_f32_16x16x32_bf16 v[30:33], v[26:29], v[10:13], 0
    v_bitop3_b32 v2, v10, s82, 1 bitop3:0x28
    v_cmp_ne_u32 vcc, 0, v2
    s_cbranch_vccz b_j_37
    s_sub_u32 s69, s69, 1
    s_cbranch_scc0 b_s_36
    s_mov_b32 s69, 0
    s_branch b_j_37
vo_last_33:
    s_cmp_lg_u32 s64, 0
    s_cbranch_scc1 chain_end_16
pollvm_39:
    buffer_load_dwordx4 v[62:65], v8, s[8:11], s73 offen offset:0 sc1
    buffer_load_dwordx4 v[66:69], v8, s[8:11], s73 offen offset:1024 sc1
    s_waitcnt vmcnt(0)
    v_bitop3_b32 v2, v62, v64, s82 bitop3:0x7e
    v_bitop3_b32 v3, v66, v68, s82 bitop3:0x7e
    v_bitop3_b32 v2, v2, v3, 1 bitop3:0xa8
    v_cmp_ne_u32 vcc, 0, v2
    s_cbranch_vccz pollvm_ok_40
    s_sub_u32 s69, s69, 1
    s_cbranch_scc0 pollvm_39
    s_mov_b32 s69, 0
pollvm_ok_40:
    v_mfma_f32_16x16x32_bf16 v[106:109], v[98:101], v[62:65], 0
    v_mfma_f32_16x16x32_bf16 v[106:109], v[102:105], v[66:69], v[106:109]
    s_nop 7
    v_cvt_pk_bf16_f32 v106, v106, v107
    v_cvt_pk_bf16_f32 v107, v108, v109
    v_min_u32 v106, -2, v106
    buffer_store_dwordx2 v[106:107], v118, s[8:11], s80 offen sc1
chain_end_16:
    s_waitcnt vmcnt(0)
    s_endpgm
bulk_2:
    s_and_b32 s75, s56, 3
    s_lshl_b32 s76, s75, 5
    s_add_u32 s76, s76, s57
    s_mov_b32 s77, 0x40000
    v_bfe_u32 v79, v1, 0, 4
    v_lshlrev_b32 v79, 4, v79
    v_bfe_u32 v75, v1, 4, 2
    v_lshl_or_b32 v79, v75, 9, v79
    s_mov_b32 s78, 0
    v_bfe_u32 v76, v1, 2, 2
    v_sub_u32 v76, 0, v76
    v_lshrrev_b32 v75, 4, v1
    v_xor_b32 v76, v76, v75
    v_and_b32 v76, 3, v76
    v_bfe_u32 v72, v1, 0, 4
    v_lshlrev_b32 v72, 6, v72
    v_lshl_or_b32 v72, v76, 4, v72
    s_lshr_b32 s74, s58, 2
    s_mul_i32 s74, s74, 4096
    v_add_u32 v72, s74, v72
    v_bfe_u32 v73, v1, 0, 2
    v_lshlrev_b32 v73, 3, v73
    v_bfe_u32 v75, v1, 4, 1
    v_lshl_or_b32 v73, v75, 5, v73
    v_bfe_u32 v75, v1, 2, 2
    v_lshl_or_b32 v73, v75, 6, v73
    v_bfe_u32 v75, v1, 2, 2
    v_lshl_or_b32 v73, v75, 8, v73
    v_bfe_u32 v75, v1, 4, 2
    v_lshl_or_b32 v73, v75, 11, v73
    s_and_b32 s74, s58, 3
    s_mul_i32 s74, s74, 64
    s_or_b32 s74, s74, 8192
    v_xor_b32 v73, s74, v73
r01_48:
    s_and_b32 s79, s57, 1
    s_lshl_b32 s84, s78, 1
    s_add_u32 s79, s79, s84
    s_bfe_u32 s80, s76, 0x50001
    s_lshl_b32 s83, s78, 3
    s_add_u32 s83, s83, 128
    s_cmp_ge_u32 s75, 2
    s_cbranch_scc1 v0_46
    s_mov_b64 s[60:61], s[36:37]
    s_mov_b32 s62, 0x400000
    s_mov_b32 s63, 0x20000
    s_mov_b64 s[64:65], s[24:25]
    s_mov_b32 s66, 0x800000
    s_mov_b32 s67, 0x20000
    v_lshrrev_b32 v76, 4, v1
    v_sub_u32 v76, 0, v76
    v_xor_b32 v76, v76, v1
    v_and_b32 v76, 3, v76
    s_mul_i32 s74, s58, 16
    v_lshrrev_b32 v77, 2, v1
    v_add3_u32 v77, v77, s74, 0
    v_lshlrev_b32 v68, 11, v77
    v_lshl_add_u32 v68, v76, 4, v68
    s_and_b32 s74, s58, 2
    v_bfe_u32 v76, v1, 0, 4
    v_bfe_u32 v77, v1, 4, 2
    v_lshlrev_b32 v77, 2, v77
    v_xor_b32 v76, v76, v77
    v_xor_b32 v76, s74, v76
    v_bfe_u32 v77, v76, 0, 1
    v_lshlrev_b32 v77, 5, v77
    v_bfe_u32 v75, v76, 1, 1
    v_lshl_or_b32 v77, v75, 4, v77
    v_bfe_u32 v75, v76, 2, 3
    v_lshl_or_b32 v77, v75, 6, v77
    v_lshrrev_b32 v76, 4, v1
    v_lshl_add_u32 v70, v76, 13, v77
    s_lshl_b32 s74, s58, 15
    v_add_u32 v70, s74, v70
    s_mov_b32 s70, 262144
    s_mul_i32 s68, s79, 262144
    s_mul_i32 s69, s80, 256
    s_mov_b32 s82, 0x40000
    s_lshl_b32 s81, s79, 1
    s_lshr_b32 s84, s58, 2
    s_add_u32 s81, s81, s84
    s_mul_i32 s81, s81, s82
    s_mul_i32 s81, s81, 2
    s_lshl_b32 s74, s80, 2
    s_and_b32 s84, s58, 3
    s_add_u32 s84, s84, s74
    s_mul_i32 s84, s84, 2048
    s_add_u32 s81, s81, s84
    s_add_u32 s81, s81, 0x1000000
    s_mul_i32 s71, s58, 1024
    s_mov_b32 m0, s71
    s_nop 0
    buffer_load_dwordx4 v68, s[60:63], s68 offen lds
    s_add_u32 m0, s71, 8192
    s_nop 0
    buffer_load_dwordx4 v70, s[64:67], s69 offen lds
    s_add_u32 s68, s68, 64
    s_add_u32 s69, s69, s70
    s_add_u32 s71, s71, 16384
    s_and_b32 s71, s71, 0x1ffff
    s_mov_b32 m0, s71
    s_nop 0
    buffer_load_dwordx4 v68, s[60:63], s68 offen lds
    s_add_u32 m0, s71, 8192
    s_nop 0
    buffer_load_dwordx4 v70, s[64:67], s69 offen lds
    s_add_u32 s68, s68, 64
    s_add_u32 s69, s69, s70
    s_add_u32 s71, s71, 16384
    s_and_b32 s71, s71, 0x1ffff
    s_mov_b32 m0, s71
    s_nop 0
    buffer_load_dwordx4 v68, s[60:63], s68 offen lds
    s_add_u32 m0, s71, 8192
    s_nop 0
    buffer_load_dwordx4 v70, s[64:67], s69 offen lds
    s_add_u32 s68, s68, 64
    s_add_u32 s69, s69, s70
    s_add_u32 s71, s71, 16384
    s_and_b32 s71, s71, 0x1ffff
    s_mov_b32 m0, s71
    s_nop 0
    buffer_load_dwordx4 v68, s[60:63], s68 offen lds
    s_add_u32 m0, s71, 8192
    s_nop 0
    buffer_load_dwordx4 v70, s[64:67], s69 offen lds
    s_add_u32 s68, s68, 64
    s_add_u32 s69, s69, s70
    s_add_u32 s71, s71, 16384
    s_and_b32 s71, s71, 0x1ffff
    s_mov_b32 m0, s71
    s_nop 0
    buffer_load_dwordx4 v68, s[60:63], s68 offen lds
    s_add_u32 m0, s71, 8192
    s_nop 0
    buffer_load_dwordx4 v70, s[64:67], s69 offen lds
    s_add_u32 s68, s68, 64
    s_add_u32 s69, s69, s70
    s_add_u32 s71, s71, 16384
    s_and_b32 s71, s71, 0x1ffff
    s_mov_b32 m0, s71
    s_nop 0
    buffer_load_dwordx4 v68, s[60:63], s68 offen lds
    s_add_u32 m0, s71, 8192
    s_nop 0
    buffer_load_dwordx4 v70, s[64:67], s69 offen lds
    s_add_u32 s68, s68, 64
    s_add_u32 s69, s69, s70
    s_add_u32 s71, s71, 16384
    s_and_b32 s71, s71, 0x1ffff
    s_mov_b32 m0, s71
    s_nop 0
    buffer_load_dwordx4 v68, s[60:63], s68 offen lds
    s_add_u32 m0, s71, 8192
    s_nop 0
    buffer_load_dwordx4 v70, s[64:67], s69 offen lds
    s_add_u32 s68, s68, 64
    s_add_u32 s69, s69, s70
    s_add_u32 s71, s71, 16384
    s_and_b32 s71, s71, 0x1ffff
    s_mov_b32 m0, s71
    s_nop 0
    buffer_load_dwordx4 v68, s[60:63], s68 offen lds
    s_add_u32 m0, s71, 8192
    s_nop 0
    buffer_load_dwordx4 v70, s[64:67], s69 offen lds
    s_add_u32 s68, s68, 64
    s_add_u32 s69, s69, s70
    s_add_u32 s71, s71, 16384
    s_and_b32 s71, s71, 0x1ffff
    s_branch f128_41
v0_46:
    s_mov_b64 s[60:61], s[36:37]
    s_mov_b32 s62, 0x400000
    s_mov_b32 s63, 0x20000
    s_mov_b64 s[64:65], s[28:29]
    s_mov_b32 s66, 0x800000
    s_mov_b32 s67, 0x20000
    v_lshrrev_b32 v76, 4, v1
    v_sub_u32 v76, 0, v76
    v_xor_b32 v76, v76, v1
    v_and_b32 v76, 3, v76
    s_mul_i32 s74, s58, 16
    v_lshrrev_b32 v77, 2, v1
    v_add3_u32 v77, v77, s74, 0
    v_bfe_u32 v68, v77, 0, 3
    v_lshlrev_b32 v68, 11, v68
    v_bfe_u32 v75, v77, 3, 1
    v_lshl_or_b32 v68, v75, 15, v68
    v_bfe_u32 v75, v77, 4, 1
    v_lshl_or_b32 v68, v75, 14, v68
    v_bfe_u32 v75, v77, 5, 3
    v_lshl_or_b32 v68, v75, 16, v68
    v_lshl_add_u32 v68, v76, 4, v68
    s_and_b32 s74, s58, 2
    v_bfe_u32 v76, v1, 0, 4
    v_bfe_u32 v77, v1, 4, 2
    v_lshlrev_b32 v77, 2, v77
    v_xor_b32 v76, v76, v77
    v_xor_b32 v76, s74, v76
    v_lshlrev_b32 v77, 4, v76
    v_lshrrev_b32 v76, 4, v1
    v_lshl_add_u32 v70, v76, 13, v77
    s_lshl_b32 s74, s58, 15
    v_add_u32 v70, s74, v70
    s_mov_b32 s70, 262144
    s_mul_i32 s68, s79, 262144
    s_mul_i32 s69, s80, 256
    s_mov_b32 s82, 0x40000
    s_lshl_b32 s81, s79, 1
    s_lshr_b32 s84, s58, 2
    s_add_u32 s81, s81, s84
    s_mul_i32 s81, s81, s82
    s_mul_i32 s81, s81, 2
    s_lshl_b32 s74, s80, 2
    s_and_b32 s84, s58, 3
    s_add_u32 s84, s84, s74
    s_mul_i32 s84, s84, 2048
    s_add_u32 s81, s81, s84
    s_add_u32 s81, s81, 0x2000000
    s_mul_i32 s71, s58, 1024
    s_mov_b32 m0, s71
    s_nop 0
    buffer_load_dwordx4 v68, s[60:63], s68 offen lds
    s_add_u32 m0, s71, 8192
    s_nop 0
    buffer_load_dwordx4 v70, s[64:67], s69 offen lds
    s_add_u32 s68, s68, 64
    s_add_u32 s69, s69, s70
    s_add_u32 s71, s71, 16384
    s_and_b32 s71, s71, 0x1ffff
    s_mov_b32 m0, s71
    s_nop 0
    buffer_load_dwordx4 v68, s[60:63], s68 offen lds
    s_add_u32 m0, s71, 8192
    s_nop 0
    buffer_load_dwordx4 v70, s[64:67], s69 offen lds
    s_add_u32 s68, s68, 64
    s_add_u32 s69, s69, s70
    s_add_u32 s71, s71, 16384
    s_and_b32 s71, s71, 0x1ffff
    s_mov_b32 m0, s71
    s_nop 0
    buffer_load_dwordx4 v68, s[60:63], s68 offen lds
    s_add_u32 m0, s71, 8192
    s_nop 0
    buffer_load_dwordx4 v70, s[64:67], s69 offen lds
    s_add_u32 s68, s68, 64
    s_add_u32 s69, s69, s70
    s_add_u32 s71, s71, 16384
    s_and_b32 s71, s71, 0x1ffff
    s_mov_b32 m0, s71
    s_nop 0
    buffer_load_dwordx4 v68, s[60:63], s68 offen lds
    s_add_u32 m0, s71, 8192
    s_nop 0
    buffer_load_dwordx4 v70, s[64:67], s69 offen lds
    s_add_u32 s68, s68, 64
    s_add_u32 s69, s69, s70
    s_add_u32 s71, s71, 16384
    s_and_b32 s71, s71, 0x1ffff
    s_mov_b32 m0, s71
    s_nop 0
    buffer_load_dwordx4 v68, s[60:63], s68 offen lds
    s_add_u32 m0, s71, 8192
    s_nop 0
    buffer_load_dwordx4 v70, s[64:67], s69 offen lds
    s_add_u32 s68, s68, 64
    s_add_u32 s69, s69, s70
    s_add_u32 s71, s71, 16384
    s_and_b32 s71, s71, 0x1ffff
    s_mov_b32 m0, s71
    s_nop 0
    buffer_load_dwordx4 v68, s[60:63], s68 offen lds
    s_add_u32 m0, s71, 8192
    s_nop 0
    buffer_load_dwordx4 v70, s[64:67], s69 offen lds
    s_add_u32 s68, s68, 64
    s_add_u32 s69, s69, s70
    s_add_u32 s71, s71, 16384
    s_and_b32 s71, s71, 0x1ffff
    s_mov_b32 m0, s71
    s_nop 0
    buffer_load_dwordx4 v68, s[60:63], s68 offen lds
    s_add_u32 m0, s71, 8192
    s_nop 0
    buffer_load_dwordx4 v70, s[64:67], s69 offen lds
    s_add_u32 s68, s68, 64
    s_add_u32 s69, s69, s70
    s_add_u32 s71, s71, 16384
    s_and_b32 s71, s71, 0x1ffff
    s_mov_b32 m0, s71
    s_nop 0
    buffer_load_dwordx4 v68, s[60:63], s68 offen lds
    s_add_u32 m0, s71, 8192
    s_nop 0
    buffer_load_dwordx4 v70, s[64:67], s69 offen lds
    s_add_u32 s68, s68, 64
    s_add_u32 s69, s69, s70
    s_add_u32 s71, s71, 16384
    s_and_b32 s71, s71, 0x1ffff
    s_mov_b32 s72, 0
    s_waitcnt vmcnt(14)
    s_barrier
    v_add_u32 v74, s72, v72
    v_add_u32 v75, s72, v73
    v_xor_b32 v76, 32, v75
    s_add_u32 s72, s72, 16384
    s_and_b32 s72, s72, 0x1ffff
    ds_read_b128 v[4:7], v74 offset:0
    ds_read_b128 v[8:11], v74 offset:1024
    ds_read_b64_tr_b16 v[36:37], v75 offset:0
    ds_read_b64_tr_b16 v[38:39], v75 offset:1024
    ds_read_b64_tr_b16 v[40:41], v76 offset:0
    ds_read_b64_tr_b16 v[42:43], v76 offset:1024
    s_waitcnt lgkmcnt(0)
    v_mfma_f32_16x16x32_bf16 v[80:83], v[4:7], v[36:39], 0
    ds_read_b128 v[12:15], v74 offset:2048
    v_mfma_f32_16x16x32_bf16 v[84:87], v[4:7], v[40:43], 0
    ds_read_b128 v[16:19], v74 offset:3072
    v_mfma_f32_16x16x32_bf16 v[88:91], v[8:11], v[36:39], 0
    v_mfma_f32_16x16x32_bf16 v[92:95], v[8:11], v[40:43], 0
    s_waitcnt vmcnt(12) lgkmcnt(0)
    s_barrier
    v_mfma_f32_16x16x32_bf16 v[96:99], v[12:15], v[36:39], 0
    v_add_u32 v74, s72, v72
    v_add_u32 v75, s72, v73
    v_xor_b32 v76, 32, v75
    s_add_u32 s72, s72, 16384
    s_and_b32 s72, s72, 0x1ffff
    ds_read_b128 v[4:7], v74 offset:0
    v_mfma_f32_16x16x32_bf16 v[100:103], v[12:15], v[40:43], 0
    ds_read_b64_tr_b16 v[52:53], v75 offset:0
    ds_read_b64_tr_b16 v[54:55], v75 offset:1024
    ds_read_b64_tr_b16 v[56:57], v76 offset:0
    ds_read_b64_tr_b16 v[58:59], v76 offset:1024
    v_mfma_f32_16x16x32_bf16 v[104:107], v[16:19], v[36:39], 0
    ds_read_b128 v[8:11], v74 offset:1024
    s_mov_b32 m0, s71
    s_nop 0
    buffer_load_dwordx4 v68, s[60:63], s68 offen lds
    s_add_u32 m0, s71, 8192
    v_mfma_f32_16x16x32_bf16 v[108:111], v[16:19], v[40:43], 0
    buffer_load_dwordx4 v70, s[64:67], s69 offen lds
    s_add_u32 s68, s68, 64
    s_add_u32 s69, s69, s70
    s_add_u32 s71, s71, 16384
    s_and_b32 s71, s71, 0x1ffff
    s_waitcnt lgkmcnt(0)
    v_mfma_f32_16x16x32_bf16 v[80:83], v[4:7], v[52:55], v[80:83]
    ds_read_b128 v[12:15], v74 offset:2048
    v_mfma_f32_16x16x32_bf16 v[84:87], v[4:7], v[56:59], v[84:87]
    ds_read_b128 v[16:19], v74 offset:3072
    v_mfma_f32_16x16x32_bf16 v[88:91], v[8:11], v[52:55], v[88:91]
    v_mfma_f32_16x16x32_bf16 v[92:95], v[8:11], v[56:59], v[92:95]
    s_waitcnt vmcnt(12) lgkmcnt(0)
    s_barrier
    v_mfma_f32_16x16x32_bf16 v[96:99], v[12:15], v[52:55], v[96:99]
    v_add_u32 v74, s72, v72
    v_add_u32 v75, s72, v73
    v_xor_b32 v76, 32, v75
    s_add_u32 s72, s72, 16384
    s_and_b32 s72, s72, 0x1ffff
    ds_read_b128 v[4:7], v74 offset:0
    v_mfma_f32_16x16x32_bf16 v[100:103], v[12:15], v[56:59], v[100:103]
    ds_read_b64_tr_b16 v[36:37], v75 offset:0
    ds_read_b64_tr_b16 v[38:39], v75 offset:1024
    ds_read_b64_tr_b16 v[40:41], v76 offset:0
    ds_read_b64_tr_b16 v[42:43], v76 offset:1024
    v_mfma_f32_16x16x32_bf16 v[104:107], v[16:19], v[52:55], v[104:107]
    ds_read_b128 v[8:11], v74 offset:1024
    s_mov_b32 m0, s71
    s_nop 0
    buffer_load_dwordx4 v68, s[60:63], s68 offen lds
    s_add_u32 m0, s71, 8192
    v_mfma_f32_16x16x32_bf16 v[108:111], v[16:19], v[56:59], v[108:111]
    buffer_load_dwordx4 v70, s[64:67], s69 offen lds
    s_add_u32 s68, s68, 64
    s_add_u32 s69, s69, s70
    s_add_u32 s71, s71, 16384
    s_and_b32 s71, s71, 0x1ffff
    s_mov_b32 s73, 11
gl_50:
    s_waitcnt lgkmcnt(0)
    v_mfma_f32_16x16x32_bf16 v[80:83], v[4:7], v[36:39], v[80:83]
    ds_read_b128 v[12:15], v74 offset:2048
    v_mfma_f32_16x16x32_bf16 v[84:87], v[4:7], v[40:43], v[84:87]
    ds_read_b128 v[16:19], v74 offset:3072
    v_mfma_f32_16x16x32_bf16 v[88:91], v[8:11], v[36:39], v[88:91]
    v_mfma_f32_16x16x32_bf16 v[92:95], v[8:11], v[40:43], v[92:95]
    s_waitcnt vmcnt(12) lgkmcnt(0)
    s_barrier
    v_mfma_f32_16x16x32_bf16 v[96:99], v[12:15], v[36:39], v[96:99]
    v_add_u32 v74, s72, v72
    v_add_u32 v75, s72, v73
    v_xor_b32 v76, 32, v75
    s_add_u32 s72, s72, 16384
    s_and_b32 s72, s72, 0x1ffff
    ds_read_b128 v[4:7], v74 offset:0
    v_mfma_f32_16x16x32_bf16 v[100:103], v[12:15], v[40:43], v[100:103]
    ds_read_b64_tr_b16 v[52:53], v75 offset:0
    ds_read_b64_tr_b16 v[54:55], v75 offset:1024
    ds_read_b64_tr_b16 v[56:57], v76 offset:0
    ds_read_b64_tr_b16 v[58:59], v76 offset:1024
    v_mfma_f32_16x16x32_bf16 v[104:107], v[16:19], v[36:39], v[104:107]
    ds_read_b128 v[8:11], v74 offset:1024
    s_mov_b32 m0, s71
    s_nop 0
    buffer_load_dwordx4 v68, s[60:63], s68 offen lds
    s_add_u32 m0, s71, 8192
    v_mfma_f32_16x16x32_bf16 v[108:111], v[16:19], v[40:43], v[108:111]
    buffer_load_dwordx4 v70, s[64:67], s69 offen lds
    s_add_u32 s68, s68, 64
    s_add_u32 s69, s69, s70
    s_add_u32 s71, s71, 16384
    s_and_b32 s71, s71, 0x1ffff
    s_waitcnt lgkmcnt(0)
    v_mfma_f32_16x16x32_bf16 v[80:83], v[4:7], v[52:55], v[80:83]
    ds_read_b128 v[12:15], v74 offset:2048
    v_mfma_f32_16x16x32_bf16 v[84:87], v[4:7], v[56:59], v[84:87]
    ds_read_b128 v[16:19], v74 offset:3072
    v_mfma_f32_16x16x32_bf16 v[88:91], v[8:11], v[52:55], v[88:91]
    v_mfma_f32_16x16x32_bf16 v[92:95], v[8:11], v[56:59], v[92:95]
    s_waitcnt vmcnt(12) lgkmcnt(0)
    s_barrier
    v_mfma_f32_16x16x32_bf16 v[96:99], v[12:15], v[52:55], v[96:99]
    v_add_u32 v74, s72, v72
    v_add_u32 v75, s72, v73
    v_xor_b32 v76, 32, v75
    s_add_u32 s72, s72, 16384
    s_and_b32 s72, s72, 0x1ffff
    ds_read_b128 v[4:7], v74 offset:0
    v_mfma_f32_16x16x32_bf16 v[100:103], v[12:15], v[56:59], v[100:103]
    ds_read_b64_tr_b16 v[36:37], v75 offset:0
    ds_read_b64_tr_b16 v[38:39], v75 offset:1024
    ds_read_b64_tr_b16 v[40:41], v76 offset:0
    ds_read_b64_tr_b16 v[42:43], v76 offset:1024
    v_mfma_f32_16x16x32_bf16 v[104:107], v[16:19], v[52:55], v[104:107]
    ds_read_b128 v[8:11], v74 offset:1024
    s_mov_b32 m0, s71
    s_nop 0
    buffer_load_dwordx4 v68, s[60:63], s68 offen lds
    s_add_u32 m0, s71, 8192
    v_mfma_f32_16x16x32_bf16 v[108:111], v[16:19], v[56:59], v[108:111]
    buffer_load_dwordx4 v70, s[64:67], s69 offen lds
    s_add_u32 s68, s68, 64
    s_add_u32 s69, s69, s70
    s_add_u32 s71, s71, 16384
    s_and_b32 s71, s71, 0x1ffff
    s_sub_u32 s73, s73, 1
    s_cmp_lg_u32 s73, 0
    s_cbranch_scc1 gl_50
    s_waitcnt lgkmcnt(0)
    v_mfma_f32_16x16x32_bf16 v[80:83], v[4:7], v[36:39], v[80:83]
    ds_read_b128 v[12:15], v74 offset:2048
    v_mfma_f32_16x16x32_bf16 v[84:87], v[4:7], v[40:43], v[84:87]
    ds_read_b128 v[16:19], v74 offset:3072
    v_mfma_f32_16x16x32_bf16 v[88:91], v[8:11], v[36:39], v[88:91]
    v_mfma_f32_16x16x32_bf16 v[92:95], v[8:11], v[40:43], v[92:95]
    s_waitcnt vmcnt(12) lgkmcnt(0)
    s_barrier
    v_mfma_f32_16x16x32_bf16 v[96:99], v[12:15], v[36:39], v[96:99]
    v_add_u32 v74, s72, v72
    v_add_u32 v75, s72, v73
    v_xor_b32 v76, 32, v75
    s_add_u32 s72, s72, 16384
    s_and_b32 s72, s72, 0x1ffff
    v_mfma_f32_16x16x32_bf16 v[100:103], v[12:15], v[40:43], v[100:103]
    ds_read_b128 v[4:7], v74 offset:0
    ds_read_b64_tr_b16 v[52:53], v75 offset:0
    v_mfma_f32_16x16x32_bf16 v[104:107], v[16:19], v[36:39], v[104:107]
    ds_read_b64_tr_b16 v[54:55], v75 offset:1024
    ds_read_b64_tr_b16 v[56:57], v76 offset:0
    v_mfma_f32_16x16x32_bf16 v[108:111], v[16:19], v[40:43], v[108:111]
    ds_read_b64_tr_b16 v[58:59], v76 offset:1024
    ds_read_b128 v[8:11], v74 offset:1024
    s_waitcnt lgkmcnt(0)
    v_mfma_f32_16x16x32_bf16 v[80:83], v[4:7], v[52:55], v[80:83]
    ds_read_b128 v[12:15], v74 offset:2048
    v_mfma_f32_16x16x32_bf16 v[84:87], v[4:7], v[56:59], v[84:87]
    ds_read_b128 v[16:19], v74 offset:3072
    v_mfma_f32_16x16x32_bf16 v[88:91], v[8:11], v[52:55], v[88:91]
    v_mfma_f32_16x16x32_bf16 v[92:95], v[8:11], v[56:59], v[92:95]
    s_waitcnt vmcnt(10) lgkmcnt(0)
    s_barrier
    v_mfma_f32_16x16x32_bf16 v[96:99], v[12:15], v[52:55], v[96:99]
    v_add_u32 v74, s72, v72
    v_add_u32 v75, s72, v73
    v_xor_b32 v76, 32, v75
    s_add_u32 s72, s72, 16384
    s_and_b32 s72, s72, 0x1ffff
    v_mfma_f32_16x16x32_bf16 v[100:103], v[12:15], v[56:59], v[100:103]
    ds_read_b128 v[4:7], v74 offset:0
    ds_read_b64_tr_b16 v[36:37], v75 offset:0
    v_mfma_f32_16x16x32_bf16 v[104:107], v[16:19], v[52:55], v[104:107]
    ds_read_b64_tr_b16 v[38:39], v75 offset:1024
    ds_read_b64_tr_b16 v[40:41], v76 offset:0
    v_mfma_f32_16x16x32_bf16 v[108:111], v[16:19], v[56:59], v[108:111]
    ds_read_b64_tr_b16 v[42:43], v76 offset:1024
    ds_read_b128 v[8:11], v74 offset:1024
    s_waitcnt lgkmcnt(0)
    v_mfma_f32_16x16x32_bf16 v[80:83], v[4:7], v[36:39], v[80:83]
    ds_read_b128 v[12:15], v74 offset:2048
    v_mfma_f32_16x16x32_bf16 v[84:87], v[4:7], v[40:43], v[84:87]
    ds_read_b128 v[16:19], v74 offset:3072
    v_mfma_f32_16x16x32_bf16 v[88:91], v[8:11], v[36:39], v[88:91]
    v_mfma_f32_16x16x32_bf16 v[92:95], v[8:11], v[40:43], v[92:95]
    s_waitcnt vmcnt(8) lgkmcnt(0)
    s_barrier
    v_mfma_f32_16x16x32_bf16 v[96:99], v[12:15], v[36:39], v[96:99]
    v_add_u32 v74, s72, v72
    v_add_u32 v75, s72, v73
    v_xor_b32 v76, 32, v75
    s_add_u32 s72, s72, 16384
    s_and_b32 s72, s72, 0x1ffff
    v_mfma_f32_16x16x32_bf16 v[100:103], v[12:15], v[40:43], v[100:103]
    ds_read_b128 v[4:7], v74 offset:0
    ds_read_b64_tr_b16 v[52:53], v75 offset:0
    v_mfma_f32_16x16x32_bf16 v[104:107], v[16:19], v[36:39], v[104:107]
    ds_read_b64_tr_b16 v[54:55], v75 offset:1024
    ds_read_b64_tr_b16 v[56:57], v76 offset:0
    v_mfma_f32_16x16x32_bf16 v[108:111], v[16:19], v[40:43], v[108:111]
    ds_read_b64_tr_b16 v[58:59], v76 offset:1024
    ds_read_b128 v[8:11], v74 offset:1024
    s_waitcnt lgkmcnt(0)
    v_mfma_f32_16x16x32_bf16 v[80:83], v[4:7], v[52:55], v[80:83]
    ds_read_b128 v[12:15], v74 offset:2048
    v_mfma_f32_16x16x32_bf16 v[84:87], v[4:7], v[56:59], v[84:87]
    ds_read_b128 v[16:19], v74 offset:3072
    v_mfma_f32_16x16x32_bf16 v[88:91], v[8:11], v[52:55], v[88:91]
    v_mfma_f32_16x16x32_bf16 v[92:95], v[8:11], v[56:59], v[92:95]
    s_waitcnt vmcnt(6) lgkmcnt(0)
    s_barrier
    v_mfma_f32_16x16x32_bf16 v[96:99], v[12:15], v[52:55], v[96:99]
    v_add_u32 v74, s72, v72
    v_add_u32 v75, s72, v73
    v_xor_b32 v76, 32, v75
    s_add_u32 s72, s72, 16384
    s_and_b32 s72, s72, 0x1ffff
    v_mfma_f32_16x16x32_bf16 v[100:103], v[12:15], v[56:59], v[100:103]
    ds_read_b128 v[4:7], v74 offset:0
    ds_read_b64_tr_b16 v[36:37], v75 offset:0
    v_mfma_f32_16x16x32_bf16 v[104:107], v[16:19], v[52:55], v[104:107]
    ds_read_b64_tr_b16 v[38:39], v75 offset:1024
    ds_read_b64_tr_b16 v[40:41], v76 offset:0
    v_mfma_f32_16x16x32_bf16 v[108:111], v[16:19], v[56:59], v[108:111]
    ds_read_b64_tr_b16 v[42:43], v76 offset:1024
    ds_read_b128 v[8:11], v74 offset:1024
    s_waitcnt lgkmcnt(0)
    v_mfma_f32_16x16x32_bf16 v[80:83], v[4:7], v[36:39], v[80:83]
    ds_read_b128 v[12:15], v74 offset:2048
    v_mfma_f32_16x16x32_bf16 v[84:87], v[4:7], v[40:43], v[84:87]
    ds_read_b128 v[16:19], v74 offset:3072
    v_mfma_f32_16x16x32_bf16 v[88:91], v[8:11], v[36:39], v[88:91]
    v_mfma_f32_16x16x32_bf16 v[92:95], v[8:11], v[40:43], v[92:95]
    s_waitcnt vmcnt(4) lgkmcnt(0)
    s_barrier
    v_mfma_f32_16x16x32_bf16 v[96:99], v[12:15], v[36:39], v[96:99]
    v_add_u32 v74, s72, v72
    v_add_u32 v75, s72, v73
    v_xor_b32 v76, 32, v75
    s_add_u32 s72, s72, 16384
    s_and_b32 s72, s72, 0x1ffff
    v_mfma_f32_16x16x32_bf16 v[100:103], v[12:15], v[40:43], v[100:103]
    ds_read_b128 v[4:7], v74 offset:0
    ds_read_b64_tr_b16 v[52:53], v75 offset:0
    v_mfma_f32_16x16x32_bf16 v[104:107], v[16:19], v[36:39], v[104:107]
    ds_read_b64_tr_b16 v[54:55], v75 offset:1024
    ds_read_b64_tr_b16 v[56:57], v76 offset:0
    v_mfma_f32_16x16x32_bf16 v[108:111], v[16:19], v[40:43], v[108:111]
    ds_read_b64_tr_b16 v[58:59], v76 offset:1024
    ds_read_b128 v[8:11], v74 offset:1024
    s_waitcnt lgkmcnt(0)
    v_mfma_f32_16x16x32_bf16 v[80:83], v[4:7], v[52:55], v[80:83]
    ds_read_b128 v[12:15], v74 offset:2048
    v_mfma_f32_16x16x32_bf16 v[84:87], v[4:7], v[56:59], v[84:87]
    ds_read_b128 v[16:19], v74 offset:3072
    v_mfma_f32_16x16x32_bf16 v[88:91], v[8:11], v[52:55], v[88:91]
    v_mfma_f32_16x16x32_bf16 v[92:95], v[8:11], v[56:59], v[92:95]
    s_waitcnt vmcnt(2) lgkmcnt(0)
    s_barrier
    v_mfma_f32_16x16x32_bf16 v[96:99], v[12:15], v[52:55], v[96:99]
    v_add_u32 v74, s72, v72
    v_add_u32 v75, s72, v73
    v_xor_b32 v76, 32, v75
    s_add_u32 s72, s72, 16384
    s_and_b32 s72, s72, 0x1ffff
    v_mfma_f32_16x16x32_bf16 v[100:103], v[12:15], v[56:59], v[100:103]
    ds_read_b128 v[4:7], v74 offset:0
    ds_read_b64_tr_b16 v[36:37], v75 offset:0
    v_mfma_f32_16x16x32_bf16 v[104:107], v[16:19], v[52:55], v[104:107]
    ds_read_b64_tr_b16 v[38:39], v75 offset:1024
    ds_read_b64_tr_b16 v[40:41], v76 offset:0
    v_mfma_f32_16x16x32_bf16 v[108:111], v[16:19], v[56:59], v[108:111]
    ds_read_b64_tr_b16 v[42:43], v76 offset:1024
    ds_read_b128 v[8:11], v74 offset:1024
    s_waitcnt lgkmcnt(0)
    v_mfma_f32_16x16x32_bf16 v[80:83], v[4:7], v[36:39], v[80:83]
    ds_read_b128 v[12:15], v74 offset:2048
    v_mfma_f32_16x16x32_bf16 v[84:87], v[4:7], v[40:43], v[84:87]
    ds_read_b128 v[16:19], v74 offset:3072
    v_mfma_f32_16x16x32_bf16 v[88:91], v[8:11], v[36:39], v[88:91]
    v_mfma_f32_16x16x32_bf16 v[92:95], v[8:11], v[40:43], v[92:95]
    s_waitcnt vmcnt(0) lgkmcnt(0)
    s_barrier
    v_mfma_f32_16x16x32_bf16 v[96:99], v[12:15], v[36:39], v[96:99]
    v_add_u32 v74, s72, v72
    v_add_u32 v75, s72, v73
    v_xor_b32 v76, 32, v75
    s_add_u32 s72, s72, 16384
    s_and_b32 s72, s72, 0x1ffff
    v_mfma_f32_16x16x32_bf16 v[100:103], v[12:15], v[40:43], v[100:103]
    ds_read_b128 v[4:7], v74 offset:0
    ds_read_b64_tr_b16 v[52:53], v75 offset:0
    v_mfma_f32_16x16x32_bf16 v[104:107], v[16:19], v[36:39], v[104:107]
    ds_read_b64_tr_b16 v[54:55], v75 offset:1024
    ds_read_b64_tr_b16 v[56:57], v76 offset:0
    v_mfma_f32_16x16x32_bf16 v[108:111], v[16:19], v[40:43], v[108:111]
    ds_read_b64_tr_b16 v[58:59], v76 offset:1024
    ds_read_b128 v[8:11], v74 offset:1024
    s_waitcnt lgkmcnt(0)
    v_mfma_f32_16x16x32_bf16 v[80:83], v[4:7], v[52:55], v[80:83]
    ds_read_b128 v[12:15], v74 offset:2048
    v_mfma_f32_16x16x32_bf16 v[84:87], v[4:7], v[56:59], v[84:87]
    ds_read_b128 v[16:19], v74 offset:3072
    v_mfma_f32_16x16x32_bf16 v[88:91], v[8:11], v[52:55], v[88:91]
    v_mfma_f32_16x16x32_bf16 v[92:95], v[8:11], v[56:59], v[92:95]
    s_waitcnt lgkmcnt(0)
    v_mfma_f32_16x16x32_bf16 v[96:99], v[12:15], v[52:55], v[96:99]
    v_mfma_f32_16x16x32_bf16 v[100:103], v[12:15], v[56:59], v[100:103]
    v_mfma_f32_16x16x32_bf16 v[104:107], v[16:19], v[52:55], v[104:107]
    v_mfma_f32_16x16x32_bf16 v[108:111], v[16:19], v[56:59], v[108:111]
    v_cvt_pk_bf16_f32 v4, v80, v81
    v_cvt_pk_bf16_f32 v5, v82, v83
    v_cvt_pk_bf16_f32 v6, v88, v89
    v_cvt_pk_bf16_f32 v7, v90, v91
    buffer_store_dwordx4 v[4:7], v79, s[8:11], s81 offen offset:0 sc1
    v_cvt_pk_bf16_f32 v8, v84, v85
    v_cvt_pk_bf16_f32 v9, v86, v87
    v_cvt_pk_bf16_f32 v10, v92, v93
    v_cvt_pk_bf16_f32 v11, v94, v95
    buffer_store_dwordx4 v[8:11], v79, s[8:11], s81 offen offset:256 sc1
    s_add_u32 s81, s81, s82
    v_cvt_pk_bf16_f32 v12, v96, v97
    v_cvt_pk_bf16_f32 v13, v98, v99
    v_cvt_pk_bf16_f32 v14, v104, v105
    v_cvt_pk_bf16_f32 v15, v106, v107
    buffer_store_dwordx4 v[12:15], v79, s[8:11], s81 offen offset:0 sc1
    v_cvt_pk_bf16_f32 v16, v100, v101
    v_cvt_pk_bf16_f32 v17, v102, v103
    v_cvt_pk_bf16_f32 v18, v108, v109
    v_cvt_pk_bf16_f32 v19, v110, v111
    buffer_store_dwordx4 v[16:19], v79, s[8:11], s81 offen offset:256 sc1
    s_branch arm_47
f128_41:
    s_mov_b32 s72, 0
    s_waitcnt vmcnt(14)
    s_barrier
    v_add_u32 v74, s72, v72
    v_add_u32 v75, s72, v73
    v_xor_b32 v76, 32, v75
    s_add_u32 s72, s72, 16384
    s_and_b32 s72, s72, 0x1ffff
    ds_read_b128 v[4:7], v74 offset:0
    ds_read_b128 v[8:11], v74 offset:1024
    ds_read_b64_tr_b16 v[36:37], v75 offset:0
    ds_read_b64_tr_b16 v[38:39], v75 offset:1024
    ds_read_b64_tr_b16 v[40:41], v76 offset:0
    ds_read_b64_tr_b16 v[42:43], v76 offset:1024
    s_waitcnt lgkmcnt(0)
    v_mfma_f32_16x16x32_bf16 v[80:83], v[36:39], v[4:7], 0
    ds_read_b128 v[12:15], v74 offset:2048
    v_mfma_f32_16x16x32_bf16 v[84:87], v[40:43], v[4:7], 0
    ds_read_b128 v[16:19], v74 offset:3072
    v_mfma_f32_16x16x32_bf16 v[88:91], v[36:39], v[8:11], 0
    v_mfma_f32_16x16x32_bf16 v[92:95], v[40:43], v[8:11], 0
    s_waitcnt vmcnt(12) lgkmcnt(0)
    s_barrier
    v_mfma_f32_16x16x32_bf16 v[96:99], v[36:39], v[12:15], 0
    v_add_u32 v74, s72, v72
    v_add_u32 v75, s72, v73
    v_xor_b32 v76, 32, v75
    s_add_u32 s72, s72, 16384
    s_and_b32 s72, s72, 0x1ffff
    ds_read_b128 v[4:7], v74 offset:0
    v_mfma_f32_16x16x32_bf16 v[100:103], v[40:43], v[12:15], 0
    ds_read_b64_tr_b16 v[52:53], v75 offset:0
    ds_read_b64_tr_b16 v[54:55], v75 offset:1024
    ds_read_b64_tr_b16 v[56:57], v76 offset:0
    ds_read_b64_tr_b16 v[58:59], v76 offset:1024
    v_mfma_f32_16x16x32_bf16 v[104:107], v[36:39], v[16:19], 0
    ds_read_b128 v[8:11], v74 offset:1024
    s_mov_b32 m0, s71
    s_nop 0
    buffer_load_dwordx4 v68, s[60:63], s68 offen lds
    s_add_u32 m0, s71, 8192
    v_mfma_f32_16x16x32_bf16 v[108:111], v[40:43], v[16:19], 0
    buffer_load_dwordx4 v70, s[64:67], s69 offen lds
    s_add_u32 s68, s68, 64
    s_add_u32 s69, s69, s70
    s_add_u32 s71, s71, 16384
    s_and_b32 s71, s71, 0x1ffff
    s_waitcnt lgkmcnt(0)
    v_mfma_f32_16x16x32_bf16 v[80:83], v[52:55], v[4:7], v[80:83]
    ds_read_b128 v[12:15], v74 offset:2048
    v_mfma_f32_16x16x32_bf16 v[84:87], v[56:59], v[4:7], v[84:87]
    ds_read_b128 v[16:19], v74 offset:3072
    v_mfma_f32_16x16x32_bf16 v[88:91], v[52:55], v[8:11], v[88:91]
    v_mfma_f32_16x16x32_bf16 v[92:95], v[56:59], v[8:11], v[92:95]
    s_waitcnt vmcnt(12) lgkmcnt(0)
    s_barrier
    v_mfma_f32_16x16x32_bf16 v[96:99], v[52:55], v[12:15], v[96:99]
    v_add_u32 v74, s72, v72
    v_add_u32 v75, s72, v73
    v_xor_b32 v76, 32, v75
    s_add_u32 s72, s72, 16384
    s_and_b32 s72, s72, 0x1ffff
    ds_read_b128 v[4:7], v74 offset:0
    v_mfma_f32_16x16x32_bf16 v[100:103], v[56:59], v[12:15], v[100:103]
    ds_read_b64_tr_b16 v[36:37], v75 offset:0
    ds_read_b64_tr_b16 v[38:39], v75 offset:1024
    ds_read_b64_tr_b16 v[40:41], v76 offset:0
    ds_read_b64_tr_b16 v[42:43], v76 offset:1024
    v_mfma_f32_16x16x32_bf16 v[104:107], v[52:55], v[16:19], v[104:107]
    ds_read_b128 v[8:11], v74 offset:1024
    s_mov_b32 m0, s71
    s_nop 0
    buffer_load_dwordx4 v68, s[60:63], s68 offen lds
    s_add_u32 m0, s71, 8192
    v_mfma_f32_16x16x32_bf16 v[108:111], v[56:59], v[16:19], v[108:111]
    buffer_load_dwordx4 v70, s[64:67], s69 offen lds
    s_add_u32 s68, s68, 64
    s_add_u32 s69, s69, s70
    s_add_u32 s71, s71, 16384
    s_and_b32 s71, s71, 0x1ffff
    s_mov_b32 s73, 11
gl_51:
    s_waitcnt lgkmcnt(0)
    v_mfma_f32_16x16x32_bf16 v[80:83], v[36:39], v[4:7], v[80:83]
    ds_read_b128 v[12:15], v74 offset:2048
    v_mfma_f32_16x16x32_bf16 v[84:87], v[40:43], v[4:7], v[84:87]
    ds_read_b128 v[16:19], v74 offset:3072
    v_mfma_f32_16x16x32_bf16 v[88:91], v[36:39], v[8:11], v[88:91]
    v_mfma_f32_16x16x32_bf16 v[92:95], v[40:43], v[8:11], v[92:95]
    s_waitcnt vmcnt(12) lgkmcnt(0)
    s_barrier
    v_mfma_f32_16x16x32_bf16 v[96:99], v[36:39], v[12:15], v[96:99]
    v_add_u32 v74, s72, v72
    v_add_u32 v75, s72, v73
    v_xor_b32 v76, 32, v75
    s_add_u32 s72, s72, 16384
    s_and_b32 s72, s72, 0x1ffff
    ds_read_b128 v[4:7], v74 offset:0
    v_mfma_f32_16x16x32_bf16 v[100:103], v[40:43], v[12:15], v[100:103]
    ds_read_b64_tr_b16 v[52:53], v75 offset:0
    ds_read_b64_tr_b16 v[54:55], v75 offset:1024
    ds_read_b64_tr_b16 v[56:57], v76 offset:0
    ds_read_b64_tr_b16 v[58:59], v76 offset:1024
    v_mfma_f32_16x16x32_bf16 v[104:107], v[36:39], v[16:19], v[104:107]
    ds_read_b128 v[8:11], v74 offset:1024
    s_mov_b32 m0, s71
    s_nop 0
    buffer_load_dwordx4 v68, s[60:63], s68 offen lds
    s_add_u32 m0, s71, 8192
    v_mfma_f32_16x16x32_bf16 v[108:111], v[40:43], v[16:19], v[108:111]
    buffer_load_dwordx4 v70, s[64:67], s69 offen lds
    s_add_u32 s68, s68, 64
    s_add_u32 s69, s69, s70
    s_add_u32 s71, s71, 16384
    s_and_b32 s71, s71, 0x1ffff
    s_waitcnt lgkmcnt(0)
    v_mfma_f32_16x16x32_bf16 v[80:83], v[52:55], v[4:7], v[80:83]
    ds_read_b128 v[12:15], v74 offset:2048
    v_mfma_f32_16x16x32_bf16 v[84:87], v[56:59], v[4:7], v[84:87]
    ds_read_b128 v[16:19], v74 offset:3072
    v_mfma_f32_16x16x32_bf16 v[88:91], v[52:55], v[8:11], v[88:91]
    v_mfma_f32_16x16x32_bf16 v[92:95], v[56:59], v[8:11], v[92:95]
    s_waitcnt vmcnt(12) lgkmcnt(0)
    s_barrier
    v_mfma_f32_16x16x32_bf16 v[96:99], v[52:55], v[12:15], v[96:99]
    v_add_u32 v74, s72, v72
    v_add_u32 v75, s72, v73
    v_xor_b32 v76, 32, v75
    s_add_u32 s72, s72, 16384
    s_and_b32 s72, s72, 0x1ffff
    ds_read_b128 v[4:7], v74 offset:0
    v_mfma_f32_16x16x32_bf16 v[100:103], v[56:59], v[12:15], v[100:103]
    ds_read_b64_tr_b16 v[36:37], v75 offset:0
    ds_read_b64_tr_b16 v[38:39], v75 offset:1024
    ds_read_b64_tr_b16 v[40:41], v76 offset:0
    ds_read_b64_tr_b16 v[42:43], v76 offset:1024
    v_mfma_f32_16x16x32_bf16 v[104:107], v[52:55], v[16:19], v[104:107]
    ds_read_b128 v[8:11], v74 offset:1024
    s_mov_b32 m0, s71
    s_nop 0
    buffer_load_dwordx4 v68, s[60:63], s68 offen lds
    s_add_u32 m0, s71, 8192
    v_mfma_f32_16x16x32_bf16 v[108:111], v[56:59], v[16:19], v[108:111]
    buffer_load_dwordx4 v70, s[64:67], s69 offen lds
    s_add_u32 s68, s68, 64
    s_add_u32 s69, s69, s70
    s_add_u32 s71, s71, 16384
    s_and_b32 s71, s71, 0x1ffff
    s_sub_u32 s73, s73, 1
    s_cmp_lg_u32 s73, 0
    s_cbranch_scc1 gl_51
    s_waitcnt lgkmcnt(0)
    v_mfma_f32_16x16x32_bf16 v[80:83], v[36:39], v[4:7], v[80:83]
    ds_read_b128 v[12:15], v74 offset:2048
    v_mfma_f32_16x16x32_bf16 v[84:87], v[40:43], v[4:7], v[84:87]
    ds_read_b128 v[16:19], v74 offset:3072
    v_mfma_f32_16x16x32_bf16 v[88:91], v[36:39], v[8:11], v[88:91]
    v_mfma_f32_16x16x32_bf16 v[92:95], v[40:43], v[8:11], v[92:95]
    s_waitcnt vmcnt(12) lgkmcnt(0)
    s_barrier
    v_mfma_f32_16x16x32_bf16 v[96:99], v[36:39], v[12:15], v[96:99]
    v_add_u32 v74, s72, v72
    v_add_u32 v75, s72, v73
    v_xor_b32 v76, 32, v75
    s_add_u32 s72, s72, 16384
    s_and_b32 s72, s72, 0x1ffff
    v_mfma_f32_16x16x32_bf16 v[100:103], v[40:43], v[12:15], v[100:103]
    ds_read_b128 v[4:7], v74 offset:0
    ds_read_b64_tr_b16 v[52:53], v75 offset:0
    v_mfma_f32_16x16x32_bf16 v[104:107], v[36:39], v[16:19], v[104:107]
    ds_read_b64_tr_b16 v[54:55], v75 offset:1024
    ds_read_b64_tr_b16 v[56:57], v76 offset:0
    v_mfma_f32_16x16x32_bf16 v[108:111], v[40:43], v[16:19], v[108:111]
    ds_read_b64_tr_b16 v[58:59], v76 offset:1024
    ds_read_b128 v[8:11], v74 offset:1024
    s_waitcnt lgkmcnt(0)
    v_mfma_f32_16x16x32_bf16 v[80:83], v[52:55], v[4:7], v[80:83]
    ds_read_b128 v[12:15], v74 offset:2048
    v_mfma_f32_16x16x32_bf16 v[84:87], v[56:59], v[4:7], v[84:87]
    ds_read_b128 v[16:19], v74 offset:3072
    v_mfma_f32_16x16x32_bf16 v[88:91], v[52:55], v[8:11], v[88:91]
    v_mfma_f32_16x16x32_bf16 v[92:95], v[56:59], v[8:11], v[92:95]
    s_waitcnt vmcnt(10) lgkmcnt(0)
    s_barrier
    v_mfma_f32_16x16x32_bf16 v[96:99], v[52:55], v[12:15], v[96:99]
    v_add_u32 v74, s72, v72
    v_add_u32 v75, s72, v73
    v_xor_b32 v76, 32, v75
    s_add_u32 s72, s72, 16384
    s_and_b32 s72, s72, 0x1ffff
    v_mfma_f32_16x16x32_bf16 v[100:103], v[56:59], v[12:15], v[100:103]
    ds_read_b128 v[4:7], v74 offset:0
    ds_read_b64_tr_b16 v[36:37], v75 offset:0
    v_mfma_f32_16x16x32_bf16 v[104:107], v[52:55], v[16:19], v[104:107]
    ds_read_b64_tr_b16 v[38:39], v75 offset:1024
    ds_read_b64_tr_b16 v[40:41], v76 offset:0
    v_mfma_f32_16x16x32_bf16 v[108:111], v[56:59], v[16:19], v[108:111]
    ds_read_b64_tr_b16 v[42:43], v76 offset:1024
    ds_read_b128 v[8:11], v74 offset:1024
    s_waitcnt lgkmcnt(0)
    v_mfma_f32_16x16x32_bf16 v[80:83], v[36:39], v[4:7], v[80:83]
    ds_read_b128 v[12:15], v74 offset:2048
    v_mfma_f32_16x16x32_bf16 v[84:87], v[40:43], v[4:7], v[84:87]
    ds_read_b128 v[16:19], v74 offset:3072
    v_mfma_f32_16x16x32_bf16 v[88:91], v[36:39], v[8:11], v[88:91]
    v_mfma_f32_16x16x32_bf16 v[92:95], v[40:43], v[8:11], v[92:95]
    s_waitcnt vmcnt(8) lgkmcnt(0)
    s_barrier
    v_mfma_f32_16x16x32_bf16 v[96:99], v[36:39], v[12:15], v[96:99]
    v_add_u32 v74, s72, v72
    v_add_u32 v75, s72, v73
    v_xor_b32 v76, 32, v75
    s_add_u32 s72, s72, 16384
    s_and_b32 s72, s72, 0x1ffff
    v_mfma_f32_16x16x32_bf16 v[100:103], v[40:43], v[12:15], v[100:103]
    ds_read_b128 v[4:7], v74 offset:0
    ds_read_b64_tr_b16 v[52:53], v75 offset:0
    v_mfma_f32_16x16x32_bf16 v[104:107], v[36:39], v[16:19], v[104:107]
    ds_read_b64_tr_b16 v[54:55], v75 offset:1024
    ds_read_b64_tr_b16 v[56:57], v76 offset:0
    v_mfma_f32_16x16x32_bf16 v[108:111], v[40:43], v[16:19], v[108:111]
    ds_read_b64_tr_b16 v[58:59], v76 offset:1024
    ds_read_b128 v[8:11], v74 offset:1024
    s_waitcnt lgkmcnt(0)
    v_mfma_f32_16x16x32_bf16 v[80:83], v[52:55], v[4:7], v[80:83]
    ds_read_b128 v[12:15], v74 offset:2048
    v_mfma_f32_16x16x32_bf16 v[84:87], v[56:59], v[4:7], v[84:87]
    ds_read_b128 v[16:19], v74 offset:3072
    v_mfma_f32_16x16x32_bf16 v[88:91], v[52:55], v[8:11], v[88:91]
    v_mfma_f32_16x16x32_bf16 v[92:95], v[56:59], v[8:11], v[92:95]
    s_waitcnt vmcnt(6) lgkmcnt(0)
    s_barrier
    v_mfma_f32_16x16x32_bf16 v[96:99], v[52:55], v[12:15], v[96:99]
    v_add_u32 v74, s72, v72
    v_add_u32 v75, s72, v73
    v_xor_b32 v76, 32, v75
    s_add_u32 s72, s72, 16384
    s_and_b32 s72, s72, 0x1ffff
    v_mfma_f32_16x16x32_bf16 v[100:103], v[56:59], v[12:15], v[100:103]
    ds_read_b128 v[4:7], v74 offset:0
    ds_read_b64_tr_b16 v[36:37], v75 offset:0
    v_mfma_f32_16x16x32_bf16 v[104:107], v[52:55], v[16:19], v[104:107]
    ds_read_b64_tr_b16 v[38:39], v75 offset:1024
    ds_read_b64_tr_b16 v[40:41], v76 offset:0
    v_mfma_f32_16x16x32_bf16 v[108:111], v[56:59], v[16:19], v[108:111]
    ds_read_b64_tr_b16 v[42:43], v76 offset:1024
    ds_read_b128 v[8:11], v74 offset:1024
    s_waitcnt lgkmcnt(0)
    v_mfma_f32_16x16x32_bf16 v[80:83], v[36:39], v[4:7], v[80:83]
    ds_read_b128 v[12:15], v74 offset:2048
    v_mfma_f32_16x16x32_bf16 v[84:87], v[40:43], v[4:7], v[84:87]
    ds_read_b128 v[16:19], v74 offset:3072
    v_mfma_f32_16x16x32_bf16 v[88:91], v[36:39], v[8:11], v[88:91]
    v_mfma_f32_16x16x32_bf16 v[92:95], v[40:43], v[8:11], v[92:95]
    s_waitcnt vmcnt(4) lgkmcnt(0)
    s_barrier
    v_mfma_f32_16x16x32_bf16 v[96:99], v[36:39], v[12:15], v[96:99]
    v_add_u32 v74, s72, v72
    v_add_u32 v75, s72, v73
    v_xor_b32 v76, 32, v75
    s_add_u32 s72, s72, 16384
    s_and_b32 s72, s72, 0x1ffff
    v_mfma_f32_16x16x32_bf16 v[100:103], v[40:43], v[12:15], v[100:103]
    ds_read_b128 v[4:7], v74 offset:0
    ds_read_b64_tr_b16 v[52:53], v75 offset:0
    v_mfma_f32_16x16x32_bf16 v[104:107], v[36:39], v[16:19], v[104:107]
    ds_read_b64_tr_b16 v[54:55], v75 offset:1024
    ds_read_b64_tr_b16 v[56:57], v76 offset:0
    v_mfma_f32_16x16x32_bf16 v[108:111], v[40:43], v[16:19], v[108:111]
    ds_read_b64_tr_b16 v[58:59], v76 offset:1024
    ds_read_b128 v[8:11], v74 offset:1024
    s_waitcnt lgkmcnt(0)
    v_mfma_f32_16x16x32_bf16 v[80:83], v[52:55], v[4:7], v[80:83]
    ds_read_b128 v[12:15], v74 offset:2048
    v_mfma_f32_16x16x32_bf16 v[84:87], v[56:59], v[4:7], v[84:87]
    ds_read_b128 v[16:19], v74 offset:3072
    v_mfma_f32_16x16x32_bf16 v[88:91], v[52:55], v[8:11], v[88:91]
    v_mfma_f32_16x16x32_bf16 v[92:95], v[56:59], v[8:11], v[92:95]
    s_waitcnt vmcnt(2) lgkmcnt(0)
    s_barrier
    v_mfma_f32_16x16x32_bf16 v[96:99], v[52:55], v[12:15], v[96:99]
    v_add_u32 v74, s72, v72
    v_add_u32 v75, s72, v73
    v_xor_b32 v76, 32, v75
    s_add_u32 s72, s72, 16384
    s_and_b32 s72, s72, 0x1ffff
    v_mfma_f32_16x16x32_bf16 v[100:103], v[56:59], v[12:15], v[100:103]
    ds_read_b128 v[4:7], v74 offset:0
    ds_read_b64_tr_b16 v[36:37], v75 offset:0
    v_mfma_f32_16x16x32_bf16 v[104:107], v[52:55], v[16:19], v[104:107]
    ds_read_b64_tr_b16 v[38:39], v75 offset:1024
    ds_read_b64_tr_b16 v[40:41], v76 offset:0
    v_mfma_f32_16x16x32_bf16 v[108:111], v[56:59], v[16:19], v[108:111]
    ds_read_b64_tr_b16 v[42:43], v76 offset:1024
    ds_read_b128 v[8:11], v74 offset:1024
    s_waitcnt lgkmcnt(0)
    v_mfma_f32_16x16x32_bf16 v[80:83], v[36:39], v[4:7], v[80:83]
    ds_read_b128 v[12:15], v74 offset:2048
    v_mfma_f32_16x16x32_bf16 v[84:87], v[40:43], v[4:7], v[84:87]
    ds_read_b128 v[16:19], v74 offset:3072
    v_mfma_f32_16x16x32_bf16 v[88:91], v[36:39], v[8:11], v[88:91]
    v_mfma_f32_16x16x32_bf16 v[92:95], v[40:43], v[8:11], v[92:95]
    s_waitcnt vmcnt(0) lgkmcnt(0)
    s_barrier
    v_mfma_f32_16x16x32_bf16 v[96:99], v[36:39], v[12:15], v[96:99]
    v_add_u32 v74, s72, v72
    v_add_u32 v75, s72, v73
    v_xor_b32 v76, 32, v75
    s_add_u32 s72, s72, 16384
    s_and_b32 s72, s72, 0x1ffff
    v_mfma_f32_16x16x32_bf16 v[100:103], v[40:43], v[12:15], v[100:103]
    ds_read_b128 v[4:7], v74 offset:0
    ds_read_b64_tr_b16 v[52:53], v75 offset:0
    v_mfma_f32_16x16x32_bf16 v[104:107], v[36:39], v[16:19], v[104:107]
    ds_read_b64_tr_b16 v[54:55], v75 offset:1024
    ds_read_b64_tr_b16 v[56:57], v76 offset:0
    v_mfma_f32_16x16x32_bf16 v[108:111], v[40:43], v[16:19], v[108:111]
    ds_read_b64_tr_b16 v[58:59], v76 offset:1024
    ds_read_b128 v[8:11], v74 offset:1024
    s_waitcnt lgkmcnt(0)
    v_mfma_f32_16x16x32_bf16 v[80:83], v[52:55], v[4:7], v[80:83]
    ds_read_b128 v[12:15], v74 offset:2048
    v_mfma_f32_16x16x32_bf16 v[84:87], v[56:59], v[4:7], v[84:87]
    ds_read_b128 v[16:19], v74 offset:3072
    v_mfma_f32_16x16x32_bf16 v[88:91], v[52:55], v[8:11], v[88:91]
    v_mfma_f32_16x16x32_bf16 v[92:95], v[56:59], v[8:11], v[92:95]
    s_waitcnt lgkmcnt(0)
    v_mfma_f32_16x16x32_bf16 v[96:99], v[52:55], v[12:15], v[96:99]
    v_mfma_f32_16x16x32_bf16 v[100:103], v[56:59], v[12:15], v[100:103]
    v_mfma_f32_16x16x32_bf16 v[104:107], v[52:55], v[16:19], v[104:107]
    v_mfma_f32_16x16x32_bf16 v[108:111], v[56:59], v[16:19], v[108:111]
    v_cvt_pk_bf16_f32 v4, v80, v81
    v_cvt_pk_bf16_f32 v5, v82, v83
    v_cvt_pk_bf16_f32 v6, v84, v85
    v_cvt_pk_bf16_f32 v7, v86, v87
    buffer_store_dwordx4 v[4:7], v79, s[8:11], s81 offen offset:0 sc1
    v_cvt_pk_bf16_f32 v8, v88, v89
    v_cvt_pk_bf16_f32 v9, v90, v91
    v_cvt_pk_bf16_f32 v10, v92, v93
    v_cvt_pk_bf16_f32 v11, v94, v95
    buffer_store_dwordx4 v[8:11], v79, s[8:11], s81 offen offset:256 sc1
    s_add_u32 s81, s81, s82
    v_cvt_pk_bf16_f32 v12, v96, v97
    v_cvt_pk_bf16_f32 v13, v98, v99
    v_cvt_pk_bf16_f32 v14, v100, v101
    v_cvt_pk_bf16_f32 v15, v102, v103
    buffer_store_dwordx4 v[12:15], v79, s[8:11], s81 offen offset:0 sc1
    v_cvt_pk_bf16_f32 v16, v104, v105
    v_cvt_pk_bf16_f32 v17, v106, v107
    v_cvt_pk_bf16_f32 v18, v108, v109
    v_cvt_pk_bf16_f32 v19, v110, v111
    buffer_store_dwordx4 v[16:19], v79, s[8:11], s81 offen offset:256 sc1
arm_47:
    s_cmp_eq_u32 s78, 0
    s_cbranch_scc1 next_45
    v_mov_b32 v132, -1
    v_mov_b32 v136, 0
    v_mov_b32 v133, -1
    v_mov_b32 v137, 0
    v_mov_b32 v134, -1
    v_mov_b32 v138, 0
    v_mov_b32 v135, -1
    v_mov_b32 v139, 0
    v_bfe_u32 v112, v1, 0, 4
    v_lshlrev_b32 v112, 4, v112
    v_bfe_u32 v113, v1, 4, 1
    v_lshl_or_b32 v112, v113, 18, v112
    v_bfe_u32 v113, v1, 5, 1
    v_lshl_or_b32 v112, v113, 22, v112
    s_lshl_b32 s84, s76, 3
    s_add_u32 s84, s84, s58
    s_lshl_b32 s81, s84, 13
    s_lshl_b32 s84, s84, 8
    s_add_u32 s84, s84, 0x4380000
    buffer_store_dwordx4 v[132:135], v112, s[8:11], s84 offen sc1
    v_lshlrev_b32 v113, 4, v1
    buffer_store_dwordx4 v[136:139], v113, s[16:19], s81 offen offset:2048 sc1
    buffer_store_dwordx4 v[136:139], v113, s[16:19], s81 offen offset:3072 sc1
    s_add_u32 s81, s81, 4096
    buffer_store_dwordx4 v[136:139], v113, s[16:19], s81 offen offset:2048 sc1
    buffer_store_dwordx4 v[136:139], v113, s[16:19], s81 offen offset:3072 sc1
    v_bfe_u32 v114, v1, 0, 4
    v_lshlrev_b32 v114, 9, v114
    s_lshl_b32 s84, s76, 2
    s_add_u32 s84, s84, 0x5100000
    v_mov_b32 v115, 0
    buffer_store_dword v115, v114, s[8:11], s84 offen
    s_lshl_b32 s84, s76, 3
    s_add_u32 s84, s84, s58
    v_lshlrev_b32 v116, 3, v1
    v_mul_u32_u24 v116, s84, v116
    v_and_b32 v117, 0x3ff, v116
    v_cvt_f32_u32 v117, v117
    v_mul_f32 v117, 0x3a800000, v117
    v_cos_f32 v118, v117
    v_sin_f32 v119, -v117
    v_add_u32 v116, s84, v116
    v_cvt_pk_bf16_f32 v122, v118, v119
    v_and_b32 v117, 0x3ff, v116
    v_cvt_f32_u32 v117, v117
    v_mul_f32 v117, 0x3a800000, v117
    v_cos_f32 v118, v117
    v_sin_f32 v119, -v117
    v_add_u32 v116, s84, v116
    v_cvt_pk_bf16_f32 v123, v118, v119
    v_and_b32 v117, 0x3ff, v116
    v_cvt_f32_u32 v117, v117
    v_mul_f32 v117, 0x3a800000, v117
    v_cos_f32 v118, v117
    v_sin_f32 v119, -v117
    v_add_u32 v116, s84, v116
    v_cvt_pk_bf16_f32 v124, v118, v119
    v_and_b32 v117, 0x3ff, v116
    v_cvt_f32_u32 v117, v117
    v_mul_f32 v117, 0x3a800000, v117
    v_cos_f32 v118, v117
    v_sin_f32 v119, -v117
    v_add_u32 v116, s84, v116
    v_cvt_pk_bf16_f32 v125, v118, v119
    v_and_b32 v117, 0x3ff, v116
    v_cvt_f32_u32 v117, v117
    v_mul_f32 v117, 0x3a800000, v117
    v_cos_f32 v118, v117
    v_sin_f32 v119, -v117
    v_add_u32 v116, s84, v116
    v_cvt_pk_bf16_f32 v126, v118, v119
    v_and_b32 v117, 0x3ff, v116
    v_cvt_f32_u32 v117, v117
    v_mul_f32 v117, 0x3a800000, v117
    v_cos_f32 v118, v117
    v_sin_f32 v119, -v117
    v_add_u32 v116, s84, v116
    v_cvt_pk_bf16_f32 v127, v118, v119
    v_and_b32 v117, 0x3ff, v116
    v_cvt_f32_u32 v117, v117
    v_mul_f32 v117, 0x3a800000, v117
    v_cos_f32 v118, v117
    v_sin_f32 v119, -v117
    v_add_u32 v116, s84, v116
    v_cvt_pk_bf16_f32 v128, v118, v119
    v_and_b32 v117, 0x3ff, v116
    v_cvt_f32_u32 v117, v117
    v_mul_f32 v117, 0x3a800000, v117
    v_cos_f32 v118, v117
    v_sin_f32 v119, -v117
    v_add_u32 v116, s84, v116
    v_cvt_pk_bf16_f32 v129, v118, v119
    v_mov_b32 v117, s84
    v_lshlrev_b32 v117, 31, v117
    v_or_b32 v117, 0x3f803f80, v117
    v_cmp_eq_u32 vcc, 0, v1
    s_nop 1
    v_cndmask_b32 v122, v122, v117, vcc
    v_lshlrev_b32 v120, 5, v1
    s_lshl_b32 s84, s84, 11
    s_add_u32 s84, s84, 0x5200000
    buffer_store_dwordx4 v[122:125], v120, s[8:11], s84 offen sc1
    buffer_store_dwordx4 v[126:129], v120, s[8:11], s84 offen offset:16 sc1
    s_branch next_45
f256_43:
    s_mov_b32 s72, 0
    s_waitcnt vmcnt(12)
    s_barrier
    v_add_u32 v74, s72, v72
    v_add_u32 v75, s72, v73
    v_xor_b32 v76, 32, v75
    v_xor_b32 v77, 64, v75
    v_xor_b32 v78, 96, v75
    s_add_u32 s72, s72, 32768
    s_and_b32 s72, s72, 0x1ffff
    ds_read_b128 v[4:7], v74 offset:0
    ds_read_b128 v[8:11], v74 offset:1024
    ds_read_b128 v[12:15], v74 offset:2048
    ds_read_b128 v[16:19], v74 offset:3072
    ds_read_b64_tr_b16 v[36:37], v75 offset:0
    ds_read_b64_tr_b16 v[38:39], v75 offset:2048
    ds_read_b64_tr_b16 v[40:41], v76 offset:0
    ds_read_b64_tr_b16 v[42:43], v76 offset:2048
    ds_read_b64_tr_b16 v[44:45], v77 offset:0
    ds_read_b64_tr_b16 v[46:47], v77 offset:2048
    ds_read_b64_tr_b16 v[48:49], v78 offset:0
    ds_read_b64_tr_b16 v[50:51], v78 offset:2048
    s_waitcnt lgkmcnt(0)
    v_mfma_f32_16x16x32_bf16 v[80:83], v[36:39], v[4:7], 0
    ds_read_b128 v[20:23], v74 offset:4096
    v_mfma_f32_16x16x32_bf16 v[84:87], v[40:43], v[4:7], 0
    v_mfma_f32_16x16x32_bf16 v[88:91], v[44:47], v[4:7], 0
    ds_read_b128 v[24:27], v74 offset:5120
    v_mfma_f32_16x16x32_bf16 v[92:95], v[48:51], v[4:7], 0
    v_mfma_f32_16x16x32_bf16 v[96:99], v[36:39], v[8:11], 0
    ds_read_b128 v[28:31], v74 offset:6144
    v_mfma_f32_16x16x32_bf16 v[100:103], v[40:43], v[8:11], 0
    v_mfma_f32_16x16x32_bf16 v[104:107], v[44:47], v[8:11], 0
    ds_read_b128 v[32:35], v74 offset:7168
    v_mfma_f32_16x16x32_bf16 v[108:111], v[48:51], v[8:11], 0
    v_mfma_f32_16x16x32_bf16 v[112:115], v[36:39], v[12:15], 0
    v_mfma_f32_16x16x32_bf16 v[116:119], v[40:43], v[12:15], 0
    v_mfma_f32_16x16x32_bf16 v[120:123], v[44:47], v[12:15], 0
    v_mfma_f32_16x16x32_bf16 v[124:127], v[48:51], v[12:15], 0
    v_mfma_f32_16x16x32_bf16 v[128:131], v[36:39], v[16:19], 0
    v_mfma_f32_16x16x32_bf16 v[132:135], v[40:43], v[16:19], 0
    v_mfma_f32_16x16x32_bf16 v[136:139], v[44:47], v[16:19], 0
    v_mfma_f32_16x16x32_bf16 v[140:143], v[48:51], v[16:19], 0
    s_waitcnt vmcnt(8) lgkmcnt(0)
    s_barrier
    v_mfma_f32_16x16x32_bf16 v[144:147], v[36:39], v[20:23], 0
    v_add_u32 v74, s72, v72
    v_add_u32 v75, s72, v73
    v_xor_b32 v76, 32, v75
    v_xor_b32 v77, 64, v75
    v_xor_b32 v78, 96, v75
    v_mfma_f32_16x16x32_bf16 v[148:151], v[40:43], v[20:23], 0
    s_add_u32 s72, s72, 32768
    s_and_b32 s72, s72, 0x1ffff
    ds_read_b128 v[4:7], v74 offset:0
    v_mfma_f32_16x16x32_bf16 v[152:155], v[44:47], v[20:23], 0
    ds_read_b64_tr_b16 v[52:53], v75 offset:0
    v_mfma_f32_16x16x32_bf16 v[156:159], v[48:51], v[20:23], 0
    ds_read_b64_tr_b16 v[54:55], v75 offset:2048
    ds_read_b64_tr_b16 v[56:57], v76 offset:0
    v_mfma_f32_16x16x32_bf16 v[160:163], v[36:39], v[24:27], 0
    ds_read_b64_tr_b16 v[58:59], v76 offset:2048
    v_mfma_f32_16x16x32_bf16 v[164:167], v[40:43], v[24:27], 0
    ds_read_b64_tr_b16 v[60:61], v77 offset:0
    ds_read_b64_tr_b16 v[62:63], v77 offset:2048
    v_mfma_f32_16x16x32_bf16 v[168:171], v[44:47], v[24:27], 0
    ds_read_b64_tr_b16 v[64:65], v78 offset:0
    v_mfma_f32_16x16x32_bf16 v[172:175], v[48:51], v[24:27], 0
    ds_read_b64_tr_b16 v[66:67], v78 offset:2048
    ds_read_b128 v[8:11], v74 offset:1024
    v_mfma_f32_16x16x32_bf16 v[176:179], v[36:39], v[28:31], 0
    ds_read_b128 v[12:15], v74 offset:2048
    ds_read_b128 v[16:19], v74 offset:3072
    v_mfma_f32_16x16x32_bf16 v[180:183], v[40:43], v[28:31], 0
    s_mov_b32 m0, s71
    v_mfma_f32_16x16x32_bf16 v[184:187], v[44:47], v[28:31], 0
    buffer_load_dwordx4 v68, s[60:63], s68 offen lds
    s_add_u32 m0, s71, 1024
    v_mfma_f32_16x16x32_bf16 v[188:191], v[48:51], v[28:31], 0
    buffer_load_dwordx4 v69, s[60:63], s68 offen lds
    v_mfma_f32_16x16x32_bf16 v[192:195], v[36:39], v[32:35], 0
    s_add_u32 m0, s71, 16384
    s_nop 0
    buffer_load_dwordx4 v70, s[64:67], s69 offen lds
    v_mfma_f32_16x16x32_bf16 v[196:199], v[40:43], v[32:35], 0
    s_add_u32 m0, s71, 17408
    v_mfma_f32_16x16x32_bf16 v[200:203], v[44:47], v[32:35], 0
    buffer_load_dwordx4 v71, s[64:67], s69 offen lds
    s_add_u32 s68, s68, 64
    s_add_u32 s69, s69, s70
    v_mfma_f32_16x16x32_bf16 v[204:207], v[48:51], v[32:35], 0
    s_add_u32 s71, s71, 32768
    s_and_b32 s71, s71, 0x1ffff
    s_waitcnt lgkmcnt(0)
    v_mfma_f32_16x16x32_bf16 v[80:83], v[52:55], v[4:7], v[80:83]
    ds_read_b128 v[20:23], v74 offset:4096
    v_mfma_f32_16x16x32_bf16 v[84:87], v[56:59], v[4:7], v[84:87]
    v_mfma_f32_16x16x32_bf16 v[88:91], v[60:63], v[4:7], v[88:91]
    ds_read_b128 v[24:27], v74 offset:5120
    v_mfma_f32_16x16x32_bf16 v[92:95], v[64:67], v[4:7], v[92:95]
    v_mfma_f32_16x16x32_bf16 v[96:99], v[52:55], v[8:11], v[96:99]
    ds_read_b128 v[28:31], v74 offset:6144
    v_mfma_f32_16x16x32_bf16 v[100:103], v[56:59], v[8:11], v[100:103]
    v_mfma_f32_16x16x32_bf16 v[104:107], v[60:63], v[8:11], v[104:107]
    ds_read_b128 v[32:35], v74 offset:7168
    v_mfma_f32_16x16x32_bf16 v[108:111], v[64:67], v[8:11], v[108:111]
    v_mfma_f32_16x16x32_bf16 v[112:115], v[52:55], v[12:15], v[112:115]
    v_mfma_f32_16x16x32_bf16 v[116:119], v[56:59], v[12:15], v[116:119]
    v_mfma_f32_16x16x32_bf16 v[120:123], v[60:63], v[12:15], v[120:123]
    v_mfma_f32_16x16x32_bf16 v[124:127], v[64:67], v[12:15], v[124:127]
    v_mfma_f32_16x16x32_bf16 v[128:131], v[52:55], v[16:19], v[128:131]
    v_mfma_f32_16x16x32_bf16 v[132:135], v[56:59], v[16:19], v[132:135]
    v_mfma_f32_16x16x32_bf16 v[136:139], v[60:63], v[16:19], v[136:139]
    v_mfma_f32_16x16x32_bf16 v[140:143], v[64:67], v[16:19], v[140:143]
    s_waitcnt vmcnt(8) lgkmcnt(0)
    s_barrier
    v_mfma_f32_16x16x32_bf16 v[144:147], v[52:55], v[20:23], v[144:147]
    v_add_u32 v74, s72, v72
    v_add_u32 v75, s72, v73
    v_xor_b32 v76, 32, v75
    v_xor_b32 v77, 64, v75
    v_xor_b32 v78, 96, v75
    v_mfma_f32_16x16x32_bf16 v[148:151], v[56:59], v[20:23], v[148:151]
    s_add_u32 s72, s72, 32768
    s_and_b32 s72, s72, 0x1ffff
    ds_read_b128 v[4:7], v74 offset:0
    v_mfma_f32_16x16x32_bf16 v[152:155], v[60:63], v[20:23], v[152:155]
    ds_read_b64_tr_b16 v[36:37], v75 offset:0
    v_mfma_f32_16x16x32_bf16 v[156:159], v[64:67], v[20:23], v[156:159]
    ds_read_b64_tr_b16 v[38:39], v75 offset:2048
    ds_read_b64_tr_b16 v[40:41], v76 offset:0
    v_mfma_f32_16x16x32_bf16 v[160:163], v[52:55], v[24:27], v[160:163]
    ds_read_b64_tr_b16 v[42:43], v76 offset:2048
    v_mfma_f32_16x16x32_bf16 v[164:167], v[56:59], v[24:27], v[164:167]
    ds_read_b64_tr_b16 v[44:45], v77 offset:0
    ds_read_b64_tr_b16 v[46:47], v77 offset:2048
    v_mfma_f32_16x16x32_bf16 v[168:171], v[60:63], v[24:27], v[168:171]
    ds_read_b64_tr_b16 v[48:49], v78 offset:0
    v_mfma_f32_16x16x32_bf16 v[172:175], v[64:67], v[24:27], v[172:175]
    ds_read_b64_tr_b16 v[50:51], v78 offset:2048
    ds_read_b128 v[8:11], v74 offset:1024
    v_mfma_f32_16x16x32_bf16 v[176:179], v[52:55], v[28:31], v[176:179]
    ds_read_b128 v[12:15], v74 offset:2048
    ds_read_b128 v[16:19], v74 offset:3072
    v_mfma_f32_16x16x32_bf16 v[180:183], v[56:59], v[28:31], v[180:183]
    s_mov_b32 m0, s71
    v_mfma_f32_16x16x32_bf16 v[184:187], v[60:63], v[28:31], v[184:187]
    buffer_load_dwordx4 v68, s[60:63], s68 offen lds
    s_add_u32 m0, s71, 1024
    v_mfma_f32_16x16x32_bf16 v[188:191], v[64:67], v[28:31], v[188:191]
    buffer_load_dwordx4 v69, s[60:63], s68 offen lds
    v_mfma_f32_16x16x32_bf16 v[192:195], v[52:55], v[32:35], v[192:195]
    s_add_u32 m0, s71, 16384
    s_nop 0
    buffer_load_dwordx4 v70, s[64:67], s69 offen lds
    v_mfma_f32_16x16x32_bf16 v[196:199], v[56:59], v[32:35], v[196:199]
    s_add_u32 m0, s71, 17408
    v_mfma_f32_16x16x32_bf16 v[200:203], v[60:63], v[32:35], v[200:203]
    buffer_load_dwordx4 v71, s[64:67], s69 offen lds
    s_add_u32 s68, s68, 64
    s_add_u32 s69, s69, s70
    v_mfma_f32_16x16x32_bf16 v[204:207], v[64:67], v[32:35], v[204:207]
    s_add_u32 s71, s71, 32768
    s_and_b32 s71, s71, 0x1ffff
    s_mov_b32 s73, 13
gl_52:
    s_waitcnt lgkmcnt(0)
    v_mfma_f32_16x16x32_bf16 v[80:83], v[36:39], v[4:7], v[80:83]
    ds_read_b128 v[20:23], v74 offset:4096
    v_mfma_f32_16x16x32_bf16 v[84:87], v[40:43], v[4:7], v[84:87]
    v_mfma_f32_16x16x32_bf16 v[88:91], v[44:47], v[4:7], v[88:91]
    ds_read_b128 v[24:27], v74 offset:5120
    v_mfma_f32_16x16x32_bf16 v[92:95], v[48:51], v[4:7], v[92:95]
    v_mfma_f32_16x16x32_bf16 v[96:99], v[36:39], v[8:11], v[96:99]
    ds_read_b128 v[28:31], v74 offset:6144
    v_mfma_f32_16x16x32_bf16 v[100:103], v[40:43], v[8:11], v[100:103]
    v_mfma_f32_16x16x32_bf16 v[104:107], v[44:47], v[8:11], v[104:107]
    ds_read_b128 v[32:35], v74 offset:7168
    v_mfma_f32_16x16x32_bf16 v[108:111], v[48:51], v[8:11], v[108:111]
    v_mfma_f32_16x16x32_bf16 v[112:115], v[36:39], v[12:15], v[112:115]
    v_mfma_f32_16x16x32_bf16 v[116:119], v[40:43], v[12:15], v[116:119]
    v_mfma_f32_16x16x32_bf16 v[120:123], v[44:47], v[12:15], v[120:123]
    v_mfma_f32_16x16x32_bf16 v[124:127], v[48:51], v[12:15], v[124:127]
    v_mfma_f32_16x16x32_bf16 v[128:131], v[36:39], v[16:19], v[128:131]
    v_mfma_f32_16x16x32_bf16 v[132:135], v[40:43], v[16:19], v[132:135]
    v_mfma_f32_16x16x32_bf16 v[136:139], v[44:47], v[16:19], v[136:139]
    v_mfma_f32_16x16x32_bf16 v[140:143], v[48:51], v[16:19], v[140:143]
    s_waitcnt vmcnt(8) lgkmcnt(0)
    s_barrier
    v_mfma_f32_16x16x32_bf16 v[144:147], v[36:39], v[20:23], v[144:147]
    v_add_u32 v74, s72, v72
    v_add_u32 v75, s72, v73
    v_xor_b32 v76, 32, v75
    v_xor_b32 v77, 64, v75
    v_xor_b32 v78, 96, v75
    v_mfma_f32_16x16x32_bf16 v[148:151], v[40:43], v[20:23], v[148:151]
    s_add_u32 s72, s72, 32768
    s_and_b32 s72, s72, 0x1ffff
    ds_read_b128 v[4:7], v74 offset:0
    v_mfma_f32_16x16x32_bf16 v[152:155], v[44:47], v[20:23], v[152:155]
    ds_read_b64_tr_b16 v[52:53], v75 offset:0
    v_mfma_f32_16x16x32_bf16 v[156:159], v[48:51], v[20:23], v[156:159]
    ds_read_b64_tr_b16 v[54:55], v75 offset:2048
    ds_read_b64_tr_b16 v[56:57], v76 offset:0
    v_mfma_f32_16x16x32_bf16 v[160:163], v[36:39], v[24:27], v[160:163]
    ds_read_b64_tr_b16 v[58:59], v76 offset:2048
    v_mfma_f32_16x16x32_bf16 v[164:167], v[40:43], v[24:27], v[164:167]
    ds_read_b64_tr_b16 v[60:61], v77 offset:0
    ds_read_b64_tr_b16 v[62:63], v77 offset:2048
    v_mfma_f32_16x16x32_bf16 v[168:171], v[44:47], v[24:27], v[168:171]
    ds_read_b64_tr_b16 v[64:65], v78 offset:0
    v_mfma_f32_16x16x32_bf16 v[172:175], v[48:51], v[24:27], v[172:175]
    ds_read_b64_tr_b16 v[66:67], v78 offset:2048
    ds_read_b128 v[8:11], v74 offset:1024
    v_mfma_f32_16x16x32_bf16 v[176:179], v[36:39], v[28:31], v[176:179]
    ds_read_b128 v[12:15], v74 offset:2048
    ds_read_b128 v[16:19], v74 offset:3072
    v_mfma_f32_16x16x32_bf16 v[180:183], v[40:43], v[28:31], v[180:183]
    s_mov_b32 m0, s71
    v_mfma_f32_16x16x32_bf16 v[184:187], v[44:47], v[28:31], v[184:187]
    buffer_load_dwordx4 v68, s[60:63], s68 offen lds
    s_add_u32 m0, s71, 1024
    v_mfma_f32_16x16x32_bf16 v[188:191], v[48:51], v[28:31], v[188:191]
    buffer_load_dwordx4 v69, s[60:63], s68 offen lds
    v_mfma_f32_16x16x32_bf16 v[192:195], v[36:39], v[32:35], v[192:195]
    s_add_u32 m0, s71, 16384
    s_nop 0
    buffer_load_dwordx4 v70, s[64:67], s69 offen lds
    v_mfma_f32_16x16x32_bf16 v[196:199], v[40:43], v[32:35], v[196:199]
    s_add_u32 m0, s71, 17408
    v_mfma_f32_16x16x32_bf16 v[200:203], v[44:47], v[32:35], v[200:203]
    buffer_load_dwordx4 v71, s[64:67], s69 offen lds
    s_add_u32 s68, s68, 64
    s_add_u32 s69, s69, s70
    v_mfma_f32_16x16x32_bf16 v[204:207], v[48:51], v[32:35], v[204:207]
    s_add_u32 s71, s71, 32768
    s_and_b32 s71, s71, 0x1ffff
    s_waitcnt lgkmcnt(0)
    v_mfma_f32_16x16x32_bf16 v[80:83], v[52:55], v[4:7], v[80:83]
    ds_read_b128 v[20:23], v74 offset:4096
    v_mfma_f32_16x16x32_bf16 v[84:87], v[56:59], v[4:7], v[84:87]
    v_mfma_f32_16x16x32_bf16 v[88:91], v[60:63], v[4:7], v[88:91]
    ds_read_b128 v[24:27], v74 offset:5120
    v_mfma_f32_16x16x32_bf16 v[92:95], v[64:67], v[4:7], v[92:95]
    v_mfma_f32_16x16x32_bf16 v[96:99], v[52:55], v[8:11], v[96:99]
    ds_read_b128 v[28:31], v74 offset:6144
    v_mfma_f32_16x16x32_bf16 v[100:103], v[56:59], v[8:11], v[100:103]
    v_mfma_f32_16x16x32_bf16 v[104:107], v[60:63], v[8:11], v[104:107]
    ds_read_b128 v[32:35], v74 offset:7168
    v_mfma_f32_16x16x32_bf16 v[108:111], v[64:67], v[8:11], v[108:111]
    v_mfma_f32_16x16x32_bf16 v[112:115], v[52:55], v[12:15], v[112:115]
    v_mfma_f32_16x16x32_bf16 v[116:119], v[56:59], v[12:15], v[116:119]
    v_mfma_f32_16x16x32_bf16 v[120:123], v[60:63], v[12:15], v[120:123]
    v_mfma_f32_16x16x32_bf16 v[124:127], v[64:67], v[12:15], v[124:127]
    v_mfma_f32_16x16x32_bf16 v[128:131], v[52:55], v[16:19], v[128:131]
    v_mfma_f32_16x16x32_bf16 v[132:135], v[56:59], v[16:19], v[132:135]
    v_mfma_f32_16x16x32_bf16 v[136:139], v[60:63], v[16:19], v[136:139]
    v_mfma_f32_16x16x32_bf16 v[140:143], v[64:67], v[16:19], v[140:143]
    s_waitcnt vmcnt(8) lgkmcnt(0)
    s_barrier
    v_mfma_f32_16x16x32_bf16 v[144:147], v[52:55], v[20:23], v[144:147]
    v_add_u32 v74, s72, v72
    v_add_u32 v75, s72, v73
    v_xor_b32 v76, 32, v75
    v_xor_b32 v77, 64, v75
    v_xor_b32 v78, 96, v75
    v_mfma_f32_16x16x32_bf16 v[148:151], v[56:59], v[20:23], v[148:151]
    s_add_u32 s72, s72, 32768
    s_and_b32 s72, s72, 0x1ffff
    ds_read_b128 v[4:7], v74 offset:0
    v_mfma_f32_16x16x32_bf16 v[152:155], v[60:63], v[20:23], v[152:155]
    ds_read_b64_tr_b16 v[36:37], v75 offset:0
    v_mfma_f32_16x16x32_bf16 v[156:159], v[64:67], v[20:23], v[156:159]
    ds_read_b64_tr_b16 v[38:39], v75 offset:2048
    ds_read_b64_tr_b16 v[40:41], v76 offset:0
    v_mfma_f32_16x16x32_bf16 v[160:163], v[52:55], v[24:27], v[160:163]
    ds_read_b64_tr_b16 v[42:43], v76 offset:2048
    v_mfma_f32_16x16x32_bf16 v[164:167], v[56:59], v[24:27], v[164:167]
    ds_read_b64_tr_b16 v[44:45], v77 offset:0
    ds_read_b64_tr_b16 v[46:47], v77 offset:2048
    v_mfma_f32_16x16x32_bf16 v[168:171], v[60:63], v[24:27], v[168:171]
    ds_read_b64_tr_b16 v[48:49], v78 offset:0
    v_mfma_f32_16x16x32_bf16 v[172:175], v[64:67], v[24:27], v[172:175]
    ds_read_b64_tr_b16 v[50:51], v78 offset:2048
    ds_read_b128 v[8:11], v74 offset:1024
    v_mfma_f32_16x16x32_bf16 v[176:179], v[52:55], v[28:31], v[176:179]
    ds_read_b128 v[12:15], v74 offset:2048
    ds_read_b128 v[16:19], v74 offset:3072
    v_mfma_f32_16x16x32_bf16 v[180:183], v[56:59], v[28:31], v[180:183]
    s_mov_b32 m0, s71
    v_mfma_f32_16x16x32_bf16 v[184:187], v[60:63], v[28:31], v[184:187]
    buffer_load_dwordx4 v68, s[60:63], s68 offen lds
    s_add_u32 m0, s71, 1024
    v_mfma_f32_16x16x32_bf16 v[188:191], v[64:67], v[28:31], v[188:191]
    buffer_load_dwordx4 v69, s[60:63], s68 offen lds
    v_mfma_f32_16x16x32_bf16 v[192:195], v[52:55], v[32:35], v[192:195]
    s_add_u32 m0, s71, 16384
    s_nop 0
    buffer_load_dwordx4 v70, s[64:67], s69 offen lds
    v_mfma_f32_16x16x32_bf16 v[196:199], v[56:59], v[32:35], v[196:199]
    s_add_u32 m0, s71, 17408
    v_mfma_f32_16x16x32_bf16 v[200:203], v[60:63], v[32:35], v[200:203]
    buffer_load_dwordx4 v71, s[64:67], s69 offen lds
    s_add_u32 s68, s68, 64
    s_add_u32 s69, s69, s70
    v_mfma_f32_16x16x32_bf16 v[204:207], v[64:67], v[32:35], v[204:207]
    s_add_u32 s71, s71, 32768
    s_and_b32 s71, s71, 0x1ffff
    s_sub_u32 s73, s73, 1
    s_cmp_lg_u32 s73, 0
    s_cbranch_scc1 gl_52
    s_waitcnt lgkmcnt(0)
    v_mfma_f32_16x16x32_bf16 v[80:83], v[36:39], v[4:7], v[80:83]
    ds_read_b128 v[20:23], v74 offset:4096
    v_mfma_f32_16x16x32_bf16 v[84:87], v[40:43], v[4:7], v[84:87]
    v_mfma_f32_16x16x32_bf16 v[88:91], v[44:47], v[4:7], v[88:91]
    ds_read_b128 v[24:27], v74 offset:5120
    v_mfma_f32_16x16x32_bf16 v[92:95], v[48:51], v[4:7], v[92:95]
    v_mfma_f32_16x16x32_bf16 v[96:99], v[36:39], v[8:11], v[96:99]
    ds_read_b128 v[28:31], v74 offset:6144
    v_mfma_f32_16x16x32_bf16 v[100:103], v[40:43], v[8:11], v[100:103]
    v_mfma_f32_16x16x32_bf16 v[104:107], v[44:47], v[8:11], v[104:107]
    ds_read_b128 v[32:35], v74 offset:7168
    v_mfma_f32_16x16x32_bf16 v[108:111], v[48:51], v[8:11], v[108:111]
    v_mfma_f32_16x16x32_bf16 v[112:115], v[36:39], v[12:15], v[112:115]
    v_mfma_f32_16x16x32_bf16 v[116:119], v[40:43], v[12:15], v[116:119]
    v_mfma_f32_16x16x32_bf16 v[120:123], v[44:47], v[12:15], v[120:123]
    v_mfma_f32_16x16x32_bf16 v[124:127], v[48:51], v[12:15], v[124:127]
    v_mfma_f32_16x16x32_bf16 v[128:131], v[36:39], v[16:19], v[128:131]
    v_mfma_f32_16x16x32_bf16 v[132:135], v[40:43], v[16:19], v[132:135]
    v_mfma_f32_16x16x32_bf16 v[136:139], v[44:47], v[16:19], v[136:139]
    v_mfma_f32_16x16x32_bf16 v[140:143], v[48:51], v[16:19], v[140:143]
    s_waitcnt vmcnt(8) lgkmcnt(0)
    s_barrier
    v_mfma_f32_16x16x32_bf16 v[144:147], v[36:39], v[20:23], v[144:147]
    v_add_u32 v74, s72, v72
    v_add_u32 v75, s72, v73
    v_mfma_f32_16x16x32_bf16 v[148:151], v[40:43], v[20:23], v[148:151]
    v_xor_b32 v76, 32, v75
    v_xor_b32 v77, 64, v75
    v_xor_b32 v78, 96, v75
    v_mfma_f32_16x16x32_bf16 v[152:155], v[44:47], v[20:23], v[152:155]
    s_add_u32 s72, s72, 32768
    s_and_b32 s72, s72, 0x1ffff
    v_mfma_f32_16x16x32_bf16 v[156:159], v[48:51], v[20:23], v[156:159]
    ds_read_b128 v[4:7], v74 offset:0
    v_mfma_f32_16x16x32_bf16 v[160:163], v[36:39], v[24:27], v[160:163]
    ds_read_b64_tr_b16 v[52:53], v75 offset:0
    v_mfma_f32_16x16x32_bf16 v[164:167], v[40:43], v[24:27], v[164:167]
    ds_read_b64_tr_b16 v[54:55], v75 offset:2048
    v_mfma_f32_16x16x32_bf16 v[168:171], v[44:47], v[24:27], v[168:171]
    ds_read_b64_tr_b16 v[56:57], v76 offset:0
    v_mfma_f32_16x16x32_bf16 v[172:175], v[48:51], v[24:27], v[172:175]
    ds_read_b64_tr_b16 v[58:59], v76 offset:2048
    v_mfma_f32_16x16x32_bf16 v[176:179], v[36:39], v[28:31], v[176:179]
    ds_read_b64_tr_b16 v[60:61], v77 offset:0
    v_mfma_f32_16x16x32_bf16 v[180:183], v[40:43], v[28:31], v[180:183]
    ds_read_b64_tr_b16 v[62:63], v77 offset:2048
    v_mfma_f32_16x16x32_bf16 v[184:187], v[44:47], v[28:31], v[184:187]
    ds_read_b64_tr_b16 v[64:65], v78 offset:0
    v_mfma_f32_16x16x32_bf16 v[188:191], v[48:51], v[28:31], v[188:191]
    ds_read_b64_tr_b16 v[66:67], v78 offset:2048
    v_mfma_f32_16x16x32_bf16 v[192:195], v[36:39], v[32:35], v[192:195]
    ds_read_b128 v[8:11], v74 offset:1024
    v_mfma_f32_16x16x32_bf16 v[196:199], v[40:43], v[32:35], v[196:199]
    ds_read_b128 v[12:15], v74 offset:2048
    v_mfma_f32_16x16x32_bf16 v[200:203], v[44:47], v[32:35], v[200:203]
    ds_read_b128 v[16:19], v74 offset:3072
    v_mfma_f32_16x16x32_bf16 v[204:207], v[48:51], v[32:35], v[204:207]
    s_waitcnt lgkmcnt(0)
    v_mfma_f32_16x16x32_bf16 v[80:83], v[52:55], v[4:7], v[80:83]
    ds_read_b128 v[20:23], v74 offset:4096
    v_mfma_f32_16x16x32_bf16 v[84:87], v[56:59], v[4:7], v[84:87]
    v_mfma_f32_16x16x32_bf16 v[88:91], v[60:63], v[4:7], v[88:91]
    ds_read_b128 v[24:27], v74 offset:5120
    v_mfma_f32_16x16x32_bf16 v[92:95], v[64:67], v[4:7], v[92:95]
    v_mfma_f32_16x16x32_bf16 v[96:99], v[52:55], v[8:11], v[96:99]
    ds_read_b128 v[28:31], v74 offset:6144
    v_mfma_f32_16x16x32_bf16 v[100:103], v[56:59], v[8:11], v[100:103]
    v_mfma_f32_16x16x32_bf16 v[104:107], v[60:63], v[8:11], v[104:107]
    ds_read_b128 v[32:35], v74 offset:7168
    v_mfma_f32_16x16x32_bf16 v[108:111], v[64:67], v[8:11], v[108:111]
    v_mfma_f32_16x16x32_bf16 v[112:115], v[52:55], v[12:15], v[112:115]
    v_mfma_f32_16x16x32_bf16 v[116:119], v[56:59], v[12:15], v[116:119]
    v_mfma_f32_16x16x32_bf16 v[120:123], v[60:63], v[12:15], v[120:123]
    v_mfma_f32_16x16x32_bf16 v[124:127], v[64:67], v[12:15], v[124:127]
    v_mfma_f32_16x16x32_bf16 v[128:131], v[52:55], v[16:19], v[128:131]
    v_mfma_f32_16x16x32_bf16 v[132:135], v[56:59], v[16:19], v[132:135]
    v_mfma_f32_16x16x32_bf16 v[136:139], v[60:63], v[16:19], v[136:139]
    v_mfma_f32_16x16x32_bf16 v[140:143], v[64:67], v[16:19], v[140:143]
    s_waitcnt vmcnt(4) lgkmcnt(0)
    s_barrier
    v_mfma_f32_16x16x32_bf16 v[144:147], v[52:55], v[20:23], v[144:147]
    v_add_u32 v74, s72, v72
    v_add_u32 v75, s72, v73
    v_mfma_f32_16x16x32_bf16 v[148:151], v[56:59], v[20:23], v[148:151]
    v_xor_b32 v76, 32, v75
    v_xor_b32 v77, 64, v75
    v_xor_b32 v78, 96, v75
    v_mfma_f32_16x16x32_bf16 v[152:155], v[60:63], v[20:23], v[152:155]
    s_add_u32 s72, s72, 32768
    s_and_b32 s72, s72, 0x1ffff
    v_mfma_f32_16x16x32_bf16 v[156:159], v[64:67], v[20:23], v[156:159]
    ds_read_b128 v[4:7], v74 offset:0
    v_mfma_f32_16x16x32_bf16 v[160:163], v[52:55], v[24:27], v[160:163]
    ds_read_b64_tr_b16 v[36:37], v75 offset:0
    v_mfma_f32_16x16x32_bf16 v[164:167], v[56:59], v[24:27], v[164:167]
    ds_read_b64_tr_b16 v[38:39], v75 offset:2048
    v_mfma_f32_16x16x32_bf16 v[168:171], v[60:63], v[24:27], v[168:171]
    ds_read_b64_tr_b16 v[40:41], v76 offset:0
    v_mfma_f32_16x16x32_bf16 v[172:175], v[64:67], v[24:27], v[172:175]
    ds_read_b64_tr_b16 v[42:43], v76 offset:2048
    v_mfma_f32_16x16x32_bf16 v[176:179], v[52:55], v[28:31], v[176:179]
    ds_read_b64_tr_b16 v[44:45], v77 offset:0
    v_mfma_f32_16x16x32_bf16 v[180:183], v[56:59], v[28:31], v[180:183]
    ds_read_b64_tr_b16 v[46:47], v77 offset:2048
    v_mfma_f32_16x16x32_bf16 v[184:187], v[60:63], v[28:31], v[184:187]
    ds_read_b64_tr_b16 v[48:49], v78 offset:0
    v_mfma_f32_16x16x32_bf16 v[188:191], v[64:67], v[28:31], v[188:191]
    ds_read_b64_tr_b16 v[50:51], v78 offset:2048
    v_mfma_f32_16x16x32_bf16 v[192:195], v[52:55], v[32:35], v[192:195]
    ds_read_b128 v[8:11], v74 offset:1024
    v_mfma_f32_16x16x32_bf16 v[196:199], v[56:59], v[32:35], v[196:199]
    ds_read_b128 v[12:15], v74 offset:2048
    v_mfma_f32_16x16x32_bf16 v[200:203], v[60:63], v[32:35], v[200:203]
    ds_read_b128 v[16:19], v74 offset:3072
    v_mfma_f32_16x16x32_bf16 v[204:207], v[64:67], v[32:35], v[204:207]
    s_waitcnt lgkmcnt(0)
    v_mfma_f32_16x16x32_bf16 v[80:83], v[36:39], v[4:7], v[80:83]
    ds_read_b128 v[20:23], v74 offset:4096
    v_mfma_f32_16x16x32_bf16 v[84:87], v[40:43], v[4:7], v[84:87]
    v_mfma_f32_16x16x32_bf16 v[88:91], v[44:47], v[4:7], v[88:91]
    ds_read_b128 v[24:27], v74 offset:5120
    v_mfma_f32_16x16x32_bf16 v[92:95], v[48:51], v[4:7], v[92:95]
    v_mfma_f32_16x16x32_bf16 v[96:99], v[36:39], v[8:11], v[96:99]
    ds_read_b128 v[28:31], v74 offset:6144
    v_mfma_f32_16x16x32_bf16 v[100:103], v[40:43], v[8:11], v[100:103]
    v_mfma_f32_16x16x32_bf16 v[104:107], v[44:47], v[8:11], v[104:107]
    ds_read_b128 v[32:35], v74 offset:7168
    v_mfma_f32_16x16x32_bf16 v[108:111], v[48:51], v[8:11], v[108:111]
    v_mfma_f32_16x16x32_bf16 v[112:115], v[36:39], v[12:15], v[112:115]
    v_mfma_f32_16x16x32_bf16 v[116:119], v[40:43], v[12:15], v[116:119]
    v_mfma_f32_16x16x32_bf16 v[120:123], v[44:47], v[12:15], v[120:123]
    v_mfma_f32_16x16x32_bf16 v[124:127], v[48:51], v[12:15], v[124:127]
    v_mfma_f32_16x16x32_bf16 v[128:131], v[36:39], v[16:19], v[128:131]
    v_mfma_f32_16x16x32_bf16 v[132:135], v[40:43], v[16:19], v[132:135]
    v_mfma_f32_16x16x32_bf16 v[136:139], v[44:47], v[16:19], v[136:139]
    v_mfma_f32_16x16x32_bf16 v[140:143], v[48:51], v[16:19], v[140:143]
    s_waitcnt vmcnt(0) lgkmcnt(0)
    s_barrier
    v_mfma_f32_16x16x32_bf16 v[144:147], v[36:39], v[20:23], v[144:147]
    v_add_u32 v74, s72, v72
    v_add_u32 v75, s72, v73
    v_mfma_f32_16x16x32_bf16 v[148:151], v[40:43], v[20:23], v[148:151]
    v_xor_b32 v76, 32, v75
    v_xor_b32 v77, 64, v75
    v_xor_b32 v78, 96, v75
    v_mfma_f32_16x16x32_bf16 v[152:155], v[44:47], v[20:23], v[152:155]
    s_add_u32 s72, s72, 32768
    s_and_b32 s72, s72, 0x1ffff
    v_mfma_f32_16x16x32_bf16 v[156:159], v[48:51], v[20:23], v[156:159]
    ds_read_b128 v[4:7], v74 offset:0
    v_mfma_f32_16x16x32_bf16 v[160:163], v[36:39], v[24:27], v[160:163]
    ds_read_b64_tr_b16 v[52:53], v75 offset:0
    v_mfma_f32_16x16x32_bf16 v[164:167], v[40:43], v[24:27], v[164:167]
    ds_read_b64_tr_b16 v[54:55], v75 offset:2048
    v_mfma_f32_16x16x32_bf16 v[168:171], v[44:47], v[24:27], v[168:171]
    ds_read_b64_tr_b16 v[56:57], v76 offset:0
    v_mfma_f32_16x16x32_bf16 v[172:175], v[48:51], v[24:27], v[172:175]
    ds_read_b64_tr_b16 v[58:59], v76 offset:2048
    v_mfma_f32_16x16x32_bf16 v[176:179], v[36:39], v[28:31], v[176:179]
    ds_read_b64_tr_b16 v[60:61], v77 offset:0
    v_mfma_f32_16x16x32_bf16 v[180:183], v[40:43], v[28:31], v[180:183]
    ds_read_b64_tr_b16 v[62:63], v77 offset:2048
    v_mfma_f32_16x16x32_bf16 v[184:187], v[44:47], v[28:31], v[184:187]
    ds_read_b64_tr_b16 v[64:65], v78 offset:0
    v_mfma_f32_16x16x32_bf16 v[188:191], v[48:51], v[28:31], v[188:191]
    ds_read_b64_tr_b16 v[66:67], v78 offset:2048
    v_mfma_f32_16x16x32_bf16 v[192:195], v[36:39], v[32:35], v[192:195]
    ds_read_b128 v[8:11], v74 offset:1024
    v_mfma_f32_16x16x32_bf16 v[196:199], v[40:43], v[32:35], v[196:199]
    ds_read_b128 v[12:15], v74 offset:2048
    v_mfma_f32_16x16x32_bf16 v[200:203], v[44:47], v[32:35], v[200:203]
    ds_read_b128 v[16:19], v74 offset:3072
    v_mfma_f32_16x16x32_bf16 v[204:207], v[48:51], v[32:35], v[204:207]
    s_waitcnt lgkmcnt(0)
    v_mfma_f32_16x16x32_bf16 v[80:83], v[52:55], v[4:7], v[80:83]
    ds_read_b128 v[20:23], v74 offset:4096
    v_mfma_f32_16x16x32_bf16 v[84:87], v[56:59], v[4:7], v[84:87]
    v_mfma_f32_16x16x32_bf16 v[88:91], v[60:63], v[4:7], v[88:91]
    ds_read_b128 v[24:27], v74 offset:5120
    v_mfma_f32_16x16x32_bf16 v[92:95], v[64:67], v[4:7], v[92:95]
    v_mfma_f32_16x16x32_bf16 v[96:99], v[52:55], v[8:11], v[96:99]
    ds_read_b128 v[28:31], v74 offset:6144
    v_mfma_f32_16x16x32_bf16 v[100:103], v[56:59], v[8:11], v[100:103]
    v_mfma_f32_16x16x32_bf16 v[104:107], v[60:63], v[8:11], v[104:107]
    ds_read_b128 v[32:35], v74 offset:7168
    v_mfma_f32_16x16x32_bf16 v[108:111], v[64:67], v[8:11], v[108:111]
    v_mfma_f32_16x16x32_bf16 v[112:115], v[52:55], v[12:15], v[112:115]
    v_mfma_f32_16x16x32_bf16 v[116:119], v[56:59], v[12:15], v[116:119]
    v_mfma_f32_16x16x32_bf16 v[120:123], v[60:63], v[12:15], v[120:123]
    v_mfma_f32_16x16x32_bf16 v[124:127], v[64:67], v[12:15], v[124:127]
    v_mfma_f32_16x16x32_bf16 v[128:131], v[52:55], v[16:19], v[128:131]
    v_mfma_f32_16x16x32_bf16 v[132:135], v[56:59], v[16:19], v[132:135]
    v_mfma_f32_16x16x32_bf16 v[136:139], v[60:63], v[16:19], v[136:139]
    v_mfma_f32_16x16x32_bf16 v[140:143], v[64:67], v[16:19], v[140:143]
    s_waitcnt lgkmcnt(0)
    v_mfma_f32_16x16x32_bf16 v[144:147], v[52:55], v[20:23], v[144:147]
    v_mfma_f32_16x16x32_bf16 v[148:151], v[56:59], v[20:23], v[148:151]
    v_mfma_f32_16x16x32_bf16 v[152:155], v[60:63], v[20:23], v[152:155]
    v_mfma_f32_16x16x32_bf16 v[156:159], v[64:67], v[20:23], v[156:159]
    v_mfma_f32_16x16x32_bf16 v[160:163], v[52:55], v[24:27], v[160:163]
    v_mfma_f32_16x16x32_bf16 v[164:167], v[56:59], v[24:27], v[164:167]
    v_mfma_f32_16x16x32_bf16 v[168:171], v[60:63], v[24:27], v[168:171]
    v_mfma_f32_16x16x32_bf16 v[172:175], v[64:67], v[24:27], v[172:175]
    v_mfma_f32_16x16x32_bf16 v[176:179], v[52:55], v[28:31], v[176:179]
    v_mfma_f32_16x16x32_bf16 v[180:183], v[56:59], v[28:31], v[180:183]
    v_mfma_f32_16x16x32_bf16 v[184:187], v[60:63], v[28:31], v[184:187]
    v_mfma_f32_16x16x32_bf16 v[188:191], v[64:67], v[28:31], v[188:191]
    v_mfma_f32_16x16x32_bf16 v[192:195], v[52:55], v[32:35], v[192:195]
    v_mfma_f32_16x16x32_bf16 v[196:199], v[56:59], v[32:35], v[196:199]
    v_mfma_f32_16x16x32_bf16 v[200:203], v[60:63], v[32:35], v[200:203]
    v_mfma_f32_16x16x32_bf16 v[204:207], v[64:67], v[32:35], v[204:207]
    v_cvt_pk_bf16_f32 v4, v80, v81
    v_cvt_pk_bf16_f32 v5, v82, v83
    v_cvt_pk_bf16_f32 v6, v84, v85
    v_cvt_pk_bf16_f32 v7, v86, v87
    buffer_store_dwordx4 v[4:7], v79, s[8:11], s81 offen offset:0 sc1
    v_cvt_pk_bf16_f32 v8, v96, v97
    v_cvt_pk_bf16_f32 v9, v98, v99
    v_cvt_pk_bf16_f32 v10, v100, v101
    v_cvt_pk_bf16_f32 v11, v102, v103
    buffer_store_dwordx4 v[8:11], v79, s[8:11], s81 offen offset:256 sc1
    v_cvt_pk_bf16_f32 v12, v88, v89
    v_cvt_pk_bf16_f32 v13, v90, v91
    v_cvt_pk_bf16_f32 v14, v92, v93
    v_cvt_pk_bf16_f32 v15, v94, v95
    buffer_store_dwordx4 v[12:15], v79, s[8:11], s81 offen offset:2048 sc1
    v_cvt_pk_bf16_f32 v16, v104, v105
    v_cvt_pk_bf16_f32 v17, v106, v107
    v_cvt_pk_bf16_f32 v18, v108, v109
    v_cvt_pk_bf16_f32 v19, v110, v111
    buffer_store_dwordx4 v[16:19], v79, s[8:11], s81 offen offset:2304 sc1
    s_add_u32 s81, s81, s82
    v_cvt_pk_bf16_f32 v20, v112, v113
    v_cvt_pk_bf16_f32 v21, v114, v115
    v_cvt_pk_bf16_f32 v22, v116, v117
    v_cvt_pk_bf16_f32 v23, v118, v119
    buffer_store_dwordx4 v[20:23], v79, s[8:11], s81 offen offset:0 sc1
    v_cvt_pk_bf16_f32 v24, v128, v129
    v_cvt_pk_bf16_f32 v25, v130, v131
    v_cvt_pk_bf16_f32 v26, v132, v133
    v_cvt_pk_bf16_f32 v27, v134, v135
    buffer_store_dwordx4 v[24:27], v79, s[8:11], s81 offen offset:256 sc1
    v_cvt_pk_bf16_f32 v28, v120, v121
    v_cvt_pk_bf16_f32 v29, v122, v123
    v_cvt_pk_bf16_f32 v30, v124, v125
    v_cvt_pk_bf16_f32 v31, v126, v127
    buffer_store_dwordx4 v[28:31], v79, s[8:11], s81 offen offset:2048 sc1
    v_cvt_pk_bf16_f32 v32, v136, v137
    v_cvt_pk_bf16_f32 v33, v138, v139
    v_cvt_pk_bf16_f32 v34, v140, v141
    v_cvt_pk_bf16_f32 v35, v142, v143
    buffer_store_dwordx4 v[32:35], v79, s[8:11], s81 offen offset:2304 sc1
    s_add_u32 s81, s81, s82
    v_cvt_pk_bf16_f32 v36, v144, v145
    v_cvt_pk_bf16_f32 v37, v146, v147
    v_cvt_pk_bf16_f32 v38, v148, v149
    v_cvt_pk_bf16_f32 v39, v150, v151
    buffer_store_dwordx4 v[36:39], v79, s[8:11], s81 offen offset:0 sc1
    v_cvt_pk_bf16_f32 v40, v160, v161
    v_cvt_pk_bf16_f32 v41, v162, v163
    v_cvt_pk_bf16_f32 v42, v164, v165
    v_cvt_pk_bf16_f32 v43, v166, v167
    buffer_store_dwordx4 v[40:43], v79, s[8:11], s81 offen offset:256 sc1
    v_cvt_pk_bf16_f32 v44, v152, v153
    v_cvt_pk_bf16_f32 v45, v154, v155
    v_cvt_pk_bf16_f32 v46, v156, v157
    v_cvt_pk_bf16_f32 v47, v158, v159
    buffer_store_dwordx4 v[44:47], v79, s[8:11], s81 offen offset:2048 sc1
    v_cvt_pk_bf16_f32 v48, v168, v169
    v_cvt_pk_bf16_f32 v49, v170, v171
    v_cvt_pk_bf16_f32 v50, v172, v173
    v_cvt_pk_bf16_f32 v51, v174, v175
    buffer_store_dwordx4 v[48:51], v79, s[8:11], s81 offen offset:2304 sc1
    s_add_u32 s81, s81, s82
    v_cvt_pk_bf16_f32 v52, v176, v177
    v_cvt_pk_bf16_f32 v53, v178, v179
    v_cvt_pk_bf16_f32 v54, v180, v181
    v_cvt_pk_bf16_f32 v55, v182, v183
    buffer_store_dwordx4 v[52:55], v79, s[8:11], s81 offen offset:0 sc1
    v_cvt_pk_bf16_f32 v56, v192, v193
    v_cvt_pk_bf16_f32 v57, v194, v195
    v_cvt_pk_bf16_f32 v58, v196, v197
    v_cvt_pk_bf16_f32 v59, v198, v199
    buffer_store_dwordx4 v[56:59], v79, s[8:11], s81 offen offset:256 sc1
    v_cvt_pk_bf16_f32 v60, v184, v185
    v_cvt_pk_bf16_f32 v61, v186, v187
    v_cvt_pk_bf16_f32 v62, v188, v189
    v_cvt_pk_bf16_f32 v63, v190, v191
    buffer_store_dwordx4 v[60:63], v79, s[8:11], s81 offen offset:2048 sc1
    v_cvt_pk_bf16_f32 v64, v200, v201
    v_cvt_pk_bf16_f32 v65, v202, v203
    v_cvt_pk_bf16_f32 v66, v204, v205
    v_cvt_pk_bf16_f32 v67, v206, v207
    buffer_store_dwordx4 v[64:67], v79, s[8:11], s81 offen offset:2304 sc1
    s_branch next_45
t256_44:
    s_mov_b32 s72, 0
    s_waitcnt vmcnt(12)
    s_barrier
    v_add_u32 v74, s72, v72
    v_add_u32 v75, s72, v73
    v_xor_b32 v76, 32, v75
    v_xor_b32 v77, 64, v75
    v_xor_b32 v78, 96, v75
    s_add_u32 s72, s72, 32768
    s_and_b32 s72, s72, 0x1ffff
    ds_read_b128 v[4:7], v74 offset:0
    ds_read_b128 v[8:11], v74 offset:1024
    ds_read_b128 v[12:15], v74 offset:2048
    ds_read_b128 v[16:19], v74 offset:3072
    ds_read_b64_tr_b16 v[36:37], v75 offset:0
    ds_read_b64_tr_b16 v[38:39], v75 offset:2048
    ds_read_b64_tr_b16 v[40:41], v76 offset:0
    ds_read_b64_tr_b16 v[42:43], v76 offset:2048
    ds_read_b64_tr_b16 v[44:45], v77 offset:0
    ds_read_b64_tr_b16 v[46:47], v77 offset:2048
    ds_read_b64_tr_b16 v[48:49], v78 offset:0
    ds_read_b64_tr_b16 v[50:51], v78 offset:2048
    s_waitcnt lgkmcnt(0)
    v_mfma_f32_16x16x32_bf16 v[80:83], v[4:7], v[36:39], 0
    ds_read_b128 v[20:23], v74 offset:4096
    v_mfma_f32_16x16x32_bf16 v[84:87], v[4:7], v[40:43], 0
    v_mfma_f32_16x16x32_bf16 v[88:91], v[4:7], v[44:47], 0
    ds_read_b128 v[24:27], v74 offset:5120
    v_mfma_f32_16x16x32_bf16 v[92:95], v[4:7], v[48:51], 0
    v_mfma_f32_16x16x32_bf16 v[96:99], v[8:11], v[36:39], 0
    ds_read_b128 v[28:31], v74 offset:6144
    v_mfma_f32_16x16x32_bf16 v[100:103], v[8:11], v[40:43], 0
    v_mfma_f32_16x16x32_bf16 v[104:107], v[8:11], v[44:47], 0
    ds_read_b128 v[32:35], v74 offset:7168
    v_mfma_f32_16x16x32_bf16 v[108:111], v[8:11], v[48:51], 0
    v_mfma_f32_16x16x32_bf16 v[112:115], v[12:15], v[36:39], 0
    v_mfma_f32_16x16x32_bf16 v[116:119], v[12:15], v[40:43], 0
    v_mfma_f32_16x16x32_bf16 v[120:123], v[12:15], v[44:47], 0
    v_mfma_f32_16x16x32_bf16 v[124:127], v[12:15], v[48:51], 0
    v_mfma_f32_16x16x32_bf16 v[128:131], v[16:19], v[36:39], 0
    v_mfma_f32_16x16x32_bf16 v[132:135], v[16:19], v[40:43], 0
    v_mfma_f32_16x16x32_bf16 v[136:139], v[16:19], v[44:47], 0
    v_mfma_f32_16x16x32_bf16 v[140:143], v[16:19], v[48:51], 0
    s_waitcnt vmcnt(8) lgkmcnt(0)
    s_barrier
    v_mfma_f32_16x16x32_bf16 v[144:147], v[20:23], v[36:39], 0
    v_add_u32 v74, s72, v72
    v_add_u32 v75, s72, v73
    v_xor_b32 v76, 32, v75
    v_xor_b32 v77, 64, v75
    v_xor_b32 v78, 96, v75
    v_mfma_f32_16x16x32_bf16 v[148:151], v[20:23], v[40:43], 0
    s_add_u32 s72, s72, 32768
    s_and_b32 s72, s72, 0x1ffff
    ds_read_b128 v[4:7], v74 offset:0
    v_mfma_f32_16x16x32_bf16 v[152:155], v[20:23], v[44:47], 0
    ds_read_b64_tr_b16 v[52:53], v75 offset:0
    v_mfma_f32_16x16x32_bf16 v[156:159], v[20:23], v[48:51], 0
    ds_read_b64_tr_b16 v[54:55], v75 offset:2048
    ds_read_b64_tr_b16 v[56:57], v76 offset:0
    v_mfma_f32_16x16x32_bf16 v[160:163], v[24:27], v[36:39], 0
    ds_read_b64_tr_b16 v[58:59], v76 offset:2048
    v_mfma_f32_16x16x32_bf16 v[164:167], v[24:27], v[40:43], 0
    ds_read_b64_tr_b16 v[60:61], v77 offset:0
    ds_read_b64_tr_b16 v[62:63], v77 offset:2048
    v_mfma_f32_16x16x32_bf16 v[168:171], v[24:27], v[44:47], 0
    ds_read_b64_tr_b16 v[64:65], v78 offset:0
    v_mfma_f32_16x16x32_bf16 v[172:175], v[24:27], v[48:51], 0
    ds_read_b64_tr_b16 v[66:67], v78 offset:2048
    ds_read_b128 v[8:11], v74 offset:1024
    v_mfma_f32_16x16x32_bf16 v[176:179], v[28:31], v[36:39], 0
    ds_read_b128 v[12:15], v74 offset:2048
    ds_read_b128 v[16:19], v74 offset:3072
    v_mfma_f32_16x16x32_bf16 v[180:183], v[28:31], v[40:43], 0
    s_mov_b32 m0, s71
    v_mfma_f32_16x16x32_bf16 v[184:187], v[28:31], v[44:47], 0
    buffer_load_dwordx4 v68, s[60:63], s68 offen lds
    s_add_u32 m0, s71, 1024
    v_mfma_f32_16x16x32_bf16 v[188:191], v[28:31], v[48:51], 0
    buffer_load_dwordx4 v69, s[60:63], s68 offen lds
    v_mfma_f32_16x16x32_bf16 v[192:195], v[32:35], v[36:39], 0
    s_add_u32 m0, s71, 16384
    s_nop 0
    buffer_load_dwordx4 v70, s[64:67], s69 offen lds
    v_mfma_f32_16x16x32_bf16 v[196:199], v[32:35], v[40:43], 0
    s_add_u32 m0, s71, 17408
    v_mfma_f32_16x16x32_bf16 v[200:203], v[32:35], v[44:47], 0
    buffer_load_dwordx4 v71, s[64:67], s69 offen lds
    s_add_u32 s68, s68, 64
    s_add_u32 s69, s69, s70
    v_mfma_f32_16x16x32_bf16 v[204:207], v[32:35], v[48:51], 0
    s_add_u32 s71, s71, 32768
    s_and_b32 s71, s71, 0x1ffff
    s_waitcnt lgkmcnt(0)
    v_mfma_f32_16x16x32_bf16 v[80:83], v[4:7], v[52:55], v[80:83]
    ds_read_b128 v[20:23], v74 offset:4096
    v_mfma_f32_16x16x32_bf16 v[84:87], v[4:7], v[56:59], v[84:87]
    v_mfma_f32_16x16x32_bf16 v[88:91], v[4:7], v[60:63], v[88:91]
    ds_read_b128 v[24:27], v74 offset:5120
    v_mfma_f32_16x16x32_bf16 v[92:95], v[4:7], v[64:67], v[92:95]
    v_mfma_f32_16x16x32_bf16 v[96:99], v[8:11], v[52:55], v[96:99]
    ds_read_b128 v[28:31], v74 offset:6144
    v_mfma_f32_16x16x32_bf16 v[100:103], v[8:11], v[56:59], v[100:103]
    v_mfma_f32_16x16x32_bf16 v[104:107], v[8:11], v[60:63], v[104:107]
    ds_read_b128 v[32:35], v74 offset:7168
    v_mfma_f32_16x16x32_bf16 v[108:111], v[8:11], v[64:67], v[108:111]
    v_mfma_f32_16x16x32_bf16 v[112:115], v[12:15], v[52:55], v[112:115]
    v_mfma_f32_16x16x32_bf16 v[116:119], v[12:15], v[56:59], v[116:119]
    v_mfma_f32_16x16x32_bf16 v[120:123], v[12:15], v[60:63], v[120:123]
    v_mfma_f32_16x16x32_bf16 v[124:127], v[12:15], v[64:67], v[124:127]
    v_mfma_f32_16x16x32_bf16 v[128:131], v[16:19], v[52:55], v[128:131]
    v_mfma_f32_16x16x32_bf16 v[132:135], v[16:19], v[56:59], v[132:135]
    v_mfma_f32_16x16x32_bf16 v[136:139], v[16:19], v[60:63], v[136:139]
    v_mfma_f32_16x16x32_bf16 v[140:143], v[16:19], v[64:67], v[140:143]
    s_waitcnt vmcnt(8) lgkmcnt(0)
    s_barrier
    v_mfma_f32_16x16x32_bf16 v[144:147], v[20:23], v[52:55], v[144:147]
    v_add_u32 v74, s72, v72
    v_add_u32 v75, s72, v73
    v_xor_b32 v76, 32, v75
    v_xor_b32 v77, 64, v75
    v_xor_b32 v78, 96, v75
    v_mfma_f32_16x16x32_bf16 v[148:151], v[20:23], v[56:59], v[148:151]
    s_add_u32 s72, s72, 32768
    s_and_b32 s72, s72, 0x1ffff
    ds_read_b128 v[4:7], v74 offset:0
    v_mfma_f32_16x16x32_bf16 v[152:155], v[20:23], v[60:63], v[152:155]
    ds_read_b64_tr_b16 v[36:37], v75 offset:0
    v_mfma_f32_16x16x32_bf16 v[156:159], v[20:23], v[64:67], v[156:159]
    ds_read_b64_tr_b16 v[38:39], v75 offset:2048
    ds_read_b64_tr_b16 v[40:41], v76 offset:0
    v_mfma_f32_16x16x32_bf16 v[160:163], v[24:27], v[52:55], v[160:163]
    ds_read_b64_tr_b16 v[42:43], v76 offset:2048
    v_mfma_f32_16x16x32_bf16 v[164:167], v[24:27], v[56:59], v[164:167]
    ds_read_b64_tr_b16 v[44:45], v77 offset:0
    ds_read_b64_tr_b16 v[46:47], v77 offset:2048
    v_mfma_f32_16x16x32_bf16 v[168:171], v[24:27], v[60:63], v[168:171]
    ds_read_b64_tr_b16 v[48:49], v78 offset:0
    v_mfma_f32_16x16x32_bf16 v[172:175], v[24:27], v[64:67], v[172:175]
    ds_read_b64_tr_b16 v[50:51], v78 offset:2048
    ds_read_b128 v[8:11], v74 offset:1024
    v_mfma_f32_16x16x32_bf16 v[176:179], v[28:31], v[52:55], v[176:179]
    ds_read_b128 v[12:15], v74 offset:2048
    ds_read_b128 v[16:19], v74 offset:3072
    v_mfma_f32_16x16x32_bf16 v[180:183], v[28:31], v[56:59], v[180:183]
    s_mov_b32 m0, s71
    v_mfma_f32_16x16x32_bf16 v[184:187], v[28:31], v[60:63], v[184:187]
    buffer_load_dwordx4 v68, s[60:63], s68 offen lds
    s_add_u32 m0, s71, 1024
    v_mfma_f32_16x16x32_bf16 v[188:191], v[28:31], v[64:67], v[188:191]
    buffer_load_dwordx4 v69, s[60:63], s68 offen lds
    v_mfma_f32_16x16x32_bf16 v[192:195], v[32:35], v[52:55], v[192:195]
    s_add_u32 m0, s71, 16384
    s_nop 0
    buffer_load_dwordx4 v70, s[64:67], s69 offen lds
    v_mfma_f32_16x16x32_bf16 v[196:199], v[32:35], v[56:59], v[196:199]
    s_add_u32 m0, s71, 17408
    v_mfma_f32_16x16x32_bf16 v[200:203], v[32:35], v[60:63], v[200:203]
    buffer_load_dwordx4 v71, s[64:67], s69 offen lds
    s_add_u32 s68, s68, 64
    s_add_u32 s69, s69, s70
    v_mfma_f32_16x16x32_bf16 v[204:207], v[32:35], v[64:67], v[204:207]
    s_add_u32 s71, s71, 32768
    s_and_b32 s71, s71, 0x1ffff
    s_mov_b32 s73, 13
gl_53:
    s_waitcnt lgkmcnt(0)
    v_mfma_f32_16x16x32_bf16 v[80:83], v[4:7], v[36:39], v[80:83]
    ds_read_b128 v[20:23], v74 offset:4096
    v_mfma_f32_16x16x32_bf16 v[84:87], v[4:7], v[40:43], v[84:87]
    v_mfma_f32_16x16x32_bf16 v[88:91], v[4:7], v[44:47], v[88:91]
    ds_read_b128 v[24:27], v74 offset:5120
    v_mfma_f32_16x16x32_bf16 v[92:95], v[4:7], v[48:51], v[92:95]
    v_mfma_f32_16x16x32_bf16 v[96:99], v[8:11], v[36:39], v[96:99]
    ds_read_b128 v[28:31], v74 offset:6144
    v_mfma_f32_16x16x32_bf16 v[100:103], v[8:11], v[40:43], v[100:103]
    v_mfma_f32_16x16x32_bf16 v[104:107], v[8:11], v[44:47], v[104:107]
    ds_read_b128 v[32:35], v74 offset:7168
    v_mfma_f32_16x16x32_bf16 v[108:111], v[8:11], v[48:51], v[108:111]
    v_mfma_f32_16x16x32_bf16 v[112:115], v[12:15], v[36:39], v[112:115]
    v_mfma_f32_16x16x32_bf16 v[116:119], v[12:15], v[40:43], v[116:119]
    v_mfma_f32_16x16x32_bf16 v[120:123], v[12:15], v[44:47], v[120:123]
    v_mfma_f32_16x16x32_bf16 v[124:127], v[12:15], v[48:51], v[124:127]
    v_mfma_f32_16x16x32_bf16 v[128:131], v[16:19], v[36:39], v[128:131]
    v_mfma_f32_16x16x32_bf16 v[132:135], v[16:19], v[40:43], v[132:135]
    v_mfma_f32_16x16x32_bf16 v[136:139], v[16:19], v[44:47], v[136:139]
    v_mfma_f32_16x16x32_bf16 v[140:143], v[16:19], v[48:51], v[140:143]
    s_waitcnt vmcnt(8) lgkmcnt(0)
    s_barrier
    v_mfma_f32_16x16x32_bf16 v[144:147], v[20:23], v[36:39], v[144:147]
    v_add_u32 v74, s72, v72
    v_add_u32 v75, s72, v73
    v_xor_b32 v76, 32, v75
    v_xor_b32 v77, 64, v75
    v_xor_b32 v78, 96, v75
    v_mfma_f32_16x16x32_bf16 v[148:151], v[20:23], v[40:43], v[148:151]
    s_add_u32 s72, s72, 32768
    s_and_b32 s72, s72, 0x1ffff
    ds_read_b128 v[4:7], v74 offset:0
    v_mfma_f32_16x16x32_bf16 v[152:155], v[20:23], v[44:47], v[152:155]
    ds_read_b64_tr_b16 v[52:53], v75 offset:0
    v_mfma_f32_16x16x32_bf16 v[156:159], v[20:23], v[48:51], v[156:159]
    ds_read_b64_tr_b16 v[54:55], v75 offset:2048
    ds_read_b64_tr_b16 v[56:57], v76 offset:0
    v_mfma_f32_16x16x32_bf16 v[160:163], v[24:27], v[36:39], v[160:163]
    ds_read_b64_tr_b16 v[58:59], v76 offset:2048
    v_mfma_f32_16x16x32_bf16 v[164:167], v[24:27], v[40:43], v[164:167]
    ds_read_b64_tr_b16 v[60:61], v77 offset:0
    ds_read_b64_tr_b16 v[62:63], v77 offset:2048
    v_mfma_f32_16x16x32_bf16 v[168:171], v[24:27], v[44:47], v[168:171]
    ds_read_b64_tr_b16 v[64:65], v78 offset:0
    v_mfma_f32_16x16x32_bf16 v[172:175], v[24:27], v[48:51], v[172:175]
    ds_read_b64_tr_b16 v[66:67], v78 offset:2048
    ds_read_b128 v[8:11], v74 offset:1024
    v_mfma_f32_16x16x32_bf16 v[176:179], v[28:31], v[36:39], v[176:179]
    ds_read_b128 v[12:15], v74 offset:2048
    ds_read_b128 v[16:19], v74 offset:3072
    v_mfma_f32_16x16x32_bf16 v[180:183], v[28:31], v[40:43], v[180:183]
    s_mov_b32 m0, s71
    v_mfma_f32_16x16x32_bf16 v[184:187], v[28:31], v[44:47], v[184:187]
    buffer_load_dwordx4 v68, s[60:63], s68 offen lds
    s_add_u32 m0, s71, 1024
    v_mfma_f32_16x16x32_bf16 v[188:191], v[28:31], v[48:51], v[188:191]
    buffer_load_dwordx4 v69, s[60:63], s68 offen lds
    v_mfma_f32_16x16x32_bf16 v[192:195], v[32:35], v[36:39], v[192:195]
    s_add_u32 m0, s71, 16384
    s_nop 0
    buffer_load_dwordx4 v70, s[64:67], s69 offen lds
    v_mfma_f32_16x16x32_bf16 v[196:199], v[32:35], v[40:43], v[196:199]
    s_add_u32 m0, s71, 17408
    v_mfma_f32_16x16x32_bf16 v[200:203], v[32:35], v[44:47], v[200:203]
    buffer_load_dwordx4 v71, s[64:67], s69 offen lds
    s_add_u32 s68, s68, 64
    s_add_u32 s69, s69, s70
    v_mfma_f32_16x16x32_bf16 v[204:207], v[32:35], v[48:51], v[204:207]
    s_add_u32 s71, s71, 32768
    s_and_b32 s71, s71, 0x1ffff
    s_waitcnt lgkmcnt(0)
    v_mfma_f32_16x16x32_bf16 v[80:83], v[4:7], v[52:55], v[80:83]
    ds_read_b128 v[20:23], v74 offset:4096
    v_mfma_f32_16x16x32_bf16 v[84:87], v[4:7], v[56:59], v[84:87]
    v_mfma_f32_16x16x32_bf16 v[88:91], v[4:7], v[60:63], v[88:91]
    ds_read_b128 v[24:27], v74 offset:5120
    v_mfma_f32_16x16x32_bf16 v[92:95], v[4:7], v[64:67], v[92:95]
    v_mfma_f32_16x16x32_bf16 v[96:99], v[8:11], v[52:55], v[96:99]
    ds_read_b128 v[28:31], v74 offset:6144
    v_mfma_f32_16x16x32_bf16 v[100:103], v[8:11], v[56:59], v[100:103]
    v_mfma_f32_16x16x32_bf16 v[104:107], v[8:11], v[60:63], v[104:107]
    ds_read_b128 v[32:35], v74 offset:7168
    v_mfma_f32_16x16x32_bf16 v[108:111], v[8:11], v[64:67], v[108:111]
    v_mfma_f32_16x16x32_bf16 v[112:115], v[12:15], v[52:55], v[112:115]
    v_mfma_f32_16x16x32_bf16 v[116:119], v[12:15], v[56:59], v[116:119]
    v_mfma_f32_16x16x32_bf16 v[120:123], v[12:15], v[60:63], v[120:123]
    v_mfma_f32_16x16x32_bf16 v[124:127], v[12:15], v[64:67], v[124:127]
    v_mfma_f32_16x16x32_bf16 v[128:131], v[16:19], v[52:55], v[128:131]
    v_mfma_f32_16x16x32_bf16 v[132:135], v[16:19], v[56:59], v[132:135]
    v_mfma_f32_16x16x32_bf16 v[136:139], v[16:19], v[60:63], v[136:139]
    v_mfma_f32_16x16x32_bf16 v[140:143], v[16:19], v[64:67], v[140:143]
    s_waitcnt vmcnt(8) lgkmcnt(0)
    s_barrier
    v_mfma_f32_16x16x32_bf16 v[144:147], v[20:23], v[52:55], v[144:147]
    v_add_u32 v74, s72, v72
    v_add_u32 v75, s72, v73
    v_xor_b32 v76, 32, v75
    v_xor_b32 v77, 64, v75
    v_xor_b32 v78, 96, v75
    v_mfma_f32_16x16x32_bf16 v[148:151], v[20:23], v[56:59], v[148:151]
    s_add_u32 s72, s72, 32768
    s_and_b32 s72, s72, 0x1ffff
    ds_read_b128 v[4:7], v74 offset:0
    v_mfma_f32_16x16x32_bf16 v[152:155], v[20:23], v[60:63], v[152:155]
    ds_read_b64_tr_b16 v[36:37], v75 offset:0
    v_mfma_f32_16x16x32_bf16 v[156:159], v[20:23], v[64:67], v[156:159]
    ds_read_b64_tr_b16 v[38:39], v75 offset:2048
    ds_read_b64_tr_b16 v[40:41], v76 offset:0
    v_mfma_f32_16x16x32_bf16 v[160:163], v[24:27], v[52:55], v[160:163]
    ds_read_b64_tr_b16 v[42:43], v76 offset:2048
    v_mfma_f32_16x16x32_bf16 v[164:167], v[24:27], v[56:59], v[164:167]
    ds_read_b64_tr_b16 v[44:45], v77 offset:0
    ds_read_b64_tr_b16 v[46:47], v77 offset:2048
    v_mfma_f32_16x16x32_bf16 v[168:171], v[24:27], v[60:63], v[168:171]
    ds_read_b64_tr_b16 v[48:49], v78 offset:0
    v_mfma_f32_16x16x32_bf16 v[172:175], v[24:27], v[64:67], v[172:175]
    ds_read_b64_tr_b16 v[50:51], v78 offset:2048
    ds_read_b128 v[8:11], v74 offset:1024
    v_mfma_f32_16x16x32_bf16 v[176:179], v[28:31], v[52:55], v[176:179]
    ds_read_b128 v[12:15], v74 offset:2048
    ds_read_b128 v[16:19], v74 offset:3072
    v_mfma_f32_16x16x32_bf16 v[180:183], v[28:31], v[56:59], v[180:183]
    s_mov_b32 m0, s71
    v_mfma_f32_16x16x32_bf16 v[184:187], v[28:31], v[60:63], v[184:187]
    buffer_load_dwordx4 v68, s[60:63], s68 offen lds
    s_add_u32 m0, s71, 1024
    v_mfma_f32_16x16x32_bf16 v[188:191], v[28:31], v[64:67], v[188:191]
    buffer_load_dwordx4 v69, s[60:63], s68 offen lds
    v_mfma_f32_16x16x32_bf16 v[192:195], v[32:35], v[52:55], v[192:195]
    s_add_u32 m0, s71, 16384
    s_nop 0
    buffer_load_dwordx4 v70, s[64:67], s69 offen lds
    v_mfma_f32_16x16x32_bf16 v[196:199], v[32:35], v[56:59], v[196:199]
    s_add_u32 m0, s71, 17408
    v_mfma_f32_16x16x32_bf16 v[200:203], v[32:35], v[60:63], v[200:203]
    buffer_load_dwordx4 v71, s[64:67], s69 offen lds
    s_add_u32 s68, s68, 64
    s_add_u32 s69, s69, s70
    v_mfma_f32_16x16x32_bf16 v[204:207], v[32:35], v[64:67], v[204:207]
    s_add_u32 s71, s71, 32768
    s_and_b32 s71, s71, 0x1ffff
    s_sub_u32 s73, s73, 1
    s_cmp_lg_u32 s73, 0
    s_cbranch_scc1 gl_53
    s_waitcnt lgkmcnt(0)
    v_mfma_f32_16x16x32_bf16 v[80:83], v[4:7], v[36:39], v[80:83]
    ds_read_b128 v[20:23], v74 offset:4096
    v_mfma_f32_16x16x32_bf16 v[84:87], v[4:7], v[40:43], v[84:87]
    v_mfma_f32_16x16x32_bf16 v[88:91], v[4:7], v[44:47], v[88:91]
    ds_read_b128 v[24:27], v74 offset:5120
    v_mfma_f32_16x16x32_bf16 v[92:95], v[4:7], v[48:51], v[92:95]
    v_mfma_f32_16x16x32_bf16 v[96:99], v[8:11], v[36:39], v[96:99]
    ds_read_b128 v[28:31], v74 offset:6144
    v_mfma_f32_16x16x32_bf16 v[100:103], v[8:11], v[40:43], v[100:103]
    v_mfma_f32_16x16x32_bf16 v[104:107], v[8:11], v[44:47], v[104:107]
    ds_read_b128 v[32:35], v74 offset:7168
    v_mfma_f32_16x16x32_bf16 v[108:111], v[8:11], v[48:51], v[108:111]
    v_mfma_f32_16x16x32_bf16 v[112:115], v[12:15], v[36:39], v[112:115]
    v_mfma_f32_16x16x32_bf16 v[116:119], v[12:15], v[40:43], v[116:119]
    v_mfma_f32_16x16x32_bf16 v[120:123], v[12:15], v[44:47], v[120:123]
    v_mfma_f32_16x16x32_bf16 v[124:127], v[12:15], v[48:51], v[124:127]
    v_mfma_f32_16x16x32_bf16 v[128:131], v[16:19], v[36:39], v[128:131]
    v_mfma_f32_16x16x32_bf16 v[132:135], v[16:19], v[40:43], v[132:135]
    v_mfma_f32_16x16x32_bf16 v[136:139], v[16:19], v[44:47], v[136:139]
    v_mfma_f32_16x16x32_bf16 v[140:143], v[16:19], v[48:51], v[140:143]
    s_waitcnt vmcnt(8) lgkmcnt(0)
    s_barrier
    v_mfma_f32_16x16x32_bf16 v[144:147], v[20:23], v[36:39], v[144:147]
    v_add_u32 v74, s72, v72
    v_add_u32 v75, s72, v73
    v_mfma_f32_16x16x32_bf16 v[148:151], v[20:23], v[40:43], v[148:151]
    v_xor_b32 v76, 32, v75
    v_xor_b32 v77, 64, v75
    v_xor_b32 v78, 96, v75
    v_mfma_f32_16x16x32_bf16 v[152:155], v[20:23], v[44:47], v[152:155]
    s_add_u32 s72, s72, 32768
    s_and_b32 s72, s72, 0x1ffff
    v_mfma_f32_16x16x32_bf16 v[156:159], v[20:23], v[48:51], v[156:159]
    ds_read_b128 v[4:7], v74 offset:0
    v_mfma_f32_16x16x32_bf16 v[160:163], v[24:27], v[36:39], v[160:163]
    ds_read_b64_tr_b16 v[52:53], v75 offset:0
    v_mfma_f32_16x16x32_bf16 v[164:167], v[24:27], v[40:43], v[164:167]
    ds_read_b64_tr_b16 v[54:55], v75 offset:2048
    v_mfma_f32_16x16x32_bf16 v[168:171], v[24:27], v[44:47], v[168:171]
    ds_read_b64_tr_b16 v[56:57], v76 offset:0
    v_mfma_f32_16x16x32_bf16 v[172:175], v[24:27], v[48:51], v[172:175]
    ds_read_b64_tr_b16 v[58:59], v76 offset:2048
    v_mfma_f32_16x16x32_bf16 v[176:179], v[28:31], v[36:39], v[176:179]
    ds_read_b64_tr_b16 v[60:61], v77 offset:0
    v_mfma_f32_16x16x32_bf16 v[180:183], v[28:31], v[40:43], v[180:183]
    ds_read_b64_tr_b16 v[62:63], v77 offset:2048
    v_mfma_f32_16x16x32_bf16 v[184:187], v[28:31], v[44:47], v[184:187]
    ds_read_b64_tr_b16 v[64:65], v78 offset:0
    v_mfma_f32_16x16x32_bf16 v[188:191], v[28:31], v[48:51], v[188:191]
    ds_read_b64_tr_b16 v[66:67], v78 offset:2048
    v_mfma_f32_16x16x32_bf16 v[192:195], v[32:35], v[36:39], v[192:195]
    ds_read_b128 v[8:11], v74 offset:1024
    v_mfma_f32_16x16x32_bf16 v[196:199], v[32:35], v[40:43], v[196:199]
    ds_read_b128 v[12:15], v74 offset:2048
    v_mfma_f32_16x16x32_bf16 v[200:203], v[32:35], v[44:47], v[200:203]
    ds_read_b128 v[16:19], v74 offset:3072
    v_mfma_f32_16x16x32_bf16 v[204:207], v[32:35], v[48:51], v[204:207]
    s_waitcnt lgkmcnt(0)
    v_mfma_f32_16x16x32_bf16 v[80:83], v[4:7], v[52:55], v[80:83]
    ds_read_b128 v[20:23], v74 offset:4096
    v_mfma_f32_16x16x32_bf16 v[84:87], v[4:7], v[56:59], v[84:87]
    v_mfma_f32_16x16x32_bf16 v[88:91], v[4:7], v[60:63], v[88:91]
    ds_read_b128 v[24:27], v74 offset:5120
    v_mfma_f32_16x16x32_bf16 v[92:95], v[4:7], v[64:67], v[92:95]
    v_mfma_f32_16x16x32_bf16 v[96:99], v[8:11], v[52:55], v[96:99]
    ds_read_b128 v[28:31], v74 offset:6144
    v_mfma_f32_16x16x32_bf16 v[100:103], v[8:11], v[56:59], v[100:103]
    v_mfma_f32_16x16x32_bf16 v[104:107], v[8:11], v[60:63], v[104:107]
    ds_read_b128 v[32:35], v74 offset:7168
    v_mfma_f32_16x16x32_bf16 v[108:111], v[8:11], v[64:67], v[108:111]
    v_mfma_f32_16x16x32_bf16 v[112:115], v[12:15], v[52:55], v[112:115]
    v_mfma_f32_16x16x32_bf16 v[116:119], v[12:15], v[56:59], v[116:119]
    v_mfma_f32_16x16x32_bf16 v[120:123], v[12:15], v[60:63], v[120:123]
    v_mfma_f32_16x16x32_bf16 v[124:127], v[12:15], v[64:67], v[124:127]
    v_mfma_f32_16x16x32_bf16 v[128:131], v[16:19], v[52:55], v[128:131]
    v_mfma_f32_16x16x32_bf16 v[132:135], v[16:19], v[56:59], v[132:135]
    v_mfma_f32_16x16x32_bf16 v[136:139], v[16:19], v[60:63], v[136:139]
    v_mfma_f32_16x16x32_bf16 v[140:143], v[16:19], v[64:67], v[140:143]
    s_waitcnt vmcnt(4) lgkmcnt(0)
    s_barrier
    v_mfma_f32_16x16x32_bf16 v[144:147], v[20:23], v[52:55], v[144:147]
    v_add_u32 v74, s72, v72
    v_add_u32 v75, s72, v73
    v_mfma_f32_16x16x32_bf16 v[148:151], v[20:23], v[56:59], v[148:151]
    v_xor_b32 v76, 32, v75
    v_xor_b32 v77, 64, v75
    v_xor_b32 v78, 96, v75
    v_mfma_f32_16x16x32_bf16 v[152:155], v[20:23], v[60:63], v[152:155]
    s_add_u32 s72, s72, 32768
    s_and_b32 s72, s72, 0x1ffff
    v_mfma_f32_16x16x32_bf16 v[156:159], v[20:23], v[64:67], v[156:159]
    ds_read_b128 v[4:7], v74 offset:0
    v_mfma_f32_16x16x32_bf16 v[160:163], v[24:27], v[52:55], v[160:163]
    ds_read_b64_tr_b16 v[36:37], v75 offset:0
    v_mfma_f32_16x16x32_bf16 v[164:167], v[24:27], v[56:59], v[164:167]
    ds_read_b64_tr_b16 v[38:39], v75 offset:2048
    v_mfma_f32_16x16x32_bf16 v[168:171], v[24:27], v[60:63], v[168:171]
    ds_read_b64_tr_b16 v[40:41], v76 offset:0
    v_mfma_f32_16x16x32_bf16 v[172:175], v[24:27], v[64:67], v[172:175]
    ds_read_b64_tr_b16 v[42:43], v76 offset:2048
    v_mfma_f32_16x16x32_bf16 v[176:179], v[28:31], v[52:55], v[176:179]
    ds_read_b64_tr_b16 v[44:45], v77 offset:0
    v_mfma_f32_16x16x32_bf16 v[180:183], v[28:31], v[56:59], v[180:183]
    ds_read_b64_tr_b16 v[46:47], v77 offset:2048
    v_mfma_f32_16x16x32_bf16 v[184:187], v[28:31], v[60:63], v[184:187]
    ds_read_b64_tr_b16 v[48:49], v78 offset:0
    v_mfma_f32_16x16x32_bf16 v[188:191], v[28:31], v[64:67], v[188:191]
    ds_read_b64_tr_b16 v[50:51], v78 offset:2048
    v_mfma_f32_16x16x32_bf16 v[192:195], v[32:35], v[52:55], v[192:195]
    ds_read_b128 v[8:11], v74 offset:1024
    v_mfma_f32_16x16x32_bf16 v[196:199], v[32:35], v[56:59], v[196:199]
    ds_read_b128 v[12:15], v74 offset:2048
    v_mfma_f32_16x16x32_bf16 v[200:203], v[32:35], v[60:63], v[200:203]
    ds_read_b128 v[16:19], v74 offset:3072
    v_mfma_f32_16x16x32_bf16 v[204:207], v[32:35], v[64:67], v[204:207]
    s_waitcnt lgkmcnt(0)
    v_mfma_f32_16x16x32_bf16 v[80:83], v[4:7], v[36:39], v[80:83]
    ds_read_b128 v[20:23], v74 offset:4096
    v_mfma_f32_16x16x32_bf16 v[84:87], v[4:7], v[40:43], v[84:87]
    v_mfma_f32_16x16x32_bf16 v[88:91], v[4:7], v[44:47], v[88:91]
    ds_read_b128 v[24:27], v74 offset:5120
    v_mfma_f32_16x16x32_bf16 v[92:95], v[4:7], v[48:51], v[92:95]
    v_mfma_f32_16x16x32_bf16 v[96:99], v[8:11], v[36:39], v[96:99]
    ds_read_b128 v[28:31], v74 offset:6144
    v_mfma_f32_16x16x32_bf16 v[100:103], v[8:11], v[40:43], v[100:103]
    v_mfma_f32_16x16x32_bf16 v[104:107], v[8:11], v[44:47], v[104:107]
    ds_read_b128 v[32:35], v74 offset:7168
    v_mfma_f32_16x16x32_bf16 v[108:111], v[8:11], v[48:51], v[108:111]
    v_mfma_f32_16x16x32_bf16 v[112:115], v[12:15], v[36:39], v[112:115]
    v_mfma_f32_16x16x32_bf16 v[116:119], v[12:15], v[40:43], v[116:119]
    v_mfma_f32_16x16x32_bf16 v[120:123], v[12:15], v[44:47], v[120:123]
    v_mfma_f32_16x16x32_bf16 v[124:127], v[12:15], v[48:51], v[124:127]
    v_mfma_f32_16x16x32_bf16 v[128:131], v[16:19], v[36:39], v[128:131]
    v_mfma_f32_16x16x32_bf16 v[132:135], v[16:19], v[40:43], v[132:135]
    v_mfma_f32_16x16x32_bf16 v[136:139], v[16:19], v[44:47], v[136:139]
    v_mfma_f32_16x16x32_bf16 v[140:143], v[16:19], v[48:51], v[140:143]
    s_waitcnt vmcnt(0) lgkmcnt(0)
    s_barrier
    v_mfma_f32_16x16x32_bf16 v[144:147], v[20:23], v[36:39], v[144:147]
    v_add_u32 v74, s72, v72
    v_add_u32 v75, s72, v73
    v_mfma_f32_16x16x32_bf16 v[148:151], v[20:23], v[40:43], v[148:151]
    v_xor_b32 v76, 32, v75
    v_xor_b32 v77, 64, v75
    v_xor_b32 v78, 96, v75
    v_mfma_f32_16x16x32_bf16 v[152:155], v[20:23], v[44:47], v[152:155]
    s_add_u32 s72, s72, 32768
    s_and_b32 s72, s72, 0x1ffff
    v_mfma_f32_16x16x32_bf16 v[156:159], v[20:23], v[48:51], v[156:159]
    ds_read_b128 v[4:7], v74 offset:0
    v_mfma_f32_16x16x32_bf16 v[160:163], v[24:27], v[36:39], v[160:163]
    ds_read_b64_tr_b16 v[52:53], v75 offset:0
    v_mfma_f32_16x16x32_bf16 v[164:167], v[24:27], v[40:43], v[164:167]
    ds_read_b64_tr_b16 v[54:55], v75 offset:2048
    v_mfma_f32_16x16x32_bf16 v[168:171], v[24:27], v[44:47], v[168:171]
    ds_read_b64_tr_b16 v[56:57], v76 offset:0
    v_mfma_f32_16x16x32_bf16 v[172:175], v[24:27], v[48:51], v[172:175]
    ds_read_b64_tr_b16 v[58:59], v76 offset:2048
    v_mfma_f32_16x16x32_bf16 v[176:179], v[28:31], v[36:39], v[176:179]
    ds_read_b64_tr_b16 v[60:61], v77 offset:0
    v_mfma_f32_16x16x32_bf16 v[180:183], v[28:31], v[40:43], v[180:183]
    ds_read_b64_tr_b16 v[62:63], v77 offset:2048
    v_mfma_f32_16x16x32_bf16 v[184:187], v[28:31], v[44:47], v[184:187]
    ds_read_b64_tr_b16 v[64:65], v78 offset:0
    v_mfma_f32_16x16x32_bf16 v[188:191], v[28:31], v[48:51], v[188:191]
    ds_read_b64_tr_b16 v[66:67], v78 offset:2048
    v_mfma_f32_16x16x32_bf16 v[192:195], v[32:35], v[36:39], v[192:195]
    ds_read_b128 v[8:11], v74 offset:1024
    v_mfma_f32_16x16x32_bf16 v[196:199], v[32:35], v[40:43], v[196:199]
    ds_read_b128 v[12:15], v74 offset:2048
    v_mfma_f32_16x16x32_bf16 v[200:203], v[32:35], v[44:47], v[200:203]
    ds_read_b128 v[16:19], v74 offset:3072
    v_mfma_f32_16x16x32_bf16 v[204:207], v[32:35], v[48:51], v[204:207]
    s_waitcnt lgkmcnt(0)
    v_mfma_f32_16x16x32_bf16 v[80:83], v[4:7], v[52:55], v[80:83]
    ds_read_b128 v[20:23], v74 offset:4096
    v_mfma_f32_16x16x32_bf16 v[84:87], v[4:7], v[56:59], v[84:87]
    v_mfma_f32_16x16x32_bf16 v[88:91], v[4:7], v[60:63], v[88:91]
    ds_read_b128 v[24:27], v74 offset:5120
    v_mfma_f32_16x16x32_bf16 v[92:95], v[4:7], v[64:67], v[92:95]
    v_mfma_f32_16x16x32_bf16 v[96:99], v[8:11], v[52:55], v[96:99]
    ds_read_b128 v[28:31], v74 offset:6144
    v_mfma_f32_16x16x32_bf16 v[100:103], v[8:11], v[56:59], v[100:103]
    v_mfma_f32_16x16x32_bf16 v[104:107], v[8:11], v[60:63], v[104:107]
    ds_read_b128 v[32:35], v74 offset:7168
    v_mfma_f32_16x16x32_bf16 v[108:111], v[8:11], v[64:67], v[108:111]
    v_mfma_f32_16x16x32_bf16 v[112:115], v[12:15], v[52:55], v[112:115]
    v_mfma_f32_16x16x32_bf16 v[116:119], v[12:15], v[56:59], v[116:119]
    v_mfma_f32_16x16x32_bf16 v[120:123], v[12:15], v[60:63], v[120:123]
    v_mfma_f32_16x16x32_bf16 v[124:127], v[12:15], v[64:67], v[124:127]
    v_mfma_f32_16x16x32_bf16 v[128:131], v[16:19], v[52:55], v[128:131]
    v_mfma_f32_16x16x32_bf16 v[132:135], v[16:19], v[56:59], v[132:135]
    v_mfma_f32_16x16x32_bf16 v[136:139], v[16:19], v[60:63], v[136:139]
    v_mfma_f32_16x16x32_bf16 v[140:143], v[16:19], v[64:67], v[140:143]
    s_waitcnt lgkmcnt(0)
    v_mfma_f32_16x16x32_bf16 v[144:147], v[20:23], v[52:55], v[144:147]
    v_mfma_f32_16x16x32_bf16 v[148:151], v[20:23], v[56:59], v[148:151]
    v_mfma_f32_16x16x32_bf16 v[152:155], v[20:23], v[60:63], v[152:155]
    v_mfma_f32_16x16x32_bf16 v[156:159], v[20:23], v[64:67], v[156:159]
    v_mfma_f32_16x16x32_bf16 v[160:163], v[24:27], v[52:55], v[160:163]
    v_mfma_f32_16x16x32_bf16 v[164:167], v[24:27], v[56:59], v[164:167]
    v_mfma_f32_16x16x32_bf16 v[168:171], v[24:27], v[60:63], v[168:171]
    v_mfma_f32_16x16x32_bf16 v[172:175], v[24:27], v[64:67], v[172:175]
    v_mfma_f32_16x16x32_bf16 v[176:179], v[28:31], v[52:55], v[176:179]
    v_mfma_f32_16x16x32_bf16 v[180:183], v[28:31], v[56:59], v[180:183]
    v_mfma_f32_16x16x32_bf16 v[184:187], v[28:31], v[60:63], v[184:187]
    v_mfma_f32_16x16x32_bf16 v[188:191], v[28:31], v[64:67], v[188:191]
    v_mfma_f32_16x16x32_bf16 v[192:195], v[32:35], v[52:55], v[192:195]
    v_mfma_f32_16x16x32_bf16 v[196:199], v[32:35], v[56:59], v[196:199]
    v_mfma_f32_16x16x32_bf16 v[200:203], v[32:35], v[60:63], v[200:203]
    v_mfma_f32_16x16x32_bf16 v[204:207], v[32:35], v[64:67], v[204:207]
    v_cvt_pk_bf16_f32 v4, v80, v81
    v_cvt_pk_bf16_f32 v5, v82, v83
    v_cvt_pk_bf16_f32 v6, v96, v97
    v_cvt_pk_bf16_f32 v7, v98, v99
    buffer_store_dwordx4 v[4:7], v79, s[8:11], s81 offen offset:0 sc1
    v_cvt_pk_bf16_f32 v8, v84, v85
    v_cvt_pk_bf16_f32 v9, v86, v87
    v_cvt_pk_bf16_f32 v10, v100, v101
    v_cvt_pk_bf16_f32 v11, v102, v103
    buffer_store_dwordx4 v[8:11], v79, s[8:11], s81 offen offset:256 sc1
    v_cvt_pk_bf16_f32 v12, v88, v89
    v_cvt_pk_bf16_f32 v13, v90, v91
    v_cvt_pk_bf16_f32 v14, v104, v105
    v_cvt_pk_bf16_f32 v15, v106, v107
    buffer_store_dwordx4 v[12:15], v79, s[8:11], s81 offen offset:2048 sc1
    v_cvt_pk_bf16_f32 v16, v92, v93
    v_cvt_pk_bf16_f32 v17, v94, v95
    v_cvt_pk_bf16_f32 v18, v108, v109
    v_cvt_pk_bf16_f32 v19, v110, v111
    buffer_store_dwordx4 v[16:19], v79, s[8:11], s81 offen offset:2304 sc1
    s_add_u32 s81, s81, s82
    v_cvt_pk_bf16_f32 v20, v112, v113
    v_cvt_pk_bf16_f32 v21, v114, v115
    v_cvt_pk_bf16_f32 v22, v128, v129
    v_cvt_pk_bf16_f32 v23, v130, v131
    buffer_store_dwordx4 v[20:23], v79, s[8:11], s81 offen offset:0 sc1
    v_cvt_pk_bf16_f32 v24, v116, v117
    v_cvt_pk_bf16_f32 v25, v118, v119
    v_cvt_pk_bf16_f32 v26, v132, v133
    v_cvt_pk_bf16_f32 v27, v134, v135
    buffer_store_dwordx4 v[24:27], v79, s[8:11], s81 offen offset:256 sc1
    v_cvt_pk_bf16_f32 v28, v120, v121
    v_cvt_pk_bf16_f32 v29, v122, v123
    v_cvt_pk_bf16_f32 v30, v136, v137
    v_cvt_pk_bf16_f32 v31, v138, v139
    buffer_store_dwordx4 v[28:31], v79, s[8:11], s81 offen offset:2048 sc1
    v_cvt_pk_bf16_f32 v32, v124, v125
    v_cvt_pk_bf16_f32 v33, v126, v127
    v_cvt_pk_bf16_f32 v34, v140, v141
    v_cvt_pk_bf16_f32 v35, v142, v143
    buffer_store_dwordx4 v[32:35], v79, s[8:11], s81 offen offset:2304 sc1
    s_add_u32 s81, s81, s82
    v_cvt_pk_bf16_f32 v36, v144, v145
    v_cvt_pk_bf16_f32 v37, v146, v147
    v_cvt_pk_bf16_f32 v38, v160, v161
    v_cvt_pk_bf16_f32 v39, v162, v163
    buffer_store_dwordx4 v[36:39], v79, s[8:11], s81 offen offset:0 sc1
    v_cvt_pk_bf16_f32 v40, v148, v149
    v_cvt_pk_bf16_f32 v41, v150, v151
    v_cvt_pk_bf16_f32 v42, v164, v165
    v_cvt_pk_bf16_f32 v43, v166, v167
    buffer_store_dwordx4 v[40:43], v79, s[8:11], s81 offen offset:256 sc1
    v_cvt_pk_bf16_f32 v44, v152, v153
    v_cvt_pk_bf16_f32 v45, v154, v155
    v_cvt_pk_bf16_f32 v46, v168, v169
    v_cvt_pk_bf16_f32 v47, v170, v171
    buffer_store_dwordx4 v[44:47], v79, s[8:11], s81 offen offset:2048 sc1
    v_cvt_pk_bf16_f32 v48, v156, v157
    v_cvt_pk_bf16_f32 v49, v158, v159
    v_cvt_pk_bf16_f32 v50, v172, v173
    v_cvt_pk_bf16_f32 v51, v174, v175
    buffer_store_dwordx4 v[48:51], v79, s[8:11], s81 offen offset:2304 sc1
    s_add_u32 s81, s81, s82
    v_cvt_pk_bf16_f32 v52, v176, v177
    v_cvt_pk_bf16_f32 v53, v178, v179
    v_cvt_pk_bf16_f32 v54, v192, v193
    v_cvt_pk_bf16_f32 v55, v194, v195
    buffer_store_dwordx4 v[52:55], v79, s[8:11], s81 offen offset:0 sc1
    v_cvt_pk_bf16_f32 v56, v180, v181
    v_cvt_pk_bf16_f32 v57, v182, v183
    v_cvt_pk_bf16_f32 v58, v196, v197
    v_cvt_pk_bf16_f32 v59, v198, v199
    buffer_store_dwordx4 v[56:59], v79, s[8:11], s81 offen offset:256 sc1
    v_cvt_pk_bf16_f32 v60, v184, v185
    v_cvt_pk_bf16_f32 v61, v186, v187
    v_cvt_pk_bf16_f32 v62, v200, v201
    v_cvt_pk_bf16_f32 v63, v202, v203
    buffer_store_dwordx4 v[60:63], v79, s[8:11], s81 offen offset:2048 sc1
    v_cvt_pk_bf16_f32 v64, v188, v189
    v_cvt_pk_bf16_f32 v65, v190, v191
    v_cvt_pk_bf16_f32 v66, v204, v205
    v_cvt_pk_bf16_f32 v67, v206, v207
    buffer_store_dwordx4 v[64:67], v79, s[8:11], s81 offen offset:2304 sc1
next_45:
    s_waitcnt vmcnt(0)
    s_barrier
    s_cmp_lg_u32 s58, 0
    s_cbranch_scc1 sig_54
    v_mov_b32 v75, 0x5ffffff0
    v_mov_b32 v76, s83
    v_cmp_eq_u32 vcc, 0, v1
    s_nop 1
    v_cndmask_b32 v76, v75, v76, vcc
    v_mov_b32 v75, 1
    buffer_atomic_add v75, v76, s[12:15], 0 offen sc1
    s_waitcnt vmcnt(0)
sig_54:
    s_add_u32 s78, s78, 1
    s_cmp_eq_u32 s78, 1
    s_cbranch_scc1 r01_48
    s_cmp_eq_u32 s78, 5
    s_cbranch_scc1 p3_59
    v_bfe_u32 v79, v1, 0, 4
    v_lshlrev_b32 v79, 4, v79
    v_bfe_u32 v75, v1, 4, 2
    v_lshl_or_b32 v79, v75, 9, v79
    v_bfe_u32 v76, v1, 2, 2
    v_sub_u32 v76, 0, v76
    v_lshrrev_b32 v75, 4, v1
    v_xor_b32 v76, v76, v75
    v_and_b32 v76, 3, v76
    v_bfe_u32 v72, v1, 0, 4
    v_lshlrev_b32 v72, 6, v72
    v_lshl_or_b32 v72, v76, 4, v72
    s_lshr_b32 s74, s58, 2
    s_mul_i32 s74, s74, 8192
    v_add_u32 v72, s74, v72
    v_bfe_u32 v73, v1, 0, 2
    v_lshlrev_b32 v73, 3, v73
    v_bfe_u32 v75, v1, 4, 1
    v_lshl_or_b32 v73, v75, 5, v73
    v_bfe_u32 v75, v1, 2, 2
    v_lshl_or_b32 v73, v75, 6, v73
    v_bfe_u32 v75, v1, 2, 2
    v_lshl_or_b32 v73, v75, 9, v73
    v_bfe_u32 v75, v1, 4, 2
    v_lshl_or_b32 v73, v75, 12, v73
    s_and_b32 s74, s58, 3
    s_mul_i32 s74, s74, 128
    s_or_b32 s74, s74, 16384
    v_xor_b32 v73, s74, v73
    s_cmp_eq_u32 s78, 4
    s_cbranch_scc1 q_55
    s_cmp_ge_u32 s57, 24
    s_cbranch_scc1 fft_60
    s_mul_i32 s79, s78, 3
    s_lshr_b32 s84, s57, 3
    s_add_u32 s79, s79, s84
    s_sub_u32 s79, s79, 4
    s_bfe_u32 s80, s76, 0x30000
    s_bfe_u32 s84, s76, 0x10005
    s_lshl_b32 s84, s84, 3
    s_or_b32 s80, s80, s84
    s_lshl_b32 s83, s79, 3
    s_add_u32 s83, s83, 128
    s_cmp_ge_u32 s75, 2
    s_cbranch_scc1 v1_58
    s_mov_b64 s[60:61], s[36:37]
    s_mov_b32 s62, 0x400000
    s_mov_b32 s63, 0x20000
    s_mov_b64 s[64:65], s[24:25]
    s_mov_b32 s66, 0x800000
    s_mov_b32 s67, 0x20000
    v_lshrrev_b32 v76, 4, v1
    v_sub_u32 v76, 0, v76
    v_xor_b32 v76, v76, v1
    v_and_b32 v76, 3, v76
    s_mul_i32 s74, s58, 32
    v_lshrrev_b32 v77, 2, v1
    v_add3_u32 v77, v77, s74, 0
    v_lshlrev_b32 v68, 11, v77
    v_lshl_add_u32 v68, v76, 4, v68
    v_lshrrev_b32 v77, 2, v1
    v_add3_u32 v77, v77, s74, 16
    v_lshlrev_b32 v69, 11, v77
    v_lshl_add_u32 v69, v76, 4, v69
    s_and_b32 s74, s58, 2
    v_bfe_u32 v76, v1, 0, 5
    v_bfe_u32 v77, v1, 5, 1
    v_lshlrev_b32 v77, 2, v77
    v_xor_b32 v76, v76, v77
    v_xor_b32 v76, s74, v76
    v_bfe_u32 v77, v76, 0, 1
    v_lshlrev_b32 v77, 5, v77
    v_bfe_u32 v75, v76, 1, 1
    v_lshl_or_b32 v77, v75, 4, v77
    v_bfe_u32 v75, v76, 2, 3
    v_lshl_or_b32 v77, v75, 6, v77
    v_lshrrev_b32 v76, 5, v1
    v_lshl_add_u32 v70, v76, 13, v77
    v_bfe_u32 v76, v1, 0, 5
    v_bfe_u32 v77, v1, 5, 1
    v_lshlrev_b32 v77, 2, v77
    v_xor_b32 v76, v76, v77
    v_xor_b32 v76, s74, v76
    v_xor_b32 v76, 8, v76
    v_bfe_u32 v77, v76, 0, 1
    v_lshlrev_b32 v77, 5, v77
    v_bfe_u32 v75, v76, 1, 1
    v_lshl_or_b32 v77, v75, 4, v77
    v_bfe_u32 v75, v76, 2, 3
    v_lshl_or_b32 v77, v75, 6, v77
    v_lshrrev_b32 v76, 5, v1
    v_lshl_add_u32 v71, v76, 13, v77
    v_add_u32 v71, 16384, v71
    s_lshl_b32 s74, s58, 15
    v_add_u32 v70, s74, v70
    v_add_u32 v71, s74, v71
    s_mov_b32 s70, 262144
    s_mul_i32 s68, s79, 524288
    s_mul_i32 s69, s80, 512
    s_mov_b32 s82, 0x40000
    s_lshl_b32 s81, s79, 1
    s_lshr_b32 s84, s58, 2
    s_add_u32 s81, s81, s84
    s_mul_i32 s81, s81, s82
    s_mul_i32 s81, s81, 4
    s_lshl_b32 s74, s80, 2
    s_and_b32 s84, s58, 3
    s_add_u32 s84, s84, s74
    s_mul_i32 s84, s84, 4096
    s_add_u32 s81, s81, s84
    s_add_u32 s81, s81, 0x1000000
    s_mul_i32 s71, s58, 2048
    s_mov_b32 m0, s71
    s_nop 0
    buffer_load_dwordx4 v68, s[60:63], s68 offen lds
    s_add_u32 m0, s71, 1024
    s_nop 0
    buffer_load_dwordx4 v69, s[60:63], s68 offen lds
    s_add_u32 m0, s71, 16384
    s_nop 0
    buffer_load_dwordx4 v70, s[64:67], s69 offen lds
    s_add_u32 m0, s71, 17408
    s_nop 0
    buffer_load_dwordx4 v71, s[64:67], s69 offen lds
    s_add_u32 s68, s68, 64
    s_add_u32 s69, s69, s70
    s_add_u32 s71, s71, 32768
    s_and_b32 s71, s71, 0x1ffff
    s_mov_b32 m0, s71
    s_nop 0
    buffer_load_dwordx4 v68, s[60:63], s68 offen lds
    s_add_u32 m0, s71, 1024
    s_nop 0
    buffer_load_dwordx4 v69, s[60:63], s68 offen lds
    s_add_u32 m0, s71, 16384
    s_nop 0
    buffer_load_dwordx4 v70, s[64:67], s69 offen lds
    s_add_u32 m0, s71, 17408
    s_nop 0
    buffer_load_dwordx4 v71, s[64:67], s69 offen lds
    s_add_u32 s68, s68, 64
    s_add_u32 s69, s69, s70
    s_add_u32 s71, s71, 32768
    s_and_b32 s71, s71, 0x1ffff
    s_mov_b32 m0, s71
    s_nop 0
    buffer_load_dwordx4 v68, s[60:63], s68 offen lds
    s_add_u32 m0, s71, 1024
    s_nop 0
    buffer_load_dwordx4 v69, s[60:63], s68 offen lds
    s_add_u32 m0, s71, 16384
    s_nop 0
    buffer_load_dwordx4 v70, s[64:67], s69 offen lds
    s_add_u32 m0, s71, 17408
    s_nop 0
    buffer_load_dwordx4 v71, s[64:67], s69 offen lds
    s_add_u32 s68, s68, 64
    s_add_u32 s69, s69, s70
    s_add_u32 s71, s71, 32768
    s_and_b32 s71, s71, 0x1ffff
    s_mov_b32 m0, s71
    s_nop 0
    buffer_load_dwordx4 v68, s[60:63], s68 offen lds
    s_add_u32 m0, s71, 1024
    s_nop 0
    buffer_load_dwordx4 v69, s[60:63], s68 offen lds
    s_add_u32 m0, s71, 16384
    s_nop 0
    buffer_load_dwordx4 v70, s[64:67], s69 offen lds
    s_add_u32 m0, s71, 17408
    s_nop 0
    buffer_load_dwordx4 v71, s[64:67], s69 offen lds
    s_add_u32 s68, s68, 64
    s_add_u32 s69, s69, s70
    s_add_u32 s71, s71, 32768
    s_and_b32 s71, s71, 0x1ffff
    s_branch f256_43
v1_58:
    s_mov_b64 s[60:61], s[36:37]
    s_mov_b32 s62, 0x400000
    s_mov_b32 s63, 0x20000
    s_mov_b64 s[64:65], s[28:29]
    s_mov_b32 s66, 0x800000
    s_mov_b32 s67, 0x20000
    v_lshrrev_b32 v76, 4, v1
    v_sub_u32 v76, 0, v76
    v_xor_b32 v76, v76, v1
    v_and_b32 v76, 3, v76
    s_mul_i32 s74, s58, 32
    v_lshrrev_b32 v77, 2, v1
    v_add3_u32 v77, v77, s74, 0
    v_bfe_u32 v68, v77, 0, 3
    v_lshlrev_b32 v68, 11, v68
    v_bfe_u32 v75, v77, 3, 1
    v_lshl_or_b32 v68, v75, 15, v68
    v_bfe_u32 v75, v77, 4, 1
    v_lshl_or_b32 v68, v75, 14, v68
    v_bfe_u32 v75, v77, 5, 3
    v_lshl_or_b32 v68, v75, 16, v68
    v_lshl_add_u32 v68, v76, 4, v68
    v_lshrrev_b32 v77, 2, v1
    v_add3_u32 v77, v77, s74, 16
    v_bfe_u32 v69, v77, 0, 3
    v_lshlrev_b32 v69, 11, v69
    v_bfe_u32 v75, v77, 3, 1
    v_lshl_or_b32 v69, v75, 15, v69
    v_bfe_u32 v75, v77, 4, 1
    v_lshl_or_b32 v69, v75, 14, v69
    v_bfe_u32 v75, v77, 5, 3
    v_lshl_or_b32 v69, v75, 16, v69
    v_lshl_add_u32 v69, v76, 4, v69
    s_and_b32 s74, s58, 2
    v_bfe_u32 v76, v1, 0, 5
    v_bfe_u32 v77, v1, 5, 1
    v_lshlrev_b32 v77, 2, v77
    v_xor_b32 v76, v76, v77
    v_xor_b32 v76, s74, v76
    v_lshlrev_b32 v77, 4, v76
    v_lshrrev_b32 v76, 5, v1
    v_lshl_add_u32 v70, v76, 13, v77
    v_bfe_u32 v76, v1, 0, 5
    v_bfe_u32 v77, v1, 5, 1
    v_lshlrev_b32 v77, 2, v77
    v_xor_b32 v76, v76, v77
    v_xor_b32 v76, s74, v76
    v_xor_b32 v76, 8, v76
    v_lshlrev_b32 v77, 4, v76
    v_lshrrev_b32 v76, 5, v1
    v_lshl_add_u32 v71, v76, 13, v77
    v_add_u32 v71, 16384, v71
    s_lshl_b32 s74, s58, 15
    v_add_u32 v70, s74, v70
    v_add_u32 v71, s74, v71
    s_mov_b32 s70, 262144
    s_mul_i32 s68, s79, 524288
    s_mul_i32 s69, s80, 512
    s_mov_b32 s82, 0x40000
    s_lshl_b32 s81, s79, 1
    s_lshr_b32 s84, s58, 2
    s_add_u32 s81, s81, s84
    s_mul_i32 s81, s81, s82
    s_mul_i32 s81, s81, 4
    s_lshl_b32 s74, s80, 2
    s_and_b32 s84, s58, 3
    s_add_u32 s84, s84, s74
    s_mul_i32 s84, s84, 4096
    s_add_u32 s81, s81, s84
    s_add_u32 s81, s81, 0x2000000
    s_mul_i32 s71, s58, 2048
    s_mov_b32 m0, s71
    s_nop 0
    buffer_load_dwordx4 v68, s[60:63], s68 offen lds
    s_add_u32 m0, s71, 1024
    s_nop 0
    buffer_load_dwordx4 v69, s[60:63], s68 offen lds
    s_add_u32 m0, s71, 16384
    s_nop 0
    buffer_load_dwordx4 v70, s[64:67], s69 offen lds
    s_add_u32 m0, s71, 17408
    s_nop 0
    buffer_load_dwordx4 v71, s[64:67], s69 offen lds
    s_add_u32 s68, s68, 64
    s_add_u32 s69, s69, s70
    s_add_u32 s71, s71, 32768
    s_and_b32 s71, s71, 0x1ffff
    s_mov_b32 m0, s71
    s_nop 0
    buffer_load_dwordx4 v68, s[60:63], s68 offen lds
    s_add_u32 m0, s71, 1024
    s_nop 0
    buffer_load_dwordx4 v69, s[60:63], s68 offen lds
    s_add_u32 m0, s71, 16384
    s_nop 0
    buffer_load_dwordx4 v70, s[64:67], s69 offen lds
    s_add_u32 m0, s71, 17408
    s_nop 0
    buffer_load_dwordx4 v71, s[64:67], s69 offen lds
    s_add_u32 s68, s68, 64
    s_add_u32 s69, s69, s70
    s_add_u32 s71, s71, 32768
    s_and_b32 s71, s71, 0x1ffff
    s_mov_b32 m0, s71
    s_nop 0
    buffer_load_dwordx4 v68, s[60:63], s68 offen lds
    s_add_u32 m0, s71, 1024
    s_nop 0
    buffer_load_dwordx4 v69, s[60:63], s68 offen lds
    s_add_u32 m0, s71, 16384
    s_nop 0
    buffer_load_dwordx4 v70, s[64:67], s69 offen lds
    s_add_u32 m0, s71, 17408
    s_nop 0
    buffer_load_dwordx4 v71, s[64:67], s69 offen lds
    s_add_u32 s68, s68, 64
    s_add_u32 s69, s69, s70
    s_add_u32 s71, s71, 32768
    s_and_b32 s71, s71, 0x1ffff
    s_mov_b32 m0, s71
    s_nop 0
    buffer_load_dwordx4 v68, s[60:63], s68 offen lds
    s_add_u32 m0, s71, 1024
    s_nop 0
    buffer_load_dwordx4 v69, s[60:63], s68 offen lds
    s_add_u32 m0, s71, 16384
    s_nop 0
    buffer_load_dwordx4 v70, s[64:67], s69 offen lds
    s_add_u32 m0, s71, 17408
    s_nop 0
    buffer_load_dwordx4 v71, s[64:67], s69 offen lds
    s_add_u32 s68, s68, 64
    s_add_u32 s69, s69, s70
    s_add_u32 s71, s71, 32768
    s_and_b32 s71, s71, 0x1ffff
    s_branch t256_44
q_55:
    s_lshr_b32 s79, s57, 2
    s_bfe_u32 s80, s76, 0x20000
    s_bfe_u32 s84, s76, 0x20005
    s_lshl_b32 s84, s84, 2
    s_or_b32 s80, s80, s84
    s_mov_b32 s83, 48
    s_mov_b64 s[60:61], s[36:37]
    s_mov_b32 s62, 0x400000
    s_mov_b32 s63, 0x20000
    s_mov_b64 s[64:65], s[20:21]
    s_mov_b32 s66, 0x800000
    s_mov_b32 s67, 0x20000
    v_lshrrev_b32 v76, 4, v1
    v_sub_u32 v76, 0, v76
    v_xor_b32 v76, v76, v1
    v_and_b32 v76, 3, v76
    s_mul_i32 s74, s58, 32
    v_lshrrev_b32 v77, 2, v1
    v_add3_u32 v77, v77, s74, 0
    v_lshlrev_b32 v68, 11, v77
    v_lshl_add_u32 v68, v76, 4, v68
    v_lshrrev_b32 v77, 2, v1
    v_add3_u32 v77, v77, s74, 16
    v_lshlrev_b32 v69, 11, v77
    v_lshl_add_u32 v69, v76, 4, v69
    s_and_b32 s74, s58, 2
    v_bfe_u32 v76, v1, 0, 5
    v_bfe_u32 v77, v1, 5, 1
    v_lshlrev_b32 v77, 2, v77
    v_xor_b32 v76, v76, v77
    v_xor_b32 v76, s74, v76
    v_bfe_u32 v77, v76, 0, 1
    v_lshlrev_b32 v77, 5, v77
    v_bfe_u32 v75, v76, 1, 1
    v_lshl_or_b32 v77, v75, 4, v77
    v_bfe_u32 v75, v76, 2, 3
    v_lshl_or_b32 v77, v75, 6, v77
    v_lshrrev_b32 v76, 5, v1
    v_lshl_add_u32 v70, v76, 13, v77
    v_bfe_u32 v76, v1, 0, 5
    v_bfe_u32 v77, v1, 5, 1
    v_lshlrev_b32 v77, 2, v77
    v_xor_b32 v76, v76, v77
    v_xor_b32 v76, s74, v76
    v_xor_b32 v76, 8, v76
    v_bfe_u32 v77, v76, 0, 1
    v_lshlrev_b32 v77, 5, v77
    v_bfe_u32 v75, v76, 1, 1
    v_lshl_or_b32 v77, v75, 4, v77
    v_bfe_u32 v75, v76, 2, 3
    v_lshl_or_b32 v77, v75, 6, v77
    v_lshrrev_b32 v76, 5, v1
    v_lshl_add_u32 v71, v76, 13, v77
    v_add_u32 v71, 16384, v71
    s_lshl_b32 s74, s58, 15
    v_add_u32 v70, s74, v70
    v_add_u32 v71, s74, v71
    s_mov_b32 s70, 262144
    s_mul_i32 s68, s79, 524288
    s_mul_i32 s69, s80, 512
    s_mov_b32 s82, 0x40000
    s_lshl_b32 s81, s79, 1
    s_lshr_b32 s84, s58, 2
    s_add_u32 s81, s81, s84
    s_mul_i32 s81, s81, s82
    s_mul_i32 s81, s81, 4
    s_lshl_b32 s74, s80, 2
    s_and_b32 s84, s58, 3
    s_add_u32 s84, s84, s74
    s_mul_i32 s84, s84, 4096
    s_add_u32 s81, s81, s84
    s_add_u32 s81, s81, 0x0
    s_mul_i32 s71, s58, 2048
    s_mov_b32 m0, s71
    s_nop 0
    buffer_load_dwordx4 v68, s[60:63], s68 offen lds
    s_add_u32 m0, s71, 1024
    s_nop 0
    buffer_load_dwordx4 v69, s[60:63], s68 offen lds
    s_add_u32 m0, s71, 16384
    s_nop 0
    buffer_load_dwordx4 v70, s[64:67], s69 offen lds
    s_add_u32 m0, s71, 17408
    s_nop 0
    buffer_load_dwordx4 v71, s[64:67], s69 offen lds
    s_add_u32 s68, s68, 64
    s_add_u32 s69, s69, s70
    s_add_u32 s71, s71, 32768
    s_and_b32 s71, s71, 0x1ffff
    s_mov_b32 m0, s71
    s_nop 0
    buffer_load_dwordx4 v68, s[60:63], s68 offen lds
    s_add_u32 m0, s71, 1024
    s_nop 0
    buffer_load_dwordx4 v69, s[60:63], s68 offen lds
    s_add_u32 m0, s71, 16384
    s_nop 0
    buffer_load_dwordx4 v70, s[64:67], s69 offen lds
    s_add_u32 m0, s71, 17408
    s_nop 0
    buffer_load_dwordx4 v71, s[64:67], s69 offen lds
    s_add_u32 s68, s68, 64
    s_add_u32 s69, s69, s70
    s_add_u32 s71, s71, 32768
    s_and_b32 s71, s71, 0x1ffff
    s_mov_b32 m0, s71
    s_nop 0
    buffer_load_dwordx4 v68, s[60:63], s68 offen lds
    s_add_u32 m0, s71, 1024
    s_nop 0
    buffer_load_dwordx4 v69, s[60:63], s68 offen lds
    s_add_u32 m0, s71, 16384
    s_nop 0
    buffer_load_dwordx4 v70, s[64:67], s69 offen lds
    s_add_u32 m0, s71, 17408
    s_nop 0
    buffer_load_dwordx4 v71, s[64:67], s69 offen lds
    s_add_u32 s68, s68, 64
    s_add_u32 s69, s69, s70
    s_add_u32 s71, s71, 32768
    s_and_b32 s71, s71, 0x1ffff
    s_mov_b32 m0, s71
    s_nop 0
    buffer_load_dwordx4 v68, s[60:63], s68 offen lds
    s_add_u32 m0, s71, 1024
    s_nop 0
    buffer_load_dwordx4 v69, s[60:63], s68 offen lds
    s_add_u32 m0, s71, 16384
    s_nop 0
    buffer_load_dwordx4 v70, s[64:67], s69 offen lds
    s_add_u32 m0, s71, 17408
    s_nop 0
    buffer_load_dwordx4 v71, s[64:67], s69 offen lds
    s_add_u32 s68, s68, 64
    s_add_u32 s69, s69, s70
    s_add_u32 s71, s71, 32768
    s_and_b32 s71, s71, 0x1ffff
    s_branch f256_43
fft_60:
    s_cmp_eq_u32 s78, 3
    s_cbranch_scc1 col_56
    s_cmp_lg_u32 s58, 0
    s_cbranch_scc1 wall_61
    v_mov_b32 v76, 136
wctr_62:
    buffer_load_dword v75, v76, s[12:15], 0 offen sc1
    s_waitcnt vmcnt(0)
    v_cmp_gt_u32 vcc, 128, v75
    s_cbranch_vccz wctr_ok_63
    s_sub_u32 s77, s77, 1
    s_cbranch_scc0 wctr_62
    s_mov_b32 s77, 0
wctr_ok_63:
wall_61:
    s_barrier
    s_and_b32 s79, s57, 7
    s_mov_b32 s80, s75
    s_mov_b32 s83, 40
    s_mov_b64 s[60:61], s[44:45]
    s_mov_b32 s62, 0x400000
    s_mov_b32 s63, 0x20000
    s_mov_b64 s[64:65], s[8:9]
    s_mov_b32 s66, 0x10000000
    s_mov_b32 s67, 0x20000
    v_lshrrev_b32 v76, 4, v1
    v_sub_u32 v76, 0, v76
    v_xor_b32 v76, v76, v1
    v_and_b32 v76, 3, v76
    s_mul_i32 s74, s58, 32
    v_lshrrev_b32 v77, 2, v1
    v_add3_u32 v77, v77, s74, 0
    v_bfe_u32 v68, v77, 0, 3
    v_lshlrev_b32 v68, 17, v68
    v_bfe_u32 v75, v77, 3, 1
    v_lshl_or_b32 v68, v75, 21, v68
    v_bfe_u32 v75, v77, 4, 1
    v_lshl_or_b32 v68, v75, 20, v68
    v_bfe_u32 v75, v77, 5, 3
    v_lshl_or_b32 v68, v75, 11, v68
    v_lshl_add_u32 v68, v76, 4, v68
    v_lshrrev_b32 v77, 2, v1
    v_add3_u32 v77, v77, s74, 16
    v_bfe_u32 v69, v77, 0, 3
    v_lshlrev_b32 v69, 17, v69
    v_bfe_u32 v75, v77, 3, 1
    v_lshl_or_b32 v69, v75, 21, v69
    v_bfe_u32 v75, v77, 4, 1
    v_lshl_or_b32 v69, v75, 20, v69
    v_bfe_u32 v75, v77, 5, 3
    v_lshl_or_b32 v69, v75, 11, v69
    v_lshl_add_u32 v69, v76, 4, v69
    s_and_b32 s74, s58, 2
    v_bfe_u32 v76, v1, 0, 5
    v_bfe_u32 v77, v1, 5, 1
    v_lshlrev_b32 v77, 2, v77
    v_xor_b32 v76, v76, v77
    v_xor_b32 v76, s74, v76
    v_lshlrev_b32 v77, 4, v76
    v_lshrrev_b32 v76, 5, v1
    v_lshl_add_u32 v70, v76, 11, v77
    v_bfe_u32 v76, v1, 0, 5
    v_bfe_u32 v77, v1, 5, 1
    v_lshlrev_b32 v77, 2, v77
    v_xor_b32 v76, v76, v77
    v_xor_b32 v76, s74, v76
    v_xor_b32 v76, 8, v76
    v_lshlrev_b32 v77, 4, v76
    v_lshrrev_b32 v76, 5, v1
    v_lshl_add_u32 v71, v76, 11, v77
    v_add_u32 v71, 4096, v71
    s_lshl_b32 s74, s58, 13
    v_add_u32 v70, s74, v70
    v_add_u32 v71, s74, v71
    s_mov_b32 s70, 65536
    s_lshl_b32 s68, s79, 14
    s_lshl_b32 s69, s80, 9
    s_add_u32 s69, s69, 0x5200000
    s_mov_b32 s82, 0x10000
    s_lshl_b32 s81, s79, 1
    s_lshr_b32 s84, s58, 2
    s_add_u32 s81, s81, s84
    s_mul_i32 s81, s81, s82
    s_mul_i32 s81, s81, 4
    s_lshl_b32 s74, s80, 2
    s_and_b32 s84, s58, 3
    s_add_u32 s84, s84, s74
    s_mul_i32 s84, s84, 4096
    s_add_u32 s81, s81, s84
    s_add_u32 s81, s81, 0x5400000
    s_mul_i32 s71, s58, 2048
    s_mov_b32 m0, s71
    s_nop 0
    buffer_load_dwordx4 v68, s[60:63], s68 offen lds
    s_add_u32 m0, s71, 1024
    s_nop 0
    buffer_load_dwordx4 v69, s[60:63], s68 offen lds
    s_add_u32 m0, s71, 16384
    s_nop 0
    buffer_load_dwordx4 v70, s[64:67], s69 offen lds
    s_add_u32 m0, s71, 17408
    s_nop 0
    buffer_load_dwordx4 v71, s[64:67], s69 offen lds
    s_add_u32 s68, s68, 64
    s_add_u32 s69, s69, s70
    s_add_u32 s71, s71, 32768
    s_and_b32 s71, s71, 0x1ffff
    s_mov_b32 m0, s71
    s_nop 0
    buffer_load_dwordx4 v68, s[60:63], s68 offen lds
    s_add_u32 m0, s71, 1024
    s_nop 0
    buffer_load_dwordx4 v69, s[60:63], s68 offen lds
    s_add_u32 m0, s71, 16384
    s_nop 0
    buffer_load_dwordx4 v70, s[64:67], s69 offen lds
    s_add_u32 m0, s71, 17408
    s_nop 0
    buffer_load_dwordx4 v71, s[64:67], s69 offen lds
    s_add_u32 s68, s68, 64
    s_add_u32 s69, s69, s70
    s_add_u32 s71, s71, 32768
    s_and_b32 s71, s71, 0x1ffff
    s_mov_b32 m0, s71
    s_nop 0
    buffer_load_dwordx4 v68, s[60:63], s68 offen lds
    s_add_u32 m0, s71, 1024
    s_nop 0
    buffer_load_dwordx4 v69, s[60:63], s68 offen lds
    s_add_u32 m0, s71, 16384
    s_nop 0
    buffer_load_dwordx4 v70, s[64:67], s69 offen lds
    s_add_u32 m0, s71, 17408
    s_nop 0
    buffer_load_dwordx4 v71, s[64:67], s69 offen lds
    s_add_u32 s68, s68, 64
    s_add_u32 s69, s69, s70
    s_add_u32 s71, s71, 32768
    s_and_b32 s71, s71, 0x1ffff
    s_mov_b32 m0, s71
    s_nop 0
    buffer_load_dwordx4 v68, s[60:63], s68 offen lds
    s_add_u32 m0, s71, 1024
    s_nop 0
    buffer_load_dwordx4 v69, s[60:63], s68 offen lds
    s_add_u32 m0, s71, 16384
    s_nop 0
    buffer_load_dwordx4 v70, s[64:67], s69 offen lds
    s_add_u32 m0, s71, 17408
    s_nop 0
    buffer_load_dwordx4 v71, s[64:67], s69 offen lds
    s_add_u32 s68, s68, 64
    s_add_u32 s69, s69, s70
    s_add_u32 s71, s71, 32768
    s_and_b32 s71, s71, 0x1ffff
    s_branch t256_44
col_56:
    s_bfe_u32 s79, s76, 0x30000
    s_bfe_u32 s84, s76, 0x20005
    s_lshl_b32 s84, s84, 3
    s_or_b32 s79, s79, s84
    v_bfe_u32 v231, v1, 0, 5
    v_bfe_u32 v235, v1, 5, 1
    v_lshl_or_b32 v231, v235, 7, v231
    v_mul_u32_u24 v231, 1026, v231
    v_and_b32 v231, -4, v231
    s_mul_i32 s5, s58, 262656
    s_lshl_b32 s2, s79, 5
    s_add_u32 s5, s5, s2
    buffer_load_dwordx4 v[84:87], v231, s[48:51], s5 offen
    buffer_load_dwordx4 v[88:91], v231, s[48:51], s5 offen offset:16
    buffer_load_dword v92, v231, s[48:51], s5 offen offset:32
    buffer_load_dwordx4 v[94:97], v231, s[52:55], s5 offen
    buffer_load_dwordx4 v[98:101], v231, s[52:55], s5 offen offset:16
    buffer_load_dword v102, v231, s[52:55], s5 offen offset:32
    s_add_u32 s5, s5, 32832
    buffer_load_dwordx4 v[104:107], v231, s[48:51], s5 offen
    buffer_load_dwordx4 v[108:111], v231, s[48:51], s5 offen offset:16
    buffer_load_dword v112, v231, s[48:51], s5 offen offset:32
    buffer_load_dwordx4 v[114:117], v231, s[52:55], s5 offen
    buffer_load_dwordx4 v[118:121], v231, s[52:55], s5 offen offset:16
    buffer_load_dword v122, v231, s[52:55], s5 offen offset:32
    s_add_u32 s5, s5, 32832
    buffer_load_dwordx4 v[124:127], v231, s[48:51], s5 offen
    buffer_load_dwordx4 v[128:131], v231, s[48:51], s5 offen offset:16
    buffer_load_dword v132, v231, s[48:51], s5 offen offset:32
    buffer_load_dwordx4 v[134:137], v231, s[52:55], s5 offen
    buffer_load_dwordx4 v[138:141], v231, s[52:55], s5 offen offset:16
    buffer_load_dword v142, v231, s[52:55], s5 offen offset:32
    s_add_u32 s5, s5, 32832
    buffer_load_dwordx4 v[144:147], v231, s[48:51], s5 offen
    buffer_load_dwordx4 v[148:151], v231, s[48:51], s5 offen offset:16
    buffer_load_dword v152, v231, s[48:51], s5 offen offset:32
    buffer_load_dwordx4 v[154:157], v231, s[52:55], s5 offen
    buffer_load_dwordx4 v[158:161], v231, s[52:55], s5 offen offset:16
    buffer_load_dword v162, v231, s[52:55], s5 offen offset:32
    s_add_u32 s5, s5, 32832
    v_and_b32 v235, 31, v1
    v_cvt_f32_u32 v228, v235
    v_and_b32 v235, 32, v1
    v_cvt_f32_u32 v235, v235
    v_mul_f32 v229, v228, v235
    v_mul_f32 v229, 0x3b000000, v229
    v_mul_f32 v234, 0x3d000000, v229
    v_fmamk_f32 v230, v235, 0x3b000000, v234
    v_and_b32 v233, 1, v1
    v_lshlrev_b32 v232, 4, v233
    v_mul_u32_u24 v233, 0x8000, v233
    v_lshl_or_b32 v233, v233, 16, v233
    v_fmamk_f32 v243, v228, 0x0, v229
    v_add_f32 v244, v243, v243
    v_cos_f32 v235, v243
    v_sin_f32 v237, v243
    v_cos_f32 v239, v244
    v_sin_f32 v241, v244
    v_fmamk_f32 v243, v228, 0x3c800000, v229
    v_add_f32 v244, v243, v243
    v_cos_f32 v236, v243
    v_sin_f32 v238, v243
    v_cos_f32 v240, v244
    v_sin_f32 v242, v244
    v_cvt_pk_bf16_f32 v4, v235, v236
    v_cvt_pk_bf16_f32 v36, v237, v238
    v_cvt_pk_bf16_f32 v68, v239, v240
    v_cvt_pk_bf16_f32 v76, v241, v242
    v_fmamk_f32 v243, v228, 0x3d000000, v229
    v_add_f32 v244, v243, v243
    v_cos_f32 v235, v243
    v_sin_f32 v237, v243
    v_cos_f32 v239, v244
    v_sin_f32 v241, v244
    v_fmamk_f32 v243, v228, 0x3d400000, v229
    v_add_f32 v244, v243, v243
    v_cos_f32 v236, v243
    v_sin_f32 v238, v243
    v_cos_f32 v240, v244
    v_sin_f32 v242, v244
    v_cvt_pk_bf16_f32 v5, v235, v236
    v_cvt_pk_bf16_f32 v37, v237, v238
    v_cvt_pk_bf16_f32 v69, v239, v240
    v_cvt_pk_bf16_f32 v77, v241, v242
    v_fmamk_f32 v243, v228, 0x3e000000, v229
    v_add_f32 v244, v243, v243
    v_cos_f32 v235, v243
    v_sin_f32 v237, v243
    v_cos_f32 v239, v244
    v_sin_f32 v241, v244
    v_fmamk_f32 v243, v228, 0x3e100000, v229
    v_add_f32 v244, v243, v243
    v_cos_f32 v236, v243
    v_sin_f32 v238, v243
    v_cos_f32 v240, v244
    v_sin_f32 v242, v244
    v_cvt_pk_bf16_f32 v6, v235, v236
    v_cvt_pk_bf16_f32 v38, v237, v238
    v_cvt_pk_bf16_f32 v70, v239, v240
    v_cvt_pk_bf16_f32 v78, v241, v242
    v_fmamk_f32 v243, v228, 0x3e200000, v229
    v_add_f32 v244, v243, v243
    v_cos_f32 v235, v243
    v_sin_f32 v237, v243
    v_cos_f32 v239, v244
    v_sin_f32 v241, v244
    v_fmamk_f32 v243, v228, 0x3e300000, v229
    v_add_f32 v244, v243, v243
    v_cos_f32 v236, v243
    v_sin_f32 v238, v243
    v_cos_f32 v240, v244
    v_sin_f32 v242, v244
    v_cvt_pk_bf16_f32 v7, v235, v236
    v_cvt_pk_bf16_f32 v39, v237, v238
    v_cvt_pk_bf16_f32 v71, v239, v240
    v_cvt_pk_bf16_f32 v79, v241, v242
    v_fmamk_f32 v243, v228, 0x3e800000, v229
    v_add_f32 v244, v243, v243
    v_cos_f32 v235, v243
    v_sin_f32 v237, v243
    v_cos_f32 v239, v244
    v_sin_f32 v241, v244
    v_fmamk_f32 v243, v228, 0x3e880000, v229
    v_add_f32 v244, v243, v243
    v_cos_f32 v236, v243
    v_sin_f32 v238, v243
    v_cos_f32 v240, v244
    v_sin_f32 v242, v244
    v_cvt_pk_bf16_f32 v8, v235, v236
    v_cvt_pk_bf16_f32 v40, v237, v238
    v_cvt_pk_bf16_f32 v72, v239, v240
    v_cvt_pk_bf16_f32 v80, v241, v242
    v_fmamk_f32 v243, v228, 0x3e900000, v229
    v_add_f32 v244, v243, v243
    v_cos_f32 v235, v243
    v_sin_f32 v237, v243
    v_cos_f32 v239, v244
    v_sin_f32 v241, v244
    v_fmamk_f32 v243, v228, 0x3e980000, v229
    v_add_f32 v244, v243, v243
    v_cos_f32 v236, v243
    v_sin_f32 v238, v243
    v_cos_f32 v240, v244
    v_sin_f32 v242, v244
    v_cvt_pk_bf16_f32 v9, v235, v236
    v_cvt_pk_bf16_f32 v41, v237, v238
    v_cvt_pk_bf16_f32 v73, v239, v240
    v_cvt_pk_bf16_f32 v81, v241, v242
    v_fmamk_f32 v243, v228, 0x3ec00000, v229
    v_add_f32 v244, v243, v243
    v_cos_f32 v235, v243
    v_sin_f32 v237, v243
    v_cos_f32 v239, v244
    v_sin_f32 v241, v244
    v_fmamk_f32 v243, v228, 0x3ec80000, v229
    v_add_f32 v244, v243, v243
    v_cos_f32 v236, v243
    v_sin_f32 v238, v243
    v_cos_f32 v240, v244
    v_sin_f32 v242, v244
    v_cvt_pk_bf16_f32 v10, v235, v236
    v_cvt_pk_bf16_f32 v42, v237, v238
    v_cvt_pk_bf16_f32 v74, v239, v240
    v_cvt_pk_bf16_f32 v82, v241, v242
    v_fmamk_f32 v243, v228, 0x3ed00000, v229
    v_add_f32 v244, v243, v243
    v_cos_f32 v235, v243
    v_sin_f32 v237, v243
    v_cos_f32 v239, v244
    v_sin_f32 v241, v244
    v_fmamk_f32 v243, v228, 0x3ed80000, v229
    v_add_f32 v244, v243, v243
    v_cos_f32 v236, v243
    v_sin_f32 v238, v243
    v_cos_f32 v240, v244
    v_sin_f32 v242, v244
    v_cvt_pk_bf16_f32 v11, v235, v236
    v_cvt_pk_bf16_f32 v43, v237, v238
    v_cvt_pk_bf16_f32 v75, v239, v240
    v_cvt_pk_bf16_f32 v83, v241, v242
    v_xor_b32 v12, v233, v4
    v_xor_b32 v13, v233, v5
    v_xor_b32 v14, v233, v6
    v_xor_b32 v15, v233, v7
    v_xor_b32 v16, v233, v8
    v_xor_b32 v17, v233, v9
    v_xor_b32 v18, v233, v10
    v_xor_b32 v19, v233, v11
    v_xor_b32 v20, 0x80000000, v4
    v_xor_b32 v21, 0x80000000, v5
    v_xor_b32 v22, 0x80000000, v6
    v_xor_b32 v23, 0x80000000, v7
    v_xor_b32 v24, 0x80000000, v8
    v_xor_b32 v25, 0x80000000, v9
    v_xor_b32 v26, 0x80000000, v10
    v_xor_b32 v27, 0x80000000, v11
    v_xor_b32 v28, 0x80000000, v12
    v_xor_b32 v29, 0x80000000, v13
    v_xor_b32 v30, 0x80000000, v14
    v_xor_b32 v31, 0x80000000, v15
    v_xor_b32 v32, 0x80000000, v16
    v_xor_b32 v33, 0x80000000, v17
    v_xor_b32 v34, 0x80000000, v18
    v_xor_b32 v35, 0x80000000, v19
    v_xor_b32 v44, v233, v36
    v_xor_b32 v45, v233, v37
    v_xor_b32 v46, v233, v38
    v_xor_b32 v47, v233, v39
    v_xor_b32 v48, v233, v40
    v_xor_b32 v49, v233, v41
    v_xor_b32 v50, v233, v42
    v_xor_b32 v51, v233, v43
    v_xor_b32 v52, 0x80000000, v36
    v_xor_b32 v53, 0x80000000, v37
    v_xor_b32 v54, 0x80000000, v38
    v_xor_b32 v55, 0x80000000, v39
    v_xor_b32 v56, 0x80000000, v40
    v_xor_b32 v57, 0x80000000, v41
    v_xor_b32 v58, 0x80000000, v42
    v_xor_b32 v59, 0x80000000, v43
    v_xor_b32 v60, 0x80000000, v44
    v_xor_b32 v61, 0x80000000, v45
    v_xor_b32 v62, 0x80000000, v46
    v_xor_b32 v63, 0x80000000, v47
    v_xor_b32 v64, 0x80000000, v48
    v_xor_b32 v65, 0x80000000, v49
    v_xor_b32 v66, 0x80000000, v50
    v_xor_b32 v67, 0x80000000, v51
    s_mov_b32 s2, 0x05040100
    s_mov_b32 s3, 0x07060302
    s_lshl_b32 s5, s58, 10
    v_lshl_add_u32 v231, v1, 4, s5
    v_add_u32 v233, 0x10000, v231
    v_add_u32 v235, 0x20000, v231
    s_waitcnt vmcnt(0)
    v_alignbit_b32 v84, v85, v84, v232
    v_alignbit_b32 v94, v95, v94, v232
    v_alignbit_b32 v104, v105, v104, v232
    v_alignbit_b32 v114, v115, v114, v232
    v_alignbit_b32 v124, v125, v124, v232
    v_alignbit_b32 v134, v135, v134, v232
    v_alignbit_b32 v144, v145, v144, v232
    v_alignbit_b32 v154, v155, v154, v232
    v_perm_b32 v196, v94, v84, s2
    v_perm_b32 v197, v114, v104, s2
    v_perm_b32 v198, v134, v124, s2
    v_perm_b32 v199, v154, v144, s2
    ds_write_b128 v231, v[196:199] offset:0
    v_perm_b32 v200, v94, v84, s3
    v_perm_b32 v201, v114, v104, s3
    v_perm_b32 v202, v134, v124, s3
    v_perm_b32 v203, v154, v144, s3
    ds_write_b128 v231, v[200:203] offset:8192
    v_alignbit_b32 v85, v86, v85, v232
    v_alignbit_b32 v95, v96, v95, v232
    v_alignbit_b32 v105, v106, v105, v232
    v_alignbit_b32 v115, v116, v115, v232
    v_alignbit_b32 v125, v126, v125, v232
    v_alignbit_b32 v135, v136, v135, v232
    v_alignbit_b32 v145, v146, v145, v232
    v_alignbit_b32 v155, v156, v155, v232
    v_perm_b32 v204, v95, v85, s2
    v_perm_b32 v205, v115, v105, s2
    v_perm_b32 v206, v135, v125, s2
    v_perm_b32 v207, v155, v145, s2
    ds_write_b128 v231, v[204:207] offset:16384
    v_perm_b32 v208, v95, v85, s3
    v_perm_b32 v209, v115, v105, s3
    v_perm_b32 v210, v135, v125, s3
    v_perm_b32 v211, v155, v145, s3
    ds_write_b128 v231, v[208:211] offset:24576
    v_alignbit_b32 v86, v87, v86, v232
    v_alignbit_b32 v96, v97, v96, v232
    v_alignbit_b32 v106, v107, v106, v232
    v_alignbit_b32 v116, v117, v116, v232
    v_alignbit_b32 v126, v127, v126, v232
    v_alignbit_b32 v136, v137, v136, v232
    v_alignbit_b32 v146, v147, v146, v232
    v_alignbit_b32 v156, v157, v156, v232
    v_perm_b32 v212, v96, v86, s2
    v_perm_b32 v213, v116, v106, s2
    v_perm_b32 v214, v136, v126, s2
    v_perm_b32 v215, v156, v146, s2
    ds_write_b128 v231, v[212:215] offset:32768
    v_perm_b32 v216, v96, v86, s3
    v_perm_b32 v217, v116, v106, s3
    v_perm_b32 v218, v136, v126, s3
    v_perm_b32 v219, v156, v146, s3
    ds_write_b128 v231, v[216:219] offset:40960
    v_alignbit_b32 v87, v88, v87, v232
    v_alignbit_b32 v97, v98, v97, v232
    v_alignbit_b32 v107, v108, v107, v232
    v_alignbit_b32 v117, v118, v117, v232
    v_alignbit_b32 v127, v128, v127, v232
    v_alignbit_b32 v137, v138, v137, v232
    v_alignbit_b32 v147, v148, v147, v232
    v_alignbit_b32 v157, v158, v157, v232
    v_perm_b32 v220, v97, v87, s2
    v_perm_b32 v221, v117, v107, s2
    v_perm_b32 v222, v137, v127, s2
    v_perm_b32 v223, v157, v147, s2
    ds_write_b128 v231, v[220:223] offset:49152
    v_perm_b32 v224, v97, v87, s3
    v_perm_b32 v225, v117, v107, s3
    v_perm_b32 v226, v137, v127, s3
    v_perm_b32 v227, v157, v147, s3
    ds_write_b128 v231, v[224:227] offset:57344
    v_alignbit_b32 v88, v89, v88, v232
    v_alignbit_b32 v98, v99, v98, v232
    v_alignbit_b32 v108, v109, v108, v232
    v_alignbit_b32 v118, v119, v118, v232
    v_alignbit_b32 v128, v129, v128, v232
    v_alignbit_b32 v138, v139, v138, v232
    v_alignbit_b32 v148, v149, v148, v232
    v_alignbit_b32 v158, v159, v158, v232
    v_perm_b32 v196, v98, v88, s2
    v_perm_b32 v197, v118, v108, s2
    v_perm_b32 v198, v138, v128, s2
    v_perm_b32 v199, v158, v148, s2
    ds_write_b128 v233, v[196:199] offset:0
    v_perm_b32 v200, v98, v88, s3
    v_perm_b32 v201, v118, v108, s3
    v_perm_b32 v202, v138, v128, s3
    v_perm_b32 v203, v158, v148, s3
    ds_write_b128 v233, v[200:203] offset:8192
    v_alignbit_b32 v89, v90, v89, v232
    v_alignbit_b32 v99, v100, v99, v232
    v_alignbit_b32 v109, v110, v109, v232
    v_alignbit_b32 v119, v120, v119, v232
    v_alignbit_b32 v129, v130, v129, v232
    v_alignbit_b32 v139, v140, v139, v232
    v_alignbit_b32 v149, v150, v149, v232
    v_alignbit_b32 v159, v160, v159, v232
    v_perm_b32 v204, v99, v89, s2
    v_perm_b32 v205, v119, v109, s2
    v_perm_b32 v206, v139, v129, s2
    v_perm_b32 v207, v159, v149, s2
    ds_write_b128 v233, v[204:207] offset:16384
    v_perm_b32 v208, v99, v89, s3
    v_perm_b32 v209, v119, v109, s3
    v_perm_b32 v210, v139, v129, s3
    v_perm_b32 v211, v159, v149, s3
    ds_write_b128 v233, v[208:211] offset:24576
    v_alignbit_b32 v90, v91, v90, v232
    v_alignbit_b32 v100, v101, v100, v232
    v_alignbit_b32 v110, v111, v110, v232
    v_alignbit_b32 v120, v121, v120, v232
    v_alignbit_b32 v130, v131, v130, v232
    v_alignbit_b32 v140, v141, v140, v232
    v_alignbit_b32 v150, v151, v150, v232
    v_alignbit_b32 v160, v161, v160, v232
    v_perm_b32 v212, v100, v90, s2
    v_perm_b32 v213, v120, v110, s2
    v_perm_b32 v214, v140, v130, s2
    v_perm_b32 v215, v160, v150, s2
    ds_write_b128 v233, v[212:215] offset:32768
    v_perm_b32 v216, v100, v90, s3
    v_perm_b32 v217, v120, v110, s3
    v_perm_b32 v218, v140, v130, s3
    v_perm_b32 v219, v160, v150, s3
    ds_write_b128 v233, v[216:219] offset:40960
    v_alignbit_b32 v91, v92, v91, v232
    v_alignbit_b32 v101, v102, v101, v232
    v_alignbit_b32 v111, v112, v111, v232
    v_alignbit_b32 v121, v122, v121, v232
    v_alignbit_b32 v131, v132, v131, v232
    v_alignbit_b32 v141, v142, v141, v232
    v_alignbit_b32 v151, v152, v151, v232
    v_alignbit_b32 v161, v162, v161, v232
    v_perm_b32 v220, v101, v91, s2
    v_perm_b32 v221, v121, v111, s2
    v_perm_b32 v222, v141, v131, s2
    v_perm_b32 v223, v161, v151, s2
    ds_write_b128 v233, v[220:223] offset:49152
    v_perm_b32 v224, v101, v91, s3
    v_perm_b32 v225, v121, v111, s3
    v_perm_b32 v226, v141, v131, s3
    v_perm_b32 v227, v161, v151, s3
    ds_write_b128 v233, v[224:227] offset:57344
    v_alignbit_b32 v92, v92, v92, v232
    v_alignbit_b32 v102, v102, v102, v232
    v_alignbit_b32 v112, v112, v112, v232
    v_alignbit_b32 v122, v122, v122, v232
    v_alignbit_b32 v132, v132, v132, v232
    v_alignbit_b32 v142, v142, v142, v232
    v_alignbit_b32 v152, v152, v152, v232
    v_alignbit_b32 v162, v162, v162, v232
    v_perm_b32 v196, v102, v92, s2
    v_perm_b32 v197, v122, v112, s2
    v_perm_b32 v198, v142, v132, s2
    v_perm_b32 v199, v162, v152, s2
    ds_write_b128 v235, v[196:199] offset:0
    s_waitcnt lgkmcnt(0)
    s_cmp_lg_u32 s58, 0
    s_cbranch_scc1 wall_64
    v_mov_b32 v236, 40
wctr_65:
    buffer_load_dword v235, v236, s[12:15], 0 offen sc1
    s_waitcnt vmcnt(0)
    v_cmp_gt_u32 vcc, 32, v235
    s_cbranch_vccz wctr_ok_66
    s_sub_u32 s77, s77, 1
    s_cbranch_scc0 wctr_65
    s_mov_b32 s77, 0
wctr_ok_66:
wall_64:
    s_barrier
    s_mov_b32 s7, s58
colloop_67:
    s_lshl_b32 s3, s79, 4
    s_add_u32 s3, s3, s7
    s_lshl_b32 s3, s3, 1
    s_cmp_eq_u32 s3, 1024
    s_cselect_b32 s3, 1, s3
    s_cmp_lt_u32 s3, 2
    s_cselect_b32 s6, 0x5ffffff0, 0
    s_mov_b32 s4, 0x35800000
    s_cselect_b32 s4, 0x35000000, s4
    v_bfe_u32 v231, v1, 0, 5
    v_lshlrev_b32 v231, 16, v231
    v_bfe_u32 v235, v1, 5, 1
    v_lshl_or_b32 v231, v235, 9, v231
    v_add_u32 v232, s6, v231
    s_bfe_u32 s5, s3, 0x50000
    s_lshl_b32 s5, s5, 4
    s_bfe_u32 s2, s3, 0x50005
    s_lshl_b32 s2, s2, 11
    s_or_b32 s5, s5, s2
    s_add_u32 s5, s5, 0x5400000
    buffer_load_dwordx4 v[84:87], v231, s[8:11], s5 offen offset:0
    buffer_load_dwordx4 v[100:103], v232, s[8:11], s5 offen offset:16
    buffer_load_dwordx4 v[88:91], v231, s[8:11], s5 offen offset:1024
    buffer_load_dwordx4 v[104:107], v232, s[8:11], s5 offen offset:1040
    s_add_u32 s5, s5, 2097152
    buffer_load_dwordx4 v[92:95], v231, s[8:11], s5 offen offset:0
    buffer_load_dwordx4 v[108:111], v232, s[8:11], s5 offen offset:16
    buffer_load_dwordx4 v[96:99], v231, s[8:11], s5 offen offset:1024
    buffer_load_dwordx4 v[112:115], v232, s[8:11], s5 offen offset:1040
    s_add_u32 s5, s5, 2097152
    s_lshl_b32 s5, s7, 13
    v_lshl_add_u32 v235, v1, 4, s5
    ds_read_b128 v[196:199], v235 offset:0
    ds_read_b128 v[200:203], v235 offset:1024
    ds_read_b128 v[204:207], v235 offset:2048
    ds_read_b128 v[208:211], v235 offset:3072
    ds_read_b128 v[212:215], v235 offset:4096
    ds_read_b128 v[216:219], v235 offset:5120
    ds_read_b128 v[220:223], v235 offset:6144
    ds_read_b128 v[224:227], v235 offset:7168
    v_and_b32 v236, 31, v1
    v_cvt_f32_u32 v228, v236
    v_mov_b32 v229, v234
    s_waitcnt vmcnt(0) lgkmcnt(0)
    v_xor_b32 v116, 0x80008000, v84
    v_xor_b32 v117, 0x80008000, v85
    v_xor_b32 v118, 0x80008000, v86
    v_xor_b32 v119, 0x80008000, v87
    v_xor_b32 v120, 0x80008000, v88
    v_xor_b32 v121, 0x80008000, v89
    v_xor_b32 v122, 0x80008000, v90
    v_xor_b32 v123, 0x80008000, v91
    v_xor_b32 v124, 0x80008000, v92
    v_xor_b32 v125, 0x80008000, v93
    v_xor_b32 v126, 0x80008000, v94
    v_xor_b32 v127, 0x80008000, v95
    v_xor_b32 v128, 0x80008000, v96
    v_xor_b32 v129, 0x80008000, v97
    v_xor_b32 v130, 0x80008000, v98
    v_xor_b32 v131, 0x80008000, v99
    v_mfma_f32_32x32x16_bf16 v[132:147], v[84:87], v[68:71], 0
    v_mfma_f32_32x32x16_bf16 v[164:179], v[100:103], v[68:71], 0
    v_mfma_f32_32x32x16_bf16 v[132:147], v[100:103], v[76:79], v[132:147]
    v_mfma_f32_32x32x16_bf16 v[164:179], v[116:119], v[76:79], v[164:179]
    v_mfma_f32_32x32x16_bf16 v[132:147], v[88:91], v[72:75], v[132:147]
    v_mfma_f32_32x32x16_bf16 v[164:179], v[104:107], v[72:75], v[164:179]
    v_mfma_f32_32x32x16_bf16 v[132:147], v[104:107], v[80:83], v[132:147]
    v_mfma_f32_32x32x16_bf16 v[164:179], v[120:123], v[80:83], v[164:179]
    v_mfma_f32_32x32x16_bf16 v[148:163], v[92:95], v[68:71], 0
    v_mfma_f32_32x32x16_bf16 v[180:195], v[108:111], v[68:71], 0
    v_mfma_f32_32x32x16_bf16 v[148:163], v[108:111], v[76:79], v[148:163]
    v_mfma_f32_32x32x16_bf16 v[180:195], v[124:127], v[76:79], v[180:195]
    v_mfma_f32_32x32x16_bf16 v[148:163], v[96:99], v[72:75], v[148:163]
    v_mfma_f32_32x32x16_bf16 v[180:195], v[112:115], v[72:75], v[180:195]
    v_mfma_f32_32x32x16_bf16 v[148:163], v[112:115], v[80:83], v[148:163]
    v_mfma_f32_32x32x16_bf16 v[180:195], v[128:131], v[80:83], v[180:195]
    v_fmamk_f32 v243, v228, 0x0, v229
    v_cos_f32 v239, v243
    v_sin_f32 v240, v243
    v_mul_f32 v239, s4, v239
    v_mul_f32 v240, s4, v240
    v_mul_f32 v235, v132, v239
    v_mul_f32 v237, v164, v239
    v_fma_f32 v235, v164, v240, v235
    v_fma_f32 v237, -v132, v240, v237
    v_fmamk_f32 v243, v228, 0x3a000000, v229
    v_cos_f32 v241, v243
    v_sin_f32 v242, v243
    v_mul_f32 v241, s4, v241
    v_mul_f32 v242, s4, v242
    v_mul_f32 v236, v133, v241
    v_mul_f32 v238, v165, v241
    v_fma_f32 v236, v165, v242, v236
    v_fma_f32 v238, -v133, v242, v238
    v_cvt_pk_bf16_f32 v84, v235, v236
    v_cvt_pk_bf16_f32 v100, v237, v238
    v_cvt_pk_bf16_f32 v116, -v235, -v236
    v_fmamk_f32 v243, v228, 0x3a800000, v229
    v_cos_f32 v239, v243
    v_sin_f32 v240, v243
    v_mul_f32 v239, s4, v239
    v_mul_f32 v240, s4, v240
    v_mul_f32 v235, v134, v239
    v_mul_f32 v237, v166, v239
    v_fma_f32 v235, v166, v240, v235
    v_fma_f32 v237, -v134, v240, v237
    v_fmamk_f32 v243, v228, 0x3ac00000, v229
    v_cos_f32 v241, v243
    v_sin_f32 v242, v243
    v_mul_f32 v241, s4, v241
    v_mul_f32 v242, s4, v242
    v_mul_f32 v236, v135, v241
    v_mul_f32 v238, v167, v241
    v_fma_f32 v236, v167, v242, v236
    v_fma_f32 v238, -v135, v242, v238
    v_cvt_pk_bf16_f32 v85, v235, v236
    v_cvt_pk_bf16_f32 v101, v237, v238
    v_cvt_pk_bf16_f32 v117, -v235, -v236
    v_fmamk_f32 v243, v228, 0x3b800000, v229
    v_cos_f32 v239, v243
    v_sin_f32 v240, v243
    v_mul_f32 v239, s4, v239
    v_mul_f32 v240, s4, v240
    v_mul_f32 v235, v136, v239
    v_mul_f32 v237, v168, v239
    v_fma_f32 v235, v168, v240, v235
    v_fma_f32 v237, -v136, v240, v237
    v_fmamk_f32 v243, v228, 0x3b900000, v229
    v_cos_f32 v241, v243
    v_sin_f32 v242, v243
    v_mul_f32 v241, s4, v241
    v_mul_f32 v242, s4, v242
    v_mul_f32 v236, v137, v241
    v_mul_f32 v238, v169, v241
    v_fma_f32 v236, v169, v242, v236
    v_fma_f32 v238, -v137, v242, v238
    v_cvt_pk_bf16_f32 v86, v235, v236
    v_cvt_pk_bf16_f32 v102, v237, v238
    v_cvt_pk_bf16_f32 v118, -v235, -v236
    v_fmamk_f32 v243, v228, 0x3ba00000, v229
    v_cos_f32 v239, v243
    v_sin_f32 v240, v243
    v_mul_f32 v239, s4, v239
    v_mul_f32 v240, s4, v240
    v_mul_f32 v235, v138, v239
    v_mul_f32 v237, v170, v239
    v_fma_f32 v235, v170, v240, v235
    v_fma_f32 v237, -v138, v240, v237
    v_fmamk_f32 v243, v228, 0x3bb00000, v229
    v_cos_f32 v241, v243
    v_sin_f32 v242, v243
    v_mul_f32 v241, s4, v241
    v_mul_f32 v242, s4, v242
    v_mul_f32 v236, v139, v241
    v_mul_f32 v238, v171, v241
    v_fma_f32 v236, v171, v242, v236
    v_fma_f32 v238, -v139, v242, v238
    v_cvt_pk_bf16_f32 v87, v235, v236
    v_cvt_pk_bf16_f32 v103, v237, v238
    v_cvt_pk_bf16_f32 v119, -v235, -v236
    v_fmamk_f32 v243, v228, 0x3c000000, v229
    v_cos_f32 v239, v243
    v_sin_f32 v240, v243
    v_mul_f32 v239, s4, v239
    v_mul_f32 v240, s4, v240
    v_mul_f32 v235, v140, v239
    v_mul_f32 v237, v172, v239
    v_fma_f32 v235, v172, v240, v235
    v_fma_f32 v237, -v140, v240, v237
    v_fmamk_f32 v243, v228, 0x3c080000, v229
    v_cos_f32 v241, v243
    v_sin_f32 v242, v243
    v_mul_f32 v241, s4, v241
    v_mul_f32 v242, s4, v242
    v_mul_f32 v236, v141, v241
    v_mul_f32 v238, v173, v241
    v_fma_f32 v236, v173, v242, v236
    v_fma_f32 v238, -v141, v242, v238
    v_cvt_pk_bf16_f32 v88, v235, v236
    v_cvt_pk_bf16_f32 v104, v237, v238
    v_cvt_pk_bf16_f32 v120, -v235, -v236
    v_fmamk_f32 v243, v228, 0x3c100000, v229
    v_cos_f32 v239, v243
    v_sin_f32 v240, v243
    v_mul_f32 v239, s4, v239
    v_mul_f32 v240, s4, v240
    v_mul_f32 v235, v142, v239
    v_mul_f32 v237, v174, v239
    v_fma_f32 v235, v174, v240, v235
    v_fma_f32 v237, -v142, v240, v237
    v_fmamk_f32 v243, v228, 0x3c180000, v229
    v_cos_f32 v241, v243
    v_sin_f32 v242, v243
    v_mul_f32 v241, s4, v241
    v_mul_f32 v242, s4, v242
    v_mul_f32 v236, v143, v241
    v_mul_f32 v238, v175, v241
    v_fma_f32 v236, v175, v242, v236
    v_fma_f32 v238, -v143, v242, v238
    v_cvt_pk_bf16_f32 v89, v235, v236
    v_cvt_pk_bf16_f32 v105, v237, v238
    v_cvt_pk_bf16_f32 v121, -v235, -v236
    v_fmamk_f32 v243, v228, 0x3c400000, v229
    v_cos_f32 v239, v243
    v_sin_f32 v240, v243
    v_mul_f32 v239, s4, v239
    v_mul_f32 v240, s4, v240
    v_mul_f32 v235, v144, v239
    v_mul_f32 v237, v176, v239
    v_fma_f32 v235, v176, v240, v235
    v_fma_f32 v237, -v144, v240, v237
    v_fmamk_f32 v243, v228, 0x3c480000, v229
    v_cos_f32 v241, v243
    v_sin_f32 v242, v243
    v_mul_f32 v241, s4, v241
    v_mul_f32 v242, s4, v242
    v_mul_f32 v236, v145, v241
    v_mul_f32 v238, v177, v241
    v_fma_f32 v236, v177, v242, v236
    v_fma_f32 v238, -v145, v242, v238
    v_cvt_pk_bf16_f32 v90, v235, v236
    v_cvt_pk_bf16_f32 v106, v237, v238
    v_cvt_pk_bf16_f32 v122, -v235, -v236
    v_fmamk_f32 v243, v228, 0x3c500000, v229
    v_cos_f32 v239, v243
    v_sin_f32 v240, v243
    v_mul_f32 v239, s4, v239
    v_mul_f32 v240, s4, v240
    v_mul_f32 v235, v146, v239
    v_mul_f32 v237, v178, v239
    v_fma_f32 v235, v178, v240, v235
    v_fma_f32 v237, -v146, v240, v237
    v_fmamk_f32 v243, v228, 0x3c580000, v229
    v_cos_f32 v241, v243
    v_sin_f32 v242, v243
    v_mul_f32 v241, s4, v241
    v_mul_f32 v242, s4, v242
    v_mul_f32 v236, v147, v241
    v_mul_f32 v238, v179, v241
    v_fma_f32 v236, v179, v242, v236
    v_fma_f32 v238, -v147, v242, v238
    v_cvt_pk_bf16_f32 v91, v235, v236
    v_cvt_pk_bf16_f32 v107, v237, v238
    v_cvt_pk_bf16_f32 v123, -v235, -v236
    v_fmamk_f32 v243, v228, 0x3c800000, v229
    v_cos_f32 v239, v243
    v_sin_f32 v240, v243
    v_mul_f32 v239, s4, v239
    v_mul_f32 v240, s4, v240
    v_mul_f32 v235, v148, v239
    v_mul_f32 v237, v180, v239
    v_fma_f32 v235, v180, v240, v235
    v_fma_f32 v237, -v148, v240, v237
    v_fmamk_f32 v243, v228, 0x3c840000, v229
    v_cos_f32 v241, v243
    v_sin_f32 v242, v243
    v_mul_f32 v241, s4, v241
    v_mul_f32 v242, s4, v242
    v_mul_f32 v236, v149, v241
    v_mul_f32 v238, v181, v241
    v_fma_f32 v236, v181, v242, v236
    v_fma_f32 v238, -v149, v242, v238
    v_cvt_pk_bf16_f32 v92, v235, v236
    v_cvt_pk_bf16_f32 v108, v237, v238
    v_cvt_pk_bf16_f32 v124, -v235, -v236
    v_fmamk_f32 v243, v228, 0x3c880000, v229
    v_cos_f32 v239, v243
    v_sin_f32 v240, v243
    v_mul_f32 v239, s4, v239
    v_mul_f32 v240, s4, v240
    v_mul_f32 v235, v150, v239
    v_mul_f32 v237, v182, v239
    v_fma_f32 v235, v182, v240, v235
    v_fma_f32 v237, -v150, v240, v237
    v_fmamk_f32 v243, v228, 0x3c8c0000, v229
    v_cos_f32 v241, v243
    v_sin_f32 v242, v243
    v_mul_f32 v241, s4, v241
    v_mul_f32 v242, s4, v242
    v_mul_f32 v236, v151, v241
    v_mul_f32 v238, v183, v241
    v_fma_f32 v236, v183, v242, v236
    v_fma_f32 v238, -v151, v242, v238
    v_cvt_pk_bf16_f32 v93, v235, v236
    v_cvt_pk_bf16_f32 v109, v237, v238
    v_cvt_pk_bf16_f32 v125, -v235, -v236
    v_fmamk_f32 v243, v228, 0x3ca00000, v229
    v_cos_f32 v239, v243
    v_sin_f32 v240, v243
    v_mul_f32 v239, s4, v239
    v_mul_f32 v240, s4, v240
    v_mul_f32 v235, v152, v239
    v_mul_f32 v237, v184, v239
    v_fma_f32 v235, v184, v240, v235
    v_fma_f32 v237, -v152, v240, v237
    v_fmamk_f32 v243, v228, 0x3ca40000, v229
    v_cos_f32 v241, v243
    v_sin_f32 v242, v243
    v_mul_f32 v241, s4, v241
    v_mul_f32 v242, s4, v242
    v_mul_f32 v236, v153, v241
    v_mul_f32 v238, v185, v241
    v_fma_f32 v236, v185, v242, v236
    v_fma_f32 v238, -v153, v242, v238
    v_cvt_pk_bf16_f32 v94, v235, v236
    v_cvt_pk_bf16_f32 v110, v237, v238
    v_cvt_pk_bf16_f32 v126, -v235, -v236
    v_fmamk_f32 v243, v228, 0x3ca80000, v229
    v_cos_f32 v239, v243
    v_sin_f32 v240, v243
    v_mul_f32 v239, s4, v239
    v_mul_f32 v240, s4, v240
    v_mul_f32 v235, v154, v239
    v_mul_f32 v237, v186, v239
    v_fma_f32 v235, v186, v240, v235
    v_fma_f32 v237, -v154, v240, v237
    v_fmamk_f32 v243, v228, 0x3cac0000, v229
    v_cos_f32 v241, v243
    v_sin_f32 v242, v243
    v_mul_f32 v241, s4, v241
    v_mul_f32 v242, s4, v242
    v_mul_f32 v236, v155, v241
    v_mul_f32 v238, v187, v241
    v_fma_f32 v236, v187, v242, v236
    v_fma_f32 v238, -v155, v242, v238
    v_cvt_pk_bf16_f32 v95, v235, v236
    v_cvt_pk_bf16_f32 v111, v237, v238
    v_cvt_pk_bf16_f32 v127, -v235, -v236
    v_fmamk_f32 v243, v228, 0x3cc00000, v229
    v_cos_f32 v239, v243
    v_sin_f32 v240, v243
    v_mul_f32 v239, s4, v239
    v_mul_f32 v240, s4, v240
    v_mul_f32 v235, v156, v239
    v_mul_f32 v237, v188, v239
    v_fma_f32 v235, v188, v240, v235
    v_fma_f32 v237, -v156, v240, v237
    v_fmamk_f32 v243, v228, 0x3cc40000, v229
    v_cos_f32 v241, v243
    v_sin_f32 v242, v243
    v_mul_f32 v241, s4, v241
    v_mul_f32 v242, s4, v242
    v_mul_f32 v236, v157, v241
    v_mul_f32 v238, v189, v241
    v_fma_f32 v236, v189, v242, v236
    v_fma_f32 v238, -v157, v242, v238
    v_cvt_pk_bf16_f32 v96, v235, v236
    v_cvt_pk_bf16_f32 v112, v237, v238
    v_cvt_pk_bf16_f32 v128, -v235, -v236
    v_fmamk_f32 v243, v228, 0x3cc80000, v229
    v_cos_f32 v239, v243
    v_sin_f32 v240, v243
    v_mul_f32 v239, s4, v239
    v_mul_f32 v240, s4, v240
    v_mul_f32 v235, v158, v239
    v_mul_f32 v237, v190, v239
    v_fma_f32 v235, v190, v240, v235
    v_fma_f32 v237, -v158, v240, v237
    v_fmamk_f32 v243, v228, 0x3ccc0000, v229
    v_cos_f32 v241, v243
    v_sin_f32 v242, v243
    v_mul_f32 v241, s4, v241
    v_mul_f32 v242, s4, v242
    v_mul_f32 v236, v159, v241
    v_mul_f32 v238, v191, v241
    v_fma_f32 v236, v191, v242, v236
    v_fma_f32 v238, -v159, v242, v238
    v_cvt_pk_bf16_f32 v97, v235, v236
    v_cvt_pk_bf16_f32 v113, v237, v238
    v_cvt_pk_bf16_f32 v129, -v235, -v236
    v_fmamk_f32 v243, v228, 0x3ce00000, v229
    v_cos_f32 v239, v243
    v_sin_f32 v240, v243
    v_mul_f32 v239, s4, v239
    v_mul_f32 v240, s4, v240
    v_mul_f32 v235, v160, v239
    v_mul_f32 v237, v192, v239
    v_fma_f32 v235, v192, v240, v235
    v_fma_f32 v237, -v160, v240, v237
    v_fmamk_f32 v243, v228, 0x3ce40000, v229
    v_cos_f32 v241, v243
    v_sin_f32 v242, v243
    v_mul_f32 v241, s4, v241
    v_mul_f32 v242, s4, v242
    v_mul_f32 v236, v161, v241
    v_mul_f32 v238, v193, v241
    v_fma_f32 v236, v193, v242, v236
    v_fma_f32 v238, -v161, v242, v238
    v_cvt_pk_bf16_f32 v98, v235, v236
    v_cvt_pk_bf16_f32 v114, v237, v238
    v_cvt_pk_bf16_f32 v130, -v235, -v236
    v_fmamk_f32 v243, v228, 0x3ce80000, v229
    v_cos_f32 v239, v243
    v_sin_f32 v240, v243
    v_mul_f32 v239, s4, v239
    v_mul_f32 v240, s4, v240
    v_mul_f32 v235, v162, v239
    v_mul_f32 v237, v194, v239
    v_fma_f32 v235, v194, v240, v235
    v_fma_f32 v237, -v162, v240, v237
    v_fmamk_f32 v243, v228, 0x3cec0000, v229
    v_cos_f32 v241, v243
    v_sin_f32 v242, v243
    v_mul_f32 v241, s4, v241
    v_mul_f32 v242, s4, v242
    v_mul_f32 v236, v163, v241
    v_mul_f32 v238, v195, v241
    v_fma_f32 v236, v195, v242, v236
    v_fma_f32 v238, -v163, v242, v238
    v_cvt_pk_bf16_f32 v99, v235, v236
    v_cvt_pk_bf16_f32 v115, v237, v238
    v_cvt_pk_bf16_f32 v131, -v235, -v236
    v_mfma_f32_32x32x16_bf16 v[132:147], v[4:7], v[84:87], 0
    v_mfma_f32_32x32x16_bf16 v[164:179], v[4:7], v[100:103], 0
    v_mfma_f32_32x32x16_bf16 v[132:147], v[36:39], v[100:103], v[132:147]
    v_mfma_f32_32x32x16_bf16 v[164:179], v[36:39], v[116:119], v[164:179]
    v_mfma_f32_32x32x16_bf16 v[132:147], v[8:11], v[88:91], v[132:147]
    v_mfma_f32_32x32x16_bf16 v[164:179], v[8:11], v[104:107], v[164:179]
    v_mfma_f32_32x32x16_bf16 v[132:147], v[40:43], v[104:107], v[132:147]
    v_mfma_f32_32x32x16_bf16 v[164:179], v[40:43], v[120:123], v[164:179]
    v_mfma_f32_32x32x16_bf16 v[132:147], v[12:15], v[92:95], v[132:147]
    v_mfma_f32_32x32x16_bf16 v[164:179], v[12:15], v[108:111], v[164:179]
    v_mfma_f32_32x32x16_bf16 v[132:147], v[44:47], v[108:111], v[132:147]
    v_mfma_f32_32x32x16_bf16 v[164:179], v[44:47], v[124:127], v[164:179]
    v_mfma_f32_32x32x16_bf16 v[132:147], v[16:19], v[96:99], v[132:147]
    v_mfma_f32_32x32x16_bf16 v[164:179], v[16:19], v[112:115], v[164:179]
    v_mfma_f32_32x32x16_bf16 v[132:147], v[48:51], v[112:115], v[132:147]
    v_mfma_f32_32x32x16_bf16 v[164:179], v[48:51], v[128:131], v[164:179]
    v_mfma_f32_32x32x16_bf16 v[148:163], v[20:23], v[84:87], 0
    v_mfma_f32_32x32x16_bf16 v[180:195], v[20:23], v[100:103], 0
    v_mfma_f32_32x32x16_bf16 v[148:163], v[52:55], v[100:103], v[148:163]
    v_mfma_f32_32x32x16_bf16 v[180:195], v[52:55], v[116:119], v[180:195]
    v_mfma_f32_32x32x16_bf16 v[148:163], v[24:27], v[88:91], v[148:163]
    v_mfma_f32_32x32x16_bf16 v[180:195], v[24:27], v[104:107], v[180:195]
    v_mfma_f32_32x32x16_bf16 v[148:163], v[56:59], v[104:107], v[148:163]
    v_mfma_f32_32x32x16_bf16 v[180:195], v[56:59], v[120:123], v[180:195]
    v_mfma_f32_32x32x16_bf16 v[148:163], v[28:31], v[92:95], v[148:163]
    v_mfma_f32_32x32x16_bf16 v[180:195], v[28:31], v[108:111], v[180:195]
    v_mfma_f32_32x32x16_bf16 v[148:163], v[60:63], v[108:111], v[148:163]
    v_mfma_f32_32x32x16_bf16 v[180:195], v[60:63], v[124:127], v[180:195]
    v_mfma_f32_32x32x16_bf16 v[148:163], v[32:35], v[96:99], v[148:163]
    v_mfma_f32_32x32x16_bf16 v[180:195], v[32:35], v[112:115], v[180:195]
    v_mfma_f32_32x32x16_bf16 v[148:163], v[64:67], v[112:115], v[148:163]
    v_mfma_f32_32x32x16_bf16 v[180:195], v[64:67], v[128:131], v[180:195]
    v_lshlrev_b32 v239, 16, v196
    v_and_b32 v240, 0xffff0000, v196
    v_mul_f32 v235, v132, v239
    v_mul_f32 v237, v164, v239
    v_fma_f32 v235, -v164, v240, v235
    v_fma_f32 v237, v132, v240, v237
    v_lshlrev_b32 v241, 16, v197
    v_and_b32 v242, 0xffff0000, v197
    v_mul_f32 v236, v133, v241
    v_mul_f32 v238, v165, v241
    v_fma_f32 v236, -v165, v242, v236
    v_fma_f32 v238, v133, v242, v238
    v_cvt_pk_bf16_f32 v84, v235, v236
    v_cvt_pk_bf16_f32 v100, v237, v238
    v_cvt_pk_bf16_f32 v116, -v237, -v238
    v_lshlrev_b32 v239, 16, v198
    v_and_b32 v240, 0xffff0000, v198
    v_mul_f32 v235, v134, v239
    v_mul_f32 v237, v166, v239
    v_fma_f32 v235, -v166, v240, v235
    v_fma_f32 v237, v134, v240, v237
    v_lshlrev_b32 v241, 16, v199
    v_and_b32 v242, 0xffff0000, v199
    v_mul_f32 v236, v135, v241
    v_mul_f32 v238, v167, v241
    v_fma_f32 v236, -v167, v242, v236
    v_fma_f32 v238, v135, v242, v238
    v_cvt_pk_bf16_f32 v85, v235, v236
    v_cvt_pk_bf16_f32 v101, v237, v238
    v_cvt_pk_bf16_f32 v117, -v237, -v238
    v_lshlrev_b32 v239, 16, v200
    v_and_b32 v240, 0xffff0000, v200
    v_mul_f32 v235, v136, v239
    v_mul_f32 v237, v168, v239
    v_fma_f32 v235, -v168, v240, v235
    v_fma_f32 v237, v136, v240, v237
    v_lshlrev_b32 v241, 16, v201
    v_and_b32 v242, 0xffff0000, v201
    v_mul_f32 v236, v137, v241
    v_mul_f32 v238, v169, v241
    v_fma_f32 v236, -v169, v242, v236
    v_fma_f32 v238, v137, v242, v238
    v_cvt_pk_bf16_f32 v86, v235, v236
    v_cvt_pk_bf16_f32 v102, v237, v238
    v_cvt_pk_bf16_f32 v118, -v237, -v238
    v_lshlrev_b32 v239, 16, v202
    v_and_b32 v240, 0xffff0000, v202
    v_mul_f32 v235, v138, v239
    v_mul_f32 v237, v170, v239
    v_fma_f32 v235, -v170, v240, v235
    v_fma_f32 v237, v138, v240, v237
    v_lshlrev_b32 v241, 16, v203
    v_and_b32 v242, 0xffff0000, v203
    v_mul_f32 v236, v139, v241
    v_mul_f32 v238, v171, v241
    v_fma_f32 v236, -v171, v242, v236
    v_fma_f32 v238, v139, v242, v238
    v_cvt_pk_bf16_f32 v87, v235, v236
    v_cvt_pk_bf16_f32 v103, v237, v238
    v_cvt_pk_bf16_f32 v119, -v237, -v238
    v_lshlrev_b32 v239, 16, v204
    v_and_b32 v240, 0xffff0000, v204
    v_mul_f32 v235, v140, v239
    v_mul_f32 v237, v172, v239
    v_fma_f32 v235, -v172, v240, v235
    v_fma_f32 v237, v140, v240, v237
    v_lshlrev_b32 v241, 16, v205
    v_and_b32 v242, 0xffff0000, v205
    v_mul_f32 v236, v141, v241
    v_mul_f32 v238, v173, v241
    v_fma_f32 v236, -v173, v242, v236
    v_fma_f32 v238, v141, v242, v238
    v_cvt_pk_bf16_f32 v88, v235, v236
    v_cvt_pk_bf16_f32 v104, v237, v238
    v_cvt_pk_bf16_f32 v120, -v237, -v238
    v_lshlrev_b32 v239, 16, v206
    v_and_b32 v240, 0xffff0000, v206
    v_mul_f32 v235, v142, v239
    v_mul_f32 v237, v174, v239
    v_fma_f32 v235, -v174, v240, v235
    v_fma_f32 v237, v142, v240, v237
    v_lshlrev_b32 v241, 16, v207
    v_and_b32 v242, 0xffff0000, v207
    v_mul_f32 v236, v143, v241
    v_mul_f32 v238, v175, v241
    v_fma_f32 v236, -v175, v242, v236
    v_fma_f32 v238, v143, v242, v238
    v_cvt_pk_bf16_f32 v89, v235, v236
    v_cvt_pk_bf16_f32 v105, v237, v238
    v_cvt_pk_bf16_f32 v121, -v237, -v238
    v_lshlrev_b32 v239, 16, v208
    v_and_b32 v240, 0xffff0000, v208
    v_mul_f32 v235, v144, v239
    v_mul_f32 v237, v176, v239
    v_fma_f32 v235, -v176, v240, v235
    v_fma_f32 v237, v144, v240, v237
    v_lshlrev_b32 v241, 16, v209
    v_and_b32 v242, 0xffff0000, v209
    v_mul_f32 v236, v145, v241
    v_mul_f32 v238, v177, v241
    v_fma_f32 v236, -v177, v242, v236
    v_fma_f32 v238, v145, v242, v238
    v_cvt_pk_bf16_f32 v90, v235, v236
    v_cvt_pk_bf16_f32 v106, v237, v238
    v_cvt_pk_bf16_f32 v122, -v237, -v238
    v_lshlrev_b32 v239, 16, v210
    v_and_b32 v240, 0xffff0000, v210
    v_mul_f32 v235, v146, v239
    v_mul_f32 v237, v178, v239
    v_fma_f32 v235, -v178, v240, v235
    v_fma_f32 v237, v146, v240, v237
    v_lshlrev_b32 v241, 16, v211
    v_and_b32 v242, 0xffff0000, v211
    v_mul_f32 v236, v147, v241
    v_mul_f32 v238, v179, v241
    v_fma_f32 v236, -v179, v242, v236
    v_fma_f32 v238, v147, v242, v238
    v_cvt_pk_bf16_f32 v91, v235, v236
    v_cvt_pk_bf16_f32 v107, v237, v238
    v_cvt_pk_bf16_f32 v123, -v237, -v238
    v_lshlrev_b32 v239, 16, v212
    v_and_b32 v240, 0xffff0000, v212
    v_mul_f32 v235, v148, v239
    v_mul_f32 v237, v180, v239
    v_fma_f32 v235, -v180, v240, v235
    v_fma_f32 v237, v148, v240, v237
    v_lshlrev_b32 v241, 16, v213
    v_and_b32 v242, 0xffff0000, v213
    v_mul_f32 v236, v149, v241
    v_mul_f32 v238, v181, v241
    v_fma_f32 v236, -v181, v242, v236
    v_fma_f32 v238, v149, v242, v238
    v_cvt_pk_bf16_f32 v92, v235, v236
    v_cvt_pk_bf16_f32 v108, v237, v238
    v_cvt_pk_bf16_f32 v124, -v237, -v238
    v_lshlrev_b32 v239, 16, v214
    v_and_b32 v240, 0xffff0000, v214
    v_mul_f32 v235, v150, v239
    v_mul_f32 v237, v182, v239
    v_fma_f32 v235, -v182, v240, v235
    v_fma_f32 v237, v150, v240, v237
    v_lshlrev_b32 v241, 16, v215
    v_and_b32 v242, 0xffff0000, v215
    v_mul_f32 v236, v151, v241
    v_mul_f32 v238, v183, v241
    v_fma_f32 v236, -v183, v242, v236
    v_fma_f32 v238, v151, v242, v238
    v_cvt_pk_bf16_f32 v93, v235, v236
    v_cvt_pk_bf16_f32 v109, v237, v238
    v_cvt_pk_bf16_f32 v125, -v237, -v238
    v_lshlrev_b32 v239, 16, v216
    v_and_b32 v240, 0xffff0000, v216
    v_mul_f32 v235, v152, v239
    v_mul_f32 v237, v184, v239
    v_fma_f32 v235, -v184, v240, v235
    v_fma_f32 v237, v152, v240, v237
    v_lshlrev_b32 v241, 16, v217
    v_and_b32 v242, 0xffff0000, v217
    v_mul_f32 v236, v153, v241
    v_mul_f32 v238, v185, v241
    v_fma_f32 v236, -v185, v242, v236
    v_fma_f32 v238, v153, v242, v238
    v_cvt_pk_bf16_f32 v94, v235, v236
    v_cvt_pk_bf16_f32 v110, v237, v238
    v_cvt_pk_bf16_f32 v126, -v237, -v238
    v_lshlrev_b32 v239, 16, v218
    v_and_b32 v240, 0xffff0000, v218
    v_mul_f32 v235, v154, v239
    v_mul_f32 v237, v186, v239
    v_fma_f32 v235, -v186, v240, v235
    v_fma_f32 v237, v154, v240, v237
    v_lshlrev_b32 v241, 16, v219
    v_and_b32 v242, 0xffff0000, v219
    v_mul_f32 v236, v155, v241
    v_mul_f32 v238, v187, v241
    v_fma_f32 v236, -v187, v242, v236
    v_fma_f32 v238, v155, v242, v238
    v_cvt_pk_bf16_f32 v95, v235, v236
    v_cvt_pk_bf16_f32 v111, v237, v238
    v_cvt_pk_bf16_f32 v127, -v237, -v238
    v_lshlrev_b32 v239, 16, v220
    v_and_b32 v240, 0xffff0000, v220
    v_mul_f32 v235, v156, v239
    v_mul_f32 v237, v188, v239
    v_fma_f32 v235, -v188, v240, v235
    v_fma_f32 v237, v156, v240, v237
    v_lshlrev_b32 v241, 16, v221
    v_and_b32 v242, 0xffff0000, v221
    v_mul_f32 v236, v157, v241
    v_mul_f32 v238, v189, v241
    v_fma_f32 v236, -v189, v242, v236
    v_fma_f32 v238, v157, v242, v238
    v_cvt_pk_bf16_f32 v96, v235, v236
    v_cvt_pk_bf16_f32 v112, v237, v238
    v_cvt_pk_bf16_f32 v128, -v237, -v238
    v_lshlrev_b32 v239, 16, v222
    v_and_b32 v240, 0xffff0000, v222
    v_mul_f32 v235, v158, v239
    v_mul_f32 v237, v190, v239
    v_fma_f32 v235, -v190, v240, v235
    v_fma_f32 v237, v158, v240, v237
    v_lshlrev_b32 v241, 16, v223
    v_and_b32 v242, 0xffff0000, v223
    v_mul_f32 v236, v159, v241
    v_mul_f32 v238, v191, v241
    v_fma_f32 v236, -v191, v242, v236
    v_fma_f32 v238, v159, v242, v238
    v_cvt_pk_bf16_f32 v97, v235, v236
    v_cvt_pk_bf16_f32 v113, v237, v238
    v_cvt_pk_bf16_f32 v129, -v237, -v238
    v_lshlrev_b32 v239, 16, v224
    v_and_b32 v240, 0xffff0000, v224
    v_mul_f32 v235, v160, v239
    v_mul_f32 v237, v192, v239
    v_fma_f32 v235, -v192, v240, v235
    v_fma_f32 v237, v160, v240, v237
    v_lshlrev_b32 v241, 16, v225
    v_and_b32 v242, 0xffff0000, v225
    v_mul_f32 v236, v161, v241
    v_mul_f32 v238, v193, v241
    v_fma_f32 v236, -v193, v242, v236
    v_fma_f32 v238, v161, v242, v238
    v_cvt_pk_bf16_f32 v98, v235, v236
    v_cvt_pk_bf16_f32 v114, v237, v238
    v_cvt_pk_bf16_f32 v130, -v237, -v238
    v_lshlrev_b32 v239, 16, v226
    v_and_b32 v240, 0xffff0000, v226
    v_mul_f32 v235, v162, v239
    v_mul_f32 v237, v194, v239
    v_fma_f32 v235, -v194, v240, v235
    v_fma_f32 v237, v162, v240, v237
    v_lshlrev_b32 v241, 16, v227
    v_and_b32 v242, 0xffff0000, v227
    v_mul_f32 v236, v163, v241
    v_mul_f32 v238, v195, v241
    v_fma_f32 v236, -v195, v242, v236
    v_fma_f32 v238, v163, v242, v238
    v_cvt_pk_bf16_f32 v99, v235, v236
    v_cvt_pk_bf16_f32 v115, v237, v238
    v_cvt_pk_bf16_f32 v131, -v237, -v238
    v_mfma_f32_32x32x16_bf16 v[132:147], v[84:87], v[4:7], 0
    v_mfma_f32_32x32x16_bf16 v[164:179], v[100:103], v[4:7], 0
    v_mfma_f32_32x32x16_bf16 v[132:147], v[116:119], v[36:39], v[132:147]
    v_mfma_f32_32x32x16_bf16 v[164:179], v[84:87], v[36:39], v[164:179]
    v_mfma_f32_32x32x16_bf16 v[132:147], v[88:91], v[8:11], v[132:147]
    v_mfma_f32_32x32x16_bf16 v[164:179], v[104:107], v[8:11], v[164:179]
    v_mfma_f32_32x32x16_bf16 v[132:147], v[120:123], v[40:43], v[132:147]
    v_mfma_f32_32x32x16_bf16 v[164:179], v[88:91], v[40:43], v[164:179]
    v_mfma_f32_32x32x16_bf16 v[132:147], v[92:95], v[12:15], v[132:147]
    v_mfma_f32_32x32x16_bf16 v[164:179], v[108:111], v[12:15], v[164:179]
    v_mfma_f32_32x32x16_bf16 v[132:147], v[124:127], v[44:47], v[132:147]
    v_mfma_f32_32x32x16_bf16 v[164:179], v[92:95], v[44:47], v[164:179]
    v_mfma_f32_32x32x16_bf16 v[132:147], v[96:99], v[16:19], v[132:147]
    v_mfma_f32_32x32x16_bf16 v[164:179], v[112:115], v[16:19], v[164:179]
    v_mfma_f32_32x32x16_bf16 v[132:147], v[128:131], v[48:51], v[132:147]
    v_mfma_f32_32x32x16_bf16 v[164:179], v[96:99], v[48:51], v[164:179]
    v_mfma_f32_32x32x16_bf16 v[148:163], v[84:87], v[20:23], 0
    v_mfma_f32_32x32x16_bf16 v[180:195], v[100:103], v[20:23], 0
    v_mfma_f32_32x32x16_bf16 v[148:163], v[116:119], v[52:55], v[148:163]
    v_mfma_f32_32x32x16_bf16 v[180:195], v[84:87], v[52:55], v[180:195]
    v_mfma_f32_32x32x16_bf16 v[148:163], v[88:91], v[24:27], v[148:163]
    v_mfma_f32_32x32x16_bf16 v[180:195], v[104:107], v[24:27], v[180:195]
    v_mfma_f32_32x32x16_bf16 v[148:163], v[120:123], v[56:59], v[148:163]
    v_mfma_f32_32x32x16_bf16 v[180:195], v[88:91], v[56:59], v[180:195]
    v_mfma_f32_32x32x16_bf16 v[148:163], v[92:95], v[28:31], v[148:163]
    v_mfma_f32_32x32x16_bf16 v[180:195], v[108:111], v[28:31], v[180:195]
    v_mfma_f32_32x32x16_bf16 v[148:163], v[124:127], v[60:63], v[148:163]
    v_mfma_f32_32x32x16_bf16 v[180:195], v[92:95], v[60:63], v[180:195]
    v_mfma_f32_32x32x16_bf16 v[148:163], v[96:99], v[32:35], v[148:163]
    v_mfma_f32_32x32x16_bf16 v[180:195], v[112:115], v[32:35], v[180:195]
    v_mfma_f32_32x32x16_bf16 v[148:163], v[128:131], v[64:67], v[148:163]
    v_mfma_f32_32x32x16_bf16 v[180:195], v[96:99], v[64:67], v[180:195]
    v_fmamk_f32 v243, v228, 0x0, v229
    v_cos_f32 v239, v243
    v_sin_f32 v240, v243
    v_mul_f32 v235, v132, v239
    v_mul_f32 v237, v164, v239
    v_fma_f32 v235, -v164, v240, v235
    v_fma_f32 v237, v132, v240, v237
    v_fmamk_f32 v243, v228, 0x3a000000, v229
    v_cos_f32 v241, v243
    v_sin_f32 v242, v243
    v_mul_f32 v236, v133, v241
    v_mul_f32 v238, v165, v241
    v_fma_f32 v236, -v165, v242, v236
    v_fma_f32 v238, v133, v242, v238
    v_cvt_pk_bf16_f32 v84, v235, v236
    v_cvt_pk_bf16_f32 v100, v237, v238
    v_cvt_pk_bf16_f32 v116, -v237, -v238
    v_fmamk_f32 v243, v228, 0x3a800000, v229
    v_cos_f32 v239, v243
    v_sin_f32 v240, v243
    v_mul_f32 v235, v134, v239
    v_mul_f32 v237, v166, v239
    v_fma_f32 v235, -v166, v240, v235
    v_fma_f32 v237, v134, v240, v237
    v_fmamk_f32 v243, v228, 0x3ac00000, v229
    v_cos_f32 v241, v243
    v_sin_f32 v242, v243
    v_mul_f32 v236, v135, v241
    v_mul_f32 v238, v167, v241
    v_fma_f32 v236, -v167, v242, v236
    v_fma_f32 v238, v135, v242, v238
    v_cvt_pk_bf16_f32 v85, v235, v236
    v_cvt_pk_bf16_f32 v101, v237, v238
    v_cvt_pk_bf16_f32 v117, -v237, -v238
    v_fmamk_f32 v243, v228, 0x3b800000, v229
    v_cos_f32 v239, v243
    v_sin_f32 v240, v243
    v_mul_f32 v235, v136, v239
    v_mul_f32 v237, v168, v239
    v_fma_f32 v235, -v168, v240, v235
    v_fma_f32 v237, v136, v240, v237
    v_fmamk_f32 v243, v228, 0x3b900000, v229
    v_cos_f32 v241, v243
    v_sin_f32 v242, v243
    v_mul_f32 v236, v137, v241
    v_mul_f32 v238, v169, v241
    v_fma_f32 v236, -v169, v242, v236
    v_fma_f32 v238, v137, v242, v238
    v_cvt_pk_bf16_f32 v86, v235, v236
    v_cvt_pk_bf16_f32 v102, v237, v238
    v_cvt_pk_bf16_f32 v118, -v237, -v238
    v_fmamk_f32 v243, v228, 0x3ba00000, v229
    v_cos_f32 v239, v243
    v_sin_f32 v240, v243
    v_mul_f32 v235, v138, v239
    v_mul_f32 v237, v170, v239
    v_fma_f32 v235, -v170, v240, v235
    v_fma_f32 v237, v138, v240, v237
    v_fmamk_f32 v243, v228, 0x3bb00000, v229
    v_cos_f32 v241, v243
    v_sin_f32 v242, v243
    v_mul_f32 v236, v139, v241
    v_mul_f32 v238, v171, v241
    v_fma_f32 v236, -v171, v242, v236
    v_fma_f32 v238, v139, v242, v238
    v_cvt_pk_bf16_f32 v87, v235, v236
    v_cvt_pk_bf16_f32 v103, v237, v238
    v_cvt_pk_bf16_f32 v119, -v237, -v238
    v_fmamk_f32 v243, v228, 0x3c000000, v229
    v_cos_f32 v239, v243
    v_sin_f32 v240, v243
    v_mul_f32 v235, v140, v239
    v_mul_f32 v237, v172, v239
    v_fma_f32 v235, -v172, v240, v235
    v_fma_f32 v237, v140, v240, v237
    v_fmamk_f32 v243, v228, 0x3c080000, v229
    v_cos_f32 v241, v243
    v_sin_f32 v242, v243
    v_mul_f32 v236, v141, v241
    v_mul_f32 v238, v173, v241
    v_fma_f32 v236, -v173, v242, v236
    v_fma_f32 v238, v141, v242, v238
    v_cvt_pk_bf16_f32 v88, v235, v236
    v_cvt_pk_bf16_f32 v104, v237, v238
    v_cvt_pk_bf16_f32 v120, -v237, -v238
    v_fmamk_f32 v243, v228, 0x3c100000, v229
    v_cos_f32 v239, v243
    v_sin_f32 v240, v243
    v_mul_f32 v235, v142, v239
    v_mul_f32 v237, v174, v239
    v_fma_f32 v235, -v174, v240, v235
    v_fma_f32 v237, v142, v240, v237
    v_fmamk_f32 v243, v228, 0x3c180000, v229
    v_cos_f32 v241, v243
    v_sin_f32 v242, v243
    v_mul_f32 v236, v143, v241
    v_mul_f32 v238, v175, v241
    v_fma_f32 v236, -v175, v242, v236
    v_fma_f32 v238, v143, v242, v238
    v_cvt_pk_bf16_f32 v89, v235, v236
    v_cvt_pk_bf16_f32 v105, v237, v238
    v_cvt_pk_bf16_f32 v121, -v237, -v238
    v_fmamk_f32 v243, v228, 0x3c400000, v229
    v_cos_f32 v239, v243
    v_sin_f32 v240, v243
    v_mul_f32 v235, v144, v239
    v_mul_f32 v237, v176, v239
    v_fma_f32 v235, -v176, v240, v235
    v_fma_f32 v237, v144, v240, v237
    v_fmamk_f32 v243, v228, 0x3c480000, v229
    v_cos_f32 v241, v243
    v_sin_f32 v242, v243
    v_mul_f32 v236, v145, v241
    v_mul_f32 v238, v177, v241
    v_fma_f32 v236, -v177, v242, v236
    v_fma_f32 v238, v145, v242, v238
    v_cvt_pk_bf16_f32 v90, v235, v236
    v_cvt_pk_bf16_f32 v106, v237, v238
    v_cvt_pk_bf16_f32 v122, -v237, -v238
    v_fmamk_f32 v243, v228, 0x3c500000, v229
    v_cos_f32 v239, v243
    v_sin_f32 v240, v243
    v_mul_f32 v235, v146, v239
    v_mul_f32 v237, v178, v239
    v_fma_f32 v235, -v178, v240, v235
    v_fma_f32 v237, v146, v240, v237
    v_fmamk_f32 v243, v228, 0x3c580000, v229
    v_cos_f32 v241, v243
    v_sin_f32 v242, v243
    v_mul_f32 v236, v147, v241
    v_mul_f32 v238, v179, v241
    v_fma_f32 v236, -v179, v242, v236
    v_fma_f32 v238, v147, v242, v238
    v_cvt_pk_bf16_f32 v91, v235, v236
    v_cvt_pk_bf16_f32 v107, v237, v238
    v_cvt_pk_bf16_f32 v123, -v237, -v238
    v_add_f32 v228, 0x42000000, v228
    v_mov_b32 v229, v230
    v_fmamk_f32 v243, v228, 0x0, v229
    v_cos_f32 v239, v243
    v_sin_f32 v240, v243
    v_mul_f32 v235, v148, v239
    v_mul_f32 v237, v180, v239
    v_fma_f32 v235, -v180, v240, v235
    v_fma_f32 v237, v148, v240, v237
    v_fmamk_f32 v243, v228, 0x3a000000, v229
    v_cos_f32 v241, v243
    v_sin_f32 v242, v243
    v_mul_f32 v236, v149, v241
    v_mul_f32 v238, v181, v241
    v_fma_f32 v236, -v181, v242, v236
    v_fma_f32 v238, v149, v242, v238
    v_cvt_pk_bf16_f32 v92, v235, v236
    v_cvt_pk_bf16_f32 v108, v237, v238
    v_cvt_pk_bf16_f32 v124, -v237, -v238
    v_fmamk_f32 v243, v228, 0x3a800000, v229
    v_cos_f32 v239, v243
    v_sin_f32 v240, v243
    v_mul_f32 v235, v150, v239
    v_mul_f32 v237, v182, v239
    v_fma_f32 v235, -v182, v240, v235
    v_fma_f32 v237, v150, v240, v237
    v_fmamk_f32 v243, v228, 0x3ac00000, v229
    v_cos_f32 v241, v243
    v_sin_f32 v242, v243
    v_mul_f32 v236, v151, v241
    v_mul_f32 v238, v183, v241
    v_fma_f32 v236, -v183, v242, v236
    v_fma_f32 v238, v151, v242, v238
    v_cvt_pk_bf16_f32 v93, v235, v236
    v_cvt_pk_bf16_f32 v109, v237, v238
    v_cvt_pk_bf16_f32 v125, -v237, -v238
    v_fmamk_f32 v243, v228, 0x3b800000, v229
    v_cos_f32 v239, v243
    v_sin_f32 v240, v243
    v_mul_f32 v235, v152, v239
    v_mul_f32 v237, v184, v239
    v_fma_f32 v235, -v184, v240, v235
    v_fma_f32 v237, v152, v240, v237
    v_fmamk_f32 v243, v228, 0x3b900000, v229
    v_cos_f32 v241, v243
    v_sin_f32 v242, v243
    v_mul_f32 v236, v153, v241
    v_mul_f32 v238, v185, v241
    v_fma_f32 v236, -v185, v242, v236
    v_fma_f32 v238, v153, v242, v238
    v_cvt_pk_bf16_f32 v94, v235, v236
    v_cvt_pk_bf16_f32 v110, v237, v238
    v_cvt_pk_bf16_f32 v126, -v237, -v238
    v_fmamk_f32 v243, v228, 0x3ba00000, v229
    v_cos_f32 v239, v243
    v_sin_f32 v240, v243
    v_mul_f32 v235, v154, v239
    v_mul_f32 v237, v186, v239
    v_fma_f32 v235, -v186, v240, v235
    v_fma_f32 v237, v154, v240, v237
    v_fmamk_f32 v243, v228, 0x3bb00000, v229
    v_cos_f32 v241, v243
    v_sin_f32 v242, v243
    v_mul_f32 v236, v155, v241
    v_mul_f32 v238, v187, v241
    v_fma_f32 v236, -v187, v242, v236
    v_fma_f32 v238, v155, v242, v238
    v_cvt_pk_bf16_f32 v95, v235, v236
    v_cvt_pk_bf16_f32 v111, v237, v238
    v_cvt_pk_bf16_f32 v127, -v237, -v238
    v_fmamk_f32 v243, v228, 0x3c000000, v229
    v_cos_f32 v239, v243
    v_sin_f32 v240, v243
    v_mul_f32 v235, v156, v239
    v_mul_f32 v237, v188, v239
    v_fma_f32 v235, -v188, v240, v235
    v_fma_f32 v237, v156, v240, v237
    v_fmamk_f32 v243, v228, 0x3c080000, v229
    v_cos_f32 v241, v243
    v_sin_f32 v242, v243
    v_mul_f32 v236, v157, v241
    v_mul_f32 v238, v189, v241
    v_fma_f32 v236, -v189, v242, v236
    v_fma_f32 v238, v157, v242, v238
    v_cvt_pk_bf16_f32 v96, v235, v236
    v_cvt_pk_bf16_f32 v112, v237, v238
    v_cvt_pk_bf16_f32 v128, -v237, -v238
    v_fmamk_f32 v243, v228, 0x3c100000, v229
    v_cos_f32 v239, v243
    v_sin_f32 v240, v243
    v_mul_f32 v235, v158, v239
    v_mul_f32 v237, v190, v239
    v_fma_f32 v235, -v190, v240, v235
    v_fma_f32 v237, v158, v240, v237
    v_fmamk_f32 v243, v228, 0x3c180000, v229
    v_cos_f32 v241, v243
    v_sin_f32 v242, v243
    v_mul_f32 v236, v159, v241
    v_mul_f32 v238, v191, v241
    v_fma_f32 v236, -v191, v242, v236
    v_fma_f32 v238, v159, v242, v238
    v_cvt_pk_bf16_f32 v97, v235, v236
    v_cvt_pk_bf16_f32 v113, v237, v238
    v_cvt_pk_bf16_f32 v129, -v237, -v238
    v_fmamk_f32 v243, v228, 0x3c400000, v229
    v_cos_f32 v239, v243
    v_sin_f32 v240, v243
    v_mul_f32 v235, v160, v239
    v_mul_f32 v237, v192, v239
    v_fma_f32 v235, -v192, v240, v235
    v_fma_f32 v237, v160, v240, v237
    v_fmamk_f32 v243, v228, 0x3c480000, v229
    v_cos_f32 v241, v243
    v_sin_f32 v242, v243
    v_mul_f32 v236, v161, v241
    v_mul_f32 v238, v193, v241
    v_fma_f32 v236, -v193, v242, v236
    v_fma_f32 v238, v161, v242, v238
    v_cvt_pk_bf16_f32 v98, v235, v236
    v_cvt_pk_bf16_f32 v114, v237, v238
    v_cvt_pk_bf16_f32 v130, -v237, -v238
    v_fmamk_f32 v243, v228, 0x3c500000, v229
    v_cos_f32 v239, v243
    v_sin_f32 v240, v243
    v_mul_f32 v235, v162, v239
    v_mul_f32 v237, v194, v239
    v_fma_f32 v235, -v194, v240, v235
    v_fma_f32 v237, v162, v240, v237
    v_fmamk_f32 v243, v228, 0x3c580000, v229
    v_cos_f32 v241, v243
    v_sin_f32 v242, v243
    v_mul_f32 v236, v163, v241
    v_mul_f32 v238, v195, v241
    v_fma_f32 v236, -v195, v242, v236
    v_fma_f32 v238, v163, v242, v238
    v_cvt_pk_bf16_f32 v99, v235, v236
    v_cvt_pk_bf16_f32 v115, v237, v238
    v_cvt_pk_bf16_f32 v131, -v237, -v238
    v_mfma_f32_32x32x16_bf16 v[132:147], v[68:71], v[84:87], 0
    v_mfma_f32_32x32x16_bf16 v[164:179], v[68:71], v[100:103], 0
    v_mfma_f32_32x32x16_bf16 v[132:147], v[76:79], v[116:119], v[132:147]
    v_mfma_f32_32x32x16_bf16 v[164:179], v[76:79], v[84:87], v[164:179]
    v_mfma_f32_32x32x16_bf16 v[132:147], v[72:75], v[88:91], v[132:147]
    v_mfma_f32_32x32x16_bf16 v[164:179], v[72:75], v[104:107], v[164:179]
    v_mfma_f32_32x32x16_bf16 v[132:147], v[80:83], v[120:123], v[132:147]
    v_mfma_f32_32x32x16_bf16 v[164:179], v[80:83], v[88:91], v[164:179]
    v_mfma_f32_32x32x16_bf16 v[148:163], v[68:71], v[92:95], 0
    v_mfma_f32_32x32x16_bf16 v[180:195], v[68:71], v[108:111], 0
    v_mfma_f32_32x32x16_bf16 v[148:163], v[76:79], v[124:127], v[148:163]
    v_mfma_f32_32x32x16_bf16 v[180:195], v[76:79], v[92:95], v[180:195]
    v_mfma_f32_32x32x16_bf16 v[148:163], v[72:75], v[96:99], v[148:163]
    v_mfma_f32_32x32x16_bf16 v[180:195], v[72:75], v[112:115], v[180:195]
    v_mfma_f32_32x32x16_bf16 v[148:163], v[80:83], v[128:131], v[148:163]
    v_mfma_f32_32x32x16_bf16 v[180:195], v[80:83], v[96:99], v[180:195]
    v_lshlrev_b32 v231, 4, v1
    v_add_u32 v232, s6, v231
    s_lshl_b32 s5, s3, 12
    s_add_u32 s5, s5, 0x5800000
    s_add_u32 s2, s5, 4096
    v_cvt_pk_bf16_f32 v84, v132, v133
    v_cvt_pk_bf16_f32 v85, v134, v135
    v_cvt_pk_bf16_f32 v86, v136, v137
    v_cvt_pk_bf16_f32 v87, v138, v139
    buffer_store_dwordx4 v[84:87], v231, s[8:11], s5 offen offset:0 sc1
    v_cvt_pk_bf16_f32 v88, v140, v141
    v_cvt_pk_bf16_f32 v89, v142, v143
    v_cvt_pk_bf16_f32 v90, v144, v145
    v_cvt_pk_bf16_f32 v91, v146, v147
    buffer_store_dwordx4 v[88:91], v231, s[8:11], s5 offen offset:1024 sc1
    v_cvt_pk_bf16_f32 v92, v148, v149
    v_cvt_pk_bf16_f32 v93, v150, v151
    v_cvt_pk_bf16_f32 v94, v152, v153
    v_cvt_pk_bf16_f32 v95, v154, v155
    buffer_store_dwordx4 v[92:95], v231, s[8:11], s5 offen offset:2048 sc1
    v_cvt_pk_bf16_f32 v96, v156, v157
    v_cvt_pk_bf16_f32 v97, v158, v159
    v_cvt_pk_bf16_f32 v98, v160, v161
    v_cvt_pk_bf16_f32 v99, v162, v163
    buffer_store_dwordx4 v[96:99], v231, s[8:11], s5 offen offset:3072 sc1
    v_cvt_pk_bf16_f32 v100, v164, v165
    v_cvt_pk_bf16_f32 v101, v166, v167
    v_cvt_pk_bf16_f32 v102, v168, v169
    v_cvt_pk_bf16_f32 v103, v170, v171
    buffer_store_dwordx4 v[100:103], v232, s[8:11], s2 offen offset:0 sc1
    v_cvt_pk_bf16_f32 v104, v172, v173
    v_cvt_pk_bf16_f32 v105, v174, v175
    v_cvt_pk_bf16_f32 v106, v176, v177
    v_cvt_pk_bf16_f32 v107, v178, v179
    buffer_store_dwordx4 v[104:107], v232, s[8:11], s2 offen offset:1024 sc1
    v_cvt_pk_bf16_f32 v108, v180, v181
    v_cvt_pk_bf16_f32 v109, v182, v183
    v_cvt_pk_bf16_f32 v110, v184, v185
    v_cvt_pk_bf16_f32 v111, v186, v187
    buffer_store_dwordx4 v[108:111], v232, s[8:11], s2 offen offset:2048 sc1
    v_cvt_pk_bf16_f32 v112, v188, v189
    v_cvt_pk_bf16_f32 v113, v190, v191
    v_cvt_pk_bf16_f32 v114, v192, v193
    v_cvt_pk_bf16_f32 v115, v194, v195
    buffer_store_dwordx4 v[112:115], v232, s[8:11], s2 offen offset:3072 sc1
    s_add_u32 s7, s7, 8
    s_cmp_lt_u32 s7, 16
    s_cbranch_scc1 colloop_67
    s_cmp_eq_u32 s3, 1008
    s_cbranch_scc1 colloop_67
    s_mov_b32 s83, 44
    s_branch next_45
p3_59:
    v_bfe_u32 v76, v1, 2, 2
    v_sub_u32 v76, 0, v76
    v_lshrrev_b32 v75, 4, v1
    v_xor_b32 v76, v76, v75
    v_and_b32 v76, 3, v76
    v_bfe_u32 v72, v1, 0, 4
    v_lshlrev_b32 v72, 6, v72
    v_lshl_or_b32 v72, v76, 4, v72
    s_lshr_b32 s74, s58, 2
    s_mul_i32 s74, s74, 4096
    v_add_u32 v72, s74, v72
    v_bfe_u32 v73, v1, 0, 2
    v_lshlrev_b32 v73, 3, v73
    v_bfe_u32 v75, v1, 4, 1
    v_lshl_or_b32 v73, v75, 5, v73
    v_bfe_u32 v75, v1, 2, 2
    v_lshl_or_b32 v73, v75, 6, v73
    v_bfe_u32 v75, v1, 2, 2
    v_lshl_or_b32 v73, v75, 8, v73
    v_bfe_u32 v75, v1, 4, 2
    v_lshl_or_b32 v73, v75, 11, v73
    s_and_b32 s74, s58, 3
    s_mul_i32 s74, s74, 64
    s_or_b32 s74, s74, 8192
    v_xor_b32 v73, s74, v73
    s_mov_b64 s[60:61], s[8:9]
    s_mov_b32 s62, 0x10000000
    s_mov_b32 s63, 0x20000
    s_mov_b64 s[64:65], s[8:9]
    s_mov_b32 s66, 0x10000000
    s_mov_b32 s67, 0x20000
    v_lshrrev_b32 v76, 4, v1
    v_sub_u32 v76, 0, v76
    v_xor_b32 v76, v76, v1
    v_and_b32 v76, 3, v76
    s_mul_i32 s74, s58, 16
    v_lshrrev_b32 v77, 2, v1
    v_add3_u32 v77, v77, s74, 0
    v_bfe_u32 v68, v77, 0, 2
    v_lshlrev_b32 v68, 11, v68
    v_bfe_u32 v75, v77, 4, 1
    v_lshl_or_b32 v68, v75, 13, v68
    v_bfe_u32 v75, v77, 2, 2
    v_lshl_or_b32 v68, v75, 14, v68
    v_bfe_u32 v75, v77, 5, 2
    v_lshl_or_b32 v68, v75, 16, v68
    v_lshl_add_u32 v68, v76, 4, v68
    s_and_b32 s74, s58, 2
    v_bfe_u32 v76, v1, 0, 4
    v_bfe_u32 v77, v1, 4, 2
    v_lshlrev_b32 v77, 2, v77
    v_xor_b32 v76, v76, v77
    v_xor_b32 v76, s74, v76
    v_lshlrev_b32 v77, 4, v76
    v_lshrrev_b32 v76, 4, v1
    v_lshl_add_u32 v70, v76, 12, v77
    s_lshl_b32 s74, s58, 14
    v_add_u32 v70, s74, v70
    s_mov_b32 s70, 131072
    s_and_b32 s79, s57, 7
    s_lshr_b32 s80, s76, 3
    s_lshl_b32 s68, s79, 18
    s_add_u32 s68, s68, 0x5200000
    s_lshl_b32 s69, s80, 8
    s_add_u32 s69, s69, 0x5800000
    s_cmp_lg_u32 s58, 0
    s_cbranch_scc1 wall_69
    v_mov_b32 v76, 64
wctr_70:
    buffer_load_dword v75, v76, s[12:15], 0 offen sc1
    s_waitcnt vmcnt(0)
    v_cmp_gt_u32 vcc, 18, v75
    s_cbranch_vccz wctr_ok_71
    s_sub_u32 s77, s77, 1
    s_cbranch_scc0 wctr_70
    s_mov_b32 s77, 0
wctr_ok_71:
wall_69:
    s_cmp_lg_u32 s58, 0
    s_cbranch_scc1 wall_72
    v_mov_b32 v76, 44
wctr_73:
    buffer_load_dword v75, v76, s[12:15], 0 offen sc1
    s_waitcnt vmcnt(0)
    v_cmp_gt_u32 vcc, 32, v75
    s_cbranch_vccz wctr_ok_74
    s_sub_u32 s77, s77, 1
    s_cbranch_scc0 wctr_73
    s_mov_b32 s77, 0
wctr_ok_74:
wall_72:
    s_barrier
    s_mul_i32 s71, s58, 1024
    s_mov_b32 m0, s71
    s_nop 0
    buffer_load_dwordx4 v68, s[60:63], s68 offen lds
    s_add_u32 m0, s71, 8192
    s_nop 0
    buffer_load_dwordx4 v70, s[64:67], s69 offen lds
    s_add_u32 s68, s68, 64
    s_add_u32 s69, s69, s70
    s_add_u32 s71, s71, 16384
    s_and_b32 s71, s71, 0x1ffff
    s_mov_b32 m0, s71
    s_nop 0
    buffer_load_dwordx4 v68, s[60:63], s68 offen lds
    s_add_u32 m0, s71, 8192
    s_nop 0
    buffer_load_dwordx4 v70, s[64:67], s69 offen lds
    s_add_u32 s68, s68, 64
    s_add_u32 s69, s69, s70
    s_add_u32 s71, s71, 16384
    s_and_b32 s71, s71, 0x1ffff
    s_mov_b32 m0, s71
    s_nop 0
    buffer_load_dwordx4 v68, s[60:63], s68 offen lds
    s_add_u32 m0, s71, 8192
    s_nop 0
    buffer_load_dwordx4 v70, s[64:67], s69 offen lds
    s_add_u32 s68, s68, 64
    s_add_u32 s69, s69, s70
    s_add_u32 s71, s71, 16384
    s_and_b32 s71, s71, 0x1ffff
    s_mov_b32 m0, s71
    s_nop 0
    buffer_load_dwordx4 v68, s[60:63], s68 offen lds
    s_add_u32 m0, s71, 8192
    s_nop 0
    buffer_load_dwordx4 v70, s[64:67], s69 offen lds
    s_add_u32 s68, s68, 64
    s_add_u32 s69, s69, s70
    s_add_u32 s71, s71, 16384
    s_and_b32 s71, s71, 0x1ffff
    s_mov_b32 m0, s71
    s_nop 0
    buffer_load_dwordx4 v68, s[60:63], s68 offen lds
    s_add_u32 m0, s71, 8192
    s_nop 0
    buffer_load_dwordx4 v70, s[64:67], s69 offen lds
    s_add_u32 s68, s68, 64
    s_add_u32 s69, s69, s70
    s_add_u32 s71, s71, 16384
    s_and_b32 s71, s71, 0x1ffff
    s_mov_b32 m0, s71
    s_nop 0
    buffer_load_dwordx4 v68, s[60:63], s68 offen lds
    s_add_u32 m0, s71, 8192
    s_nop 0
    buffer_load_dwordx4 v70, s[64:67], s69 offen lds
    s_add_u32 s68, s68, 64
    s_add_u32 s69, s69, s70
    s_add_u32 s71, s71, 16384
    s_and_b32 s71, s71, 0x1ffff
    s_mov_b32 m0, s71
    s_nop 0
    buffer_load_dwordx4 v68, s[60:63], s68 offen lds
    s_add_u32 m0, s71, 8192
    s_nop 0
    buffer_load_dwordx4 v70, s[64:67], s69 offen lds
    s_add_u32 s68, s68, 64
    s_add_u32 s69, s69, s70
    s_add_u32 s71, s71, 16384
    s_and_b32 s71, s71, 0x1ffff
    s_mov_b32 m0, s71
    s_nop 0
    buffer_load_dwordx4 v68, s[60:63], s68 offen lds
    s_add_u32 m0, s71, 8192
    s_nop 0
    buffer_load_dwordx4 v70, s[64:67], s69 offen lds
    s_add_u32 s68, s68, 64
    s_add_u32 s69, s69, s70
    s_add_u32 s71, s71, 16384
    s_and_b32 s71, s71, 0x1ffff
    v_lshlrev_b32 v75, 4, v1
    s_bfe_u32 s84, s57, 0x10000
    s_lshl_b32 s84, s84, 17
    s_bfe_u32 s74, s57, 0x40001
    s_lshl_b32 s74, s74, 19
    s_or_b32 s84, s84, s74
    s_lshl_b32 s74, s58, 14
    s_add_u32 s84, s84, s74
    s_add_u32 s84, s84, 0x6000000
    buffer_load_dwordx4 v[128:131], v75, s[8:11], s84 offen offset:0
    buffer_load_dwordx4 v[132:135], v75, s[8:11], s84 offen offset:1024
    buffer_load_dwordx4 v[136:139], v75, s[8:11], s84 offen offset:2048
    buffer_load_dwordx4 v[140:143], v75, s[8:11], s84 offen offset:3072
    s_add_u32 s84, s84, 4096
    buffer_load_dwordx4 v[144:147], v75, s[8:11], s84 offen offset:0
    buffer_load_dwordx4 v[148:151], v75, s[8:11], s84 offen offset:1024
    buffer_load_dwordx4 v[152:155], v75, s[8:11], s84 offen offset:2048
    buffer_load_dwordx4 v[156:159], v75, s[8:11], s84 offen offset:3072
    s_add_u32 s84, s84, 4096
    buffer_load_dwordx4 v[160:163], v75, s[8:11], s84 offen offset:0
    buffer_load_dwordx4 v[164:167], v75, s[8:11], s84 offen offset:1024
    buffer_load_dwordx4 v[168:171], v75, s[8:11], s84 offen offset:2048
    buffer_load_dwordx4 v[172:175], v75, s[8:11], s84 offen offset:3072
    s_add_u32 s84, s84, 4096
    buffer_load_dwordx4 v[176:179], v75, s[8:11], s84 offen offset:0
    buffer_load_dwordx4 v[180:183], v75, s[8:11], s84 offen offset:1024
    buffer_load_dwordx4 v[184:187], v75, s[8:11], s84 offen offset:2048
    buffer_load_dwordx4 v[188:191], v75, s[8:11], s84 offen offset:3072
    s_add_u32 s84, s84, 249856
    buffer_load_dwordx4 v[192:195], v75, s[8:11], s84 offen offset:0
    buffer_load_dwordx4 v[196:199], v75, s[8:11], s84 offen offset:1024
    buffer_load_dwordx4 v[200:203], v75, s[8:11], s84 offen offset:2048
    buffer_load_dwordx4 v[204:207], v75, s[8:11], s84 offen offset:3072
    s_add_u32 s84, s84, 4096
    buffer_load_dwordx4 v[208:211], v75, s[8:11], s84 offen offset:0
    buffer_load_dwordx4 v[212:215], v75, s[8:11], s84 offen offset:1024
    buffer_load_dwordx4 v[216:219], v75, s[8:11], s84 offen offset:2048
    buffer_load_dwordx4 v[220:223], v75, s[8:11], s84 offen offset:3072
    s_add_u32 s84, s84, 4096
    buffer_load_dwordx4 v[224:227], v75, s[8:11], s84 offen offset:0
    buffer_load_dwordx4 v[228:231], v75, s[8:11], s84 offen offset:1024
    buffer_load_dwordx4 v[232:235], v75, s[8:11], s84 offen offset:2048
    buffer_load_dwordx4 v[236:239], v75, s[8:11], s84 offen offset:3072
    s_add_u32 s84, s84, 4096
    buffer_load_dwordx4 v[240:243], v75, s[8:11], s84 offen offset:0
    buffer_load_dwordx4 v[244:247], v75, s[8:11], s84 offen offset:1024
    buffer_load_dwordx4 v[248:251], v75, s[8:11], s84 offen offset:2048
    buffer_load_dwordx4 v[252:255], v75, s[8:11], s84 offen offset:3072
    s_mov_b32 s72, 0
    s_waitcnt vmcnt(46)
    s_barrier
    v_add_u32 v74, s72, v72
    v_add_u32 v75, s72, v73
    v_xor_b32 v76, 32, v75
    s_add_u32 s72, s72, 16384
    s_and_b32 s72, s72, 0x1ffff
    ds_read_b128 v[4:7], v74 offset:0
    ds_read_b128 v[8:11], v74 offset:1024
    ds_read_b64_tr_b16 v[36:37], v75 offset:0
    ds_read_b64_tr_b16 v[38:39], v75 offset:1024
    ds_read_b64_tr_b16 v[40:41], v76 offset:0
    ds_read_b64_tr_b16 v[42:43], v76 offset:1024
    s_waitcnt lgkmcnt(0)
    v_mfma_f32_16x16x32_bf16 v[80:83], v[4:7], v[36:39], 0
    ds_read_b128 v[12:15], v74 offset:2048
    v_mfma_f32_16x16x32_bf16 v[84:87], v[4:7], v[40:43], 0
    ds_read_b128 v[16:19], v74 offset:3072
    v_mfma_f32_16x16x32_bf16 v[88:91], v[8:11], v[36:39], 0
    v_mfma_f32_16x16x32_bf16 v[92:95], v[8:11], v[40:43], 0
    s_waitcnt vmcnt(44) lgkmcnt(0)
    s_barrier
    v_mfma_f32_16x16x32_bf16 v[96:99], v[12:15], v[36:39], 0
    v_add_u32 v74, s72, v72
    v_add_u32 v75, s72, v73
    v_xor_b32 v76, 32, v75
    s_add_u32 s72, s72, 16384
    s_and_b32 s72, s72, 0x1ffff
    ds_read_b128 v[4:7], v74 offset:0
    v_mfma_f32_16x16x32_bf16 v[100:103], v[12:15], v[40:43], 0
    ds_read_b64_tr_b16 v[52:53], v75 offset:0
    ds_read_b64_tr_b16 v[54:55], v75 offset:1024
    ds_read_b64_tr_b16 v[56:57], v76 offset:0
    ds_read_b64_tr_b16 v[58:59], v76 offset:1024
    v_mfma_f32_16x16x32_bf16 v[104:107], v[16:19], v[36:39], 0
    ds_read_b128 v[8:11], v74 offset:1024
    s_mov_b32 m0, s71
    s_nop 0
    buffer_load_dwordx4 v68, s[60:63], s68 offen lds
    s_add_u32 m0, s71, 8192
    v_mfma_f32_16x16x32_bf16 v[108:111], v[16:19], v[40:43], 0
    buffer_load_dwordx4 v70, s[64:67], s69 offen lds
    s_add_u32 s68, s68, 64
    s_add_u32 s69, s69, s70
    s_add_u32 s71, s71, 16384
    s_and_b32 s71, s71, 0x1ffff
    s_waitcnt lgkmcnt(0)
    v_mfma_f32_16x16x32_bf16 v[80:83], v[4:7], v[52:55], v[80:83]
    ds_read_b128 v[12:15], v74 offset:2048
    v_mfma_f32_16x16x32_bf16 v[84:87], v[4:7], v[56:59], v[84:87]
    ds_read_b128 v[16:19], v74 offset:3072
    v_mfma_f32_16x16x32_bf16 v[88:91], v[8:11], v[52:55], v[88:91]
    v_mfma_f32_16x16x32_bf16 v[92:95], v[8:11], v[56:59], v[92:95]
    s_waitcnt vmcnt(44) lgkmcnt(0)
    s_barrier
    v_mfma_f32_16x16x32_bf16 v[96:99], v[12:15], v[52:55], v[96:99]
    v_add_u32 v74, s72, v72
    v_add_u32 v75, s72, v73
    v_xor_b32 v76, 32, v75
    s_add_u32 s72, s72, 16384
    s_and_b32 s72, s72, 0x1ffff
    ds_read_b128 v[4:7], v74 offset:0
    v_mfma_f32_16x16x32_bf16 v[100:103], v[12:15], v[56:59], v[100:103]
    ds_read_b64_tr_b16 v[36:37], v75 offset:0
    ds_read_b64_tr_b16 v[38:39], v75 offset:1024
    ds_read_b64_tr_b16 v[40:41], v76 offset:0
    ds_read_b64_tr_b16 v[42:43], v76 offset:1024
    v_mfma_f32_16x16x32_bf16 v[104:107], v[16:19], v[52:55], v[104:107]
    ds_read_b128 v[8:11], v74 offset:1024
    s_mov_b32 m0, s71
    s_nop 0
    buffer_load_dwordx4 v68, s[60:63], s68 offen lds
    s_add_u32 m0, s71, 8192
    v_mfma_f32_16x16x32_bf16 v[108:111], v[16:19], v[56:59], v[108:111]
    buffer_load_dwordx4 v70, s[64:67], s69 offen lds
    s_add_u32 s68, s68, 64
    s_add_u32 s69, s69, s70
    s_add_u32 s71, s71, 16384
    s_and_b32 s71, s71, 0x1ffff
    s_waitcnt lgkmcnt(0)
    v_mfma_f32_16x16x32_bf16 v[80:83], v[4:7], v[36:39], v[80:83]
    ds_read_b128 v[12:15], v74 offset:2048
    v_mfma_f32_16x16x32_bf16 v[84:87], v[4:7], v[40:43], v[84:87]
    ds_read_b128 v[16:19], v74 offset:3072
    v_mfma_f32_16x16x32_bf16 v[88:91], v[8:11], v[36:39], v[88:91]
    v_mfma_f32_16x16x32_bf16 v[92:95], v[8:11], v[40:43], v[92:95]
    s_waitcnt vmcnt(44) lgkmcnt(0)
    s_barrier
    v_mfma_f32_16x16x32_bf16 v[96:99], v[12:15], v[36:39], v[96:99]
    v_add_u32 v74, s72, v72
    v_add_u32 v75, s72, v73
    v_xor_b32 v76, 32, v75
    s_add_u32 s72, s72, 16384
    s_and_b32 s72, s72, 0x1ffff
    ds_read_b128 v[4:7], v74 offset:0
    v_mfma_f32_16x16x32_bf16 v[100:103], v[12:15], v[40:43], v[100:103]
    ds_read_b64_tr_b16 v[52:53], v75 offset:0
    ds_read_b64_tr_b16 v[54:55], v75 offset:1024
    ds_read_b64_tr_b16 v[56:57], v76 offset:0
    ds_read_b64_tr_b16 v[58:59], v76 offset:1024
    v_mfma_f32_16x16x32_bf16 v[104:107], v[16:19], v[36:39], v[104:107]
    ds_read_b128 v[8:11], v74 offset:1024
    s_mov_b32 m0, s71
    s_nop 0
    buffer_load_dwordx4 v68, s[60:63], s68 offen lds
    s_add_u32 m0, s71, 8192
    v_mfma_f32_16x16x32_bf16 v[108:111], v[16:19], v[40:43], v[108:111]
    buffer_load_dwordx4 v70, s[64:67], s69 offen lds
    s_add_u32 s68, s68, 64
    s_add_u32 s69, s69, s70
    s_add_u32 s71, s71, 16384
    s_and_b32 s71, s71, 0x1ffff
    s_waitcnt lgkmcnt(0)
    v_mfma_f32_16x16x32_bf16 v[80:83], v[4:7], v[52:55], v[80:83]
    ds_read_b128 v[12:15], v74 offset:2048
    v_mfma_f32_16x16x32_bf16 v[84:87], v[4:7], v[56:59], v[84:87]
    ds_read_b128 v[16:19], v74 offset:3072
    v_mfma_f32_16x16x32_bf16 v[88:91], v[8:11], v[52:55], v[88:91]
    v_mfma_f32_16x16x32_bf16 v[92:95], v[8:11], v[56:59], v[92:95]
    s_waitcnt vmcnt(44) lgkmcnt(0)
    s_barrier
    v_mfma_f32_16x16x32_bf16 v[96:99], v[12:15], v[52:55], v[96:99]
    v_add_u32 v74, s72, v72
    v_add_u32 v75, s72, v73
    v_xor_b32 v76, 32, v75
    s_add_u32 s72, s72, 16384
    s_and_b32 s72, s72, 0x1ffff
    ds_read_b128 v[4:7], v74 offset:0
    v_mfma_f32_16x16x32_bf16 v[100:103], v[12:15], v[56:59], v[100:103]
    ds_read_b64_tr_b16 v[36:37], v75 offset:0
    ds_read_b64_tr_b16 v[38:39], v75 offset:1024
    ds_read_b64_tr_b16 v[40:41], v76 offset:0
    ds_read_b64_tr_b16 v[42:43], v76 offset:1024
    v_mfma_f32_16x16x32_bf16 v[104:107], v[16:19], v[52:55], v[104:107]
    ds_read_b128 v[8:11], v74 offset:1024
    s_mov_b32 m0, s71
    s_nop 0
    buffer_load_dwordx4 v68, s[60:63], s68 offen lds
    s_add_u32 m0, s71, 8192
    v_mfma_f32_16x16x32_bf16 v[108:111], v[16:19], v[56:59], v[108:111]
    buffer_load_dwordx4 v70, s[64:67], s69 offen lds
    s_add_u32 s68, s68, 64
    s_add_u32 s69, s69, s70
    s_add_u32 s71, s71, 16384
    s_and_b32 s71, s71, 0x1ffff
    s_waitcnt lgkmcnt(0)
    v_mfma_f32_16x16x32_bf16 v[80:83], v[4:7], v[36:39], v[80:83]
    ds_read_b128 v[12:15], v74 offset:2048
    v_mfma_f32_16x16x32_bf16 v[84:87], v[4:7], v[40:43], v[84:87]
    ds_read_b128 v[16:19], v74 offset:3072
    v_mfma_f32_16x16x32_bf16 v[88:91], v[8:11], v[36:39], v[88:91]
    v_mfma_f32_16x16x32_bf16 v[92:95], v[8:11], v[40:43], v[92:95]
    s_waitcnt vmcnt(44) lgkmcnt(0)
    s_barrier
    v_mfma_f32_16x16x32_bf16 v[96:99], v[12:15], v[36:39], v[96:99]
    v_add_u32 v74, s72, v72
    v_add_u32 v75, s72, v73
    v_xor_b32 v76, 32, v75
    s_add_u32 s72, s72, 16384
    s_and_b32 s72, s72, 0x1ffff
    ds_read_b128 v[4:7], v74 offset:0
    v_mfma_f32_16x16x32_bf16 v[100:103], v[12:15], v[40:43], v[100:103]
    ds_read_b64_tr_b16 v[52:53], v75 offset:0
    ds_read_b64_tr_b16 v[54:55], v75 offset:1024
    ds_read_b64_tr_b16 v[56:57], v76 offset:0
    ds_read_b64_tr_b16 v[58:59], v76 offset:1024
    v_mfma_f32_16x16x32_bf16 v[104:107], v[16:19], v[36:39], v[104:107]
    ds_read_b128 v[8:11], v74 offset:1024
    s_mov_b32 m0, s71
    s_nop 0
    buffer_load_dwordx4 v68, s[60:63], s68 offen lds
    s_add_u32 m0, s71, 8192
    v_mfma_f32_16x16x32_bf16 v[108:111], v[16:19], v[40:43], v[108:111]
    buffer_load_dwordx4 v70, s[64:67], s69 offen lds
    s_add_u32 s68, s68, 64
    s_add_u32 s69, s69, s70
    s_add_u32 s71, s71, 16384
    s_and_b32 s71, s71, 0x1ffff
    s_waitcnt lgkmcnt(0)
    v_mfma_f32_16x16x32_bf16 v[80:83], v[4:7], v[52:55], v[80:83]
    ds_read_b128 v[12:15], v74 offset:2048
    v_mfma_f32_16x16x32_bf16 v[84:87], v[4:7], v[56:59], v[84:87]
    ds_read_b128 v[16:19], v74 offset:3072
    v_mfma_f32_16x16x32_bf16 v[88:91], v[8:11], v[52:55], v[88:91]
    v_mfma_f32_16x16x32_bf16 v[92:95], v[8:11], v[56:59], v[92:95]
    s_waitcnt vmcnt(44) lgkmcnt(0)
    s_barrier
    v_mfma_f32_16x16x32_bf16 v[96:99], v[12:15], v[52:55], v[96:99]
    v_add_u32 v74, s72, v72
    v_add_u32 v75, s72, v73
    v_xor_b32 v76, 32, v75
    s_add_u32 s72, s72, 16384
    s_and_b32 s72, s72, 0x1ffff
    ds_read_b128 v[4:7], v74 offset:0
    v_mfma_f32_16x16x32_bf16 v[100:103], v[12:15], v[56:59], v[100:103]
    ds_read_b64_tr_b16 v[36:37], v75 offset:0
    ds_read_b64_tr_b16 v[38:39], v75 offset:1024
    ds_read_b64_tr_b16 v[40:41], v76 offset:0
    ds_read_b64_tr_b16 v[42:43], v76 offset:1024
    v_mfma_f32_16x16x32_bf16 v[104:107], v[16:19], v[52:55], v[104:107]
    ds_read_b128 v[8:11], v74 offset:1024
    s_mov_b32 m0, s71
    s_nop 0
    buffer_load_dwordx4 v68, s[60:63], s68 offen lds
    s_add_u32 m0, s71, 8192
    v_mfma_f32_16x16x32_bf16 v[108:111], v[16:19], v[56:59], v[108:111]
    buffer_load_dwordx4 v70, s[64:67], s69 offen lds
    s_add_u32 s68, s68, 64
    s_add_u32 s69, s69, s70
    s_add_u32 s71, s71, 16384
    s_and_b32 s71, s71, 0x1ffff
    s_waitcnt lgkmcnt(0)
    v_mfma_f32_16x16x32_bf16 v[80:83], v[4:7], v[36:39], v[80:83]
    ds_read_b128 v[12:15], v74 offset:2048
    v_mfma_f32_16x16x32_bf16 v[84:87], v[4:7], v[40:43], v[84:87]
    ds_read_b128 v[16:19], v74 offset:3072
    v_mfma_f32_16x16x32_bf16 v[88:91], v[8:11], v[36:39], v[88:91]
    v_mfma_f32_16x16x32_bf16 v[92:95], v[8:11], v[40:43], v[92:95]
    s_waitcnt vmcnt(44) lgkmcnt(0)
    s_barrier
    v_mfma_f32_16x16x32_bf16 v[96:99], v[12:15], v[36:39], v[96:99]
    v_add_u32 v74, s72, v72
    v_add_u32 v75, s72, v73
    v_xor_b32 v76, 32, v75
    s_add_u32 s72, s72, 16384
    s_and_b32 s72, s72, 0x1ffff
    ds_read_b128 v[4:7], v74 offset:0
    v_mfma_f32_16x16x32_bf16 v[100:103], v[12:15], v[40:43], v[100:103]
    ds_read_b64_tr_b16 v[52:53], v75 offset:0
    ds_read_b64_tr_b16 v[54:55], v75 offset:1024
    ds_read_b64_tr_b16 v[56:57], v76 offset:0
    ds_read_b64_tr_b16 v[58:59], v76 offset:1024
    v_mfma_f32_16x16x32_bf16 v[104:107], v[16:19], v[36:39], v[104:107]
    ds_read_b128 v[8:11], v74 offset:1024
    s_mov_b32 m0, s71
    s_nop 0
    buffer_load_dwordx4 v68, s[60:63], s68 offen lds
    s_add_u32 m0, s71, 8192
    v_mfma_f32_16x16x32_bf16 v[108:111], v[16:19], v[40:43], v[108:111]
    buffer_load_dwordx4 v70, s[64:67], s69 offen lds
    s_add_u32 s68, s68, 64
    s_add_u32 s69, s69, s70
    s_add_u32 s71, s71, 16384
    s_and_b32 s71, s71, 0x1ffff
    s_waitcnt lgkmcnt(0)
    v_mfma_f32_16x16x32_bf16 v[80:83], v[4:7], v[52:55], v[80:83]
    ds_read_b128 v[12:15], v74 offset:2048
    v_mfma_f32_16x16x32_bf16 v[84:87], v[4:7], v[56:59], v[84:87]
    ds_read_b128 v[16:19], v74 offset:3072
    v_mfma_f32_16x16x32_bf16 v[88:91], v[8:11], v[52:55], v[88:91]
    v_mfma_f32_16x16x32_bf16 v[92:95], v[8:11], v[56:59], v[92:95]
    s_waitcnt vmcnt(12) lgkmcnt(0)
    s_barrier
    v_mfma_f32_16x16x32_bf16 v[96:99], v[12:15], v[52:55], v[96:99]
    v_add_u32 v74, s72, v72
    v_add_u32 v75, s72, v73
    v_xor_b32 v76, 32, v75
    s_add_u32 s72, s72, 16384
    s_and_b32 s72, s72, 0x1ffff
    ds_read_b128 v[4:7], v74 offset:0
    v_mfma_f32_16x16x32_bf16 v[100:103], v[12:15], v[56:59], v[100:103]
    ds_read_b64_tr_b16 v[36:37], v75 offset:0
    ds_read_b64_tr_b16 v[38:39], v75 offset:1024
    ds_read_b64_tr_b16 v[40:41], v76 offset:0
    ds_read_b64_tr_b16 v[42:43], v76 offset:1024
    v_mfma_f32_16x16x32_bf16 v[104:107], v[16:19], v[52:55], v[104:107]
    ds_read_b128 v[8:11], v74 offset:1024
    s_mov_b32 m0, s71
    s_nop 0
    buffer_load_dwordx4 v68, s[60:63], s68 offen lds
    s_add_u32 m0, s71, 8192
    v_mfma_f32_16x16x32_bf16 v[108:111], v[16:19], v[56:59], v[108:111]
    buffer_load_dwordx4 v70, s[64:67], s69 offen lds
    s_add_u32 s68, s68, 64
    s_add_u32 s69, s69, s70
    s_add_u32 s71, s71, 16384
    s_and_b32 s71, s71, 0x1ffff
    s_mov_b32 s73, 8
gl_75:
    s_waitcnt lgkmcnt(0)
    v_mfma_f32_16x16x32_bf16 v[80:83], v[4:7], v[36:39], v[80:83]
    ds_read_b128 v[12:15], v74 offset:2048
    v_mfma_f32_16x16x32_bf16 v[84:87], v[4:7], v[40:43], v[84:87]
    ds_read_b128 v[16:19], v74 offset:3072
    v_mfma_f32_16x16x32_bf16 v[88:91], v[8:11], v[36:39], v[88:91]
    v_mfma_f32_16x16x32_bf16 v[92:95], v[8:11], v[40:43], v[92:95]
    s_waitcnt vmcnt(12) lgkmcnt(0)
    s_barrier
    v_mfma_f32_16x16x32_bf16 v[96:99], v[12:15], v[36:39], v[96:99]
    v_add_u32 v74, s72, v72
    v_add_u32 v75, s72, v73
    v_xor_b32 v76, 32, v75
    s_add_u32 s72, s72, 16384
    s_and_b32 s72, s72, 0x1ffff
    ds_read_b128 v[4:7], v74 offset:0
    v_mfma_f32_16x16x32_bf16 v[100:103], v[12:15], v[40:43], v[100:103]
    ds_read_b64_tr_b16 v[52:53], v75 offset:0
    ds_read_b64_tr_b16 v[54:55], v75 offset:1024
    ds_read_b64_tr_b16 v[56:57], v76 offset:0
    ds_read_b64_tr_b16 v[58:59], v76 offset:1024
    v_mfma_f32_16x16x32_bf16 v[104:107], v[16:19], v[36:39], v[104:107]
    ds_read_b128 v[8:11], v74 offset:1024
    s_mov_b32 m0, s71
    s_nop 0
    buffer_load_dwordx4 v68, s[60:63], s68 offen lds
    s_add_u32 m0, s71, 8192
    v_mfma_f32_16x16x32_bf16 v[108:111], v[16:19], v[40:43], v[108:111]
    buffer_load_dwordx4 v70, s[64:67], s69 offen lds
    s_add_u32 s68, s68, 64
    s_add_u32 s69, s69, s70
    s_add_u32 s71, s71, 16384
    s_and_b32 s71, s71, 0x1ffff
    s_waitcnt lgkmcnt(0)
    v_mfma_f32_16x16x32_bf16 v[80:83], v[4:7], v[52:55], v[80:83]
    ds_read_b128 v[12:15], v74 offset:2048
    v_mfma_f32_16x16x32_bf16 v[84:87], v[4:7], v[56:59], v[84:87]
    ds_read_b128 v[16:19], v74 offset:3072
    v_mfma_f32_16x16x32_bf16 v[88:91], v[8:11], v[52:55], v[88:91]
    v_mfma_f32_16x16x32_bf16 v[92:95], v[8:11], v[56:59], v[92:95]
    s_waitcnt vmcnt(12) lgkmcnt(0)
    s_barrier
    v_mfma_f32_16x16x32_bf16 v[96:99], v[12:15], v[52:55], v[96:99]
    v_add_u32 v74, s72, v72
    v_add_u32 v75, s72, v73
    v_xor_b32 v76, 32, v75
    s_add_u32 s72, s72, 16384
    s_and_b32 s72, s72, 0x1ffff
    ds_read_b128 v[4:7], v74 offset:0
    v_mfma_f32_16x16x32_bf16 v[100:103], v[12:15], v[56:59], v[100:103]
    ds_read_b64_tr_b16 v[36:37], v75 offset:0
    ds_read_b64_tr_b16 v[38:39], v75 offset:1024
    ds_read_b64_tr_b16 v[40:41], v76 offset:0
    ds_read_b64_tr_b16 v[42:43], v76 offset:1024
    v_mfma_f32_16x16x32_bf16 v[104:107], v[16:19], v[52:55], v[104:107]
    ds_read_b128 v[8:11], v74 offset:1024
    s_mov_b32 m0, s71
    s_nop 0
    buffer_load_dwordx4 v68, s[60:63], s68 offen lds
    s_add_u32 m0, s71, 8192
    v_mfma_f32_16x16x32_bf16 v[108:111], v[16:19], v[56:59], v[108:111]
    buffer_load_dwordx4 v70, s[64:67], s69 offen lds
    s_add_u32 s68, s68, 64
    s_add_u32 s69, s69, s70
    s_add_u32 s71, s71, 16384
    s_and_b32 s71, s71, 0x1ffff
    s_sub_u32 s73, s73, 1
    s_cmp_lg_u32 s73, 0
    s_cbranch_scc1 gl_75
    s_waitcnt lgkmcnt(0)
    v_mfma_f32_16x16x32_bf16 v[80:83], v[4:7], v[36:39], v[80:83]
    ds_read_b128 v[12:15], v74 offset:2048
    v_mfma_f32_16x16x32_bf16 v[84:87], v[4:7], v[40:43], v[84:87]
    ds_read_b128 v[16:19], v74 offset:3072
    v_mfma_f32_16x16x32_bf16 v[88:91], v[8:11], v[36:39], v[88:91]
    v_mfma_f32_16x16x32_bf16 v[92:95], v[8:11], v[40:43], v[92:95]
    s_waitcnt vmcnt(12) lgkmcnt(0)
    s_barrier
    v_mfma_f32_16x16x32_bf16 v[96:99], v[12:15], v[36:39], v[96:99]
    v_add_u32 v74, s72, v72
    v_add_u32 v75, s72, v73
    v_xor_b32 v76, 32, v75
    s_add_u32 s72, s72, 16384
    s_and_b32 s72, s72, 0x1ffff
    v_mfma_f32_16x16x32_bf16 v[100:103], v[12:15], v[40:43], v[100:103]
    ds_read_b128 v[4:7], v74 offset:0
    ds_read_b64_tr_b16 v[52:53], v75 offset:0
    v_mfma_f32_16x16x32_bf16 v[104:107], v[16:19], v[36:39], v[104:107]
    ds_read_b64_tr_b16 v[54:55], v75 offset:1024
    ds_read_b64_tr_b16 v[56:57], v76 offset:0
    v_mfma_f32_16x16x32_bf16 v[108:111], v[16:19], v[40:43], v[108:111]
    ds_read_b64_tr_b16 v[58:59], v76 offset:1024
    ds_read_b128 v[8:11], v74 offset:1024
    s_waitcnt lgkmcnt(0)
    v_mfma_f32_16x16x32_bf16 v[80:83], v[4:7], v[52:55], v[80:83]
    ds_read_b128 v[12:15], v74 offset:2048
    v_mfma_f32_16x16x32_bf16 v[84:87], v[4:7], v[56:59], v[84:87]
    ds_read_b128 v[16:19], v74 offset:3072
    v_mfma_f32_16x16x32_bf16 v[88:91], v[8:11], v[52:55], v[88:91]
    v_mfma_f32_16x16x32_bf16 v[92:95], v[8:11], v[56:59], v[92:95]
    s_waitcnt vmcnt(10) lgkmcnt(0)
    s_barrier
    v_mfma_f32_16x16x32_bf16 v[96:99], v[12:15], v[52:55], v[96:99]
    v_add_u32 v74, s72, v72
    v_add_u32 v75, s72, v73
    v_xor_b32 v76, 32, v75
    s_add_u32 s72, s72, 16384
    s_and_b32 s72, s72, 0x1ffff
    v_mfma_f32_16x16x32_bf16 v[100:103], v[12:15], v[56:59], v[100:103]
    ds_read_b128 v[4:7], v74 offset:0
    ds_read_b64_tr_b16 v[36:37], v75 offset:0
    v_mfma_f32_16x16x32_bf16 v[104:107], v[16:19], v[52:55], v[104:107]
    ds_read_b64_tr_b16 v[38:39], v75 offset:1024
    ds_read_b64_tr_b16 v[40:41], v76 offset:0
    v_mfma_f32_16x16x32_bf16 v[108:111], v[16:19], v[56:59], v[108:111]
    ds_read_b64_tr_b16 v[42:43], v76 offset:1024
    ds_read_b128 v[8:11], v74 offset:1024
    s_waitcnt lgkmcnt(0)
    v_mfma_f32_16x16x32_bf16 v[80:83], v[4:7], v[36:39], v[80:83]
    ds_read_b128 v[12:15], v74 offset:2048
    v_mfma_f32_16x16x32_bf16 v[84:87], v[4:7], v[40:43], v[84:87]
    ds_read_b128 v[16:19], v74 offset:3072
    v_mfma_f32_16x16x32_bf16 v[88:91], v[8:11], v[36:39], v[88:91]
    v_mfma_f32_16x16x32_bf16 v[92:95], v[8:11], v[40:43], v[92:95]
    s_waitcnt vmcnt(8) lgkmcnt(0)
    s_barrier
    v_mfma_f32_16x16x32_bf16 v[96:99], v[12:15], v[36:39], v[96:99]
    v_add_u32 v74, s72, v72
    v_add_u32 v75, s72, v73
    v_xor_b32 v76, 32, v75
    s_add_u32 s72, s72, 16384
    s_and_b32 s72, s72, 0x1ffff
    v_mfma_f32_16x16x32_bf16 v[100:103], v[12:15], v[40:43], v[100:103]
    ds_read_b128 v[4:7], v74 offset:0
    ds_read_b64_tr_b16 v[52:53], v75 offset:0
    v_mfma_f32_16x16x32_bf16 v[104:107], v[16:19], v[36:39], v[104:107]
    ds_read_b64_tr_b16 v[54:55], v75 offset:1024
    ds_read_b64_tr_b16 v[56:57], v76 offset:0
    v_mfma_f32_16x16x32_bf16 v[108:111], v[16:19], v[40:43], v[108:111]
    ds_read_b64_tr_b16 v[58:59], v76 offset:1024
    ds_read_b128 v[8:11], v74 offset:1024
    s_waitcnt lgkmcnt(0)
    v_mfma_f32_16x16x32_bf16 v[80:83], v[4:7], v[52:55], v[80:83]
    ds_read_b128 v[12:15], v74 offset:2048
    v_mfma_f32_16x16x32_bf16 v[84:87], v[4:7], v[56:59], v[84:87]
    ds_read_b128 v[16:19], v74 offset:3072
    v_mfma_f32_16x16x32_bf16 v[88:91], v[8:11], v[52:55], v[88:91]
    v_mfma_f32_16x16x32_bf16 v[92:95], v[8:11], v[56:59], v[92:95]
    s_waitcnt vmcnt(6) lgkmcnt(0)
    s_barrier
    v_mfma_f32_16x16x32_bf16 v[96:99], v[12:15], v[52:55], v[96:99]
    v_add_u32 v74, s72, v72
    v_add_u32 v75, s72, v73
    v_xor_b32 v76, 32, v75
    s_add_u32 s72, s72, 16384
    s_and_b32 s72, s72, 0x1ffff
    v_mfma_f32_16x16x32_bf16 v[100:103], v[12:15], v[56:59], v[100:103]
    ds_read_b128 v[4:7], v74 offset:0
    ds_read_b64_tr_b16 v[36:37], v75 offset:0
    v_mfma_f32_16x16x32_bf16 v[104:107], v[16:19], v[52:55], v[104:107]
    ds_read_b64_tr_b16 v[38:39], v75 offset:1024
    ds_read_b64_tr_b16 v[40:41], v76 offset:0
    v_mfma_f32_16x16x32_bf16 v[108:111], v[16:19], v[56:59], v[108:111]
    ds_read_b64_tr_b16 v[42:43], v76 offset:1024
    ds_read_b128 v[8:11], v74 offset:1024
    s_waitcnt lgkmcnt(0)
    v_mfma_f32_16x16x32_bf16 v[80:83], v[4:7], v[36:39], v[80:83]
    ds_read_b128 v[12:15], v74 offset:2048
    v_mfma_f32_16x16x32_bf16 v[84:87], v[4:7], v[40:43], v[84:87]
    ds_read_b128 v[16:19], v74 offset:3072
    v_mfma_f32_16x16x32_bf16 v[88:91], v[8:11], v[36:39], v[88:91]
    v_mfma_f32_16x16x32_bf16 v[92:95], v[8:11], v[40:43], v[92:95]
    s_waitcnt vmcnt(4) lgkmcnt(0)
    s_barrier
    v_mfma_f32_16x16x32_bf16 v[96:99], v[12:15], v[36:39], v[96:99]
    v_add_u32 v74, s72, v72
    v_add_u32 v75, s72, v73
    v_xor_b32 v76, 32, v75
    s_add_u32 s72, s72, 16384
    s_and_b32 s72, s72, 0x1ffff
    v_mfma_f32_16x16x32_bf16 v[100:103], v[12:15], v[40:43], v[100:103]
    ds_read_b128 v[4:7], v74 offset:0
    ds_read_b64_tr_b16 v[52:53], v75 offset:0
    v_mfma_f32_16x16x32_bf16 v[104:107], v[16:19], v[36:39], v[104:107]
    ds_read_b64_tr_b16 v[54:55], v75 offset:1024
    ds_read_b64_tr_b16 v[56:57], v76 offset:0
    v_mfma_f32_16x16x32_bf16 v[108:111], v[16:19], v[40:43], v[108:111]
    ds_read_b64_tr_b16 v[58:59], v76 offset:1024
    ds_read_b128 v[8:11], v74 offset:1024
    s_waitcnt lgkmcnt(0)
    v_mfma_f32_16x16x32_bf16 v[80:83], v[4:7], v[52:55], v[80:83]
    ds_read_b128 v[12:15], v74 offset:2048
    v_mfma_f32_16x16x32_bf16 v[84:87], v[4:7], v[56:59], v[84:87]
    ds_read_b128 v[16:19], v74 offset:3072
    v_mfma_f32_16x16x32_bf16 v[88:91], v[8:11], v[52:55], v[88:91]
    v_mfma_f32_16x16x32_bf16 v[92:95], v[8:11], v[56:59], v[92:95]
    s_waitcnt vmcnt(2) lgkmcnt(0)
    s_barrier
    v_mfma_f32_16x16x32_bf16 v[96:99], v[12:15], v[52:55], v[96:99]
    v_add_u32 v74, s72, v72
    v_add_u32 v75, s72, v73
    v_xor_b32 v76, 32, v75
    s_add_u32 s72, s72, 16384
    s_and_b32 s72, s72, 0x1ffff
    v_mfma_f32_16x16x32_bf16 v[100:103], v[12:15], v[56:59], v[100:103]
    ds_read_b128 v[4:7], v74 offset:0
    ds_read_b64_tr_b16 v[36:37], v75 offset:0
    v_mfma_f32_16x16x32_bf16 v[104:107], v[16:19], v[52:55], v[104:107]
    ds_read_b64_tr_b16 v[38:39], v75 offset:1024
    ds_read_b64_tr_b16 v[40:41], v76 offset:0
    v_mfma_f32_16x16x32_bf16 v[108:111], v[16:19], v[56:59], v[108:111]
    ds_read_b64_tr_b16 v[42:43], v76 offset:1024
    ds_read_b128 v[8:11], v74 offset:1024
    s_waitcnt lgkmcnt(0)
    v_mfma_f32_16x16x32_bf16 v[80:83], v[4:7], v[36:39], v[80:83]
    ds_read_b128 v[12:15], v74 offset:2048
    v_mfma_f32_16x16x32_bf16 v[84:87], v[4:7], v[40:43], v[84:87]
    ds_read_b128 v[16:19], v74 offset:3072
    v_mfma_f32_16x16x32_bf16 v[88:91], v[8:11], v[36:39], v[88:91]
    v_mfma_f32_16x16x32_bf16 v[92:95], v[8:11], v[40:43], v[92:95]
    s_waitcnt vmcnt(0) lgkmcnt(0)
    s_barrier
    v_mfma_f32_16x16x32_bf16 v[96:99], v[12:15], v[36:39], v[96:99]
    v_add_u32 v74, s72, v72
    v_add_u32 v75, s72, v73
    v_xor_b32 v76, 32, v75
    s_add_u32 s72, s72, 16384
    s_and_b32 s72, s72, 0x1ffff
    v_mfma_f32_16x16x32_bf16 v[100:103], v[12:15], v[40:43], v[100:103]
    ds_read_b128 v[4:7], v74 offset:0
    ds_read_b64_tr_b16 v[52:53], v75 offset:0
    v_mfma_f32_16x16x32_bf16 v[104:107], v[16:19], v[36:39], v[104:107]
    ds_read_b64_tr_b16 v[54:55], v75 offset:1024
    ds_read_b64_tr_b16 v[56:57], v76 offset:0
    v_mfma_f32_16x16x32_bf16 v[108:111], v[16:19], v[40:43], v[108:111]
    ds_read_b64_tr_b16 v[58:59], v76 offset:1024
    ds_read_b128 v[8:11], v74 offset:1024
    s_waitcnt lgkmcnt(0)
    v_mfma_f32_16x16x32_bf16 v[80:83], v[4:7], v[52:55], v[80:83]
    ds_read_b128 v[12:15], v74 offset:2048
    v_mfma_f32_16x16x32_bf16 v[84:87], v[4:7], v[56:59], v[84:87]
    ds_read_b128 v[16:19], v74 offset:3072
    v_mfma_f32_16x16x32_bf16 v[88:91], v[8:11], v[52:55], v[88:91]
    v_mfma_f32_16x16x32_bf16 v[92:95], v[8:11], v[56:59], v[92:95]
    s_waitcnt lgkmcnt(0)
    v_mfma_f32_16x16x32_bf16 v[96:99], v[12:15], v[52:55], v[96:99]
    v_mfma_f32_16x16x32_bf16 v[100:103], v[12:15], v[56:59], v[100:103]
    v_mfma_f32_16x16x32_bf16 v[104:107], v[16:19], v[52:55], v[104:107]
    v_mfma_f32_16x16x32_bf16 v[108:111], v[16:19], v[56:59], v[108:111]
    s_lshl_b32 s84, s80, 2
    s_and_b32 s81, s58, 3
    s_add_u32 s84, s84, s81
    s_lshl_b32 s84, s84, 5
    v_and_b32 v77, 15, v1
    v_add_u32 v77, s84, v77
    v_bfe_u32 v76, v77, 3, 5
    v_lshlrev_b32 v76, 12, v76
    v_bfe_u32 v75, v77, 10, 1
    v_lshl_or_b32 v76, v75, 17, v76
    v_bfe_u32 v75, v77, 0, 2
    v_lshl_or_b32 v76, v75, 18, v76
    v_bfe_u32 v75, v77, 8, 1
    v_lshl_or_b32 v76, v75, 20, v76
    v_bfe_u32 v75, v77, 2, 1
    v_lshl_or_b32 v76, v75, 21, v76
    v_bfe_u32 v75, v77, 9, 1
    v_lshl_or_b32 v76, v75, 22, v76
    v_bfe_u32 v77, v1, 4, 2
    v_lshlrev_b32 v77, 4, v77
    v_add_u32 v76, v76, v77
    s_lshl_b32 s81, s79, 8
    s_lshr_b32 s84, s58, 2
    s_lshl_b32 s84, s84, 7
    s_add_u32 s81, s81, s84
    v_cvt_pk_bf16_f32 v4, v80, v81
    v_cvt_pk_bf16_f32 v5, v82, v83
    v_cvt_pk_bf16_f32 v6, v88, v89
    v_cvt_pk_bf16_f32 v7, v90, v91
    buffer_store_dwordx4 v[4:7], v76, s[16:19], s81 offen offset:0
    v_cvt_pk_bf16_f32 v8, v96, v97
    v_cvt_pk_bf16_f32 v9, v98, v99
    v_cvt_pk_bf16_f32 v10, v104, v105
    v_cvt_pk_bf16_f32 v11, v106, v107
    buffer_store_dwordx4 v[8:11], v76, s[16:19], s81 offen offset:64
    s_add_u32 s81, s81, 8192
    v_cvt_pk_bf16_f32 v12, v84, v85
    v_cvt_pk_bf16_f32 v13, v86, v87
    v_cvt_pk_bf16_f32 v14, v92, v93
    v_cvt_pk_bf16_f32 v15, v94, v95
    buffer_store_dwordx4 v[12:15], v76, s[16:19], s81 offen offset:0
    v_cvt_pk_bf16_f32 v16, v100, v101
    v_cvt_pk_bf16_f32 v17, v102, v103
    v_cvt_pk_bf16_f32 v18, v108, v109
    v_cvt_pk_bf16_f32 v19, v110, v111
    buffer_store_dwordx4 v[16:19], v76, s[16:19], s81 offen offset:64
    s_add_u32 s81, s81, 8192
    s_cmp_lg_u32 s58, 0
    s_cbranch_scc1 wall_76
    v_mov_b32 v76, 48
wctr_77:
    buffer_load_dword v75, v76, s[12:15], 0 offen sc1
    s_waitcnt vmcnt(0)
    v_cmp_gt_u32 vcc, 128, v75
    s_cbranch_vccz wctr_ok_78
    s_sub_u32 s77, s77, 1
    s_cbranch_scc0 wctr_77
    s_mov_b32 s77, 0
wctr_ok_78:
wall_76:
    s_barrier
    v_lshlrev_b32 v8, 4, v1
    v_bfe_u32 v9, v1, 0, 3
    v_lshlrev_b32 v9, 4, v9
    v_bfe_u32 v3, v1, 5, 1
    v_lshl_or_b32 v9, v3, 7, v9
    v_lshlrev_b32 v10, 3, v1
    s_and_b32 s93, s57, 1
    s_lshl_b32 s93, s93, 3
    s_add_u32 s93, s93, s58
    s_lshl_b32 s87, s93, 3
    v_mov_b32 v11, s87
    s_lshl_b32 s93, s93, 14
    s_add_u32 s93, s93, 0x3000000
    s_mul_i32 s87, s58, 8448
    v_bfe_u32 v2, v1, 5, 1
    v_lshlrev_b32 v2, 4, v2
    v_add3_u32 v12, s87, v8, v2
    v_bfe_u32 v2, v1, 1, 4
    v_mul_u32_u24 v2, 528, v2
    v_bfe_u32 v13, v1, 0, 1
    v_lshlrev_b32 v13, 3, v13
    v_bfe_u32 v3, v1, 5, 1
    v_lshl_or_b32 v13, v3, 4, v13
    s_lshl_b32 s87, s58, 6
    v_add3_u32 v13, s87, v13, v2
    v_bfe_u32 v14, v1, 0, 5
    v_lshlrev_b32 v14, 2, v14
    v_bfe_u32 v3, v1, 5, 1
    v_lshl_or_b32 v14, v3, 12, v14
    s_lshl_b32 s87, s58, 14
    s_bfe_u32 s88, s57, 0x40001
    s_lshl_b32 s88, s88, 7
    s_add_u32 s87, s87, s88
    s_add_u32 s87, s87, 2048
    v_add_u32 v14, s87, v14
    v_bfe_u32 v2, v1, 5, 1
    v_lshlrev_b32 v2, 2, v2
    v_and_b32 v15, 31, v1
    v_sub_u32 v15, v15, v2
    s_mov_b32 s89, 0x3e0293ee
    s_mov_b32 s85, 0
    s_mov_b32 s86, s58
    s_mov_b32 s92, 0
    buffer_load_dword v3, off, s[12:15], 0 offset:64 sc1
    s_waitcnt vmcnt(0)
    v_readfirstlane_b32 s91, v3
aw_loop_79:
    s_cmp_lg_u32 s92, 0
    s_cbranch_scc1 aw_stream_82
    s_lshl_b32 s87, s86, 2
    s_add_u32 s87, s87, s75
    s_cmp_ge_u32 s86, 14
    s_cselect_b32 s88, 1, 3
    s_add_u32 s88, s88, s87
    s_cmp_ge_u32 s91, s88
    s_cbranch_scc1 aw_att_81
    s_cmp_lg_u32 s86, s85
    s_cbranch_scc1 aw_wo_80
    s_lshl_b32 s87, s86, 2
    s_add_u32 s87, s87, s75
    s_cmp_ge_u32 s86, 14
    s_cselect_b32 s88, -1, 3
    s_add_u32 s88, s88, s87
pollprog_83:
    buffer_load_dword v3, off, s[12:15], 0 offset:64 sc1
    s_waitcnt vmcnt(0)
    v_cmp_gt_u32 vcc, s88, v3
    s_cbranch_vccz pollprog_ok_84
    s_sub_u32 s77, s77, 1
    s_cbranch_scc0 pollprog_83
    s_mov_b32 s77, 0
pollprog_ok_84:
aw_att_81:
    s_lshl_b32 s87, s87, 5
    s_add_u32 s87, s87, s57
    s_lshl_b32 s88, s87, 11
    s_add_u32 s88, s88, 0x4000000
    s_lshl_b32 s90, s87, 13
    buffer_load_dwordx4 v[96:99], v9, s[8:11], s88 offen offset:0 sc1
    buffer_load_dwordx4 v[100:103], v9, s[8:11], s88 offen offset:256 sc1
    buffer_load_dwordx4 v[104:107], v9, s[8:11], s88 offen offset:512 sc1
    buffer_load_dwordx4 v[108:111], v9, s[8:11], s88 offen offset:768 sc1
    buffer_load_dwordx4 v[112:115], v9, s[8:11], s88 offen offset:1024 sc1
    buffer_load_dwordx4 v[116:119], v9, s[8:11], s88 offen offset:1280 sc1
    buffer_load_dwordx4 v[120:123], v9, s[8:11], s88 offen offset:1536 sc1
    buffer_load_dwordx4 v[124:127], v9, s[8:11], s88 offen offset:1792 sc1
    s_add_u32 s87, s90, 0x0
    buffer_load_dwordx4 v[32:35], v8, s[8:11], s87 offen offset:0 sc1
    buffer_load_dwordx4 v[36:39], v8, s[8:11], s87 offen offset:1024 sc1
    buffer_load_dwordx4 v[40:43], v8, s[8:11], s87 offen offset:2048 sc1
    buffer_load_dwordx4 v[44:47], v8, s[8:11], s87 offen offset:3072 sc1
    s_add_u32 s87, s87, 4096
    buffer_load_dwordx4 v[48:51], v8, s[8:11], s87 offen offset:0 sc1
    buffer_load_dwordx4 v[52:55], v8, s[8:11], s87 offen offset:1024 sc1
    buffer_load_dwordx4 v[56:59], v8, s[8:11], s87 offen offset:2048 sc1
    buffer_load_dwordx4 v[60:63], v8, s[8:11], s87 offen offset:3072 sc1
    s_add_u32 s87, s90, 0x1000000
    buffer_load_dwordx4 v[64:67], v8, s[8:11], s87 offen offset:0 sc1
    buffer_load_dwordx4 v[68:71], v8, s[8:11], s87 offen offset:1024 sc1
    buffer_load_dwordx4 v[72:75], v8, s[8:11], s87 offen offset:2048 sc1
    buffer_load_dwordx4 v[76:79], v8, s[8:11], s87 offen offset:3072 sc1
    s_add_u32 s87, s87, 4096
    buffer_load_dwordx4 v[80:83], v8, s[8:11], s87 offen offset:0 sc1
    buffer_load_dwordx4 v[84:87], v8, s[8:11], s87 offen offset:1024 sc1
    buffer_load_dwordx4 v[88:91], v8, s[8:11], s87 offen offset:2048 sc1
    buffer_load_dwordx4 v[92:95], v8, s[8:11], s87 offen offset:3072 sc1
    s_waitcnt vmcnt(0)
    v_max3_u32 v2, v96, v100, v104
    v_max3_u32 v2, v2, v108, v112
    v_max3_u32 v2, v2, v116, v120
    v_max_u32 v2, v2, v124
    v_cmp_eq_u32 vcc, -1, v2
    s_cbranch_vccz pollkm_ok_86
pollkm_85:
    buffer_load_dwordx4 v[96:99], v9, s[8:11], s88 offen offset:0 sc1
    buffer_load_dwordx4 v[100:103], v9, s[8:11], s88 offen offset:256 sc1
    buffer_load_dwordx4 v[104:107], v9, s[8:11], s88 offen offset:512 sc1
    buffer_load_dwordx4 v[108:111], v9, s[8:11], s88 offen offset:768 sc1
    buffer_load_dwordx4 v[112:115], v9, s[8:11], s88 offen offset:1024 sc1
    buffer_load_dwordx4 v[116:119], v9, s[8:11], s88 offen offset:1280 sc1
    buffer_load_dwordx4 v[120:123], v9, s[8:11], s88 offen offset:1536 sc1
    buffer_load_dwordx4 v[124:127], v9, s[8:11], s88 offen offset:1792 sc1
    s_waitcnt vmcnt(0)
    v_max3_u32 v2, v96, v100, v104
    v_max3_u32 v2, v2, v108, v112
    v_max3_u32 v2, v2, v116, v120
    v_max_u32 v2, v2, v124
    v_cmp_eq_u32 vcc, -1, v2
    s_cbranch_vccz pollkm_ok_86
    s_sub_u32 s77, s77, 1
    s_cbranch_scc0 pollkm_85
    s_mov_b32 s77, 0
pollkm_ok_86:
    v_mfma_f32_32x32x16_bf16 v[16:31], v[96:99], v[32:35], 0
    v_mfma_f32_32x32x16_bf16 v[16:31], v[100:103], v[36:39], v[16:31]
    v_mfma_f32_32x32x16_bf16 v[16:31], v[104:107], v[40:43], v[16:31]
    v_mfma_f32_32x32x16_bf16 v[16:31], v[108:111], v[44:47], v[16:31]
    v_mfma_f32_32x32x16_bf16 v[16:31], v[112:115], v[48:51], v[16:31]
    v_mfma_f32_32x32x16_bf16 v[16:31], v[116:119], v[52:55], v[16:31]
    v_mfma_f32_32x32x16_bf16 v[16:31], v[120:123], v[56:59], v[16:31]
    v_mfma_f32_32x32x16_bf16 v[16:31], v[124:127], v[60:63], v[16:31]
    s_nop 11
    v_mov_b32 v4, v16
    v_mov_b32 v5, v17
    v_mov_b32 v6, v18
    v_mov_b32 v7, v19
    s_add_u32 s87, s90, 0x2000000
    buffer_load_dwordx4 v[96:99], v8, s[8:11], s87 offen offset:0 sc1
    buffer_load_dwordx4 v[100:103], v8, s[8:11], s87 offen offset:1024 sc1
    buffer_load_dwordx4 v[104:107], v8, s[8:11], s87 offen offset:2048 sc1
    buffer_load_dwordx4 v[108:111], v8, s[8:11], s87 offen offset:3072 sc1
    s_add_u32 s87, s87, 4096
    buffer_load_dwordx4 v[112:115], v8, s[8:11], s87 offen offset:0 sc1
    buffer_load_dwordx4 v[116:119], v8, s[8:11], s87 offen offset:1024 sc1
    buffer_load_dwordx4 v[120:123], v8, s[8:11], s87 offen offset:2048 sc1
    buffer_load_dwordx4 v[124:127], v8, s[8:11], s87 offen offset:3072 sc1
    v_mfma_f32_32x32x16_bf16 v[16:31], v[64:67], v[32:35], 0
    v_mfma_f32_32x32x16_bf16 v[16:31], v[68:71], v[36:39], v[16:31]
    v_mfma_f32_32x32x16_bf16 v[16:31], v[72:75], v[40:43], v[16:31]
    v_mfma_f32_32x32x16_bf16 v[16:31], v[76:79], v[44:47], v[16:31]
    v_mfma_f32_32x32x16_bf16 v[16:31], v[80:83], v[48:51], v[16:31]
    v_mfma_f32_32x32x16_bf16 v[16:31], v[84:87], v[52:55], v[16:31]
    v_mfma_f32_32x32x16_bf16 v[16:31], v[88:91], v[56:59], v[16:31]
    v_mfma_f32_32x32x16_bf16 v[16:31], v[92:95], v[60:63], v[16:31]
    v_mov_b32 v3, 0xff800000
    v_cmp_le_i32 vcc, 0, v15
    s_nop 9
    v_cndmask_b32 v16, v3, v16, vcc
    v_cmp_le_i32 vcc, 1, v15
    s_nop 1
    v_cndmask_b32 v17, v3, v17, vcc
    v_cmp_le_i32 vcc, 2, v15
    s_nop 1
    v_cndmask_b32 v18, v3, v18, vcc
    v_cmp_le_i32 vcc, 3, v15
    s_nop 1
    v_cndmask_b32 v19, v3, v19, vcc
    v_cmp_le_i32 vcc, 8, v15
    s_nop 1
    v_cndmask_b32 v20, v3, v20, vcc
    v_cmp_le_i32 vcc, 9, v15
    s_nop 1
    v_cndmask_b32 v21, v3, v21, vcc
    v_cmp_le_i32 vcc, 10, v15
    s_nop 1
    v_cndmask_b32 v22, v3, v22, vcc
    v_cmp_le_i32 vcc, 11, v15
    s_nop 1
    v_cndmask_b32 v23, v3, v23, vcc
    v_cmp_le_i32 vcc, 16, v15
    s_nop 1
    v_cndmask_b32 v24, v3, v24, vcc
    v_cmp_le_i32 vcc, 17, v15
    s_nop 1
    v_cndmask_b32 v25, v3, v25, vcc
    v_cmp_le_i32 vcc, 18, v15
    s_nop 1
    v_cndmask_b32 v26, v3, v26, vcc
    v_cmp_le_i32 vcc, 19, v15
    s_nop 1
    v_cndmask_b32 v27, v3, v27, vcc
    v_cmp_le_i32 vcc, 24, v15
    s_nop 1
    v_cndmask_b32 v28, v3, v28, vcc
    v_cmp_le_i32 vcc, 25, v15
    s_nop 1
    v_cndmask_b32 v29, v3, v29, vcc
    v_cmp_le_i32 vcc, 26, v15
    s_nop 1
    v_cndmask_b32 v30, v3, v30, vcc
    v_cmp_le_i32 vcc, 27, v15
    s_nop 1
    v_cndmask_b32 v31, v3, v31, vcc
    s_add_u32 s88, s88, 0x400000
    buffer_load_dwordx2 v[64:65], v10, s[8:11], s88 offen offset:0 sc1
    buffer_load_dwordx2 v[66:67], v10, s[8:11], s88 offen offset:512 sc1
    buffer_load_dwordx2 v[68:69], v10, s[8:11], s88 offen offset:1024 sc1
    buffer_load_dwordx2 v[70:71], v10, s[8:11], s88 offen offset:1536 sc1
    v_max3_f32 v2, v16, v17, v18
    v_max3_f32 v2, v2, v19, v20
    v_max3_f32 v2, v2, v21, v22
    v_max3_f32 v2, v2, v23, v24
    v_max3_f32 v2, v2, v25, v26
    v_max3_f32 v2, v2, v27, v28
    v_max3_f32 v2, v2, v29, v30
    v_max3_f32 v2, v2, v31, v4
    v_max3_f32 v2, v2, v5, v6
    v_max_f32 v2, v2, v7
    v_mov_b32 v3, v2
    s_nop 1
    v_permlane32_swap_b32 v2, v3
    v_max_f32 v2, v2, v3
    v_mul_f32 v2, s89, v2
    v_fma_f32 v16, v16, s89, -v2
    v_fma_f32 v17, v17, s89, -v2
    v_fma_f32 v18, v18, s89, -v2
    v_fma_f32 v19, v19, s89, -v2
    v_fma_f32 v20, v20, s89, -v2
    v_fma_f32 v21, v21, s89, -v2
    v_fma_f32 v22, v22, s89, -v2
    v_fma_f32 v23, v23, s89, -v2
    v_fma_f32 v24, v24, s89, -v2
    v_fma_f32 v25, v25, s89, -v2
    v_fma_f32 v26, v26, s89, -v2
    v_fma_f32 v27, v27, s89, -v2
    v_fma_f32 v28, v28, s89, -v2
    v_fma_f32 v29, v29, s89, -v2
    v_fma_f32 v30, v30, s89, -v2
    v_fma_f32 v31, v31, s89, -v2
    v_fma_f32 v4, v4, s89, -v2
    v_fma_f32 v5, v5, s89, -v2
    v_fma_f32 v6, v6, s89, -v2
    v_fma_f32 v7, v7, s89, -v2
    v_exp_f32 v16, v16
    v_exp_f32 v17, v17
    v_exp_f32 v18, v18
    v_exp_f32 v19, v19
    v_exp_f32 v20, v20
    v_exp_f32 v21, v21
    v_exp_f32 v22, v22
    v_exp_f32 v23, v23
    v_exp_f32 v24, v24
    v_exp_f32 v25, v25
    v_exp_f32 v26, v26
    v_exp_f32 v27, v27
    v_exp_f32 v28, v28
    v_exp_f32 v29, v29
    v_exp_f32 v30, v30
    v_exp_f32 v31, v31
    v_exp_f32 v4, v4
    v_exp_f32 v5, v5
    v_exp_f32 v6, v6
    v_exp_f32 v7, v7
    v_cvt_pk_bf16_f32 v32, v16, v17
    v_cvt_pk_bf16_f32 v33, v18, v19
    v_cvt_pk_bf16_f32 v34, v20, v21
    v_cvt_pk_bf16_f32 v35, v22, v23
    v_cvt_pk_bf16_f32 v36, v24, v25
    v_cvt_pk_bf16_f32 v37, v26, v27
    v_cvt_pk_bf16_f32 v38, v28, v29
    v_cvt_pk_bf16_f32 v39, v30, v31
    v_cvt_pk_bf16_f32 v40, v4, v5
    v_cvt_pk_bf16_f32 v41, v6, v7
    v_add_f32 v2, v16, v17
    v_add_f32 v2, v2, v18
    v_add_f32 v2, v2, v19
    v_add_f32 v2, v2, v20
    v_add_f32 v2, v2, v21
    v_add_f32 v2, v2, v22
    v_add_f32 v2, v2, v23
    v_add_f32 v2, v2, v24
    v_add_f32 v2, v2, v25
    v_add_f32 v2, v2, v26
    v_add_f32 v2, v2, v27
    v_add_f32 v2, v2, v28
    v_add_f32 v2, v2, v29
    v_add_f32 v2, v2, v30
    v_add_f32 v2, v2, v31
    v_add_f32 v2, v2, v4
    v_add_f32 v2, v2, v5
    v_add_f32 v2, v2, v6
    v_add_f32 v2, v2, v7
    v_mov_b32 v3, v2
    s_nop 1
    v_permlane32_swap_b32 v2, v3
    v_add_f32 v2, v2, v3
    v_rcp_f32 v2, v2
    s_waitcnt vmcnt(0)
    v_max3_u32 v3, v64, v66, v68
    v_max_u32 v3, v3, v70
    v_cmp_eq_u32 vcc, -1, v3
    s_cbranch_vccz pollvm_ok_88
pollvm_87:
    buffer_load_dwordx2 v[64:65], v10, s[8:11], s88 offen offset:0 sc1
    buffer_load_dwordx2 v[66:67], v10, s[8:11], s88 offen offset:512 sc1
    buffer_load_dwordx2 v[68:69], v10, s[8:11], s88 offen offset:1024 sc1
    buffer_load_dwordx2 v[70:71], v10, s[8:11], s88 offen offset:1536 sc1
    s_waitcnt vmcnt(0)
    v_max3_u32 v3, v64, v66, v68
    v_max_u32 v3, v3, v70
    v_cmp_eq_u32 vcc, -1, v3
    s_cbranch_vccz pollvm_ok_88
    s_sub_u32 s77, s77, 1
    s_cbranch_scc0 pollvm_87
    s_mov_b32 s77, 0
pollvm_ok_88:
    s_add_u32 s87, s90, 0x3000000
    v_mfma_f32_32x32x8_bf16 v[48:63], v[64:65], v[40:41], 0
    s_nop 9
    v_mfma_f32_32x32x16_bf16 v[48:63], v[96:99], v[32:35], v[48:63]
    v_mfma_f32_32x32x16_bf16 v[48:63], v[100:103], v[36:39], v[48:63]
    v_mfma_f32_32x32x8_bf16 v[80:95], v[66:67], v[40:41], 0
    s_nop 9
    v_mfma_f32_32x32x16_bf16 v[80:95], v[104:107], v[32:35], v[80:95]
    v_mfma_f32_32x32x16_bf16 v[80:95], v[108:111], v[36:39], v[80:95]
    v_mfma_f32_32x32x8_bf16 v[16:31], v[68:69], v[40:41], 0
    s_nop 9
    v_mfma_f32_32x32x16_bf16 v[16:31], v[112:115], v[32:35], v[16:31]
    v_mfma_f32_32x32x16_bf16 v[16:31], v[116:119], v[36:39], v[16:31]
    v_mul_f32 v48, v2, v48
    v_mul_f32 v49, v2, v49
    v_mul_f32 v50, v2, v50
    v_mul_f32 v51, v2, v51
    v_mul_f32 v52, v2, v52
    v_mul_f32 v53, v2, v53
    v_mul_f32 v54, v2, v54
    v_mul_f32 v55, v2, v55
    v_mul_f32 v56, v2, v56
    v_mul_f32 v57, v2, v57
    v_mul_f32 v58, v2, v58
    v_mul_f32 v59, v2, v59
    v_mul_f32 v60, v2, v60
    v_mul_f32 v61, v2, v61
    v_mul_f32 v62, v2, v62
    v_mul_f32 v63, v2, v63
    v_cvt_pk_bf16_f32 v72, v48, v49
    v_cvt_pk_bf16_f32 v73, v50, v51
    v_cvt_pk_bf16_f32 v74, v52, v53
    v_cvt_pk_bf16_f32 v75, v54, v55
    buffer_store_dwordx4 v[72:75], v8, s[8:11], s87 offen offset:0
    v_cvt_pk_bf16_f32 v76, v56, v57
    v_cvt_pk_bf16_f32 v77, v58, v59
    v_cvt_pk_bf16_f32 v78, v60, v61
    v_cvt_pk_bf16_f32 v79, v62, v63
    buffer_store_dwordx4 v[76:79], v8, s[8:11], s87 offen offset:1024
    v_mfma_f32_32x32x8_bf16 v[48:63], v[70:71], v[40:41], 0
    s_nop 9
    v_mfma_f32_32x32x16_bf16 v[48:63], v[120:123], v[32:35], v[48:63]
    v_mfma_f32_32x32x16_bf16 v[48:63], v[124:127], v[36:39], v[48:63]
    v_mul_f32 v80, v2, v80
    v_mul_f32 v81, v2, v81
    v_mul_f32 v82, v2, v82
    v_mul_f32 v83, v2, v83
    v_mul_f32 v84, v2, v84
    v_mul_f32 v85, v2, v85
    v_mul_f32 v86, v2, v86
    v_mul_f32 v87, v2, v87
    v_mul_f32 v88, v2, v88
    v_mul_f32 v89, v2, v89
    v_mul_f32 v90, v2, v90
    v_mul_f32 v91, v2, v91
    v_mul_f32 v92, v2, v92
    v_mul_f32 v93, v2, v93
    v_mul_f32 v94, v2, v94
    v_mul_f32 v95, v2, v95
    v_cvt_pk_bf16_f32 v72, v80, v81
    v_cvt_pk_bf16_f32 v73, v82, v83
    v_cvt_pk_bf16_f32 v74, v84, v85
    v_cvt_pk_bf16_f32 v75, v86, v87
    buffer_store_dwordx4 v[72:75], v8, s[8:11], s87 offen offset:2048
    v_cvt_pk_bf16_f32 v76, v88, v89
    v_cvt_pk_bf16_f32 v77, v90, v91
    v_cvt_pk_bf16_f32 v78, v92, v93
    v_cvt_pk_bf16_f32 v79, v94, v95
    buffer_store_dwordx4 v[76:79], v8, s[8:11], s87 offen offset:3072
    s_add_u32 s87, s87, 4096
    v_mul_f32 v16, v2, v16
    v_mul_f32 v17, v2, v17
    v_mul_f32 v18, v2, v18
    v_mul_f32 v19, v2, v19
    v_mul_f32 v20, v2, v20
    v_mul_f32 v21, v2, v21
    v_mul_f32 v22, v2, v22
    v_mul_f32 v23, v2, v23
    v_mul_f32 v24, v2, v24
    v_mul_f32 v25, v2, v25
    v_mul_f32 v26, v2, v26
    v_mul_f32 v27, v2, v27
    v_mul_f32 v28, v2, v28
    v_mul_f32 v29, v2, v29
    v_mul_f32 v30, v2, v30
    v_mul_f32 v31, v2, v31
    v_cvt_pk_bf16_f32 v72, v16, v17
    v_cvt_pk_bf16_f32 v73, v18, v19
    v_cvt_pk_bf16_f32 v74, v20, v21
    v_cvt_pk_bf16_f32 v75, v22, v23
    buffer_store_dwordx4 v[72:75], v8, s[8:11], s87 offen offset:0
    v_cvt_pk_bf16_f32 v76, v24, v25
    v_cvt_pk_bf16_f32 v77, v26, v27
    v_cvt_pk_bf16_f32 v78, v28, v29
    v_cvt_pk_bf16_f32 v79, v30, v31
    buffer_store_dwordx4 v[76:79], v8, s[8:11], s87 offen offset:1024
    v_mul_f32 v48, v2, v48
    v_mul_f32 v49, v2, v49
    v_mul_f32 v50, v2, v50
    v_mul_f32 v51, v2, v51
    v_mul_f32 v52, v2, v52
    v_mul_f32 v53, v2, v53
    v_mul_f32 v54, v2, v54
    v_mul_f32 v55, v2, v55
    v_mul_f32 v56, v2, v56
    v_mul_f32 v57, v2, v57
    v_mul_f32 v58, v2, v58
    v_mul_f32 v59, v2, v59
    v_mul_f32 v60, v2, v60
    v_mul_f32 v61, v2, v61
    v_mul_f32 v62, v2, v62
    v_mul_f32 v63, v2, v63
    v_cvt_pk_bf16_f32 v72, v48, v49
    v_cvt_pk_bf16_f32 v73, v50, v51
    v_cvt_pk_bf16_f32 v74, v52, v53
    v_cvt_pk_bf16_f32 v75, v54, v55
    buffer_store_dwordx4 v[72:75], v8, s[8:11], s87 offen offset:2048
    v_cvt_pk_bf16_f32 v76, v56, v57
    v_cvt_pk_bf16_f32 v77, v58, v59
    v_cvt_pk_bf16_f32 v78, v60, v61
    v_cvt_pk_bf16_f32 v79, v62, v63
    buffer_store_dwordx4 v[76:79], v8, s[8:11], s87 offen offset:3072
    s_lshr_b32 s87, s90, 11
    s_add_u32 s87, s87, 0x5100000
    v_mov_b32 v2, 1
    v_mov_b32 v3, 0
    s_waitcnt vmcnt(0)
    buffer_store_dword v2, v3, s[8:11], s87 offen
    s_add_u32 s86, s86, 8
aw_wo_80:
    s_lshl_b32 s88, s85, 2
    s_add_u32 s88, s88, s75
    s_lshl_b32 s88, s88, 7
    s_add_u32 s88, s88, 0x5100000
pollfl_89:
    buffer_load_dwordx2 v[4:5], v11, s[8:11], s88 offen sc1
    s_waitcnt vmcnt(0)
    v_min_u32 v4, v4, v5
    v_cmp_eq_u32 vcc, 0, v4
    s_cbranch_vccz pollfl_ok_90
    s_sub_u32 s77, s77, 1
    s_cbranch_scc0 pollfl_89
    s_mov_b32 s77, 0
pollfl_ok_90:
    s_lshl_b32 s88, s85, 2
    s_add_u32 s88, s88, s75
    s_lshl_b32 s88, s88, 7
    s_add_u32 s88, s88, 0x5100200
    buffer_load_dwordx2 v[4:5], v11, s[8:11], s88 offen sc1
    buffer_load_dword v6, off, s[12:15], 0 offset:64 sc1
    s_lshl_b32 s90, s85, 2
    s_add_u32 s90, s90, s75
    s_add_u32 s90, s90, 0
    s_lshl_b32 s90, s90, 18
    s_add_u32 s90, s90, s93
    buffer_load_dwordx4 v[48:51], v8, s[8:11], s90 offen offset:0 sc1
    buffer_load_dwordx4 v[52:55], v8, s[8:11], s90 offen offset:1024 sc1
    buffer_load_dwordx4 v[56:59], v8, s[8:11], s90 offen offset:2048 sc1
    buffer_load_dwordx4 v[60:63], v8, s[8:11], s90 offen offset:3072 sc1
    s_add_u32 s90, s90, 4096
    buffer_load_dwordx4 v[64:67], v8, s[8:11], s90 offen offset:0 sc1
    buffer_load_dwordx4 v[68:71], v8, s[8:11], s90 offen offset:1024 sc1
    buffer_load_dwordx4 v[72:75], v8, s[8:11], s90 offen offset:2048 sc1
    buffer_load_dwordx4 v[76:79], v8, s[8:11], s90 offen offset:3072 sc1
    s_add_u32 s90, s90, 4096
    buffer_load_dwordx4 v[80:83], v8, s[8:11], s90 offen offset:0 sc1
    buffer_load_dwordx4 v[84:87], v8, s[8:11], s90 offen offset:1024 sc1
    buffer_load_dwordx4 v[88:91], v8, s[8:11], s90 offen offset:2048 sc1
    buffer_load_dwordx4 v[92:95], v8, s[8:11], s90 offen offset:3072 sc1
    s_add_u32 s90, s90, 4096
    buffer_load_dwordx4 v[96:99], v8, s[8:11], s90 offen offset:0 sc1
    buffer_load_dwordx4 v[100:103], v8, s[8:11], s90 offen offset:1024 sc1
    buffer_load_dwordx4 v[104:107], v8, s[8:11], s90 offen offset:2048 sc1
    buffer_load_dwordx4 v[108:111], v8, s[8:11], s90 offen offset:3072 sc1
    v_mov_b32 v2, 0x5ffffff0
    buffer_load_dword v7, v2, s[8:11], 0 offen
    buffer_load_dword v7, v2, s[8:11], 0 offen
aw_stream_82:
    s_waitcnt vmcnt(18)
    v_readfirstlane_b32 s91, v6
    v_min_u32 v4, v4, v5
    v_cmp_eq_u32 vcc, 0, v4
    s_lshl_b32 s88, s85, 2
    s_add_u32 s88, s88, s75
    s_lshl_b32 s88, s88, 7
    s_add_u32 s88, s88, 0x5100400
    buffer_load_dwordx2 v[4:5], v11, s[8:11], s88 offen sc1
    buffer_load_dword v6, off, s[12:15], 0 offset:64 sc1
    s_mov_b32 s92, 0
    s_cbranch_vccnz aw_b_91
    s_cmp_ge_u32 s85, 15
    s_cbranch_scc1 aw_b_91
    s_lshl_b32 s87, s86, 2
    s_add_u32 s87, s87, s75
    s_cmp_ge_u32 s86, 14
    s_cselect_b32 s88, 1, 3
    s_add_u32 s88, s88, s87
    s_cmp_ge_u32 s91, s88
    s_cbranch_scc1 aw_b_91
    s_add_u32 s87, s85, 1
    s_cmp_eq_u32 s86, s87
    s_cbranch_scc1 aw_b_91
    s_mov_b32 s92, 1
    s_lshl_b32 s90, s85, 2
    s_add_u32 s90, s90, s75
    s_add_u32 s90, s90, 4
    s_lshl_b32 s90, s90, 18
    s_add_u32 s90, s90, s93
    s_waitcnt vmcnt(19)
    v_mfma_f32_32x32x16_bf16 v[16:31], v[128:131], v[48:51], 0
    v_mfma_f32_32x32x16_bf16 v[32:47], v[192:195], v[48:51], 0
    buffer_load_dwordx4 v[48:51], v8, s[8:11], s90 offen offset:0 sc1
    s_waitcnt vmcnt(19)
    v_mfma_f32_32x32x16_bf16 v[16:31], v[132:135], v[52:55], v[16:31]
    v_mfma_f32_32x32x16_bf16 v[32:47], v[196:199], v[52:55], v[32:47]
    buffer_load_dwordx4 v[52:55], v8, s[8:11], s90 offen offset:1024 sc1
    s_waitcnt vmcnt(19)
    v_mfma_f32_32x32x16_bf16 v[16:31], v[136:139], v[56:59], v[16:31]
    v_mfma_f32_32x32x16_bf16 v[32:47], v[200:203], v[56:59], v[32:47]
    buffer_load_dwordx4 v[56:59], v8, s[8:11], s90 offen offset:2048 sc1
    s_waitcnt vmcnt(19)
    v_mfma_f32_32x32x16_bf16 v[16:31], v[140:143], v[60:63], v[16:31]
    v_mfma_f32_32x32x16_bf16 v[32:47], v[204:207], v[60:63], v[32:47]
    buffer_load_dwordx4 v[60:63], v8, s[8:11], s90 offen offset:3072 sc1
    s_waitcnt vmcnt(19)
    v_mfma_f32_32x32x16_bf16 v[16:31], v[144:147], v[64:67], v[16:31]
    v_mfma_f32_32x32x16_bf16 v[32:47], v[208:211], v[64:67], v[32:47]
    s_add_u32 s90, s90, 4096
    buffer_load_dwordx4 v[64:67], v8, s[8:11], s90 offen offset:0 sc1
    s_waitcnt vmcnt(19)
    v_mfma_f32_32x32x16_bf16 v[16:31], v[148:151], v[68:71], v[16:31]
    v_mfma_f32_32x32x16_bf16 v[32:47], v[212:215], v[68:71], v[32:47]
    buffer_load_dwordx4 v[68:71], v8, s[8:11], s90 offen offset:1024 sc1
    s_waitcnt vmcnt(19)
    v_mfma_f32_32x32x16_bf16 v[16:31], v[152:155], v[72:75], v[16:31]
    v_mfma_f32_32x32x16_bf16 v[32:47], v[216:219], v[72:75], v[32:47]
    buffer_load_dwordx4 v[72:75], v8, s[8:11], s90 offen offset:2048 sc1
    s_waitcnt vmcnt(19)
    v_mfma_f32_32x32x16_bf16 v[16:31], v[156:159], v[76:79], v[16:31]
    v_mfma_f32_32x32x16_bf16 v[32:47], v[220:223], v[76:79], v[32:47]
    buffer_load_dwordx4 v[76:79], v8, s[8:11], s90 offen offset:3072 sc1
    s_waitcnt vmcnt(19)
    v_mfma_f32_32x32x16_bf16 v[16:31], v[160:163], v[80:83], v[16:31]
    v_mfma_f32_32x32x16_bf16 v[32:47], v[224:227], v[80:83], v[32:47]
    s_add_u32 s90, s90, 4096
    buffer_load_dwordx4 v[80:83], v8, s[8:11], s90 offen offset:0 sc1
    s_waitcnt vmcnt(19)
    v_mfma_f32_32x32x16_bf16 v[16:31], v[164:167], v[84:87], v[16:31]
    v_mfma_f32_32x32x16_bf16 v[32:47], v[228:231], v[84:87], v[32:47]
    buffer_load_dwordx4 v[84:87], v8, s[8:11], s90 offen offset:1024 sc1
    s_waitcnt vmcnt(19)
    v_mfma_f32_32x32x16_bf16 v[16:31], v[168:171], v[88:91], v[16:31]
    v_mfma_f32_32x32x16_bf16 v[32:47], v[232:235], v[88:91], v[32:47]
    buffer_load_dwordx4 v[88:91], v8, s[8:11], s90 offen offset:2048 sc1
    s_waitcnt vmcnt(19)
    v_mfma_f32_32x32x16_bf16 v[16:31], v[172:175], v[92:95], v[16:31]
    v_mfma_f32_32x32x16_bf16 v[32:47], v[236:239], v[92:95], v[32:47]
    buffer_load_dwordx4 v[92:95], v8, s[8:11], s90 offen offset:3072 sc1
    s_waitcnt vmcnt(19)
    v_mfma_f32_32x32x16_bf16 v[16:31], v[176:179], v[96:99], v[16:31]
    v_mfma_f32_32x32x16_bf16 v[32:47], v[240:243], v[96:99], v[32:47]
    s_add_u32 s90, s90, 4096
    buffer_load_dwordx4 v[96:99], v8, s[8:11], s90 offen offset:0 sc1
    s_waitcnt vmcnt(19)
    v_mfma_f32_32x32x16_bf16 v[16:31], v[180:183], v[100:103], v[16:31]
    v_mfma_f32_32x32x16_bf16 v[32:47], v[244:247], v[100:103], v[32:47]
    buffer_load_dwordx4 v[100:103], v8, s[8:11], s90 offen offset:1024 sc1
    s_waitcnt vmcnt(19)
    v_mfma_f32_32x32x16_bf16 v[16:31], v[184:187], v[104:107], v[16:31]
    v_mfma_f32_32x32x16_bf16 v[32:47], v[248:251], v[104:107], v[32:47]
    buffer_load_dwordx4 v[104:107], v8, s[8:11], s90 offen offset:2048 sc1
    s_waitcnt vmcnt(19)
    v_mfma_f32_32x32x16_bf16 v[16:31], v[188:191], v[108:111], v[16:31]
    v_mfma_f32_32x32x16_bf16 v[32:47], v[252:255], v[108:111], v[32:47]
    buffer_load_dwordx4 v[108:111], v8, s[8:11], s90 offen offset:3072 sc1
    s_branch aw_red_92
aw_b_91:
    s_waitcnt vmcnt(19)
    v_mfma_f32_32x32x16_bf16 v[16:31], v[128:131], v[48:51], 0
    v_mfma_f32_32x32x16_bf16 v[32:47], v[192:195], v[48:51], 0
    s_waitcnt vmcnt(18)
    v_mfma_f32_32x32x16_bf16 v[16:31], v[132:135], v[52:55], v[16:31]
    v_mfma_f32_32x32x16_bf16 v[32:47], v[196:199], v[52:55], v[32:47]
    s_waitcnt vmcnt(17)
    v_mfma_f32_32x32x16_bf16 v[16:31], v[136:139], v[56:59], v[16:31]
    v_mfma_f32_32x32x16_bf16 v[32:47], v[200:203], v[56:59], v[32:47]
    s_waitcnt vmcnt(16)
    v_mfma_f32_32x32x16_bf16 v[16:31], v[140:143], v[60:63], v[16:31]
    v_mfma_f32_32x32x16_bf16 v[32:47], v[204:207], v[60:63], v[32:47]
    s_waitcnt vmcnt(15)
    v_mfma_f32_32x32x16_bf16 v[16:31], v[144:147], v[64:67], v[16:31]
    v_mfma_f32_32x32x16_bf16 v[32:47], v[208:211], v[64:67], v[32:47]
    s_waitcnt vmcnt(14)
    v_mfma_f32_32x32x16_bf16 v[16:31], v[148:151], v[68:71], v[16:31]
    v_mfma_f32_32x32x16_bf16 v[32:47], v[212:215], v[68:71], v[32:47]
    s_waitcnt vmcnt(13)
    v_mfma_f32_32x32x16_bf16 v[16:31], v[152:155], v[72:75], v[16:31]
    v_mfma_f32_32x32x16_bf16 v[32:47], v[216:219], v[72:75], v[32:47]
    s_waitcnt vmcnt(12)
    v_mfma_f32_32x32x16_bf16 v[16:31], v[156:159], v[76:79], v[16:31]
    v_mfma_f32_32x32x16_bf16 v[32:47], v[220:223], v[76:79], v[32:47]
    s_waitcnt vmcnt(11)
    v_mfma_f32_32x32x16_bf16 v[16:31], v[160:163], v[80:83], v[16:31]
    v_mfma_f32_32x32x16_bf16 v[32:47], v[224:227], v[80:83], v[32:47]
    s_waitcnt vmcnt(10)
    v_mfma_f32_32x32x16_bf16 v[16:31], v[164:167], v[84:87], v[16:31]
    v_mfma_f32_32x32x16_bf16 v[32:47], v[228:231], v[84:87], v[32:47]
    s_waitcnt vmcnt(9)
    v_mfma_f32_32x32x16_bf16 v[16:31], v[168:171], v[88:91], v[16:31]
    v_mfma_f32_32x32x16_bf16 v[32:47], v[232:235], v[88:91], v[32:47]
    s_waitcnt vmcnt(8)
    v_mfma_f32_32x32x16_bf16 v[16:31], v[172:175], v[92:95], v[16:31]
    v_mfma_f32_32x32x16_bf16 v[32:47], v[236:239], v[92:95], v[32:47]
    s_waitcnt vmcnt(7)
    v_mfma_f32_32x32x16_bf16 v[16:31], v[176:179], v[96:99], v[16:31]
    v_mfma_f32_32x32x16_bf16 v[32:47], v[240:243], v[96:99], v[32:47]
    s_waitcnt vmcnt(6)
    v_mfma_f32_32x32x16_bf16 v[16:31], v[180:183], v[100:103], v[16:31]
    v_mfma_f32_32x32x16_bf16 v[32:47], v[244:247], v[100:103], v[32:47]
    s_waitcnt vmcnt(5)
    v_mfma_f32_32x32x16_bf16 v[16:31], v[184:187], v[104:107], v[16:31]
    v_mfma_f32_32x32x16_bf16 v[32:47], v[248:251], v[104:107], v[32:47]
    s_waitcnt vmcnt(4)
    v_mfma_f32_32x32x16_bf16 v[16:31], v[188:191], v[108:111], v[16:31]
    v_mfma_f32_32x32x16_bf16 v[32:47], v[252:255], v[108:111], v[32:47]
    s_waitcnt vmcnt(0)
    v_readfirstlane_b32 s91, v6
aw_red_92:
    s_and_b32 s88, s85, 1
    s_mul_i32 s88, s88, 67584
    v_add_u32 v2, s88, v12
    v_add_u32 v3, s88, v13
    s_nop 4
    ds_write_b128 v2, v[16:19] offset:0
    ds_write_b128 v2, v[20:23] offset:1056
    ds_write_b128 v2, v[24:27] offset:2112
    ds_write_b128 v2, v[28:31] offset:3168
    ds_write_b128 v2, v[32:35] offset:4224
    ds_write_b128 v2, v[36:39] offset:5280
    ds_write_b128 v2, v[40:43] offset:6336
    ds_write_b128 v2, v[44:47] offset:7392
    s_waitcnt lgkmcnt(0)
    s_barrier
    ds_read_b64 v[16:17], v3 offset:0
    ds_read_b64 v[18:19], v3 offset:8448
    ds_read_b64 v[20:21], v3 offset:16896
    ds_read_b64 v[22:23], v3 offset:25344
    ds_read_b64 v[24:25], v3 offset:33792
    ds_read_b64 v[26:27], v3 offset:42240
    ds_read_b64 v[28:29], v3 offset:50688
    ds_read_b64 v[30:31], v3 offset:59136
    ds_read_b64 v[32:33], v3 offset:32
    ds_read_b64 v[34:35], v3 offset:8480
    ds_read_b64 v[36:37], v3 offset:16928
    ds_read_b64 v[38:39], v3 offset:25376
    ds_read_b64 v[40:41], v3 offset:33824
    ds_read_b64 v[42:43], v3 offset:42272
    ds_read_b64 v[44:45], v3 offset:50720
    ds_read_b64 v[46:47], v3 offset:59168
    s_lshl_b32 s87, s85, 2
    s_add_u32 s87, s87, s75
    s_lshl_b32 s87, s87, 17
    s_add_u32 s88, s87, 8192
    s_waitcnt lgkmcnt(8)
    v_pk_add_f32 v[16:17], v[16:17], v[24:25]
    v_pk_add_f32 v[18:19], v[18:19], v[26:27]
    v_pk_add_f32 v[20:21], v[20:21], v[28:29]
    v_pk_add_f32 v[22:23], v[22:23], v[30:31]
    v_pk_add_f32 v[16:17], v[16:17], v[20:21]
    v_pk_add_f32 v[18:19], v[18:19], v[22:23]
    v_pk_add_f32 v[16:17], v[16:17], v[18:19]
    v_cvt_pk_bf16_f32 v2, v16, v17
    buffer_atomic_pk_add_bf16 v2, v14, s[16:19], s87 offen
    s_waitcnt lgkmcnt(0)
    v_pk_add_f32 v[32:33], v[32:33], v[40:41]
    v_pk_add_f32 v[34:35], v[34:35], v[42:43]
    v_pk_add_f32 v[36:37], v[36:37], v[44:45]
    v_pk_add_f32 v[38:39], v[38:39], v[46:47]
    v_pk_add_f32 v[32:33], v[32:33], v[36:37]
    v_pk_add_f32 v[34:35], v[34:35], v[38:39]
    v_pk_add_f32 v[32:33], v[32:33], v[34:35]
    v_cvt_pk_bf16_f32 v3, v32, v33
    buffer_atomic_pk_add_bf16 v3, v14, s[16:19], s88 offen
    s_add_u32 s85, s85, 1
    s_cmp_lt_u32 s85, 16
    s_cbranch_scc1 aw_loop_79
    s_waitcnt vmcnt(0)
    s_endpgm
.section .rodata,"a"
.p2align 6
.amdhsa_kernel concat_heads__spectral_gfnet__memory_aug_recurrent_mem_tr__prompt_kernel
  .amdhsa_next_free_vgpr 256
  .amdhsa_next_free_sgpr 102
  .amdhsa_accum_offset 256
  .amdhsa_group_segment_fixed_size 0
  .amdhsa_kernarg_size 104
  .amdhsa_user_sgpr_count 2
  .amdhsa_user_sgpr_kernarg_segment_ptr 1
  .amdhsa_system_sgpr_workgroup_id_x 1
  .amdhsa_float_denorm_mode_32 3
  .amdhsa_float_denorm_mode_16_64 3
.end_amdhsa_kernel
```

```asm
; @launch grid=(256,1,1) block=(512,1,1) lds=163840
.amdgcn_target "amdgcn-amd-amdhsa--gfx950"
.text
.globl concat_heads__spectral_gfnet__memory_aug_recurrent_mem_tr__prompt_kernel
.p2align 8
.type concat_heads__spectral_gfnet__memory_aug_recurrent_mem_tr__prompt_kernel,@function
concat_heads__spectral_gfnet__memory_aug_recurrent_mem_tr__prompt_kernel:
    s_load_dwordx2 s[8:9], s[0:1], 96
    s_load_dwordx2 s[12:13], s[0:1], 88
    s_load_dwordx2 s[16:17], s[0:1], 80
    s_load_dwordx2 s[20:21], s[0:1], 40
    s_load_dwordx2 s[24:25], s[0:1], 48
    s_load_dwordx2 s[28:29], s[0:1], 56
    s_load_dwordx2 s[32:33], s[0:1], 64
    s_load_dwordx2 s[36:37], s[0:1], 24
    s_load_dwordx2 s[40:41], s[0:1], 32
    s_load_dwordx2 s[44:45], s[0:1], 0
    s_load_dwordx2 s[48:49], s[0:1], 8
    s_load_dwordx2 s[52:53], s[0:1], 16
    s_mov_b32 s10, 0x10000000
    s_mov_b32 s11, 0x20000
    s_mov_b32 s14, 0x100
    s_mov_b32 s15, 0x20000
    s_mov_b32 s18, 0x800000
    s_mov_b32 s19, 0x20000
    s_mov_b32 s22, 0x800000
    s_mov_b32 s23, 0x20000
    s_mov_b32 s26, 0x800000
    s_mov_b32 s27, 0x20000
    s_mov_b32 s30, 0x800000
    s_mov_b32 s31, 0x20000
    s_mov_b32 s34, 0x800000
    s_mov_b32 s35, 0x20000
    s_mov_b32 s38, 0x400000
    s_mov_b32 s39, 0x20000
    s_mov_b32 s42, 0x4000
    s_mov_b32 s43, 0x20000
    s_mov_b32 s46, 0x400000
    s_mov_b32 s47, 0x20000
    s_mov_b32 s50, 0x201000
    s_mov_b32 s51, 0x20000
    s_mov_b32 s54, 0x201000
    s_mov_b32 s55, 0x20000
    s_waitcnt lgkmcnt(0)
    s_getreg_b32 s56, hwreg(HW_REG_XCC_ID, 0, 3)
    v_lshrrev_b32 v2, 6, v0
    v_and_b32 v1, 63, v0
    v_readfirstlane_b32 s58, v2
    s_nop 0
    s_cmp_lg_u32 s58, 0
    s_cbranch_scc1 notw0_1
    s_lshl_b32 s57, s56, 5
    s_add_u32 s57, s57, 28
    v_mov_b32 v2, s57
    v_mov_b32 v3, 0x5ffffff0
    v_cmp_eq_u32 vcc, 0, v1
    s_nop 1
    v_cndmask_b32 v2, v3, v2, vcc
    v_mov_b32 v3, 1
    buffer_atomic_add v3, v2, s[12:15], 0 offen sc0 sc1
    v_mov_b32 v4, 0x27ff0
    s_waitcnt vmcnt(0)
    v_readfirstlane_b32 s3, v3
    s_nop 1
    v_mov_b32 v3, s3
    ds_write_b32 v4, v3
    s_waitcnt lgkmcnt(0)
notw0_1:
    s_barrier
    v_mov_b32 v4, 0x27ff0
    ds_read_b32 v3, v4
    s_waitcnt lgkmcnt(0)
    v_readfirstlane_b32 s57, v3
    s_nop 0
    s_cmp_lt_u32 s57, 32
    s_cbranch_scc1 go_3
    s_endpgm
go_3:
    s_cmp_ge_u32 s56, 4
    s_cbranch_scc1 bulk_2
    s_and_b32 s64, s57, 3
    s_lshr_b32 s65, s57, 2
    s_lshl_b32 s66, s56, 3
    s_add_u32 s66, s66, s65
    s_and_b32 s67, s58, 3
    s_mov_b32 s69, 0x40000
    v_and_b32 v6, 15, v1
    v_lshlrev_b32 v8, 4, v1
    v_mov_b32 v14, -1
    v_mov_b32 v15, -1
    v_mov_b32 v16, -1
    v_mov_b32 v17, -1
    s_mov_b32 s86, 0
    s_mov_b32 s87, 0
    s_mov_b32 s88, 0
    s_mov_b32 s89, 0
    s_mov_b32 s90, 0
    s_mov_b32 s91, 0
    s_mov_b32 s92, 0
    s_mov_b32 s93, 0
    s_mov_b32 s94, 0
    s_mov_b32 s95, 0
    s_mov_b32 s96, 0
    s_mov_b32 s97, 0
    s_mov_b32 s98, 0
    v_mov_b32 v2, 0x4444
    v_mov_b32 v3, 0xeeee
    v_and_b32 v4, 2, v1
    v_cmp_eq_u32 vcc, 0, v4
    s_nop 1
    v_cndmask_b32 v7, v3, v2, vcc
    v_bfe_u32 v36, v1, 0, 2
    v_lshlrev_b32 v36, 4, v36
    v_bfe_u32 v2, v1, 5, 1
    v_lshl_or_b32 v36, v2, 6, v36
    v_bfe_u32 v2, v1, 2, 2
    v_lshl_or_b32 v36, v2, 10, v36
    v_bfe_u32 v2, v1, 4, 1
    v_lshl_or_b32 v36, v2, 12, v36
    s_lshl_b32 s70, s56, 2
    s_add_u32 s70, s70, s64
    s_lshl_b32 s70, s70, 15
    s_add_u32 s70, s70, 0x4a00000
    s_lshl_b32 s71, s65, 2
    s_add_u32 s71, s71, s67
    s_lshl_b32 s72, s71, 10
    s_add_u32 s78, s70, s72
    s_lshl_b32 s72, s67, 13
    s_add_u32 s79, s70, s72
    s_lshl_b32 s72, s65, 7
    s_add_u32 s79, s79, s72
    s_bfe_u32 s77, s71, 0x20001
    s_lshl_b32 s77, s77, 7
    s_bfe_u32 s72, s71, 0x10000
    s_lshl_b32 s72, s72, 11
    s_or_b32 s77, s77, s72
    s_bfe_u32 s72, s71, 0x10003
    s_lshl_b32 s72, s72, 12
    s_or_b32 s77, s77, s72
    s_bfe_u32 s72, s71, 0x10004
    s_lshl_b32 s72, s72, 14
    s_or_b32 s77, s77, s72
    s_lshl_b32 s72, s56, 9
    s_add_u32 s77, s77, s72
    s_bfe_u32 s76, s58, 0x10000
    s_lshl_b32 s76, s76, 12
    s_bfe_u32 s72, s58, 0x10001
    s_lshl_b32 s72, s72, 14
    s_or_b32 s76, s76, s72
    s_lshl_b32 s72, s64, 15
    s_add_u32 s76, s76, s72
    s_add_u32 s72, s72, 0x20000
    s_add_u32 s77, s77, s72
    s_sub_u32 s7, 0, s8
    s_and_b32 s7, s7, 0x1fffff
    s_add_u32 s7, s7, 0x6c00000
    v_bfe_u32 v37, v1, 0, 2
    v_lshlrev_b32 v37, 4, v37
    v_bfe_u32 v2, v1, 4, 1
    v_lshl_or_b32 v37, v2, 6, v37
    v_bfe_u32 v2, v1, 2, 2
    v_lshl_or_b32 v37, v2, 7, v37
    v_bfe_u32 v2, v1, 5, 1
    v_lshl_or_b32 v37, v2, 9, v37
    v_add_u32 v37, s7, v37
    v_mov_b32 v5, 0x5ffffff0
    v_add_u32 v3, s7, v8
    v_cmp_gt_u32 vcc, 8, v1
    s_nop 1
    v_cndmask_b32 v35, v5, v3, vcc
    s_lshl_b32 s70, s66, 2
    s_add_u32 s70, s70, s67
    s_lshl_b32 s74, s70, 11
    s_add_u32 s74, s74, 0x4900000
    s_cmp_ge_u32 s58, 4
    s_cbranch_scc1 vo_arm_4
    s_lshl_b32 s73, s70, 12
    s_add_u32 s73, s73, 0x4800000
    s_lshl_b32 s71, s64, 10
    v_add_u32 v34, s71, v8
    s_add_u32 s71, s73, 0x80000
    buffer_store_dwordx4 v[14:17], v34, s[8:11], s73 offen
    buffer_store_dwordx4 v[14:17], v34, s[8:11], s71 offen
    v_bfe_u32 v2, v1, 0, 3
    v_lshlrev_b32 v2, 4, v2
    v_bfe_u32 v3, v1, 3, 1
    v_lshl_or_b32 v2, v3, 13, v2
    v_bfe_u32 v3, v1, 4, 2
    v_lshl_or_b32 v2, v3, 17, v2
    v_add_u32 v2, s7, v2
    buffer_store_dwordx4 v[14:17], v2, s[8:11], s77 offen sc1
    s_add_u32 s77, s77, 0x80000
    s_branch arm_done_5
vo_arm_4:
    s_mov_b32 s73, s74
    v_bfe_u32 v34, v1, 0, 4
    v_lshlrev_b32 v34, 4, v34
    v_bfe_u32 v2, v1, 5, 1
    v_lshl_or_b32 v34, v2, 8, v34
    v_bfe_u32 v2, v1, 4, 1
    v_lshl_or_b32 v34, v2, 10, v34
    s_bfe_u32 s71, s64, 0x10000
    s_lshl_b32 s71, s71, 3
    s_bfe_u32 s72, s64, 0x10001
    s_lshl_b32 s72, s72, 9
    s_or_b32 s71, s71, s72
    v_add_u32 v34, s71, v34
    s_add_u32 s71, s73, 0x40000
    buffer_store_dwordx2 v[14:15], v34, s[8:11], s73 offen
    buffer_store_dwordx2 v[14:15], v34, s[8:11], s71 offen
    s_add_u32 s71, s79, 0x80000
    buffer_store_dwordx4 v[14:17], v36, s[8:11], s79 offen
    buffer_store_dwordx4 v[14:17], v36, s[8:11], s71 offen
    s_add_u32 s2, s77, s7
    s_add_u32 s2, s2, 0x1c0000
    v_bfe_u32 v2, v1, 0, 2
    v_lshlrev_b32 v2, 21, v2
    v_bfe_u32 v3, v1, 2, 1
    v_lshl_or_b32 v2, v3, 13, v2
    s_cmp_lg_u32 s58, 4
    s_cbranch_scc1 arm_done_5
    buffer_store_dword v14, v2, s[8:11], s2 offen sc1
arm_done_5:
    v_bfe_u32 v2, v1, 0, 1
    v_lshlrev_b32 v2, 11, v2
    v_bfe_u32 v3, v1, 2, 2
    v_lshl_or_b32 v2, v3, 12, v2
    v_bfe_u32 v3, v1, 1, 1
    v_lshl_or_b32 v2, v3, 8, v2
    v_bfe_u32 v3, v1, 4, 2
    v_lshl_or_b32 v2, v3, 4, v2
    s_lshl_b32 s70, s64, 9
    s_lshl_b32 s71, s67, 6
    s_add_u32 s70, s70, s71
    buffer_load_dwordx4 v[10:13], v2, s[40:43], s70 offen
    v_bfe_u32 v2, v1, 4, 1
    v_lshlrev_b32 v2, 4, v2
    v_bfe_u32 v3, v1, 5, 1
    v_lshl_or_b32 v2, v3, 6, v2
    v_bfe_u32 v3, v1, 4, 2
    v_lshl_or_b32 v2, v3, 13, v2
    v_lshlrev_b32 v3, 4, v6
    v_xor_b32 v38, v2, v3
    v_xor_b32 v39, 0x80, v38
    v_bfe_u32 v2, v1, 5, 1
    v_lshlrev_b32 v2, 5, v2
    v_bfe_u32 v3, v1, 5, 1
    v_lshl_or_b32 v2, v3, 11, v2
    v_bfe_u32 v3, v1, 0, 5
    v_lshlrev_b32 v3, 4, v3
    v_xor_b32 v40, v2, v3
    s_lshl_b32 s71, s67, 6
    v_bfe_u32 v4, v1, 0, 1
    v_lshlrev_b32 v4, 3, v4
    v_bfe_u32 v2, v1, 2, 1
    v_lshl_or_b32 v4, v2, 4, v4
    v_bfe_u32 v2, v1, 1, 1
    v_lshl_or_b32 v4, v2, 5, v4
    v_bfe_u32 v2, v1, 5, 1
    v_lshl_or_b32 v4, v2, 7, v4
    v_bfe_u32 v2, v1, 2, 1
    v_lshl_or_b32 v4, v2, 8, v4
    v_bfe_u32 v2, v1, 4, 2
    v_lshl_or_b32 v4, v2, 10, v4
    v_bfe_u32 v2, v1, 3, 1
    v_lshl_or_b32 v4, v2, 15, v4
    s_lshl_b32 s70, s58, 13
    s_cmp_ge_u32 s58, 4
    s_cselect_b32 s70, 0, s70
    s_or_b32 s70, s70, s71
    v_xor_b32 v41, s70, v4
    v_bfe_u32 v4, v1, 0, 1
    v_lshlrev_b32 v4, 3, v4
    v_bfe_u32 v2, v1, 1, 1
    v_lshl_or_b32 v4, v2, 4, v4
    v_bfe_u32 v2, v1, 2, 1
    v_lshl_or_b32 v4, v2, 5, v4
    v_bfe_u32 v2, v1, 5, 1
    v_lshl_or_b32 v4, v2, 7, v4
    v_bfe_u32 v2, v1, 2, 1
    v_lshl_or_b32 v4, v2, 9, v4
    v_bfe_u32 v2, v1, 5, 1
    v_lshl_or_b32 v4, v2, 11, v4
    v_bfe_u32 v2, v1, 4, 1
    v_lshl_or_b32 v4, v2, 12, v4
    v_bfe_u32 v2, v1, 3, 1
    v_lshl_or_b32 v4, v2, 14, v4
    s_or_b32 s71, s71, 0x10000
    v_xor_b32 v42, s71, v4
    s_lshl_b32 s70, s64, 21
    s_lshl_b32 s71, s58, 18
    s_add_u32 s70, s70, s71
    s_lshl_b32 s71, s66, 8
    s_add_u32 s70, s70, s71
    s_lshl_b32 s71, s58, 13
    s_add_u32 s71, s71, 0
    s_mov_b32 m0, s71
    s_nop 0
    buffer_load_dwordx4 v38, s[24:27], s70 offen lds
    s_add_u32 s71, s71, 0x400
    s_add_u32 s70, s70, 0x8000
    s_mov_b32 m0, s71
    s_nop 0
    buffer_load_dwordx4 v38, s[24:27], s70 offen lds
    s_add_u32 s71, s71, 0x400
    s_add_u32 s70, s70, 0x8000
    s_mov_b32 m0, s71
    s_nop 0
    buffer_load_dwordx4 v39, s[24:27], s70 offen lds
    s_add_u32 s71, s71, 0x400
    s_add_u32 s70, s70, 0x8000
    s_mov_b32 m0, s71
    s_nop 0
    buffer_load_dwordx4 v39, s[24:27], s70 offen lds
    s_add_u32 s71, s71, 0x400
    s_add_u32 s70, s70, 0x8000
    s_mov_b32 m0, s71
    s_nop 0
    buffer_load_dwordx4 v38, s[24:27], s70 offen lds
    s_add_u32 s71, s71, 0x400
    s_add_u32 s70, s70, 0x8000
    s_mov_b32 m0, s71
    s_nop 0
    buffer_load_dwordx4 v38, s[24:27], s70 offen lds
    s_add_u32 s71, s71, 0x400
    s_add_u32 s70, s70, 0x8000
    s_mov_b32 m0, s71
    s_nop 0
    buffer_load_dwordx4 v39, s[24:27], s70 offen lds
    s_add_u32 s71, s71, 0x400
    s_add_u32 s70, s70, 0x8000
    s_mov_b32 m0, s71
    s_nop 0
    buffer_load_dwordx4 v39, s[24:27], s70 offen lds
    s_add_u32 s71, s71, 0x400
    s_add_u32 s70, s70, 0x8000
    s_lshl_b32 s70, s64, 21
    s_lshl_b32 s71, s58, 18
    s_add_u32 s70, s70, s71
    s_lshl_b32 s71, s66, 8
    s_add_u32 s70, s70, s71
    s_lshl_b32 s71, s58, 13
    s_add_u32 s71, s71, 65536
    s_mov_b32 m0, s71
    s_nop 0
    buffer_load_dwordx4 v38, s[28:31], s70 offen lds
    s_add_u32 s71, s71, 0x400
    s_add_u32 s70, s70, 0x8000
    s_mov_b32 m0, s71
    s_nop 0
    buffer_load_dwordx4 v38, s[28:31], s70 offen lds
    s_add_u32 s71, s71, 0x400
    s_add_u32 s70, s70, 0x8000
    s_mov_b32 m0, s71
    s_nop 0
    buffer_load_dwordx4 v39, s[28:31], s70 offen lds
    s_add_u32 s71, s71, 0x400
    s_add_u32 s70, s70, 0x8000
    s_mov_b32 m0, s71
    s_nop 0
    buffer_load_dwordx4 v39, s[28:31], s70 offen lds
    s_add_u32 s71, s71, 0x400
    s_add_u32 s70, s70, 0x8000
    s_mov_b32 m0, s71
    s_nop 0
    buffer_load_dwordx4 v38, s[28:31], s70 offen lds
    s_add_u32 s71, s71, 0x400
    s_add_u32 s70, s70, 0x8000
    s_mov_b32 m0, s71
    s_nop 0
    buffer_load_dwordx4 v38, s[28:31], s70 offen lds
    s_add_u32 s71, s71, 0x400
    s_add_u32 s70, s70, 0x8000
    s_mov_b32 m0, s71
    s_nop 0
    buffer_load_dwordx4 v39, s[28:31], s70 offen lds
    s_add_u32 s71, s71, 0x400
    s_add_u32 s70, s70, 0x8000
    s_mov_b32 m0, s71
    s_nop 0
    buffer_load_dwordx4 v39, s[28:31], s70 offen lds
    s_add_u32 s71, s71, 0x400
    s_add_u32 s70, s70, 0x8000
    s_cmp_lg_u32 s58, 4
    s_cbranch_scc1 novote_6
    s_waitcnt vmcnt(16)
    s_mov_b32 s3, 1
    s_mov_b32 s59, 0
    s_bitcmp1_b32 s57, 0
    s_cselect_b32 s60, -1, 1
    s_cselect_b32 s70, 0x2000, 0
    s_cselect_b32 s71, 0, 0x2000
    s_add_u32 s70, s70, s2
    s_add_u32 s71, s71, s2
    s_mov_b64 s[4:5], 0
    s_buffer_load_dword s4, s[8:11], s70
    s_buffer_load_dword s5, s[8:11], s71
    s_waitcnt lgkmcnt(1)
    s_sub_u32 s72, s4, s5
    s_waitcnt lgkmcnt(0)
    s_mul_i32 s72, s72, s60
    s_add_u32 s72, s72, 1
    s_min_u32 s72, s72, 2
    s_lshl_b32 s72, s72, 10
    s_add_u32 s3, s3, s72
    s_add_u32 s70, s70, 0x200000
    s_add_u32 s71, s71, 0x200000
    s_mov_b64 s[4:5], 0
    s_buffer_load_dword s4, s[8:11], s70
    s_buffer_load_dword s5, s[8:11], s71
    s_waitcnt lgkmcnt(1)
    s_sub_u32 s72, s4, s5
    s_waitcnt lgkmcnt(0)
    s_mul_i32 s72, s72, s60
    s_add_u32 s72, s72, 1
    s_min_u32 s72, s72, 2
    s_lshl_b32 s72, s72, 20
    s_add_u32 s3, s3, s72
    s_add_u32 s70, s70, 0x200000
    s_add_u32 s71, s71, 0x200000
    s_mov_b64 s[4:5], 0
    s_buffer_load_dword s4, s[8:11], s70
    s_buffer_load_dword s5, s[8:11], s71
    s_waitcnt lgkmcnt(1)
    s_sub_u32 s72, s4, s5
    s_waitcnt lgkmcnt(0)
    s_mul_i32 s72, s72, s60
    s_add_u32 s72, s72, 1
    s_min_u32 s72, s72, 2
    s_lshl_b32 s72, s72, 10
    s_add_u32 s59, s59, s72
    s_add_u32 s70, s70, 0x200000
    s_add_u32 s71, s71, 0x200000
    s_mov_b64 s[4:5], 0
    s_buffer_load_dword s4, s[8:11], s70
    s_buffer_load_dword s5, s[8:11], s71
    s_waitcnt lgkmcnt(1)
    s_sub_u32 s72, s4, s5
    s_waitcnt lgkmcnt(0)
    s_mul_i32 s72, s72, s60
    s_add_u32 s72, s72, 1
    s_min_u32 s72, s72, 2
    s_lshl_b32 s72, s72, 20
    s_add_u32 s59, s59, s72
    s_add_u32 s70, s70, 0x200000
    s_add_u32 s71, s71, 0x200000
novote_6:
    s_waitcnt vmcnt(0)
    s_barrier
    s_cmp_lg_u32 s58, 4
    s_cbranch_scc1 nosig_7
    v_mov_b32 v2, s3
    v_mov_b32 v3, s59
    v_cmp_eq_u32 vcc, 0, v1
    v_mov_b32 v5, 32
    v_mov_b32 v4, 0x5ffffff0
    v_cndmask_b32 v4, v4, v5, vcc
    buffer_atomic_add_x2 v[2:3], v4, s[12:15], 0 offen sc1
nosig_7:
    s_cmp_ge_u32 s58, 4
    s_cbranch_scc1 skip_8
    v_xor_b32 v2, 0x0, v41
    v_xor_b32 v3, 0x40, v41
    ds_read_b64_tr_b16 v[192:193], v2 offset:0
    ds_read_b64_tr_b16 v[194:195], v3 offset:512
    ds_read_b64_tr_b16 v[196:197], v2 offset:4096
    ds_read_b64_tr_b16 v[198:199], v3 offset:4608
    v_xor_b32 v2, 0x2000, v41
    v_xor_b32 v3, 0x2040, v41
    ds_read_b64_tr_b16 v[200:201], v2 offset:0
    ds_read_b64_tr_b16 v[202:203], v3 offset:512
    ds_read_b64_tr_b16 v[204:205], v2 offset:4096
    ds_read_b64_tr_b16 v[206:207], v3 offset:4608
    v_xor_b32 v2, 0x4000, v41
    v_xor_b32 v3, 0x4040, v41
    ds_read_b64_tr_b16 v[208:209], v2 offset:0
    ds_read_b64_tr_b16 v[210:211], v3 offset:512
    ds_read_b64_tr_b16 v[212:213], v2 offset:4096
    ds_read_b64_tr_b16 v[214:215], v3 offset:4608
    v_xor_b32 v2, 0x6000, v41
    v_xor_b32 v3, 0x6040, v41
    ds_read_b64_tr_b16 v[216:217], v2 offset:0
    ds_read_b64_tr_b16 v[218:219], v3 offset:512
    ds_read_b64_tr_b16 v[220:221], v2 offset:4096
    ds_read_b64_tr_b16 v[222:223], v3 offset:4608
    s_waitcnt lgkmcnt(0)
    v_xor_b32 v2, 0x10, v41
    v_xor_b32 v3, 0x50, v41
    ds_read_b64_tr_b16 v[224:225], v2 offset:0
    ds_read_b64_tr_b16 v[226:227], v3 offset:512
    ds_read_b64_tr_b16 v[228:229], v2 offset:4096
    ds_read_b64_tr_b16 v[230:231], v3 offset:4608
    v_xor_b32 v2, 0x2010, v41
    v_xor_b32 v3, 0x2050, v41
    ds_read_b64_tr_b16 v[232:233], v2 offset:0
    ds_read_b64_tr_b16 v[234:235], v3 offset:512
    ds_read_b64_tr_b16 v[236:237], v2 offset:4096
    ds_read_b64_tr_b16 v[238:239], v3 offset:4608
    v_xor_b32 v2, 0x4010, v41
    v_xor_b32 v3, 0x4050, v41
    ds_read_b64_tr_b16 v[240:241], v2 offset:0
    ds_read_b64_tr_b16 v[242:243], v3 offset:512
    ds_read_b64_tr_b16 v[244:245], v2 offset:4096
    ds_read_b64_tr_b16 v[246:247], v3 offset:4608
    v_xor_b32 v2, 0x6010, v41
    v_xor_b32 v3, 0x6050, v41
    ds_read_b64_tr_b16 v[248:249], v2 offset:0
    ds_read_b64_tr_b16 v[250:251], v3 offset:512
    ds_read_b64_tr_b16 v[252:253], v2 offset:4096
    ds_read_b64_tr_b16 v[254:255], v3 offset:4608
    s_waitcnt lgkmcnt(0)
skip_8:
    s_cmp_ge_u32 s58, 4
    s_cbranch_scc0 skip_9
    v_xor_b32 v2, 0x10000, v41
    v_xor_b32 v3, 0x10040, v41
    ds_read_b64_tr_b16 v[128:129], v2 offset:0
    ds_read_b64_tr_b16 v[130:131], v3 offset:512
    ds_read_b64_tr_b16 v[132:133], v2 offset:4096
    ds_read_b64_tr_b16 v[134:135], v3 offset:4608
    v_xor_b32 v2, 0x12000, v41
    v_xor_b32 v3, 0x12040, v41
    ds_read_b64_tr_b16 v[136:137], v2 offset:0
    ds_read_b64_tr_b16 v[138:139], v3 offset:512
    ds_read_b64_tr_b16 v[140:141], v2 offset:4096
    ds_read_b64_tr_b16 v[142:143], v3 offset:4608
    v_xor_b32 v2, 0x14000, v41
    v_xor_b32 v3, 0x14040, v41
    ds_read_b64_tr_b16 v[144:145], v2 offset:0
    ds_read_b64_tr_b16 v[146:147], v3 offset:512
    ds_read_b64_tr_b16 v[148:149], v2 offset:4096
    ds_read_b64_tr_b16 v[150:151], v3 offset:4608
    v_xor_b32 v2, 0x16000, v41
    v_xor_b32 v3, 0x16040, v41
    ds_read_b64_tr_b16 v[152:153], v2 offset:0
    ds_read_b64_tr_b16 v[154:155], v3 offset:512
    ds_read_b64_tr_b16 v[156:157], v2 offset:4096
    ds_read_b64_tr_b16 v[158:159], v3 offset:4608
    s_waitcnt lgkmcnt(0)
    v_xor_b32 v2, 0x10010, v41
    v_xor_b32 v3, 0x10050, v41
    ds_read_b64_tr_b16 v[160:161], v2 offset:0
    ds_read_b64_tr_b16 v[162:163], v3 offset:512
    ds_read_b64_tr_b16 v[164:165], v2 offset:4096
    ds_read_b64_tr_b16 v[166:167], v3 offset:4608
    v_xor_b32 v2, 0x12010, v41
    v_xor_b32 v3, 0x12050, v41
    ds_read_b64_tr_b16 v[168:169], v2 offset:0
    ds_read_b64_tr_b16 v[170:171], v3 offset:512
    ds_read_b64_tr_b16 v[172:173], v2 offset:4096
    ds_read_b64_tr_b16 v[174:175], v3 offset:4608
    v_xor_b32 v2, 0x14010, v41
    v_xor_b32 v3, 0x14050, v41
    ds_read_b64_tr_b16 v[176:177], v2 offset:0
    ds_read_b64_tr_b16 v[178:179], v3 offset:512
    ds_read_b64_tr_b16 v[180:181], v2 offset:4096
    ds_read_b64_tr_b16 v[182:183], v3 offset:4608
    v_xor_b32 v2, 0x16010, v41
    v_xor_b32 v3, 0x16050, v41
    ds_read_b64_tr_b16 v[184:185], v2 offset:0
    ds_read_b64_tr_b16 v[186:187], v3 offset:512
    ds_read_b64_tr_b16 v[188:189], v2 offset:4096
    ds_read_b64_tr_b16 v[190:191], v3 offset:4608
    s_waitcnt lgkmcnt(0)
skip_9:
    s_barrier
    s_lshl_b32 s70, s64, 21
    s_lshl_b32 s71, s58, 18
    s_add_u32 s70, s70, s71
    s_lshl_b32 s71, s66, 8
    s_add_u32 s70, s70, s71
    s_lshl_b32 s71, s58, 13
    s_add_u32 s71, s71, 0
    s_mov_b32 m0, s71
    s_nop 0
    buffer_load_dwordx4 v38, s[20:23], s70 offen lds
    s_add_u32 s71, s71, 0x400
    s_add_u32 s70, s70, 0x8000
    s_mov_b32 m0, s71
    s_nop 0
    buffer_load_dwordx4 v38, s[20:23], s70 offen lds
    s_add_u32 s71, s71, 0x400
    s_add_u32 s70, s70, 0x8000
    s_mov_b32 m0, s71
    s_nop 0
    buffer_load_dwordx4 v39, s[20:23], s70 offen lds
    s_add_u32 s71, s71, 0x400
    s_add_u32 s70, s70, 0x8000
    s_mov_b32 m0, s71
    s_nop 0
    buffer_load_dwordx4 v39, s[20:23], s70 offen lds
    s_add_u32 s71, s71, 0x400
    s_add_u32 s70, s70, 0x8000
    s_mov_b32 m0, s71
    s_nop 0
    buffer_load_dwordx4 v38, s[20:23], s70 offen lds
    s_add_u32 s71, s71, 0x400
    s_add_u32 s70, s70, 0x8000
    s_mov_b32 m0, s71
    s_nop 0
    buffer_load_dwordx4 v38, s[20:23], s70 offen lds
    s_add_u32 s71, s71, 0x400
    s_add_u32 s70, s70, 0x8000
    s_mov_b32 m0, s71
    s_nop 0
    buffer_load_dwordx4 v39, s[20:23], s70 offen lds
    s_add_u32 s71, s71, 0x400
    s_add_u32 s70, s70, 0x8000
    s_mov_b32 m0, s71
    s_nop 0
    buffer_load_dwordx4 v39, s[20:23], s70 offen lds
    s_add_u32 s71, s71, 0x400
    s_add_u32 s70, s70, 0x8000
    s_lshl_b32 s70, s66, 18
    s_lshl_b32 s71, s58, 15
    s_add_u32 s70, s70, s71
    s_lshl_b32 s71, s64, 9
    s_add_u32 s70, s70, s71
    s_lshl_b32 s71, s58, 13
    s_add_u32 s71, s71, 65536
    v_xor_b32 v2, 0, v40
    s_mov_b32 m0, s71
    s_nop 0
    buffer_load_dwordx4 v2, s[32:35], s70 offen lds
    s_add_u32 s71, s71, 0x400
    s_add_u32 s70, s70, 0x1000
    v_xor_b32 v2, 64, v40
    s_mov_b32 m0, s71
    s_nop 0
    buffer_load_dwordx4 v2, s[32:35], s70 offen lds
    s_add_u32 s71, s71, 0x400
    s_add_u32 s70, s70, 0x1000
    v_xor_b32 v2, 128, v40
    s_mov_b32 m0, s71
    s_nop 0
    buffer_load_dwordx4 v2, s[32:35], s70 offen lds
    s_add_u32 s71, s71, 0x400
    s_add_u32 s70, s70, 0x1000
    v_xor_b32 v2, 192, v40
    s_mov_b32 m0, s71
    s_nop 0
    buffer_load_dwordx4 v2, s[32:35], s70 offen lds
    s_add_u32 s71, s71, 0x400
    s_add_u32 s70, s70, 0x1000
    v_xor_b32 v2, 0, v40
    s_mov_b32 m0, s71
    s_nop 0
    buffer_load_dwordx4 v2, s[32:35], s70 offen lds
    s_add_u32 s71, s71, 0x400
    s_add_u32 s70, s70, 0x1000
    v_xor_b32 v2, 64, v40
    s_mov_b32 m0, s71
    s_nop 0
    buffer_load_dwordx4 v2, s[32:35], s70 offen lds
    s_add_u32 s71, s71, 0x400
    s_add_u32 s70, s70, 0x1000
    v_xor_b32 v2, 128, v40
    s_mov_b32 m0, s71
    s_nop 0
    buffer_load_dwordx4 v2, s[32:35], s70 offen lds
    s_add_u32 s71, s71, 0x400
    s_add_u32 s70, s70, 0x1000
    v_xor_b32 v2, 192, v40
    s_mov_b32 m0, s71
    s_nop 0
    buffer_load_dwordx4 v2, s[32:35], s70 offen lds
    s_add_u32 s71, s71, 0x400
    s_add_u32 s70, s70, 0x1000
    s_waitcnt vmcnt(0)
    s_barrier
    s_cmp_ge_u32 s58, 4
    s_cbranch_scc1 skip_10
    v_xor_b32 v2, 0x0, v41
    v_xor_b32 v3, 0x40, v41
    ds_read_b64_tr_b16 v[128:129], v2 offset:0
    ds_read_b64_tr_b16 v[130:131], v3 offset:512
    ds_read_b64_tr_b16 v[132:133], v2 offset:4096
    ds_read_b64_tr_b16 v[134:135], v3 offset:4608
    v_xor_b32 v2, 0x2000, v41
    v_xor_b32 v3, 0x2040, v41
    ds_read_b64_tr_b16 v[136:137], v2 offset:0
    ds_read_b64_tr_b16 v[138:139], v3 offset:512
    ds_read_b64_tr_b16 v[140:141], v2 offset:4096
    ds_read_b64_tr_b16 v[142:143], v3 offset:4608
    v_xor_b32 v2, 0x4000, v41
    v_xor_b32 v3, 0x4040, v41
    ds_read_b64_tr_b16 v[144:145], v2 offset:0
    ds_read_b64_tr_b16 v[146:147], v3 offset:512
    ds_read_b64_tr_b16 v[148:149], v2 offset:4096
    ds_read_b64_tr_b16 v[150:151], v3 offset:4608
    v_xor_b32 v2, 0x6000, v41
    v_xor_b32 v3, 0x6040, v41
    ds_read_b64_tr_b16 v[152:153], v2 offset:0
    ds_read_b64_tr_b16 v[154:155], v3 offset:512
    ds_read_b64_tr_b16 v[156:157], v2 offset:4096
    ds_read_b64_tr_b16 v[158:159], v3 offset:4608
    s_waitcnt lgkmcnt(0)
    v_xor_b32 v2, 0x10, v41
    v_xor_b32 v3, 0x50, v41
    ds_read_b64_tr_b16 v[160:161], v2 offset:0
    ds_read_b64_tr_b16 v[162:163], v3 offset:512
    ds_read_b64_tr_b16 v[164:165], v2 offset:4096
    ds_read_b64_tr_b16 v[166:167], v3 offset:4608
    v_xor_b32 v2, 0x2010, v41
    v_xor_b32 v3, 0x2050, v41
    ds_read_b64_tr_b16 v[168:169], v2 offset:0
    ds_read_b64_tr_b16 v[170:171], v3 offset:512
    ds_read_b64_tr_b16 v[172:173], v2 offset:4096
    ds_read_b64_tr_b16 v[174:175], v3 offset:4608
    v_xor_b32 v2, 0x4010, v41
    v_xor_b32 v3, 0x4050, v41
    ds_read_b64_tr_b16 v[176:177], v2 offset:0
    ds_read_b64_tr_b16 v[178:179], v3 offset:512
    ds_read_b64_tr_b16 v[180:181], v2 offset:4096
    ds_read_b64_tr_b16 v[182:183], v3 offset:4608
    v_xor_b32 v2, 0x6010, v41
    v_xor_b32 v3, 0x6050, v41
    ds_read_b64_tr_b16 v[184:185], v2 offset:0
    ds_read_b64_tr_b16 v[186:187], v3 offset:512
    ds_read_b64_tr_b16 v[188:189], v2 offset:4096
    ds_read_b64_tr_b16 v[190:191], v3 offset:4608
    s_waitcnt lgkmcnt(0)
skip_10:
    s_cmp_ge_u32 s58, 4
    s_cbranch_scc0 skip_11
    v_xor_b32 v2, 0, v42
    v_xor_b32 v3, 64, v42
    ds_read_b64_tr_b16 v[192:193], v2 offset:0
    ds_read_b64_tr_b16 v[194:195], v3 offset:1024
    ds_read_b64_tr_b16 v[196:197], v2 offset:8192
    ds_read_b64_tr_b16 v[198:199], v3 offset:9216
    ds_read_b64_tr_b16 v[200:201], v2 offset:32768
    ds_read_b64_tr_b16 v[202:203], v3 offset:33792
    ds_read_b64_tr_b16 v[204:205], v2 offset:40960
    ds_read_b64_tr_b16 v[206:207], v3 offset:41984
    ds_read_b64_tr_b16 v[224:225], v2 offset:256
    ds_read_b64_tr_b16 v[226:227], v3 offset:1280
    ds_read_b64_tr_b16 v[228:229], v2 offset:8448
    ds_read_b64_tr_b16 v[230:231], v3 offset:9472
    ds_read_b64_tr_b16 v[232:233], v2 offset:33024
    ds_read_b64_tr_b16 v[234:235], v3 offset:34048
    ds_read_b64_tr_b16 v[236:237], v2 offset:41216
    ds_read_b64_tr_b16 v[238:239], v3 offset:42240
    s_waitcnt lgkmcnt(0)
    v_xor_b32 v2, 32, v42
    v_xor_b32 v3, 96, v42
    ds_read_b64_tr_b16 v[208:209], v2 offset:0
    ds_read_b64_tr_b16 v[210:211], v3 offset:1024
    ds_read_b64_tr_b16 v[212:213], v2 offset:8192
    ds_read_b64_tr_b16 v[214:215], v3 offset:9216
    ds_read_b64_tr_b16 v[216:217], v2 offset:32768
    ds_read_b64_tr_b16 v[218:219], v3 offset:33792
    ds_read_b64_tr_b16 v[220:221], v2 offset:40960
    ds_read_b64_tr_b16 v[222:223], v3 offset:41984
    ds_read_b64_tr_b16 v[240:241], v2 offset:256
    ds_read_b64_tr_b16 v[242:243], v3 offset:1280
    ds_read_b64_tr_b16 v[244:245], v2 offset:8448
    ds_read_b64_tr_b16 v[246:247], v3 offset:9472
    ds_read_b64_tr_b16 v[248:249], v2 offset:33024
    ds_read_b64_tr_b16 v[250:251], v3 offset:34048
    ds_read_b64_tr_b16 v[252:253], v2 offset:41216
    ds_read_b64_tr_b16 v[254:255], v3 offset:42240
    s_waitcnt lgkmcnt(0)
skip_11:
    v_mov_b32 v4, 0x27ff0
    s_cmp_lg_u32 s58, 4
    s_cbranch_scc1 armw_12
armwait_13:
    buffer_load_dwordx2 v[2:3], off, s[12:15], 0 offset:32 sc1
    s_waitcnt vmcnt(0)
    v_and_b32 v5, 0x3ff, v2
    v_cmp_gt_u32 vcc, 128, v5
    s_cbranch_vccz armwait_ok_14
    s_sub_u32 s69, s69, 1
    s_cbranch_scc0 armwait_13
    s_mov_b32 s69, 0
armwait_ok_14:
    ds_write_b64 v4, v[2:3]
    s_waitcnt lgkmcnt(0)
armw_12:
    s_barrier
    ds_read_b64 v[2:3], v4
    s_mov_b32 s59, 0
    s_waitcnt lgkmcnt(0)
    v_readfirstlane_b32 s70, v2
    v_readfirstlane_b32 s71, v3
    s_bfe_u32 s72, s70, 0xa000a
    s_cmp_gt_u32 s72, 128
    s_cselect_b32 s72, 1, 0
    s_or_b32 s59, s59, s72
    s_bfe_u32 s72, s70, 0xa0014
    s_cmp_gt_u32 s72, 128
    s_cselect_b32 s72, 2, 0
    s_or_b32 s59, s59, s72
    s_bfe_u32 s72, s71, 0xa000a
    s_cmp_gt_u32 s72, 128
    s_cselect_b32 s72, 4, 0
    s_or_b32 s59, s59, s72
    s_bfe_u32 s72, s71, 0xa0014
    s_cmp_gt_u32 s72, 128
    s_cselect_b32 s72, 8, 0
    s_or_b32 s59, s59, s72
    s_and_b32 s70, s59, 1
    s_lshl_b32 s70, s70, 13
    s_add_u32 s77, s77, s70
    s_add_u32 s76, s76, s70
    s_mov_b32 s68, 0
    s_mov_b32 s82, 0
    s_lshl_b32 s80, s66, 11
    s_lshl_b32 s70, s67, 9
    s_add_u32 s80, s80, s70
    s_cmp_ge_u32 s58, 4
    s_cbranch_scc1 vo_main_15
    s_setprio 3
    v_bfe_u32 v111, v1, 0, 3
    v_lshlrev_b32 v111, 4, v111
    v_bfe_u32 v2, v1, 3, 1
    v_lshl_or_b32 v111, v2, 8, v111
    v_bfe_u32 v2, v1, 4, 2
    v_lshl_or_b32 v111, v2, 9, v111
    s_lshl_b32 s75, s66, 13
    s_lshl_b32 s70, s67, 11
    s_add_u32 s75, s75, s70
    s_add_u32 s75, s75, 0x1000000
    s_add_u32 s78, s70, 13312
    v_mov_b32 v113, 128
    s_mov_b32 s2, 128
    s_lshl_b32 s70, s66, 4
    s_lshl_b32 s71, s64, 2
    s_add_u32 s71, s71, s67
    s_add_u32 s3, s70, s71
    s_add_u32 s80, s80, 0x4000000
    s_lshl_b32 s70, s67, 10
    v_add_u32 v108, s70, v8
    v_lshrrev_b32 v109, 2, v108
    v_bfe_u32 v2, v1, 0, 3
    v_lshlrev_b32 v2, 4, v2
    v_bfe_u32 v3, v1, 4, 2
    v_lshl_or_b32 v2, v3, 7, v2
    v_mov_b32 v3, 0x5ffffff0
    v_cmp_le_u32 vcc, 8, v6
    s_nop 1
    v_cndmask_b32 v110, v3, v2, vcc
    v_xor_b32 v106, 1024, v108
    v_xor_b32 v107, 2048, v108
    v_xor_b32 v36, 3072, v108
    v_xor_b32 v116, 0x400, v34
    v_bfe_u32 v115, v1, 0, 4
    v_lshlrev_b32 v115, 4, v115
    v_bfe_u32 v2, v1, 4, 2
    v_lshl_or_b32 v115, v2, 9, v115
    s_lshl_b32 s70, s64, 10
    s_xor_b32 s70, s70, 0x800
    v_xor_b32 v115, s70, v115
    v_and_b32 v2, 1, v1
    v_lshlrev_b32 v2, 4, v2
    v_mov_b32 v3, 0x3f80
    v_lshlrev_b32 v2, v2, v3
    v_bfe_u32 v3, v1, 1, 1
    v_bfe_u32 v4, v1, 3, 1
    v_lshl_or_b32 v3, v4, 1, v3
    v_bfe_u32 v4, v1, 2, 1
    v_lshl_or_b32 v3, v4, 2, v3
    v_bfe_u32 v4, v1, 4, 1
    v_lshlrev_b32 v4, 2, v4
    v_xor_b32 v3, v3, v4
    v_cmp_eq_u32 vcc, 0, v3
    s_nop 1
    v_cndmask_b32 v26, 0, v2, vcc
    v_cmp_eq_u32 vcc, 1, v3
    s_nop 1
    v_cndmask_b32 v27, 0, v2, vcc
    v_cmp_eq_u32 vcc, 2, v3
    s_nop 1
    v_cndmask_b32 v28, 0, v2, vcc
    v_cmp_eq_u32 vcc, 3, v3
    s_nop 1
    v_cndmask_b32 v29, 0, v2, vcc
    v_bfe_u32 v3, v1, 1, 1
    v_bfe_u32 v4, v1, 3, 1
    v_lshl_or_b32 v3, v4, 1, v3
    v_bfe_u32 v4, v1, 4, 1
    v_lshl_or_b32 v3, v4, 2, v3
    v_bfe_u32 v4, v1, 2, 1
    v_lshl_or_b32 v3, v4, 3, v3
    v_bfe_u32 v4, v1, 5, 1
    v_lshlrev_b32 v4, 3, v4
    v_xor_b32 v3, v3, v4
    v_cmp_eq_u32 vcc, 0, v3
    s_nop 1
    v_cndmask_b32 v98, 0, v2, vcc
    v_cmp_eq_u32 vcc, 1, v3
    s_nop 1
    v_cndmask_b32 v99, 0, v2, vcc
    v_cmp_eq_u32 vcc, 2, v3
    s_nop 1
    v_cndmask_b32 v100, 0, v2, vcc
    v_cmp_eq_u32 vcc, 3, v3
    s_nop 1
    v_cndmask_b32 v101, 0, v2, vcc
    v_cmp_eq_u32 vcc, 4, v3
    s_nop 1
    v_cndmask_b32 v102, 0, v2, vcc
    v_cmp_eq_u32 vcc, 5, v3
    s_nop 1
    v_cndmask_b32 v103, 0, v2, vcc
    v_cmp_eq_u32 vcc, 6, v3
    s_nop 1
    v_cndmask_b32 v104, 0, v2, vcc
    v_cmp_eq_u32 vcc, 7, v3
    s_nop 1
    v_cndmask_b32 v105, 0, v2, vcc
    v_bfe_u32 v3, v1, 2, 1
    v_bfe_u32 v4, v1, 1, 1
    v_lshl_or_b32 v3, v4, 1, v3
    v_bfe_u32 v4, v1, 3, 1
    v_lshl_or_b32 v3, v4, 2, v3
    v_bfe_u32 v4, v1, 4, 1
    v_lshlrev_b32 v4, 2, v4
    v_xor_b32 v3, v3, v4
    v_cmp_eq_u32 vcc, 0, v3
    s_nop 1
    v_cndmask_b32 v30, 0, v2, vcc
    v_cmp_eq_u32 vcc, 1, v3
    s_nop 1
    v_cndmask_b32 v31, 0, v2, vcc
    v_cmp_eq_u32 vcc, 2, v3
    s_nop 1
    v_cndmask_b32 v32, 0, v2, vcc
    v_cmp_eq_u32 vcc, 3, v3
    s_nop 1
    v_cndmask_b32 v33, 0, v2, vcc
    v_mov_b32 v38, 0
    v_mov_b32 v39, 0
    v_mov_b32 v40, 0
    v_mov_b32 v41, 0
    v_mov_b32 v42, 0
    v_mov_b32 v43, 0
    v_mov_b32 v44, 0
    v_mov_b32 v45, 0
    v_mov_b32 v46, 0
    v_mov_b32 v47, 0
    v_mov_b32 v48, 0
    v_mov_b32 v49, 0
    v_mov_b32 v50, 0
    v_mov_b32 v51, 0
    v_mov_b32 v52, 0
    v_mov_b32 v53, 0
    s_barrier
    s_add_u32 s70, s75, 0x1000000
    s_mov_b32 m0, s78
    buffer_load_dwordx4 v[90:93], v111, s[8:11], s75 offen
    buffer_load_dwordx4 v111, s[8:11], s70 offen lds
    s_add_u32 m0, s78, 896
    buffer_load_dwordx4 v[94:97], v111, s[8:11], s75 offen offset:128
    buffer_load_dwordx4 v111, s[8:11], s70 offen offset:128 lds
    s_add_u32 s75, s75, 0x40000
    s_lshl_b32 s70, s64, 9
    s_add_u32 s70, s70, s75
    s_add_u32 s71, s70, 0x1000000
    s_buffer_load_dword s4, s[8:11], s70 offset:0
    s_buffer_load_dword s5, s[8:11], s71 offset:0
    s_buffer_load_dword s4, s[8:11], s70 offset:128
    s_buffer_load_dword s5, s[8:11], s71 offset:128
    s_buffer_load_dword s4, s[8:11], s70 offset:256
    s_buffer_load_dword s5, s[8:11], s71 offset:256
    s_buffer_load_dword s4, s[8:11], s70 offset:384
    s_buffer_load_dword s5, s[8:11], s71 offset:384
    s_waitcnt vmcnt(0)
qk_loop_17:
    ds_write_b128 v108, v[10:13] offset:0
    s_waitcnt lgkmcnt(0)
    s_barrier
    ds_read_b128 v[14:17], v106 offset:0
    ds_read_b128 v[18:21], v107 offset:0
    ds_read_b128 v[22:25], v36 offset:0
    v_smfmac_f32_16x16x64_bf16 v[38:41], v[10:13], v[128:135], v7
    v_smfmac_f32_16x16x64_bf16 v[42:45], v[10:13], v[160:167], v7
    v_smfmac_f32_16x16x64_bf16 v[46:49], v[10:13], v[192:199], v7
    v_smfmac_f32_16x16x64_bf16 v[50:53], v[10:13], v[224:231], v7
    s_waitcnt lgkmcnt(2)
    v_smfmac_f32_16x16x64_bf16 v[38:41], v[14:17], v[136:143], v7
    v_smfmac_f32_16x16x64_bf16 v[42:45], v[14:17], v[168:175], v7
    s_waitcnt lgkmcnt(1)
    v_smfmac_f32_16x16x64_bf16 v[38:41], v[18:21], v[144:151], v7
    v_smfmac_f32_16x16x64_bf16 v[42:45], v[18:21], v[176:183], v7
    s_waitcnt lgkmcnt(0)
    v_smfmac_f32_16x16x64_bf16 v[38:41], v[22:25], v[152:159], v7
    v_smfmac_f32_16x16x64_bf16 v[42:45], v[22:25], v[184:191], v7
    v_smfmac_f32_16x16x64_bf16 v[46:49], v[14:17], v[200:207], v7
    v_smfmac_f32_16x16x64_bf16 v[46:49], v[18:21], v[208:215], v7
    v_smfmac_f32_16x16x64_bf16 v[46:49], v[22:25], v[216:223], v7
    v_smfmac_f32_16x16x64_bf16 v[50:53], v[14:17], v[232:239], v7
    s_nop 1
    v_smfmac_f32_16x16x64_bf16 v[50:53], v[18:21], v[240:247], v7
    v_pk_add_f32 v[38:39], v[38:39], v[40:41]
    v_cvt_pk_bf16_f32 v86, v38, v39
    v_smfmac_f32_16x16x64_bf16 v[50:53], v[22:25], v[248:255], v7
    v_pk_add_f32 v[42:43], v[42:43], v[44:45]
    v_cvt_pk_bf16_f32 v87, v42, v43
    v_pk_add_f32 v[46:47], v[46:47], v[48:49]
    v_cvt_pk_bf16_f32 v88, v46, v47
    v_permlane16_swap_b32 v86, v87
    v_bfi_b32 v86, 1, s82, v86
    s_nop 1
    v_pk_add_f32 v[50:51], v[50:51], v[52:53]
    v_cvt_pk_bf16_f32 v89, v50, v51
    s_nop 1
    v_permlane16_swap_b32 v88, v89
    buffer_store_dwordx4 v[86:89], v34, s[8:11], s73 offen
    s_nop 15
    buffer_load_dwordx4 v[54:57], v116, s[8:11], s73 offen sc1
    buffer_load_dwordx4 v[58:61], v115, s[8:11], s73 offen sc1
    buffer_load_dwordx4 v[62:65], v115, s[8:11], s73 offen offset:256 sc1
    v_mfma_f32_16x16x32_bf16 v[78:81], v[86:89], v[98:101], 0
    v_mfma_f32_16x16x32_bf16 v[82:85], v[86:89], v[102:105], 0
    v_mov_b32 v38, 0
    v_mov_b32 v39, 0
    v_mov_b32 v40, 0
    v_mov_b32 v41, 0
    v_mov_b32 v42, 0
    v_mov_b32 v43, 0
    v_mov_b32 v44, 0
    v_mov_b32 v45, 0
    v_mov_b32 v46, 0
    v_mov_b32 v47, 0
    v_mov_b32 v48, 0
    v_mov_b32 v49, 0
    v_mov_b32 v50, 0
    v_mov_b32 v51, 0
    v_mov_b32 v52, 0
    v_mov_b32 v53, 0
    s_nop 15
    buffer_load_dwordx4 v[66:69], v116, s[8:11], s73 offen sc1
    buffer_load_dwordx4 v[70:73], v115, s[8:11], s73 offen sc1
    buffer_load_dwordx4 v[74:77], v115, s[8:11], s73 offen offset:256 sc1
    s_waitcnt vmcnt(5)
    v_mfma_f32_16x16x32_bf16 v[18:21], v[54:57], v[98:101], v[78:81]
    v_mfma_f32_16x16x32_bf16 v[22:25], v[54:57], v[102:105], v[82:85]
    s_waitcnt vmcnt(4)
    v_mfma_f32_16x16x32_bf16 v[18:21], v[58:61], v[26:29], v[18:21]
    s_waitcnt vmcnt(3)
    v_mfma_f32_16x16x32_bf16 v[22:25], v[62:65], v[26:29], v[22:25]
    v_bitop3_b32 v2, v54, v58, s82 bitop3:0x7e
    v_xor_b32 v3, s82, v62
    v_bitop3_b32 v2, v2, v3, 1 bitop3:0xa8
    v_cmp_ne_u32 vcc, 0, v2
    s_cbranch_vccnz x_s_18
x_j_19:
    s_nop 1
    v_cvt_pk_bf16_f32 v86, v18, v19
    v_cvt_pk_bf16_f32 v87, v20, v21
    v_cvt_pk_bf16_f32 v88, v22, v23
    v_cvt_pk_bf16_f32 v89, v24, v25
    s_nop 1
    v_mfma_f32_16x16x32_bf16 v[18:21], v[86:89], v[86:89], 0
    s_nop 1
    v_mfma_f32_16x16x32_bf16 v[14:17], v[94:97], v[86:89], 0
    s_nop 1
    v_mfma_f32_16x16x32_bf16 v[10:13], v[90:93], v[86:89], 0
    s_nop 1
    v_mov_b32_dpp v18, v20 row_shr:8 row_mask:0xf bank_mask:0xc
    v_mov_b32_dpp v19, v21 row_shr:8 row_mask:0xf bank_mask:0xc
    s_nop 1
    v_permlane32_swap_b32 v18, v19
    ds_write_b32 v109, v19 offset:8192
    v_mov_b32_dpp v10, v14 row_shr:8 row_mask:0xf bank_mask:0xc
    v_mov_b32_dpp v11, v15 row_shr:8 row_mask:0xf bank_mask:0xc
    v_mov_b32_dpp v12, v16 row_shr:8 row_mask:0xf bank_mask:0xc
    v_mov_b32_dpp v13, v17 row_shr:8 row_mask:0xf bank_mask:0xc
    ds_write_b128 v108, v[10:13] offset:4096
    s_and_b32 s72, s68, 3
    s_waitcnt lgkmcnt(0)
    s_barrier
    s_setprio 0
    s_cmp_lg_u32 s72, s64
    s_cbranch_scc1 nokm_20
    v_min_u32 v86, -2, v86
    buffer_store_dwordx4 v[86:89], v110, s[8:11], s80 offen sc1
nokm_20:
    s_cmp_eq_u32 s68, 63
    s_cbranch_scc1 chain_end_16
    s_cmp_lg_u32 s72, 3
    s_cbranch_scc1 kv7_22
    v_cmp_gt_u16 vcc, s2, v112
    s_cbranch_vccz kv8_23
kvw_26:
    buffer_load_dword v112, v113, s[12:15], 0 offen sc1
    s_waitcnt vmcnt(0)
    v_cmp_gt_u16 vcc, s2, v112
    s_cbranch_vccz kvw_ok_27
    s_sub_u32 s69, s69, 1
    s_cbranch_scc0 kvw_26
    s_mov_b32 s69, 0
kvw_ok_27:
kv8_23:
    s_cmp_ge_u32 s68, 19
    s_cselect_b32 s70, 32, 128
    s_min_u32 s2, s2, s70
kv7_22:
    s_add_u32 s70, s75, 0x1000000
    s_mov_b32 m0, s78
    buffer_load_dwordx4 v[90:93], v111, s[8:11], s75 offen
    buffer_load_dwordx4 v111, s[8:11], s70 offen lds
    s_add_u32 m0, s78, 896
    buffer_load_dwordx4 v[94:97], v111, s[8:11], s75 offen offset:128
    buffer_load_dwordx4 v111, s[8:11], s70 offen offset:128 lds
    s_add_u32 s75, s75, 0x40000
    v_mov_b32 v10, -1
    v_mov_b32 v11, -1
    v_mov_b32 v12, -1
    v_mov_b32 v13, -1
    buffer_store_dwordx4 v[10:13], v35, s[8:11], s77 offen sc1
    s_add_u32 s77, s77, 0x20000
    s_lshr_b32 s60, s77, 21
    s_bitcmp1_b32 s59, s60
    s_cselect_b32 s60, 0x2000, 0
    s_bitset0_b32 s77, 13
    s_or_b32 s77, s77, s60
    s_cmp_lg_u32 s3, 1
    s_cbranch_scc1 noprog_24
    v_mov_b32 v2, s68
    buffer_store_dword v2, off, s[12:15], 0 offset:64 sc1
noprog_24:
    s_cmp_lg_u32 s72, 1
    s_cbranch_scc1 kv6_21
    s_cmp_ge_u32 s68, 21
    s_cselect_b32 s70, -8, -4
    s_add_u32 s71, s68, 131
    s_and_b32 s70, s70, s71
    v_mov_b32 v113, s70
    buffer_load_dword v112, v113, s[12:15], 0 offen sc1
kv6_21:
    s_barrier
    s_add_u32 s80, s80, 0x10000
    s_cmp_lg_u32 s72, 2
    s_cbranch_scc1 pf_28
    v_cmp_gt_u16 vcc, s2, v112
    s_cbranch_vccnz nopf_29
pf_28:
    s_lshl_b32 s70, s64, 9
    s_add_u32 s70, s70, s75
    s_add_u32 s71, s70, 0x1000000
    s_buffer_load_dword s4, s[8:11], s70 offset:0
    s_buffer_load_dword s5, s[8:11], s71 offset:0
    s_buffer_load_dword s4, s[8:11], s70 offset:128
    s_buffer_load_dword s5, s[8:11], s71 offset:128
    s_buffer_load_dword s4, s[8:11], s70 offset:256
    s_buffer_load_dword s5, s[8:11], s71 offset:256
    s_buffer_load_dword s4, s[8:11], s70 offset:384
    s_buffer_load_dword s5, s[8:11], s71 offset:384
nopf_29:
    s_add_u32 s76, s76, 0x20000
    s_lshr_b32 s60, s76, 21
    s_bitcmp1_b32 s59, s60
    s_cselect_b32 s60, 0x2000, 0
    s_bitset0_b32 s76, 13
    s_or_b32 s76, s76, s60
    s_add_u32 s68, s68, 1
    s_bfe_u32 s82, s68, 0x10001
    s_xor_b32 s73, s73, 0x80000
    s_setprio 3
    s_barrier
    s_nop 15
    s_nop 15
    s_nop 15
    s_nop 15
    s_nop 15
    s_nop 15
    s_nop 15
    buffer_load_dwordx4 v[54:57], v37, s[8:11], s76 offen offset:0 sc1
    buffer_load_dwordx4 v[58:61], v37, s[8:11], s76 offen offset:1024 sc1
    buffer_load_dwordx4 v[62:65], v37, s[8:11], s76 offen offset:2048 sc1
    buffer_load_dwordx4 v[66:69], v37, s[8:11], s76 offen offset:3072 sc1
    s_waitcnt vmcnt(3)
    v_mfma_f32_16x16x32_bf16 v[78:81], v[54:57], v[30:33], 0
    s_waitcnt vmcnt(2)
    v_mfma_f32_16x16x32_bf16 v[78:81], v[58:61], v[30:33], v[78:81]
    s_waitcnt vmcnt(1)
    v_mfma_f32_16x16x32_bf16 v[82:85], v[62:65], v[30:33], 0
    s_waitcnt vmcnt(0)
    v_mfma_f32_16x16x32_bf16 v[82:85], v[66:69], v[30:33], v[82:85]
    v_max3_u32 v2, v54, v58, v62
    v_max_u32 v2, v2, v66
    v_cmp_eq_u32 vcc, -1, v2
    s_cbranch_vccnz c_s_30
c_j_31:
    s_nop 1
    v_cvt_pk_bf16_f32 v10, v78, v79
    v_cvt_pk_bf16_f32 v11, v80, v81
    v_cvt_pk_bf16_f32 v12, v82, v83
    v_cvt_pk_bf16_f32 v13, v84, v85
    s_branch qk_loop_17
x_s_18:
    buffer_load_dwordx4 v[54:57], v116, s[8:11], s73 offen sc1
    buffer_load_dwordx4 v[58:61], v115, s[8:11], s73 offen sc1
    buffer_load_dwordx4 v[62:65], v115, s[8:11], s73 offen offset:256 sc1
    s_waitcnt vmcnt(3)
    v_mfma_f32_16x16x32_bf16 v[18:21], v[66:69], v[98:101], v[78:81]
    v_mfma_f32_16x16x32_bf16 v[22:25], v[66:69], v[102:105], v[82:85]
    v_mfma_f32_16x16x32_bf16 v[18:21], v[70:73], v[26:29], v[18:21]
    v_mfma_f32_16x16x32_bf16 v[22:25], v[74:77], v[26:29], v[22:25]
    v_bitop3_b32 v2, v66, v70, s82 bitop3:0x7e
    v_xor_b32 v3, s82, v74
    v_bitop3_b32 v2, v2, v3, 1 bitop3:0xa8
    v_cmp_ne_u32 vcc, 0, v2
    s_cbranch_vccz x_j_19
    buffer_load_dwordx4 v[66:69], v116, s[8:11], s73 offen sc1
    buffer_load_dwordx4 v[70:73], v115, s[8:11], s73 offen sc1
    buffer_load_dwordx4 v[74:77], v115, s[8:11], s73 offen offset:256 sc1
    s_waitcnt vmcnt(3)
    v_mfma_f32_16x16x32_bf16 v[18:21], v[54:57], v[98:101], v[78:81]
    v_mfma_f32_16x16x32_bf16 v[22:25], v[54:57], v[102:105], v[82:85]
    v_mfma_f32_16x16x32_bf16 v[18:21], v[58:61], v[26:29], v[18:21]
    v_mfma_f32_16x16x32_bf16 v[22:25], v[62:65], v[26:29], v[22:25]
    v_bitop3_b32 v2, v54, v58, s82 bitop3:0x7e
    v_xor_b32 v3, s82, v62
    v_bitop3_b32 v2, v2, v3, 1 bitop3:0xa8
    v_cmp_ne_u32 vcc, 0, v2
    s_cbranch_vccz x_j_19
    s_sub_u32 s69, s69, 1
    s_cbranch_scc0 x_s_18
    s_mov_b32 s69, 0
    s_branch x_j_19
c_s_30:
    buffer_load_dwordx4 v[54:57], v37, s[8:11], s76 offen offset:0 sc1
    buffer_load_dwordx4 v[58:61], v37, s[8:11], s76 offen offset:1024 sc1
    buffer_load_dwordx4 v[62:65], v37, s[8:11], s76 offen offset:2048 sc1
    buffer_load_dwordx4 v[66:69], v37, s[8:11], s76 offen offset:3072 sc1
    s_waitcnt vmcnt(0)
    v_mfma_f32_16x16x32_bf16 v[78:81], v[54:57], v[30:33], 0
    v_mfma_f32_16x16x32_bf16 v[78:81], v[58:61], v[30:33], v[78:81]
    v_mfma_f32_16x16x32_bf16 v[82:85], v[62:65], v[30:33], 0
    v_mfma_f32_16x16x32_bf16 v[82:85], v[66:69], v[30:33], v[82:85]
    v_max3_u32 v2, v54, v58, v62
    v_max_u32 v2, v2, v66
    v_cmp_eq_u32 vcc, -1, v2
    s_cbranch_vccz c_j_31
    s_sub_u32 s69, s69, 1
    s_cbranch_scc0 c_s_30
    s_mov_b32 s69, 0
    s_branch c_j_31
vo_main_15:
    s_setprio 1
    v_mov_b32 v86, 0x3f803f80
    v_mov_b32 v90, 0x3e803e80
    v_mov_b32 v87, 0x3f803f80
    v_mov_b32 v91, 0x3e803e80
    v_mov_b32 v88, 0x3f803f80
    v_mov_b32 v92, 0x3e803e80
    v_mov_b32 v89, 0x3f803f80
    v_mov_b32 v93, 0x3e803e80
    v_and_b32 v2, 1, v1
    v_lshlrev_b32 v2, 4, v2
    v_mov_b32 v3, 0x3f80
    v_lshlrev_b32 v2, v2, v3
    v_lshrrev_b32 v3, 1, v6
    v_cmp_eq_u32 vcc, 0, v3
    s_nop 1
    v_cndmask_b32 v26, 0, v2, vcc
    v_cmp_eq_u32 vcc, 1, v3
    s_nop 1
    v_cndmask_b32 v27, 0, v2, vcc
    v_cmp_eq_u32 vcc, 2, v3
    s_nop 1
    v_cndmask_b32 v28, 0, v2, vcc
    v_cmp_eq_u32 vcc, 3, v3
    s_nop 1
    v_cndmask_b32 v29, 0, v2, vcc
    v_bfe_u32 v118, v1, 0, 3
    v_lshlrev_b32 v118, 3, v118
    v_bfe_u32 v3, v1, 3, 1
    v_lshl_or_b32 v118, v3, 7, v118
    v_bfe_u32 v3, v1, 5, 1
    v_lshl_or_b32 v118, v3, 6, v118
    v_bfe_u32 v3, v1, 4, 1
    v_lshl_or_b32 v118, v3, 8, v118
    v_bfe_u32 v3, v1, 1, 3
    v_bfe_u32 v4, v1, 4, 1
    v_lshlrev_b32 v4, 1, v4
    v_xor_b32 v3, v3, v4
    v_cmp_eq_u32 vcc, 0, v3
    s_nop 1
    v_cndmask_b32 v98, 0, v2, vcc
    v_cndmask_b32 v100, 0, v2, vcc
    v_cmp_eq_u32 vcc, 1, v3
    s_nop 1
    v_cndmask_b32 v99, 0, v2, vcc
    v_cndmask_b32 v101, 0, v2, vcc
    v_cmp_eq_u32 vcc, 4, v3
    s_nop 1
    v_cndmask_b32 v102, 0, v2, vcc
    v_cndmask_b32 v104, 0, v2, vcc
    v_cmp_eq_u32 vcc, 5, v3
    s_nop 1
    v_cndmask_b32 v103, 0, v2, vcc
    v_cndmask_b32 v105, 0, v2, vcc
    s_add_u32 s80, s80, 0x4400000
    s_mov_b32 s81, 0x3e0293ee
    v_lshlrev_b32 v114, 2, v1
    v_add_u32 v114, 8192, v114
    v_bfe_u32 v117, v1, 0, 1
    v_lshlrev_b32 v117, 4, v117
    v_bfe_u32 v2, v1, 2, 2
    v_lshl_or_b32 v117, v2, 5, v117
    v_bfe_u32 v2, v1, 1, 1
    v_lshl_or_b32 v117, v2, 7, v117
    v_bfe_u32 v2, v1, 4, 2
    v_lshl_or_b32 v117, v2, 8, v117
    v_bfe_u32 v2, v1, 1, 1
    v_lshl_or_b32 v117, v2, 10, v117
    v_bfe_u32 v119, v1, 4, 2
    v_lshlrev_b32 v119, 3, v119
    s_lshl_b32 s70, s67, 11
    v_add_u32 v116, s70, v8
    s_bfe_u32 s70, s67, 0x10000
    s_lshl_b32 s70, s70, 7
    s_bfe_u32 s71, s67, 0x20000
    s_lshl_b32 s71, s71, 10
    s_or_b32 s70, s70, s71
    v_xor_b32 v115, s70, v8
    s_cmp_lg_u32 s58, 4
    s_cbranch_scc1 kv0w_32
kv0_33:
    buffer_load_dword v5, off, s[12:15], 0 offset:128 sc1
    s_waitcnt vmcnt(0)
    v_cmp_gt_u16 vcc, 128, v5
    s_cbranch_vccz kv0_ok_34
    s_sub_u32 s69, s69, 1
    s_cbranch_scc0 kv0_33
    s_mov_b32 s69, 0
kv0_ok_34:
kv0w_32:
    s_barrier
vo_loop_35:
    v_mov_b32 v38, 0
    v_mov_b32 v39, 0
    v_mov_b32 v40, 0
    v_mov_b32 v41, 0
    v_mov_b32 v42, 0
    v_mov_b32 v43, 0
    v_mov_b32 v44, 0
    v_mov_b32 v45, 0
    s_barrier
    v_mov_b32 v46, 0
    v_mov_b32 v47, 0
    v_mov_b32 v48, 0
    v_mov_b32 v49, 0
    v_mov_b32 v50, 0
    v_mov_b32 v51, 0
    v_mov_b32 v52, 0
    v_mov_b32 v53, 0
    v_mov_b32 v54, 0
    v_mov_b32 v55, 0
    v_mov_b32 v56, 0
    v_mov_b32 v57, 0
    v_mov_b32 v58, 0
    v_mov_b32 v59, 0
    v_mov_b32 v60, 0
    v_mov_b32 v61, 0
    ds_read_b128 v[10:13], v8 offset:0
    ds_read_b128 v[14:17], v8 offset:1024
    ds_read_b128 v[18:21], v8 offset:2048
    ds_read_b128 v[22:25], v8 offset:3072
    ds_read_b128 v[70:73], v116 offset:13312
    ds_read_b128 v[74:77], v116 offset:14336
    s_waitcnt lgkmcnt(5)
    v_smfmac_f32_16x16x64_bf16 v[38:41], v[10:13], v[128:135], v7
    v_smfmac_f32_16x16x64_bf16 v[42:45], v[10:13], v[160:167], v7
    s_waitcnt lgkmcnt(4)
    v_smfmac_f32_16x16x64_bf16 v[38:41], v[14:17], v[136:143], v7
    v_smfmac_f32_16x16x64_bf16 v[42:45], v[14:17], v[168:175], v7
    s_waitcnt lgkmcnt(3)
    v_smfmac_f32_16x16x64_bf16 v[38:41], v[18:21], v[144:151], v7
    v_smfmac_f32_16x16x64_bf16 v[42:45], v[18:21], v[176:183], v7
    s_waitcnt lgkmcnt(2)
    v_smfmac_f32_16x16x64_bf16 v[38:41], v[22:25], v[152:159], v7
    v_smfmac_f32_16x16x64_bf16 v[42:45], v[22:25], v[184:191], v7
    s_nop 6
    v_pk_add_f32 v[38:39], v[38:39], v[40:41]
    v_cvt_pk_bf16_f32 v78, v38, v39
    v_pk_add_f32 v[42:43], v[42:43], v[44:45]
    v_cvt_pk_bf16_f32 v79, v42, v43
    s_nop 1
    v_permlane16_swap_b32 v78, v79
    v_bfi_b32 v78, 1, s82, v78
    buffer_store_dwordx2 v[78:79], v34, s[8:11], s73 offen
    s_and_b32 s70, s68, 1
    s_lshl_b32 s70, s70, 19
    s_add_u32 s71, s70, s79
    s_add_u32 s70, s70, s78
    s_cmp_eq_u32 s68, 63
    s_cbranch_scc1 vo_last_36
    s_waitcnt lgkmcnt(0)
    s_barrier
    ds_read_b128 v[10:13], v8 offset:4096
    ds_read_b128 v[14:17], v8 offset:5120
    ds_read2st64_b32 v[30:31], v114 offset0:0 offset1:1
    ds_read_b128 v[18:21], v8 offset:6144
    ds_read_b128 v[22:25], v8 offset:7168
    ds_read2st64_b32 v[32:33], v114 offset0:2 offset1:3
    buffer_load_dwordx4 v[62:65], v8, s[8:11], s73 offen offset:0 sc1
    buffer_load_dwordx4 v[66:69], v8, s[8:11], s73 offen offset:1024 sc1
    s_waitcnt lgkmcnt(4)
    v_pk_add_f32 v[10:11], v[10:11], v[14:15]
    v_pk_add_f32 v[12:13], v[12:13], v[16:17]
    s_waitcnt lgkmcnt(2)
    v_pk_add_f32 v[10:11], v[10:11], v[18:19]
    v_pk_add_f32 v[12:13], v[12:13], v[20:21]
    s_waitcnt lgkmcnt(0)
    v_pk_add_f32 v[30:31], v[30:31], v[32:33]
    v_pk_add_f32 v[10:11], v[10:11], v[22:23]
    v_pk_add_f32 v[12:13], v[12:13], v[24:25]
    v_add_f32 v14, v30, v31
    v_max3_f32 v2, v10, v11, v12
    v_max3_f32 v3, v2, v13, v14
    v_max3_f32 v2, v2, v13, v14
    s_nop 1
    v_permlane32_swap_b32 v2, v3
    v_max_f32 v4, v2, v3
    v_max_f32 v3, v2, v3
    s_nop 1
    v_permlane16_swap_b32 v4, v3
    v_max_f32 v2, v4, v3
    v_mul_f32 v2, s81, v2
    s_nop 1
    v_max_f32_dpp v2, v2, v2 row_ror:8 row_mask:0xf bank_mask:0xf
    v_fma_f32 v10, v10, s81, -v2
    v_fma_f32 v11, v11, s81, -v2
    v_fma_f32 v12, v12, s81, -v2
    v_fma_f32 v13, v13, s81, -v2
    v_fma_f32 v14, v14, s81, -v2
    v_exp_f32 v10, v10
    v_exp_f32 v11, v11
    v_exp_f32 v12, v12
    v_exp_f32 v13, v13
    v_exp_f32 v15, v14
    v_cvt_pk_bf16_f32 v78, v10, v11
    v_cvt_pk_bf16_f32 v79, v12, v13
    v_mov_b32 v14, v15
    v_mov_b32_dpp v80, v78 row_ror:8 row_mask:0xf bank_mask:0xf
    v_mov_b32_dpp v81, v79 row_ror:8 row_mask:0xf bank_mask:0xf
    v_permlane32_swap_b32 v14, v15
    v_cvt_pk_bf16_f32 v82, v14, v15
    v_mfma_f32_16x16x32_bf16 v[106:109], v[70:73], v[78:81], 0
    v_mov_b32 v84, v82
    v_mov_b32_dpp v83, v82 row_ror:8 row_mask:0xf bank_mask:0xf
    v_mov_b32_dpp v85, v82 row_ror:8 row_mask:0xf bank_mask:0xf
    v_mfma_f32_16x16x32_bf16 v[110:113], v[74:77], v[78:81], 0
    s_waitcnt vmcnt(0)
    v_mfma_f32_16x16x32_bf16 v[18:21], v[62:65], v[82:85], v[106:109]
    v_bitop3_b32 v2, v62, v64, s82 bitop3:0x7e
    v_bitop3_b32 v3, v66, v68, s82 bitop3:0x7e
    v_mfma_f32_16x16x32_bf16 v[22:25], v[66:69], v[82:85], v[110:113]
    v_bitop3_b32 v2, v2, v3, 1 bitop3:0xa8
    v_cmp_ne_u32 vcc, 0, v2
    s_cbranch_vccnz xv_s_37
xv_j_38:
    v_mfma_f32_16x16x32_bf16 v[94:97], v[86:89], v[78:81], 0
    s_nop 0
    v_cvt_pk_bf16_f32 v106, v18, v19
    v_cvt_pk_bf16_f32 v107, v20, v21
    s_nop 0
    v_cvt_pk_bf16_f32 v108, v22, v23
    v_cvt_pk_bf16_f32 v109, v24, v25
    ds_write_b128 v115, v[106:109] offset:9216
    v_mfma_f32_16x16x32_bf16 v[94:97], v[90:93], v[82:85], v[94:97]
    s_nop 3
    s_waitcnt lgkmcnt(0)
    s_barrier
    ds_read_b128 v[10:13], v117 offset:9216
    ds_read_b128 v[14:17], v117 offset:11264
    v_rcp_f32 v96, v94
    s_nop 0
    ds_bpermute_b32 v94, v119, v96 offset:0
    ds_bpermute_b32 v95, v119, v96 offset:4
    s_waitcnt lgkmcnt(3)
    v_smfmac_f32_16x16x64_bf16 v[46:49], v[10:13], v[192:199], v7
    v_smfmac_f32_16x16x64_bf16 v[50:53], v[10:13], v[208:215], v7
    s_waitcnt lgkmcnt(2)
    v_smfmac_f32_16x16x64_bf16 v[46:49], v[14:17], v[200:207], v7
    s_nop 1
    v_smfmac_f32_16x16x64_bf16 v[50:53], v[14:17], v[216:223], v7
    s_nop 1
    v_smfmac_f32_16x16x64_bf16 v[54:57], v[10:13], v[224:231], v7
    s_waitcnt lgkmcnt(0)
    v_smfmac_f32_16x16x64_bf16 v[54:57], v[14:17], v[232:239], v7
    v_pk_add_f32 v[46:47], v[46:47], v[48:49]
    v_smfmac_f32_16x16x64_bf16 v[58:61], v[10:13], v[240:247], v7
    v_pk_mul_f32 v[46:47], v[46:47], v[94:95]
    v_cvt_pk_bf16_f32 v78, v46, v47
    v_smfmac_f32_16x16x64_bf16 v[58:61], v[14:17], v[248:255], v7
    v_pk_add_f32 v[50:51], v[50:51], v[52:53]
    v_pk_mul_f32 v[50:51], v[50:51], v[94:95]
    v_cvt_pk_bf16_f32 v79, v50, v51
    v_pk_add_f32 v[54:55], v[54:55], v[56:57]
    v_pk_mul_f32 v[54:55], v[54:55], v[94:95]
    v_cvt_pk_bf16_f32 v80, v54, v55
    v_permlane16_swap_b32 v78, v79
    v_bfi_b32 v78, 1, s82, v78
    v_pk_add_f32 v[58:59], v[58:59], v[60:61]
    v_pk_mul_f32 v[58:59], v[58:59], v[94:95]
    v_cvt_pk_bf16_f32 v81, v58, v59
    s_nop 1
    v_permlane16_swap_b32 v80, v81
    buffer_store_dwordx4 v[78:81], v36, s[8:11], s71 offen
    s_nop 15
    s_nop 15
    buffer_load_dwordx4 v[10:13], v8, s[8:11], s70 offen sc1
    s_nop 15
    buffer_load_dwordx4 v[14:17], v8, s[8:11], s70 offen sc1
    s_nop 15
    buffer_load_dwordx4 v[18:21], v8, s[8:11], s70 offen sc1
    s_waitcnt vmcnt(2)
    v_mfma_f32_16x16x32_bf16 v[30:33], v[26:29], v[10:13], 0
    v_bitop3_b32 v2, v10, s82, 1 bitop3:0x28
    v_cmp_ne_u32 vcc, 0, v2
    s_cbranch_vccnz b_s_39
b_j_40:
    s_nop 4
    v_add_f32_dpp v30, v30, v30 row_ror:8 row_mask:0xf bank_mask:0xf
    v_add_f32_dpp v31, v31, v31 row_ror:8 row_mask:0xf bank_mask:0xf
    v_add_f32_dpp v32, v32, v32 row_ror:8 row_mask:0xf bank_mask:0xf
    v_add_f32_dpp v33, v33, v33 row_ror:8 row_mask:0xf bank_mask:0xf
    v_cvt_pk_bf16_f32 v30, v30, v31
    v_cvt_pk_bf16_f32 v31, v32, v33
    v_min_u32 v30, -2, v30
    s_nop 0
    v_permlane16_swap_b32 v31, v33
    v_permlane16_swap_b32 v30, v32
    buffer_store_dwordx4 v[30:33], v35, s[8:11], s77 offen sc1
    s_barrier
    s_add_u32 s68, s68, 1
    s_bfe_u32 s82, s68, 0x10001
    s_xor_b32 s73, s73, 0x40000
    s_add_u32 s77, s77, 0x20000
    s_lshr_b32 s60, s77, 21
    s_bitcmp1_b32 s59, s60
    s_cselect_b32 s60, 0x2000, 0
    s_bitset0_b32 s77, 13
    s_or_b32 s77, s77, s60
    s_waitcnt vmcnt(1)
    s_and_b32 s72, s68, 3
    s_cmp_lg_u32 s72, s64
    s_cbranch_scc1 novm_41
    v_mfma_f32_16x16x32_bf16 v[106:109], v[98:101], v[62:65], 0
    v_mfma_f32_16x16x32_bf16 v[106:109], v[102:105], v[66:69], v[106:109]
    s_nop 7
    v_cvt_pk_bf16_f32 v106, v106, v107
    v_cvt_pk_bf16_f32 v107, v108, v109
    v_min_u32 v106, -2, v106
    buffer_store_dwordx2 v[106:107], v118, s[8:11], s80 offen sc1
novm_41:
    s_add_u32 s80, s80, 0x10000
    s_branch vo_loop_35
xv_s_37:
    buffer_load_dwordx4 v[62:65], v8, s[8:11], s73 offen offset:0 sc1
    buffer_load_dwordx4 v[66:69], v8, s[8:11], s73 offen offset:1024 sc1
    s_waitcnt vmcnt(0)
    v_mfma_f32_16x16x32_bf16 v[18:21], v[62:65], v[82:85], v[106:109]
    v_bitop3_b32 v2, v62, v64, s82 bitop3:0x7e
    v_bitop3_b32 v3, v66, v68, s82 bitop3:0x7e
    v_mfma_f32_16x16x32_bf16 v[22:25], v[66:69], v[82:85], v[110:113]
    v_bitop3_b32 v2, v2, v3, 1 bitop3:0xa8
    v_cmp_ne_u32 vcc, 0, v2
    s_cbranch_vccz xv_j_38
    s_sub_u32 s69, s69, 1
    s_cbranch_scc0 xv_s_37
    s_mov_b32 s69, 0
    s_branch xv_j_38
b_s_39:
    buffer_load_dwordx4 v[10:13], v8, s[8:11], s70 offen sc1
    s_waitcnt vmcnt(2)
    s_nop 0
    v_mfma_f32_16x16x32_bf16 v[30:33], v[26:29], v[14:17], 0
    v_bitop3_b32 v2, v14, s82, 1 bitop3:0x28
    v_cmp_ne_u32 vcc, 0, v2
    s_cbranch_vccz b_j_40
    buffer_load_dwordx4 v[14:17], v8, s[8:11], s70 offen sc1
    s_waitcnt vmcnt(2)
    s_nop 0
    v_mfma_f32_16x16x32_bf16 v[30:33], v[26:29], v[18:21], 0
    v_bitop3_b32 v2, v18, s82, 1 bitop3:0x28
    v_cmp_ne_u32 vcc, 0, v2
    s_cbranch_vccz b_j_40
    buffer_load_dwordx4 v[18:21], v8, s[8:11], s70 offen sc1
    s_waitcnt vmcnt(2)
    s_nop 0
    v_mfma_f32_16x16x32_bf16 v[30:33], v[26:29], v[10:13], 0
    v_bitop3_b32 v2, v10, s82, 1 bitop3:0x28
    v_cmp_ne_u32 vcc, 0, v2
    s_cbranch_vccz b_j_40
    s_sub_u32 s69, s69, 1
    s_cbranch_scc0 b_s_39
    s_mov_b32 s69, 0
    s_branch b_j_40
vo_last_36:
    s_cmp_lg_u32 s64, 0
    s_cbranch_scc1 chain_end_16
pollvm_42:
    buffer_load_dwordx4 v[62:65], v8, s[8:11], s73 offen offset:0 sc1
    buffer_load_dwordx4 v[66:69], v8, s[8:11], s73 offen offset:1024 sc1
    s_waitcnt vmcnt(0)
    v_bitop3_b32 v2, v62, v64, s82 bitop3:0x7e
    v_bitop3_b32 v3, v66, v68, s82 bitop3:0x7e
    v_bitop3_b32 v2, v2, v3, 1 bitop3:0xa8
    v_cmp_ne_u32 vcc, 0, v2
    s_cbranch_vccz pollvm_ok_43
    s_sub_u32 s69, s69, 1
    s_cbranch_scc0 pollvm_42
    s_mov_b32 s69, 0
pollvm_ok_43:
    v_mfma_f32_16x16x32_bf16 v[106:109], v[98:101], v[62:65], 0
    v_mfma_f32_16x16x32_bf16 v[106:109], v[102:105], v[66:69], v[106:109]
    s_nop 7
    v_cvt_pk_bf16_f32 v106, v106, v107
    v_cvt_pk_bf16_f32 v107, v108, v109
    v_min_u32 v106, -2, v106
    buffer_store_dwordx2 v[106:107], v118, s[8:11], s80 offen sc1
chain_end_16:
    s_waitcnt vmcnt(0)
    s_endpgm
bulk_2:
    s_and_b32 s75, s56, 3
    s_lshl_b32 s76, s75, 5
    s_add_u32 s76, s76, s57
    s_mov_b32 s77, 0x40000
    s_mov_b32 s78, 0
    s_cmp_ge_u32 s75, 2
    s_cbranch_scc1 v0_47
    v_bfe_u32 v208, v1, 4, 1
    v_lshlrev_b32 v208, 1, v208
    s_and_b32 s85, s58, 4
    v_xor_b32 v208, s85, v208
    v_xor_b32 v208, v208, v1
    v_bfe_u32 v70, v208, 0, 1
    v_lshlrev_b32 v70, 5, v70
    v_bfe_u32 v209, v208, 1, 1
    v_lshl_or_b32 v70, v209, 4, v70
    v_bfe_u32 v209, v208, 2, 1
    v_lshl_or_b32 v70, v209, 6, v70
    v_bfe_u32 v209, v208, 3, 3
    v_lshl_or_b32 v70, v209, 13, v70
    s_bfe_u32 s69, s76, 0x60000
    s_lshl_b32 s69, s69, 7
    s_lshl_b32 s85, s58, 16
    s_add_u32 s69, s69, s85
    s_lshl_b32 s71, s58, 10
    s_mov_b32 m0, s71
    s_nop 0
    buffer_load_dwordx4 v70, s[24:27], s69 offen lds
    s_add_u32 s69, s69, 0x80000
    s_add_u32 s71, s71, 0x2000
    s_mov_b32 m0, s71
    s_nop 0
    buffer_load_dwordx4 v70, s[24:27], s69 offen lds
    s_add_u32 s69, s69, 0x80000
    s_add_u32 s71, s71, 0x2000
    s_mov_b32 m0, s71
    s_nop 0
    buffer_load_dwordx4 v70, s[24:27], s69 offen lds
    s_add_u32 s69, s69, 0x80000
    s_add_u32 s71, s71, 0x2000
    s_mov_b32 m0, s71
    s_nop 0
    buffer_load_dwordx4 v70, s[24:27], s69 offen lds
    s_add_u32 s69, s69, 0x80000
    s_add_u32 s71, s71, 0x2000
    s_mov_b32 m0, s71
    s_nop 0
    buffer_load_dwordx4 v70, s[24:27], s69 offen lds
    s_add_u32 s69, s69, 0x80000
    s_add_u32 s71, s71, 0x2000
    s_mov_b32 m0, s71
    s_nop 0
    buffer_load_dwordx4 v70, s[24:27], s69 offen lds
    s_add_u32 s69, s69, 0x80000
    s_add_u32 s71, s71, 0x2000
    s_mov_b32 m0, s71
    s_nop 0
    buffer_load_dwordx4 v70, s[24:27], s69 offen lds
    s_add_u32 s69, s69, 0x80000
    s_add_u32 s71, s71, 0x2000
    s_mov_b32 m0, s71
    s_nop 0
    buffer_load_dwordx4 v70, s[24:27], s69 offen lds
    s_add_u32 s69, s69, 0x80000
    s_add_u32 s71, s71, 0x2000
    s_mov_b32 m0, s71
    s_nop 0
    buffer_load_dwordx4 v70, s[24:27], s69 offen lds
    s_add_u32 s69, s69, 0x80000
    s_add_u32 s71, s71, 0x2000
    s_mov_b32 m0, s71
    s_nop 0
    buffer_load_dwordx4 v70, s[24:27], s69 offen lds
    s_add_u32 s69, s69, 0x80000
    s_add_u32 s71, s71, 0x2000
    s_mov_b32 m0, s71
    s_nop 0
    buffer_load_dwordx4 v70, s[24:27], s69 offen lds
    s_add_u32 s69, s69, 0x80000
    s_add_u32 s71, s71, 0x2000
    s_mov_b32 m0, s71
    s_nop 0
    buffer_load_dwordx4 v70, s[24:27], s69 offen lds
    s_add_u32 s69, s69, 0x80000
    s_add_u32 s71, s71, 0x2000
    s_mov_b32 m0, s71
    s_nop 0
    buffer_load_dwordx4 v70, s[24:27], s69 offen lds
    s_add_u32 s69, s69, 0x80000
    s_add_u32 s71, s71, 0x2000
    s_mov_b32 m0, s71
    s_nop 0
    buffer_load_dwordx4 v70, s[24:27], s69 offen lds
    s_add_u32 s69, s69, 0x80000
    s_add_u32 s71, s71, 0x2000
    s_mov_b32 m0, s71
    s_nop 0
    buffer_load_dwordx4 v70, s[24:27], s69 offen lds
    s_add_u32 s69, s69, 0x80000
    s_add_u32 s71, s71, 0x2000
    s_mov_b32 m0, s71
    s_nop 0
    buffer_load_dwordx4 v70, s[24:27], s69 offen lds
    s_add_u32 s69, s69, 0x80000
    s_add_u32 s71, s71, 0x2000
    s_lshl_b32 s85, s58, 5
    s_add_u32 s74, s58, s57
    s_and_b32 s74, s74, 7
    s_lshl_b32 s74, s74, 8
    v_bfe_u32 v209, v1, 0, 2
    v_lshlrev_b32 v209, 4, v209
    v_bfe_u32 v210, v1, 4, 2
    v_lshl_or_b32 v209, v210, 6, v209
    v_and_b32 v208, 12, v1
    v_add3_u32 v208, v208, s85, 0
    v_lshlrev_b32 v68, 11, v208
    v_add3_u32 v68, v68, v209, s74
    v_add_u32 v71, 4096, v68
    v_and_b32 v208, 12, v1
    v_add3_u32 v208, v208, s85, 16
    v_lshlrev_b32 v69, 11, v208
    v_add3_u32 v69, v69, v209, s74
    v_add_u32 v72, 4096, v69
    v_bfe_u32 v79, v1, 0, 4
    v_lshlrev_b32 v79, 4, v79
    v_bfe_u32 v75, v1, 4, 2
    v_lshl_or_b32 v79, v75, 9, v79
    v_bfe_u32 v75, v1, 0, 2
    v_lshlrev_b32 v75, 3, v75
    v_bfe_u32 v208, v1, 3, 1
    v_lshl_or_b32 v75, v208, 5, v75
    v_bfe_u32 v208, v1, 4, 1
    v_lshl_or_b32 v75, v208, 6, v75
    v_bfe_u32 v208, v1, 2, 2
    v_lshl_or_b32 v75, v208, 7, v75
    v_bfe_u32 v208, v1, 4, 2
    v_lshl_or_b32 v75, v208, 12, v75
    v_lshl_or_b32 v75, s74, 6, v75
    v_xor_b32 v76, 32, v75
    v_xor_b32 v77, 64, v75
    v_xor_b32 v78, 96, v75
    v_mov_b32 v4, 0
    v_mov_b32 v5, 0
    v_mov_b32 v6, 0
    v_mov_b32 v7, 0
    v_mov_b32 v8, 0
    v_mov_b32 v9, 0
    v_mov_b32 v10, 0
    v_mov_b32 v11, 0
    v_mov_b32 v12, 0
    v_mov_b32 v13, 0
    v_mov_b32 v14, 0
    v_mov_b32 v15, 0
    v_mov_b32 v16, 0
    v_mov_b32 v17, 0
    v_mov_b32 v18, 0
    v_mov_b32 v19, 0
    v_mov_b32 v20, 0
    v_mov_b32 v21, 0
    v_mov_b32 v22, 0
    v_mov_b32 v23, 0
    v_mov_b32 v24, 0
    v_mov_b32 v25, 0
    v_mov_b32 v26, 0
    v_mov_b32 v27, 0
    v_mov_b32 v28, 0
    v_mov_b32 v29, 0
    v_mov_b32 v30, 0
    v_mov_b32 v31, 0
    v_mov_b32 v32, 0
    v_mov_b32 v33, 0
    v_mov_b32 v34, 0
    v_mov_b32 v35, 0
    s_bfe_u32 s81, s76, 0x60000
    s_lshl_b32 s81, s81, 12
    s_lshl_b32 s85, s58, 18
    s_add_u32 s81, s81, s85
    s_add_u32 s81, s81, 0x1000000
    s_and_b32 s85, s58, 4
    s_add_u32 s83, s85, 128
    s_mov_b32 s73, 0
    s_mov_b32 s72, 0
    s_mov_b32 s68, 0
    v_mov_b32 v208, 163776
    ds_write_b128 v208, v[4:7]
    ds_write_b128 v208, v[4:7] offset:16
    s_cmp_lt_u32 s58, 4
    s_cbranch_scc1 p0x_51
    s_waitcnt vmcnt(0) lgkmcnt(0)
    s_barrier
    s_barrier
p0x_51:
    buffer_load_dwordx4 v[80:83], v68, s[36:39], s68 offen offset:0
    buffer_load_dwordx4 v[96:99], v69, s[36:39], s68 offen offset:0
    buffer_load_dwordx4 v[84:87], v68, s[36:39], s68 offen offset:2048
    buffer_load_dwordx4 v[100:103], v69, s[36:39], s68 offen offset:2048
    buffer_load_dwordx4 v[88:91], v71, s[36:39], s68 offen offset:0
    buffer_load_dwordx4 v[104:107], v72, s[36:39], s68 offen offset:0
    buffer_load_dwordx4 v[92:95], v71, s[36:39], s68 offen offset:2048
    buffer_load_dwordx4 v[108:111], v72, s[36:39], s68 offen offset:2048
    v_xor_b32 v68, 0x100, v68
    v_xor_b32 v69, 0x100, v69
    v_xor_b32 v71, 0x100, v71
    v_xor_b32 v72, 0x100, v72
    buffer_load_dwordx4 v[112:115], v68, s[36:39], s68 offen offset:0
    buffer_load_dwordx4 v[128:131], v69, s[36:39], s68 offen offset:0
    buffer_load_dwordx4 v[116:119], v68, s[36:39], s68 offen offset:2048
    buffer_load_dwordx4 v[132:135], v69, s[36:39], s68 offen offset:2048
    buffer_load_dwordx4 v[120:123], v71, s[36:39], s68 offen offset:0
    buffer_load_dwordx4 v[136:139], v72, s[36:39], s68 offen offset:0
    buffer_load_dwordx4 v[124:127], v71, s[36:39], s68 offen offset:2048
    buffer_load_dwordx4 v[140:143], v72, s[36:39], s68 offen offset:2048
    v_xor_b32 v68, 0x300, v68
    v_xor_b32 v69, 0x300, v69
    v_xor_b32 v71, 0x300, v71
    v_xor_b32 v72, 0x300, v72
    buffer_load_dwordx4 v[144:147], v68, s[36:39], s68 offen offset:0
    buffer_load_dwordx4 v[160:163], v69, s[36:39], s68 offen offset:0
    buffer_load_dwordx4 v[148:151], v68, s[36:39], s68 offen offset:2048
    buffer_load_dwordx4 v[164:167], v69, s[36:39], s68 offen offset:2048
    buffer_load_dwordx4 v[152:155], v71, s[36:39], s68 offen offset:0
    buffer_load_dwordx4 v[168:171], v72, s[36:39], s68 offen offset:0
    buffer_load_dwordx4 v[156:159], v71, s[36:39], s68 offen offset:2048
    buffer_load_dwordx4 v[172:175], v72, s[36:39], s68 offen offset:2048
    v_xor_b32 v68, 0x100, v68
    v_xor_b32 v69, 0x100, v69
    v_xor_b32 v71, 0x100, v71
    v_xor_b32 v72, 0x100, v72
    buffer_load_dwordx4 v[176:179], v68, s[36:39], s68 offen offset:0
    buffer_load_dwordx4 v[192:195], v69, s[36:39], s68 offen offset:0
    buffer_load_dwordx4 v[180:183], v68, s[36:39], s68 offen offset:2048
    buffer_load_dwordx4 v[196:199], v69, s[36:39], s68 offen offset:2048
    buffer_load_dwordx4 v[184:187], v71, s[36:39], s68 offen offset:0
    buffer_load_dwordx4 v[200:203], v72, s[36:39], s68 offen offset:0
    buffer_load_dwordx4 v[188:191], v71, s[36:39], s68 offen offset:2048
    buffer_load_dwordx4 v[204:207], v72, s[36:39], s68 offen offset:2048
    v_xor_b32 v68, 0x700, v68
    v_xor_b32 v69, 0x700, v69
    v_xor_b32 v71, 0x700, v71
    v_xor_b32 v72, 0x700, v72
    s_waitcnt vmcnt(24) lgkmcnt(0)
    s_mov_b32 vcc_lo, 0x55555555
    s_mov_b32 vcc_hi, 0x55555555
    v_cndmask_b32_dpp v224, v84, v80, vcc quad_perm:[1,0,3,2] row_mask:0xf bank_mask:0xf
    v_cndmask_b32_dpp v225, v85, v81, vcc quad_perm:[1,0,3,2] row_mask:0xf bank_mask:0xf
    v_cndmask_b32_dpp v226, v86, v82, vcc quad_perm:[1,0,3,2] row_mask:0xf bank_mask:0xf
    v_cndmask_b32_dpp v227, v87, v83, vcc quad_perm:[1,0,3,2] row_mask:0xf bank_mask:0xf
    v_cndmask_b32_dpp v232, v92, v88, vcc quad_perm:[1,0,3,2] row_mask:0xf bank_mask:0xf
    v_cndmask_b32_dpp v233, v93, v89, vcc quad_perm:[1,0,3,2] row_mask:0xf bank_mask:0xf
    v_cndmask_b32_dpp v234, v94, v90, vcc quad_perm:[1,0,3,2] row_mask:0xf bank_mask:0xf
    v_cndmask_b32_dpp v235, v95, v91, vcc quad_perm:[1,0,3,2] row_mask:0xf bank_mask:0xf
    s_mov_b32 vcc_lo, 0xaaaaaaaa
    s_mov_b32 vcc_hi, 0xaaaaaaaa
    v_cndmask_b32_dpp v228, v80, v84, vcc quad_perm:[1,0,3,2] row_mask:0xf bank_mask:0xf
    v_cndmask_b32_dpp v229, v81, v85, vcc quad_perm:[1,0,3,2] row_mask:0xf bank_mask:0xf
    v_cndmask_b32_dpp v230, v82, v86, vcc quad_perm:[1,0,3,2] row_mask:0xf bank_mask:0xf
    v_cndmask_b32_dpp v231, v83, v87, vcc quad_perm:[1,0,3,2] row_mask:0xf bank_mask:0xf
    v_cndmask_b32_dpp v236, v88, v92, vcc quad_perm:[1,0,3,2] row_mask:0xf bank_mask:0xf
    v_cndmask_b32_dpp v237, v89, v93, vcc quad_perm:[1,0,3,2] row_mask:0xf bank_mask:0xf
    v_cndmask_b32_dpp v238, v90, v94, vcc quad_perm:[1,0,3,2] row_mask:0xf bank_mask:0xf
    v_cndmask_b32_dpp v239, v91, v95, vcc quad_perm:[1,0,3,2] row_mask:0xf bank_mask:0xf
    s_mov_b32 vcc_lo, 0x33333333
    s_mov_b32 vcc_hi, 0x33333333
    v_cndmask_b32_dpp v80, v232, v224, vcc quad_perm:[2,3,0,1] row_mask:0xf bank_mask:0xf
    v_cndmask_b32_dpp v81, v233, v225, vcc quad_perm:[2,3,0,1] row_mask:0xf bank_mask:0xf
    v_cndmask_b32_dpp v82, v234, v226, vcc quad_perm:[2,3,0,1] row_mask:0xf bank_mask:0xf
    v_cndmask_b32_dpp v83, v235, v227, vcc quad_perm:[2,3,0,1] row_mask:0xf bank_mask:0xf
    v_cndmask_b32_dpp v84, v236, v228, vcc quad_perm:[2,3,0,1] row_mask:0xf bank_mask:0xf
    v_cndmask_b32_dpp v85, v237, v229, vcc quad_perm:[2,3,0,1] row_mask:0xf bank_mask:0xf
    v_cndmask_b32_dpp v86, v238, v230, vcc quad_perm:[2,3,0,1] row_mask:0xf bank_mask:0xf
    v_cndmask_b32_dpp v87, v239, v231, vcc quad_perm:[2,3,0,1] row_mask:0xf bank_mask:0xf
    s_mov_b32 vcc_lo, 0xcccccccc
    s_mov_b32 vcc_hi, 0xcccccccc
    v_cndmask_b32_dpp v88, v224, v232, vcc quad_perm:[2,3,0,1] row_mask:0xf bank_mask:0xf
    v_cndmask_b32_dpp v89, v225, v233, vcc quad_perm:[2,3,0,1] row_mask:0xf bank_mask:0xf
    v_cndmask_b32_dpp v90, v226, v234, vcc quad_perm:[2,3,0,1] row_mask:0xf bank_mask:0xf
    v_cndmask_b32_dpp v91, v227, v235, vcc quad_perm:[2,3,0,1] row_mask:0xf bank_mask:0xf
    v_cndmask_b32_dpp v92, v228, v236, vcc quad_perm:[2,3,0,1] row_mask:0xf bank_mask:0xf
    v_cndmask_b32_dpp v93, v229, v237, vcc quad_perm:[2,3,0,1] row_mask:0xf bank_mask:0xf
    v_cndmask_b32_dpp v94, v230, v238, vcc quad_perm:[2,3,0,1] row_mask:0xf bank_mask:0xf
    v_cndmask_b32_dpp v95, v231, v239, vcc quad_perm:[2,3,0,1] row_mask:0xf bank_mask:0xf
    s_mov_b32 vcc_lo, 0x55555555
    s_mov_b32 vcc_hi, 0x55555555
    v_cndmask_b32_dpp v224, v100, v96, vcc quad_perm:[1,0,3,2] row_mask:0xf bank_mask:0xf
    v_cndmask_b32_dpp v225, v101, v97, vcc quad_perm:[1,0,3,2] row_mask:0xf bank_mask:0xf
    v_cndmask_b32_dpp v226, v102, v98, vcc quad_perm:[1,0,3,2] row_mask:0xf bank_mask:0xf
    v_cndmask_b32_dpp v227, v103, v99, vcc quad_perm:[1,0,3,2] row_mask:0xf bank_mask:0xf
    v_cndmask_b32_dpp v232, v108, v104, vcc quad_perm:[1,0,3,2] row_mask:0xf bank_mask:0xf
    v_cndmask_b32_dpp v233, v109, v105, vcc quad_perm:[1,0,3,2] row_mask:0xf bank_mask:0xf
    v_cndmask_b32_dpp v234, v110, v106, vcc quad_perm:[1,0,3,2] row_mask:0xf bank_mask:0xf
    v_cndmask_b32_dpp v235, v111, v107, vcc quad_perm:[1,0,3,2] row_mask:0xf bank_mask:0xf
    s_mov_b32 vcc_lo, 0xaaaaaaaa
    s_mov_b32 vcc_hi, 0xaaaaaaaa
    v_cndmask_b32_dpp v228, v96, v100, vcc quad_perm:[1,0,3,2] row_mask:0xf bank_mask:0xf
    v_cndmask_b32_dpp v229, v97, v101, vcc quad_perm:[1,0,3,2] row_mask:0xf bank_mask:0xf
    v_cndmask_b32_dpp v230, v98, v102, vcc quad_perm:[1,0,3,2] row_mask:0xf bank_mask:0xf
    v_cndmask_b32_dpp v231, v99, v103, vcc quad_perm:[1,0,3,2] row_mask:0xf bank_mask:0xf
    v_cndmask_b32_dpp v236, v104, v108, vcc quad_perm:[1,0,3,2] row_mask:0xf bank_mask:0xf
    v_cndmask_b32_dpp v237, v105, v109, vcc quad_perm:[1,0,3,2] row_mask:0xf bank_mask:0xf
    v_cndmask_b32_dpp v238, v106, v110, vcc quad_perm:[1,0,3,2] row_mask:0xf bank_mask:0xf
    v_cndmask_b32_dpp v239, v107, v111, vcc quad_perm:[1,0,3,2] row_mask:0xf bank_mask:0xf
    s_mov_b32 vcc_lo, 0x33333333
    s_mov_b32 vcc_hi, 0x33333333
    v_cndmask_b32_dpp v96, v232, v224, vcc quad_perm:[2,3,0,1] row_mask:0xf bank_mask:0xf
    v_cndmask_b32_dpp v97, v233, v225, vcc quad_perm:[2,3,0,1] row_mask:0xf bank_mask:0xf
    v_cndmask_b32_dpp v98, v234, v226, vcc quad_perm:[2,3,0,1] row_mask:0xf bank_mask:0xf
    v_cndmask_b32_dpp v99, v235, v227, vcc quad_perm:[2,3,0,1] row_mask:0xf bank_mask:0xf
    v_cndmask_b32_dpp v100, v236, v228, vcc quad_perm:[2,3,0,1] row_mask:0xf bank_mask:0xf
    v_cndmask_b32_dpp v101, v237, v229, vcc quad_perm:[2,3,0,1] row_mask:0xf bank_mask:0xf
    v_cndmask_b32_dpp v102, v238, v230, vcc quad_perm:[2,3,0,1] row_mask:0xf bank_mask:0xf
    v_cndmask_b32_dpp v103, v239, v231, vcc quad_perm:[2,3,0,1] row_mask:0xf bank_mask:0xf
    s_mov_b32 vcc_lo, 0xcccccccc
    s_mov_b32 vcc_hi, 0xcccccccc
    v_cndmask_b32_dpp v104, v224, v232, vcc quad_perm:[2,3,0,1] row_mask:0xf bank_mask:0xf
    v_cndmask_b32_dpp v105, v225, v233, vcc quad_perm:[2,3,0,1] row_mask:0xf bank_mask:0xf
    v_cndmask_b32_dpp v106, v226, v234, vcc quad_perm:[2,3,0,1] row_mask:0xf bank_mask:0xf
    v_cndmask_b32_dpp v107, v227, v235, vcc quad_perm:[2,3,0,1] row_mask:0xf bank_mask:0xf
    v_cndmask_b32_dpp v108, v228, v236, vcc quad_perm:[2,3,0,1] row_mask:0xf bank_mask:0xf
    v_cndmask_b32_dpp v109, v229, v237, vcc quad_perm:[2,3,0,1] row_mask:0xf bank_mask:0xf
    v_cndmask_b32_dpp v110, v230, v238, vcc quad_perm:[2,3,0,1] row_mask:0xf bank_mask:0xf
    v_cndmask_b32_dpp v111, v231, v239, vcc quad_perm:[2,3,0,1] row_mask:0xf bank_mask:0xf
    s_cmp_ge_u32 s58, 4
    s_cbranch_scc1 p0y_52
    s_barrier
p0y_52:
    ds_read_b64_tr_b16 v[36:37], v75 offset:0
    ds_read_b64_tr_b16 v[38:39], v75 offset:512
    ds_read_b64_tr_b16 v[40:41], v76 offset:0
    ds_read_b64_tr_b16 v[42:43], v76 offset:512
    ds_read_b64_tr_b16 v[44:45], v77 offset:0
    ds_read_b64_tr_b16 v[46:47], v77 offset:512
    ds_read_b64_tr_b16 v[48:49], v78 offset:0
    ds_read_b64_tr_b16 v[50:51], v78 offset:512
p0_53:
    s_waitcnt vmcnt(16) lgkmcnt(0)
    v_mfma_f32_16x16x32_bf16 v[4:7], v[36:39], v[80:83], v[4:7]
    ds_read_b64_tr_b16 v[52:53], v75 offset:1024
    ds_read_b64_tr_b16 v[54:55], v75 offset:1536
    s_mov_b32 vcc_lo, 0x55555555
    s_mov_b32 vcc_hi, 0x55555555
    v_cndmask_b32_dpp v224, v116, v112, vcc quad_perm:[1,0,3,2] row_mask:0xf bank_mask:0xf
    v_cndmask_b32_dpp v225, v117, v113, vcc quad_perm:[1,0,3,2] row_mask:0xf bank_mask:0xf
    v_mfma_f32_16x16x32_bf16 v[8:11], v[40:43], v[80:83], v[8:11]
    ds_read_b64_tr_b16 v[56:57], v76 offset:1024
    ds_read_b64_tr_b16 v[58:59], v76 offset:1536
    v_cndmask_b32_dpp v226, v118, v114, vcc quad_perm:[1,0,3,2] row_mask:0xf bank_mask:0xf
    v_cndmask_b32_dpp v227, v119, v115, vcc quad_perm:[1,0,3,2] row_mask:0xf bank_mask:0xf
    v_mfma_f32_16x16x32_bf16 v[12:15], v[44:47], v[80:83], v[12:15]
    ds_read_b64_tr_b16 v[60:61], v77 offset:1024
    ds_read_b64_tr_b16 v[62:63], v77 offset:1536
    v_cndmask_b32_dpp v232, v124, v120, vcc quad_perm:[1,0,3,2] row_mask:0xf bank_mask:0xf
    v_cndmask_b32_dpp v233, v125, v121, vcc quad_perm:[1,0,3,2] row_mask:0xf bank_mask:0xf
    v_mfma_f32_16x16x32_bf16 v[16:19], v[48:51], v[80:83], v[16:19]
    ds_read_b64_tr_b16 v[64:65], v78 offset:1024
    ds_read_b64_tr_b16 v[66:67], v78 offset:1536
    v_cndmask_b32_dpp v234, v126, v122, vcc quad_perm:[1,0,3,2] row_mask:0xf bank_mask:0xf
    v_cndmask_b32_dpp v235, v127, v123, vcc quad_perm:[1,0,3,2] row_mask:0xf bank_mask:0xf
    buffer_load_dwordx4 v[80:83], v68, s[36:39], s68 offen offset:0
    v_mfma_f32_16x16x32_bf16 v[20:23], v[36:39], v[96:99], v[20:23]
    s_mov_b32 vcc_lo, 0xaaaaaaaa
    s_mov_b32 vcc_hi, 0xaaaaaaaa
    v_cndmask_b32_dpp v228, v112, v116, vcc quad_perm:[1,0,3,2] row_mask:0xf bank_mask:0xf
    v_cndmask_b32_dpp v229, v113, v117, vcc quad_perm:[1,0,3,2] row_mask:0xf bank_mask:0xf
    v_mfma_f32_16x16x32_bf16 v[24:27], v[40:43], v[96:99], v[24:27]
    v_cndmask_b32_dpp v230, v114, v118, vcc quad_perm:[1,0,3,2] row_mask:0xf bank_mask:0xf
    v_cndmask_b32_dpp v231, v115, v119, vcc quad_perm:[1,0,3,2] row_mask:0xf bank_mask:0xf
    v_mfma_f32_16x16x32_bf16 v[28:31], v[44:47], v[96:99], v[28:31]
    v_cndmask_b32_dpp v236, v120, v124, vcc quad_perm:[1,0,3,2] row_mask:0xf bank_mask:0xf
    v_cndmask_b32_dpp v237, v121, v125, vcc quad_perm:[1,0,3,2] row_mask:0xf bank_mask:0xf
    v_mfma_f32_16x16x32_bf16 v[32:35], v[48:51], v[96:99], v[32:35]
    v_cndmask_b32_dpp v238, v122, v126, vcc quad_perm:[1,0,3,2] row_mask:0xf bank_mask:0xf
    v_cndmask_b32_dpp v239, v123, v127, vcc quad_perm:[1,0,3,2] row_mask:0xf bank_mask:0xf
    buffer_load_dwordx4 v[96:99], v69, s[36:39], s68 offen offset:0
    s_waitcnt lgkmcnt(0)
    v_mfma_f32_16x16x32_bf16 v[4:7], v[52:55], v[84:87], v[4:7]
    ds_read_b64_tr_b16 v[36:37], v75 offset:2048
    ds_read_b64_tr_b16 v[38:39], v75 offset:2560
    s_mov_b32 vcc_lo, 0x33333333
    s_mov_b32 vcc_hi, 0x33333333
    v_cndmask_b32_dpp v112, v232, v224, vcc quad_perm:[2,3,0,1] row_mask:0xf bank_mask:0xf
    v_cndmask_b32_dpp v113, v233, v225, vcc quad_perm:[2,3,0,1] row_mask:0xf bank_mask:0xf
    v_mfma_f32_16x16x32_bf16 v[8:11], v[56:59], v[84:87], v[8:11]
    ds_read_b64_tr_b16 v[40:41], v76 offset:2048
    ds_read_b64_tr_b16 v[42:43], v76 offset:2560
    v_cndmask_b32_dpp v114, v234, v226, vcc quad_perm:[2,3,0,1] row_mask:0xf bank_mask:0xf
    v_cndmask_b32_dpp v115, v235, v227, vcc quad_perm:[2,3,0,1] row_mask:0xf bank_mask:0xf
    v_mfma_f32_16x16x32_bf16 v[12:15], v[60:63], v[84:87], v[12:15]
    ds_read_b64_tr_b16 v[44:45], v77 offset:2048
    ds_read_b64_tr_b16 v[46:47], v77 offset:2560
    v_cndmask_b32_dpp v116, v236, v228, vcc quad_perm:[2,3,0,1] row_mask:0xf bank_mask:0xf
    v_cndmask_b32_dpp v117, v237, v229, vcc quad_perm:[2,3,0,1] row_mask:0xf bank_mask:0xf
    v_mfma_f32_16x16x32_bf16 v[16:19], v[64:67], v[84:87], v[16:19]
    ds_read_b64_tr_b16 v[48:49], v78 offset:2048
    ds_read_b64_tr_b16 v[50:51], v78 offset:2560
    v_cndmask_b32_dpp v118, v238, v230, vcc quad_perm:[2,3,0,1] row_mask:0xf bank_mask:0xf
    v_cndmask_b32_dpp v119, v239, v231, vcc quad_perm:[2,3,0,1] row_mask:0xf bank_mask:0xf
    buffer_load_dwordx4 v[84:87], v68, s[36:39], s68 offen offset:2048
    v_mfma_f32_16x16x32_bf16 v[20:23], v[52:55], v[100:103], v[20:23]
    s_mov_b32 vcc_lo, 0xcccccccc
    s_mov_b32 vcc_hi, 0xcccccccc
    v_cndmask_b32_dpp v120, v224, v232, vcc quad_perm:[2,3,0,1] row_mask:0xf bank_mask:0xf
    v_cndmask_b32_dpp v121, v225, v233, vcc quad_perm:[2,3,0,1] row_mask:0xf bank_mask:0xf
    v_mfma_f32_16x16x32_bf16 v[24:27], v[56:59], v[100:103], v[24:27]
    v_cndmask_b32_dpp v122, v226, v234, vcc quad_perm:[2,3,0,1] row_mask:0xf bank_mask:0xf
    v_cndmask_b32_dpp v123, v227, v235, vcc quad_perm:[2,3,0,1] row_mask:0xf bank_mask:0xf
    v_mfma_f32_16x16x32_bf16 v[28:31], v[60:63], v[100:103], v[28:31]
    v_cndmask_b32_dpp v124, v228, v236, vcc quad_perm:[2,3,0,1] row_mask:0xf bank_mask:0xf
    v_cndmask_b32_dpp v125, v229, v237, vcc quad_perm:[2,3,0,1] row_mask:0xf bank_mask:0xf
    v_mfma_f32_16x16x32_bf16 v[32:35], v[64:67], v[100:103], v[32:35]
    v_cndmask_b32_dpp v126, v230, v238, vcc quad_perm:[2,3,0,1] row_mask:0xf bank_mask:0xf
    v_cndmask_b32_dpp v127, v231, v239, vcc quad_perm:[2,3,0,1] row_mask:0xf bank_mask:0xf
    buffer_load_dwordx4 v[100:103], v69, s[36:39], s68 offen offset:2048
    s_waitcnt lgkmcnt(0)
    v_mfma_f32_16x16x32_bf16 v[4:7], v[36:39], v[88:91], v[4:7]
    ds_read_b64_tr_b16 v[52:53], v75 offset:3072
    ds_read_b64_tr_b16 v[54:55], v75 offset:3584
    s_mov_b32 vcc_lo, 0x55555555
    s_mov_b32 vcc_hi, 0x55555555
    v_cndmask_b32_dpp v224, v132, v128, vcc quad_perm:[1,0,3,2] row_mask:0xf bank_mask:0xf
    v_cndmask_b32_dpp v225, v133, v129, vcc quad_perm:[1,0,3,2] row_mask:0xf bank_mask:0xf
    v_mfma_f32_16x16x32_bf16 v[8:11], v[40:43], v[88:91], v[8:11]
    ds_read_b64_tr_b16 v[56:57], v76 offset:3072
    ds_read_b64_tr_b16 v[58:59], v76 offset:3584
    v_cndmask_b32_dpp v226, v134, v130, vcc quad_perm:[1,0,3,2] row_mask:0xf bank_mask:0xf
    v_cndmask_b32_dpp v227, v135, v131, vcc quad_perm:[1,0,3,2] row_mask:0xf bank_mask:0xf
    v_mfma_f32_16x16x32_bf16 v[12:15], v[44:47], v[88:91], v[12:15]
    ds_read_b64_tr_b16 v[60:61], v77 offset:3072
    ds_read_b64_tr_b16 v[62:63], v77 offset:3584
    v_cndmask_b32_dpp v232, v140, v136, vcc quad_perm:[1,0,3,2] row_mask:0xf bank_mask:0xf
    v_cndmask_b32_dpp v233, v141, v137, vcc quad_perm:[1,0,3,2] row_mask:0xf bank_mask:0xf
    v_mfma_f32_16x16x32_bf16 v[16:19], v[48:51], v[88:91], v[16:19]
    ds_read_b64_tr_b16 v[64:65], v78 offset:3072
    ds_read_b64_tr_b16 v[66:67], v78 offset:3584
    v_cndmask_b32_dpp v234, v142, v138, vcc quad_perm:[1,0,3,2] row_mask:0xf bank_mask:0xf
    v_cndmask_b32_dpp v235, v143, v139, vcc quad_perm:[1,0,3,2] row_mask:0xf bank_mask:0xf
    buffer_load_dwordx4 v[88:91], v71, s[36:39], s68 offen offset:0
    v_mfma_f32_16x16x32_bf16 v[20:23], v[36:39], v[104:107], v[20:23]
    s_mov_b32 vcc_lo, 0xaaaaaaaa
    s_mov_b32 vcc_hi, 0xaaaaaaaa
    v_cndmask_b32_dpp v228, v128, v132, vcc quad_perm:[1,0,3,2] row_mask:0xf bank_mask:0xf
    v_cndmask_b32_dpp v229, v129, v133, vcc quad_perm:[1,0,3,2] row_mask:0xf bank_mask:0xf
    v_mfma_f32_16x16x32_bf16 v[24:27], v[40:43], v[104:107], v[24:27]
    v_cndmask_b32_dpp v230, v130, v134, vcc quad_perm:[1,0,3,2] row_mask:0xf bank_mask:0xf
    v_cndmask_b32_dpp v231, v131, v135, vcc quad_perm:[1,0,3,2] row_mask:0xf bank_mask:0xf
    v_mfma_f32_16x16x32_bf16 v[28:31], v[44:47], v[104:107], v[28:31]
    v_cndmask_b32_dpp v236, v136, v140, vcc quad_perm:[1,0,3,2] row_mask:0xf bank_mask:0xf
    v_cndmask_b32_dpp v237, v137, v141, vcc quad_perm:[1,0,3,2] row_mask:0xf bank_mask:0xf
    v_mfma_f32_16x16x32_bf16 v[32:35], v[48:51], v[104:107], v[32:35]
    v_cndmask_b32_dpp v238, v138, v142, vcc quad_perm:[1,0,3,2] row_mask:0xf bank_mask:0xf
    v_cndmask_b32_dpp v239, v139, v143, vcc quad_perm:[1,0,3,2] row_mask:0xf bank_mask:0xf
    buffer_load_dwordx4 v[104:107], v72, s[36:39], s68 offen offset:0
    s_waitcnt lgkmcnt(0)
    v_xor_b32 v75, 0x4000, v75
    v_xor_b32 v76, 0x4000, v76
    v_xor_b32 v77, 0x4000, v77
    v_xor_b32 v78, 0x4000, v78
    v_mfma_f32_16x16x32_bf16 v[4:7], v[52:55], v[92:95], v[4:7]
    ds_read_b64_tr_b16 v[36:37], v75 offset:0
    ds_read_b64_tr_b16 v[38:39], v75 offset:512
    s_mov_b32 vcc_lo, 0x33333333
    s_mov_b32 vcc_hi, 0x33333333
    v_cndmask_b32_dpp v128, v232, v224, vcc quad_perm:[2,3,0,1] row_mask:0xf bank_mask:0xf
    v_cndmask_b32_dpp v129, v233, v225, vcc quad_perm:[2,3,0,1] row_mask:0xf bank_mask:0xf
    v_mfma_f32_16x16x32_bf16 v[8:11], v[56:59], v[92:95], v[8:11]
    ds_read_b64_tr_b16 v[40:41], v76 offset:0
    ds_read_b64_tr_b16 v[42:43], v76 offset:512
    v_cndmask_b32_dpp v130, v234, v226, vcc quad_perm:[2,3,0,1] row_mask:0xf bank_mask:0xf
    v_cndmask_b32_dpp v131, v235, v227, vcc quad_perm:[2,3,0,1] row_mask:0xf bank_mask:0xf
    v_mfma_f32_16x16x32_bf16 v[12:15], v[60:63], v[92:95], v[12:15]
    ds_read_b64_tr_b16 v[44:45], v77 offset:0
    ds_read_b64_tr_b16 v[46:47], v77 offset:512
    v_cndmask_b32_dpp v132, v236, v228, vcc quad_perm:[2,3,0,1] row_mask:0xf bank_mask:0xf
    v_cndmask_b32_dpp v133, v237, v229, vcc quad_perm:[2,3,0,1] row_mask:0xf bank_mask:0xf
    v_mfma_f32_16x16x32_bf16 v[16:19], v[64:67], v[92:95], v[16:19]
    ds_read_b64_tr_b16 v[48:49], v78 offset:0
    ds_read_b64_tr_b16 v[50:51], v78 offset:512
    v_cndmask_b32_dpp v134, v238, v230, vcc quad_perm:[2,3,0,1] row_mask:0xf bank_mask:0xf
    v_cndmask_b32_dpp v135, v239, v231, vcc quad_perm:[2,3,0,1] row_mask:0xf bank_mask:0xf
    buffer_load_dwordx4 v[92:95], v71, s[36:39], s68 offen offset:2048
    v_mfma_f32_16x16x32_bf16 v[20:23], v[52:55], v[108:111], v[20:23]
    s_mov_b32 vcc_lo, 0xcccccccc
    s_mov_b32 vcc_hi, 0xcccccccc
    v_cndmask_b32_dpp v136, v224, v232, vcc quad_perm:[2,3,0,1] row_mask:0xf bank_mask:0xf
    v_cndmask_b32_dpp v137, v225, v233, vcc quad_perm:[2,3,0,1] row_mask:0xf bank_mask:0xf
    v_mfma_f32_16x16x32_bf16 v[24:27], v[56:59], v[108:111], v[24:27]
    v_cndmask_b32_dpp v138, v226, v234, vcc quad_perm:[2,3,0,1] row_mask:0xf bank_mask:0xf
    v_cndmask_b32_dpp v139, v227, v235, vcc quad_perm:[2,3,0,1] row_mask:0xf bank_mask:0xf
    v_mfma_f32_16x16x32_bf16 v[28:31], v[60:63], v[108:111], v[28:31]
    v_cndmask_b32_dpp v140, v228, v236, vcc quad_perm:[2,3,0,1] row_mask:0xf bank_mask:0xf
    v_cndmask_b32_dpp v141, v229, v237, vcc quad_perm:[2,3,0,1] row_mask:0xf bank_mask:0xf
    v_mfma_f32_16x16x32_bf16 v[32:35], v[64:67], v[108:111], v[32:35]
    v_cndmask_b32_dpp v142, v230, v238, vcc quad_perm:[2,3,0,1] row_mask:0xf bank_mask:0xf
    v_cndmask_b32_dpp v143, v231, v239, vcc quad_perm:[2,3,0,1] row_mask:0xf bank_mask:0xf
    buffer_load_dwordx4 v[108:111], v72, s[36:39], s68 offen offset:2048
    v_xor_b32 v68, 0x100, v68
    v_xor_b32 v69, 0x100, v69
    v_xor_b32 v71, 0x100, v71
    v_xor_b32 v72, 0x100, v72
    s_cmp_lg_u32 s72, 0
    s_cbranch_scc1 p0sig_54
p0ret_55:
    s_waitcnt vmcnt(16) lgkmcnt(0)
    v_mfma_f32_16x16x32_bf16 v[4:7], v[36:39], v[112:115], v[4:7]
    ds_read_b64_tr_b16 v[52:53], v75 offset:1024
    ds_read_b64_tr_b16 v[54:55], v75 offset:1536
    s_mov_b32 vcc_lo, 0x55555555
    s_mov_b32 vcc_hi, 0x55555555
    v_cndmask_b32_dpp v224, v148, v144, vcc quad_perm:[1,0,3,2] row_mask:0xf bank_mask:0xf
    v_cndmask_b32_dpp v225, v149, v145, vcc quad_perm:[1,0,3,2] row_mask:0xf bank_mask:0xf
    v_mfma_f32_16x16x32_bf16 v[8:11], v[40:43], v[112:115], v[8:11]
    ds_read_b64_tr_b16 v[56:57], v76 offset:1024
    ds_read_b64_tr_b16 v[58:59], v76 offset:1536
    v_cndmask_b32_dpp v226, v150, v146, vcc quad_perm:[1,0,3,2] row_mask:0xf bank_mask:0xf
    v_cndmask_b32_dpp v227, v151, v147, vcc quad_perm:[1,0,3,2] row_mask:0xf bank_mask:0xf
    v_mfma_f32_16x16x32_bf16 v[12:15], v[44:47], v[112:115], v[12:15]
    ds_read_b64_tr_b16 v[60:61], v77 offset:1024
    ds_read_b64_tr_b16 v[62:63], v77 offset:1536
    v_cndmask_b32_dpp v232, v156, v152, vcc quad_perm:[1,0,3,2] row_mask:0xf bank_mask:0xf
    v_cndmask_b32_dpp v233, v157, v153, vcc quad_perm:[1,0,3,2] row_mask:0xf bank_mask:0xf
    v_mfma_f32_16x16x32_bf16 v[16:19], v[48:51], v[112:115], v[16:19]
    ds_read_b64_tr_b16 v[64:65], v78 offset:1024
    ds_read_b64_tr_b16 v[66:67], v78 offset:1536
    v_cndmask_b32_dpp v234, v158, v154, vcc quad_perm:[1,0,3,2] row_mask:0xf bank_mask:0xf
    v_cndmask_b32_dpp v235, v159, v155, vcc quad_perm:[1,0,3,2] row_mask:0xf bank_mask:0xf
    buffer_load_dwordx4 v[112:115], v68, s[36:39], s68 offen offset:0
    v_mfma_f32_16x16x32_bf16 v[20:23], v[36:39], v[128:131], v[20:23]
    s_mov_b32 vcc_lo, 0xaaaaaaaa
    s_mov_b32 vcc_hi, 0xaaaaaaaa
    v_cndmask_b32_dpp v228, v144, v148, vcc quad_perm:[1,0,3,2] row_mask:0xf bank_mask:0xf
    v_cndmask_b32_dpp v229, v145, v149, vcc quad_perm:[1,0,3,2] row_mask:0xf bank_mask:0xf
    v_mfma_f32_16x16x32_bf16 v[24:27], v[40:43], v[128:131], v[24:27]
    v_cndmask_b32_dpp v230, v146, v150, vcc quad_perm:[1,0,3,2] row_mask:0xf bank_mask:0xf
    v_cndmask_b32_dpp v231, v147, v151, vcc quad_perm:[1,0,3,2] row_mask:0xf bank_mask:0xf
    v_mfma_f32_16x16x32_bf16 v[28:31], v[44:47], v[128:131], v[28:31]
    v_cndmask_b32_dpp v236, v152, v156, vcc quad_perm:[1,0,3,2] row_mask:0xf bank_mask:0xf
    v_cndmask_b32_dpp v237, v153, v157, vcc quad_perm:[1,0,3,2] row_mask:0xf bank_mask:0xf
    v_mfma_f32_16x16x32_bf16 v[32:35], v[48:51], v[128:131], v[32:35]
    v_cndmask_b32_dpp v238, v154, v158, vcc quad_perm:[1,0,3,2] row_mask:0xf bank_mask:0xf
    v_cndmask_b32_dpp v239, v155, v159, vcc quad_perm:[1,0,3,2] row_mask:0xf bank_mask:0xf
    buffer_load_dwordx4 v[128:131], v69, s[36:39], s68 offen offset:0
    s_waitcnt lgkmcnt(0)
    v_mfma_f32_16x16x32_bf16 v[4:7], v[52:55], v[116:119], v[4:7]
    ds_read_b64_tr_b16 v[36:37], v75 offset:2048
    ds_read_b64_tr_b16 v[38:39], v75 offset:2560
    s_mov_b32 vcc_lo, 0x33333333
    s_mov_b32 vcc_hi, 0x33333333
    v_cndmask_b32_dpp v144, v232, v224, vcc quad_perm:[2,3,0,1] row_mask:0xf bank_mask:0xf
    v_cndmask_b32_dpp v145, v233, v225, vcc quad_perm:[2,3,0,1] row_mask:0xf bank_mask:0xf
    v_mfma_f32_16x16x32_bf16 v[8:11], v[56:59], v[116:119], v[8:11]
    ds_read_b64_tr_b16 v[40:41], v76 offset:2048
    ds_read_b64_tr_b16 v[42:43], v76 offset:2560
    v_cndmask_b32_dpp v146, v234, v226, vcc quad_perm:[2,3,0,1] row_mask:0xf bank_mask:0xf
    v_cndmask_b32_dpp v147, v235, v227, vcc quad_perm:[2,3,0,1] row_mask:0xf bank_mask:0xf
    v_mfma_f32_16x16x32_bf16 v[12:15], v[60:63], v[116:119], v[12:15]
    ds_read_b64_tr_b16 v[44:45], v77 offset:2048
    ds_read_b64_tr_b16 v[46:47], v77 offset:2560
    v_cndmask_b32_dpp v148, v236, v228, vcc quad_perm:[2,3,0,1] row_mask:0xf bank_mask:0xf
    v_cndmask_b32_dpp v149, v237, v229, vcc quad_perm:[2,3,0,1] row_mask:0xf bank_mask:0xf
    v_mfma_f32_16x16x32_bf16 v[16:19], v[64:67], v[116:119], v[16:19]
    ds_read_b64_tr_b16 v[48:49], v78 offset:2048
    ds_read_b64_tr_b16 v[50:51], v78 offset:2560
    v_cndmask_b32_dpp v150, v238, v230, vcc quad_perm:[2,3,0,1] row_mask:0xf bank_mask:0xf
    v_cndmask_b32_dpp v151, v239, v231, vcc quad_perm:[2,3,0,1] row_mask:0xf bank_mask:0xf
    buffer_load_dwordx4 v[116:119], v68, s[36:39], s68 offen offset:2048
    v_mfma_f32_16x16x32_bf16 v[20:23], v[52:55], v[132:135], v[20:23]
    s_mov_b32 vcc_lo, 0xcccccccc
    s_mov_b32 vcc_hi, 0xcccccccc
    v_cndmask_b32_dpp v152, v224, v232, vcc quad_perm:[2,3,0,1] row_mask:0xf bank_mask:0xf
    v_cndmask_b32_dpp v153, v225, v233, vcc quad_perm:[2,3,0,1] row_mask:0xf bank_mask:0xf
    v_mfma_f32_16x16x32_bf16 v[24:27], v[56:59], v[132:135], v[24:27]
    v_cndmask_b32_dpp v154, v226, v234, vcc quad_perm:[2,3,0,1] row_mask:0xf bank_mask:0xf
    v_cndmask_b32_dpp v155, v227, v235, vcc quad_perm:[2,3,0,1] row_mask:0xf bank_mask:0xf
    v_mfma_f32_16x16x32_bf16 v[28:31], v[60:63], v[132:135], v[28:31]
    v_cndmask_b32_dpp v156, v228, v236, vcc quad_perm:[2,3,0,1] row_mask:0xf bank_mask:0xf
    v_cndmask_b32_dpp v157, v229, v237, vcc quad_perm:[2,3,0,1] row_mask:0xf bank_mask:0xf
    v_mfma_f32_16x16x32_bf16 v[32:35], v[64:67], v[132:135], v[32:35]
    v_cndmask_b32_dpp v158, v230, v238, vcc quad_perm:[2,3,0,1] row_mask:0xf bank_mask:0xf
    v_cndmask_b32_dpp v159, v231, v239, vcc quad_perm:[2,3,0,1] row_mask:0xf bank_mask:0xf
    buffer_load_dwordx4 v[132:135], v69, s[36:39], s68 offen offset:2048
    s_waitcnt lgkmcnt(0)
    v_mfma_f32_16x16x32_bf16 v[4:7], v[36:39], v[120:123], v[4:7]
    ds_read_b64_tr_b16 v[52:53], v75 offset:3072
    ds_read_b64_tr_b16 v[54:55], v75 offset:3584
    s_mov_b32 vcc_lo, 0x55555555
    s_mov_b32 vcc_hi, 0x55555555
    v_cndmask_b32_dpp v224, v164, v160, vcc quad_perm:[1,0,3,2] row_mask:0xf bank_mask:0xf
    v_cndmask_b32_dpp v225, v165, v161, vcc quad_perm:[1,0,3,2] row_mask:0xf bank_mask:0xf
    v_mfma_f32_16x16x32_bf16 v[8:11], v[40:43], v[120:123], v[8:11]
    ds_read_b64_tr_b16 v[56:57], v76 offset:3072
    ds_read_b64_tr_b16 v[58:59], v76 offset:3584
    v_cndmask_b32_dpp v226, v166, v162, vcc quad_perm:[1,0,3,2] row_mask:0xf bank_mask:0xf
    v_cndmask_b32_dpp v227, v167, v163, vcc quad_perm:[1,0,3,2] row_mask:0xf bank_mask:0xf
    v_mfma_f32_16x16x32_bf16 v[12:15], v[44:47], v[120:123], v[12:15]
    ds_read_b64_tr_b16 v[60:61], v77 offset:3072
    ds_read_b64_tr_b16 v[62:63], v77 offset:3584
    v_cndmask_b32_dpp v232, v172, v168, vcc quad_perm:[1,0,3,2] row_mask:0xf bank_mask:0xf
    v_cndmask_b32_dpp v233, v173, v169, vcc quad_perm:[1,0,3,2] row_mask:0xf bank_mask:0xf
    v_mfma_f32_16x16x32_bf16 v[16:19], v[48:51], v[120:123], v[16:19]
    ds_read_b64_tr_b16 v[64:65], v78 offset:3072
    ds_read_b64_tr_b16 v[66:67], v78 offset:3584
    v_cndmask_b32_dpp v234, v174, v170, vcc quad_perm:[1,0,3,2] row_mask:0xf bank_mask:0xf
    v_cndmask_b32_dpp v235, v175, v171, vcc quad_perm:[1,0,3,2] row_mask:0xf bank_mask:0xf
    buffer_load_dwordx4 v[120:123], v71, s[36:39], s68 offen offset:0
    v_mfma_f32_16x16x32_bf16 v[20:23], v[36:39], v[136:139], v[20:23]
    s_mov_b32 vcc_lo, 0xaaaaaaaa
    s_mov_b32 vcc_hi, 0xaaaaaaaa
    v_cndmask_b32_dpp v228, v160, v164, vcc quad_perm:[1,0,3,2] row_mask:0xf bank_mask:0xf
    v_cndmask_b32_dpp v229, v161, v165, vcc quad_perm:[1,0,3,2] row_mask:0xf bank_mask:0xf
    v_mfma_f32_16x16x32_bf16 v[24:27], v[40:43], v[136:139], v[24:27]
    v_cndmask_b32_dpp v230, v162, v166, vcc quad_perm:[1,0,3,2] row_mask:0xf bank_mask:0xf
    v_cndmask_b32_dpp v231, v163, v167, vcc quad_perm:[1,0,3,2] row_mask:0xf bank_mask:0xf
    v_mfma_f32_16x16x32_bf16 v[28:31], v[44:47], v[136:139], v[28:31]
    v_cndmask_b32_dpp v236, v168, v172, vcc quad_perm:[1,0,3,2] row_mask:0xf bank_mask:0xf
    v_cndmask_b32_dpp v237, v169, v173, vcc quad_perm:[1,0,3,2] row_mask:0xf bank_mask:0xf
    v_mfma_f32_16x16x32_bf16 v[32:35], v[48:51], v[136:139], v[32:35]
    v_cndmask_b32_dpp v238, v170, v174, vcc quad_perm:[1,0,3,2] row_mask:0xf bank_mask:0xf
    v_cndmask_b32_dpp v239, v171, v175, vcc quad_perm:[1,0,3,2] row_mask:0xf bank_mask:0xf
    buffer_load_dwordx4 v[136:139], v72, s[36:39], s68 offen offset:0
    s_waitcnt lgkmcnt(0)
    v_xor_b32 v75, 0xc000, v75
    v_xor_b32 v76, 0xc000, v76
    v_xor_b32 v77, 0xc000, v77
    v_xor_b32 v78, 0xc000, v78
    v_mfma_f32_16x16x32_bf16 v[4:7], v[52:55], v[124:127], v[4:7]
    ds_read_b64_tr_b16 v[36:37], v75 offset:0
    ds_read_b64_tr_b16 v[38:39], v75 offset:512
    s_mov_b32 vcc_lo, 0x33333333
    s_mov_b32 vcc_hi, 0x33333333
    v_cndmask_b32_dpp v160, v232, v224, vcc quad_perm:[2,3,0,1] row_mask:0xf bank_mask:0xf
    v_cndmask_b32_dpp v161, v233, v225, vcc quad_perm:[2,3,0,1] row_mask:0xf bank_mask:0xf
    v_mfma_f32_16x16x32_bf16 v[8:11], v[56:59], v[124:127], v[8:11]
    ds_read_b64_tr_b16 v[40:41], v76 offset:0
    ds_read_b64_tr_b16 v[42:43], v76 offset:512
    v_cndmask_b32_dpp v162, v234, v226, vcc quad_perm:[2,3,0,1] row_mask:0xf bank_mask:0xf
    v_cndmask_b32_dpp v163, v235, v227, vcc quad_perm:[2,3,0,1] row_mask:0xf bank_mask:0xf
    v_mfma_f32_16x16x32_bf16 v[12:15], v[60:63], v[124:127], v[12:15]
    ds_read_b64_tr_b16 v[44:45], v77 offset:0
    ds_read_b64_tr_b16 v[46:47], v77 offset:512
    v_cndmask_b32_dpp v164, v236, v228, vcc quad_perm:[2,3,0,1] row_mask:0xf bank_mask:0xf
    v_cndmask_b32_dpp v165, v237, v229, vcc quad_perm:[2,3,0,1] row_mask:0xf bank_mask:0xf
    v_mfma_f32_16x16x32_bf16 v[16:19], v[64:67], v[124:127], v[16:19]
    ds_read_b64_tr_b16 v[48:49], v78 offset:0
    ds_read_b64_tr_b16 v[50:51], v78 offset:512
    v_cndmask_b32_dpp v166, v238, v230, vcc quad_perm:[2,3,0,1] row_mask:0xf bank_mask:0xf
    v_cndmask_b32_dpp v167, v239, v231, vcc quad_perm:[2,3,0,1] row_mask:0xf bank_mask:0xf
    buffer_load_dwordx4 v[124:127], v71, s[36:39], s68 offen offset:2048
    v_mfma_f32_16x16x32_bf16 v[20:23], v[52:55], v[140:143], v[20:23]
    s_mov_b32 vcc_lo, 0xcccccccc
    s_mov_b32 vcc_hi, 0xcccccccc
    v_cndmask_b32_dpp v168, v224, v232, vcc quad_perm:[2,3,0,1] row_mask:0xf bank_mask:0xf
    v_cndmask_b32_dpp v169, v225, v233, vcc quad_perm:[2,3,0,1] row_mask:0xf bank_mask:0xf
    v_mfma_f32_16x16x32_bf16 v[24:27], v[56:59], v[140:143], v[24:27]
    v_cndmask_b32_dpp v170, v226, v234, vcc quad_perm:[2,3,0,1] row_mask:0xf bank_mask:0xf
    v_cndmask_b32_dpp v171, v227, v235, vcc quad_perm:[2,3,0,1] row_mask:0xf bank_mask:0xf
    v_mfma_f32_16x16x32_bf16 v[28:31], v[60:63], v[140:143], v[28:31]
    v_cndmask_b32_dpp v172, v228, v236, vcc quad_perm:[2,3,0,1] row_mask:0xf bank_mask:0xf
    v_cndmask_b32_dpp v173, v229, v237, vcc quad_perm:[2,3,0,1] row_mask:0xf bank_mask:0xf
    v_mfma_f32_16x16x32_bf16 v[32:35], v[64:67], v[140:143], v[32:35]
    v_cndmask_b32_dpp v174, v230, v238, vcc quad_perm:[2,3,0,1] row_mask:0xf bank_mask:0xf
    v_cndmask_b32_dpp v175, v231, v239, vcc quad_perm:[2,3,0,1] row_mask:0xf bank_mask:0xf
    buffer_load_dwordx4 v[140:143], v72, s[36:39], s68 offen offset:2048
    v_xor_b32 v68, 0x300, v68
    v_xor_b32 v69, 0x300, v69
    v_xor_b32 v71, 0x300, v71
    v_xor_b32 v72, 0x300, v72
    s_waitcnt vmcnt(16) lgkmcnt(0)
    v_mfma_f32_16x16x32_bf16 v[4:7], v[36:39], v[144:147], v[4:7]
    ds_read_b64_tr_b16 v[52:53], v75 offset:1024
    ds_read_b64_tr_b16 v[54:55], v75 offset:1536
    s_mov_b32 vcc_lo, 0x55555555
    s_mov_b32 vcc_hi, 0x55555555
    v_cndmask_b32_dpp v224, v180, v176, vcc quad_perm:[1,0,3,2] row_mask:0xf bank_mask:0xf
    v_cndmask_b32_dpp v225, v181, v177, vcc quad_perm:[1,0,3,2] row_mask:0xf bank_mask:0xf
    v_mfma_f32_16x16x32_bf16 v[8:11], v[40:43], v[144:147], v[8:11]
    ds_read_b64_tr_b16 v[56:57], v76 offset:1024
    ds_read_b64_tr_b16 v[58:59], v76 offset:1536
    v_cndmask_b32_dpp v226, v182, v178, vcc quad_perm:[1,0,3,2] row_mask:0xf bank_mask:0xf
    v_cndmask_b32_dpp v227, v183, v179, vcc quad_perm:[1,0,3,2] row_mask:0xf bank_mask:0xf
    v_mfma_f32_16x16x32_bf16 v[12:15], v[44:47], v[144:147], v[12:15]
    ds_read_b64_tr_b16 v[60:61], v77 offset:1024
    ds_read_b64_tr_b16 v[62:63], v77 offset:1536
    v_cndmask_b32_dpp v232, v188, v184, vcc quad_perm:[1,0,3,2] row_mask:0xf bank_mask:0xf
    v_cndmask_b32_dpp v233, v189, v185, vcc quad_perm:[1,0,3,2] row_mask:0xf bank_mask:0xf
    v_mfma_f32_16x16x32_bf16 v[16:19], v[48:51], v[144:147], v[16:19]
    ds_read_b64_tr_b16 v[64:65], v78 offset:1024
    ds_read_b64_tr_b16 v[66:67], v78 offset:1536
    v_cndmask_b32_dpp v234, v190, v186, vcc quad_perm:[1,0,3,2] row_mask:0xf bank_mask:0xf
    v_cndmask_b32_dpp v235, v191, v187, vcc quad_perm:[1,0,3,2] row_mask:0xf bank_mask:0xf
    buffer_load_dwordx4 v[144:147], v68, s[36:39], s68 offen offset:0
    v_mfma_f32_16x16x32_bf16 v[20:23], v[36:39], v[160:163], v[20:23]
    s_mov_b32 vcc_lo, 0xaaaaaaaa
    s_mov_b32 vcc_hi, 0xaaaaaaaa
    v_cndmask_b32_dpp v228, v176, v180, vcc quad_perm:[1,0,3,2] row_mask:0xf bank_mask:0xf
    v_cndmask_b32_dpp v229, v177, v181, vcc quad_perm:[1,0,3,2] row_mask:0xf bank_mask:0xf
    v_mfma_f32_16x16x32_bf16 v[24:27], v[40:43], v[160:163], v[24:27]
    v_cndmask_b32_dpp v230, v178, v182, vcc quad_perm:[1,0,3,2] row_mask:0xf bank_mask:0xf
    v_cndmask_b32_dpp v231, v179, v183, vcc quad_perm:[1,0,3,2] row_mask:0xf bank_mask:0xf
    v_mfma_f32_16x16x32_bf16 v[28:31], v[44:47], v[160:163], v[28:31]
    v_cndmask_b32_dpp v236, v184, v188, vcc quad_perm:[1,0,3,2] row_mask:0xf bank_mask:0xf
    v_cndmask_b32_dpp v237, v185, v189, vcc quad_perm:[1,0,3,2] row_mask:0xf bank_mask:0xf
    v_mfma_f32_16x16x32_bf16 v[32:35], v[48:51], v[160:163], v[32:35]
    v_cndmask_b32_dpp v238, v186, v190, vcc quad_perm:[1,0,3,2] row_mask:0xf bank_mask:0xf
    v_cndmask_b32_dpp v239, v187, v191, vcc quad_perm:[1,0,3,2] row_mask:0xf bank_mask:0xf
    buffer_load_dwordx4 v[160:163], v69, s[36:39], s68 offen offset:0
    s_waitcnt lgkmcnt(0)
    v_mfma_f32_16x16x32_bf16 v[4:7], v[52:55], v[148:151], v[4:7]
    ds_read_b64_tr_b16 v[36:37], v75 offset:2048
    ds_read_b64_tr_b16 v[38:39], v75 offset:2560
    s_mov_b32 vcc_lo, 0x33333333
    s_mov_b32 vcc_hi, 0x33333333
    v_cndmask_b32_dpp v176, v232, v224, vcc quad_perm:[2,3,0,1] row_mask:0xf bank_mask:0xf
    v_cndmask_b32_dpp v177, v233, v225, vcc quad_perm:[2,3,0,1] row_mask:0xf bank_mask:0xf
    v_mfma_f32_16x16x32_bf16 v[8:11], v[56:59], v[148:151], v[8:11]
    ds_read_b64_tr_b16 v[40:41], v76 offset:2048
    ds_read_b64_tr_b16 v[42:43], v76 offset:2560
    v_cndmask_b32_dpp v178, v234, v226, vcc quad_perm:[2,3,0,1] row_mask:0xf bank_mask:0xf
    v_cndmask_b32_dpp v179, v235, v227, vcc quad_perm:[2,3,0,1] row_mask:0xf bank_mask:0xf
    v_mfma_f32_16x16x32_bf16 v[12:15], v[60:63], v[148:151], v[12:15]
    ds_read_b64_tr_b16 v[44:45], v77 offset:2048
    ds_read_b64_tr_b16 v[46:47], v77 offset:2560
    v_cndmask_b32_dpp v180, v236, v228, vcc quad_perm:[2,3,0,1] row_mask:0xf bank_mask:0xf
    v_cndmask_b32_dpp v181, v237, v229, vcc quad_perm:[2,3,0,1] row_mask:0xf bank_mask:0xf
    v_mfma_f32_16x16x32_bf16 v[16:19], v[64:67], v[148:151], v[16:19]
    ds_read_b64_tr_b16 v[48:49], v78 offset:2048
    ds_read_b64_tr_b16 v[50:51], v78 offset:2560
    v_cndmask_b32_dpp v182, v238, v230, vcc quad_perm:[2,3,0,1] row_mask:0xf bank_mask:0xf
    v_cndmask_b32_dpp v183, v239, v231, vcc quad_perm:[2,3,0,1] row_mask:0xf bank_mask:0xf
    buffer_load_dwordx4 v[148:151], v68, s[36:39], s68 offen offset:2048
    v_mfma_f32_16x16x32_bf16 v[20:23], v[52:55], v[164:167], v[20:23]
    s_mov_b32 vcc_lo, 0xcccccccc
    s_mov_b32 vcc_hi, 0xcccccccc
    v_cndmask_b32_dpp v184, v224, v232, vcc quad_perm:[2,3,0,1] row_mask:0xf bank_mask:0xf
    v_cndmask_b32_dpp v185, v225, v233, vcc quad_perm:[2,3,0,1] row_mask:0xf bank_mask:0xf
    v_mfma_f32_16x16x32_bf16 v[24:27], v[56:59], v[164:167], v[24:27]
    v_cndmask_b32_dpp v186, v226, v234, vcc quad_perm:[2,3,0,1] row_mask:0xf bank_mask:0xf
    v_cndmask_b32_dpp v187, v227, v235, vcc quad_perm:[2,3,0,1] row_mask:0xf bank_mask:0xf
    v_mfma_f32_16x16x32_bf16 v[28:31], v[60:63], v[164:167], v[28:31]
    v_cndmask_b32_dpp v188, v228, v236, vcc quad_perm:[2,3,0,1] row_mask:0xf bank_mask:0xf
    v_cndmask_b32_dpp v189, v229, v237, vcc quad_perm:[2,3,0,1] row_mask:0xf bank_mask:0xf
    v_mfma_f32_16x16x32_bf16 v[32:35], v[64:67], v[164:167], v[32:35]
    v_cndmask_b32_dpp v190, v230, v238, vcc quad_perm:[2,3,0,1] row_mask:0xf bank_mask:0xf
    v_cndmask_b32_dpp v191, v231, v239, vcc quad_perm:[2,3,0,1] row_mask:0xf bank_mask:0xf
    buffer_load_dwordx4 v[164:167], v69, s[36:39], s68 offen offset:2048
    s_waitcnt lgkmcnt(0)
    v_mfma_f32_16x16x32_bf16 v[4:7], v[36:39], v[152:155], v[4:7]
    ds_read_b64_tr_b16 v[52:53], v75 offset:3072
    ds_read_b64_tr_b16 v[54:55], v75 offset:3584
    s_mov_b32 vcc_lo, 0x55555555
    s_mov_b32 vcc_hi, 0x55555555
    v_cndmask_b32_dpp v224, v196, v192, vcc quad_perm:[1,0,3,2] row_mask:0xf bank_mask:0xf
    v_cndmask_b32_dpp v225, v197, v193, vcc quad_perm:[1,0,3,2] row_mask:0xf bank_mask:0xf
    v_mfma_f32_16x16x32_bf16 v[8:11], v[40:43], v[152:155], v[8:11]
    ds_read_b64_tr_b16 v[56:57], v76 offset:3072
    ds_read_b64_tr_b16 v[58:59], v76 offset:3584
    v_cndmask_b32_dpp v226, v198, v194, vcc quad_perm:[1,0,3,2] row_mask:0xf bank_mask:0xf
    v_cndmask_b32_dpp v227, v199, v195, vcc quad_perm:[1,0,3,2] row_mask:0xf bank_mask:0xf
    v_mfma_f32_16x16x32_bf16 v[12:15], v[44:47], v[152:155], v[12:15]
    ds_read_b64_tr_b16 v[60:61], v77 offset:3072
    ds_read_b64_tr_b16 v[62:63], v77 offset:3584
    v_cndmask_b32_dpp v232, v204, v200, vcc quad_perm:[1,0,3,2] row_mask:0xf bank_mask:0xf
    v_cndmask_b32_dpp v233, v205, v201, vcc quad_perm:[1,0,3,2] row_mask:0xf bank_mask:0xf
    v_mfma_f32_16x16x32_bf16 v[16:19], v[48:51], v[152:155], v[16:19]
    ds_read_b64_tr_b16 v[64:65], v78 offset:3072
    ds_read_b64_tr_b16 v[66:67], v78 offset:3584
    v_cndmask_b32_dpp v234, v206, v202, vcc quad_perm:[1,0,3,2] row_mask:0xf bank_mask:0xf
    v_cndmask_b32_dpp v235, v207, v203, vcc quad_perm:[1,0,3,2] row_mask:0xf bank_mask:0xf
    buffer_load_dwordx4 v[152:155], v71, s[36:39], s68 offen offset:0
    v_mfma_f32_16x16x32_bf16 v[20:23], v[36:39], v[168:171], v[20:23]
    s_mov_b32 vcc_lo, 0xaaaaaaaa
    s_mov_b32 vcc_hi, 0xaaaaaaaa
    v_cndmask_b32_dpp v228, v192, v196, vcc quad_perm:[1,0,3,2] row_mask:0xf bank_mask:0xf
    v_cndmask_b32_dpp v229, v193, v197, vcc quad_perm:[1,0,3,2] row_mask:0xf bank_mask:0xf
    v_mfma_f32_16x16x32_bf16 v[24:27], v[40:43], v[168:171], v[24:27]
    v_cndmask_b32_dpp v230, v194, v198, vcc quad_perm:[1,0,3,2] row_mask:0xf bank_mask:0xf
    v_cndmask_b32_dpp v231, v195, v199, vcc quad_perm:[1,0,3,2] row_mask:0xf bank_mask:0xf
    v_mfma_f32_16x16x32_bf16 v[28:31], v[44:47], v[168:171], v[28:31]
    v_cndmask_b32_dpp v236, v200, v204, vcc quad_perm:[1,0,3,2] row_mask:0xf bank_mask:0xf
    v_cndmask_b32_dpp v237, v201, v205, vcc quad_perm:[1,0,3,2] row_mask:0xf bank_mask:0xf
    v_mfma_f32_16x16x32_bf16 v[32:35], v[48:51], v[168:171], v[32:35]
    v_cndmask_b32_dpp v238, v202, v206, vcc quad_perm:[1,0,3,2] row_mask:0xf bank_mask:0xf
    v_cndmask_b32_dpp v239, v203, v207, vcc quad_perm:[1,0,3,2] row_mask:0xf bank_mask:0xf
    buffer_load_dwordx4 v[168:171], v72, s[36:39], s68 offen offset:0
    s_waitcnt lgkmcnt(0)
    v_xor_b32 v75, 0x4000, v75
    v_xor_b32 v76, 0x4000, v76
    v_xor_b32 v77, 0x4000, v77
    v_xor_b32 v78, 0x4000, v78
    v_mfma_f32_16x16x32_bf16 v[4:7], v[52:55], v[156:159], v[4:7]
    ds_read_b64_tr_b16 v[36:37], v75 offset:0
    ds_read_b64_tr_b16 v[38:39], v75 offset:512
    s_mov_b32 vcc_lo, 0x33333333
    s_mov_b32 vcc_hi, 0x33333333
    v_cndmask_b32_dpp v192, v232, v224, vcc quad_perm:[2,3,0,1] row_mask:0xf bank_mask:0xf
    v_cndmask_b32_dpp v193, v233, v225, vcc quad_perm:[2,3,0,1] row_mask:0xf bank_mask:0xf
    v_mfma_f32_16x16x32_bf16 v[8:11], v[56:59], v[156:159], v[8:11]
    ds_read_b64_tr_b16 v[40:41], v76 offset:0
    ds_read_b64_tr_b16 v[42:43], v76 offset:512
    v_cndmask_b32_dpp v194, v234, v226, vcc quad_perm:[2,3,0,1] row_mask:0xf bank_mask:0xf
    v_cndmask_b32_dpp v195, v235, v227, vcc quad_perm:[2,3,0,1] row_mask:0xf bank_mask:0xf
    v_mfma_f32_16x16x32_bf16 v[12:15], v[60:63], v[156:159], v[12:15]
    ds_read_b64_tr_b16 v[44:45], v77 offset:0
    ds_read_b64_tr_b16 v[46:47], v77 offset:512
    v_cndmask_b32_dpp v196, v236, v228, vcc quad_perm:[2,3,0,1] row_mask:0xf bank_mask:0xf
    v_cndmask_b32_dpp v197, v237, v229, vcc quad_perm:[2,3,0,1] row_mask:0xf bank_mask:0xf
    v_mfma_f32_16x16x32_bf16 v[16:19], v[64:67], v[156:159], v[16:19]
    ds_read_b64_tr_b16 v[48:49], v78 offset:0
    ds_read_b64_tr_b16 v[50:51], v78 offset:512
    v_cndmask_b32_dpp v198, v238, v230, vcc quad_perm:[2,3,0,1] row_mask:0xf bank_mask:0xf
    v_cndmask_b32_dpp v199, v239, v231, vcc quad_perm:[2,3,0,1] row_mask:0xf bank_mask:0xf
    buffer_load_dwordx4 v[156:159], v71, s[36:39], s68 offen offset:2048
    v_mfma_f32_16x16x32_bf16 v[20:23], v[52:55], v[172:175], v[20:23]
    s_mov_b32 vcc_lo, 0xcccccccc
    s_mov_b32 vcc_hi, 0xcccccccc
    v_cndmask_b32_dpp v200, v224, v232, vcc quad_perm:[2,3,0,1] row_mask:0xf bank_mask:0xf
    v_cndmask_b32_dpp v201, v225, v233, vcc quad_perm:[2,3,0,1] row_mask:0xf bank_mask:0xf
    v_mfma_f32_16x16x32_bf16 v[24:27], v[56:59], v[172:175], v[24:27]
    v_cndmask_b32_dpp v202, v226, v234, vcc quad_perm:[2,3,0,1] row_mask:0xf bank_mask:0xf
    v_cndmask_b32_dpp v203, v227, v235, vcc quad_perm:[2,3,0,1] row_mask:0xf bank_mask:0xf
    v_mfma_f32_16x16x32_bf16 v[28:31], v[60:63], v[172:175], v[28:31]
    v_cndmask_b32_dpp v204, v228, v236, vcc quad_perm:[2,3,0,1] row_mask:0xf bank_mask:0xf
    v_cndmask_b32_dpp v205, v229, v237, vcc quad_perm:[2,3,0,1] row_mask:0xf bank_mask:0xf
    v_mfma_f32_16x16x32_bf16 v[32:35], v[64:67], v[172:175], v[32:35]
    v_cndmask_b32_dpp v206, v230, v238, vcc quad_perm:[2,3,0,1] row_mask:0xf bank_mask:0xf
    v_cndmask_b32_dpp v207, v231, v239, vcc quad_perm:[2,3,0,1] row_mask:0xf bank_mask:0xf
    buffer_load_dwordx4 v[172:175], v72, s[36:39], s68 offen offset:2048
    v_xor_b32 v68, 0x100, v68
    v_xor_b32 v69, 0x100, v69
    v_xor_b32 v71, 0x100, v71
    v_xor_b32 v72, 0x100, v72
    s_waitcnt vmcnt(16) lgkmcnt(0)
    v_mfma_f32_16x16x32_bf16 v[4:7], v[36:39], v[176:179], v[4:7]
    ds_read_b64_tr_b16 v[52:53], v75 offset:1024
    ds_read_b64_tr_b16 v[54:55], v75 offset:1536
    s_mov_b32 vcc_lo, 0x55555555
    s_mov_b32 vcc_hi, 0x55555555
    v_cndmask_b32_dpp v224, v84, v80, vcc quad_perm:[1,0,3,2] row_mask:0xf bank_mask:0xf
    v_cndmask_b32_dpp v225, v85, v81, vcc quad_perm:[1,0,3,2] row_mask:0xf bank_mask:0xf
    v_mfma_f32_16x16x32_bf16 v[8:11], v[40:43], v[176:179], v[8:11]
    ds_read_b64_tr_b16 v[56:57], v76 offset:1024
    ds_read_b64_tr_b16 v[58:59], v76 offset:1536
    v_cndmask_b32_dpp v226, v86, v82, vcc quad_perm:[1,0,3,2] row_mask:0xf bank_mask:0xf
    v_cndmask_b32_dpp v227, v87, v83, vcc quad_perm:[1,0,3,2] row_mask:0xf bank_mask:0xf
    v_mfma_f32_16x16x32_bf16 v[12:15], v[44:47], v[176:179], v[12:15]
    ds_read_b64_tr_b16 v[60:61], v77 offset:1024
    ds_read_b64_tr_b16 v[62:63], v77 offset:1536
    v_cndmask_b32_dpp v232, v92, v88, vcc quad_perm:[1,0,3,2] row_mask:0xf bank_mask:0xf
    v_cndmask_b32_dpp v233, v93, v89, vcc quad_perm:[1,0,3,2] row_mask:0xf bank_mask:0xf
    v_mfma_f32_16x16x32_bf16 v[16:19], v[48:51], v[176:179], v[16:19]
    ds_read_b64_tr_b16 v[64:65], v78 offset:1024
    ds_read_b64_tr_b16 v[66:67], v78 offset:1536
    v_cndmask_b32_dpp v234, v94, v90, vcc quad_perm:[1,0,3,2] row_mask:0xf bank_mask:0xf
    v_cndmask_b32_dpp v235, v95, v91, vcc quad_perm:[1,0,3,2] row_mask:0xf bank_mask:0xf
    buffer_load_dwordx4 v[176:179], v68, s[36:39], s68 offen offset:0
    v_mfma_f32_16x16x32_bf16 v[20:23], v[36:39], v[192:195], v[20:23]
    s_mov_b32 vcc_lo, 0xaaaaaaaa
    s_mov_b32 vcc_hi, 0xaaaaaaaa
    v_cndmask_b32_dpp v228, v80, v84, vcc quad_perm:[1,0,3,2] row_mask:0xf bank_mask:0xf
    v_cndmask_b32_dpp v229, v81, v85, vcc quad_perm:[1,0,3,2] row_mask:0xf bank_mask:0xf
    v_mfma_f32_16x16x32_bf16 v[24:27], v[40:43], v[192:195], v[24:27]
    v_cndmask_b32_dpp v230, v82, v86, vcc quad_perm:[1,0,3,2] row_mask:0xf bank_mask:0xf
    v_cndmask_b32_dpp v231, v83, v87, vcc quad_perm:[1,0,3,2] row_mask:0xf bank_mask:0xf
    v_mfma_f32_16x16x32_bf16 v[28:31], v[44:47], v[192:195], v[28:31]
    v_cndmask_b32_dpp v236, v88, v92, vcc quad_perm:[1,0,3,2] row_mask:0xf bank_mask:0xf
    v_cndmask_b32_dpp v237, v89, v93, vcc quad_perm:[1,0,3,2] row_mask:0xf bank_mask:0xf
    v_mfma_f32_16x16x32_bf16 v[32:35], v[48:51], v[192:195], v[32:35]
    v_cndmask_b32_dpp v238, v90, v94, vcc quad_perm:[1,0,3,2] row_mask:0xf bank_mask:0xf
    v_cndmask_b32_dpp v239, v91, v95, vcc quad_perm:[1,0,3,2] row_mask:0xf bank_mask:0xf
    buffer_load_dwordx4 v[192:195], v69, s[36:39], s68 offen offset:0
    s_waitcnt lgkmcnt(0)
    v_mfma_f32_16x16x32_bf16 v[4:7], v[52:55], v[180:183], v[4:7]
    ds_read_b64_tr_b16 v[36:37], v75 offset:2048
    ds_read_b64_tr_b16 v[38:39], v75 offset:2560
    s_mov_b32 vcc_lo, 0x33333333
    s_mov_b32 vcc_hi, 0x33333333
    v_cndmask_b32_dpp v80, v232, v224, vcc quad_perm:[2,3,0,1] row_mask:0xf bank_mask:0xf
    v_cndmask_b32_dpp v81, v233, v225, vcc quad_perm:[2,3,0,1] row_mask:0xf bank_mask:0xf
    v_mfma_f32_16x16x32_bf16 v[8:11], v[56:59], v[180:183], v[8:11]
    ds_read_b64_tr_b16 v[40:41], v76 offset:2048
    ds_read_b64_tr_b16 v[42:43], v76 offset:2560
    v_cndmask_b32_dpp v82, v234, v226, vcc quad_perm:[2,3,0,1] row_mask:0xf bank_mask:0xf
    v_cndmask_b32_dpp v83, v235, v227, vcc quad_perm:[2,3,0,1] row_mask:0xf bank_mask:0xf
    v_mfma_f32_16x16x32_bf16 v[12:15], v[60:63], v[180:183], v[12:15]
    ds_read_b64_tr_b16 v[44:45], v77 offset:2048
    ds_read_b64_tr_b16 v[46:47], v77 offset:2560
    v_cndmask_b32_dpp v84, v236, v228, vcc quad_perm:[2,3,0,1] row_mask:0xf bank_mask:0xf
    v_cndmask_b32_dpp v85, v237, v229, vcc quad_perm:[2,3,0,1] row_mask:0xf bank_mask:0xf
    v_mfma_f32_16x16x32_bf16 v[16:19], v[64:67], v[180:183], v[16:19]
    ds_read_b64_tr_b16 v[48:49], v78 offset:2048
    ds_read_b64_tr_b16 v[50:51], v78 offset:2560
    v_cndmask_b32_dpp v86, v238, v230, vcc quad_perm:[2,3,0,1] row_mask:0xf bank_mask:0xf
    v_cndmask_b32_dpp v87, v239, v231, vcc quad_perm:[2,3,0,1] row_mask:0xf bank_mask:0xf
    buffer_load_dwordx4 v[180:183], v68, s[36:39], s68 offen offset:2048
    v_mfma_f32_16x16x32_bf16 v[20:23], v[52:55], v[196:199], v[20:23]
    s_mov_b32 vcc_lo, 0xcccccccc
    s_mov_b32 vcc_hi, 0xcccccccc
    v_cndmask_b32_dpp v88, v224, v232, vcc quad_perm:[2,3,0,1] row_mask:0xf bank_mask:0xf
    v_cndmask_b32_dpp v89, v225, v233, vcc quad_perm:[2,3,0,1] row_mask:0xf bank_mask:0xf
    v_mfma_f32_16x16x32_bf16 v[24:27], v[56:59], v[196:199], v[24:27]
    v_cndmask_b32_dpp v90, v226, v234, vcc quad_perm:[2,3,0,1] row_mask:0xf bank_mask:0xf
    v_cndmask_b32_dpp v91, v227, v235, vcc quad_perm:[2,3,0,1] row_mask:0xf bank_mask:0xf
    v_mfma_f32_16x16x32_bf16 v[28:31], v[60:63], v[196:199], v[28:31]
    v_cndmask_b32_dpp v92, v228, v236, vcc quad_perm:[2,3,0,1] row_mask:0xf bank_mask:0xf
    v_cndmask_b32_dpp v93, v229, v237, vcc quad_perm:[2,3,0,1] row_mask:0xf bank_mask:0xf
    v_mfma_f32_16x16x32_bf16 v[32:35], v[64:67], v[196:199], v[32:35]
    v_cndmask_b32_dpp v94, v230, v238, vcc quad_perm:[2,3,0,1] row_mask:0xf bank_mask:0xf
    v_cndmask_b32_dpp v95, v231, v239, vcc quad_perm:[2,3,0,1] row_mask:0xf bank_mask:0xf
    buffer_load_dwordx4 v[196:199], v69, s[36:39], s68 offen offset:2048
    s_waitcnt lgkmcnt(0)
    v_mfma_f32_16x16x32_bf16 v[4:7], v[36:39], v[184:187], v[4:7]
    ds_read_b64_tr_b16 v[52:53], v75 offset:3072
    ds_read_b64_tr_b16 v[54:55], v75 offset:3584
    s_mov_b32 vcc_lo, 0x55555555
    s_mov_b32 vcc_hi, 0x55555555
    v_cndmask_b32_dpp v224, v100, v96, vcc quad_perm:[1,0,3,2] row_mask:0xf bank_mask:0xf
    v_cndmask_b32_dpp v225, v101, v97, vcc quad_perm:[1,0,3,2] row_mask:0xf bank_mask:0xf
    v_mfma_f32_16x16x32_bf16 v[8:11], v[40:43], v[184:187], v[8:11]
    ds_read_b64_tr_b16 v[56:57], v76 offset:3072
    ds_read_b64_tr_b16 v[58:59], v76 offset:3584
    v_cndmask_b32_dpp v226, v102, v98, vcc quad_perm:[1,0,3,2] row_mask:0xf bank_mask:0xf
    v_cndmask_b32_dpp v227, v103, v99, vcc quad_perm:[1,0,3,2] row_mask:0xf bank_mask:0xf
    v_mfma_f32_16x16x32_bf16 v[12:15], v[44:47], v[184:187], v[12:15]
    ds_read_b64_tr_b16 v[60:61], v77 offset:3072
    ds_read_b64_tr_b16 v[62:63], v77 offset:3584
    v_cndmask_b32_dpp v232, v108, v104, vcc quad_perm:[1,0,3,2] row_mask:0xf bank_mask:0xf
    v_cndmask_b32_dpp v233, v109, v105, vcc quad_perm:[1,0,3,2] row_mask:0xf bank_mask:0xf
    v_mfma_f32_16x16x32_bf16 v[16:19], v[48:51], v[184:187], v[16:19]
    ds_read_b64_tr_b16 v[64:65], v78 offset:3072
    ds_read_b64_tr_b16 v[66:67], v78 offset:3584
    v_cndmask_b32_dpp v234, v110, v106, vcc quad_perm:[1,0,3,2] row_mask:0xf bank_mask:0xf
    v_cndmask_b32_dpp v235, v111, v107, vcc quad_perm:[1,0,3,2] row_mask:0xf bank_mask:0xf
    buffer_load_dwordx4 v[184:187], v71, s[36:39], s68 offen offset:0
    v_mfma_f32_16x16x32_bf16 v[20:23], v[36:39], v[200:203], v[20:23]
    s_mov_b32 vcc_lo, 0xaaaaaaaa
    s_mov_b32 vcc_hi, 0xaaaaaaaa
    v_cndmask_b32_dpp v228, v96, v100, vcc quad_perm:[1,0,3,2] row_mask:0xf bank_mask:0xf
    v_cndmask_b32_dpp v229, v97, v101, vcc quad_perm:[1,0,3,2] row_mask:0xf bank_mask:0xf
    v_mfma_f32_16x16x32_bf16 v[24:27], v[40:43], v[200:203], v[24:27]
    v_cndmask_b32_dpp v230, v98, v102, vcc quad_perm:[1,0,3,2] row_mask:0xf bank_mask:0xf
    v_cndmask_b32_dpp v231, v99, v103, vcc quad_perm:[1,0,3,2] row_mask:0xf bank_mask:0xf
    v_mfma_f32_16x16x32_bf16 v[28:31], v[44:47], v[200:203], v[28:31]
    v_cndmask_b32_dpp v236, v104, v108, vcc quad_perm:[1,0,3,2] row_mask:0xf bank_mask:0xf
    v_cndmask_b32_dpp v237, v105, v109, vcc quad_perm:[1,0,3,2] row_mask:0xf bank_mask:0xf
    v_mfma_f32_16x16x32_bf16 v[32:35], v[48:51], v[200:203], v[32:35]
    v_cndmask_b32_dpp v238, v106, v110, vcc quad_perm:[1,0,3,2] row_mask:0xf bank_mask:0xf
    v_cndmask_b32_dpp v239, v107, v111, vcc quad_perm:[1,0,3,2] row_mask:0xf bank_mask:0xf
    buffer_load_dwordx4 v[200:203], v72, s[36:39], s68 offen offset:0
    s_waitcnt lgkmcnt(0)
    v_xor_b32 v75, 0x1c000, v75
    v_xor_b32 v76, 0x1c000, v76
    v_xor_b32 v77, 0x1c000, v77
    v_xor_b32 v78, 0x1c000, v78
    v_mfma_f32_16x16x32_bf16 v[4:7], v[52:55], v[188:191], v[4:7]
    ds_read_b64_tr_b16 v[36:37], v75 offset:0
    ds_read_b64_tr_b16 v[38:39], v75 offset:512
    s_mov_b32 vcc_lo, 0x33333333
    s_mov_b32 vcc_hi, 0x33333333
    v_cndmask_b32_dpp v96, v232, v224, vcc quad_perm:[2,3,0,1] row_mask:0xf bank_mask:0xf
    v_cndmask_b32_dpp v97, v233, v225, vcc quad_perm:[2,3,0,1] row_mask:0xf bank_mask:0xf
    v_mfma_f32_16x16x32_bf16 v[8:11], v[56:59], v[188:191], v[8:11]
    ds_read_b64_tr_b16 v[40:41], v76 offset:0
    ds_read_b64_tr_b16 v[42:43], v76 offset:512
    v_cndmask_b32_dpp v98, v234, v226, vcc quad_perm:[2,3,0,1] row_mask:0xf bank_mask:0xf
    v_cndmask_b32_dpp v99, v235, v227, vcc quad_perm:[2,3,0,1] row_mask:0xf bank_mask:0xf
    v_mfma_f32_16x16x32_bf16 v[12:15], v[60:63], v[188:191], v[12:15]
    ds_read_b64_tr_b16 v[44:45], v77 offset:0
    ds_read_b64_tr_b16 v[46:47], v77 offset:512
    v_cndmask_b32_dpp v100, v236, v228, vcc quad_perm:[2,3,0,1] row_mask:0xf bank_mask:0xf
    v_cndmask_b32_dpp v101, v237, v229, vcc quad_perm:[2,3,0,1] row_mask:0xf bank_mask:0xf
    v_mfma_f32_16x16x32_bf16 v[16:19], v[64:67], v[188:191], v[16:19]
    ds_read_b64_tr_b16 v[48:49], v78 offset:0
    ds_read_b64_tr_b16 v[50:51], v78 offset:512
    v_cndmask_b32_dpp v102, v238, v230, vcc quad_perm:[2,3,0,1] row_mask:0xf bank_mask:0xf
    v_cndmask_b32_dpp v103, v239, v231, vcc quad_perm:[2,3,0,1] row_mask:0xf bank_mask:0xf
    buffer_load_dwordx4 v[188:191], v71, s[36:39], s68 offen offset:2048
    v_mfma_f32_16x16x32_bf16 v[20:23], v[52:55], v[204:207], v[20:23]
    s_mov_b32 vcc_lo, 0xcccccccc
    s_mov_b32 vcc_hi, 0xcccccccc
    v_cndmask_b32_dpp v104, v224, v232, vcc quad_perm:[2,3,0,1] row_mask:0xf bank_mask:0xf
    v_cndmask_b32_dpp v105, v225, v233, vcc quad_perm:[2,3,0,1] row_mask:0xf bank_mask:0xf
    v_mfma_f32_16x16x32_bf16 v[24:27], v[56:59], v[204:207], v[24:27]
    v_cndmask_b32_dpp v106, v226, v234, vcc quad_perm:[2,3,0,1] row_mask:0xf bank_mask:0xf
    v_cndmask_b32_dpp v107, v227, v235, vcc quad_perm:[2,3,0,1] row_mask:0xf bank_mask:0xf
    v_mfma_f32_16x16x32_bf16 v[28:31], v[60:63], v[204:207], v[28:31]
    v_cndmask_b32_dpp v108, v228, v236, vcc quad_perm:[2,3,0,1] row_mask:0xf bank_mask:0xf
    v_cndmask_b32_dpp v109, v229, v237, vcc quad_perm:[2,3,0,1] row_mask:0xf bank_mask:0xf
    v_mfma_f32_16x16x32_bf16 v[32:35], v[64:67], v[204:207], v[32:35]
    v_cndmask_b32_dpp v110, v230, v238, vcc quad_perm:[2,3,0,1] row_mask:0xf bank_mask:0xf
    v_cndmask_b32_dpp v111, v231, v239, vcc quad_perm:[2,3,0,1] row_mask:0xf bank_mask:0xf
    buffer_load_dwordx4 v[204:207], v72, s[36:39], s68 offen offset:2048
    v_xor_b32 v68, 0x700, v68
    v_xor_b32 v69, 0x700, v69
    v_xor_b32 v71, 0x700, v71
    v_xor_b32 v72, 0x700, v72
    s_and_b32 s85, s58, 4
    s_or_b32 s85, s85, s73
    s_cbranch_scc1 p0z_57
    s_barrier
p0z_57:
    s_add_u32 s73, s73, 1
    s_add_u32 s85, s73, 1
    s_bfe_u32 s68, s85, 0x40001
    s_lshl_b32 s68, s68, 19
    s_cmp_ge_u32 s85, 6
    s_cselect_b32 s68, 0x5ffffff0, s68
    s_bitcmp1_b32 s73, 0
    s_cbranch_scc1 p0_53
    v_cvt_pk_bf16_f32 v208, v4, v5
    v_cvt_pk_bf16_f32 v209, v6, v7
    v_cvt_pk_bf16_f32 v210, v8, v9
    v_cvt_pk_bf16_f32 v211, v10, v11
    buffer_store_dwordx4 v[208:211], v79, s[8:11], s81 offen offset:0 sc1
    v_cvt_pk_bf16_f32 v212, v20, v21
    v_cvt_pk_bf16_f32 v213, v22, v23
    v_cvt_pk_bf16_f32 v214, v24, v25
    v_cvt_pk_bf16_f32 v215, v26, v27
    buffer_store_dwordx4 v[212:215], v79, s[8:11], s81 offen offset:256 sc1
    v_cvt_pk_bf16_f32 v216, v12, v13
    v_cvt_pk_bf16_f32 v217, v14, v15
    v_cvt_pk_bf16_f32 v218, v16, v17
    v_cvt_pk_bf16_f32 v219, v18, v19
    buffer_store_dwordx4 v[216:219], v79, s[8:11], s81 offen offset:2048 sc1
    v_cvt_pk_bf16_f32 v220, v28, v29
    v_cvt_pk_bf16_f32 v221, v30, v31
    v_cvt_pk_bf16_f32 v222, v32, v33
    v_cvt_pk_bf16_f32 v223, v34, v35
    buffer_store_dwordx4 v[220:223], v79, s[8:11], s81 offen offset:2304 sc1
    v_mov_b32 v4, 0
    v_mov_b32 v5, 0
    v_mov_b32 v6, 0
    v_mov_b32 v7, 0
    v_mov_b32 v8, 0
    v_mov_b32 v9, 0
    v_mov_b32 v10, 0
    v_mov_b32 v11, 0
    v_mov_b32 v12, 0
    v_mov_b32 v13, 0
    v_mov_b32 v14, 0
    v_mov_b32 v15, 0
    v_mov_b32 v16, 0
    v_mov_b32 v17, 0
    v_mov_b32 v18, 0
    v_mov_b32 v19, 0
    v_mov_b32 v20, 0
    v_mov_b32 v21, 0
    v_mov_b32 v22, 0
    v_mov_b32 v23, 0
    v_mov_b32 v24, 0
    v_mov_b32 v25, 0
    v_mov_b32 v26, 0
    v_mov_b32 v27, 0
    v_mov_b32 v28, 0
    v_mov_b32 v29, 0
    v_mov_b32 v30, 0
    v_mov_b32 v31, 0
    v_mov_b32 v32, 0
    v_mov_b32 v33, 0
    v_mov_b32 v34, 0
    v_mov_b32 v35, 0
    s_add_u32 s81, s81, 0x200000
    s_mov_b32 s72, 1
    s_cmp_lt_u32 s73, 6
    s_cbranch_scc1 p0_53
    s_waitcnt vmcnt(0)
p0sig_54:
    s_add_u32 s85, s83, 163648
    s_waitcnt vmcnt(8)
    v_mov_b32 v208, s85
    v_mov_b32 v209, 1
    ds_add_rtn_u32 v210, v208, v209
    v_mov_b32 v208, s83
    v_mov_b32 v211, 0x5ffffff0
    s_add_u32 s83, s83, 8
    s_mov_b32 s72, 0
    s_waitcnt lgkmcnt(0)
    v_cmp_eq_u32 vcc, 255, v210
    s_nop 1
    v_cndmask_b32 v208, v211, v208, vcc
    s_cbranch_vccz p0nl_56
    buffer_atomic_add v209, v208, s[12:15], 0 offen sc1
p0nl_56:
    s_cmp_eq_u32 s73, 6
    s_cbranch_scc1 p0e_49
    s_cmp_lg_u32 s73, 2
    s_cbranch_scc1 p0ret_55
    s_nop 4
    v_mov_b32 v228, -1
    v_mov_b32 v232, 0
    v_mov_b32 v229, -1
    v_mov_b32 v233, 0
    v_mov_b32 v230, -1
    v_mov_b32 v234, 0
    v_mov_b32 v231, -1
    v_mov_b32 v235, 0
    v_bfe_u32 v208, v1, 0, 4
    v_lshlrev_b32 v208, 4, v208
    v_bfe_u32 v209, v1, 4, 1
    v_lshl_or_b32 v208, v209, 18, v208
    v_bfe_u32 v209, v1, 5, 1
    v_lshl_or_b32 v208, v209, 22, v208
    s_lshl_b32 s85, s76, 3
    s_add_u32 s85, s85, s58
    s_lshl_b32 s74, s85, 12
    v_lshlrev_b32 v209, 6, v1
    buffer_load_dword v240, v209, s[44:47], s74 offen
    buffer_load_dword v241, v209, s[36:39], s74 offen
    buffer_load_dword v242, v209, s[48:51], s74 offen
    buffer_load_dword v243, v209, s[52:55], s74 offen
    s_add_u32 s74, s74, 0x6000000
    v_lshlrev_b32 v210, 4, v1
    buffer_store_dwordx4 v[228:231], v210, s[8:11], s74 offen offset:0 sc1
    buffer_store_dwordx4 v[228:231], v210, s[8:11], s74 offen offset:1024 sc1
    buffer_store_dwordx4 v[228:231], v210, s[8:11], s74 offen offset:2048 sc1
    buffer_store_dwordx4 v[228:231], v210, s[8:11], s74 offen offset:3072 sc1
    s_lshl_b32 s74, s85, 5
    s_lshl_b32 s85, s85, 8
    s_add_u32 s85, s85, 0x4300000
    buffer_store_dwordx4 v[228:231], v208, s[8:11], s85 offen sc1
    s_add_u32 s85, s85, 0x80000
    buffer_store_dwordx4 v[228:231], v208, s[8:11], s85 offen sc1
    s_add_u32 s85, s85, 0x80000
    s_add_u32 s74, s74, 0x5100000
    v_and_b32 v211, 16, v210
    buffer_store_dwordx4 v[232:235], v211, s[8:11], s74 offen sc1
    s_lshl_b32 s85, s76, 3
    s_add_u32 s85, s85, s58
    v_lshlrev_b32 v212, 3, v1
    v_mul_u32_u24 v212, s85, v212
    v_and_b32 v213, 0x3ff, v212
    v_cvt_f32_u32 v213, v213
    v_mul_f32 v213, 0x3a800000, v213
    v_cos_f32 v214, v213
    v_sin_f32 v215, -v213
    v_add_u32 v212, s85, v212
    v_cvt_pk_bf16_f32 v218, v214, v215
    v_and_b32 v213, 0x3ff, v212
    v_cvt_f32_u32 v213, v213
    v_mul_f32 v213, 0x3a800000, v213
    v_cos_f32 v214, v213
    v_sin_f32 v215, -v213
    v_add_u32 v212, s85, v212
    v_cvt_pk_bf16_f32 v219, v214, v215
    v_and_b32 v213, 0x3ff, v212
    v_cvt_f32_u32 v213, v213
    v_mul_f32 v213, 0x3a800000, v213
    v_cos_f32 v214, v213
    v_sin_f32 v215, -v213
    v_add_u32 v212, s85, v212
    v_cvt_pk_bf16_f32 v220, v214, v215
    v_and_b32 v213, 0x3ff, v212
    v_cvt_f32_u32 v213, v213
    v_mul_f32 v213, 0x3a800000, v213
    v_cos_f32 v214, v213
    v_sin_f32 v215, -v213
    v_add_u32 v212, s85, v212
    v_cvt_pk_bf16_f32 v221, v214, v215
    v_and_b32 v213, 0x3ff, v212
    v_cvt_f32_u32 v213, v213
    v_mul_f32 v213, 0x3a800000, v213
    v_cos_f32 v214, v213
    v_sin_f32 v215, -v213
    v_add_u32 v212, s85, v212
    v_cvt_pk_bf16_f32 v222, v214, v215
    v_and_b32 v213, 0x3ff, v212
    v_cvt_f32_u32 v213, v213
    v_mul_f32 v213, 0x3a800000, v213
    v_cos_f32 v214, v213
    v_sin_f32 v215, -v213
    v_add_u32 v212, s85, v212
    v_cvt_pk_bf16_f32 v223, v214, v215
    v_and_b32 v213, 0x3ff, v212
    v_cvt_f32_u32 v213, v213
    v_mul_f32 v213, 0x3a800000, v213
    v_cos_f32 v214, v213
    v_sin_f32 v215, -v213
    v_add_u32 v212, s85, v212
    v_cvt_pk_bf16_f32 v224, v214, v215
    v_and_b32 v213, 0x3ff, v212
    v_cvt_f32_u32 v213, v213
    v_mul_f32 v213, 0x3a800000, v213
    v_cos_f32 v214, v213
    v_sin_f32 v215, -v213
    v_add_u32 v212, s85, v212
    v_cvt_pk_bf16_f32 v225, v214, v215
    v_mov_b32 v213, s85
    v_lshlrev_b32 v213, 31, v213
    v_or_b32 v213, 0x3f803f80, v213
    v_cmp_eq_u32 vcc, 0, v1
    s_nop 1
    v_cndmask_b32 v218, v218, v213, vcc
    v_lshlrev_b32 v216, 5, v1
    s_lshl_b32 s85, s85, 11
    s_add_u32 s85, s85, 0x5200000
    buffer_store_dwordx4 v[218:221], v216, s[8:11], s85 offen sc1
    buffer_store_dwordx4 v[222:225], v216, s[8:11], s85 offen offset:16 sc1
    s_branch p0ret_55
v0_47:
    v_bfe_u32 v208, v1, 4, 1
    v_lshlrev_b32 v208, 1, v208
    s_and_b32 s85, s58, 4
    v_xor_b32 v208, s85, v208
    v_xor_b32 v208, v208, v1
    v_bfe_u32 v70, v208, 0, 2
    v_lshlrev_b32 v70, 4, v70
    v_bfe_u32 v209, v208, 2, 1
    v_lshl_or_b32 v70, v209, 6, v70
    v_bfe_u32 v209, v208, 3, 3
    v_lshl_or_b32 v70, v209, 13, v70
    s_bfe_u32 s69, s76, 0x60000
    s_lshl_b32 s69, s69, 7
    s_lshl_b32 s85, s58, 16
    s_add_u32 s69, s69, s85
    s_lshl_b32 s71, s58, 10
    s_mov_b32 m0, s71
    s_nop 0
    buffer_load_dwordx4 v70, s[28:31], s69 offen lds
    s_add_u32 s69, s69, 0x80000
    s_add_u32 s71, s71, 0x2000
    s_mov_b32 m0, s71
    s_nop 0
    buffer_load_dwordx4 v70, s[28:31], s69 offen lds
    s_add_u32 s69, s69, 0x80000
    s_add_u32 s71, s71, 0x2000
    s_mov_b32 m0, s71
    s_nop 0
    buffer_load_dwordx4 v70, s[28:31], s69 offen lds
    s_add_u32 s69, s69, 0x80000
    s_add_u32 s71, s71, 0x2000
    s_mov_b32 m0, s71
    s_nop 0
    buffer_load_dwordx4 v70, s[28:31], s69 offen lds
    s_add_u32 s69, s69, 0x80000
    s_add_u32 s71, s71, 0x2000
    s_mov_b32 m0, s71
    s_nop 0
    buffer_load_dwordx4 v70, s[28:31], s69 offen lds
    s_add_u32 s69, s69, 0x80000
    s_add_u32 s71, s71, 0x2000
    s_mov_b32 m0, s71
    s_nop 0
    buffer_load_dwordx4 v70, s[28:31], s69 offen lds
    s_add_u32 s69, s69, 0x80000
    s_add_u32 s71, s71, 0x2000
    s_mov_b32 m0, s71
    s_nop 0
    buffer_load_dwordx4 v70, s[28:31], s69 offen lds
    s_add_u32 s69, s69, 0x80000
    s_add_u32 s71, s71, 0x2000
    s_mov_b32 m0, s71
    s_nop 0
    buffer_load_dwordx4 v70, s[28:31], s69 offen lds
    s_add_u32 s69, s69, 0x80000
    s_add_u32 s71, s71, 0x2000
    s_mov_b32 m0, s71
    s_nop 0
    buffer_load_dwordx4 v70, s[28:31], s69 offen lds
    s_add_u32 s69, s69, 0x80000
    s_add_u32 s71, s71, 0x2000
    s_mov_b32 m0, s71
    s_nop 0
    buffer_load_dwordx4 v70, s[28:31], s69 offen lds
    s_add_u32 s69, s69, 0x80000
    s_add_u32 s71, s71, 0x2000
    s_mov_b32 m0, s71
    s_nop 0
    buffer_load_dwordx4 v70, s[28:31], s69 offen lds
    s_add_u32 s69, s69, 0x80000
    s_add_u32 s71, s71, 0x2000
    s_mov_b32 m0, s71
    s_nop 0
    buffer_load_dwordx4 v70, s[28:31], s69 offen lds
    s_add_u32 s69, s69, 0x80000
    s_add_u32 s71, s71, 0x2000
    s_mov_b32 m0, s71
    s_nop 0
    buffer_load_dwordx4 v70, s[28:31], s69 offen lds
    s_add_u32 s69, s69, 0x80000
    s_add_u32 s71, s71, 0x2000
    s_mov_b32 m0, s71
    s_nop 0
    buffer_load_dwordx4 v70, s[28:31], s69 offen lds
    s_add_u32 s69, s69, 0x80000
    s_add_u32 s71, s71, 0x2000
    s_mov_b32 m0, s71
    s_nop 0
    buffer_load_dwordx4 v70, s[28:31], s69 offen lds
    s_add_u32 s69, s69, 0x80000
    s_add_u32 s71, s71, 0x2000
    s_mov_b32 m0, s71
    s_nop 0
    buffer_load_dwordx4 v70, s[28:31], s69 offen lds
    s_add_u32 s69, s69, 0x80000
    s_add_u32 s71, s71, 0x2000
    s_lshl_b32 s85, s58, 5
    s_add_u32 s74, s58, s57
    s_and_b32 s74, s74, 7
    s_lshl_b32 s74, s74, 8
    v_bfe_u32 v209, v1, 0, 2
    v_lshlrev_b32 v209, 4, v209
    v_bfe_u32 v210, v1, 4, 2
    v_lshl_or_b32 v209, v210, 6, v209
    v_and_b32 v208, 12, v1
    v_add3_u32 v208, v208, s85, 0
    v_bfe_u32 v68, v208, 0, 3
    v_lshlrev_b32 v68, 11, v68
    v_bfe_u32 v210, v208, 3, 1
    v_lshl_or_b32 v68, v210, 15, v68
    v_bfe_u32 v210, v208, 4, 1
    v_lshl_or_b32 v68, v210, 14, v68
    v_bfe_u32 v210, v208, 5, 3
    v_lshl_or_b32 v68, v210, 16, v68
    v_add3_u32 v68, v68, v209, s74
    v_add_u32 v71, 4096, v68
    v_and_b32 v208, 12, v1
    v_add3_u32 v208, v208, s85, 16
    v_bfe_u32 v69, v208, 0, 3
    v_lshlrev_b32 v69, 11, v69
    v_bfe_u32 v210, v208, 3, 1
    v_lshl_or_b32 v69, v210, 15, v69
    v_bfe_u32 v210, v208, 4, 1
    v_lshl_or_b32 v69, v210, 14, v69
    v_bfe_u32 v210, v208, 5, 3
    v_lshl_or_b32 v69, v210, 16, v69
    v_add3_u32 v69, v69, v209, s74
    v_add_u32 v72, 4096, v69
    v_bfe_u32 v79, v1, 0, 4
    v_lshlrev_b32 v79, 4, v79
    v_bfe_u32 v75, v1, 4, 2
    v_lshl_or_b32 v79, v75, 9, v79
    v_bfe_u32 v75, v1, 0, 2
    v_lshlrev_b32 v75, 3, v75
    v_bfe_u32 v208, v1, 3, 1
    v_lshl_or_b32 v75, v208, 5, v75
    v_bfe_u32 v208, v1, 4, 1
    v_lshl_or_b32 v75, v208, 6, v75
    v_bfe_u32 v208, v1, 2, 2
    v_lshl_or_b32 v75, v208, 7, v75
    v_bfe_u32 v208, v1, 4, 2
    v_lshl_or_b32 v75, v208, 12, v75
    v_lshl_or_b32 v75, s74, 6, v75
    v_xor_b32 v76, 32, v75
    v_xor_b32 v77, 64, v75
    v_xor_b32 v78, 96, v75
    v_mov_b32 v4, 0
    v_mov_b32 v5, 0
    v_mov_b32 v6, 0
    v_mov_b32 v7, 0
    v_mov_b32 v8, 0
    v_mov_b32 v9, 0
    v_mov_b32 v10, 0
    v_mov_b32 v11, 0
    v_mov_b32 v12, 0
    v_mov_b32 v13, 0
    v_mov_b32 v14, 0
    v_mov_b32 v15, 0
    v_mov_b32 v16, 0
    v_mov_b32 v17, 0
    v_mov_b32 v18, 0
    v_mov_b32 v19, 0
    v_mov_b32 v20, 0
    v_mov_b32 v21, 0
    v_mov_b32 v22, 0
    v_mov_b32 v23, 0
    v_mov_b32 v24, 0
    v_mov_b32 v25, 0
    v_mov_b32 v26, 0
    v_mov_b32 v27, 0
    v_mov_b32 v28, 0
    v_mov_b32 v29, 0
    v_mov_b32 v30, 0
    v_mov_b32 v31, 0
    v_mov_b32 v32, 0
    v_mov_b32 v33, 0
    v_mov_b32 v34, 0
    v_mov_b32 v35, 0
    s_bfe_u32 s81, s76, 0x60000
    s_lshl_b32 s81, s81, 12
    s_lshl_b32 s85, s58, 18
    s_add_u32 s81, s81, s85
    s_add_u32 s81, s81, 0x2000000
    s_and_b32 s85, s58, 4
    s_add_u32 s83, s85, 128
    s_mov_b32 s73, 0
    s_mov_b32 s72, 0
    s_mov_b32 s68, 0
    v_mov_b32 v208, 163776
    ds_write_b128 v208, v[4:7]
    ds_write_b128 v208, v[4:7] offset:16
    s_cmp_lt_u32 s58, 4
    s_cbranch_scc1 p0x_58
    s_waitcnt vmcnt(0) lgkmcnt(0)
    s_barrier
    s_barrier
p0x_58:
    buffer_load_dwordx4 v[80:83], v68, s[36:39], s68 offen offset:0
    buffer_load_dwordx4 v[96:99], v69, s[36:39], s68 offen offset:0
    buffer_load_dwordx4 v[84:87], v68, s[36:39], s68 offen offset:2048
    buffer_load_dwordx4 v[100:103], v69, s[36:39], s68 offen offset:2048
    buffer_load_dwordx4 v[88:91], v71, s[36:39], s68 offen offset:0
    buffer_load_dwordx4 v[104:107], v72, s[36:39], s68 offen offset:0
    buffer_load_dwordx4 v[92:95], v71, s[36:39], s68 offen offset:2048
    buffer_load_dwordx4 v[108:111], v72, s[36:39], s68 offen offset:2048
    v_xor_b32 v68, 0x100, v68
    v_xor_b32 v69, 0x100, v69
    v_xor_b32 v71, 0x100, v71
    v_xor_b32 v72, 0x100, v72
    buffer_load_dwordx4 v[112:115], v68, s[36:39], s68 offen offset:0
    buffer_load_dwordx4 v[128:131], v69, s[36:39], s68 offen offset:0
    buffer_load_dwordx4 v[116:119], v68, s[36:39], s68 offen offset:2048
    buffer_load_dwordx4 v[132:135], v69, s[36:39], s68 offen offset:2048
    buffer_load_dwordx4 v[120:123], v71, s[36:39], s68 offen offset:0
    buffer_load_dwordx4 v[136:139], v72, s[36:39], s68 offen offset:0
    buffer_load_dwordx4 v[124:127], v71, s[36:39], s68 offen offset:2048
    buffer_load_dwordx4 v[140:143], v72, s[36:39], s68 offen offset:2048
    v_xor_b32 v68, 0x300, v68
    v_xor_b32 v69, 0x300, v69
    v_xor_b32 v71, 0x300, v71
    v_xor_b32 v72, 0x300, v72
    buffer_load_dwordx4 v[144:147], v68, s[36:39], s68 offen offset:0
    buffer_load_dwordx4 v[160:163], v69, s[36:39], s68 offen offset:0
    buffer_load_dwordx4 v[148:151], v68, s[36:39], s68 offen offset:2048
    buffer_load_dwordx4 v[164:167], v69, s[36:39], s68 offen offset:2048
    buffer_load_dwordx4 v[152:155], v71, s[36:39], s68 offen offset:0
    buffer_load_dwordx4 v[168:171], v72, s[36:39], s68 offen offset:0
    buffer_load_dwordx4 v[156:159], v71, s[36:39], s68 offen offset:2048
    buffer_load_dwordx4 v[172:175], v72, s[36:39], s68 offen offset:2048
    v_xor_b32 v68, 0x100, v68
    v_xor_b32 v69, 0x100, v69
    v_xor_b32 v71, 0x100, v71
    v_xor_b32 v72, 0x100, v72
    buffer_load_dwordx4 v[176:179], v68, s[36:39], s68 offen offset:0
    buffer_load_dwordx4 v[192:195], v69, s[36:39], s68 offen offset:0
    buffer_load_dwordx4 v[180:183], v68, s[36:39], s68 offen offset:2048
    buffer_load_dwordx4 v[196:199], v69, s[36:39], s68 offen offset:2048
    buffer_load_dwordx4 v[184:187], v71, s[36:39], s68 offen offset:0
    buffer_load_dwordx4 v[200:203], v72, s[36:39], s68 offen offset:0
    buffer_load_dwordx4 v[188:191], v71, s[36:39], s68 offen offset:2048
    buffer_load_dwordx4 v[204:207], v72, s[36:39], s68 offen offset:2048
    v_xor_b32 v68, 0x700, v68
    v_xor_b32 v69, 0x700, v69
    v_xor_b32 v71, 0x700, v71
    v_xor_b32 v72, 0x700, v72
    s_waitcnt vmcnt(24) lgkmcnt(0)
    s_mov_b32 vcc_lo, 0x55555555
    s_mov_b32 vcc_hi, 0x55555555
    v_cndmask_b32_dpp v224, v84, v80, vcc quad_perm:[1,0,3,2] row_mask:0xf bank_mask:0xf
    v_cndmask_b32_dpp v225, v85, v81, vcc quad_perm:[1,0,3,2] row_mask:0xf bank_mask:0xf
    v_cndmask_b32_dpp v226, v86, v82, vcc quad_perm:[1,0,3,2] row_mask:0xf bank_mask:0xf
    v_cndmask_b32_dpp v227, v87, v83, vcc quad_perm:[1,0,3,2] row_mask:0xf bank_mask:0xf
    v_cndmask_b32_dpp v232, v92, v88, vcc quad_perm:[1,0,3,2] row_mask:0xf bank_mask:0xf
    v_cndmask_b32_dpp v233, v93, v89, vcc quad_perm:[1,0,3,2] row_mask:0xf bank_mask:0xf
    v_cndmask_b32_dpp v234, v94, v90, vcc quad_perm:[1,0,3,2] row_mask:0xf bank_mask:0xf
    v_cndmask_b32_dpp v235, v95, v91, vcc quad_perm:[1,0,3,2] row_mask:0xf bank_mask:0xf
    s_mov_b32 vcc_lo, 0xaaaaaaaa
    s_mov_b32 vcc_hi, 0xaaaaaaaa
    v_cndmask_b32_dpp v228, v80, v84, vcc quad_perm:[1,0,3,2] row_mask:0xf bank_mask:0xf
    v_cndmask_b32_dpp v229, v81, v85, vcc quad_perm:[1,0,3,2] row_mask:0xf bank_mask:0xf
    v_cndmask_b32_dpp v230, v82, v86, vcc quad_perm:[1,0,3,2] row_mask:0xf bank_mask:0xf
    v_cndmask_b32_dpp v231, v83, v87, vcc quad_perm:[1,0,3,2] row_mask:0xf bank_mask:0xf
    v_cndmask_b32_dpp v236, v88, v92, vcc quad_perm:[1,0,3,2] row_mask:0xf bank_mask:0xf
    v_cndmask_b32_dpp v237, v89, v93, vcc quad_perm:[1,0,3,2] row_mask:0xf bank_mask:0xf
    v_cndmask_b32_dpp v238, v90, v94, vcc quad_perm:[1,0,3,2] row_mask:0xf bank_mask:0xf
    v_cndmask_b32_dpp v239, v91, v95, vcc quad_perm:[1,0,3,2] row_mask:0xf bank_mask:0xf
    s_mov_b32 vcc_lo, 0x33333333
    s_mov_b32 vcc_hi, 0x33333333
    v_cndmask_b32_dpp v80, v232, v224, vcc quad_perm:[2,3,0,1] row_mask:0xf bank_mask:0xf
    v_cndmask_b32_dpp v81, v233, v225, vcc quad_perm:[2,3,0,1] row_mask:0xf bank_mask:0xf
    v_cndmask_b32_dpp v82, v234, v226, vcc quad_perm:[2,3,0,1] row_mask:0xf bank_mask:0xf
    v_cndmask_b32_dpp v83, v235, v227, vcc quad_perm:[2,3,0,1] row_mask:0xf bank_mask:0xf
    v_cndmask_b32_dpp v84, v236, v228, vcc quad_perm:[2,3,0,1] row_mask:0xf bank_mask:0xf
    v_cndmask_b32_dpp v85, v237, v229, vcc quad_perm:[2,3,0,1] row_mask:0xf bank_mask:0xf
    v_cndmask_b32_dpp v86, v238, v230, vcc quad_perm:[2,3,0,1] row_mask:0xf bank_mask:0xf
    v_cndmask_b32_dpp v87, v239, v231, vcc quad_perm:[2,3,0,1] row_mask:0xf bank_mask:0xf
    s_mov_b32 vcc_lo, 0xcccccccc
    s_mov_b32 vcc_hi, 0xcccccccc
    v_cndmask_b32_dpp v88, v224, v232, vcc quad_perm:[2,3,0,1] row_mask:0xf bank_mask:0xf
    v_cndmask_b32_dpp v89, v225, v233, vcc quad_perm:[2,3,0,1] row_mask:0xf bank_mask:0xf
    v_cndmask_b32_dpp v90, v226, v234, vcc quad_perm:[2,3,0,1] row_mask:0xf bank_mask:0xf
    v_cndmask_b32_dpp v91, v227, v235, vcc quad_perm:[2,3,0,1] row_mask:0xf bank_mask:0xf
    v_cndmask_b32_dpp v92, v228, v236, vcc quad_perm:[2,3,0,1] row_mask:0xf bank_mask:0xf
    v_cndmask_b32_dpp v93, v229, v237, vcc quad_perm:[2,3,0,1] row_mask:0xf bank_mask:0xf
    v_cndmask_b32_dpp v94, v230, v238, vcc quad_perm:[2,3,0,1] row_mask:0xf bank_mask:0xf
    v_cndmask_b32_dpp v95, v231, v239, vcc quad_perm:[2,3,0,1] row_mask:0xf bank_mask:0xf
    s_mov_b32 vcc_lo, 0x55555555
    s_mov_b32 vcc_hi, 0x55555555
    v_cndmask_b32_dpp v224, v100, v96, vcc quad_perm:[1,0,3,2] row_mask:0xf bank_mask:0xf
    v_cndmask_b32_dpp v225, v101, v97, vcc quad_perm:[1,0,3,2] row_mask:0xf bank_mask:0xf
    v_cndmask_b32_dpp v226, v102, v98, vcc quad_perm:[1,0,3,2] row_mask:0xf bank_mask:0xf
    v_cndmask_b32_dpp v227, v103, v99, vcc quad_perm:[1,0,3,2] row_mask:0xf bank_mask:0xf
    v_cndmask_b32_dpp v232, v108, v104, vcc quad_perm:[1,0,3,2] row_mask:0xf bank_mask:0xf
    v_cndmask_b32_dpp v233, v109, v105, vcc quad_perm:[1,0,3,2] row_mask:0xf bank_mask:0xf
    v_cndmask_b32_dpp v234, v110, v106, vcc quad_perm:[1,0,3,2] row_mask:0xf bank_mask:0xf
    v_cndmask_b32_dpp v235, v111, v107, vcc quad_perm:[1,0,3,2] row_mask:0xf bank_mask:0xf
    s_mov_b32 vcc_lo, 0xaaaaaaaa
    s_mov_b32 vcc_hi, 0xaaaaaaaa
    v_cndmask_b32_dpp v228, v96, v100, vcc quad_perm:[1,0,3,2] row_mask:0xf bank_mask:0xf
    v_cndmask_b32_dpp v229, v97, v101, vcc quad_perm:[1,0,3,2] row_mask:0xf bank_mask:0xf
    v_cndmask_b32_dpp v230, v98, v102, vcc quad_perm:[1,0,3,2] row_mask:0xf bank_mask:0xf
    v_cndmask_b32_dpp v231, v99, v103, vcc quad_perm:[1,0,3,2] row_mask:0xf bank_mask:0xf
    v_cndmask_b32_dpp v236, v104, v108, vcc quad_perm:[1,0,3,2] row_mask:0xf bank_mask:0xf
    v_cndmask_b32_dpp v237, v105, v109, vcc quad_perm:[1,0,3,2] row_mask:0xf bank_mask:0xf
    v_cndmask_b32_dpp v238, v106, v110, vcc quad_perm:[1,0,3,2] row_mask:0xf bank_mask:0xf
    v_cndmask_b32_dpp v239, v107, v111, vcc quad_perm:[1,0,3,2] row_mask:0xf bank_mask:0xf
    s_mov_b32 vcc_lo, 0x33333333
    s_mov_b32 vcc_hi, 0x33333333
    v_cndmask_b32_dpp v96, v232, v224, vcc quad_perm:[2,3,0,1] row_mask:0xf bank_mask:0xf
    v_cndmask_b32_dpp v97, v233, v225, vcc quad_perm:[2,3,0,1] row_mask:0xf bank_mask:0xf
    v_cndmask_b32_dpp v98, v234, v226, vcc quad_perm:[2,3,0,1] row_mask:0xf bank_mask:0xf
    v_cndmask_b32_dpp v99, v235, v227, vcc quad_perm:[2,3,0,1] row_mask:0xf bank_mask:0xf
    v_cndmask_b32_dpp v100, v236, v228, vcc quad_perm:[2,3,0,1] row_mask:0xf bank_mask:0xf
    v_cndmask_b32_dpp v101, v237, v229, vcc quad_perm:[2,3,0,1] row_mask:0xf bank_mask:0xf
    v_cndmask_b32_dpp v102, v238, v230, vcc quad_perm:[2,3,0,1] row_mask:0xf bank_mask:0xf
    v_cndmask_b32_dpp v103, v239, v231, vcc quad_perm:[2,3,0,1] row_mask:0xf bank_mask:0xf
    s_mov_b32 vcc_lo, 0xcccccccc
    s_mov_b32 vcc_hi, 0xcccccccc
    v_cndmask_b32_dpp v104, v224, v232, vcc quad_perm:[2,3,0,1] row_mask:0xf bank_mask:0xf
    v_cndmask_b32_dpp v105, v225, v233, vcc quad_perm:[2,3,0,1] row_mask:0xf bank_mask:0xf
    v_cndmask_b32_dpp v106, v226, v234, vcc quad_perm:[2,3,0,1] row_mask:0xf bank_mask:0xf
    v_cndmask_b32_dpp v107, v227, v235, vcc quad_perm:[2,3,0,1] row_mask:0xf bank_mask:0xf
    v_cndmask_b32_dpp v108, v228, v236, vcc quad_perm:[2,3,0,1] row_mask:0xf bank_mask:0xf
    v_cndmask_b32_dpp v109, v229, v237, vcc quad_perm:[2,3,0,1] row_mask:0xf bank_mask:0xf
    v_cndmask_b32_dpp v110, v230, v238, vcc quad_perm:[2,3,0,1] row_mask:0xf bank_mask:0xf
    v_cndmask_b32_dpp v111, v231, v239, vcc quad_perm:[2,3,0,1] row_mask:0xf bank_mask:0xf
    s_cmp_ge_u32 s58, 4
    s_cbranch_scc1 p0y_59
    s_barrier
p0y_59:
    ds_read_b64_tr_b16 v[36:37], v75 offset:0
    ds_read_b64_tr_b16 v[38:39], v75 offset:512
    ds_read_b64_tr_b16 v[40:41], v76 offset:0
    ds_read_b64_tr_b16 v[42:43], v76 offset:512
    ds_read_b64_tr_b16 v[44:45], v77 offset:0
    ds_read_b64_tr_b16 v[46:47], v77 offset:512
    ds_read_b64_tr_b16 v[48:49], v78 offset:0
    ds_read_b64_tr_b16 v[50:51], v78 offset:512
p0_60:
    s_waitcnt vmcnt(16) lgkmcnt(0)
    v_mfma_f32_16x16x32_bf16 v[4:7], v[80:83], v[36:39], v[4:7]
    ds_read_b64_tr_b16 v[52:53], v75 offset:1024
    ds_read_b64_tr_b16 v[54:55], v75 offset:1536
    s_mov_b32 vcc_lo, 0x55555555
    s_mov_b32 vcc_hi, 0x55555555
    v_cndmask_b32_dpp v224, v116, v112, vcc quad_perm:[1,0,3,2] row_mask:0xf bank_mask:0xf
    v_cndmask_b32_dpp v225, v117, v113, vcc quad_perm:[1,0,3,2] row_mask:0xf bank_mask:0xf
    v_mfma_f32_16x16x32_bf16 v[8:11], v[80:83], v[40:43], v[8:11]
    ds_read_b64_tr_b16 v[56:57], v76 offset:1024
    ds_read_b64_tr_b16 v[58:59], v76 offset:1536
    v_cndmask_b32_dpp v226, v118, v114, vcc quad_perm:[1,0,3,2] row_mask:0xf bank_mask:0xf
    v_cndmask_b32_dpp v227, v119, v115, vcc quad_perm:[1,0,3,2] row_mask:0xf bank_mask:0xf
    v_mfma_f32_16x16x32_bf16 v[12:15], v[80:83], v[44:47], v[12:15]
    ds_read_b64_tr_b16 v[60:61], v77 offset:1024
    ds_read_b64_tr_b16 v[62:63], v77 offset:1536
    v_cndmask_b32_dpp v232, v124, v120, vcc quad_perm:[1,0,3,2] row_mask:0xf bank_mask:0xf
    v_cndmask_b32_dpp v233, v125, v121, vcc quad_perm:[1,0,3,2] row_mask:0xf bank_mask:0xf
    v_mfma_f32_16x16x32_bf16 v[16:19], v[80:83], v[48:51], v[16:19]
    ds_read_b64_tr_b16 v[64:65], v78 offset:1024
    ds_read_b64_tr_b16 v[66:67], v78 offset:1536
    v_cndmask_b32_dpp v234, v126, v122, vcc quad_perm:[1,0,3,2] row_mask:0xf bank_mask:0xf
    v_cndmask_b32_dpp v235, v127, v123, vcc quad_perm:[1,0,3,2] row_mask:0xf bank_mask:0xf
    buffer_load_dwordx4 v[80:83], v68, s[36:39], s68 offen offset:0
    v_mfma_f32_16x16x32_bf16 v[20:23], v[96:99], v[36:39], v[20:23]
    s_mov_b32 vcc_lo, 0xaaaaaaaa
    s_mov_b32 vcc_hi, 0xaaaaaaaa
    v_cndmask_b32_dpp v228, v112, v116, vcc quad_perm:[1,0,3,2] row_mask:0xf bank_mask:0xf
    v_cndmask_b32_dpp v229, v113, v117, vcc quad_perm:[1,0,3,2] row_mask:0xf bank_mask:0xf
    v_mfma_f32_16x16x32_bf16 v[24:27], v[96:99], v[40:43], v[24:27]
    v_cndmask_b32_dpp v230, v114, v118, vcc quad_perm:[1,0,3,2] row_mask:0xf bank_mask:0xf
    v_cndmask_b32_dpp v231, v115, v119, vcc quad_perm:[1,0,3,2] row_mask:0xf bank_mask:0xf
    v_mfma_f32_16x16x32_bf16 v[28:31], v[96:99], v[44:47], v[28:31]
    v_cndmask_b32_dpp v236, v120, v124, vcc quad_perm:[1,0,3,2] row_mask:0xf bank_mask:0xf
    v_cndmask_b32_dpp v237, v121, v125, vcc quad_perm:[1,0,3,2] row_mask:0xf bank_mask:0xf
    v_mfma_f32_16x16x32_bf16 v[32:35], v[96:99], v[48:51], v[32:35]
    v_cndmask_b32_dpp v238, v122, v126, vcc quad_perm:[1,0,3,2] row_mask:0xf bank_mask:0xf
    v_cndmask_b32_dpp v239, v123, v127, vcc quad_perm:[1,0,3,2] row_mask:0xf bank_mask:0xf
    buffer_load_dwordx4 v[96:99], v69, s[36:39], s68 offen offset:0
    s_waitcnt lgkmcnt(0)
    v_mfma_f32_16x16x32_bf16 v[4:7], v[84:87], v[52:55], v[4:7]
    ds_read_b64_tr_b16 v[36:37], v75 offset:2048
    ds_read_b64_tr_b16 v[38:39], v75 offset:2560
    s_mov_b32 vcc_lo, 0x33333333
    s_mov_b32 vcc_hi, 0x33333333
    v_cndmask_b32_dpp v112, v232, v224, vcc quad_perm:[2,3,0,1] row_mask:0xf bank_mask:0xf
    v_cndmask_b32_dpp v113, v233, v225, vcc quad_perm:[2,3,0,1] row_mask:0xf bank_mask:0xf
    v_mfma_f32_16x16x32_bf16 v[8:11], v[84:87], v[56:59], v[8:11]
    ds_read_b64_tr_b16 v[40:41], v76 offset:2048
    ds_read_b64_tr_b16 v[42:43], v76 offset:2560
    v_cndmask_b32_dpp v114, v234, v226, vcc quad_perm:[2,3,0,1] row_mask:0xf bank_mask:0xf
    v_cndmask_b32_dpp v115, v235, v227, vcc quad_perm:[2,3,0,1] row_mask:0xf bank_mask:0xf
    v_mfma_f32_16x16x32_bf16 v[12:15], v[84:87], v[60:63], v[12:15]
    ds_read_b64_tr_b16 v[44:45], v77 offset:2048
    ds_read_b64_tr_b16 v[46:47], v77 offset:2560
    v_cndmask_b32_dpp v116, v236, v228, vcc quad_perm:[2,3,0,1] row_mask:0xf bank_mask:0xf
    v_cndmask_b32_dpp v117, v237, v229, vcc quad_perm:[2,3,0,1] row_mask:0xf bank_mask:0xf
    v_mfma_f32_16x16x32_bf16 v[16:19], v[84:87], v[64:67], v[16:19]
    ds_read_b64_tr_b16 v[48:49], v78 offset:2048
    ds_read_b64_tr_b16 v[50:51], v78 offset:2560
    v_cndmask_b32_dpp v118, v238, v230, vcc quad_perm:[2,3,0,1] row_mask:0xf bank_mask:0xf
    v_cndmask_b32_dpp v119, v239, v231, vcc quad_perm:[2,3,0,1] row_mask:0xf bank_mask:0xf
    buffer_load_dwordx4 v[84:87], v68, s[36:39], s68 offen offset:2048
    v_mfma_f32_16x16x32_bf16 v[20:23], v[100:103], v[52:55], v[20:23]
    s_mov_b32 vcc_lo, 0xcccccccc
    s_mov_b32 vcc_hi, 0xcccccccc
    v_cndmask_b32_dpp v120, v224, v232, vcc quad_perm:[2,3,0,1] row_mask:0xf bank_mask:0xf
    v_cndmask_b32_dpp v121, v225, v233, vcc quad_perm:[2,3,0,1] row_mask:0xf bank_mask:0xf
    v_mfma_f32_16x16x32_bf16 v[24:27], v[100:103], v[56:59], v[24:27]
    v_cndmask_b32_dpp v122, v226, v234, vcc quad_perm:[2,3,0,1] row_mask:0xf bank_mask:0xf
    v_cndmask_b32_dpp v123, v227, v235, vcc quad_perm:[2,3,0,1] row_mask:0xf bank_mask:0xf
    v_mfma_f32_16x16x32_bf16 v[28:31], v[100:103], v[60:63], v[28:31]
    v_cndmask_b32_dpp v124, v228, v236, vcc quad_perm:[2,3,0,1] row_mask:0xf bank_mask:0xf
    v_cndmask_b32_dpp v125, v229, v237, vcc quad_perm:[2,3,0,1] row_mask:0xf bank_mask:0xf
    v_mfma_f32_16x16x32_bf16 v[32:35], v[100:103], v[64:67], v[32:35]
    v_cndmask_b32_dpp v126, v230, v238, vcc quad_perm:[2,3,0,1] row_mask:0xf bank_mask:0xf
    v_cndmask_b32_dpp v127, v231, v239, vcc quad_perm:[2,3,0,1] row_mask:0xf bank_mask:0xf
    buffer_load_dwordx4 v[100:103], v69, s[36:39], s68 offen offset:2048
    s_waitcnt lgkmcnt(0)
    v_mfma_f32_16x16x32_bf16 v[4:7], v[88:91], v[36:39], v[4:7]
    ds_read_b64_tr_b16 v[52:53], v75 offset:3072
    ds_read_b64_tr_b16 v[54:55], v75 offset:3584
    s_mov_b32 vcc_lo, 0x55555555
    s_mov_b32 vcc_hi, 0x55555555
    v_cndmask_b32_dpp v224, v132, v128, vcc quad_perm:[1,0,3,2] row_mask:0xf bank_mask:0xf
    v_cndmask_b32_dpp v225, v133, v129, vcc quad_perm:[1,0,3,2] row_mask:0xf bank_mask:0xf
    v_mfma_f32_16x16x32_bf16 v[8:11], v[88:91], v[40:43], v[8:11]
    ds_read_b64_tr_b16 v[56:57], v76 offset:3072
    ds_read_b64_tr_b16 v[58:59], v76 offset:3584
    v_cndmask_b32_dpp v226, v134, v130, vcc quad_perm:[1,0,3,2] row_mask:0xf bank_mask:0xf
    v_cndmask_b32_dpp v227, v135, v131, vcc quad_perm:[1,0,3,2] row_mask:0xf bank_mask:0xf
    v_mfma_f32_16x16x32_bf16 v[12:15], v[88:91], v[44:47], v[12:15]
    ds_read_b64_tr_b16 v[60:61], v77 offset:3072
    ds_read_b64_tr_b16 v[62:63], v77 offset:3584
    v_cndmask_b32_dpp v232, v140, v136, vcc quad_perm:[1,0,3,2] row_mask:0xf bank_mask:0xf
    v_cndmask_b32_dpp v233, v141, v137, vcc quad_perm:[1,0,3,2] row_mask:0xf bank_mask:0xf
    v_mfma_f32_16x16x32_bf16 v[16:19], v[88:91], v[48:51], v[16:19]
    ds_read_b64_tr_b16 v[64:65], v78 offset:3072
    ds_read_b64_tr_b16 v[66:67], v78 offset:3584
    v_cndmask_b32_dpp v234, v142, v138, vcc quad_perm:[1,0,3,2] row_mask:0xf bank_mask:0xf
    v_cndmask_b32_dpp v235, v143, v139, vcc quad_perm:[1,0,3,2] row_mask:0xf bank_mask:0xf
    buffer_load_dwordx4 v[88:91], v71, s[36:39], s68 offen offset:0
    v_mfma_f32_16x16x32_bf16 v[20:23], v[104:107], v[36:39], v[20:23]
    s_mov_b32 vcc_lo, 0xaaaaaaaa
    s_mov_b32 vcc_hi, 0xaaaaaaaa
    v_cndmask_b32_dpp v228, v128, v132, vcc quad_perm:[1,0,3,2] row_mask:0xf bank_mask:0xf
    v_cndmask_b32_dpp v229, v129, v133, vcc quad_perm:[1,0,3,2] row_mask:0xf bank_mask:0xf
    v_mfma_f32_16x16x32_bf16 v[24:27], v[104:107], v[40:43], v[24:27]
    v_cndmask_b32_dpp v230, v130, v134, vcc quad_perm:[1,0,3,2] row_mask:0xf bank_mask:0xf
    v_cndmask_b32_dpp v231, v131, v135, vcc quad_perm:[1,0,3,2] row_mask:0xf bank_mask:0xf
    v_mfma_f32_16x16x32_bf16 v[28:31], v[104:107], v[44:47], v[28:31]
    v_cndmask_b32_dpp v236, v136, v140, vcc quad_perm:[1,0,3,2] row_mask:0xf bank_mask:0xf
    v_cndmask_b32_dpp v237, v137, v141, vcc quad_perm:[1,0,3,2] row_mask:0xf bank_mask:0xf
    v_mfma_f32_16x16x32_bf16 v[32:35], v[104:107], v[48:51], v[32:35]
    v_cndmask_b32_dpp v238, v138, v142, vcc quad_perm:[1,0,3,2] row_mask:0xf bank_mask:0xf
    v_cndmask_b32_dpp v239, v139, v143, vcc quad_perm:[1,0,3,2] row_mask:0xf bank_mask:0xf
    buffer_load_dwordx4 v[104:107], v72, s[36:39], s68 offen offset:0
    s_waitcnt lgkmcnt(0)
    v_xor_b32 v75, 0x4000, v75
    v_xor_b32 v76, 0x4000, v76
    v_xor_b32 v77, 0x4000, v77
    v_xor_b32 v78, 0x4000, v78
    v_mfma_f32_16x16x32_bf16 v[4:7], v[92:95], v[52:55], v[4:7]
    ds_read_b64_tr_b16 v[36:37], v75 offset:0
    ds_read_b64_tr_b16 v[38:39], v75 offset:512
    s_mov_b32 vcc_lo, 0x33333333
    s_mov_b32 vcc_hi, 0x33333333
    v_cndmask_b32_dpp v128, v232, v224, vcc quad_perm:[2,3,0,1] row_mask:0xf bank_mask:0xf
    v_cndmask_b32_dpp v129, v233, v225, vcc quad_perm:[2,3,0,1] row_mask:0xf bank_mask:0xf
    v_mfma_f32_16x16x32_bf16 v[8:11], v[92:95], v[56:59], v[8:11]
    ds_read_b64_tr_b16 v[40:41], v76 offset:0
    ds_read_b64_tr_b16 v[42:43], v76 offset:512
    v_cndmask_b32_dpp v130, v234, v226, vcc quad_perm:[2,3,0,1] row_mask:0xf bank_mask:0xf
    v_cndmask_b32_dpp v131, v235, v227, vcc quad_perm:[2,3,0,1] row_mask:0xf bank_mask:0xf
    v_mfma_f32_16x16x32_bf16 v[12:15], v[92:95], v[60:63], v[12:15]
    ds_read_b64_tr_b16 v[44:45], v77 offset:0
    ds_read_b64_tr_b16 v[46:47], v77 offset:512
    v_cndmask_b32_dpp v132, v236, v228, vcc quad_perm:[2,3,0,1] row_mask:0xf bank_mask:0xf
    v_cndmask_b32_dpp v133, v237, v229, vcc quad_perm:[2,3,0,1] row_mask:0xf bank_mask:0xf
    v_mfma_f32_16x16x32_bf16 v[16:19], v[92:95], v[64:67], v[16:19]
    ds_read_b64_tr_b16 v[48:49], v78 offset:0
    ds_read_b64_tr_b16 v[50:51], v78 offset:512
    v_cndmask_b32_dpp v134, v238, v230, vcc quad_perm:[2,3,0,1] row_mask:0xf bank_mask:0xf
    v_cndmask_b32_dpp v135, v239, v231, vcc quad_perm:[2,3,0,1] row_mask:0xf bank_mask:0xf
    buffer_load_dwordx4 v[92:95], v71, s[36:39], s68 offen offset:2048
    v_mfma_f32_16x16x32_bf16 v[20:23], v[108:111], v[52:55], v[20:23]
    s_mov_b32 vcc_lo, 0xcccccccc
    s_mov_b32 vcc_hi, 0xcccccccc
    v_cndmask_b32_dpp v136, v224, v232, vcc quad_perm:[2,3,0,1] row_mask:0xf bank_mask:0xf
    v_cndmask_b32_dpp v137, v225, v233, vcc quad_perm:[2,3,0,1] row_mask:0xf bank_mask:0xf
    v_mfma_f32_16x16x32_bf16 v[24:27], v[108:111], v[56:59], v[24:27]
    v_cndmask_b32_dpp v138, v226, v234, vcc quad_perm:[2,3,0,1] row_mask:0xf bank_mask:0xf
    v_cndmask_b32_dpp v139, v227, v235, vcc quad_perm:[2,3,0,1] row_mask:0xf bank_mask:0xf
    v_mfma_f32_16x16x32_bf16 v[28:31], v[108:111], v[60:63], v[28:31]
    v_cndmask_b32_dpp v140, v228, v236, vcc quad_perm:[2,3,0,1] row_mask:0xf bank_mask:0xf
    v_cndmask_b32_dpp v141, v229, v237, vcc quad_perm:[2,3,0,1] row_mask:0xf bank_mask:0xf
    v_mfma_f32_16x16x32_bf16 v[32:35], v[108:111], v[64:67], v[32:35]
    v_cndmask_b32_dpp v142, v230, v238, vcc quad_perm:[2,3,0,1] row_mask:0xf bank_mask:0xf
    v_cndmask_b32_dpp v143, v231, v239, vcc quad_perm:[2,3,0,1] row_mask:0xf bank_mask:0xf
    buffer_load_dwordx4 v[108:111], v72, s[36:39], s68 offen offset:2048
    v_xor_b32 v68, 0x100, v68
    v_xor_b32 v69, 0x100, v69
    v_xor_b32 v71, 0x100, v71
    v_xor_b32 v72, 0x100, v72
    s_cmp_lg_u32 s72, 0
    s_cbranch_scc1 p0sig_61
p0ret_62:
    s_waitcnt vmcnt(16) lgkmcnt(0)
    v_mfma_f32_16x16x32_bf16 v[4:7], v[112:115], v[36:39], v[4:7]
    ds_read_b64_tr_b16 v[52:53], v75 offset:1024
    ds_read_b64_tr_b16 v[54:55], v75 offset:1536
    s_mov_b32 vcc_lo, 0x55555555
    s_mov_b32 vcc_hi, 0x55555555
    v_cndmask_b32_dpp v224, v148, v144, vcc quad_perm:[1,0,3,2] row_mask:0xf bank_mask:0xf
    v_cndmask_b32_dpp v225, v149, v145, vcc quad_perm:[1,0,3,2] row_mask:0xf bank_mask:0xf
    v_mfma_f32_16x16x32_bf16 v[8:11], v[112:115], v[40:43], v[8:11]
    ds_read_b64_tr_b16 v[56:57], v76 offset:1024
    ds_read_b64_tr_b16 v[58:59], v76 offset:1536
    v_cndmask_b32_dpp v226, v150, v146, vcc quad_perm:[1,0,3,2] row_mask:0xf bank_mask:0xf
    v_cndmask_b32_dpp v227, v151, v147, vcc quad_perm:[1,0,3,2] row_mask:0xf bank_mask:0xf
    v_mfma_f32_16x16x32_bf16 v[12:15], v[112:115], v[44:47], v[12:15]
    ds_read_b64_tr_b16 v[60:61], v77 offset:1024
    ds_read_b64_tr_b16 v[62:63], v77 offset:1536
    v_cndmask_b32_dpp v232, v156, v152, vcc quad_perm:[1,0,3,2] row_mask:0xf bank_mask:0xf
    v_cndmask_b32_dpp v233, v157, v153, vcc quad_perm:[1,0,3,2] row_mask:0xf bank_mask:0xf
    v_mfma_f32_16x16x32_bf16 v[16:19], v[112:115], v[48:51], v[16:19]
    ds_read_b64_tr_b16 v[64:65], v78 offset:1024
    ds_read_b64_tr_b16 v[66:67], v78 offset:1536
    v_cndmask_b32_dpp v234, v158, v154, vcc quad_perm:[1,0,3,2] row_mask:0xf bank_mask:0xf
    v_cndmask_b32_dpp v235, v159, v155, vcc quad_perm:[1,0,3,2] row_mask:0xf bank_mask:0xf
    buffer_load_dwordx4 v[112:115], v68, s[36:39], s68 offen offset:0
    v_mfma_f32_16x16x32_bf16 v[20:23], v[128:131], v[36:39], v[20:23]
    s_mov_b32 vcc_lo, 0xaaaaaaaa
    s_mov_b32 vcc_hi, 0xaaaaaaaa
    v_cndmask_b32_dpp v228, v144, v148, vcc quad_perm:[1,0,3,2] row_mask:0xf bank_mask:0xf
    v_cndmask_b32_dpp v229, v145, v149, vcc quad_perm:[1,0,3,2] row_mask:0xf bank_mask:0xf
    v_mfma_f32_16x16x32_bf16 v[24:27], v[128:131], v[40:43], v[24:27]
    v_cndmask_b32_dpp v230, v146, v150, vcc quad_perm:[1,0,3,2] row_mask:0xf bank_mask:0xf
    v_cndmask_b32_dpp v231, v147, v151, vcc quad_perm:[1,0,3,2] row_mask:0xf bank_mask:0xf
    v_mfma_f32_16x16x32_bf16 v[28:31], v[128:131], v[44:47], v[28:31]
    v_cndmask_b32_dpp v236, v152, v156, vcc quad_perm:[1,0,3,2] row_mask:0xf bank_mask:0xf
    v_cndmask_b32_dpp v237, v153, v157, vcc quad_perm:[1,0,3,2] row_mask:0xf bank_mask:0xf
    v_mfma_f32_16x16x32_bf16 v[32:35], v[128:131], v[48:51], v[32:35]
    v_cndmask_b32_dpp v238, v154, v158, vcc quad_perm:[1,0,3,2] row_mask:0xf bank_mask:0xf
    v_cndmask_b32_dpp v239, v155, v159, vcc quad_perm:[1,0,3,2] row_mask:0xf bank_mask:0xf
    buffer_load_dwordx4 v[128:131], v69, s[36:39], s68 offen offset:0
    s_waitcnt lgkmcnt(0)
    v_mfma_f32_16x16x32_bf16 v[4:7], v[116:119], v[52:55], v[4:7]
    ds_read_b64_tr_b16 v[36:37], v75 offset:2048
    ds_read_b64_tr_b16 v[38:39], v75 offset:2560
    s_mov_b32 vcc_lo, 0x33333333
    s_mov_b32 vcc_hi, 0x33333333
    v_cndmask_b32_dpp v144, v232, v224, vcc quad_perm:[2,3,0,1] row_mask:0xf bank_mask:0xf
    v_cndmask_b32_dpp v145, v233, v225, vcc quad_perm:[2,3,0,1] row_mask:0xf bank_mask:0xf
    v_mfma_f32_16x16x32_bf16 v[8:11], v[116:119], v[56:59], v[8:11]
    ds_read_b64_tr_b16 v[40:41], v76 offset:2048
    ds_read_b64_tr_b16 v[42:43], v76 offset:2560
    v_cndmask_b32_dpp v146, v234, v226, vcc quad_perm:[2,3,0,1] row_mask:0xf bank_mask:0xf
    v_cndmask_b32_dpp v147, v235, v227, vcc quad_perm:[2,3,0,1] row_mask:0xf bank_mask:0xf
    v_mfma_f32_16x16x32_bf16 v[12:15], v[116:119], v[60:63], v[12:15]
    ds_read_b64_tr_b16 v[44:45], v77 offset:2048
    ds_read_b64_tr_b16 v[46:47], v77 offset:2560
    v_cndmask_b32_dpp v148, v236, v228, vcc quad_perm:[2,3,0,1] row_mask:0xf bank_mask:0xf
    v_cndmask_b32_dpp v149, v237, v229, vcc quad_perm:[2,3,0,1] row_mask:0xf bank_mask:0xf
    v_mfma_f32_16x16x32_bf16 v[16:19], v[116:119], v[64:67], v[16:19]
    ds_read_b64_tr_b16 v[48:49], v78 offset:2048
    ds_read_b64_tr_b16 v[50:51], v78 offset:2560
    v_cndmask_b32_dpp v150, v238, v230, vcc quad_perm:[2,3,0,1] row_mask:0xf bank_mask:0xf
    v_cndmask_b32_dpp v151, v239, v231, vcc quad_perm:[2,3,0,1] row_mask:0xf bank_mask:0xf
    buffer_load_dwordx4 v[116:119], v68, s[36:39], s68 offen offset:2048
    v_mfma_f32_16x16x32_bf16 v[20:23], v[132:135], v[52:55], v[20:23]
    s_mov_b32 vcc_lo, 0xcccccccc
    s_mov_b32 vcc_hi, 0xcccccccc
    v_cndmask_b32_dpp v152, v224, v232, vcc quad_perm:[2,3,0,1] row_mask:0xf bank_mask:0xf
    v_cndmask_b32_dpp v153, v225, v233, vcc quad_perm:[2,3,0,1] row_mask:0xf bank_mask:0xf
    v_mfma_f32_16x16x32_bf16 v[24:27], v[132:135], v[56:59], v[24:27]
    v_cndmask_b32_dpp v154, v226, v234, vcc quad_perm:[2,3,0,1] row_mask:0xf bank_mask:0xf
    v_cndmask_b32_dpp v155, v227, v235, vcc quad_perm:[2,3,0,1] row_mask:0xf bank_mask:0xf
    v_mfma_f32_16x16x32_bf16 v[28:31], v[132:135], v[60:63], v[28:31]
    v_cndmask_b32_dpp v156, v228, v236, vcc quad_perm:[2,3,0,1] row_mask:0xf bank_mask:0xf
    v_cndmask_b32_dpp v157, v229, v237, vcc quad_perm:[2,3,0,1] row_mask:0xf bank_mask:0xf
    v_mfma_f32_16x16x32_bf16 v[32:35], v[132:135], v[64:67], v[32:35]
    v_cndmask_b32_dpp v158, v230, v238, vcc quad_perm:[2,3,0,1] row_mask:0xf bank_mask:0xf
    v_cndmask_b32_dpp v159, v231, v239, vcc quad_perm:[2,3,0,1] row_mask:0xf bank_mask:0xf
    buffer_load_dwordx4 v[132:135], v69, s[36:39], s68 offen offset:2048
    s_waitcnt lgkmcnt(0)
    v_mfma_f32_16x16x32_bf16 v[4:7], v[120:123], v[36:39], v[4:7]
    ds_read_b64_tr_b16 v[52:53], v75 offset:3072
    ds_read_b64_tr_b16 v[54:55], v75 offset:3584
    s_mov_b32 vcc_lo, 0x55555555
    s_mov_b32 vcc_hi, 0x55555555
    v_cndmask_b32_dpp v224, v164, v160, vcc quad_perm:[1,0,3,2] row_mask:0xf bank_mask:0xf
    v_cndmask_b32_dpp v225, v165, v161, vcc quad_perm:[1,0,3,2] row_mask:0xf bank_mask:0xf
    v_mfma_f32_16x16x32_bf16 v[8:11], v[120:123], v[40:43], v[8:11]
    ds_read_b64_tr_b16 v[56:57], v76 offset:3072
    ds_read_b64_tr_b16 v[58:59], v76 offset:3584
    v_cndmask_b32_dpp v226, v166, v162, vcc quad_perm:[1,0,3,2] row_mask:0xf bank_mask:0xf
    v_cndmask_b32_dpp v227, v167, v163, vcc quad_perm:[1,0,3,2] row_mask:0xf bank_mask:0xf
    v_mfma_f32_16x16x32_bf16 v[12:15], v[120:123], v[44:47], v[12:15]
    ds_read_b64_tr_b16 v[60:61], v77 offset:3072
    ds_read_b64_tr_b16 v[62:63], v77 offset:3584
    v_cndmask_b32_dpp v232, v172, v168, vcc quad_perm:[1,0,3,2] row_mask:0xf bank_mask:0xf
    v_cndmask_b32_dpp v233, v173, v169, vcc quad_perm:[1,0,3,2] row_mask:0xf bank_mask:0xf
    v_mfma_f32_16x16x32_bf16 v[16:19], v[120:123], v[48:51], v[16:19]
    ds_read_b64_tr_b16 v[64:65], v78 offset:3072
    ds_read_b64_tr_b16 v[66:67], v78 offset:3584
    v_cndmask_b32_dpp v234, v174, v170, vcc quad_perm:[1,0,3,2] row_mask:0xf bank_mask:0xf
    v_cndmask_b32_dpp v235, v175, v171, vcc quad_perm:[1,0,3,2] row_mask:0xf bank_mask:0xf
    buffer_load_dwordx4 v[120:123], v71, s[36:39], s68 offen offset:0
    v_mfma_f32_16x16x32_bf16 v[20:23], v[136:139], v[36:39], v[20:23]
    s_mov_b32 vcc_lo, 0xaaaaaaaa
    s_mov_b32 vcc_hi, 0xaaaaaaaa
    v_cndmask_b32_dpp v228, v160, v164, vcc quad_perm:[1,0,3,2] row_mask:0xf bank_mask:0xf
    v_cndmask_b32_dpp v229, v161, v165, vcc quad_perm:[1,0,3,2] row_mask:0xf bank_mask:0xf
    v_mfma_f32_16x16x32_bf16 v[24:27], v[136:139], v[40:43], v[24:27]
    v_cndmask_b32_dpp v230, v162, v166, vcc quad_perm:[1,0,3,2] row_mask:0xf bank_mask:0xf
    v_cndmask_b32_dpp v231, v163, v167, vcc quad_perm:[1,0,3,2] row_mask:0xf bank_mask:0xf
    v_mfma_f32_16x16x32_bf16 v[28:31], v[136:139], v[44:47], v[28:31]
    v_cndmask_b32_dpp v236, v168, v172, vcc quad_perm:[1,0,3,2] row_mask:0xf bank_mask:0xf
    v_cndmask_b32_dpp v237, v169, v173, vcc quad_perm:[1,0,3,2] row_mask:0xf bank_mask:0xf
    v_mfma_f32_16x16x32_bf16 v[32:35], v[136:139], v[48:51], v[32:35]
    v_cndmask_b32_dpp v238, v170, v174, vcc quad_perm:[1,0,3,2] row_mask:0xf bank_mask:0xf
    v_cndmask_b32_dpp v239, v171, v175, vcc quad_perm:[1,0,3,2] row_mask:0xf bank_mask:0xf
    buffer_load_dwordx4 v[136:139], v72, s[36:39], s68 offen offset:0
    s_waitcnt lgkmcnt(0)
    v_xor_b32 v75, 0xc000, v75
    v_xor_b32 v76, 0xc000, v76
    v_xor_b32 v77, 0xc000, v77
    v_xor_b32 v78, 0xc000, v78
    v_mfma_f32_16x16x32_bf16 v[4:7], v[124:127], v[52:55], v[4:7]
    ds_read_b64_tr_b16 v[36:37], v75 offset:0
    ds_read_b64_tr_b16 v[38:39], v75 offset:512
    s_mov_b32 vcc_lo, 0x33333333
    s_mov_b32 vcc_hi, 0x33333333
    v_cndmask_b32_dpp v160, v232, v224, vcc quad_perm:[2,3,0,1] row_mask:0xf bank_mask:0xf
    v_cndmask_b32_dpp v161, v233, v225, vcc quad_perm:[2,3,0,1] row_mask:0xf bank_mask:0xf
    v_mfma_f32_16x16x32_bf16 v[8:11], v[124:127], v[56:59], v[8:11]
    ds_read_b64_tr_b16 v[40:41], v76 offset:0
    ds_read_b64_tr_b16 v[42:43], v76 offset:512
    v_cndmask_b32_dpp v162, v234, v226, vcc quad_perm:[2,3,0,1] row_mask:0xf bank_mask:0xf
    v_cndmask_b32_dpp v163, v235, v227, vcc quad_perm:[2,3,0,1] row_mask:0xf bank_mask:0xf
    v_mfma_f32_16x16x32_bf16 v[12:15], v[124:127], v[60:63], v[12:15]
    ds_read_b64_tr_b16 v[44:45], v77 offset:0
    ds_read_b64_tr_b16 v[46:47], v77 offset:512
    v_cndmask_b32_dpp v164, v236, v228, vcc quad_perm:[2,3,0,1] row_mask:0xf bank_mask:0xf
    v_cndmask_b32_dpp v165, v237, v229, vcc quad_perm:[2,3,0,1] row_mask:0xf bank_mask:0xf
    v_mfma_f32_16x16x32_bf16 v[16:19], v[124:127], v[64:67], v[16:19]
    ds_read_b64_tr_b16 v[48:49], v78 offset:0
    ds_read_b64_tr_b16 v[50:51], v78 offset:512
    v_cndmask_b32_dpp v166, v238, v230, vcc quad_perm:[2,3,0,1] row_mask:0xf bank_mask:0xf
    v_cndmask_b32_dpp v167, v239, v231, vcc quad_perm:[2,3,0,1] row_mask:0xf bank_mask:0xf
    buffer_load_dwordx4 v[124:127], v71, s[36:39], s68 offen offset:2048
    v_mfma_f32_16x16x32_bf16 v[20:23], v[140:143], v[52:55], v[20:23]
    s_mov_b32 vcc_lo, 0xcccccccc
    s_mov_b32 vcc_hi, 0xcccccccc
    v_cndmask_b32_dpp v168, v224, v232, vcc quad_perm:[2,3,0,1] row_mask:0xf bank_mask:0xf
    v_cndmask_b32_dpp v169, v225, v233, vcc quad_perm:[2,3,0,1] row_mask:0xf bank_mask:0xf
    v_mfma_f32_16x16x32_bf16 v[24:27], v[140:143], v[56:59], v[24:27]
    v_cndmask_b32_dpp v170, v226, v234, vcc quad_perm:[2,3,0,1] row_mask:0xf bank_mask:0xf
    v_cndmask_b32_dpp v171, v227, v235, vcc quad_perm:[2,3,0,1] row_mask:0xf bank_mask:0xf
    v_mfma_f32_16x16x32_bf16 v[28:31], v[140:143], v[60:63], v[28:31]
    v_cndmask_b32_dpp v172, v228, v236, vcc quad_perm:[2,3,0,1] row_mask:0xf bank_mask:0xf
    v_cndmask_b32_dpp v173, v229, v237, vcc quad_perm:[2,3,0,1] row_mask:0xf bank_mask:0xf
    v_mfma_f32_16x16x32_bf16 v[32:35], v[140:143], v[64:67], v[32:35]
    v_cndmask_b32_dpp v174, v230, v238, vcc quad_perm:[2,3,0,1] row_mask:0xf bank_mask:0xf
    v_cndmask_b32_dpp v175, v231, v239, vcc quad_perm:[2,3,0,1] row_mask:0xf bank_mask:0xf
    buffer_load_dwordx4 v[140:143], v72, s[36:39], s68 offen offset:2048
    v_xor_b32 v68, 0x300, v68
    v_xor_b32 v69, 0x300, v69
    v_xor_b32 v71, 0x300, v71
    v_xor_b32 v72, 0x300, v72
    s_waitcnt vmcnt(16) lgkmcnt(0)
    v_mfma_f32_16x16x32_bf16 v[4:7], v[144:147], v[36:39], v[4:7]
    ds_read_b64_tr_b16 v[52:53], v75 offset:1024
    ds_read_b64_tr_b16 v[54:55], v75 offset:1536
    s_mov_b32 vcc_lo, 0x55555555
    s_mov_b32 vcc_hi, 0x55555555
    v_cndmask_b32_dpp v224, v180, v176, vcc quad_perm:[1,0,3,2] row_mask:0xf bank_mask:0xf
    v_cndmask_b32_dpp v225, v181, v177, vcc quad_perm:[1,0,3,2] row_mask:0xf bank_mask:0xf
    v_mfma_f32_16x16x32_bf16 v[8:11], v[144:147], v[40:43], v[8:11]
    ds_read_b64_tr_b16 v[56:57], v76 offset:1024
    ds_read_b64_tr_b16 v[58:59], v76 offset:1536
    v_cndmask_b32_dpp v226, v182, v178, vcc quad_perm:[1,0,3,2] row_mask:0xf bank_mask:0xf
    v_cndmask_b32_dpp v227, v183, v179, vcc quad_perm:[1,0,3,2] row_mask:0xf bank_mask:0xf
    v_mfma_f32_16x16x32_bf16 v[12:15], v[144:147], v[44:47], v[12:15]
    ds_read_b64_tr_b16 v[60:61], v77 offset:1024
    ds_read_b64_tr_b16 v[62:63], v77 offset:1536
    v_cndmask_b32_dpp v232, v188, v184, vcc quad_perm:[1,0,3,2] row_mask:0xf bank_mask:0xf
    v_cndmask_b32_dpp v233, v189, v185, vcc quad_perm:[1,0,3,2] row_mask:0xf bank_mask:0xf
    v_mfma_f32_16x16x32_bf16 v[16:19], v[144:147], v[48:51], v[16:19]
    ds_read_b64_tr_b16 v[64:65], v78 offset:1024
    ds_read_b64_tr_b16 v[66:67], v78 offset:1536
    v_cndmask_b32_dpp v234, v190, v186, vcc quad_perm:[1,0,3,2] row_mask:0xf bank_mask:0xf
    v_cndmask_b32_dpp v235, v191, v187, vcc quad_perm:[1,0,3,2] row_mask:0xf bank_mask:0xf
    buffer_load_dwordx4 v[144:147], v68, s[36:39], s68 offen offset:0
    v_mfma_f32_16x16x32_bf16 v[20:23], v[160:163], v[36:39], v[20:23]
    s_mov_b32 vcc_lo, 0xaaaaaaaa
    s_mov_b32 vcc_hi, 0xaaaaaaaa
    v_cndmask_b32_dpp v228, v176, v180, vcc quad_perm:[1,0,3,2] row_mask:0xf bank_mask:0xf
    v_cndmask_b32_dpp v229, v177, v181, vcc quad_perm:[1,0,3,2] row_mask:0xf bank_mask:0xf
    v_mfma_f32_16x16x32_bf16 v[24:27], v[160:163], v[40:43], v[24:27]
    v_cndmask_b32_dpp v230, v178, v182, vcc quad_perm:[1,0,3,2] row_mask:0xf bank_mask:0xf
    v_cndmask_b32_dpp v231, v179, v183, vcc quad_perm:[1,0,3,2] row_mask:0xf bank_mask:0xf
    v_mfma_f32_16x16x32_bf16 v[28:31], v[160:163], v[44:47], v[28:31]
    v_cndmask_b32_dpp v236, v184, v188, vcc quad_perm:[1,0,3,2] row_mask:0xf bank_mask:0xf
    v_cndmask_b32_dpp v237, v185, v189, vcc quad_perm:[1,0,3,2] row_mask:0xf bank_mask:0xf
    v_mfma_f32_16x16x32_bf16 v[32:35], v[160:163], v[48:51], v[32:35]
    v_cndmask_b32_dpp v238, v186, v190, vcc quad_perm:[1,0,3,2] row_mask:0xf bank_mask:0xf
    v_cndmask_b32_dpp v239, v187, v191, vcc quad_perm:[1,0,3,2] row_mask:0xf bank_mask:0xf
    buffer_load_dwordx4 v[160:163], v69, s[36:39], s68 offen offset:0
    s_waitcnt lgkmcnt(0)
    v_mfma_f32_16x16x32_bf16 v[4:7], v[148:151], v[52:55], v[4:7]
    ds_read_b64_tr_b16 v[36:37], v75 offset:2048
    ds_read_b64_tr_b16 v[38:39], v75 offset:2560
    s_mov_b32 vcc_lo, 0x33333333
    s_mov_b32 vcc_hi, 0x33333333
    v_cndmask_b32_dpp v176, v232, v224, vcc quad_perm:[2,3,0,1] row_mask:0xf bank_mask:0xf
    v_cndmask_b32_dpp v177, v233, v225, vcc quad_perm:[2,3,0,1] row_mask:0xf bank_mask:0xf
    v_mfma_f32_16x16x32_bf16 v[8:11], v[148:151], v[56:59], v[8:11]
    ds_read_b64_tr_b16 v[40:41], v76 offset:2048
    ds_read_b64_tr_b16 v[42:43], v76 offset:2560
    v_cndmask_b32_dpp v178, v234, v226, vcc quad_perm:[2,3,0,1] row_mask:0xf bank_mask:0xf
    v_cndmask_b32_dpp v179, v235, v227, vcc quad_perm:[2,3,0,1] row_mask:0xf bank_mask:0xf
    v_mfma_f32_16x16x32_bf16 v[12:15], v[148:151], v[60:63], v[12:15]
    ds_read_b64_tr_b16 v[44:45], v77 offset:2048
    ds_read_b64_tr_b16 v[46:47], v77 offset:2560
    v_cndmask_b32_dpp v180, v236, v228, vcc quad_perm:[2,3,0,1] row_mask:0xf bank_mask:0xf
    v_cndmask_b32_dpp v181, v237, v229, vcc quad_perm:[2,3,0,1] row_mask:0xf bank_mask:0xf
    v_mfma_f32_16x16x32_bf16 v[16:19], v[148:151], v[64:67], v[16:19]
    ds_read_b64_tr_b16 v[48:49], v78 offset:2048
    ds_read_b64_tr_b16 v[50:51], v78 offset:2560
    v_cndmask_b32_dpp v182, v238, v230, vcc quad_perm:[2,3,0,1] row_mask:0xf bank_mask:0xf
    v_cndmask_b32_dpp v183, v239, v231, vcc quad_perm:[2,3,0,1] row_mask:0xf bank_mask:0xf
    buffer_load_dwordx4 v[148:151], v68, s[36:39], s68 offen offset:2048
    v_mfma_f32_16x16x32_bf16 v[20:23], v[164:167], v[52:55], v[20:23]
    s_mov_b32 vcc_lo, 0xcccccccc
    s_mov_b32 vcc_hi, 0xcccccccc
    v_cndmask_b32_dpp v184, v224, v232, vcc quad_perm:[2,3,0,1] row_mask:0xf bank_mask:0xf
    v_cndmask_b32_dpp v185, v225, v233, vcc quad_perm:[2,3,0,1] row_mask:0xf bank_mask:0xf
    v_mfma_f32_16x16x32_bf16 v[24:27], v[164:167], v[56:59], v[24:27]
    v_cndmask_b32_dpp v186, v226, v234, vcc quad_perm:[2,3,0,1] row_mask:0xf bank_mask:0xf
    v_cndmask_b32_dpp v187, v227, v235, vcc quad_perm:[2,3,0,1] row_mask:0xf bank_mask:0xf
    v_mfma_f32_16x16x32_bf16 v[28:31], v[164:167], v[60:63], v[28:31]
    v_cndmask_b32_dpp v188, v228, v236, vcc quad_perm:[2,3,0,1] row_mask:0xf bank_mask:0xf
    v_cndmask_b32_dpp v189, v229, v237, vcc quad_perm:[2,3,0,1] row_mask:0xf bank_mask:0xf
    v_mfma_f32_16x16x32_bf16 v[32:35], v[164:167], v[64:67], v[32:35]
    v_cndmask_b32_dpp v190, v230, v238, vcc quad_perm:[2,3,0,1] row_mask:0xf bank_mask:0xf
    v_cndmask_b32_dpp v191, v231, v239, vcc quad_perm:[2,3,0,1] row_mask:0xf bank_mask:0xf
    buffer_load_dwordx4 v[164:167], v69, s[36:39], s68 offen offset:2048
    s_waitcnt lgkmcnt(0)
    v_mfma_f32_16x16x32_bf16 v[4:7], v[152:155], v[36:39], v[4:7]
    ds_read_b64_tr_b16 v[52:53], v75 offset:3072
    ds_read_b64_tr_b16 v[54:55], v75 offset:3584
    s_mov_b32 vcc_lo, 0x55555555
    s_mov_b32 vcc_hi, 0x55555555
    v_cndmask_b32_dpp v224, v196, v192, vcc quad_perm:[1,0,3,2] row_mask:0xf bank_mask:0xf
    v_cndmask_b32_dpp v225, v197, v193, vcc quad_perm:[1,0,3,2] row_mask:0xf bank_mask:0xf
    v_mfma_f32_16x16x32_bf16 v[8:11], v[152:155], v[40:43], v[8:11]
    ds_read_b64_tr_b16 v[56:57], v76 offset:3072
    ds_read_b64_tr_b16 v[58:59], v76 offset:3584
    v_cndmask_b32_dpp v226, v198, v194, vcc quad_perm:[1,0,3,2] row_mask:0xf bank_mask:0xf
    v_cndmask_b32_dpp v227, v199, v195, vcc quad_perm:[1,0,3,2] row_mask:0xf bank_mask:0xf
    v_mfma_f32_16x16x32_bf16 v[12:15], v[152:155], v[44:47], v[12:15]
    ds_read_b64_tr_b16 v[60:61], v77 offset:3072
    ds_read_b64_tr_b16 v[62:63], v77 offset:3584
    v_cndmask_b32_dpp v232, v204, v200, vcc quad_perm:[1,0,3,2] row_mask:0xf bank_mask:0xf
    v_cndmask_b32_dpp v233, v205, v201, vcc quad_perm:[1,0,3,2] row_mask:0xf bank_mask:0xf
    v_mfma_f32_16x16x32_bf16 v[16:19], v[152:155], v[48:51], v[16:19]
    ds_read_b64_tr_b16 v[64:65], v78 offset:3072
    ds_read_b64_tr_b16 v[66:67], v78 offset:3584
    v_cndmask_b32_dpp v234, v206, v202, vcc quad_perm:[1,0,3,2] row_mask:0xf bank_mask:0xf
    v_cndmask_b32_dpp v235, v207, v203, vcc quad_perm:[1,0,3,2] row_mask:0xf bank_mask:0xf
    buffer_load_dwordx4 v[152:155], v71, s[36:39], s68 offen offset:0
    v_mfma_f32_16x16x32_bf16 v[20:23], v[168:171], v[36:39], v[20:23]
    s_mov_b32 vcc_lo, 0xaaaaaaaa
    s_mov_b32 vcc_hi, 0xaaaaaaaa
    v_cndmask_b32_dpp v228, v192, v196, vcc quad_perm:[1,0,3,2] row_mask:0xf bank_mask:0xf
    v_cndmask_b32_dpp v229, v193, v197, vcc quad_perm:[1,0,3,2] row_mask:0xf bank_mask:0xf
    v_mfma_f32_16x16x32_bf16 v[24:27], v[168:171], v[40:43], v[24:27]
    v_cndmask_b32_dpp v230, v194, v198, vcc quad_perm:[1,0,3,2] row_mask:0xf bank_mask:0xf
    v_cndmask_b32_dpp v231, v195, v199, vcc quad_perm:[1,0,3,2] row_mask:0xf bank_mask:0xf
    v_mfma_f32_16x16x32_bf16 v[28:31], v[168:171], v[44:47], v[28:31]
    v_cndmask_b32_dpp v236, v200, v204, vcc quad_perm:[1,0,3,2] row_mask:0xf bank_mask:0xf
    v_cndmask_b32_dpp v237, v201, v205, vcc quad_perm:[1,0,3,2] row_mask:0xf bank_mask:0xf
    v_mfma_f32_16x16x32_bf16 v[32:35], v[168:171], v[48:51], v[32:35]
    v_cndmask_b32_dpp v238, v202, v206, vcc quad_perm:[1,0,3,2] row_mask:0xf bank_mask:0xf
    v_cndmask_b32_dpp v239, v203, v207, vcc quad_perm:[1,0,3,2] row_mask:0xf bank_mask:0xf
    buffer_load_dwordx4 v[168:171], v72, s[36:39], s68 offen offset:0
    s_waitcnt lgkmcnt(0)
    v_xor_b32 v75, 0x4000, v75
    v_xor_b32 v76, 0x4000, v76
    v_xor_b32 v77, 0x4000, v77
    v_xor_b32 v78, 0x4000, v78
    v_mfma_f32_16x16x32_bf16 v[4:7], v[156:159], v[52:55], v[4:7]
    ds_read_b64_tr_b16 v[36:37], v75 offset:0
    ds_read_b64_tr_b16 v[38:39], v75 offset:512
    s_mov_b32 vcc_lo, 0x33333333
    s_mov_b32 vcc_hi, 0x33333333
    v_cndmask_b32_dpp v192, v232, v224, vcc quad_perm:[2,3,0,1] row_mask:0xf bank_mask:0xf
    v_cndmask_b32_dpp v193, v233, v225, vcc quad_perm:[2,3,0,1] row_mask:0xf bank_mask:0xf
    v_mfma_f32_16x16x32_bf16 v[8:11], v[156:159], v[56:59], v[8:11]
    ds_read_b64_tr_b16 v[40:41], v76 offset:0
    ds_read_b64_tr_b16 v[42:43], v76 offset:512
    v_cndmask_b32_dpp v194, v234, v226, vcc quad_perm:[2,3,0,1] row_mask:0xf bank_mask:0xf
    v_cndmask_b32_dpp v195, v235, v227, vcc quad_perm:[2,3,0,1] row_mask:0xf bank_mask:0xf
    v_mfma_f32_16x16x32_bf16 v[12:15], v[156:159], v[60:63], v[12:15]
    ds_read_b64_tr_b16 v[44:45], v77 offset:0
    ds_read_b64_tr_b16 v[46:47], v77 offset:512
    v_cndmask_b32_dpp v196, v236, v228, vcc quad_perm:[2,3,0,1] row_mask:0xf bank_mask:0xf
    v_cndmask_b32_dpp v197, v237, v229, vcc quad_perm:[2,3,0,1] row_mask:0xf bank_mask:0xf
    v_mfma_f32_16x16x32_bf16 v[16:19], v[156:159], v[64:67], v[16:19]
    ds_read_b64_tr_b16 v[48:49], v78 offset:0
    ds_read_b64_tr_b16 v[50:51], v78 offset:512
    v_cndmask_b32_dpp v198, v238, v230, vcc quad_perm:[2,3,0,1] row_mask:0xf bank_mask:0xf
    v_cndmask_b32_dpp v199, v239, v231, vcc quad_perm:[2,3,0,1] row_mask:0xf bank_mask:0xf
    buffer_load_dwordx4 v[156:159], v71, s[36:39], s68 offen offset:2048
    v_mfma_f32_16x16x32_bf16 v[20:23], v[172:175], v[52:55], v[20:23]
    s_mov_b32 vcc_lo, 0xcccccccc
    s_mov_b32 vcc_hi, 0xcccccccc
    v_cndmask_b32_dpp v200, v224, v232, vcc quad_perm:[2,3,0,1] row_mask:0xf bank_mask:0xf
    v_cndmask_b32_dpp v201, v225, v233, vcc quad_perm:[2,3,0,1] row_mask:0xf bank_mask:0xf
    v_mfma_f32_16x16x32_bf16 v[24:27], v[172:175], v[56:59], v[24:27]
    v_cndmask_b32_dpp v202, v226, v234, vcc quad_perm:[2,3,0,1] row_mask:0xf bank_mask:0xf
    v_cndmask_b32_dpp v203, v227, v235, vcc quad_perm:[2,3,0,1] row_mask:0xf bank_mask:0xf
    v_mfma_f32_16x16x32_bf16 v[28:31], v[172:175], v[60:63], v[28:31]
    v_cndmask_b32_dpp v204, v228, v236, vcc quad_perm:[2,3,0,1] row_mask:0xf bank_mask:0xf
    v_cndmask_b32_dpp v205, v229, v237, vcc quad_perm:[2,3,0,1] row_mask:0xf bank_mask:0xf
    v_mfma_f32_16x16x32_bf16 v[32:35], v[172:175], v[64:67], v[32:35]
    v_cndmask_b32_dpp v206, v230, v238, vcc quad_perm:[2,3,0,1] row_mask:0xf bank_mask:0xf
    v_cndmask_b32_dpp v207, v231, v239, vcc quad_perm:[2,3,0,1] row_mask:0xf bank_mask:0xf
    buffer_load_dwordx4 v[172:175], v72, s[36:39], s68 offen offset:2048
    v_xor_b32 v68, 0x100, v68
    v_xor_b32 v69, 0x100, v69
    v_xor_b32 v71, 0x100, v71
    v_xor_b32 v72, 0x100, v72
    s_waitcnt vmcnt(16) lgkmcnt(0)
    v_mfma_f32_16x16x32_bf16 v[4:7], v[176:179], v[36:39], v[4:7]
    ds_read_b64_tr_b16 v[52:53], v75 offset:1024
    ds_read_b64_tr_b16 v[54:55], v75 offset:1536
    s_mov_b32 vcc_lo, 0x55555555
    s_mov_b32 vcc_hi, 0x55555555
    v_cndmask_b32_dpp v224, v84, v80, vcc quad_perm:[1,0,3,2] row_mask:0xf bank_mask:0xf
    v_cndmask_b32_dpp v225, v85, v81, vcc quad_perm:[1,0,3,2] row_mask:0xf bank_mask:0xf
    v_mfma_f32_16x16x32_bf16 v[8:11], v[176:179], v[40:43], v[8:11]
    ds_read_b64_tr_b16 v[56:57], v76 offset:1024
    ds_read_b64_tr_b16 v[58:59], v76 offset:1536
    v_cndmask_b32_dpp v226, v86, v82, vcc quad_perm:[1,0,3,2] row_mask:0xf bank_mask:0xf
    v_cndmask_b32_dpp v227, v87, v83, vcc quad_perm:[1,0,3,2] row_mask:0xf bank_mask:0xf
    v_mfma_f32_16x16x32_bf16 v[12:15], v[176:179], v[44:47], v[12:15]
    ds_read_b64_tr_b16 v[60:61], v77 offset:1024
    ds_read_b64_tr_b16 v[62:63], v77 offset:1536
    v_cndmask_b32_dpp v232, v92, v88, vcc quad_perm:[1,0,3,2] row_mask:0xf bank_mask:0xf
    v_cndmask_b32_dpp v233, v93, v89, vcc quad_perm:[1,0,3,2] row_mask:0xf bank_mask:0xf
    v_mfma_f32_16x16x32_bf16 v[16:19], v[176:179], v[48:51], v[16:19]
    ds_read_b64_tr_b16 v[64:65], v78 offset:1024
    ds_read_b64_tr_b16 v[66:67], v78 offset:1536
    v_cndmask_b32_dpp v234, v94, v90, vcc quad_perm:[1,0,3,2] row_mask:0xf bank_mask:0xf
    v_cndmask_b32_dpp v235, v95, v91, vcc quad_perm:[1,0,3,2] row_mask:0xf bank_mask:0xf
    buffer_load_dwordx4 v[176:179], v68, s[36:39], s68 offen offset:0
    v_mfma_f32_16x16x32_bf16 v[20:23], v[192:195], v[36:39], v[20:23]
    s_mov_b32 vcc_lo, 0xaaaaaaaa
    s_mov_b32 vcc_hi, 0xaaaaaaaa
    v_cndmask_b32_dpp v228, v80, v84, vcc quad_perm:[1,0,3,2] row_mask:0xf bank_mask:0xf
    v_cndmask_b32_dpp v229, v81, v85, vcc quad_perm:[1,0,3,2] row_mask:0xf bank_mask:0xf
    v_mfma_f32_16x16x32_bf16 v[24:27], v[192:195], v[40:43], v[24:27]
    v_cndmask_b32_dpp v230, v82, v86, vcc quad_perm:[1,0,3,2] row_mask:0xf bank_mask:0xf
    v_cndmask_b32_dpp v231, v83, v87, vcc quad_perm:[1,0,3,2] row_mask:0xf bank_mask:0xf
    v_mfma_f32_16x16x32_bf16 v[28:31], v[192:195], v[44:47], v[28:31]
    v_cndmask_b32_dpp v236, v88, v92, vcc quad_perm:[1,0,3,2] row_mask:0xf bank_mask:0xf
    v_cndmask_b32_dpp v237, v89, v93, vcc quad_perm:[1,0,3,2] row_mask:0xf bank_mask:0xf
    v_mfma_f32_16x16x32_bf16 v[32:35], v[192:195], v[48:51], v[32:35]
    v_cndmask_b32_dpp v238, v90, v94, vcc quad_perm:[1,0,3,2] row_mask:0xf bank_mask:0xf
    v_cndmask_b32_dpp v239, v91, v95, vcc quad_perm:[1,0,3,2] row_mask:0xf bank_mask:0xf
    buffer_load_dwordx4 v[192:195], v69, s[36:39], s68 offen offset:0
    s_waitcnt lgkmcnt(0)
    v_mfma_f32_16x16x32_bf16 v[4:7], v[180:183], v[52:55], v[4:7]
    ds_read_b64_tr_b16 v[36:37], v75 offset:2048
    ds_read_b64_tr_b16 v[38:39], v75 offset:2560
    s_mov_b32 vcc_lo, 0x33333333
    s_mov_b32 vcc_hi, 0x33333333
    v_cndmask_b32_dpp v80, v232, v224, vcc quad_perm:[2,3,0,1] row_mask:0xf bank_mask:0xf
    v_cndmask_b32_dpp v81, v233, v225, vcc quad_perm:[2,3,0,1] row_mask:0xf bank_mask:0xf
    v_mfma_f32_16x16x32_bf16 v[8:11], v[180:183], v[56:59], v[8:11]
    ds_read_b64_tr_b16 v[40:41], v76 offset:2048
    ds_read_b64_tr_b16 v[42:43], v76 offset:2560
    v_cndmask_b32_dpp v82, v234, v226, vcc quad_perm:[2,3,0,1] row_mask:0xf bank_mask:0xf
    v_cndmask_b32_dpp v83, v235, v227, vcc quad_perm:[2,3,0,1] row_mask:0xf bank_mask:0xf
    v_mfma_f32_16x16x32_bf16 v[12:15], v[180:183], v[60:63], v[12:15]
    ds_read_b64_tr_b16 v[44:45], v77 offset:2048
    ds_read_b64_tr_b16 v[46:47], v77 offset:2560
    v_cndmask_b32_dpp v84, v236, v228, vcc quad_perm:[2,3,0,1] row_mask:0xf bank_mask:0xf
    v_cndmask_b32_dpp v85, v237, v229, vcc quad_perm:[2,3,0,1] row_mask:0xf bank_mask:0xf
    v_mfma_f32_16x16x32_bf16 v[16:19], v[180:183], v[64:67], v[16:19]
    ds_read_b64_tr_b16 v[48:49], v78 offset:2048
    ds_read_b64_tr_b16 v[50:51], v78 offset:2560
    v_cndmask_b32_dpp v86, v238, v230, vcc quad_perm:[2,3,0,1] row_mask:0xf bank_mask:0xf
    v_cndmask_b32_dpp v87, v239, v231, vcc quad_perm:[2,3,0,1] row_mask:0xf bank_mask:0xf
    buffer_load_dwordx4 v[180:183], v68, s[36:39], s68 offen offset:2048
    v_mfma_f32_16x16x32_bf16 v[20:23], v[196:199], v[52:55], v[20:23]
    s_mov_b32 vcc_lo, 0xcccccccc
    s_mov_b32 vcc_hi, 0xcccccccc
    v_cndmask_b32_dpp v88, v224, v232, vcc quad_perm:[2,3,0,1] row_mask:0xf bank_mask:0xf
    v_cndmask_b32_dpp v89, v225, v233, vcc quad_perm:[2,3,0,1] row_mask:0xf bank_mask:0xf
    v_mfma_f32_16x16x32_bf16 v[24:27], v[196:199], v[56:59], v[24:27]
    v_cndmask_b32_dpp v90, v226, v234, vcc quad_perm:[2,3,0,1] row_mask:0xf bank_mask:0xf
    v_cndmask_b32_dpp v91, v227, v235, vcc quad_perm:[2,3,0,1] row_mask:0xf bank_mask:0xf
    v_mfma_f32_16x16x32_bf16 v[28:31], v[196:199], v[60:63], v[28:31]
    v_cndmask_b32_dpp v92, v228, v236, vcc quad_perm:[2,3,0,1] row_mask:0xf bank_mask:0xf
    v_cndmask_b32_dpp v93, v229, v237, vcc quad_perm:[2,3,0,1] row_mask:0xf bank_mask:0xf
    v_mfma_f32_16x16x32_bf16 v[32:35], v[196:199], v[64:67], v[32:35]
    v_cndmask_b32_dpp v94, v230, v238, vcc quad_perm:[2,3,0,1] row_mask:0xf bank_mask:0xf
    v_cndmask_b32_dpp v95, v231, v239, vcc quad_perm:[2,3,0,1] row_mask:0xf bank_mask:0xf
    buffer_load_dwordx4 v[196:199], v69, s[36:39], s68 offen offset:2048
    s_waitcnt lgkmcnt(0)
    v_mfma_f32_16x16x32_bf16 v[4:7], v[184:187], v[36:39], v[4:7]
    ds_read_b64_tr_b16 v[52:53], v75 offset:3072
    ds_read_b64_tr_b16 v[54:55], v75 offset:3584
    s_mov_b32 vcc_lo, 0x55555555
    s_mov_b32 vcc_hi, 0x55555555
    v_cndmask_b32_dpp v224, v100, v96, vcc quad_perm:[1,0,3,2] row_mask:0xf bank_mask:0xf
    v_cndmask_b32_dpp v225, v101, v97, vcc quad_perm:[1,0,3,2] row_mask:0xf bank_mask:0xf
    v_mfma_f32_16x16x32_bf16 v[8:11], v[184:187], v[40:43], v[8:11]
    ds_read_b64_tr_b16 v[56:57], v76 offset:3072
    ds_read_b64_tr_b16 v[58:59], v76 offset:3584
    v_cndmask_b32_dpp v226, v102, v98, vcc quad_perm:[1,0,3,2] row_mask:0xf bank_mask:0xf
    v_cndmask_b32_dpp v227, v103, v99, vcc quad_perm:[1,0,3,2] row_mask:0xf bank_mask:0xf
    v_mfma_f32_16x16x32_bf16 v[12:15], v[184:187], v[44:47], v[12:15]
    ds_read_b64_tr_b16 v[60:61], v77 offset:3072
    ds_read_b64_tr_b16 v[62:63], v77 offset:3584
    v_cndmask_b32_dpp v232, v108, v104, vcc quad_perm:[1,0,3,2] row_mask:0xf bank_mask:0xf
    v_cndmask_b32_dpp v233, v109, v105, vcc quad_perm:[1,0,3,2] row_mask:0xf bank_mask:0xf
    v_mfma_f32_16x16x32_bf16 v[16:19], v[184:187], v[48:51], v[16:19]
    ds_read_b64_tr_b16 v[64:65], v78 offset:3072
    ds_read_b64_tr_b16 v[66:67], v78 offset:3584
    v_cndmask_b32_dpp v234, v110, v106, vcc quad_perm:[1,0,3,2] row_mask:0xf bank_mask:0xf
    v_cndmask_b32_dpp v235, v111, v107, vcc quad_perm:[1,0,3,2] row_mask:0xf bank_mask:0xf
    buffer_load_dwordx4 v[184:187], v71, s[36:39], s68 offen offset:0
    v_mfma_f32_16x16x32_bf16 v[20:23], v[200:203], v[36:39], v[20:23]
    s_mov_b32 vcc_lo, 0xaaaaaaaa
    s_mov_b32 vcc_hi, 0xaaaaaaaa
    v_cndmask_b32_dpp v228, v96, v100, vcc quad_perm:[1,0,3,2] row_mask:0xf bank_mask:0xf
    v_cndmask_b32_dpp v229, v97, v101, vcc quad_perm:[1,0,3,2] row_mask:0xf bank_mask:0xf
    v_mfma_f32_16x16x32_bf16 v[24:27], v[200:203], v[40:43], v[24:27]
    v_cndmask_b32_dpp v230, v98, v102, vcc quad_perm:[1,0,3,2] row_mask:0xf bank_mask:0xf
    v_cndmask_b32_dpp v231, v99, v103, vcc quad_perm:[1,0,3,2] row_mask:0xf bank_mask:0xf
    v_mfma_f32_16x16x32_bf16 v[28:31], v[200:203], v[44:47], v[28:31]
    v_cndmask_b32_dpp v236, v104, v108, vcc quad_perm:[1,0,3,2] row_mask:0xf bank_mask:0xf
    v_cndmask_b32_dpp v237, v105, v109, vcc quad_perm:[1,0,3,2] row_mask:0xf bank_mask:0xf
    v_mfma_f32_16x16x32_bf16 v[32:35], v[200:203], v[48:51], v[32:35]
    v_cndmask_b32_dpp v238, v106, v110, vcc quad_perm:[1,0,3,2] row_mask:0xf bank_mask:0xf
    v_cndmask_b32_dpp v239, v107, v111, vcc quad_perm:[1,0,3,2] row_mask:0xf bank_mask:0xf
    buffer_load_dwordx4 v[200:203], v72, s[36:39], s68 offen offset:0
    s_waitcnt lgkmcnt(0)
    v_xor_b32 v75, 0x1c000, v75
    v_xor_b32 v76, 0x1c000, v76
    v_xor_b32 v77, 0x1c000, v77
    v_xor_b32 v78, 0x1c000, v78
    v_mfma_f32_16x16x32_bf16 v[4:7], v[188:191], v[52:55], v[4:7]
    ds_read_b64_tr_b16 v[36:37], v75 offset:0
    ds_read_b64_tr_b16 v[38:39], v75 offset:512
    s_mov_b32 vcc_lo, 0x33333333
    s_mov_b32 vcc_hi, 0x33333333
    v_cndmask_b32_dpp v96, v232, v224, vcc quad_perm:[2,3,0,1] row_mask:0xf bank_mask:0xf
    v_cndmask_b32_dpp v97, v233, v225, vcc quad_perm:[2,3,0,1] row_mask:0xf bank_mask:0xf
    v_mfma_f32_16x16x32_bf16 v[8:11], v[188:191], v[56:59], v[8:11]
    ds_read_b64_tr_b16 v[40:41], v76 offset:0
    ds_read_b64_tr_b16 v[42:43], v76 offset:512
    v_cndmask_b32_dpp v98, v234, v226, vcc quad_perm:[2,3,0,1] row_mask:0xf bank_mask:0xf
    v_cndmask_b32_dpp v99, v235, v227, vcc quad_perm:[2,3,0,1] row_mask:0xf bank_mask:0xf
    v_mfma_f32_16x16x32_bf16 v[12:15], v[188:191], v[60:63], v[12:15]
    ds_read_b64_tr_b16 v[44:45], v77 offset:0
    ds_read_b64_tr_b16 v[46:47], v77 offset:512
    v_cndmask_b32_dpp v100, v236, v228, vcc quad_perm:[2,3,0,1] row_mask:0xf bank_mask:0xf
    v_cndmask_b32_dpp v101, v237, v229, vcc quad_perm:[2,3,0,1] row_mask:0xf bank_mask:0xf
    v_mfma_f32_16x16x32_bf16 v[16:19], v[188:191], v[64:67], v[16:19]
    ds_read_b64_tr_b16 v[48:49], v78 offset:0
    ds_read_b64_tr_b16 v[50:51], v78 offset:512
    v_cndmask_b32_dpp v102, v238, v230, vcc quad_perm:[2,3,0,1] row_mask:0xf bank_mask:0xf
    v_cndmask_b32_dpp v103, v239, v231, vcc quad_perm:[2,3,0,1] row_mask:0xf bank_mask:0xf
    buffer_load_dwordx4 v[188:191], v71, s[36:39], s68 offen offset:2048
    v_mfma_f32_16x16x32_bf16 v[20:23], v[204:207], v[52:55], v[20:23]
    s_mov_b32 vcc_lo, 0xcccccccc
    s_mov_b32 vcc_hi, 0xcccccccc
    v_cndmask_b32_dpp v104, v224, v232, vcc quad_perm:[2,3,0,1] row_mask:0xf bank_mask:0xf
    v_cndmask_b32_dpp v105, v225, v233, vcc quad_perm:[2,3,0,1] row_mask:0xf bank_mask:0xf
    v_mfma_f32_16x16x32_bf16 v[24:27], v[204:207], v[56:59], v[24:27]
    v_cndmask_b32_dpp v106, v226, v234, vcc quad_perm:[2,3,0,1] row_mask:0xf bank_mask:0xf
    v_cndmask_b32_dpp v107, v227, v235, vcc quad_perm:[2,3,0,1] row_mask:0xf bank_mask:0xf
    v_mfma_f32_16x16x32_bf16 v[28:31], v[204:207], v[60:63], v[28:31]
    v_cndmask_b32_dpp v108, v228, v236, vcc quad_perm:[2,3,0,1] row_mask:0xf bank_mask:0xf
    v_cndmask_b32_dpp v109, v229, v237, vcc quad_perm:[2,3,0,1] row_mask:0xf bank_mask:0xf
    v_mfma_f32_16x16x32_bf16 v[32:35], v[204:207], v[64:67], v[32:35]
    v_cndmask_b32_dpp v110, v230, v238, vcc quad_perm:[2,3,0,1] row_mask:0xf bank_mask:0xf
    v_cndmask_b32_dpp v111, v231, v239, vcc quad_perm:[2,3,0,1] row_mask:0xf bank_mask:0xf
    buffer_load_dwordx4 v[204:207], v72, s[36:39], s68 offen offset:2048
    v_xor_b32 v68, 0x700, v68
    v_xor_b32 v69, 0x700, v69
    v_xor_b32 v71, 0x700, v71
    v_xor_b32 v72, 0x700, v72
    s_and_b32 s85, s58, 4
    s_or_b32 s85, s85, s73
    s_cbranch_scc1 p0z_64
    s_barrier
p0z_64:
    s_add_u32 s73, s73, 1
    s_add_u32 s85, s73, 1
    s_bfe_u32 s68, s85, 0x40001
    s_lshl_b32 s68, s68, 19
    s_cmp_ge_u32 s85, 6
    s_cselect_b32 s68, 0x5ffffff0, s68
    s_bitcmp1_b32 s73, 0
    s_cbranch_scc1 p0_60
    v_cvt_pk_bf16_f32 v208, v4, v5
    v_cvt_pk_bf16_f32 v209, v6, v7
    v_cvt_pk_bf16_f32 v210, v20, v21
    v_cvt_pk_bf16_f32 v211, v22, v23
    buffer_store_dwordx4 v[208:211], v79, s[8:11], s81 offen offset:0 sc1
    v_cvt_pk_bf16_f32 v212, v8, v9
    v_cvt_pk_bf16_f32 v213, v10, v11
    v_cvt_pk_bf16_f32 v214, v24, v25
    v_cvt_pk_bf16_f32 v215, v26, v27
    buffer_store_dwordx4 v[212:215], v79, s[8:11], s81 offen offset:256 sc1
    v_cvt_pk_bf16_f32 v216, v12, v13
    v_cvt_pk_bf16_f32 v217, v14, v15
    v_cvt_pk_bf16_f32 v218, v28, v29
    v_cvt_pk_bf16_f32 v219, v30, v31
    buffer_store_dwordx4 v[216:219], v79, s[8:11], s81 offen offset:2048 sc1
    v_cvt_pk_bf16_f32 v220, v16, v17
    v_cvt_pk_bf16_f32 v221, v18, v19
    v_cvt_pk_bf16_f32 v222, v32, v33
    v_cvt_pk_bf16_f32 v223, v34, v35
    buffer_store_dwordx4 v[220:223], v79, s[8:11], s81 offen offset:2304 sc1
    v_mov_b32 v4, 0
    v_mov_b32 v5, 0
    v_mov_b32 v6, 0
    v_mov_b32 v7, 0
    v_mov_b32 v8, 0
    v_mov_b32 v9, 0
    v_mov_b32 v10, 0
    v_mov_b32 v11, 0
    v_mov_b32 v12, 0
    v_mov_b32 v13, 0
    v_mov_b32 v14, 0
    v_mov_b32 v15, 0
    v_mov_b32 v16, 0
    v_mov_b32 v17, 0
    v_mov_b32 v18, 0
    v_mov_b32 v19, 0
    v_mov_b32 v20, 0
    v_mov_b32 v21, 0
    v_mov_b32 v22, 0
    v_mov_b32 v23, 0
    v_mov_b32 v24, 0
    v_mov_b32 v25, 0
    v_mov_b32 v26, 0
    v_mov_b32 v27, 0
    v_mov_b32 v28, 0
    v_mov_b32 v29, 0
    v_mov_b32 v30, 0
    v_mov_b32 v31, 0
    v_mov_b32 v32, 0
    v_mov_b32 v33, 0
    v_mov_b32 v34, 0
    v_mov_b32 v35, 0
    s_add_u32 s81, s81, 0x200000
    s_mov_b32 s72, 1
    s_cmp_lt_u32 s73, 6
    s_cbranch_scc1 p0_60
    s_waitcnt vmcnt(0)
p0sig_61:
    s_add_u32 s85, s83, 163648
    s_waitcnt vmcnt(8)
    v_mov_b32 v208, s85
    v_mov_b32 v209, 1
    ds_add_rtn_u32 v210, v208, v209
    v_mov_b32 v208, s83
    v_mov_b32 v211, 0x5ffffff0
    s_add_u32 s83, s83, 8
    s_mov_b32 s72, 0
    s_waitcnt lgkmcnt(0)
    v_cmp_eq_u32 vcc, 255, v210
    s_nop 1
    v_cndmask_b32 v208, v211, v208, vcc
    s_cbranch_vccz p0nl_63
    buffer_atomic_add v209, v208, s[12:15], 0 offen sc1
p0nl_63:
    s_cmp_eq_u32 s73, 6
    s_cbranch_scc1 p0e_49
    s_cmp_lg_u32 s73, 2
    s_cbranch_scc1 p0ret_62
    s_nop 4
    v_mov_b32 v228, -1
    v_mov_b32 v232, 0
    v_mov_b32 v229, -1
    v_mov_b32 v233, 0
    v_mov_b32 v230, -1
    v_mov_b32 v234, 0
    v_mov_b32 v231, -1
    v_mov_b32 v235, 0
    v_bfe_u32 v208, v1, 0, 4
    v_lshlrev_b32 v208, 4, v208
    v_bfe_u32 v209, v1, 4, 1
    v_lshl_or_b32 v208, v209, 18, v208
    v_bfe_u32 v209, v1, 5, 1
    v_lshl_or_b32 v208, v209, 22, v208
    s_lshl_b32 s85, s76, 3
    s_add_u32 s85, s85, s58
    s_lshl_b32 s74, s85, 12
    v_lshlrev_b32 v209, 6, v1
    buffer_load_dword v240, v209, s[44:47], s74 offen
    buffer_load_dword v241, v209, s[36:39], s74 offen
    buffer_load_dword v242, v209, s[48:51], s74 offen
    buffer_load_dword v243, v209, s[52:55], s74 offen
    s_add_u32 s74, s74, 0x6000000
    v_lshlrev_b32 v210, 4, v1
    buffer_store_dwordx4 v[228:231], v210, s[8:11], s74 offen offset:0 sc1
    buffer_store_dwordx4 v[228:231], v210, s[8:11], s74 offen offset:1024 sc1
    buffer_store_dwordx4 v[228:231], v210, s[8:11], s74 offen offset:2048 sc1
    buffer_store_dwordx4 v[228:231], v210, s[8:11], s74 offen offset:3072 sc1
    s_lshl_b32 s74, s85, 5
    s_lshl_b32 s85, s85, 8
    s_add_u32 s85, s85, 0x4300000
    buffer_store_dwordx4 v[228:231], v208, s[8:11], s85 offen sc1
    s_add_u32 s85, s85, 0x80000
    buffer_store_dwordx4 v[228:231], v208, s[8:11], s85 offen sc1
    s_add_u32 s85, s85, 0x80000
    s_add_u32 s74, s74, 0x5100000
    v_and_b32 v211, 16, v210
    buffer_store_dwordx4 v[232:235], v211, s[8:11], s74 offen sc1
    s_lshl_b32 s85, s76, 3
    s_add_u32 s85, s85, s58
    v_lshlrev_b32 v212, 3, v1
    v_mul_u32_u24 v212, s85, v212
    v_and_b32 v213, 0x3ff, v212
    v_cvt_f32_u32 v213, v213
    v_mul_f32 v213, 0x3a800000, v213
    v_cos_f32 v214, v213
    v_sin_f32 v215, -v213
    v_add_u32 v212, s85, v212
    v_cvt_pk_bf16_f32 v218, v214, v215
    v_and_b32 v213, 0x3ff, v212
    v_cvt_f32_u32 v213, v213
    v_mul_f32 v213, 0x3a800000, v213
    v_cos_f32 v214, v213
    v_sin_f32 v215, -v213
    v_add_u32 v212, s85, v212
    v_cvt_pk_bf16_f32 v219, v214, v215
    v_and_b32 v213, 0x3ff, v212
    v_cvt_f32_u32 v213, v213
    v_mul_f32 v213, 0x3a800000, v213
    v_cos_f32 v214, v213
    v_sin_f32 v215, -v213
    v_add_u32 v212, s85, v212
    v_cvt_pk_bf16_f32 v220, v214, v215
    v_and_b32 v213, 0x3ff, v212
    v_cvt_f32_u32 v213, v213
    v_mul_f32 v213, 0x3a800000, v213
    v_cos_f32 v214, v213
    v_sin_f32 v215, -v213
    v_add_u32 v212, s85, v212
    v_cvt_pk_bf16_f32 v221, v214, v215
    v_and_b32 v213, 0x3ff, v212
    v_cvt_f32_u32 v213, v213
    v_mul_f32 v213, 0x3a800000, v213
    v_cos_f32 v214, v213
    v_sin_f32 v215, -v213
    v_add_u32 v212, s85, v212
    v_cvt_pk_bf16_f32 v222, v214, v215
    v_and_b32 v213, 0x3ff, v212
    v_cvt_f32_u32 v213, v213
    v_mul_f32 v213, 0x3a800000, v213
    v_cos_f32 v214, v213
    v_sin_f32 v215, -v213
    v_add_u32 v212, s85, v212
    v_cvt_pk_bf16_f32 v223, v214, v215
    v_and_b32 v213, 0x3ff, v212
    v_cvt_f32_u32 v213, v213
    v_mul_f32 v213, 0x3a800000, v213
    v_cos_f32 v214, v213
    v_sin_f32 v215, -v213
    v_add_u32 v212, s85, v212
    v_cvt_pk_bf16_f32 v224, v214, v215
    v_and_b32 v213, 0x3ff, v212
    v_cvt_f32_u32 v213, v213
    v_mul_f32 v213, 0x3a800000, v213
    v_cos_f32 v214, v213
    v_sin_f32 v215, -v213
    v_add_u32 v212, s85, v212
    v_cvt_pk_bf16_f32 v225, v214, v215
    v_mov_b32 v213, s85
    v_lshlrev_b32 v213, 31, v213
    v_or_b32 v213, 0x3f803f80, v213
    v_cmp_eq_u32 vcc, 0, v1
    s_nop 1
    v_cndmask_b32 v218, v218, v213, vcc
    v_lshlrev_b32 v216, 5, v1
    s_lshl_b32 s85, s85, 11
    s_add_u32 s85, s85, 0x5200000
    buffer_store_dwordx4 v[218:221], v216, s[8:11], s85 offen sc1
    buffer_store_dwordx4 v[222:225], v216, s[8:11], s85 offen offset:16 sc1
    s_branch p0ret_62
p0e_49:
    s_barrier
    s_branch disp_50
f256_44:
    s_mov_b32 s72, 0
    s_waitcnt vmcnt(12)
    s_barrier
    v_add_u32 v74, s72, v72
    v_add_u32 v75, s72, v73
    v_xor_b32 v76, 32, v75
    v_xor_b32 v77, 64, v75
    v_xor_b32 v78, 96, v75
    s_add_u32 s72, s72, 32768
    s_and_b32 s72, s72, 0x1ffff
    ds_read_b128 v[4:7], v74 offset:0
    ds_read_b128 v[8:11], v74 offset:1024
    ds_read_b128 v[12:15], v74 offset:2048
    ds_read_b128 v[16:19], v74 offset:3072
    ds_read_b64_tr_b16 v[36:37], v75 offset:0
    ds_read_b64_tr_b16 v[38:39], v75 offset:2048
    ds_read_b64_tr_b16 v[40:41], v76 offset:0
    ds_read_b64_tr_b16 v[42:43], v76 offset:2048
    ds_read_b64_tr_b16 v[44:45], v77 offset:0
    ds_read_b64_tr_b16 v[46:47], v77 offset:2048
    ds_read_b64_tr_b16 v[48:49], v78 offset:0
    ds_read_b64_tr_b16 v[50:51], v78 offset:2048
    s_waitcnt lgkmcnt(0)
    v_mfma_f32_16x16x32_bf16 v[80:83], v[36:39], v[4:7], 0
    ds_read_b128 v[20:23], v74 offset:4096
    v_mfma_f32_16x16x32_bf16 v[84:87], v[40:43], v[4:7], 0
    v_mfma_f32_16x16x32_bf16 v[88:91], v[44:47], v[4:7], 0
    ds_read_b128 v[24:27], v74 offset:5120
    v_mfma_f32_16x16x32_bf16 v[92:95], v[48:51], v[4:7], 0
    v_mfma_f32_16x16x32_bf16 v[96:99], v[36:39], v[8:11], 0
    ds_read_b128 v[28:31], v74 offset:6144
    v_mfma_f32_16x16x32_bf16 v[100:103], v[40:43], v[8:11], 0
    v_mfma_f32_16x16x32_bf16 v[104:107], v[44:47], v[8:11], 0
    ds_read_b128 v[32:35], v74 offset:7168
    v_mfma_f32_16x16x32_bf16 v[108:111], v[48:51], v[8:11], 0
    v_mfma_f32_16x16x32_bf16 v[112:115], v[36:39], v[12:15], 0
    v_mfma_f32_16x16x32_bf16 v[116:119], v[40:43], v[12:15], 0
    v_mfma_f32_16x16x32_bf16 v[120:123], v[44:47], v[12:15], 0
    v_mfma_f32_16x16x32_bf16 v[124:127], v[48:51], v[12:15], 0
    v_mfma_f32_16x16x32_bf16 v[128:131], v[36:39], v[16:19], 0
    v_mfma_f32_16x16x32_bf16 v[132:135], v[40:43], v[16:19], 0
    v_mfma_f32_16x16x32_bf16 v[136:139], v[44:47], v[16:19], 0
    v_mfma_f32_16x16x32_bf16 v[140:143], v[48:51], v[16:19], 0
    s_waitcnt vmcnt(8) lgkmcnt(0)
    s_barrier
    v_mfma_f32_16x16x32_bf16 v[144:147], v[36:39], v[20:23], 0
    v_add_u32 v74, s72, v72
    v_add_u32 v75, s72, v73
    v_xor_b32 v76, 32, v75
    v_xor_b32 v77, 64, v75
    v_xor_b32 v78, 96, v75
    v_mfma_f32_16x16x32_bf16 v[148:151], v[40:43], v[20:23], 0
    s_add_u32 s72, s72, 32768
    s_and_b32 s72, s72, 0x1ffff
    ds_read_b128 v[4:7], v74 offset:0
    v_mfma_f32_16x16x32_bf16 v[152:155], v[44:47], v[20:23], 0
    ds_read_b64_tr_b16 v[52:53], v75 offset:0
    v_mfma_f32_16x16x32_bf16 v[156:159], v[48:51], v[20:23], 0
    ds_read_b64_tr_b16 v[54:55], v75 offset:2048
    ds_read_b64_tr_b16 v[56:57], v76 offset:0
    v_mfma_f32_16x16x32_bf16 v[160:163], v[36:39], v[24:27], 0
    ds_read_b64_tr_b16 v[58:59], v76 offset:2048
    v_mfma_f32_16x16x32_bf16 v[164:167], v[40:43], v[24:27], 0
    ds_read_b64_tr_b16 v[60:61], v77 offset:0
    ds_read_b64_tr_b16 v[62:63], v77 offset:2048
    v_mfma_f32_16x16x32_bf16 v[168:171], v[44:47], v[24:27], 0
    ds_read_b64_tr_b16 v[64:65], v78 offset:0
    v_mfma_f32_16x16x32_bf16 v[172:175], v[48:51], v[24:27], 0
    ds_read_b64_tr_b16 v[66:67], v78 offset:2048
    ds_read_b128 v[8:11], v74 offset:1024
    v_mfma_f32_16x16x32_bf16 v[176:179], v[36:39], v[28:31], 0
    ds_read_b128 v[12:15], v74 offset:2048
    ds_read_b128 v[16:19], v74 offset:3072
    v_mfma_f32_16x16x32_bf16 v[180:183], v[40:43], v[28:31], 0
    s_mov_b32 m0, s71
    v_mfma_f32_16x16x32_bf16 v[184:187], v[44:47], v[28:31], 0
    buffer_load_dwordx4 v68, s[60:63], s68 offen lds
    s_add_u32 m0, s71, 1024
    v_mfma_f32_16x16x32_bf16 v[188:191], v[48:51], v[28:31], 0
    buffer_load_dwordx4 v69, s[60:63], s68 offen lds
    v_mfma_f32_16x16x32_bf16 v[192:195], v[36:39], v[32:35], 0
    s_add_u32 m0, s71, 16384
    s_nop 0
    buffer_load_dwordx4 v70, s[64:67], s69 offen lds
    v_mfma_f32_16x16x32_bf16 v[196:199], v[40:43], v[32:35], 0
    s_add_u32 m0, s71, 17408
    v_mfma_f32_16x16x32_bf16 v[200:203], v[44:47], v[32:35], 0
    buffer_load_dwordx4 v71, s[64:67], s69 offen lds
    s_add_u32 s68, s68, 64
    s_add_u32 s69, s69, s70
    v_mfma_f32_16x16x32_bf16 v[204:207], v[48:51], v[32:35], 0
    s_add_u32 s71, s71, 32768
    s_and_b32 s71, s71, 0x1ffff
    s_waitcnt lgkmcnt(0)
    v_mfma_f32_16x16x32_bf16 v[80:83], v[52:55], v[4:7], v[80:83]
    ds_read_b128 v[20:23], v74 offset:4096
    v_mfma_f32_16x16x32_bf16 v[84:87], v[56:59], v[4:7], v[84:87]
    v_mfma_f32_16x16x32_bf16 v[88:91], v[60:63], v[4:7], v[88:91]
    ds_read_b128 v[24:27], v74 offset:5120
    v_mfma_f32_16x16x32_bf16 v[92:95], v[64:67], v[4:7], v[92:95]
    v_mfma_f32_16x16x32_bf16 v[96:99], v[52:55], v[8:11], v[96:99]
    ds_read_b128 v[28:31], v74 offset:6144
    v_mfma_f32_16x16x32_bf16 v[100:103], v[56:59], v[8:11], v[100:103]
    v_mfma_f32_16x16x32_bf16 v[104:107], v[60:63], v[8:11], v[104:107]
    ds_read_b128 v[32:35], v74 offset:7168
    v_mfma_f32_16x16x32_bf16 v[108:111], v[64:67], v[8:11], v[108:111]
    v_mfma_f32_16x16x32_bf16 v[112:115], v[52:55], v[12:15], v[112:115]
    v_mfma_f32_16x16x32_bf16 v[116:119], v[56:59], v[12:15], v[116:119]
    v_mfma_f32_16x16x32_bf16 v[120:123], v[60:63], v[12:15], v[120:123]
    v_mfma_f32_16x16x32_bf16 v[124:127], v[64:67], v[12:15], v[124:127]
    v_mfma_f32_16x16x32_bf16 v[128:131], v[52:55], v[16:19], v[128:131]
    v_mfma_f32_16x16x32_bf16 v[132:135], v[56:59], v[16:19], v[132:135]
    v_mfma_f32_16x16x32_bf16 v[136:139], v[60:63], v[16:19], v[136:139]
    v_mfma_f32_16x16x32_bf16 v[140:143], v[64:67], v[16:19], v[140:143]
    s_waitcnt vmcnt(8) lgkmcnt(0)
    s_barrier
    v_mfma_f32_16x16x32_bf16 v[144:147], v[52:55], v[20:23], v[144:147]
    v_add_u32 v74, s72, v72
    v_add_u32 v75, s72, v73
    v_xor_b32 v76, 32, v75
    v_xor_b32 v77, 64, v75
    v_xor_b32 v78, 96, v75
    v_mfma_f32_16x16x32_bf16 v[148:151], v[56:59], v[20:23], v[148:151]
    s_add_u32 s72, s72, 32768
    s_and_b32 s72, s72, 0x1ffff
    ds_read_b128 v[4:7], v74 offset:0
    v_mfma_f32_16x16x32_bf16 v[152:155], v[60:63], v[20:23], v[152:155]
    ds_read_b64_tr_b16 v[36:37], v75 offset:0
    v_mfma_f32_16x16x32_bf16 v[156:159], v[64:67], v[20:23], v[156:159]
    ds_read_b64_tr_b16 v[38:39], v75 offset:2048
    ds_read_b64_tr_b16 v[40:41], v76 offset:0
    v_mfma_f32_16x16x32_bf16 v[160:163], v[52:55], v[24:27], v[160:163]
    ds_read_b64_tr_b16 v[42:43], v76 offset:2048
    v_mfma_f32_16x16x32_bf16 v[164:167], v[56:59], v[24:27], v[164:167]
    ds_read_b64_tr_b16 v[44:45], v77 offset:0
    ds_read_b64_tr_b16 v[46:47], v77 offset:2048
    v_mfma_f32_16x16x32_bf16 v[168:171], v[60:63], v[24:27], v[168:171]
    ds_read_b64_tr_b16 v[48:49], v78 offset:0
    v_mfma_f32_16x16x32_bf16 v[172:175], v[64:67], v[24:27], v[172:175]
    ds_read_b64_tr_b16 v[50:51], v78 offset:2048
    ds_read_b128 v[8:11], v74 offset:1024
    v_mfma_f32_16x16x32_bf16 v[176:179], v[52:55], v[28:31], v[176:179]
    ds_read_b128 v[12:15], v74 offset:2048
    ds_read_b128 v[16:19], v74 offset:3072
    v_mfma_f32_16x16x32_bf16 v[180:183], v[56:59], v[28:31], v[180:183]
    s_mov_b32 m0, s71
    v_mfma_f32_16x16x32_bf16 v[184:187], v[60:63], v[28:31], v[184:187]
    buffer_load_dwordx4 v68, s[60:63], s68 offen lds
    s_add_u32 m0, s71, 1024
    v_mfma_f32_16x16x32_bf16 v[188:191], v[64:67], v[28:31], v[188:191]
    buffer_load_dwordx4 v69, s[60:63], s68 offen lds
    v_mfma_f32_16x16x32_bf16 v[192:195], v[52:55], v[32:35], v[192:195]
    s_add_u32 m0, s71, 16384
    s_nop 0
    buffer_load_dwordx4 v70, s[64:67], s69 offen lds
    v_mfma_f32_16x16x32_bf16 v[196:199], v[56:59], v[32:35], v[196:199]
    s_add_u32 m0, s71, 17408
    v_mfma_f32_16x16x32_bf16 v[200:203], v[60:63], v[32:35], v[200:203]
    buffer_load_dwordx4 v71, s[64:67], s69 offen lds
    s_add_u32 s68, s68, 64
    s_add_u32 s69, s69, s70
    v_mfma_f32_16x16x32_bf16 v[204:207], v[64:67], v[32:35], v[204:207]
    s_add_u32 s71, s71, 32768
    s_and_b32 s71, s71, 0x1ffff
    s_mov_b32 s73, 13
gl_65:
    s_waitcnt lgkmcnt(0)
    v_mfma_f32_16x16x32_bf16 v[80:83], v[36:39], v[4:7], v[80:83]
    ds_read_b128 v[20:23], v74 offset:4096
    v_mfma_f32_16x16x32_bf16 v[84:87], v[40:43], v[4:7], v[84:87]
    v_mfma_f32_16x16x32_bf16 v[88:91], v[44:47], v[4:7], v[88:91]
    ds_read_b128 v[24:27], v74 offset:5120
    v_mfma_f32_16x16x32_bf16 v[92:95], v[48:51], v[4:7], v[92:95]
    v_mfma_f32_16x16x32_bf16 v[96:99], v[36:39], v[8:11], v[96:99]
    ds_read_b128 v[28:31], v74 offset:6144
    v_mfma_f32_16x16x32_bf16 v[100:103], v[40:43], v[8:11], v[100:103]
    v_mfma_f32_16x16x32_bf16 v[104:107], v[44:47], v[8:11], v[104:107]
    ds_read_b128 v[32:35], v74 offset:7168
    v_mfma_f32_16x16x32_bf16 v[108:111], v[48:51], v[8:11], v[108:111]
    v_mfma_f32_16x16x32_bf16 v[112:115], v[36:39], v[12:15], v[112:115]
    v_mfma_f32_16x16x32_bf16 v[116:119], v[40:43], v[12:15], v[116:119]
    v_mfma_f32_16x16x32_bf16 v[120:123], v[44:47], v[12:15], v[120:123]
    v_mfma_f32_16x16x32_bf16 v[124:127], v[48:51], v[12:15], v[124:127]
    v_mfma_f32_16x16x32_bf16 v[128:131], v[36:39], v[16:19], v[128:131]
    v_mfma_f32_16x16x32_bf16 v[132:135], v[40:43], v[16:19], v[132:135]
    v_mfma_f32_16x16x32_bf16 v[136:139], v[44:47], v[16:19], v[136:139]
    v_mfma_f32_16x16x32_bf16 v[140:143], v[48:51], v[16:19], v[140:143]
    s_waitcnt vmcnt(8) lgkmcnt(0)
    s_barrier
    v_mfma_f32_16x16x32_bf16 v[144:147], v[36:39], v[20:23], v[144:147]
    v_add_u32 v74, s72, v72
    v_add_u32 v75, s72, v73
    v_xor_b32 v76, 32, v75
    v_xor_b32 v77, 64, v75
    v_xor_b32 v78, 96, v75
    v_mfma_f32_16x16x32_bf16 v[148:151], v[40:43], v[20:23], v[148:151]
    s_add_u32 s72, s72, 32768
    s_and_b32 s72, s72, 0x1ffff
    ds_read_b128 v[4:7], v74 offset:0
    v_mfma_f32_16x16x32_bf16 v[152:155], v[44:47], v[20:23], v[152:155]
    ds_read_b64_tr_b16 v[52:53], v75 offset:0
    v_mfma_f32_16x16x32_bf16 v[156:159], v[48:51], v[20:23], v[156:159]
    ds_read_b64_tr_b16 v[54:55], v75 offset:2048
    ds_read_b64_tr_b16 v[56:57], v76 offset:0
    v_mfma_f32_16x16x32_bf16 v[160:163], v[36:39], v[24:27], v[160:163]
    ds_read_b64_tr_b16 v[58:59], v76 offset:2048
    v_mfma_f32_16x16x32_bf16 v[164:167], v[40:43], v[24:27], v[164:167]
    ds_read_b64_tr_b16 v[60:61], v77 offset:0
    ds_read_b64_tr_b16 v[62:63], v77 offset:2048
    v_mfma_f32_16x16x32_bf16 v[168:171], v[44:47], v[24:27], v[168:171]
    ds_read_b64_tr_b16 v[64:65], v78 offset:0
    v_mfma_f32_16x16x32_bf16 v[172:175], v[48:51], v[24:27], v[172:175]
    ds_read_b64_tr_b16 v[66:67], v78 offset:2048
    ds_read_b128 v[8:11], v74 offset:1024
    v_mfma_f32_16x16x32_bf16 v[176:179], v[36:39], v[28:31], v[176:179]
    ds_read_b128 v[12:15], v74 offset:2048
    ds_read_b128 v[16:19], v74 offset:3072
    v_mfma_f32_16x16x32_bf16 v[180:183], v[40:43], v[28:31], v[180:183]
    s_mov_b32 m0, s71
    v_mfma_f32_16x16x32_bf16 v[184:187], v[44:47], v[28:31], v[184:187]
    buffer_load_dwordx4 v68, s[60:63], s68 offen lds
    s_add_u32 m0, s71, 1024
    v_mfma_f32_16x16x32_bf16 v[188:191], v[48:51], v[28:31], v[188:191]
    buffer_load_dwordx4 v69, s[60:63], s68 offen lds
    v_mfma_f32_16x16x32_bf16 v[192:195], v[36:39], v[32:35], v[192:195]
    s_add_u32 m0, s71, 16384
    s_nop 0
    buffer_load_dwordx4 v70, s[64:67], s69 offen lds
    v_mfma_f32_16x16x32_bf16 v[196:199], v[40:43], v[32:35], v[196:199]
    s_add_u32 m0, s71, 17408
    v_mfma_f32_16x16x32_bf16 v[200:203], v[44:47], v[32:35], v[200:203]
    buffer_load_dwordx4 v71, s[64:67], s69 offen lds
    s_add_u32 s68, s68, 64
    s_add_u32 s69, s69, s70
    v_mfma_f32_16x16x32_bf16 v[204:207], v[48:51], v[32:35], v[204:207]
    s_add_u32 s71, s71, 32768
    s_and_b32 s71, s71, 0x1ffff
    s_waitcnt lgkmcnt(0)
    v_mfma_f32_16x16x32_bf16 v[80:83], v[52:55], v[4:7], v[80:83]
    ds_read_b128 v[20:23], v74 offset:4096
    v_mfma_f32_16x16x32_bf16 v[84:87], v[56:59], v[4:7], v[84:87]
    v_mfma_f32_16x16x32_bf16 v[88:91], v[60:63], v[4:7], v[88:91]
    ds_read_b128 v[24:27], v74 offset:5120
    v_mfma_f32_16x16x32_bf16 v[92:95], v[64:67], v[4:7], v[92:95]
    v_mfma_f32_16x16x32_bf16 v[96:99], v[52:55], v[8:11], v[96:99]
    ds_read_b128 v[28:31], v74 offset:6144
    v_mfma_f32_16x16x32_bf16 v[100:103], v[56:59], v[8:11], v[100:103]
    v_mfma_f32_16x16x32_bf16 v[104:107], v[60:63], v[8:11], v[104:107]
    ds_read_b128 v[32:35], v74 offset:7168
    v_mfma_f32_16x16x32_bf16 v[108:111], v[64:67], v[8:11], v[108:111]
    v_mfma_f32_16x16x32_bf16 v[112:115], v[52:55], v[12:15], v[112:115]
    v_mfma_f32_16x16x32_bf16 v[116:119], v[56:59], v[12:15], v[116:119]
    v_mfma_f32_16x16x32_bf16 v[120:123], v[60:63], v[12:15], v[120:123]
    v_mfma_f32_16x16x32_bf16 v[124:127], v[64:67], v[12:15], v[124:127]
    v_mfma_f32_16x16x32_bf16 v[128:131], v[52:55], v[16:19], v[128:131]
    v_mfma_f32_16x16x32_bf16 v[132:135], v[56:59], v[16:19], v[132:135]
    v_mfma_f32_16x16x32_bf16 v[136:139], v[60:63], v[16:19], v[136:139]
    v_mfma_f32_16x16x32_bf16 v[140:143], v[64:67], v[16:19], v[140:143]
    s_waitcnt vmcnt(8) lgkmcnt(0)
    s_barrier
    v_mfma_f32_16x16x32_bf16 v[144:147], v[52:55], v[20:23], v[144:147]
    v_add_u32 v74, s72, v72
    v_add_u32 v75, s72, v73
    v_xor_b32 v76, 32, v75
    v_xor_b32 v77, 64, v75
    v_xor_b32 v78, 96, v75
    v_mfma_f32_16x16x32_bf16 v[148:151], v[56:59], v[20:23], v[148:151]
    s_add_u32 s72, s72, 32768
    s_and_b32 s72, s72, 0x1ffff
    ds_read_b128 v[4:7], v74 offset:0
    v_mfma_f32_16x16x32_bf16 v[152:155], v[60:63], v[20:23], v[152:155]
    ds_read_b64_tr_b16 v[36:37], v75 offset:0
    v_mfma_f32_16x16x32_bf16 v[156:159], v[64:67], v[20:23], v[156:159]
    ds_read_b64_tr_b16 v[38:39], v75 offset:2048
    ds_read_b64_tr_b16 v[40:41], v76 offset:0
    v_mfma_f32_16x16x32_bf16 v[160:163], v[52:55], v[24:27], v[160:163]
    ds_read_b64_tr_b16 v[42:43], v76 offset:2048
    v_mfma_f32_16x16x32_bf16 v[164:167], v[56:59], v[24:27], v[164:167]
    ds_read_b64_tr_b16 v[44:45], v77 offset:0
    ds_read_b64_tr_b16 v[46:47], v77 offset:2048
    v_mfma_f32_16x16x32_bf16 v[168:171], v[60:63], v[24:27], v[168:171]
    ds_read_b64_tr_b16 v[48:49], v78 offset:0
    v_mfma_f32_16x16x32_bf16 v[172:175], v[64:67], v[24:27], v[172:175]
    ds_read_b64_tr_b16 v[50:51], v78 offset:2048
    ds_read_b128 v[8:11], v74 offset:1024
    v_mfma_f32_16x16x32_bf16 v[176:179], v[52:55], v[28:31], v[176:179]
    ds_read_b128 v[12:15], v74 offset:2048
    ds_read_b128 v[16:19], v74 offset:3072
    v_mfma_f32_16x16x32_bf16 v[180:183], v[56:59], v[28:31], v[180:183]
    s_mov_b32 m0, s71
    v_mfma_f32_16x16x32_bf16 v[184:187], v[60:63], v[28:31], v[184:187]
    buffer_load_dwordx4 v68, s[60:63], s68 offen lds
    s_add_u32 m0, s71, 1024
    v_mfma_f32_16x16x32_bf16 v[188:191], v[64:67], v[28:31], v[188:191]
    buffer_load_dwordx4 v69, s[60:63], s68 offen lds
    v_mfma_f32_16x16x32_bf16 v[192:195], v[52:55], v[32:35], v[192:195]
    s_add_u32 m0, s71, 16384
    s_nop 0
    buffer_load_dwordx4 v70, s[64:67], s69 offen lds
    v_mfma_f32_16x16x32_bf16 v[196:199], v[56:59], v[32:35], v[196:199]
    s_add_u32 m0, s71, 17408
    v_mfma_f32_16x16x32_bf16 v[200:203], v[60:63], v[32:35], v[200:203]
    buffer_load_dwordx4 v71, s[64:67], s69 offen lds
    s_add_u32 s68, s68, 64
    s_add_u32 s69, s69, s70
    v_mfma_f32_16x16x32_bf16 v[204:207], v[64:67], v[32:35], v[204:207]
    s_add_u32 s71, s71, 32768
    s_and_b32 s71, s71, 0x1ffff
    s_sub_u32 s73, s73, 1
    s_cmp_lg_u32 s73, 0
    s_cbranch_scc1 gl_65
    s_waitcnt lgkmcnt(0)
    v_mfma_f32_16x16x32_bf16 v[80:83], v[36:39], v[4:7], v[80:83]
    ds_read_b128 v[20:23], v74 offset:4096
    v_mfma_f32_16x16x32_bf16 v[84:87], v[40:43], v[4:7], v[84:87]
    v_mfma_f32_16x16x32_bf16 v[88:91], v[44:47], v[4:7], v[88:91]
    ds_read_b128 v[24:27], v74 offset:5120
    v_mfma_f32_16x16x32_bf16 v[92:95], v[48:51], v[4:7], v[92:95]
    v_mfma_f32_16x16x32_bf16 v[96:99], v[36:39], v[8:11], v[96:99]
    ds_read_b128 v[28:31], v74 offset:6144
    v_mfma_f32_16x16x32_bf16 v[100:103], v[40:43], v[8:11], v[100:103]
    v_mfma_f32_16x16x32_bf16 v[104:107], v[44:47], v[8:11], v[104:107]
    ds_read_b128 v[32:35], v74 offset:7168
    v_mfma_f32_16x16x32_bf16 v[108:111], v[48:51], v[8:11], v[108:111]
    v_mfma_f32_16x16x32_bf16 v[112:115], v[36:39], v[12:15], v[112:115]
    v_mfma_f32_16x16x32_bf16 v[116:119], v[40:43], v[12:15], v[116:119]
    v_mfma_f32_16x16x32_bf16 v[120:123], v[44:47], v[12:15], v[120:123]
    v_mfma_f32_16x16x32_bf16 v[124:127], v[48:51], v[12:15], v[124:127]
    v_mfma_f32_16x16x32_bf16 v[128:131], v[36:39], v[16:19], v[128:131]
    v_mfma_f32_16x16x32_bf16 v[132:135], v[40:43], v[16:19], v[132:135]
    v_mfma_f32_16x16x32_bf16 v[136:139], v[44:47], v[16:19], v[136:139]
    v_mfma_f32_16x16x32_bf16 v[140:143], v[48:51], v[16:19], v[140:143]
    s_waitcnt vmcnt(8) lgkmcnt(0)
    s_barrier
    v_mfma_f32_16x16x32_bf16 v[144:147], v[36:39], v[20:23], v[144:147]
    v_add_u32 v74, s72, v72
    v_add_u32 v75, s72, v73
    v_mfma_f32_16x16x32_bf16 v[148:151], v[40:43], v[20:23], v[148:151]
    v_xor_b32 v76, 32, v75
    v_xor_b32 v77, 64, v75
    v_xor_b32 v78, 96, v75
    v_mfma_f32_16x16x32_bf16 v[152:155], v[44:47], v[20:23], v[152:155]
    s_add_u32 s72, s72, 32768
    s_and_b32 s72, s72, 0x1ffff
    v_mfma_f32_16x16x32_bf16 v[156:159], v[48:51], v[20:23], v[156:159]
    ds_read_b128 v[4:7], v74 offset:0
    v_mfma_f32_16x16x32_bf16 v[160:163], v[36:39], v[24:27], v[160:163]
    ds_read_b64_tr_b16 v[52:53], v75 offset:0
    v_mfma_f32_16x16x32_bf16 v[164:167], v[40:43], v[24:27], v[164:167]
    ds_read_b64_tr_b16 v[54:55], v75 offset:2048
    v_mfma_f32_16x16x32_bf16 v[168:171], v[44:47], v[24:27], v[168:171]
    ds_read_b64_tr_b16 v[56:57], v76 offset:0
    v_mfma_f32_16x16x32_bf16 v[172:175], v[48:51], v[24:27], v[172:175]
    ds_read_b64_tr_b16 v[58:59], v76 offset:2048
    v_mfma_f32_16x16x32_bf16 v[176:179], v[36:39], v[28:31], v[176:179]
    ds_read_b64_tr_b16 v[60:61], v77 offset:0
    v_mfma_f32_16x16x32_bf16 v[180:183], v[40:43], v[28:31], v[180:183]
    ds_read_b64_tr_b16 v[62:63], v77 offset:2048
    v_mfma_f32_16x16x32_bf16 v[184:187], v[44:47], v[28:31], v[184:187]
    ds_read_b64_tr_b16 v[64:65], v78 offset:0
    v_mfma_f32_16x16x32_bf16 v[188:191], v[48:51], v[28:31], v[188:191]
    ds_read_b64_tr_b16 v[66:67], v78 offset:2048
    v_mfma_f32_16x16x32_bf16 v[192:195], v[36:39], v[32:35], v[192:195]
    ds_read_b128 v[8:11], v74 offset:1024
    v_mfma_f32_16x16x32_bf16 v[196:199], v[40:43], v[32:35], v[196:199]
    ds_read_b128 v[12:15], v74 offset:2048
    v_mfma_f32_16x16x32_bf16 v[200:203], v[44:47], v[32:35], v[200:203]
    ds_read_b128 v[16:19], v74 offset:3072
    v_mfma_f32_16x16x32_bf16 v[204:207], v[48:51], v[32:35], v[204:207]
    s_waitcnt lgkmcnt(0)
    v_mfma_f32_16x16x32_bf16 v[80:83], v[52:55], v[4:7], v[80:83]
    ds_read_b128 v[20:23], v74 offset:4096
    v_mfma_f32_16x16x32_bf16 v[84:87], v[56:59], v[4:7], v[84:87]
    v_mfma_f32_16x16x32_bf16 v[88:91], v[60:63], v[4:7], v[88:91]
    ds_read_b128 v[24:27], v74 offset:5120
    v_mfma_f32_16x16x32_bf16 v[92:95], v[64:67], v[4:7], v[92:95]
    v_mfma_f32_16x16x32_bf16 v[96:99], v[52:55], v[8:11], v[96:99]
    ds_read_b128 v[28:31], v74 offset:6144
    v_mfma_f32_16x16x32_bf16 v[100:103], v[56:59], v[8:11], v[100:103]
    v_mfma_f32_16x16x32_bf16 v[104:107], v[60:63], v[8:11], v[104:107]
    ds_read_b128 v[32:35], v74 offset:7168
    v_mfma_f32_16x16x32_bf16 v[108:111], v[64:67], v[8:11], v[108:111]
    v_mfma_f32_16x16x32_bf16 v[112:115], v[52:55], v[12:15], v[112:115]
    v_mfma_f32_16x16x32_bf16 v[116:119], v[56:59], v[12:15], v[116:119]
    v_mfma_f32_16x16x32_bf16 v[120:123], v[60:63], v[12:15], v[120:123]
    v_mfma_f32_16x16x32_bf16 v[124:127], v[64:67], v[12:15], v[124:127]
    v_mfma_f32_16x16x32_bf16 v[128:131], v[52:55], v[16:19], v[128:131]
    v_mfma_f32_16x16x32_bf16 v[132:135], v[56:59], v[16:19], v[132:135]
    v_mfma_f32_16x16x32_bf16 v[136:139], v[60:63], v[16:19], v[136:139]
    v_mfma_f32_16x16x32_bf16 v[140:143], v[64:67], v[16:19], v[140:143]
    s_waitcnt vmcnt(4) lgkmcnt(0)
    s_barrier
    v_mfma_f32_16x16x32_bf16 v[144:147], v[52:55], v[20:23], v[144:147]
    v_add_u32 v74, s72, v72
    v_add_u32 v75, s72, v73
    v_mfma_f32_16x16x32_bf16 v[148:151], v[56:59], v[20:23], v[148:151]
    v_xor_b32 v76, 32, v75
    v_xor_b32 v77, 64, v75
    v_xor_b32 v78, 96, v75
    v_mfma_f32_16x16x32_bf16 v[152:155], v[60:63], v[20:23], v[152:155]
    s_add_u32 s72, s72, 32768
    s_and_b32 s72, s72, 0x1ffff
    v_mfma_f32_16x16x32_bf16 v[156:159], v[64:67], v[20:23], v[156:159]
    ds_read_b128 v[4:7], v74 offset:0
    v_mfma_f32_16x16x32_bf16 v[160:163], v[52:55], v[24:27], v[160:163]
    ds_read_b64_tr_b16 v[36:37], v75 offset:0
    v_mfma_f32_16x16x32_bf16 v[164:167], v[56:59], v[24:27], v[164:167]
    ds_read_b64_tr_b16 v[38:39], v75 offset:2048
    v_mfma_f32_16x16x32_bf16 v[168:171], v[60:63], v[24:27], v[168:171]
    ds_read_b64_tr_b16 v[40:41], v76 offset:0
    v_mfma_f32_16x16x32_bf16 v[172:175], v[64:67], v[24:27], v[172:175]
    ds_read_b64_tr_b16 v[42:43], v76 offset:2048
    v_mfma_f32_16x16x32_bf16 v[176:179], v[52:55], v[28:31], v[176:179]
    ds_read_b64_tr_b16 v[44:45], v77 offset:0
    v_mfma_f32_16x16x32_bf16 v[180:183], v[56:59], v[28:31], v[180:183]
    ds_read_b64_tr_b16 v[46:47], v77 offset:2048
    v_mfma_f32_16x16x32_bf16 v[184:187], v[60:63], v[28:31], v[184:187]
    ds_read_b64_tr_b16 v[48:49], v78 offset:0
    v_mfma_f32_16x16x32_bf16 v[188:191], v[64:67], v[28:31], v[188:191]
    ds_read_b64_tr_b16 v[50:51], v78 offset:2048
    v_mfma_f32_16x16x32_bf16 v[192:195], v[52:55], v[32:35], v[192:195]
    ds_read_b128 v[8:11], v74 offset:1024
    v_mfma_f32_16x16x32_bf16 v[196:199], v[56:59], v[32:35], v[196:199]
    ds_read_b128 v[12:15], v74 offset:2048
    v_mfma_f32_16x16x32_bf16 v[200:203], v[60:63], v[32:35], v[200:203]
    ds_read_b128 v[16:19], v74 offset:3072
    v_mfma_f32_16x16x32_bf16 v[204:207], v[64:67], v[32:35], v[204:207]
    s_waitcnt lgkmcnt(0)
    v_mfma_f32_16x16x32_bf16 v[80:83], v[36:39], v[4:7], v[80:83]
    ds_read_b128 v[20:23], v74 offset:4096
    v_mfma_f32_16x16x32_bf16 v[84:87], v[40:43], v[4:7], v[84:87]
    v_mfma_f32_16x16x32_bf16 v[88:91], v[44:47], v[4:7], v[88:91]
    ds_read_b128 v[24:27], v74 offset:5120
    v_mfma_f32_16x16x32_bf16 v[92:95], v[48:51], v[4:7], v[92:95]
    v_mfma_f32_16x16x32_bf16 v[96:99], v[36:39], v[8:11], v[96:99]
    ds_read_b128 v[28:31], v74 offset:6144
    v_mfma_f32_16x16x32_bf16 v[100:103], v[40:43], v[8:11], v[100:103]
    v_mfma_f32_16x16x32_bf16 v[104:107], v[44:47], v[8:11], v[104:107]
    ds_read_b128 v[32:35], v74 offset:7168
    v_mfma_f32_16x16x32_bf16 v[108:111], v[48:51], v[8:11], v[108:111]
    v_mfma_f32_16x16x32_bf16 v[112:115], v[36:39], v[12:15], v[112:115]
    v_mfma_f32_16x16x32_bf16 v[116:119], v[40:43], v[12:15], v[116:119]
    v_mfma_f32_16x16x32_bf16 v[120:123], v[44:47], v[12:15], v[120:123]
    v_mfma_f32_16x16x32_bf16 v[124:127], v[48:51], v[12:15], v[124:127]
    v_mfma_f32_16x16x32_bf16 v[128:131], v[36:39], v[16:19], v[128:131]
    v_mfma_f32_16x16x32_bf16 v[132:135], v[40:43], v[16:19], v[132:135]
    v_mfma_f32_16x16x32_bf16 v[136:139], v[44:47], v[16:19], v[136:139]
    v_mfma_f32_16x16x32_bf16 v[140:143], v[48:51], v[16:19], v[140:143]
    s_waitcnt vmcnt(0) lgkmcnt(0)
    s_barrier
    v_mfma_f32_16x16x32_bf16 v[144:147], v[36:39], v[20:23], v[144:147]
    v_add_u32 v74, s72, v72
    v_add_u32 v75, s72, v73
    v_mfma_f32_16x16x32_bf16 v[148:151], v[40:43], v[20:23], v[148:151]
    v_xor_b32 v76, 32, v75
    v_xor_b32 v77, 64, v75
    v_xor_b32 v78, 96, v75
    v_mfma_f32_16x16x32_bf16 v[152:155], v[44:47], v[20:23], v[152:155]
    s_add_u32 s72, s72, 32768
    s_and_b32 s72, s72, 0x1ffff
    v_mfma_f32_16x16x32_bf16 v[156:159], v[48:51], v[20:23], v[156:159]
    ds_read_b128 v[4:7], v74 offset:0
    v_mfma_f32_16x16x32_bf16 v[160:163], v[36:39], v[24:27], v[160:163]
    ds_read_b64_tr_b16 v[52:53], v75 offset:0
    v_mfma_f32_16x16x32_bf16 v[164:167], v[40:43], v[24:27], v[164:167]
    ds_read_b64_tr_b16 v[54:55], v75 offset:2048
    v_mfma_f32_16x16x32_bf16 v[168:171], v[44:47], v[24:27], v[168:171]
    ds_read_b64_tr_b16 v[56:57], v76 offset:0
    v_mfma_f32_16x16x32_bf16 v[172:175], v[48:51], v[24:27], v[172:175]
    ds_read_b64_tr_b16 v[58:59], v76 offset:2048
    v_mfma_f32_16x16x32_bf16 v[176:179], v[36:39], v[28:31], v[176:179]
    ds_read_b64_tr_b16 v[60:61], v77 offset:0
    v_mfma_f32_16x16x32_bf16 v[180:183], v[40:43], v[28:31], v[180:183]
    ds_read_b64_tr_b16 v[62:63], v77 offset:2048
    v_mfma_f32_16x16x32_bf16 v[184:187], v[44:47], v[28:31], v[184:187]
    ds_read_b64_tr_b16 v[64:65], v78 offset:0
    v_mfma_f32_16x16x32_bf16 v[188:191], v[48:51], v[28:31], v[188:191]
    ds_read_b64_tr_b16 v[66:67], v78 offset:2048
    v_mfma_f32_16x16x32_bf16 v[192:195], v[36:39], v[32:35], v[192:195]
    ds_read_b128 v[8:11], v74 offset:1024
    v_mfma_f32_16x16x32_bf16 v[196:199], v[40:43], v[32:35], v[196:199]
    ds_read_b128 v[12:15], v74 offset:2048
    v_mfma_f32_16x16x32_bf16 v[200:203], v[44:47], v[32:35], v[200:203]
    ds_read_b128 v[16:19], v74 offset:3072
    v_mfma_f32_16x16x32_bf16 v[204:207], v[48:51], v[32:35], v[204:207]
    s_waitcnt lgkmcnt(0)
    v_mfma_f32_16x16x32_bf16 v[80:83], v[52:55], v[4:7], v[80:83]
    ds_read_b128 v[20:23], v74 offset:4096
    v_mfma_f32_16x16x32_bf16 v[84:87], v[56:59], v[4:7], v[84:87]
    v_mfma_f32_16x16x32_bf16 v[88:91], v[60:63], v[4:7], v[88:91]
    ds_read_b128 v[24:27], v74 offset:5120
    v_mfma_f32_16x16x32_bf16 v[92:95], v[64:67], v[4:7], v[92:95]
    v_mfma_f32_16x16x32_bf16 v[96:99], v[52:55], v[8:11], v[96:99]
    ds_read_b128 v[28:31], v74 offset:6144
    v_mfma_f32_16x16x32_bf16 v[100:103], v[56:59], v[8:11], v[100:103]
    v_mfma_f32_16x16x32_bf16 v[104:107], v[60:63], v[8:11], v[104:107]
    ds_read_b128 v[32:35], v74 offset:7168
    v_mfma_f32_16x16x32_bf16 v[108:111], v[64:67], v[8:11], v[108:111]
    v_mfma_f32_16x16x32_bf16 v[112:115], v[52:55], v[12:15], v[112:115]
    v_mfma_f32_16x16x32_bf16 v[116:119], v[56:59], v[12:15], v[116:119]
    v_mfma_f32_16x16x32_bf16 v[120:123], v[60:63], v[12:15], v[120:123]
    v_mfma_f32_16x16x32_bf16 v[124:127], v[64:67], v[12:15], v[124:127]
    v_mfma_f32_16x16x32_bf16 v[128:131], v[52:55], v[16:19], v[128:131]
    v_mfma_f32_16x16x32_bf16 v[132:135], v[56:59], v[16:19], v[132:135]
    v_mfma_f32_16x16x32_bf16 v[136:139], v[60:63], v[16:19], v[136:139]
    v_mfma_f32_16x16x32_bf16 v[140:143], v[64:67], v[16:19], v[140:143]
    s_waitcnt lgkmcnt(0)
    v_mfma_f32_16x16x32_bf16 v[144:147], v[52:55], v[20:23], v[144:147]
    v_mfma_f32_16x16x32_bf16 v[148:151], v[56:59], v[20:23], v[148:151]
    v_mfma_f32_16x16x32_bf16 v[152:155], v[60:63], v[20:23], v[152:155]
    v_mfma_f32_16x16x32_bf16 v[156:159], v[64:67], v[20:23], v[156:159]
    v_mfma_f32_16x16x32_bf16 v[160:163], v[52:55], v[24:27], v[160:163]
    v_mfma_f32_16x16x32_bf16 v[164:167], v[56:59], v[24:27], v[164:167]
    v_mfma_f32_16x16x32_bf16 v[168:171], v[60:63], v[24:27], v[168:171]
    v_mfma_f32_16x16x32_bf16 v[172:175], v[64:67], v[24:27], v[172:175]
    v_mfma_f32_16x16x32_bf16 v[176:179], v[52:55], v[28:31], v[176:179]
    v_mfma_f32_16x16x32_bf16 v[180:183], v[56:59], v[28:31], v[180:183]
    v_mfma_f32_16x16x32_bf16 v[184:187], v[60:63], v[28:31], v[184:187]
    v_mfma_f32_16x16x32_bf16 v[188:191], v[64:67], v[28:31], v[188:191]
    v_mfma_f32_16x16x32_bf16 v[192:195], v[52:55], v[32:35], v[192:195]
    v_mfma_f32_16x16x32_bf16 v[196:199], v[56:59], v[32:35], v[196:199]
    v_mfma_f32_16x16x32_bf16 v[200:203], v[60:63], v[32:35], v[200:203]
    v_mfma_f32_16x16x32_bf16 v[204:207], v[64:67], v[32:35], v[204:207]
    v_cvt_pk_bf16_f32 v4, v80, v81
    v_cvt_pk_bf16_f32 v5, v82, v83
    v_cvt_pk_bf16_f32 v6, v84, v85
    v_cvt_pk_bf16_f32 v7, v86, v87
    buffer_store_dwordx4 v[4:7], v79, s[8:11], s81 offen offset:0 sc1
    v_cvt_pk_bf16_f32 v8, v96, v97
    v_cvt_pk_bf16_f32 v9, v98, v99
    v_cvt_pk_bf16_f32 v10, v100, v101
    v_cvt_pk_bf16_f32 v11, v102, v103
    buffer_store_dwordx4 v[8:11], v79, s[8:11], s81 offen offset:256 sc1
    v_cvt_pk_bf16_f32 v12, v88, v89
    v_cvt_pk_bf16_f32 v13, v90, v91
    v_cvt_pk_bf16_f32 v14, v92, v93
    v_cvt_pk_bf16_f32 v15, v94, v95
    buffer_store_dwordx4 v[12:15], v79, s[8:11], s81 offen offset:2048 sc1
    v_cvt_pk_bf16_f32 v16, v104, v105
    v_cvt_pk_bf16_f32 v17, v106, v107
    v_cvt_pk_bf16_f32 v18, v108, v109
    v_cvt_pk_bf16_f32 v19, v110, v111
    buffer_store_dwordx4 v[16:19], v79, s[8:11], s81 offen offset:2304 sc1
    s_add_u32 s81, s81, s82
    v_cvt_pk_bf16_f32 v20, v112, v113
    v_cvt_pk_bf16_f32 v21, v114, v115
    v_cvt_pk_bf16_f32 v22, v116, v117
    v_cvt_pk_bf16_f32 v23, v118, v119
    buffer_store_dwordx4 v[20:23], v79, s[8:11], s81 offen offset:0 sc1
    v_cvt_pk_bf16_f32 v24, v128, v129
    v_cvt_pk_bf16_f32 v25, v130, v131
    v_cvt_pk_bf16_f32 v26, v132, v133
    v_cvt_pk_bf16_f32 v27, v134, v135
    buffer_store_dwordx4 v[24:27], v79, s[8:11], s81 offen offset:256 sc1
    v_cvt_pk_bf16_f32 v28, v120, v121
    v_cvt_pk_bf16_f32 v29, v122, v123
    v_cvt_pk_bf16_f32 v30, v124, v125
    v_cvt_pk_bf16_f32 v31, v126, v127
    buffer_store_dwordx4 v[28:31], v79, s[8:11], s81 offen offset:2048 sc1
    v_cvt_pk_bf16_f32 v32, v136, v137
    v_cvt_pk_bf16_f32 v33, v138, v139
    v_cvt_pk_bf16_f32 v34, v140, v141
    v_cvt_pk_bf16_f32 v35, v142, v143
    buffer_store_dwordx4 v[32:35], v79, s[8:11], s81 offen offset:2304 sc1
    s_add_u32 s81, s81, s82
    v_cvt_pk_bf16_f32 v36, v144, v145
    v_cvt_pk_bf16_f32 v37, v146, v147
    v_cvt_pk_bf16_f32 v38, v148, v149
    v_cvt_pk_bf16_f32 v39, v150, v151
    buffer_store_dwordx4 v[36:39], v79, s[8:11], s81 offen offset:0 sc1
    v_cvt_pk_bf16_f32 v40, v160, v161
    v_cvt_pk_bf16_f32 v41, v162, v163
    v_cvt_pk_bf16_f32 v42, v164, v165
    v_cvt_pk_bf16_f32 v43, v166, v167
    buffer_store_dwordx4 v[40:43], v79, s[8:11], s81 offen offset:256 sc1
    v_cvt_pk_bf16_f32 v44, v152, v153
    v_cvt_pk_bf16_f32 v45, v154, v155
    v_cvt_pk_bf16_f32 v46, v156, v157
    v_cvt_pk_bf16_f32 v47, v158, v159
    buffer_store_dwordx4 v[44:47], v79, s[8:11], s81 offen offset:2048 sc1
    v_cvt_pk_bf16_f32 v48, v168, v169
    v_cvt_pk_bf16_f32 v49, v170, v171
    v_cvt_pk_bf16_f32 v50, v172, v173
    v_cvt_pk_bf16_f32 v51, v174, v175
    buffer_store_dwordx4 v[48:51], v79, s[8:11], s81 offen offset:2304 sc1
    s_add_u32 s81, s81, s82
    v_cvt_pk_bf16_f32 v52, v176, v177
    v_cvt_pk_bf16_f32 v53, v178, v179
    v_cvt_pk_bf16_f32 v54, v180, v181
    v_cvt_pk_bf16_f32 v55, v182, v183
    buffer_store_dwordx4 v[52:55], v79, s[8:11], s81 offen offset:0 sc1
    v_cvt_pk_bf16_f32 v56, v192, v193
    v_cvt_pk_bf16_f32 v57, v194, v195
    v_cvt_pk_bf16_f32 v58, v196, v197
    v_cvt_pk_bf16_f32 v59, v198, v199
    buffer_store_dwordx4 v[56:59], v79, s[8:11], s81 offen offset:256 sc1
    v_cvt_pk_bf16_f32 v60, v184, v185
    v_cvt_pk_bf16_f32 v61, v186, v187
    v_cvt_pk_bf16_f32 v62, v188, v189
    v_cvt_pk_bf16_f32 v63, v190, v191
    buffer_store_dwordx4 v[60:63], v79, s[8:11], s81 offen offset:2048 sc1
    v_cvt_pk_bf16_f32 v64, v200, v201
    v_cvt_pk_bf16_f32 v65, v202, v203
    v_cvt_pk_bf16_f32 v66, v204, v205
    v_cvt_pk_bf16_f32 v67, v206, v207
    buffer_store_dwordx4 v[64:67], v79, s[8:11], s81 offen offset:2304 sc1
    s_branch next_46
t256_45:
    s_mov_b32 s72, 0
    s_waitcnt vmcnt(12)
    s_barrier
    v_add_u32 v74, s72, v72
    v_add_u32 v75, s72, v73
    v_xor_b32 v76, 32, v75
    v_xor_b32 v77, 64, v75
    v_xor_b32 v78, 96, v75
    s_add_u32 s72, s72, 32768
    s_and_b32 s72, s72, 0x1ffff
    ds_read_b128 v[4:7], v74 offset:0
    ds_read_b128 v[8:11], v74 offset:1024
    ds_read_b128 v[12:15], v74 offset:2048
    ds_read_b128 v[16:19], v74 offset:3072
    ds_read_b64_tr_b16 v[36:37], v75 offset:0
    ds_read_b64_tr_b16 v[38:39], v75 offset:2048
    ds_read_b64_tr_b16 v[40:41], v76 offset:0
    ds_read_b64_tr_b16 v[42:43], v76 offset:2048
    ds_read_b64_tr_b16 v[44:45], v77 offset:0
    ds_read_b64_tr_b16 v[46:47], v77 offset:2048
    ds_read_b64_tr_b16 v[48:49], v78 offset:0
    ds_read_b64_tr_b16 v[50:51], v78 offset:2048
    s_waitcnt lgkmcnt(0)
    v_mfma_f32_16x16x32_bf16 v[80:83], v[4:7], v[36:39], 0
    ds_read_b128 v[20:23], v74 offset:4096
    v_mfma_f32_16x16x32_bf16 v[84:87], v[4:7], v[40:43], 0
    v_mfma_f32_16x16x32_bf16 v[88:91], v[4:7], v[44:47], 0
    ds_read_b128 v[24:27], v74 offset:5120
    v_mfma_f32_16x16x32_bf16 v[92:95], v[4:7], v[48:51], 0
    v_mfma_f32_16x16x32_bf16 v[96:99], v[8:11], v[36:39], 0
    ds_read_b128 v[28:31], v74 offset:6144
    v_mfma_f32_16x16x32_bf16 v[100:103], v[8:11], v[40:43], 0
    v_mfma_f32_16x16x32_bf16 v[104:107], v[8:11], v[44:47], 0
    ds_read_b128 v[32:35], v74 offset:7168
    v_mfma_f32_16x16x32_bf16 v[108:111], v[8:11], v[48:51], 0
    v_mfma_f32_16x16x32_bf16 v[112:115], v[12:15], v[36:39], 0
    v_mfma_f32_16x16x32_bf16 v[116:119], v[12:15], v[40:43], 0
    v_mfma_f32_16x16x32_bf16 v[120:123], v[12:15], v[44:47], 0
    v_mfma_f32_16x16x32_bf16 v[124:127], v[12:15], v[48:51], 0
    v_mfma_f32_16x16x32_bf16 v[128:131], v[16:19], v[36:39], 0
    v_mfma_f32_16x16x32_bf16 v[132:135], v[16:19], v[40:43], 0
    v_mfma_f32_16x16x32_bf16 v[136:139], v[16:19], v[44:47], 0
    v_mfma_f32_16x16x32_bf16 v[140:143], v[16:19], v[48:51], 0
    s_waitcnt vmcnt(8) lgkmcnt(0)
    s_barrier
    v_mfma_f32_16x16x32_bf16 v[144:147], v[20:23], v[36:39], 0
    v_add_u32 v74, s72, v72
    v_add_u32 v75, s72, v73
    v_xor_b32 v76, 32, v75
    v_xor_b32 v77, 64, v75
    v_xor_b32 v78, 96, v75
    v_mfma_f32_16x16x32_bf16 v[148:151], v[20:23], v[40:43], 0
    s_add_u32 s72, s72, 32768
    s_and_b32 s72, s72, 0x1ffff
    ds_read_b128 v[4:7], v74 offset:0
    v_mfma_f32_16x16x32_bf16 v[152:155], v[20:23], v[44:47], 0
    ds_read_b64_tr_b16 v[52:53], v75 offset:0
    v_mfma_f32_16x16x32_bf16 v[156:159], v[20:23], v[48:51], 0
    ds_read_b64_tr_b16 v[54:55], v75 offset:2048
    ds_read_b64_tr_b16 v[56:57], v76 offset:0
    v_mfma_f32_16x16x32_bf16 v[160:163], v[24:27], v[36:39], 0
    ds_read_b64_tr_b16 v[58:59], v76 offset:2048
    v_mfma_f32_16x16x32_bf16 v[164:167], v[24:27], v[40:43], 0
    ds_read_b64_tr_b16 v[60:61], v77 offset:0
    ds_read_b64_tr_b16 v[62:63], v77 offset:2048
    v_mfma_f32_16x16x32_bf16 v[168:171], v[24:27], v[44:47], 0
    ds_read_b64_tr_b16 v[64:65], v78 offset:0
    v_mfma_f32_16x16x32_bf16 v[172:175], v[24:27], v[48:51], 0
    ds_read_b64_tr_b16 v[66:67], v78 offset:2048
    ds_read_b128 v[8:11], v74 offset:1024
    v_mfma_f32_16x16x32_bf16 v[176:179], v[28:31], v[36:39], 0
    ds_read_b128 v[12:15], v74 offset:2048
    ds_read_b128 v[16:19], v74 offset:3072
    v_mfma_f32_16x16x32_bf16 v[180:183], v[28:31], v[40:43], 0
    s_mov_b32 m0, s71
    v_mfma_f32_16x16x32_bf16 v[184:187], v[28:31], v[44:47], 0
    buffer_load_dwordx4 v68, s[60:63], s68 offen lds
    s_add_u32 m0, s71, 1024
    v_mfma_f32_16x16x32_bf16 v[188:191], v[28:31], v[48:51], 0
    buffer_load_dwordx4 v69, s[60:63], s68 offen lds
    v_mfma_f32_16x16x32_bf16 v[192:195], v[32:35], v[36:39], 0
    s_add_u32 m0, s71, 16384
    s_nop 0
    buffer_load_dwordx4 v70, s[64:67], s69 offen lds
    v_mfma_f32_16x16x32_bf16 v[196:199], v[32:35], v[40:43], 0
    s_add_u32 m0, s71, 17408
    v_mfma_f32_16x16x32_bf16 v[200:203], v[32:35], v[44:47], 0
    buffer_load_dwordx4 v71, s[64:67], s69 offen lds
    s_add_u32 s68, s68, 64
    s_add_u32 s69, s69, s70
    v_mfma_f32_16x16x32_bf16 v[204:207], v[32:35], v[48:51], 0
    s_add_u32 s71, s71, 32768
    s_and_b32 s71, s71, 0x1ffff
    s_waitcnt lgkmcnt(0)
    v_mfma_f32_16x16x32_bf16 v[80:83], v[4:7], v[52:55], v[80:83]
    ds_read_b128 v[20:23], v74 offset:4096
    v_mfma_f32_16x16x32_bf16 v[84:87], v[4:7], v[56:59], v[84:87]
    v_mfma_f32_16x16x32_bf16 v[88:91], v[4:7], v[60:63], v[88:91]
    ds_read_b128 v[24:27], v74 offset:5120
    v_mfma_f32_16x16x32_bf16 v[92:95], v[4:7], v[64:67], v[92:95]
    v_mfma_f32_16x16x32_bf16 v[96:99], v[8:11], v[52:55], v[96:99]
    ds_read_b128 v[28:31], v74 offset:6144
    v_mfma_f32_16x16x32_bf16 v[100:103], v[8:11], v[56:59], v[100:103]
    v_mfma_f32_16x16x32_bf16 v[104:107], v[8:11], v[60:63], v[104:107]
    ds_read_b128 v[32:35], v74 offset:7168
    v_mfma_f32_16x16x32_bf16 v[108:111], v[8:11], v[64:67], v[108:111]
    v_mfma_f32_16x16x32_bf16 v[112:115], v[12:15], v[52:55], v[112:115]
    v_mfma_f32_16x16x32_bf16 v[116:119], v[12:15], v[56:59], v[116:119]
    v_mfma_f32_16x16x32_bf16 v[120:123], v[12:15], v[60:63], v[120:123]
    v_mfma_f32_16x16x32_bf16 v[124:127], v[12:15], v[64:67], v[124:127]
    v_mfma_f32_16x16x32_bf16 v[128:131], v[16:19], v[52:55], v[128:131]
    v_mfma_f32_16x16x32_bf16 v[132:135], v[16:19], v[56:59], v[132:135]
    v_mfma_f32_16x16x32_bf16 v[136:139], v[16:19], v[60:63], v[136:139]
    v_mfma_f32_16x16x32_bf16 v[140:143], v[16:19], v[64:67], v[140:143]
    s_waitcnt vmcnt(8) lgkmcnt(0)
    s_barrier
    v_mfma_f32_16x16x32_bf16 v[144:147], v[20:23], v[52:55], v[144:147]
    v_add_u32 v74, s72, v72
    v_add_u32 v75, s72, v73
    v_xor_b32 v76, 32, v75
    v_xor_b32 v77, 64, v75
    v_xor_b32 v78, 96, v75
    v_mfma_f32_16x16x32_bf16 v[148:151], v[20:23], v[56:59], v[148:151]
    s_add_u32 s72, s72, 32768
    s_and_b32 s72, s72, 0x1ffff
    ds_read_b128 v[4:7], v74 offset:0
    v_mfma_f32_16x16x32_bf16 v[152:155], v[20:23], v[60:63], v[152:155]
    ds_read_b64_tr_b16 v[36:37], v75 offset:0
    v_mfma_f32_16x16x32_bf16 v[156:159], v[20:23], v[64:67], v[156:159]
    ds_read_b64_tr_b16 v[38:39], v75 offset:2048
    ds_read_b64_tr_b16 v[40:41], v76 offset:0
    v_mfma_f32_16x16x32_bf16 v[160:163], v[24:27], v[52:55], v[160:163]
    ds_read_b64_tr_b16 v[42:43], v76 offset:2048
    v_mfma_f32_16x16x32_bf16 v[164:167], v[24:27], v[56:59], v[164:167]
    ds_read_b64_tr_b16 v[44:45], v77 offset:0
    ds_read_b64_tr_b16 v[46:47], v77 offset:2048
    v_mfma_f32_16x16x32_bf16 v[168:171], v[24:27], v[60:63], v[168:171]
    ds_read_b64_tr_b16 v[48:49], v78 offset:0
    v_mfma_f32_16x16x32_bf16 v[172:175], v[24:27], v[64:67], v[172:175]
    ds_read_b64_tr_b16 v[50:51], v78 offset:2048
    ds_read_b128 v[8:11], v74 offset:1024
    v_mfma_f32_16x16x32_bf16 v[176:179], v[28:31], v[52:55], v[176:179]
    ds_read_b128 v[12:15], v74 offset:2048
    ds_read_b128 v[16:19], v74 offset:3072
    v_mfma_f32_16x16x32_bf16 v[180:183], v[28:31], v[56:59], v[180:183]
    s_mov_b32 m0, s71
    v_mfma_f32_16x16x32_bf16 v[184:187], v[28:31], v[60:63], v[184:187]
    buffer_load_dwordx4 v68, s[60:63], s68 offen lds
    s_add_u32 m0, s71, 1024
    v_mfma_f32_16x16x32_bf16 v[188:191], v[28:31], v[64:67], v[188:191]
    buffer_load_dwordx4 v69, s[60:63], s68 offen lds
    v_mfma_f32_16x16x32_bf16 v[192:195], v[32:35], v[52:55], v[192:195]
    s_add_u32 m0, s71, 16384
    s_nop 0
    buffer_load_dwordx4 v70, s[64:67], s69 offen lds
    v_mfma_f32_16x16x32_bf16 v[196:199], v[32:35], v[56:59], v[196:199]
    s_add_u32 m0, s71, 17408
    v_mfma_f32_16x16x32_bf16 v[200:203], v[32:35], v[60:63], v[200:203]
    buffer_load_dwordx4 v71, s[64:67], s69 offen lds
    s_add_u32 s68, s68, 64
    s_add_u32 s69, s69, s70
    v_mfma_f32_16x16x32_bf16 v[204:207], v[32:35], v[64:67], v[204:207]
    s_add_u32 s71, s71, 32768
    s_and_b32 s71, s71, 0x1ffff
    s_mov_b32 s73, 13
gl_66:
    s_waitcnt lgkmcnt(0)
    v_mfma_f32_16x16x32_bf16 v[80:83], v[4:7], v[36:39], v[80:83]
    ds_read_b128 v[20:23], v74 offset:4096
    v_mfma_f32_16x16x32_bf16 v[84:87], v[4:7], v[40:43], v[84:87]
    v_mfma_f32_16x16x32_bf16 v[88:91], v[4:7], v[44:47], v[88:91]
    ds_read_b128 v[24:27], v74 offset:5120
    v_mfma_f32_16x16x32_bf16 v[92:95], v[4:7], v[48:51], v[92:95]
    v_mfma_f32_16x16x32_bf16 v[96:99], v[8:11], v[36:39], v[96:99]
    ds_read_b128 v[28:31], v74 offset:6144
    v_mfma_f32_16x16x32_bf16 v[100:103], v[8:11], v[40:43], v[100:103]
    v_mfma_f32_16x16x32_bf16 v[104:107], v[8:11], v[44:47], v[104:107]
    ds_read_b128 v[32:35], v74 offset:7168
    v_mfma_f32_16x16x32_bf16 v[108:111], v[8:11], v[48:51], v[108:111]
    v_mfma_f32_16x16x32_bf16 v[112:115], v[12:15], v[36:39], v[112:115]
    v_mfma_f32_16x16x32_bf16 v[116:119], v[12:15], v[40:43], v[116:119]
    v_mfma_f32_16x16x32_bf16 v[120:123], v[12:15], v[44:47], v[120:123]
    v_mfma_f32_16x16x32_bf16 v[124:127], v[12:15], v[48:51], v[124:127]
    v_mfma_f32_16x16x32_bf16 v[128:131], v[16:19], v[36:39], v[128:131]
    v_mfma_f32_16x16x32_bf16 v[132:135], v[16:19], v[40:43], v[132:135]
    v_mfma_f32_16x16x32_bf16 v[136:139], v[16:19], v[44:47], v[136:139]
    v_mfma_f32_16x16x32_bf16 v[140:143], v[16:19], v[48:51], v[140:143]
    s_waitcnt vmcnt(8) lgkmcnt(0)
    s_barrier
    v_mfma_f32_16x16x32_bf16 v[144:147], v[20:23], v[36:39], v[144:147]
    v_add_u32 v74, s72, v72
    v_add_u32 v75, s72, v73
    v_xor_b32 v76, 32, v75
    v_xor_b32 v77, 64, v75
    v_xor_b32 v78, 96, v75
    v_mfma_f32_16x16x32_bf16 v[148:151], v[20:23], v[40:43], v[148:151]
    s_add_u32 s72, s72, 32768
    s_and_b32 s72, s72, 0x1ffff
    ds_read_b128 v[4:7], v74 offset:0
    v_mfma_f32_16x16x32_bf16 v[152:155], v[20:23], v[44:47], v[152:155]
    ds_read_b64_tr_b16 v[52:53], v75 offset:0
    v_mfma_f32_16x16x32_bf16 v[156:159], v[20:23], v[48:51], v[156:159]
    ds_read_b64_tr_b16 v[54:55], v75 offset:2048
    ds_read_b64_tr_b16 v[56:57], v76 offset:0
    v_mfma_f32_16x16x32_bf16 v[160:163], v[24:27], v[36:39], v[160:163]
    ds_read_b64_tr_b16 v[58:59], v76 offset:2048
    v_mfma_f32_16x16x32_bf16 v[164:167], v[24:27], v[40:43], v[164:167]
    ds_read_b64_tr_b16 v[60:61], v77 offset:0
    ds_read_b64_tr_b16 v[62:63], v77 offset:2048
    v_mfma_f32_16x16x32_bf16 v[168:171], v[24:27], v[44:47], v[168:171]
    ds_read_b64_tr_b16 v[64:65], v78 offset:0
    v_mfma_f32_16x16x32_bf16 v[172:175], v[24:27], v[48:51], v[172:175]
    ds_read_b64_tr_b16 v[66:67], v78 offset:2048
    ds_read_b128 v[8:11], v74 offset:1024
    v_mfma_f32_16x16x32_bf16 v[176:179], v[28:31], v[36:39], v[176:179]
    ds_read_b128 v[12:15], v74 offset:2048
    ds_read_b128 v[16:19], v74 offset:3072
    v_mfma_f32_16x16x32_bf16 v[180:183], v[28:31], v[40:43], v[180:183]
    s_mov_b32 m0, s71
    v_mfma_f32_16x16x32_bf16 v[184:187], v[28:31], v[44:47], v[184:187]
    buffer_load_dwordx4 v68, s[60:63], s68 offen lds
    s_add_u32 m0, s71, 1024
    v_mfma_f32_16x16x32_bf16 v[188:191], v[28:31], v[48:51], v[188:191]
    buffer_load_dwordx4 v69, s[60:63], s68 offen lds
    v_mfma_f32_16x16x32_bf16 v[192:195], v[32:35], v[36:39], v[192:195]
    s_add_u32 m0, s71, 16384
    s_nop 0
    buffer_load_dwordx4 v70, s[64:67], s69 offen lds
    v_mfma_f32_16x16x32_bf16 v[196:199], v[32:35], v[40:43], v[196:199]
    s_add_u32 m0, s71, 17408
    v_mfma_f32_16x16x32_bf16 v[200:203], v[32:35], v[44:47], v[200:203]
    buffer_load_dwordx4 v71, s[64:67], s69 offen lds
    s_add_u32 s68, s68, 64
    s_add_u32 s69, s69, s70
    v_mfma_f32_16x16x32_bf16 v[204:207], v[32:35], v[48:51], v[204:207]
    s_add_u32 s71, s71, 32768
    s_and_b32 s71, s71, 0x1ffff
    s_waitcnt lgkmcnt(0)
    v_mfma_f32_16x16x32_bf16 v[80:83], v[4:7], v[52:55], v[80:83]
    ds_read_b128 v[20:23], v74 offset:4096
    v_mfma_f32_16x16x32_bf16 v[84:87], v[4:7], v[56:59], v[84:87]
    v_mfma_f32_16x16x32_bf16 v[88:91], v[4:7], v[60:63], v[88:91]
    ds_read_b128 v[24:27], v74 offset:5120
    v_mfma_f32_16x16x32_bf16 v[92:95], v[4:7], v[64:67], v[92:95]
    v_mfma_f32_16x16x32_bf16 v[96:99], v[8:11], v[52:55], v[96:99]
    ds_read_b128 v[28:31], v74 offset:6144
    v_mfma_f32_16x16x32_bf16 v[100:103], v[8:11], v[56:59], v[100:103]
    v_mfma_f32_16x16x32_bf16 v[104:107], v[8:11], v[60:63], v[104:107]
    ds_read_b128 v[32:35], v74 offset:7168
    v_mfma_f32_16x16x32_bf16 v[108:111], v[8:11], v[64:67], v[108:111]
    v_mfma_f32_16x16x32_bf16 v[112:115], v[12:15], v[52:55], v[112:115]
    v_mfma_f32_16x16x32_bf16 v[116:119], v[12:15], v[56:59], v[116:119]
    v_mfma_f32_16x16x32_bf16 v[120:123], v[12:15], v[60:63], v[120:123]
    v_mfma_f32_16x16x32_bf16 v[124:127], v[12:15], v[64:67], v[124:127]
    v_mfma_f32_16x16x32_bf16 v[128:131], v[16:19], v[52:55], v[128:131]
    v_mfma_f32_16x16x32_bf16 v[132:135], v[16:19], v[56:59], v[132:135]
    v_mfma_f32_16x16x32_bf16 v[136:139], v[16:19], v[60:63], v[136:139]
    v_mfma_f32_16x16x32_bf16 v[140:143], v[16:19], v[64:67], v[140:143]
    s_waitcnt vmcnt(8) lgkmcnt(0)
    s_barrier
    v_mfma_f32_16x16x32_bf16 v[144:147], v[20:23], v[52:55], v[144:147]
    v_add_u32 v74, s72, v72
    v_add_u32 v75, s72, v73
    v_xor_b32 v76, 32, v75
    v_xor_b32 v77, 64, v75
    v_xor_b32 v78, 96, v75
    v_mfma_f32_16x16x32_bf16 v[148:151], v[20:23], v[56:59], v[148:151]
    s_add_u32 s72, s72, 32768
    s_and_b32 s72, s72, 0x1ffff
    ds_read_b128 v[4:7], v74 offset:0
    v_mfma_f32_16x16x32_bf16 v[152:155], v[20:23], v[60:63], v[152:155]
    ds_read_b64_tr_b16 v[36:37], v75 offset:0
    v_mfma_f32_16x16x32_bf16 v[156:159], v[20:23], v[64:67], v[156:159]
    ds_read_b64_tr_b16 v[38:39], v75 offset:2048
    ds_read_b64_tr_b16 v[40:41], v76 offset:0
    v_mfma_f32_16x16x32_bf16 v[160:163], v[24:27], v[52:55], v[160:163]
    ds_read_b64_tr_b16 v[42:43], v76 offset:2048
    v_mfma_f32_16x16x32_bf16 v[164:167], v[24:27], v[56:59], v[164:167]
    ds_read_b64_tr_b16 v[44:45], v77 offset:0
    ds_read_b64_tr_b16 v[46:47], v77 offset:2048
    v_mfma_f32_16x16x32_bf16 v[168:171], v[24:27], v[60:63], v[168:171]
    ds_read_b64_tr_b16 v[48:49], v78 offset:0
    v_mfma_f32_16x16x32_bf16 v[172:175], v[24:27], v[64:67], v[172:175]
    ds_read_b64_tr_b16 v[50:51], v78 offset:2048
    ds_read_b128 v[8:11], v74 offset:1024
    v_mfma_f32_16x16x32_bf16 v[176:179], v[28:31], v[52:55], v[176:179]
    ds_read_b128 v[12:15], v74 offset:2048
    ds_read_b128 v[16:19], v74 offset:3072
    v_mfma_f32_16x16x32_bf16 v[180:183], v[28:31], v[56:59], v[180:183]
    s_mov_b32 m0, s71
    v_mfma_f32_16x16x32_bf16 v[184:187], v[28:31], v[60:63], v[184:187]
    buffer_load_dwordx4 v68, s[60:63], s68 offen lds
    s_add_u32 m0, s71, 1024
    v_mfma_f32_16x16x32_bf16 v[188:191], v[28:31], v[64:67], v[188:191]
    buffer_load_dwordx4 v69, s[60:63], s68 offen lds
    v_mfma_f32_16x16x32_bf16 v[192:195], v[32:35], v[52:55], v[192:195]
    s_add_u32 m0, s71, 16384
    s_nop 0
    buffer_load_dwordx4 v70, s[64:67], s69 offen lds
    v_mfma_f32_16x16x32_bf16 v[196:199], v[32:35], v[56:59], v[196:199]
    s_add_u32 m0, s71, 17408
    v_mfma_f32_16x16x32_bf16 v[200:203], v[32:35], v[60:63], v[200:203]
    buffer_load_dwordx4 v71, s[64:67], s69 offen lds
    s_add_u32 s68, s68, 64
    s_add_u32 s69, s69, s70
    v_mfma_f32_16x16x32_bf16 v[204:207], v[32:35], v[64:67], v[204:207]
    s_add_u32 s71, s71, 32768
    s_and_b32 s71, s71, 0x1ffff
    s_sub_u32 s73, s73, 1
    s_cmp_lg_u32 s73, 0
    s_cbranch_scc1 gl_66
    s_waitcnt lgkmcnt(0)
    v_mfma_f32_16x16x32_bf16 v[80:83], v[4:7], v[36:39], v[80:83]
    ds_read_b128 v[20:23], v74 offset:4096
    v_mfma_f32_16x16x32_bf16 v[84:87], v[4:7], v[40:43], v[84:87]
    v_mfma_f32_16x16x32_bf16 v[88:91], v[4:7], v[44:47], v[88:91]
    ds_read_b128 v[24:27], v74 offset:5120
    v_mfma_f32_16x16x32_bf16 v[92:95], v[4:7], v[48:51], v[92:95]
    v_mfma_f32_16x16x32_bf16 v[96:99], v[8:11], v[36:39], v[96:99]
    ds_read_b128 v[28:31], v74 offset:6144
    v_mfma_f32_16x16x32_bf16 v[100:103], v[8:11], v[40:43], v[100:103]
    v_mfma_f32_16x16x32_bf16 v[104:107], v[8:11], v[44:47], v[104:107]
    ds_read_b128 v[32:35], v74 offset:7168
    v_mfma_f32_16x16x32_bf16 v[108:111], v[8:11], v[48:51], v[108:111]
    v_mfma_f32_16x16x32_bf16 v[112:115], v[12:15], v[36:39], v[112:115]
    v_mfma_f32_16x16x32_bf16 v[116:119], v[12:15], v[40:43], v[116:119]
    v_mfma_f32_16x16x32_bf16 v[120:123], v[12:15], v[44:47], v[120:123]
    v_mfma_f32_16x16x32_bf16 v[124:127], v[12:15], v[48:51], v[124:127]
    v_mfma_f32_16x16x32_bf16 v[128:131], v[16:19], v[36:39], v[128:131]
    v_mfma_f32_16x16x32_bf16 v[132:135], v[16:19], v[40:43], v[132:135]
    v_mfma_f32_16x16x32_bf16 v[136:139], v[16:19], v[44:47], v[136:139]
    v_mfma_f32_16x16x32_bf16 v[140:143], v[16:19], v[48:51], v[140:143]
    s_waitcnt vmcnt(8) lgkmcnt(0)
    s_barrier
    v_mfma_f32_16x16x32_bf16 v[144:147], v[20:23], v[36:39], v[144:147]
    v_add_u32 v74, s72, v72
    v_add_u32 v75, s72, v73
    v_mfma_f32_16x16x32_bf16 v[148:151], v[20:23], v[40:43], v[148:151]
    v_xor_b32 v76, 32, v75
    v_xor_b32 v77, 64, v75
    v_xor_b32 v78, 96, v75
    v_mfma_f32_16x16x32_bf16 v[152:155], v[20:23], v[44:47], v[152:155]
    s_add_u32 s72, s72, 32768
    s_and_b32 s72, s72, 0x1ffff
    v_mfma_f32_16x16x32_bf16 v[156:159], v[20:23], v[48:51], v[156:159]
    ds_read_b128 v[4:7], v74 offset:0
    v_mfma_f32_16x16x32_bf16 v[160:163], v[24:27], v[36:39], v[160:163]
    ds_read_b64_tr_b16 v[52:53], v75 offset:0
    v_mfma_f32_16x16x32_bf16 v[164:167], v[24:27], v[40:43], v[164:167]
    ds_read_b64_tr_b16 v[54:55], v75 offset:2048
    v_mfma_f32_16x16x32_bf16 v[168:171], v[24:27], v[44:47], v[168:171]
    ds_read_b64_tr_b16 v[56:57], v76 offset:0
    v_mfma_f32_16x16x32_bf16 v[172:175], v[24:27], v[48:51], v[172:175]
    ds_read_b64_tr_b16 v[58:59], v76 offset:2048
    v_mfma_f32_16x16x32_bf16 v[176:179], v[28:31], v[36:39], v[176:179]
    ds_read_b64_tr_b16 v[60:61], v77 offset:0
    v_mfma_f32_16x16x32_bf16 v[180:183], v[28:31], v[40:43], v[180:183]
    ds_read_b64_tr_b16 v[62:63], v77 offset:2048
    v_mfma_f32_16x16x32_bf16 v[184:187], v[28:31], v[44:47], v[184:187]
    ds_read_b64_tr_b16 v[64:65], v78 offset:0
    v_mfma_f32_16x16x32_bf16 v[188:191], v[28:31], v[48:51], v[188:191]
    ds_read_b64_tr_b16 v[66:67], v78 offset:2048
    v_mfma_f32_16x16x32_bf16 v[192:195], v[32:35], v[36:39], v[192:195]
    ds_read_b128 v[8:11], v74 offset:1024
    v_mfma_f32_16x16x32_bf16 v[196:199], v[32:35], v[40:43], v[196:199]
    ds_read_b128 v[12:15], v74 offset:2048
    v_mfma_f32_16x16x32_bf16 v[200:203], v[32:35], v[44:47], v[200:203]
    ds_read_b128 v[16:19], v74 offset:3072
    v_mfma_f32_16x16x32_bf16 v[204:207], v[32:35], v[48:51], v[204:207]
    s_waitcnt lgkmcnt(0)
    v_mfma_f32_16x16x32_bf16 v[80:83], v[4:7], v[52:55], v[80:83]
    ds_read_b128 v[20:23], v74 offset:4096
    v_mfma_f32_16x16x32_bf16 v[84:87], v[4:7], v[56:59], v[84:87]
    v_mfma_f32_16x16x32_bf16 v[88:91], v[4:7], v[60:63], v[88:91]
    ds_read_b128 v[24:27], v74 offset:5120
    v_mfma_f32_16x16x32_bf16 v[92:95], v[4:7], v[64:67], v[92:95]
    v_mfma_f32_16x16x32_bf16 v[96:99], v[8:11], v[52:55], v[96:99]
    ds_read_b128 v[28:31], v74 offset:6144
    v_mfma_f32_16x16x32_bf16 v[100:103], v[8:11], v[56:59], v[100:103]
    v_mfma_f32_16x16x32_bf16 v[104:107], v[8:11], v[60:63], v[104:107]
    ds_read_b128 v[32:35], v74 offset:7168
    v_mfma_f32_16x16x32_bf16 v[108:111], v[8:11], v[64:67], v[108:111]
    v_mfma_f32_16x16x32_bf16 v[112:115], v[12:15], v[52:55], v[112:115]
    v_mfma_f32_16x16x32_bf16 v[116:119], v[12:15], v[56:59], v[116:119]
    v_mfma_f32_16x16x32_bf16 v[120:123], v[12:15], v[60:63], v[120:123]
    v_mfma_f32_16x16x32_bf16 v[124:127], v[12:15], v[64:67], v[124:127]
    v_mfma_f32_16x16x32_bf16 v[128:131], v[16:19], v[52:55], v[128:131]
    v_mfma_f32_16x16x32_bf16 v[132:135], v[16:19], v[56:59], v[132:135]
    v_mfma_f32_16x16x32_bf16 v[136:139], v[16:19], v[60:63], v[136:139]
    v_mfma_f32_16x16x32_bf16 v[140:143], v[16:19], v[64:67], v[140:143]
    s_waitcnt vmcnt(4) lgkmcnt(0)
    s_barrier
    v_mfma_f32_16x16x32_bf16 v[144:147], v[20:23], v[52:55], v[144:147]
    v_add_u32 v74, s72, v72
    v_add_u32 v75, s72, v73
    v_mfma_f32_16x16x32_bf16 v[148:151], v[20:23], v[56:59], v[148:151]
    v_xor_b32 v76, 32, v75
    v_xor_b32 v77, 64, v75
    v_xor_b32 v78, 96, v75
    v_mfma_f32_16x16x32_bf16 v[152:155], v[20:23], v[60:63], v[152:155]
    s_add_u32 s72, s72, 32768
    s_and_b32 s72, s72, 0x1ffff
    v_mfma_f32_16x16x32_bf16 v[156:159], v[20:23], v[64:67], v[156:159]
    ds_read_b128 v[4:7], v74 offset:0
    v_mfma_f32_16x16x32_bf16 v[160:163], v[24:27], v[52:55], v[160:163]
    ds_read_b64_tr_b16 v[36:37], v75 offset:0
    v_mfma_f32_16x16x32_bf16 v[164:167], v[24:27], v[56:59], v[164:167]
    ds_read_b64_tr_b16 v[38:39], v75 offset:2048
    v_mfma_f32_16x16x32_bf16 v[168:171], v[24:27], v[60:63], v[168:171]
    ds_read_b64_tr_b16 v[40:41], v76 offset:0
    v_mfma_f32_16x16x32_bf16 v[172:175], v[24:27], v[64:67], v[172:175]
    ds_read_b64_tr_b16 v[42:43], v76 offset:2048
    v_mfma_f32_16x16x32_bf16 v[176:179], v[28:31], v[52:55], v[176:179]
    ds_read_b64_tr_b16 v[44:45], v77 offset:0
    v_mfma_f32_16x16x32_bf16 v[180:183], v[28:31], v[56:59], v[180:183]
    ds_read_b64_tr_b16 v[46:47], v77 offset:2048
    v_mfma_f32_16x16x32_bf16 v[184:187], v[28:31], v[60:63], v[184:187]
    ds_read_b64_tr_b16 v[48:49], v78 offset:0
    v_mfma_f32_16x16x32_bf16 v[188:191], v[28:31], v[64:67], v[188:191]
    ds_read_b64_tr_b16 v[50:51], v78 offset:2048
    v_mfma_f32_16x16x32_bf16 v[192:195], v[32:35], v[52:55], v[192:195]
    ds_read_b128 v[8:11], v74 offset:1024
    v_mfma_f32_16x16x32_bf16 v[196:199], v[32:35], v[56:59], v[196:199]
    ds_read_b128 v[12:15], v74 offset:2048
    v_mfma_f32_16x16x32_bf16 v[200:203], v[32:35], v[60:63], v[200:203]
    ds_read_b128 v[16:19], v74 offset:3072
    v_mfma_f32_16x16x32_bf16 v[204:207], v[32:35], v[64:67], v[204:207]
    s_waitcnt lgkmcnt(0)
    v_mfma_f32_16x16x32_bf16 v[80:83], v[4:7], v[36:39], v[80:83]
    ds_read_b128 v[20:23], v74 offset:4096
    v_mfma_f32_16x16x32_bf16 v[84:87], v[4:7], v[40:43], v[84:87]
    v_mfma_f32_16x16x32_bf16 v[88:91], v[4:7], v[44:47], v[88:91]
    ds_read_b128 v[24:27], v74 offset:5120
    v_mfma_f32_16x16x32_bf16 v[92:95], v[4:7], v[48:51], v[92:95]
    v_mfma_f32_16x16x32_bf16 v[96:99], v[8:11], v[36:39], v[96:99]
    ds_read_b128 v[28:31], v74 offset:6144
    v_mfma_f32_16x16x32_bf16 v[100:103], v[8:11], v[40:43], v[100:103]
    v_mfma_f32_16x16x32_bf16 v[104:107], v[8:11], v[44:47], v[104:107]
    ds_read_b128 v[32:35], v74 offset:7168
    v_mfma_f32_16x16x32_bf16 v[108:111], v[8:11], v[48:51], v[108:111]
    v_mfma_f32_16x16x32_bf16 v[112:115], v[12:15], v[36:39], v[112:115]
    v_mfma_f32_16x16x32_bf16 v[116:119], v[12:15], v[40:43], v[116:119]
    v_mfma_f32_16x16x32_bf16 v[120:123], v[12:15], v[44:47], v[120:123]
    v_mfma_f32_16x16x32_bf16 v[124:127], v[12:15], v[48:51], v[124:127]
    v_mfma_f32_16x16x32_bf16 v[128:131], v[16:19], v[36:39], v[128:131]
    v_mfma_f32_16x16x32_bf16 v[132:135], v[16:19], v[40:43], v[132:135]
    v_mfma_f32_16x16x32_bf16 v[136:139], v[16:19], v[44:47], v[136:139]
    v_mfma_f32_16x16x32_bf16 v[140:143], v[16:19], v[48:51], v[140:143]
    s_waitcnt vmcnt(0) lgkmcnt(0)
    s_barrier
    v_mfma_f32_16x16x32_bf16 v[144:147], v[20:23], v[36:39], v[144:147]
    v_add_u32 v74, s72, v72
    v_add_u32 v75, s72, v73
    v_mfma_f32_16x16x32_bf16 v[148:151], v[20:23], v[40:43], v[148:151]
    v_xor_b32 v76, 32, v75
    v_xor_b32 v77, 64, v75
    v_xor_b32 v78, 96, v75
    v_mfma_f32_16x16x32_bf16 v[152:155], v[20:23], v[44:47], v[152:155]
    s_add_u32 s72, s72, 32768
    s_and_b32 s72, s72, 0x1ffff
    v_mfma_f32_16x16x32_bf16 v[156:159], v[20:23], v[48:51], v[156:159]
    ds_read_b128 v[4:7], v74 offset:0
    v_mfma_f32_16x16x32_bf16 v[160:163], v[24:27], v[36:39], v[160:163]
    ds_read_b64_tr_b16 v[52:53], v75 offset:0
    v_mfma_f32_16x16x32_bf16 v[164:167], v[24:27], v[40:43], v[164:167]
    ds_read_b64_tr_b16 v[54:55], v75 offset:2048
    v_mfma_f32_16x16x32_bf16 v[168:171], v[24:27], v[44:47], v[168:171]
    ds_read_b64_tr_b16 v[56:57], v76 offset:0
    v_mfma_f32_16x16x32_bf16 v[172:175], v[24:27], v[48:51], v[172:175]
    ds_read_b64_tr_b16 v[58:59], v76 offset:2048
    v_mfma_f32_16x16x32_bf16 v[176:179], v[28:31], v[36:39], v[176:179]
    ds_read_b64_tr_b16 v[60:61], v77 offset:0
    v_mfma_f32_16x16x32_bf16 v[180:183], v[28:31], v[40:43], v[180:183]
    ds_read_b64_tr_b16 v[62:63], v77 offset:2048
    v_mfma_f32_16x16x32_bf16 v[184:187], v[28:31], v[44:47], v[184:187]
    ds_read_b64_tr_b16 v[64:65], v78 offset:0
    v_mfma_f32_16x16x32_bf16 v[188:191], v[28:31], v[48:51], v[188:191]
    ds_read_b64_tr_b16 v[66:67], v78 offset:2048
    v_mfma_f32_16x16x32_bf16 v[192:195], v[32:35], v[36:39], v[192:195]
    ds_read_b128 v[8:11], v74 offset:1024
    v_mfma_f32_16x16x32_bf16 v[196:199], v[32:35], v[40:43], v[196:199]
    ds_read_b128 v[12:15], v74 offset:2048
    v_mfma_f32_16x16x32_bf16 v[200:203], v[32:35], v[44:47], v[200:203]
    ds_read_b128 v[16:19], v74 offset:3072
    v_mfma_f32_16x16x32_bf16 v[204:207], v[32:35], v[48:51], v[204:207]
    s_waitcnt lgkmcnt(0)
    v_mfma_f32_16x16x32_bf16 v[80:83], v[4:7], v[52:55], v[80:83]
    ds_read_b128 v[20:23], v74 offset:4096
    v_mfma_f32_16x16x32_bf16 v[84:87], v[4:7], v[56:59], v[84:87]
    v_mfma_f32_16x16x32_bf16 v[88:91], v[4:7], v[60:63], v[88:91]
    ds_read_b128 v[24:27], v74 offset:5120
    v_mfma_f32_16x16x32_bf16 v[92:95], v[4:7], v[64:67], v[92:95]
    v_mfma_f32_16x16x32_bf16 v[96:99], v[8:11], v[52:55], v[96:99]
    ds_read_b128 v[28:31], v74 offset:6144
    v_mfma_f32_16x16x32_bf16 v[100:103], v[8:11], v[56:59], v[100:103]
    v_mfma_f32_16x16x32_bf16 v[104:107], v[8:11], v[60:63], v[104:107]
    ds_read_b128 v[32:35], v74 offset:7168
    v_mfma_f32_16x16x32_bf16 v[108:111], v[8:11], v[64:67], v[108:111]
    v_mfma_f32_16x16x32_bf16 v[112:115], v[12:15], v[52:55], v[112:115]
    v_mfma_f32_16x16x32_bf16 v[116:119], v[12:15], v[56:59], v[116:119]
    v_mfma_f32_16x16x32_bf16 v[120:123], v[12:15], v[60:63], v[120:123]
    v_mfma_f32_16x16x32_bf16 v[124:127], v[12:15], v[64:67], v[124:127]
    v_mfma_f32_16x16x32_bf16 v[128:131], v[16:19], v[52:55], v[128:131]
    v_mfma_f32_16x16x32_bf16 v[132:135], v[16:19], v[56:59], v[132:135]
    v_mfma_f32_16x16x32_bf16 v[136:139], v[16:19], v[60:63], v[136:139]
    v_mfma_f32_16x16x32_bf16 v[140:143], v[16:19], v[64:67], v[140:143]
    s_waitcnt lgkmcnt(0)
    v_mfma_f32_16x16x32_bf16 v[144:147], v[20:23], v[52:55], v[144:147]
    v_mfma_f32_16x16x32_bf16 v[148:151], v[20:23], v[56:59], v[148:151]
    v_mfma_f32_16x16x32_bf16 v[152:155], v[20:23], v[60:63], v[152:155]
    v_mfma_f32_16x16x32_bf16 v[156:159], v[20:23], v[64:67], v[156:159]
    v_mfma_f32_16x16x32_bf16 v[160:163], v[24:27], v[52:55], v[160:163]
    v_mfma_f32_16x16x32_bf16 v[164:167], v[24:27], v[56:59], v[164:167]
    v_mfma_f32_16x16x32_bf16 v[168:171], v[24:27], v[60:63], v[168:171]
    v_mfma_f32_16x16x32_bf16 v[172:175], v[24:27], v[64:67], v[172:175]
    v_mfma_f32_16x16x32_bf16 v[176:179], v[28:31], v[52:55], v[176:179]
    v_mfma_f32_16x16x32_bf16 v[180:183], v[28:31], v[56:59], v[180:183]
    v_mfma_f32_16x16x32_bf16 v[184:187], v[28:31], v[60:63], v[184:187]
    v_mfma_f32_16x16x32_bf16 v[188:191], v[28:31], v[64:67], v[188:191]
    v_mfma_f32_16x16x32_bf16 v[192:195], v[32:35], v[52:55], v[192:195]
    v_mfma_f32_16x16x32_bf16 v[196:199], v[32:35], v[56:59], v[196:199]
    v_mfma_f32_16x16x32_bf16 v[200:203], v[32:35], v[60:63], v[200:203]
    v_mfma_f32_16x16x32_bf16 v[204:207], v[32:35], v[64:67], v[204:207]
    s_cmp_eq_u32 s84, 0
    s_cbranch_scc1 p3e_48
    v_cvt_pk_bf16_f32 v4, v80, v81
    v_cvt_pk_bf16_f32 v5, v82, v83
    v_cvt_pk_bf16_f32 v6, v96, v97
    v_cvt_pk_bf16_f32 v7, v98, v99
    buffer_store_dwordx4 v[4:7], v79, s[8:11], s81 offen offset:0 sc1
    v_cvt_pk_bf16_f32 v8, v84, v85
    v_cvt_pk_bf16_f32 v9, v86, v87
    v_cvt_pk_bf16_f32 v10, v100, v101
    v_cvt_pk_bf16_f32 v11, v102, v103
    buffer_store_dwordx4 v[8:11], v79, s[8:11], s81 offen offset:256 sc1
    v_cvt_pk_bf16_f32 v12, v88, v89
    v_cvt_pk_bf16_f32 v13, v90, v91
    v_cvt_pk_bf16_f32 v14, v104, v105
    v_cvt_pk_bf16_f32 v15, v106, v107
    buffer_store_dwordx4 v[12:15], v79, s[8:11], s81 offen offset:2048 sc1
    v_cvt_pk_bf16_f32 v16, v92, v93
    v_cvt_pk_bf16_f32 v17, v94, v95
    v_cvt_pk_bf16_f32 v18, v108, v109
    v_cvt_pk_bf16_f32 v19, v110, v111
    buffer_store_dwordx4 v[16:19], v79, s[8:11], s81 offen offset:2304 sc1
    s_add_u32 s81, s81, s82
    v_cvt_pk_bf16_f32 v20, v112, v113
    v_cvt_pk_bf16_f32 v21, v114, v115
    v_cvt_pk_bf16_f32 v22, v128, v129
    v_cvt_pk_bf16_f32 v23, v130, v131
    buffer_store_dwordx4 v[20:23], v79, s[8:11], s81 offen offset:0 sc1
    v_cvt_pk_bf16_f32 v24, v116, v117
    v_cvt_pk_bf16_f32 v25, v118, v119
    v_cvt_pk_bf16_f32 v26, v132, v133
    v_cvt_pk_bf16_f32 v27, v134, v135
    buffer_store_dwordx4 v[24:27], v79, s[8:11], s81 offen offset:256 sc1
    v_cvt_pk_bf16_f32 v28, v120, v121
    v_cvt_pk_bf16_f32 v29, v122, v123
    v_cvt_pk_bf16_f32 v30, v136, v137
    v_cvt_pk_bf16_f32 v31, v138, v139
    buffer_store_dwordx4 v[28:31], v79, s[8:11], s81 offen offset:2048 sc1
    v_cvt_pk_bf16_f32 v32, v124, v125
    v_cvt_pk_bf16_f32 v33, v126, v127
    v_cvt_pk_bf16_f32 v34, v140, v141
    v_cvt_pk_bf16_f32 v35, v142, v143
    buffer_store_dwordx4 v[32:35], v79, s[8:11], s81 offen offset:2304 sc1
    s_add_u32 s81, s81, s82
    v_cvt_pk_bf16_f32 v36, v144, v145
    v_cvt_pk_bf16_f32 v37, v146, v147
    v_cvt_pk_bf16_f32 v38, v160, v161
    v_cvt_pk_bf16_f32 v39, v162, v163
    buffer_store_dwordx4 v[36:39], v79, s[8:11], s81 offen offset:0 sc1
    v_cvt_pk_bf16_f32 v40, v148, v149
    v_cvt_pk_bf16_f32 v41, v150, v151
    v_cvt_pk_bf16_f32 v42, v164, v165
    v_cvt_pk_bf16_f32 v43, v166, v167
    buffer_store_dwordx4 v[40:43], v79, s[8:11], s81 offen offset:256 sc1
    v_cvt_pk_bf16_f32 v44, v152, v153
    v_cvt_pk_bf16_f32 v45, v154, v155
    v_cvt_pk_bf16_f32 v46, v168, v169
    v_cvt_pk_bf16_f32 v47, v170, v171
    buffer_store_dwordx4 v[44:47], v79, s[8:11], s81 offen offset:2048 sc1
    v_cvt_pk_bf16_f32 v48, v156, v157
    v_cvt_pk_bf16_f32 v49, v158, v159
    v_cvt_pk_bf16_f32 v50, v172, v173
    v_cvt_pk_bf16_f32 v51, v174, v175
    buffer_store_dwordx4 v[48:51], v79, s[8:11], s81 offen offset:2304 sc1
    s_add_u32 s81, s81, s82
    v_cvt_pk_bf16_f32 v52, v176, v177
    v_cvt_pk_bf16_f32 v53, v178, v179
    v_cvt_pk_bf16_f32 v54, v192, v193
    v_cvt_pk_bf16_f32 v55, v194, v195
    buffer_store_dwordx4 v[52:55], v79, s[8:11], s81 offen offset:0 sc1
    v_cvt_pk_bf16_f32 v56, v180, v181
    v_cvt_pk_bf16_f32 v57, v182, v183
    v_cvt_pk_bf16_f32 v58, v196, v197
    v_cvt_pk_bf16_f32 v59, v198, v199
    buffer_store_dwordx4 v[56:59], v79, s[8:11], s81 offen offset:256 sc1
    v_cvt_pk_bf16_f32 v60, v184, v185
    v_cvt_pk_bf16_f32 v61, v186, v187
    v_cvt_pk_bf16_f32 v62, v200, v201
    v_cvt_pk_bf16_f32 v63, v202, v203
    buffer_store_dwordx4 v[60:63], v79, s[8:11], s81 offen offset:2048 sc1
    v_cvt_pk_bf16_f32 v64, v188, v189
    v_cvt_pk_bf16_f32 v65, v190, v191
    v_cvt_pk_bf16_f32 v66, v204, v205
    v_cvt_pk_bf16_f32 v67, v206, v207
    buffer_store_dwordx4 v[64:67], v79, s[8:11], s81 offen offset:2304 sc1
next_46:
    s_waitcnt vmcnt(0)
    s_barrier
    s_cmp_lg_u32 s58, 0
    s_cbranch_scc1 sig_67
    v_mov_b32 v75, 0x5ffffff0
    v_mov_b32 v76, s83
    v_cmp_eq_u32 vcc, 0, v1
    s_nop 1
    v_cndmask_b32 v76, v75, v76, vcc
    v_mov_b32 v75, s84
    buffer_atomic_add v75, v76, s[12:15], 0 offen sc1
sig_67:
disp_50:
    s_add_u32 s78, s78, 1
    v_bfe_u32 v79, v1, 0, 4
    v_lshlrev_b32 v79, 4, v79
    v_bfe_u32 v75, v1, 4, 2
    v_lshl_or_b32 v79, v75, 9, v79
    v_bfe_u32 v76, v1, 2, 2
    v_sub_u32 v76, 0, v76
    v_lshrrev_b32 v75, 4, v1
    v_xor_b32 v76, v76, v75
    v_and_b32 v76, 3, v76
    v_bfe_u32 v72, v1, 0, 4
    v_lshlrev_b32 v72, 6, v72
    v_lshl_or_b32 v72, v76, 4, v72
    s_lshr_b32 s74, s58, 2
    s_mul_i32 s74, s74, 8192
    v_add_u32 v72, s74, v72
    v_bfe_u32 v73, v1, 0, 2
    v_lshlrev_b32 v73, 3, v73
    v_bfe_u32 v75, v1, 4, 1
    v_lshl_or_b32 v73, v75, 5, v73
    v_bfe_u32 v75, v1, 2, 2
    v_lshl_or_b32 v73, v75, 6, v73
    v_bfe_u32 v75, v1, 2, 2
    v_lshl_or_b32 v73, v75, 9, v73
    v_bfe_u32 v75, v1, 4, 2
    v_lshl_or_b32 v73, v75, 12, v73
    s_and_b32 s74, s58, 3
    s_mul_i32 s74, s74, 128
    s_or_b32 s74, s74, 16384
    v_xor_b32 v73, s74, v73
    s_mov_b32 s84, 1
    s_cmp_eq_u32 s78, 1
    s_cbranch_scc1 r1_74
    s_cmp_eq_u32 s78, 2
    s_cselect_b32 s85, 8, 12
    s_cmp_lt_u32 s57, s85
    s_cbranch_scc1 fol_73
    s_cmp_ge_u32 s57, 24
    s_cbranch_scc1 fft_72
    s_cmp_eq_u32 s78, 5
    s_cbranch_scc1 r5_77
    s_cmp_ge_u32 s57, 12
    s_addc_u32 s79, s78, 2
    s_cmp_lt_u32 s57, 16
    s_cbranch_scc1 q_68
    s_branch kv_75
r1_74:
    s_lshr_b32 s79, s57, 2
    s_cmp_lt_u32 s57, 16
    s_cbranch_scc1 q_68
    s_lshr_b32 s79, s57, 3
    s_add_u32 s79, s79, 1
kv_75:
    s_bfe_u32 s80, s76, 0x30000
    s_bfe_u32 s85, s76, 0x10005
    s_lshl_b32 s85, s85, 3
    s_or_b32 s80, s80, s85
    s_lshl_b32 s83, s79, 3
    s_add_u32 s83, s83, 128
    s_cmp_ge_u32 s75, 2
    s_cbranch_scc1 v1_70
    s_mov_b64 s[60:61], s[36:37]
    s_mov_b32 s62, 0x400000
    s_mov_b32 s63, 0x20000
    s_mov_b64 s[64:65], s[24:25]
    s_mov_b32 s66, 0x800000
    s_mov_b32 s67, 0x20000
    v_lshrrev_b32 v76, 4, v1
    v_sub_u32 v76, 0, v76
    v_xor_b32 v76, v76, v1
    v_and_b32 v76, 3, v76
    s_mul_i32 s74, s58, 32
    v_lshrrev_b32 v77, 2, v1
    v_add3_u32 v77, v77, s74, 0
    v_lshlrev_b32 v68, 11, v77
    v_lshl_add_u32 v68, v76, 4, v68
    v_lshrrev_b32 v77, 2, v1
    v_add3_u32 v77, v77, s74, 16
    v_lshlrev_b32 v69, 11, v77
    v_lshl_add_u32 v69, v76, 4, v69
    s_and_b32 s74, s58, 2
    v_bfe_u32 v76, v1, 0, 5
    v_bfe_u32 v77, v1, 5, 1
    v_lshlrev_b32 v77, 2, v77
    v_xor_b32 v76, v76, v77
    v_xor_b32 v76, s74, v76
    v_bfe_u32 v77, v76, 0, 1
    v_lshlrev_b32 v77, 5, v77
    v_bfe_u32 v75, v76, 1, 1
    v_lshl_or_b32 v77, v75, 4, v77
    v_bfe_u32 v75, v76, 2, 3
    v_lshl_or_b32 v77, v75, 6, v77
    v_lshrrev_b32 v76, 5, v1
    v_lshl_add_u32 v70, v76, 13, v77
    v_bfe_u32 v76, v1, 0, 5
    v_bfe_u32 v77, v1, 5, 1
    v_lshlrev_b32 v77, 2, v77
    v_xor_b32 v76, v76, v77
    v_xor_b32 v76, s74, v76
    v_xor_b32 v76, 8, v76
    v_bfe_u32 v77, v76, 0, 1
    v_lshlrev_b32 v77, 5, v77
    v_bfe_u32 v75, v76, 1, 1
    v_lshl_or_b32 v77, v75, 4, v77
    v_bfe_u32 v75, v76, 2, 3
    v_lshl_or_b32 v77, v75, 6, v77
    v_lshrrev_b32 v76, 5, v1
    v_lshl_add_u32 v71, v76, 13, v77
    v_add_u32 v71, 16384, v71
    s_lshl_b32 s74, s58, 15
    v_add_u32 v70, s74, v70
    v_add_u32 v71, s74, v71
    s_mov_b32 s70, 262144
    s_mul_i32 s68, s79, 524288
    s_mul_i32 s69, s80, 512
    s_mov_b32 s82, 0x40000
    s_lshl_b32 s81, s79, 1
    s_lshr_b32 s85, s58, 2
    s_add_u32 s81, s81, s85
    s_mul_i32 s81, s81, s82
    s_mul_i32 s81, s81, 4
    s_lshl_b32 s74, s80, 2
    s_and_b32 s85, s58, 3
    s_add_u32 s85, s85, s74
    s_mul_i32 s85, s85, 4096
    s_add_u32 s81, s81, s85
    s_add_u32 s81, s81, 0x1000000
    s_mul_i32 s71, s58, 2048
    s_mov_b32 m0, s71
    s_nop 0
    buffer_load_dwordx4 v68, s[60:63], s68 offen lds
    s_add_u32 m0, s71, 1024
    s_nop 0
    buffer_load_dwordx4 v69, s[60:63], s68 offen lds
    s_add_u32 m0, s71, 16384
    s_nop 0
    buffer_load_dwordx4 v70, s[64:67], s69 offen lds
    s_add_u32 m0, s71, 17408
    s_nop 0
    buffer_load_dwordx4 v71, s[64:67], s69 offen lds
    s_add_u32 s68, s68, 64
    s_add_u32 s69, s69, s70
    s_add_u32 s71, s71, 32768
    s_and_b32 s71, s71, 0x1ffff
    s_mov_b32 m0, s71
    s_nop 0
    buffer_load_dwordx4 v68, s[60:63], s68 offen lds
    s_add_u32 m0, s71, 1024
    s_nop 0
    buffer_load_dwordx4 v69, s[60:63], s68 offen lds
    s_add_u32 m0, s71, 16384
    s_nop 0
    buffer_load_dwordx4 v70, s[64:67], s69 offen lds
    s_add_u32 m0, s71, 17408
    s_nop 0
    buffer_load_dwordx4 v71, s[64:67], s69 offen lds
    s_add_u32 s68, s68, 64
    s_add_u32 s69, s69, s70
    s_add_u32 s71, s71, 32768
    s_and_b32 s71, s71, 0x1ffff
    s_mov_b32 m0, s71
    s_nop 0
    buffer_load_dwordx4 v68, s[60:63], s68 offen lds
    s_add_u32 m0, s71, 1024
    s_nop 0
    buffer_load_dwordx4 v69, s[60:63], s68 offen lds
    s_add_u32 m0, s71, 16384
    s_nop 0
    buffer_load_dwordx4 v70, s[64:67], s69 offen lds
    s_add_u32 m0, s71, 17408
    s_nop 0
    buffer_load_dwordx4 v71, s[64:67], s69 offen lds
    s_add_u32 s68, s68, 64
    s_add_u32 s69, s69, s70
    s_add_u32 s71, s71, 32768
    s_and_b32 s71, s71, 0x1ffff
    s_mov_b32 m0, s71
    s_nop 0
    buffer_load_dwordx4 v68, s[60:63], s68 offen lds
    s_add_u32 m0, s71, 1024
    s_nop 0
    buffer_load_dwordx4 v69, s[60:63], s68 offen lds
    s_add_u32 m0, s71, 16384
    s_nop 0
    buffer_load_dwordx4 v70, s[64:67], s69 offen lds
    s_add_u32 m0, s71, 17408
    s_nop 0
    buffer_load_dwordx4 v71, s[64:67], s69 offen lds
    s_add_u32 s68, s68, 64
    s_add_u32 s69, s69, s70
    s_add_u32 s71, s71, 32768
    s_and_b32 s71, s71, 0x1ffff
    s_branch f256_44
v1_70:
    s_mov_b64 s[60:61], s[36:37]
    s_mov_b32 s62, 0x400000
    s_mov_b32 s63, 0x20000
    s_mov_b64 s[64:65], s[28:29]
    s_mov_b32 s66, 0x800000
    s_mov_b32 s67, 0x20000
    v_lshrrev_b32 v76, 4, v1
    v_sub_u32 v76, 0, v76
    v_xor_b32 v76, v76, v1
    v_and_b32 v76, 3, v76
    s_mul_i32 s74, s58, 32
    v_lshrrev_b32 v77, 2, v1
    v_add3_u32 v77, v77, s74, 0
    v_bfe_u32 v68, v77, 0, 3
    v_lshlrev_b32 v68, 11, v68
    v_bfe_u32 v75, v77, 3, 1
    v_lshl_or_b32 v68, v75, 15, v68
    v_bfe_u32 v75, v77, 4, 1
    v_lshl_or_b32 v68, v75, 14, v68
    v_bfe_u32 v75, v77, 5, 3
    v_lshl_or_b32 v68, v75, 16, v68
    v_lshl_add_u32 v68, v76, 4, v68
    v_lshrrev_b32 v77, 2, v1
    v_add3_u32 v77, v77, s74, 16
    v_bfe_u32 v69, v77, 0, 3
    v_lshlrev_b32 v69, 11, v69
    v_bfe_u32 v75, v77, 3, 1
    v_lshl_or_b32 v69, v75, 15, v69
    v_bfe_u32 v75, v77, 4, 1
    v_lshl_or_b32 v69, v75, 14, v69
    v_bfe_u32 v75, v77, 5, 3
    v_lshl_or_b32 v69, v75, 16, v69
    v_lshl_add_u32 v69, v76, 4, v69
    s_and_b32 s74, s58, 2
    v_bfe_u32 v76, v1, 0, 5
    v_bfe_u32 v77, v1, 5, 1
    v_lshlrev_b32 v77, 2, v77
    v_xor_b32 v76, v76, v77
    v_xor_b32 v76, s74, v76
    v_lshlrev_b32 v77, 4, v76
    v_lshrrev_b32 v76, 5, v1
    v_lshl_add_u32 v70, v76, 13, v77
    v_bfe_u32 v76, v1, 0, 5
    v_bfe_u32 v77, v1, 5, 1
    v_lshlrev_b32 v77, 2, v77
    v_xor_b32 v76, v76, v77
    v_xor_b32 v76, s74, v76
    v_xor_b32 v76, 8, v76
    v_lshlrev_b32 v77, 4, v76
    v_lshrrev_b32 v76, 5, v1
    v_lshl_add_u32 v71, v76, 13, v77
    v_add_u32 v71, 16384, v71
    s_lshl_b32 s74, s58, 15
    v_add_u32 v70, s74, v70
    v_add_u32 v71, s74, v71
    s_mov_b32 s70, 262144
    s_mul_i32 s68, s79, 524288
    s_mul_i32 s69, s80, 512
    s_mov_b32 s82, 0x40000
    s_lshl_b32 s81, s79, 1
    s_lshr_b32 s85, s58, 2
    s_add_u32 s81, s81, s85
    s_mul_i32 s81, s81, s82
    s_mul_i32 s81, s81, 4
    s_lshl_b32 s74, s80, 2
    s_and_b32 s85, s58, 3
    s_add_u32 s85, s85, s74
    s_mul_i32 s85, s85, 4096
    s_add_u32 s81, s81, s85
    s_add_u32 s81, s81, 0x2000000
    s_mul_i32 s71, s58, 2048
    s_mov_b32 m0, s71
    s_nop 0
    buffer_load_dwordx4 v68, s[60:63], s68 offen lds
    s_add_u32 m0, s71, 1024
    s_nop 0
    buffer_load_dwordx4 v69, s[60:63], s68 offen lds
    s_add_u32 m0, s71, 16384
    s_nop 0
    buffer_load_dwordx4 v70, s[64:67], s69 offen lds
    s_add_u32 m0, s71, 17408
    s_nop 0
    buffer_load_dwordx4 v71, s[64:67], s69 offen lds
    s_add_u32 s68, s68, 64
    s_add_u32 s69, s69, s70
    s_add_u32 s71, s71, 32768
    s_and_b32 s71, s71, 0x1ffff
    s_mov_b32 m0, s71
    s_nop 0
    buffer_load_dwordx4 v68, s[60:63], s68 offen lds
    s_add_u32 m0, s71, 1024
    s_nop 0
    buffer_load_dwordx4 v69, s[60:63], s68 offen lds
    s_add_u32 m0, s71, 16384
    s_nop 0
    buffer_load_dwordx4 v70, s[64:67], s69 offen lds
    s_add_u32 m0, s71, 17408
    s_nop 0
    buffer_load_dwordx4 v71, s[64:67], s69 offen lds
    s_add_u32 s68, s68, 64
    s_add_u32 s69, s69, s70
    s_add_u32 s71, s71, 32768
    s_and_b32 s71, s71, 0x1ffff
    s_mov_b32 m0, s71
    s_nop 0
    buffer_load_dwordx4 v68, s[60:63], s68 offen lds
    s_add_u32 m0, s71, 1024
    s_nop 0
    buffer_load_dwordx4 v69, s[60:63], s68 offen lds
    s_add_u32 m0, s71, 16384
    s_nop 0
    buffer_load_dwordx4 v70, s[64:67], s69 offen lds
    s_add_u32 m0, s71, 17408
    s_nop 0
    buffer_load_dwordx4 v71, s[64:67], s69 offen lds
    s_add_u32 s68, s68, 64
    s_add_u32 s69, s69, s70
    s_add_u32 s71, s71, 32768
    s_and_b32 s71, s71, 0x1ffff
    s_mov_b32 m0, s71
    s_nop 0
    buffer_load_dwordx4 v68, s[60:63], s68 offen lds
    s_add_u32 m0, s71, 1024
    s_nop 0
    buffer_load_dwordx4 v69, s[60:63], s68 offen lds
    s_add_u32 m0, s71, 16384
    s_nop 0
    buffer_load_dwordx4 v70, s[64:67], s69 offen lds
    s_add_u32 m0, s71, 17408
    s_nop 0
    buffer_load_dwordx4 v71, s[64:67], s69 offen lds
    s_add_u32 s68, s68, 64
    s_add_u32 s69, s69, s70
    s_add_u32 s71, s71, 32768
    s_and_b32 s71, s71, 0x1ffff
    s_branch t256_45
q_68:
    s_bfe_u32 s80, s76, 0x20000
    s_bfe_u32 s85, s76, 0x20005
    s_lshl_b32 s85, s85, 2
    s_or_b32 s80, s80, s85
    s_lshl_b32 s83, s79, 3
    s_add_u32 s83, s83, 128
    s_mov_b32 s84, 0x10000
    s_mov_b64 s[60:61], s[36:37]
    s_mov_b32 s62, 0x400000
    s_mov_b32 s63, 0x20000
    s_mov_b64 s[64:65], s[20:21]
    s_mov_b32 s66, 0x800000
    s_mov_b32 s67, 0x20000
    v_lshrrev_b32 v76, 4, v1
    v_sub_u32 v76, 0, v76
    v_xor_b32 v76, v76, v1
    v_and_b32 v76, 3, v76
    s_mul_i32 s74, s58, 32
    v_lshrrev_b32 v77, 2, v1
    v_add3_u32 v77, v77, s74, 0
    v_lshlrev_b32 v68, 11, v77
    v_lshl_add_u32 v68, v76, 4, v68
    v_lshrrev_b32 v77, 2, v1
    v_add3_u32 v77, v77, s74, 16
    v_lshlrev_b32 v69, 11, v77
    v_lshl_add_u32 v69, v76, 4, v69
    s_and_b32 s74, s58, 2
    v_bfe_u32 v76, v1, 0, 5
    v_bfe_u32 v77, v1, 5, 1
    v_lshlrev_b32 v77, 2, v77
    v_xor_b32 v76, v76, v77
    v_xor_b32 v76, s74, v76
    v_bfe_u32 v77, v76, 0, 1
    v_lshlrev_b32 v77, 5, v77
    v_bfe_u32 v75, v76, 1, 1
    v_lshl_or_b32 v77, v75, 4, v77
    v_bfe_u32 v75, v76, 2, 3
    v_lshl_or_b32 v77, v75, 6, v77
    v_lshrrev_b32 v76, 5, v1
    v_lshl_add_u32 v70, v76, 13, v77
    v_bfe_u32 v76, v1, 0, 5
    v_bfe_u32 v77, v1, 5, 1
    v_lshlrev_b32 v77, 2, v77
    v_xor_b32 v76, v76, v77
    v_xor_b32 v76, s74, v76
    v_xor_b32 v76, 8, v76
    v_bfe_u32 v77, v76, 0, 1
    v_lshlrev_b32 v77, 5, v77
    v_bfe_u32 v75, v76, 1, 1
    v_lshl_or_b32 v77, v75, 4, v77
    v_bfe_u32 v75, v76, 2, 3
    v_lshl_or_b32 v77, v75, 6, v77
    v_lshrrev_b32 v76, 5, v1
    v_lshl_add_u32 v71, v76, 13, v77
    v_add_u32 v71, 16384, v71
    s_lshl_b32 s74, s58, 15
    v_add_u32 v70, s74, v70
    v_add_u32 v71, s74, v71
    s_mov_b32 s70, 262144
    s_mul_i32 s68, s79, 524288
    s_mul_i32 s69, s80, 512
    s_mov_b32 s82, 0x40000
    s_lshl_b32 s81, s79, 1
    s_lshr_b32 s85, s58, 2
    s_add_u32 s81, s81, s85
    s_mul_i32 s81, s81, s82
    s_mul_i32 s81, s81, 4
    s_lshl_b32 s74, s80, 2
    s_and_b32 s85, s58, 3
    s_add_u32 s85, s85, s74
    s_mul_i32 s85, s85, 4096
    s_add_u32 s81, s81, s85
    s_add_u32 s81, s81, 0x0
    s_mul_i32 s71, s58, 2048
    s_mov_b32 m0, s71
    s_nop 0
    buffer_load_dwordx4 v68, s[60:63], s68 offen lds
    s_add_u32 m0, s71, 1024
    s_nop 0
    buffer_load_dwordx4 v69, s[60:63], s68 offen lds
    s_add_u32 m0, s71, 16384
    s_nop 0
    buffer_load_dwordx4 v70, s[64:67], s69 offen lds
    s_add_u32 m0, s71, 17408
    s_nop 0
    buffer_load_dwordx4 v71, s[64:67], s69 offen lds
    s_add_u32 s68, s68, 64
    s_add_u32 s69, s69, s70
    s_add_u32 s71, s71, 32768
    s_and_b32 s71, s71, 0x1ffff
    s_mov_b32 m0, s71
    s_nop 0
    buffer_load_dwordx4 v68, s[60:63], s68 offen lds
    s_add_u32 m0, s71, 1024
    s_nop 0
    buffer_load_dwordx4 v69, s[60:63], s68 offen lds
    s_add_u32 m0, s71, 16384
    s_nop 0
    buffer_load_dwordx4 v70, s[64:67], s69 offen lds
    s_add_u32 m0, s71, 17408
    s_nop 0
    buffer_load_dwordx4 v71, s[64:67], s69 offen lds
    s_add_u32 s68, s68, 64
    s_add_u32 s69, s69, s70
    s_add_u32 s71, s71, 32768
    s_and_b32 s71, s71, 0x1ffff
    s_mov_b32 m0, s71
    s_nop 0
    buffer_load_dwordx4 v68, s[60:63], s68 offen lds
    s_add_u32 m0, s71, 1024
    s_nop 0
    buffer_load_dwordx4 v69, s[60:63], s68 offen lds
    s_add_u32 m0, s71, 16384
    s_nop 0
    buffer_load_dwordx4 v70, s[64:67], s69 offen lds
    s_add_u32 m0, s71, 17408
    s_nop 0
    buffer_load_dwordx4 v71, s[64:67], s69 offen lds
    s_add_u32 s68, s68, 64
    s_add_u32 s69, s69, s70
    s_add_u32 s71, s71, 32768
    s_and_b32 s71, s71, 0x1ffff
    s_mov_b32 m0, s71
    s_nop 0
    buffer_load_dwordx4 v68, s[60:63], s68 offen lds
    s_add_u32 m0, s71, 1024
    s_nop 0
    buffer_load_dwordx4 v69, s[60:63], s68 offen lds
    s_add_u32 m0, s71, 16384
    s_nop 0
    buffer_load_dwordx4 v70, s[64:67], s69 offen lds
    s_add_u32 m0, s71, 17408
    s_nop 0
    buffer_load_dwordx4 v71, s[64:67], s69 offen lds
    s_add_u32 s68, s68, 64
    s_add_u32 s69, s69, s70
    s_add_u32 s71, s71, 32768
    s_and_b32 s71, s71, 0x1ffff
    s_branch f256_44
fft_72:
    s_cmp_eq_u32 s78, 3
    s_cbranch_scc1 col_69
    s_cmp_eq_u32 s78, 4
    s_cbranch_scc1 p3_71
    s_cmp_lg_u32 s58, 0
    s_cbranch_scc1 wall_79
    v_mov_b32 v76, 136
wctr_80:
    buffer_load_dword v75, v76, s[12:15], 0 offen sc1
    s_waitcnt vmcnt(0)
    v_cmp_gt_u16 vcc, 128, v75
    s_cbranch_vccz wctr_ok_81
    s_sub_u32 s77, s77, 1
    s_cbranch_scc0 wctr_80
    s_mov_b32 s77, 0
wctr_ok_81:
wall_79:
    s_cmp_lg_u32 s58, 0
    s_cbranch_scc1 wall_82
    v_mov_b32 v76, 140
wctr_83:
    buffer_load_dword v75, v76, s[12:15], 0 offen sc1
    s_waitcnt vmcnt(0)
    v_cmp_gt_u16 vcc, 128, v75
    s_cbranch_vccz wctr_ok_84
    s_sub_u32 s77, s77, 1
    s_cbranch_scc0 wctr_83
    s_mov_b32 s77, 0
wctr_ok_84:
wall_82:
    s_barrier
    s_and_b32 s79, s57, 7
    s_mov_b32 s80, s75
    s_mov_b32 s83, 40
    s_mov_b64 s[60:61], s[44:45]
    s_mov_b32 s62, 0x400000
    s_mov_b32 s63, 0x20000
    s_mov_b64 s[64:65], s[8:9]
    s_mov_b32 s66, 0x10000000
    s_mov_b32 s67, 0x20000
    v_lshrrev_b32 v76, 4, v1
    v_sub_u32 v76, 0, v76
    v_xor_b32 v76, v76, v1
    v_and_b32 v76, 3, v76
    s_mul_i32 s74, s58, 32
    v_lshrrev_b32 v77, 2, v1
    v_add3_u32 v77, v77, s74, 0
    v_bfe_u32 v68, v77, 0, 3
    v_lshlrev_b32 v68, 17, v68
    v_bfe_u32 v75, v77, 3, 1
    v_lshl_or_b32 v68, v75, 21, v68
    v_bfe_u32 v75, v77, 4, 1
    v_lshl_or_b32 v68, v75, 20, v68
    v_bfe_u32 v75, v77, 5, 3
    v_lshl_or_b32 v68, v75, 11, v68
    v_lshl_add_u32 v68, v76, 4, v68
    v_lshrrev_b32 v77, 2, v1
    v_add3_u32 v77, v77, s74, 16
    v_bfe_u32 v69, v77, 0, 3
    v_lshlrev_b32 v69, 17, v69
    v_bfe_u32 v75, v77, 3, 1
    v_lshl_or_b32 v69, v75, 21, v69
    v_bfe_u32 v75, v77, 4, 1
    v_lshl_or_b32 v69, v75, 20, v69
    v_bfe_u32 v75, v77, 5, 3
    v_lshl_or_b32 v69, v75, 11, v69
    v_lshl_add_u32 v69, v76, 4, v69
    s_and_b32 s74, s58, 2
    v_bfe_u32 v76, v1, 0, 5
    v_bfe_u32 v77, v1, 5, 1
    v_lshlrev_b32 v77, 2, v77
    v_xor_b32 v76, v76, v77
    v_xor_b32 v76, s74, v76
    v_lshlrev_b32 v77, 4, v76
    v_lshrrev_b32 v76, 5, v1
    v_lshl_add_u32 v70, v76, 11, v77
    v_bfe_u32 v76, v1, 0, 5
    v_bfe_u32 v77, v1, 5, 1
    v_lshlrev_b32 v77, 2, v77
    v_xor_b32 v76, v76, v77
    v_xor_b32 v76, s74, v76
    v_xor_b32 v76, 8, v76
    v_lshlrev_b32 v77, 4, v76
    v_lshrrev_b32 v76, 5, v1
    v_lshl_add_u32 v71, v76, 11, v77
    v_add_u32 v71, 4096, v71
    s_lshl_b32 s74, s58, 13
    v_add_u32 v70, s74, v70
    v_add_u32 v71, s74, v71
    s_mov_b32 s70, 65536
    s_lshl_b32 s68, s79, 14
    s_lshl_b32 s69, s80, 9
    s_add_u32 s69, s69, 0x5200000
    s_mov_b32 s82, 0x10000
    s_lshl_b32 s81, s79, 1
    s_lshr_b32 s85, s58, 2
    s_add_u32 s81, s81, s85
    s_mul_i32 s81, s81, s82
    s_mul_i32 s81, s81, 4
    s_lshl_b32 s74, s80, 2
    s_and_b32 s85, s58, 3
    s_add_u32 s85, s85, s74
    s_mul_i32 s85, s85, 4096
    s_add_u32 s81, s81, s85
    s_add_u32 s81, s81, 0x5400000
    s_mul_i32 s71, s58, 2048
    s_mov_b32 m0, s71
    s_nop 0
    buffer_load_dwordx4 v68, s[60:63], s68 offen lds
    s_add_u32 m0, s71, 1024
    s_nop 0
    buffer_load_dwordx4 v69, s[60:63], s68 offen lds
    s_add_u32 m0, s71, 16384
    s_nop 0
    buffer_load_dwordx4 v70, s[64:67], s69 offen lds
    s_add_u32 m0, s71, 17408
    s_nop 0
    buffer_load_dwordx4 v71, s[64:67], s69 offen lds
    s_add_u32 s68, s68, 64
    s_add_u32 s69, s69, s70
    s_add_u32 s71, s71, 32768
    s_and_b32 s71, s71, 0x1ffff
    s_mov_b32 m0, s71
    s_nop 0
    buffer_load_dwordx4 v68, s[60:63], s68 offen lds
    s_add_u32 m0, s71, 1024
    s_nop 0
    buffer_load_dwordx4 v69, s[60:63], s68 offen lds
    s_add_u32 m0, s71, 16384
    s_nop 0
    buffer_load_dwordx4 v70, s[64:67], s69 offen lds
    s_add_u32 m0, s71, 17408
    s_nop 0
    buffer_load_dwordx4 v71, s[64:67], s69 offen lds
    s_add_u32 s68, s68, 64
    s_add_u32 s69, s69, s70
    s_add_u32 s71, s71, 32768
    s_and_b32 s71, s71, 0x1ffff
    s_mov_b32 m0, s71
    s_nop 0
    buffer_load_dwordx4 v68, s[60:63], s68 offen lds
    s_add_u32 m0, s71, 1024
    s_nop 0
    buffer_load_dwordx4 v69, s[60:63], s68 offen lds
    s_add_u32 m0, s71, 16384
    s_nop 0
    buffer_load_dwordx4 v70, s[64:67], s69 offen lds
    s_add_u32 m0, s71, 17408
    s_nop 0
    buffer_load_dwordx4 v71, s[64:67], s69 offen lds
    s_add_u32 s68, s68, 64
    s_add_u32 s69, s69, s70
    s_add_u32 s71, s71, 32768
    s_and_b32 s71, s71, 0x1ffff
    s_mov_b32 m0, s71
    s_nop 0
    buffer_load_dwordx4 v68, s[60:63], s68 offen lds
    s_add_u32 m0, s71, 1024
    s_nop 0
    buffer_load_dwordx4 v69, s[60:63], s68 offen lds
    s_add_u32 m0, s71, 16384
    s_nop 0
    buffer_load_dwordx4 v70, s[64:67], s69 offen lds
    s_add_u32 m0, s71, 17408
    s_nop 0
    buffer_load_dwordx4 v71, s[64:67], s69 offen lds
    s_add_u32 s68, s68, 64
    s_add_u32 s69, s69, s70
    s_add_u32 s71, s71, 32768
    s_and_b32 s71, s71, 0x1ffff
    s_branch t256_45
col_69:
    s_bfe_u32 s79, s76, 0x30000
    s_bfe_u32 s85, s76, 0x20005
    s_lshl_b32 s85, s85, 3
    s_or_b32 s79, s79, s85
    v_bfe_u32 v231, v1, 0, 5
    v_bfe_u32 v235, v1, 5, 1
    v_lshl_or_b32 v231, v235, 7, v231
    v_mul_u32_u24 v231, 1026, v231
    v_and_b32 v231, -4, v231
    s_mul_i32 s5, s58, 262656
    s_lshl_b32 s2, s79, 5
    s_add_u32 s5, s5, s2
    buffer_load_dwordx4 v[84:87], v231, s[48:51], s5 offen
    buffer_load_dwordx4 v[88:91], v231, s[48:51], s5 offen offset:16
    buffer_load_dword v92, v231, s[48:51], s5 offen offset:32
    buffer_load_dwordx4 v[94:97], v231, s[52:55], s5 offen
    buffer_load_dwordx4 v[98:101], v231, s[52:55], s5 offen offset:16
    buffer_load_dword v102, v231, s[52:55], s5 offen offset:32
    s_add_u32 s5, s5, 32832
    buffer_load_dwordx4 v[104:107], v231, s[48:51], s5 offen
    buffer_load_dwordx4 v[108:111], v231, s[48:51], s5 offen offset:16
    buffer_load_dword v112, v231, s[48:51], s5 offen offset:32
    buffer_load_dwordx4 v[114:117], v231, s[52:55], s5 offen
    buffer_load_dwordx4 v[118:121], v231, s[52:55], s5 offen offset:16
    buffer_load_dword v122, v231, s[52:55], s5 offen offset:32
    s_add_u32 s5, s5, 32832
    buffer_load_dwordx4 v[124:127], v231, s[48:51], s5 offen
    buffer_load_dwordx4 v[128:131], v231, s[48:51], s5 offen offset:16
    buffer_load_dword v132, v231, s[48:51], s5 offen offset:32
    buffer_load_dwordx4 v[134:137], v231, s[52:55], s5 offen
    buffer_load_dwordx4 v[138:141], v231, s[52:55], s5 offen offset:16
    buffer_load_dword v142, v231, s[52:55], s5 offen offset:32
    s_add_u32 s5, s5, 32832
    buffer_load_dwordx4 v[144:147], v231, s[48:51], s5 offen
    buffer_load_dwordx4 v[148:151], v231, s[48:51], s5 offen offset:16
    buffer_load_dword v152, v231, s[48:51], s5 offen offset:32
    buffer_load_dwordx4 v[154:157], v231, s[52:55], s5 offen
    buffer_load_dwordx4 v[158:161], v231, s[52:55], s5 offen offset:16
    buffer_load_dword v162, v231, s[52:55], s5 offen offset:32
    s_add_u32 s5, s5, 32832
    v_and_b32 v235, 31, v1
    v_cvt_f32_u32 v228, v235
    v_and_b32 v235, 32, v1
    v_cvt_f32_u32 v235, v235
    v_mul_f32 v229, v228, v235
    v_mul_f32 v229, 0x3b000000, v229
    v_mul_f32 v234, 0x3d000000, v229
    v_fmamk_f32 v230, v235, 0x3b000000, v234
    v_and_b32 v233, 1, v1
    v_lshlrev_b32 v232, 4, v233
    v_mul_u32_u24 v233, 0x8000, v233
    v_lshl_or_b32 v233, v233, 16, v233
    v_fmamk_f32 v243, v228, 0x0, v229
    v_add_f32 v244, v243, v243
    v_cos_f32 v235, v243
    v_sin_f32 v237, v243
    v_cos_f32 v239, v244
    v_sin_f32 v241, v244
    v_fmamk_f32 v243, v228, 0x3c800000, v229
    v_add_f32 v244, v243, v243
    v_cos_f32 v236, v243
    v_sin_f32 v238, v243
    v_cos_f32 v240, v244
    v_sin_f32 v242, v244
    v_cvt_pk_bf16_f32 v4, v235, v236
    v_cvt_pk_bf16_f32 v36, v237, v238
    v_cvt_pk_bf16_f32 v68, v239, v240
    v_cvt_pk_bf16_f32 v76, v241, v242
    v_fmamk_f32 v243, v228, 0x3d000000, v229
    v_add_f32 v244, v243, v243
    v_cos_f32 v235, v243
    v_sin_f32 v237, v243
    v_cos_f32 v239, v244
    v_sin_f32 v241, v244
    v_fmamk_f32 v243, v228, 0x3d400000, v229
    v_add_f32 v244, v243, v243
    v_cos_f32 v236, v243
    v_sin_f32 v238, v243
    v_cos_f32 v240, v244
    v_sin_f32 v242, v244
    v_cvt_pk_bf16_f32 v5, v235, v236
    v_cvt_pk_bf16_f32 v37, v237, v238
    v_cvt_pk_bf16_f32 v69, v239, v240
    v_cvt_pk_bf16_f32 v77, v241, v242
    v_fmamk_f32 v243, v228, 0x3e000000, v229
    v_add_f32 v244, v243, v243
    v_cos_f32 v235, v243
    v_sin_f32 v237, v243
    v_cos_f32 v239, v244
    v_sin_f32 v241, v244
    v_fmamk_f32 v243, v228, 0x3e100000, v229
    v_add_f32 v244, v243, v243
    v_cos_f32 v236, v243
    v_sin_f32 v238, v243
    v_cos_f32 v240, v244
    v_sin_f32 v242, v244
    v_cvt_pk_bf16_f32 v6, v235, v236
    v_cvt_pk_bf16_f32 v38, v237, v238
    v_cvt_pk_bf16_f32 v70, v239, v240
    v_cvt_pk_bf16_f32 v78, v241, v242
    v_fmamk_f32 v243, v228, 0x3e200000, v229
    v_add_f32 v244, v243, v243
    v_cos_f32 v235, v243
    v_sin_f32 v237, v243
    v_cos_f32 v239, v244
    v_sin_f32 v241, v244
    v_fmamk_f32 v243, v228, 0x3e300000, v229
    v_add_f32 v244, v243, v243
    v_cos_f32 v236, v243
    v_sin_f32 v238, v243
    v_cos_f32 v240, v244
    v_sin_f32 v242, v244
    v_cvt_pk_bf16_f32 v7, v235, v236
    v_cvt_pk_bf16_f32 v39, v237, v238
    v_cvt_pk_bf16_f32 v71, v239, v240
    v_cvt_pk_bf16_f32 v79, v241, v242
    v_fmamk_f32 v243, v228, 0x3e800000, v229
    v_add_f32 v244, v243, v243
    v_cos_f32 v235, v243
    v_sin_f32 v237, v243
    v_cos_f32 v239, v244
    v_sin_f32 v241, v244
    v_fmamk_f32 v243, v228, 0x3e880000, v229
    v_add_f32 v244, v243, v243
    v_cos_f32 v236, v243
    v_sin_f32 v238, v243
    v_cos_f32 v240, v244
    v_sin_f32 v242, v244
    v_cvt_pk_bf16_f32 v8, v235, v236
    v_cvt_pk_bf16_f32 v40, v237, v238
    v_cvt_pk_bf16_f32 v72, v239, v240
    v_cvt_pk_bf16_f32 v80, v241, v242
    v_fmamk_f32 v243, v228, 0x3e900000, v229
    v_add_f32 v244, v243, v243
    v_cos_f32 v235, v243
    v_sin_f32 v237, v243
    v_cos_f32 v239, v244
    v_sin_f32 v241, v244
    v_fmamk_f32 v243, v228, 0x3e980000, v229
    v_add_f32 v244, v243, v243
    v_cos_f32 v236, v243
    v_sin_f32 v238, v243
    v_cos_f32 v240, v244
    v_sin_f32 v242, v244
    v_cvt_pk_bf16_f32 v9, v235, v236
    v_cvt_pk_bf16_f32 v41, v237, v238
    v_cvt_pk_bf16_f32 v73, v239, v240
    v_cvt_pk_bf16_f32 v81, v241, v242
    v_fmamk_f32 v243, v228, 0x3ec00000, v229
    v_add_f32 v244, v243, v243
    v_cos_f32 v235, v243
    v_sin_f32 v237, v243
    v_cos_f32 v239, v244
    v_sin_f32 v241, v244
    v_fmamk_f32 v243, v228, 0x3ec80000, v229
    v_add_f32 v244, v243, v243
    v_cos_f32 v236, v243
    v_sin_f32 v238, v243
    v_cos_f32 v240, v244
    v_sin_f32 v242, v244
    v_cvt_pk_bf16_f32 v10, v235, v236
    v_cvt_pk_bf16_f32 v42, v237, v238
    v_cvt_pk_bf16_f32 v74, v239, v240
    v_cvt_pk_bf16_f32 v82, v241, v242
    v_fmamk_f32 v243, v228, 0x3ed00000, v229
    v_add_f32 v244, v243, v243
    v_cos_f32 v235, v243
    v_sin_f32 v237, v243
    v_cos_f32 v239, v244
    v_sin_f32 v241, v244
    v_fmamk_f32 v243, v228, 0x3ed80000, v229
    v_add_f32 v244, v243, v243
    v_cos_f32 v236, v243
    v_sin_f32 v238, v243
    v_cos_f32 v240, v244
    v_sin_f32 v242, v244
    v_cvt_pk_bf16_f32 v11, v235, v236
    v_cvt_pk_bf16_f32 v43, v237, v238
    v_cvt_pk_bf16_f32 v75, v239, v240
    v_cvt_pk_bf16_f32 v83, v241, v242
    v_xor_b32 v12, v233, v4
    v_xor_b32 v13, v233, v5
    v_xor_b32 v14, v233, v6
    v_xor_b32 v15, v233, v7
    v_xor_b32 v16, v233, v8
    v_xor_b32 v17, v233, v9
    v_xor_b32 v18, v233, v10
    v_xor_b32 v19, v233, v11
    v_xor_b32 v20, 0x80000000, v4
    v_xor_b32 v21, 0x80000000, v5
    v_xor_b32 v22, 0x80000000, v6
    v_xor_b32 v23, 0x80000000, v7
    v_xor_b32 v24, 0x80000000, v8
    v_xor_b32 v25, 0x80000000, v9
    v_xor_b32 v26, 0x80000000, v10
    v_xor_b32 v27, 0x80000000, v11
    v_xor_b32 v28, 0x80000000, v12
    v_xor_b32 v29, 0x80000000, v13
    v_xor_b32 v30, 0x80000000, v14
    v_xor_b32 v31, 0x80000000, v15
    v_xor_b32 v32, 0x80000000, v16
    v_xor_b32 v33, 0x80000000, v17
    v_xor_b32 v34, 0x80000000, v18
    v_xor_b32 v35, 0x80000000, v19
    v_xor_b32 v44, v233, v36
    v_xor_b32 v45, v233, v37
    v_xor_b32 v46, v233, v38
    v_xor_b32 v47, v233, v39
    v_xor_b32 v48, v233, v40
    v_xor_b32 v49, v233, v41
    v_xor_b32 v50, v233, v42
    v_xor_b32 v51, v233, v43
    v_xor_b32 v52, 0x80000000, v36
    v_xor_b32 v53, 0x80000000, v37
    v_xor_b32 v54, 0x80000000, v38
    v_xor_b32 v55, 0x80000000, v39
    v_xor_b32 v56, 0x80000000, v40
    v_xor_b32 v57, 0x80000000, v41
    v_xor_b32 v58, 0x80000000, v42
    v_xor_b32 v59, 0x80000000, v43
    v_xor_b32 v60, 0x80000000, v44
    v_xor_b32 v61, 0x80000000, v45
    v_xor_b32 v62, 0x80000000, v46
    v_xor_b32 v63, 0x80000000, v47
    v_xor_b32 v64, 0x80000000, v48
    v_xor_b32 v65, 0x80000000, v49
    v_xor_b32 v66, 0x80000000, v50
    v_xor_b32 v67, 0x80000000, v51
    s_mov_b32 s2, 0x05040100
    s_mov_b32 s3, 0x07060302
    s_lshl_b32 s5, s58, 10
    v_lshl_add_u32 v231, v1, 4, s5
    v_add_u32 v233, 0x10000, v231
    v_add_u32 v235, 0x20000, v231
    s_waitcnt vmcnt(0)
    v_alignbit_b32 v84, v85, v84, v232
    v_alignbit_b32 v94, v95, v94, v232
    v_alignbit_b32 v104, v105, v104, v232
    v_alignbit_b32 v114, v115, v114, v232
    v_alignbit_b32 v124, v125, v124, v232
    v_alignbit_b32 v134, v135, v134, v232
    v_alignbit_b32 v144, v145, v144, v232
    v_alignbit_b32 v154, v155, v154, v232
    v_perm_b32 v196, v94, v84, s2
    v_perm_b32 v197, v114, v104, s2
    v_perm_b32 v198, v134, v124, s2
    v_perm_b32 v199, v154, v144, s2
    ds_write_b128 v231, v[196:199] offset:0
    v_perm_b32 v200, v94, v84, s3
    v_perm_b32 v201, v114, v104, s3
    v_perm_b32 v202, v134, v124, s3
    v_perm_b32 v203, v154, v144, s3
    ds_write_b128 v231, v[200:203] offset:8192
    v_alignbit_b32 v85, v86, v85, v232
    v_alignbit_b32 v95, v96, v95, v232
    v_alignbit_b32 v105, v106, v105, v232
    v_alignbit_b32 v115, v116, v115, v232
    v_alignbit_b32 v125, v126, v125, v232
    v_alignbit_b32 v135, v136, v135, v232
    v_alignbit_b32 v145, v146, v145, v232
    v_alignbit_b32 v155, v156, v155, v232
    v_perm_b32 v204, v95, v85, s2
    v_perm_b32 v205, v115, v105, s2
    v_perm_b32 v206, v135, v125, s2
    v_perm_b32 v207, v155, v145, s2
    ds_write_b128 v231, v[204:207] offset:16384
    v_perm_b32 v208, v95, v85, s3
    v_perm_b32 v209, v115, v105, s3
    v_perm_b32 v210, v135, v125, s3
    v_perm_b32 v211, v155, v145, s3
    ds_write_b128 v231, v[208:211] offset:24576
    v_alignbit_b32 v86, v87, v86, v232
    v_alignbit_b32 v96, v97, v96, v232
    v_alignbit_b32 v106, v107, v106, v232
    v_alignbit_b32 v116, v117, v116, v232
    v_alignbit_b32 v126, v127, v126, v232
    v_alignbit_b32 v136, v137, v136, v232
    v_alignbit_b32 v146, v147, v146, v232
    v_alignbit_b32 v156, v157, v156, v232
    v_perm_b32 v212, v96, v86, s2
    v_perm_b32 v213, v116, v106, s2
    v_perm_b32 v214, v136, v126, s2
    v_perm_b32 v215, v156, v146, s2
    ds_write_b128 v231, v[212:215] offset:32768
    v_perm_b32 v216, v96, v86, s3
    v_perm_b32 v217, v116, v106, s3
    v_perm_b32 v218, v136, v126, s3
    v_perm_b32 v219, v156, v146, s3
    ds_write_b128 v231, v[216:219] offset:40960
    v_alignbit_b32 v87, v88, v87, v232
    v_alignbit_b32 v97, v98, v97, v232
    v_alignbit_b32 v107, v108, v107, v232
    v_alignbit_b32 v117, v118, v117, v232
    v_alignbit_b32 v127, v128, v127, v232
    v_alignbit_b32 v137, v138, v137, v232
    v_alignbit_b32 v147, v148, v147, v232
    v_alignbit_b32 v157, v158, v157, v232
    v_perm_b32 v220, v97, v87, s2
    v_perm_b32 v221, v117, v107, s2
    v_perm_b32 v222, v137, v127, s2
    v_perm_b32 v223, v157, v147, s2
    ds_write_b128 v231, v[220:223] offset:49152
    v_perm_b32 v224, v97, v87, s3
    v_perm_b32 v225, v117, v107, s3
    v_perm_b32 v226, v137, v127, s3
    v_perm_b32 v227, v157, v147, s3
    ds_write_b128 v231, v[224:227] offset:57344
    v_alignbit_b32 v88, v89, v88, v232
    v_alignbit_b32 v98, v99, v98, v232
    v_alignbit_b32 v108, v109, v108, v232
    v_alignbit_b32 v118, v119, v118, v232
    v_alignbit_b32 v128, v129, v128, v232
    v_alignbit_b32 v138, v139, v138, v232
    v_alignbit_b32 v148, v149, v148, v232
    v_alignbit_b32 v158, v159, v158, v232
    v_perm_b32 v196, v98, v88, s2
    v_perm_b32 v197, v118, v108, s2
    v_perm_b32 v198, v138, v128, s2
    v_perm_b32 v199, v158, v148, s2
    ds_write_b128 v233, v[196:199] offset:0
    v_perm_b32 v200, v98, v88, s3
    v_perm_b32 v201, v118, v108, s3
    v_perm_b32 v202, v138, v128, s3
    v_perm_b32 v203, v158, v148, s3
    ds_write_b128 v233, v[200:203] offset:8192
    v_alignbit_b32 v89, v90, v89, v232
    v_alignbit_b32 v99, v100, v99, v232
    v_alignbit_b32 v109, v110, v109, v232
    v_alignbit_b32 v119, v120, v119, v232
    v_alignbit_b32 v129, v130, v129, v232
    v_alignbit_b32 v139, v140, v139, v232
    v_alignbit_b32 v149, v150, v149, v232
    v_alignbit_b32 v159, v160, v159, v232
    v_perm_b32 v204, v99, v89, s2
    v_perm_b32 v205, v119, v109, s2
    v_perm_b32 v206, v139, v129, s2
    v_perm_b32 v207, v159, v149, s2
    ds_write_b128 v233, v[204:207] offset:16384
    v_perm_b32 v208, v99, v89, s3
    v_perm_b32 v209, v119, v109, s3
    v_perm_b32 v210, v139, v129, s3
    v_perm_b32 v211, v159, v149, s3
    ds_write_b128 v233, v[208:211] offset:24576
    v_alignbit_b32 v90, v91, v90, v232
    v_alignbit_b32 v100, v101, v100, v232
    v_alignbit_b32 v110, v111, v110, v232
    v_alignbit_b32 v120, v121, v120, v232
    v_alignbit_b32 v130, v131, v130, v232
    v_alignbit_b32 v140, v141, v140, v232
    v_alignbit_b32 v150, v151, v150, v232
    v_alignbit_b32 v160, v161, v160, v232
    v_perm_b32 v212, v100, v90, s2
    v_perm_b32 v213, v120, v110, s2
    v_perm_b32 v214, v140, v130, s2
    v_perm_b32 v215, v160, v150, s2
    ds_write_b128 v233, v[212:215] offset:32768
    v_perm_b32 v216, v100, v90, s3
    v_perm_b32 v217, v120, v110, s3
    v_perm_b32 v218, v140, v130, s3
    v_perm_b32 v219, v160, v150, s3
    ds_write_b128 v233, v[216:219] offset:40960
    v_alignbit_b32 v91, v92, v91, v232
    v_alignbit_b32 v101, v102, v101, v232
    v_alignbit_b32 v111, v112, v111, v232
    v_alignbit_b32 v121, v122, v121, v232
    v_alignbit_b32 v131, v132, v131, v232
    v_alignbit_b32 v141, v142, v141, v232
    v_alignbit_b32 v151, v152, v151, v232
    v_alignbit_b32 v161, v162, v161, v232
    v_perm_b32 v220, v101, v91, s2
    v_perm_b32 v221, v121, v111, s2
    v_perm_b32 v222, v141, v131, s2
    v_perm_b32 v223, v161, v151, s2
    ds_write_b128 v233, v[220:223] offset:49152
    v_perm_b32 v224, v101, v91, s3
    v_perm_b32 v225, v121, v111, s3
    v_perm_b32 v226, v141, v131, s3
    v_perm_b32 v227, v161, v151, s3
    ds_write_b128 v233, v[224:227] offset:57344
    v_alignbit_b32 v92, v92, v92, v232
    v_alignbit_b32 v102, v102, v102, v232
    v_alignbit_b32 v112, v112, v112, v232
    v_alignbit_b32 v122, v122, v122, v232
    v_alignbit_b32 v132, v132, v132, v232
    v_alignbit_b32 v142, v142, v142, v232
    v_alignbit_b32 v152, v152, v152, v232
    v_alignbit_b32 v162, v162, v162, v232
    v_perm_b32 v196, v102, v92, s2
    v_perm_b32 v197, v122, v112, s2
    v_perm_b32 v198, v142, v132, s2
    v_perm_b32 v199, v162, v152, s2
    ds_write_b128 v235, v[196:199] offset:0
    s_waitcnt lgkmcnt(0)
    s_cmp_lg_u32 s58, 0
    s_cbranch_scc1 wall_85
    v_mov_b32 v236, 40
wctr_86:
    buffer_load_dword v235, v236, s[12:15], 0 offen sc1
    s_waitcnt vmcnt(0)
    v_cmp_gt_u16 vcc, 32, v235
    s_cbranch_vccz wctr_ok_87
    s_sub_u32 s77, s77, 1
    s_cbranch_scc0 wctr_86
    s_mov_b32 s77, 0
wctr_ok_87:
wall_85:
    s_barrier
    s_mov_b32 s7, s58
colloop_88:
    s_lshl_b32 s3, s79, 4
    s_add_u32 s3, s3, s7
    s_lshl_b32 s3, s3, 1
    s_cmp_eq_u32 s3, 1024
    s_cselect_b32 s3, 1, s3
    s_cmp_lt_u32 s3, 2
    s_cselect_b32 s6, 0x5ffffff0, 0
    s_mov_b32 s4, 0x35800000
    s_cselect_b32 s4, 0x35000000, s4
    v_bfe_u32 v231, v1, 0, 5
    v_lshlrev_b32 v231, 16, v231
    v_bfe_u32 v235, v1, 5, 1
    v_lshl_or_b32 v231, v235, 9, v231
    v_add_u32 v232, s6, v231
    s_bfe_u32 s5, s3, 0x50000
    s_lshl_b32 s5, s5, 4
    s_bfe_u32 s2, s3, 0x50005
    s_lshl_b32 s2, s2, 11
    s_or_b32 s5, s5, s2
    s_add_u32 s5, s5, 0x5400000
    buffer_load_dwordx4 v[84:87], v231, s[8:11], s5 offen offset:0
    buffer_load_dwordx4 v[100:103], v232, s[8:11], s5 offen offset:16
    buffer_load_dwordx4 v[88:91], v231, s[8:11], s5 offen offset:1024
    buffer_load_dwordx4 v[104:107], v232, s[8:11], s5 offen offset:1040
    s_add_u32 s5, s5, 2097152
    buffer_load_dwordx4 v[92:95], v231, s[8:11], s5 offen offset:0
    buffer_load_dwordx4 v[108:111], v232, s[8:11], s5 offen offset:16
    buffer_load_dwordx4 v[96:99], v231, s[8:11], s5 offen offset:1024
    buffer_load_dwordx4 v[112:115], v232, s[8:11], s5 offen offset:1040
    s_add_u32 s5, s5, 2097152
    s_lshl_b32 s5, s7, 13
    v_lshl_add_u32 v235, v1, 4, s5
    ds_read_b128 v[196:199], v235 offset:0
    ds_read_b128 v[200:203], v235 offset:1024
    ds_read_b128 v[204:207], v235 offset:2048
    ds_read_b128 v[208:211], v235 offset:3072
    ds_read_b128 v[212:215], v235 offset:4096
    ds_read_b128 v[216:219], v235 offset:5120
    ds_read_b128 v[220:223], v235 offset:6144
    ds_read_b128 v[224:227], v235 offset:7168
    v_and_b32 v236, 31, v1
    v_cvt_f32_u32 v228, v236
    v_mov_b32 v229, v234
    s_waitcnt vmcnt(0) lgkmcnt(0)
    v_xor_b32 v116, 0x80008000, v84
    v_xor_b32 v117, 0x80008000, v85
    v_xor_b32 v118, 0x80008000, v86
    v_xor_b32 v119, 0x80008000, v87
    v_xor_b32 v120, 0x80008000, v88
    v_xor_b32 v121, 0x80008000, v89
    v_xor_b32 v122, 0x80008000, v90
    v_xor_b32 v123, 0x80008000, v91
    v_xor_b32 v124, 0x80008000, v92
    v_xor_b32 v125, 0x80008000, v93
    v_xor_b32 v126, 0x80008000, v94
    v_xor_b32 v127, 0x80008000, v95
    v_xor_b32 v128, 0x80008000, v96
    v_xor_b32 v129, 0x80008000, v97
    v_xor_b32 v130, 0x80008000, v98
    v_xor_b32 v131, 0x80008000, v99
    v_mfma_f32_32x32x16_bf16 v[132:147], v[84:87], v[68:71], 0
    v_mfma_f32_32x32x16_bf16 v[164:179], v[100:103], v[68:71], 0
    v_mfma_f32_32x32x16_bf16 v[132:147], v[100:103], v[76:79], v[132:147]
    v_mfma_f32_32x32x16_bf16 v[164:179], v[116:119], v[76:79], v[164:179]
    v_mfma_f32_32x32x16_bf16 v[132:147], v[88:91], v[72:75], v[132:147]
    v_mfma_f32_32x32x16_bf16 v[164:179], v[104:107], v[72:75], v[164:179]
    v_mfma_f32_32x32x16_bf16 v[132:147], v[104:107], v[80:83], v[132:147]
    v_mfma_f32_32x32x16_bf16 v[164:179], v[120:123], v[80:83], v[164:179]
    v_mfma_f32_32x32x16_bf16 v[148:163], v[92:95], v[68:71], 0
    v_mfma_f32_32x32x16_bf16 v[180:195], v[108:111], v[68:71], 0
    v_mfma_f32_32x32x16_bf16 v[148:163], v[108:111], v[76:79], v[148:163]
    v_mfma_f32_32x32x16_bf16 v[180:195], v[124:127], v[76:79], v[180:195]
    v_mfma_f32_32x32x16_bf16 v[148:163], v[96:99], v[72:75], v[148:163]
    v_mfma_f32_32x32x16_bf16 v[180:195], v[112:115], v[72:75], v[180:195]
    v_mfma_f32_32x32x16_bf16 v[148:163], v[112:115], v[80:83], v[148:163]
    v_mfma_f32_32x32x16_bf16 v[180:195], v[128:131], v[80:83], v[180:195]
    v_fmamk_f32 v243, v228, 0x0, v229
    v_cos_f32 v239, v243
    v_sin_f32 v240, v243
    v_mul_f32 v239, s4, v239
    v_mul_f32 v240, s4, v240
    v_mul_f32 v235, v132, v239
    v_mul_f32 v237, v164, v239
    v_fma_f32 v235, v164, v240, v235
    v_fma_f32 v237, -v132, v240, v237
    v_fmamk_f32 v243, v228, 0x3a000000, v229
    v_cos_f32 v241, v243
    v_sin_f32 v242, v243
    v_mul_f32 v241, s4, v241
    v_mul_f32 v242, s4, v242
    v_mul_f32 v236, v133, v241
    v_mul_f32 v238, v165, v241
    v_fma_f32 v236, v165, v242, v236
    v_fma_f32 v238, -v133, v242, v238
    v_cvt_pk_bf16_f32 v84, v235, v236
    v_cvt_pk_bf16_f32 v100, v237, v238
    v_cvt_pk_bf16_f32 v116, -v235, -v236
    v_fmamk_f32 v243, v228, 0x3a800000, v229
    v_cos_f32 v239, v243
    v_sin_f32 v240, v243
    v_mul_f32 v239, s4, v239
    v_mul_f32 v240, s4, v240
    v_mul_f32 v235, v134, v239
    v_mul_f32 v237, v166, v239
    v_fma_f32 v235, v166, v240, v235
    v_fma_f32 v237, -v134, v240, v237
    v_fmamk_f32 v243, v228, 0x3ac00000, v229
    v_cos_f32 v241, v243
    v_sin_f32 v242, v243
    v_mul_f32 v241, s4, v241
    v_mul_f32 v242, s4, v242
    v_mul_f32 v236, v135, v241
    v_mul_f32 v238, v167, v241
    v_fma_f32 v236, v167, v242, v236
    v_fma_f32 v238, -v135, v242, v238
    v_cvt_pk_bf16_f32 v85, v235, v236
    v_cvt_pk_bf16_f32 v101, v237, v238
    v_cvt_pk_bf16_f32 v117, -v235, -v236
    v_fmamk_f32 v243, v228, 0x3b800000, v229
    v_cos_f32 v239, v243
    v_sin_f32 v240, v243
    v_mul_f32 v239, s4, v239
    v_mul_f32 v240, s4, v240
    v_mul_f32 v235, v136, v239
    v_mul_f32 v237, v168, v239
    v_fma_f32 v235, v168, v240, v235
    v_fma_f32 v237, -v136, v240, v237
    v_fmamk_f32 v243, v228, 0x3b900000, v229
    v_cos_f32 v241, v243
    v_sin_f32 v242, v243
    v_mul_f32 v241, s4, v241
    v_mul_f32 v242, s4, v242
    v_mul_f32 v236, v137, v241
    v_mul_f32 v238, v169, v241
    v_fma_f32 v236, v169, v242, v236
    v_fma_f32 v238, -v137, v242, v238
    v_cvt_pk_bf16_f32 v86, v235, v236
    v_cvt_pk_bf16_f32 v102, v237, v238
    v_cvt_pk_bf16_f32 v118, -v235, -v236
    v_fmamk_f32 v243, v228, 0x3ba00000, v229
    v_cos_f32 v239, v243
    v_sin_f32 v240, v243
    v_mul_f32 v239, s4, v239
    v_mul_f32 v240, s4, v240
    v_mul_f32 v235, v138, v239
    v_mul_f32 v237, v170, v239
    v_fma_f32 v235, v170, v240, v235
    v_fma_f32 v237, -v138, v240, v237
    v_fmamk_f32 v243, v228, 0x3bb00000, v229
    v_cos_f32 v241, v243
    v_sin_f32 v242, v243
    v_mul_f32 v241, s4, v241
    v_mul_f32 v242, s4, v242
    v_mul_f32 v236, v139, v241
    v_mul_f32 v238, v171, v241
    v_fma_f32 v236, v171, v242, v236
    v_fma_f32 v238, -v139, v242, v238
    v_cvt_pk_bf16_f32 v87, v235, v236
    v_cvt_pk_bf16_f32 v103, v237, v238
    v_cvt_pk_bf16_f32 v119, -v235, -v236
    v_fmamk_f32 v243, v228, 0x3c000000, v229
    v_cos_f32 v239, v243
    v_sin_f32 v240, v243
    v_mul_f32 v239, s4, v239
    v_mul_f32 v240, s4, v240
    v_mul_f32 v235, v140, v239
    v_mul_f32 v237, v172, v239
    v_fma_f32 v235, v172, v240, v235
    v_fma_f32 v237, -v140, v240, v237
    v_fmamk_f32 v243, v228, 0x3c080000, v229
    v_cos_f32 v241, v243
    v_sin_f32 v242, v243
    v_mul_f32 v241, s4, v241
    v_mul_f32 v242, s4, v242
    v_mul_f32 v236, v141, v241
    v_mul_f32 v238, v173, v241
    v_fma_f32 v236, v173, v242, v236
    v_fma_f32 v238, -v141, v242, v238
    v_cvt_pk_bf16_f32 v88, v235, v236
    v_cvt_pk_bf16_f32 v104, v237, v238
    v_cvt_pk_bf16_f32 v120, -v235, -v236
    v_fmamk_f32 v243, v228, 0x3c100000, v229
    v_cos_f32 v239, v243
    v_sin_f32 v240, v243
    v_mul_f32 v239, s4, v239
    v_mul_f32 v240, s4, v240
    v_mul_f32 v235, v142, v239
    v_mul_f32 v237, v174, v239
    v_fma_f32 v235, v174, v240, v235
    v_fma_f32 v237, -v142, v240, v237
    v_fmamk_f32 v243, v228, 0x3c180000, v229
    v_cos_f32 v241, v243
    v_sin_f32 v242, v243
    v_mul_f32 v241, s4, v241
    v_mul_f32 v242, s4, v242
    v_mul_f32 v236, v143, v241
    v_mul_f32 v238, v175, v241
    v_fma_f32 v236, v175, v242, v236
    v_fma_f32 v238, -v143, v242, v238
    v_cvt_pk_bf16_f32 v89, v235, v236
    v_cvt_pk_bf16_f32 v105, v237, v238
    v_cvt_pk_bf16_f32 v121, -v235, -v236
    v_fmamk_f32 v243, v228, 0x3c400000, v229
    v_cos_f32 v239, v243
    v_sin_f32 v240, v243
    v_mul_f32 v239, s4, v239
    v_mul_f32 v240, s4, v240
    v_mul_f32 v235, v144, v239
    v_mul_f32 v237, v176, v239
    v_fma_f32 v235, v176, v240, v235
    v_fma_f32 v237, -v144, v240, v237
    v_fmamk_f32 v243, v228, 0x3c480000, v229
    v_cos_f32 v241, v243
    v_sin_f32 v242, v243
    v_mul_f32 v241, s4, v241
    v_mul_f32 v242, s4, v242
    v_mul_f32 v236, v145, v241
    v_mul_f32 v238, v177, v241
    v_fma_f32 v236, v177, v242, v236
    v_fma_f32 v238, -v145, v242, v238
    v_cvt_pk_bf16_f32 v90, v235, v236
    v_cvt_pk_bf16_f32 v106, v237, v238
    v_cvt_pk_bf16_f32 v122, -v235, -v236
    v_fmamk_f32 v243, v228, 0x3c500000, v229
    v_cos_f32 v239, v243
    v_sin_f32 v240, v243
    v_mul_f32 v239, s4, v239
    v_mul_f32 v240, s4, v240
    v_mul_f32 v235, v146, v239
    v_mul_f32 v237, v178, v239
    v_fma_f32 v235, v178, v240, v235
    v_fma_f32 v237, -v146, v240, v237
    v_fmamk_f32 v243, v228, 0x3c580000, v229
    v_cos_f32 v241, v243
    v_sin_f32 v242, v243
    v_mul_f32 v241, s4, v241
    v_mul_f32 v242, s4, v242
    v_mul_f32 v236, v147, v241
    v_mul_f32 v238, v179, v241
    v_fma_f32 v236, v179, v242, v236
    v_fma_f32 v238, -v147, v242, v238
    v_cvt_pk_bf16_f32 v91, v235, v236
    v_cvt_pk_bf16_f32 v107, v237, v238
    v_cvt_pk_bf16_f32 v123, -v235, -v236
    v_fmamk_f32 v243, v228, 0x3c800000, v229
    v_cos_f32 v239, v243
    v_sin_f32 v240, v243
    v_mul_f32 v239, s4, v239
    v_mul_f32 v240, s4, v240
    v_mul_f32 v235, v148, v239
    v_mul_f32 v237, v180, v239
    v_fma_f32 v235, v180, v240, v235
    v_fma_f32 v237, -v148, v240, v237
    v_fmamk_f32 v243, v228, 0x3c840000, v229
    v_cos_f32 v241, v243
    v_sin_f32 v242, v243
    v_mul_f32 v241, s4, v241
    v_mul_f32 v242, s4, v242
    v_mul_f32 v236, v149, v241
    v_mul_f32 v238, v181, v241
    v_fma_f32 v236, v181, v242, v236
    v_fma_f32 v238, -v149, v242, v238
    v_cvt_pk_bf16_f32 v92, v235, v236
    v_cvt_pk_bf16_f32 v108, v237, v238
    v_cvt_pk_bf16_f32 v124, -v235, -v236
    v_fmamk_f32 v243, v228, 0x3c880000, v229
    v_cos_f32 v239, v243
    v_sin_f32 v240, v243
    v_mul_f32 v239, s4, v239
    v_mul_f32 v240, s4, v240
    v_mul_f32 v235, v150, v239
    v_mul_f32 v237, v182, v239
    v_fma_f32 v235, v182, v240, v235
    v_fma_f32 v237, -v150, v240, v237
    v_fmamk_f32 v243, v228, 0x3c8c0000, v229
    v_cos_f32 v241, v243
    v_sin_f32 v242, v243
    v_mul_f32 v241, s4, v241
    v_mul_f32 v242, s4, v242
    v_mul_f32 v236, v151, v241
    v_mul_f32 v238, v183, v241
    v_fma_f32 v236, v183, v242, v236
    v_fma_f32 v238, -v151, v242, v238
    v_cvt_pk_bf16_f32 v93, v235, v236
    v_cvt_pk_bf16_f32 v109, v237, v238
    v_cvt_pk_bf16_f32 v125, -v235, -v236
    v_fmamk_f32 v243, v228, 0x3ca00000, v229
    v_cos_f32 v239, v243
    v_sin_f32 v240, v243
    v_mul_f32 v239, s4, v239
    v_mul_f32 v240, s4, v240
    v_mul_f32 v235, v152, v239
    v_mul_f32 v237, v184, v239
    v_fma_f32 v235, v184, v240, v235
    v_fma_f32 v237, -v152, v240, v237
    v_fmamk_f32 v243, v228, 0x3ca40000, v229
    v_cos_f32 v241, v243
    v_sin_f32 v242, v243
    v_mul_f32 v241, s4, v241
    v_mul_f32 v242, s4, v242
    v_mul_f32 v236, v153, v241
    v_mul_f32 v238, v185, v241
    v_fma_f32 v236, v185, v242, v236
    v_fma_f32 v238, -v153, v242, v238
    v_cvt_pk_bf16_f32 v94, v235, v236
    v_cvt_pk_bf16_f32 v110, v237, v238
    v_cvt_pk_bf16_f32 v126, -v235, -v236
    v_fmamk_f32 v243, v228, 0x3ca80000, v229
    v_cos_f32 v239, v243
    v_sin_f32 v240, v243
    v_mul_f32 v239, s4, v239
    v_mul_f32 v240, s4, v240
    v_mul_f32 v235, v154, v239
    v_mul_f32 v237, v186, v239
    v_fma_f32 v235, v186, v240, v235
    v_fma_f32 v237, -v154, v240, v237
    v_fmamk_f32 v243, v228, 0x3cac0000, v229
    v_cos_f32 v241, v243
    v_sin_f32 v242, v243
    v_mul_f32 v241, s4, v241
    v_mul_f32 v242, s4, v242
    v_mul_f32 v236, v155, v241
    v_mul_f32 v238, v187, v241
    v_fma_f32 v236, v187, v242, v236
    v_fma_f32 v238, -v155, v242, v238
    v_cvt_pk_bf16_f32 v95, v235, v236
    v_cvt_pk_bf16_f32 v111, v237, v238
    v_cvt_pk_bf16_f32 v127, -v235, -v236
    v_fmamk_f32 v243, v228, 0x3cc00000, v229
    v_cos_f32 v239, v243
    v_sin_f32 v240, v243
    v_mul_f32 v239, s4, v239
    v_mul_f32 v240, s4, v240
    v_mul_f32 v235, v156, v239
    v_mul_f32 v237, v188, v239
    v_fma_f32 v235, v188, v240, v235
    v_fma_f32 v237, -v156, v240, v237
    v_fmamk_f32 v243, v228, 0x3cc40000, v229
    v_cos_f32 v241, v243
    v_sin_f32 v242, v243
    v_mul_f32 v241, s4, v241
    v_mul_f32 v242, s4, v242
    v_mul_f32 v236, v157, v241
    v_mul_f32 v238, v189, v241
    v_fma_f32 v236, v189, v242, v236
    v_fma_f32 v238, -v157, v242, v238
    v_cvt_pk_bf16_f32 v96, v235, v236
    v_cvt_pk_bf16_f32 v112, v237, v238
    v_cvt_pk_bf16_f32 v128, -v235, -v236
    v_fmamk_f32 v243, v228, 0x3cc80000, v229
    v_cos_f32 v239, v243
    v_sin_f32 v240, v243
    v_mul_f32 v239, s4, v239
    v_mul_f32 v240, s4, v240
    v_mul_f32 v235, v158, v239
    v_mul_f32 v237, v190, v239
    v_fma_f32 v235, v190, v240, v235
    v_fma_f32 v237, -v158, v240, v237
    v_fmamk_f32 v243, v228, 0x3ccc0000, v229
    v_cos_f32 v241, v243
    v_sin_f32 v242, v243
    v_mul_f32 v241, s4, v241
    v_mul_f32 v242, s4, v242
    v_mul_f32 v236, v159, v241
    v_mul_f32 v238, v191, v241
    v_fma_f32 v236, v191, v242, v236
    v_fma_f32 v238, -v159, v242, v238
    v_cvt_pk_bf16_f32 v97, v235, v236
    v_cvt_pk_bf16_f32 v113, v237, v238
    v_cvt_pk_bf16_f32 v129, -v235, -v236
    v_fmamk_f32 v243, v228, 0x3ce00000, v229
    v_cos_f32 v239, v243
    v_sin_f32 v240, v243
    v_mul_f32 v239, s4, v239
    v_mul_f32 v240, s4, v240
    v_mul_f32 v235, v160, v239
    v_mul_f32 v237, v192, v239
    v_fma_f32 v235, v192, v240, v235
    v_fma_f32 v237, -v160, v240, v237
    v_fmamk_f32 v243, v228, 0x3ce40000, v229
    v_cos_f32 v241, v243
    v_sin_f32 v242, v243
    v_mul_f32 v241, s4, v241
    v_mul_f32 v242, s4, v242
    v_mul_f32 v236, v161, v241
    v_mul_f32 v238, v193, v241
    v_fma_f32 v236, v193, v242, v236
    v_fma_f32 v238, -v161, v242, v238
    v_cvt_pk_bf16_f32 v98, v235, v236
    v_cvt_pk_bf16_f32 v114, v237, v238
    v_cvt_pk_bf16_f32 v130, -v235, -v236
    v_fmamk_f32 v243, v228, 0x3ce80000, v229
    v_cos_f32 v239, v243
    v_sin_f32 v240, v243
    v_mul_f32 v239, s4, v239
    v_mul_f32 v240, s4, v240
    v_mul_f32 v235, v162, v239
    v_mul_f32 v237, v194, v239
    v_fma_f32 v235, v194, v240, v235
    v_fma_f32 v237, -v162, v240, v237
    v_fmamk_f32 v243, v228, 0x3cec0000, v229
    v_cos_f32 v241, v243
    v_sin_f32 v242, v243
    v_mul_f32 v241, s4, v241
    v_mul_f32 v242, s4, v242
    v_mul_f32 v236, v163, v241
    v_mul_f32 v238, v195, v241
    v_fma_f32 v236, v195, v242, v236
    v_fma_f32 v238, -v163, v242, v238
    v_cvt_pk_bf16_f32 v99, v235, v236
    v_cvt_pk_bf16_f32 v115, v237, v238
    v_cvt_pk_bf16_f32 v131, -v235, -v236
    v_mfma_f32_32x32x16_bf16 v[132:147], v[4:7], v[84:87], 0
    v_mfma_f32_32x32x16_bf16 v[164:179], v[4:7], v[100:103], 0
    v_mfma_f32_32x32x16_bf16 v[132:147], v[36:39], v[100:103], v[132:147]
    v_mfma_f32_32x32x16_bf16 v[164:179], v[36:39], v[116:119], v[164:179]
    v_mfma_f32_32x32x16_bf16 v[132:147], v[8:11], v[88:91], v[132:147]
    v_mfma_f32_32x32x16_bf16 v[164:179], v[8:11], v[104:107], v[164:179]
    v_mfma_f32_32x32x16_bf16 v[132:147], v[40:43], v[104:107], v[132:147]
    v_mfma_f32_32x32x16_bf16 v[164:179], v[40:43], v[120:123], v[164:179]
    v_mfma_f32_32x32x16_bf16 v[132:147], v[12:15], v[92:95], v[132:147]
    v_mfma_f32_32x32x16_bf16 v[164:179], v[12:15], v[108:111], v[164:179]
    v_mfma_f32_32x32x16_bf16 v[132:147], v[44:47], v[108:111], v[132:147]
    v_mfma_f32_32x32x16_bf16 v[164:179], v[44:47], v[124:127], v[164:179]
    v_mfma_f32_32x32x16_bf16 v[132:147], v[16:19], v[96:99], v[132:147]
    v_mfma_f32_32x32x16_bf16 v[164:179], v[16:19], v[112:115], v[164:179]
    v_mfma_f32_32x32x16_bf16 v[132:147], v[48:51], v[112:115], v[132:147]
    v_mfma_f32_32x32x16_bf16 v[164:179], v[48:51], v[128:131], v[164:179]
    v_mfma_f32_32x32x16_bf16 v[148:163], v[20:23], v[84:87], 0
    v_mfma_f32_32x32x16_bf16 v[180:195], v[20:23], v[100:103], 0
    v_mfma_f32_32x32x16_bf16 v[148:163], v[52:55], v[100:103], v[148:163]
    v_mfma_f32_32x32x16_bf16 v[180:195], v[52:55], v[116:119], v[180:195]
    v_mfma_f32_32x32x16_bf16 v[148:163], v[24:27], v[88:91], v[148:163]
    v_mfma_f32_32x32x16_bf16 v[180:195], v[24:27], v[104:107], v[180:195]
    v_mfma_f32_32x32x16_bf16 v[148:163], v[56:59], v[104:107], v[148:163]
    v_mfma_f32_32x32x16_bf16 v[180:195], v[56:59], v[120:123], v[180:195]
    v_mfma_f32_32x32x16_bf16 v[148:163], v[28:31], v[92:95], v[148:163]
    v_mfma_f32_32x32x16_bf16 v[180:195], v[28:31], v[108:111], v[180:195]
    v_mfma_f32_32x32x16_bf16 v[148:163], v[60:63], v[108:111], v[148:163]
    v_mfma_f32_32x32x16_bf16 v[180:195], v[60:63], v[124:127], v[180:195]
    v_mfma_f32_32x32x16_bf16 v[148:163], v[32:35], v[96:99], v[148:163]
    v_mfma_f32_32x32x16_bf16 v[180:195], v[32:35], v[112:115], v[180:195]
    v_mfma_f32_32x32x16_bf16 v[148:163], v[64:67], v[112:115], v[148:163]
    v_mfma_f32_32x32x16_bf16 v[180:195], v[64:67], v[128:131], v[180:195]
    v_lshlrev_b32 v239, 16, v196
    v_and_b32 v240, 0xffff0000, v196
    v_mul_f32 v235, v132, v239
    v_mul_f32 v237, v164, v239
    v_fma_f32 v235, -v164, v240, v235
    v_fma_f32 v237, v132, v240, v237
    v_lshlrev_b32 v241, 16, v197
    v_and_b32 v242, 0xffff0000, v197
    v_mul_f32 v236, v133, v241
    v_mul_f32 v238, v165, v241
    v_fma_f32 v236, -v165, v242, v236
    v_fma_f32 v238, v133, v242, v238
    v_cvt_pk_bf16_f32 v84, v235, v236
    v_cvt_pk_bf16_f32 v100, v237, v238
    v_cvt_pk_bf16_f32 v116, -v237, -v238
    v_lshlrev_b32 v239, 16, v198
    v_and_b32 v240, 0xffff0000, v198
    v_mul_f32 v235, v134, v239
    v_mul_f32 v237, v166, v239
    v_fma_f32 v235, -v166, v240, v235
    v_fma_f32 v237, v134, v240, v237
    v_lshlrev_b32 v241, 16, v199
    v_and_b32 v242, 0xffff0000, v199
    v_mul_f32 v236, v135, v241
    v_mul_f32 v238, v167, v241
    v_fma_f32 v236, -v167, v242, v236
    v_fma_f32 v238, v135, v242, v238
    v_cvt_pk_bf16_f32 v85, v235, v236
    v_cvt_pk_bf16_f32 v101, v237, v238
    v_cvt_pk_bf16_f32 v117, -v237, -v238
    v_lshlrev_b32 v239, 16, v200
    v_and_b32 v240, 0xffff0000, v200
    v_mul_f32 v235, v136, v239
    v_mul_f32 v237, v168, v239
    v_fma_f32 v235, -v168, v240, v235
    v_fma_f32 v237, v136, v240, v237
    v_lshlrev_b32 v241, 16, v201
    v_and_b32 v242, 0xffff0000, v201
    v_mul_f32 v236, v137, v241
    v_mul_f32 v238, v169, v241
    v_fma_f32 v236, -v169, v242, v236
    v_fma_f32 v238, v137, v242, v238
    v_cvt_pk_bf16_f32 v86, v235, v236
    v_cvt_pk_bf16_f32 v102, v237, v238
    v_cvt_pk_bf16_f32 v118, -v237, -v238
    v_lshlrev_b32 v239, 16, v202
    v_and_b32 v240, 0xffff0000, v202
    v_mul_f32 v235, v138, v239
    v_mul_f32 v237, v170, v239
    v_fma_f32 v235, -v170, v240, v235
    v_fma_f32 v237, v138, v240, v237
    v_lshlrev_b32 v241, 16, v203
    v_and_b32 v242, 0xffff0000, v203
    v_mul_f32 v236, v139, v241
    v_mul_f32 v238, v171, v241
    v_fma_f32 v236, -v171, v242, v236
    v_fma_f32 v238, v139, v242, v238
    v_cvt_pk_bf16_f32 v87, v235, v236
    v_cvt_pk_bf16_f32 v103, v237, v238
    v_cvt_pk_bf16_f32 v119, -v237, -v238
    v_lshlrev_b32 v239, 16, v204
    v_and_b32 v240, 0xffff0000, v204
    v_mul_f32 v235, v140, v239
    v_mul_f32 v237, v172, v239
    v_fma_f32 v235, -v172, v240, v235
    v_fma_f32 v237, v140, v240, v237
    v_lshlrev_b32 v241, 16, v205
    v_and_b32 v242, 0xffff0000, v205
    v_mul_f32 v236, v141, v241
    v_mul_f32 v238, v173, v241
    v_fma_f32 v236, -v173, v242, v236
    v_fma_f32 v238, v141, v242, v238
    v_cvt_pk_bf16_f32 v88, v235, v236
    v_cvt_pk_bf16_f32 v104, v237, v238
    v_cvt_pk_bf16_f32 v120, -v237, -v238
    v_lshlrev_b32 v239, 16, v206
    v_and_b32 v240, 0xffff0000, v206
    v_mul_f32 v235, v142, v239
    v_mul_f32 v237, v174, v239
    v_fma_f32 v235, -v174, v240, v235
    v_fma_f32 v237, v142, v240, v237
    v_lshlrev_b32 v241, 16, v207
    v_and_b32 v242, 0xffff0000, v207
    v_mul_f32 v236, v143, v241
    v_mul_f32 v238, v175, v241
    v_fma_f32 v236, -v175, v242, v236
    v_fma_f32 v238, v143, v242, v238
    v_cvt_pk_bf16_f32 v89, v235, v236
    v_cvt_pk_bf16_f32 v105, v237, v238
    v_cvt_pk_bf16_f32 v121, -v237, -v238
    v_lshlrev_b32 v239, 16, v208
    v_and_b32 v240, 0xffff0000, v208
    v_mul_f32 v235, v144, v239
    v_mul_f32 v237, v176, v239
    v_fma_f32 v235, -v176, v240, v235
    v_fma_f32 v237, v144, v240, v237
    v_lshlrev_b32 v241, 16, v209
    v_and_b32 v242, 0xffff0000, v209
    v_mul_f32 v236, v145, v241
    v_mul_f32 v238, v177, v241
    v_fma_f32 v236, -v177, v242, v236
    v_fma_f32 v238, v145, v242, v238
    v_cvt_pk_bf16_f32 v90, v235, v236
    v_cvt_pk_bf16_f32 v106, v237, v238
    v_cvt_pk_bf16_f32 v122, -v237, -v238
    v_lshlrev_b32 v239, 16, v210
    v_and_b32 v240, 0xffff0000, v210
    v_mul_f32 v235, v146, v239
    v_mul_f32 v237, v178, v239
    v_fma_f32 v235, -v178, v240, v235
    v_fma_f32 v237, v146, v240, v237
    v_lshlrev_b32 v241, 16, v211
    v_and_b32 v242, 0xffff0000, v211
    v_mul_f32 v236, v147, v241
    v_mul_f32 v238, v179, v241
    v_fma_f32 v236, -v179, v242, v236
    v_fma_f32 v238, v147, v242, v238
    v_cvt_pk_bf16_f32 v91, v235, v236
    v_cvt_pk_bf16_f32 v107, v237, v238
    v_cvt_pk_bf16_f32 v123, -v237, -v238
    v_lshlrev_b32 v239, 16, v212
    v_and_b32 v240, 0xffff0000, v212
    v_mul_f32 v235, v148, v239
    v_mul_f32 v237, v180, v239
    v_fma_f32 v235, -v180, v240, v235
    v_fma_f32 v237, v148, v240, v237
    v_lshlrev_b32 v241, 16, v213
    v_and_b32 v242, 0xffff0000, v213
    v_mul_f32 v236, v149, v241
    v_mul_f32 v238, v181, v241
    v_fma_f32 v236, -v181, v242, v236
    v_fma_f32 v238, v149, v242, v238
    v_cvt_pk_bf16_f32 v92, v235, v236
    v_cvt_pk_bf16_f32 v108, v237, v238
    v_cvt_pk_bf16_f32 v124, -v237, -v238
    v_lshlrev_b32 v239, 16, v214
    v_and_b32 v240, 0xffff0000, v214
    v_mul_f32 v235, v150, v239
    v_mul_f32 v237, v182, v239
    v_fma_f32 v235, -v182, v240, v235
    v_fma_f32 v237, v150, v240, v237
    v_lshlrev_b32 v241, 16, v215
    v_and_b32 v242, 0xffff0000, v215
    v_mul_f32 v236, v151, v241
    v_mul_f32 v238, v183, v241
    v_fma_f32 v236, -v183, v242, v236
    v_fma_f32 v238, v151, v242, v238
    v_cvt_pk_bf16_f32 v93, v235, v236
    v_cvt_pk_bf16_f32 v109, v237, v238
    v_cvt_pk_bf16_f32 v125, -v237, -v238
    v_lshlrev_b32 v239, 16, v216
    v_and_b32 v240, 0xffff0000, v216
    v_mul_f32 v235, v152, v239
    v_mul_f32 v237, v184, v239
    v_fma_f32 v235, -v184, v240, v235
    v_fma_f32 v237, v152, v240, v237
    v_lshlrev_b32 v241, 16, v217
    v_and_b32 v242, 0xffff0000, v217
    v_mul_f32 v236, v153, v241
    v_mul_f32 v238, v185, v241
    v_fma_f32 v236, -v185, v242, v236
    v_fma_f32 v238, v153, v242, v238
    v_cvt_pk_bf16_f32 v94, v235, v236
    v_cvt_pk_bf16_f32 v110, v237, v238
    v_cvt_pk_bf16_f32 v126, -v237, -v238
    v_lshlrev_b32 v239, 16, v218
    v_and_b32 v240, 0xffff0000, v218
    v_mul_f32 v235, v154, v239
    v_mul_f32 v237, v186, v239
    v_fma_f32 v235, -v186, v240, v235
    v_fma_f32 v237, v154, v240, v237
    v_lshlrev_b32 v241, 16, v219
    v_and_b32 v242, 0xffff0000, v219
    v_mul_f32 v236, v155, v241
    v_mul_f32 v238, v187, v241
    v_fma_f32 v236, -v187, v242, v236
    v_fma_f32 v238, v155, v242, v238
    v_cvt_pk_bf16_f32 v95, v235, v236
    v_cvt_pk_bf16_f32 v111, v237, v238
    v_cvt_pk_bf16_f32 v127, -v237, -v238
    v_lshlrev_b32 v239, 16, v220
    v_and_b32 v240, 0xffff0000, v220
    v_mul_f32 v235, v156, v239
    v_mul_f32 v237, v188, v239
    v_fma_f32 v235, -v188, v240, v235
    v_fma_f32 v237, v156, v240, v237
    v_lshlrev_b32 v241, 16, v221
    v_and_b32 v242, 0xffff0000, v221
    v_mul_f32 v236, v157, v241
    v_mul_f32 v238, v189, v241
    v_fma_f32 v236, -v189, v242, v236
    v_fma_f32 v238, v157, v242, v238
    v_cvt_pk_bf16_f32 v96, v235, v236
    v_cvt_pk_bf16_f32 v112, v237, v238
    v_cvt_pk_bf16_f32 v128, -v237, -v238
    v_lshlrev_b32 v239, 16, v222
    v_and_b32 v240, 0xffff0000, v222
    v_mul_f32 v235, v158, v239
    v_mul_f32 v237, v190, v239
    v_fma_f32 v235, -v190, v240, v235
    v_fma_f32 v237, v158, v240, v237
    v_lshlrev_b32 v241, 16, v223
    v_and_b32 v242, 0xffff0000, v223
    v_mul_f32 v236, v159, v241
    v_mul_f32 v238, v191, v241
    v_fma_f32 v236, -v191, v242, v236
    v_fma_f32 v238, v159, v242, v238
    v_cvt_pk_bf16_f32 v97, v235, v236
    v_cvt_pk_bf16_f32 v113, v237, v238
    v_cvt_pk_bf16_f32 v129, -v237, -v238
    v_lshlrev_b32 v239, 16, v224
    v_and_b32 v240, 0xffff0000, v224
    v_mul_f32 v235, v160, v239
    v_mul_f32 v237, v192, v239
    v_fma_f32 v235, -v192, v240, v235
    v_fma_f32 v237, v160, v240, v237
    v_lshlrev_b32 v241, 16, v225
    v_and_b32 v242, 0xffff0000, v225
    v_mul_f32 v236, v161, v241
    v_mul_f32 v238, v193, v241
    v_fma_f32 v236, -v193, v242, v236
    v_fma_f32 v238, v161, v242, v238
    v_cvt_pk_bf16_f32 v98, v235, v236
    v_cvt_pk_bf16_f32 v114, v237, v238
    v_cvt_pk_bf16_f32 v130, -v237, -v238
    v_lshlrev_b32 v239, 16, v226
    v_and_b32 v240, 0xffff0000, v226
    v_mul_f32 v235, v162, v239
    v_mul_f32 v237, v194, v239
    v_fma_f32 v235, -v194, v240, v235
    v_fma_f32 v237, v162, v240, v237
    v_lshlrev_b32 v241, 16, v227
    v_and_b32 v242, 0xffff0000, v227
    v_mul_f32 v236, v163, v241
    v_mul_f32 v238, v195, v241
    v_fma_f32 v236, -v195, v242, v236
    v_fma_f32 v238, v163, v242, v238
    v_cvt_pk_bf16_f32 v99, v235, v236
    v_cvt_pk_bf16_f32 v115, v237, v238
    v_cvt_pk_bf16_f32 v131, -v237, -v238
    v_mfma_f32_32x32x16_bf16 v[132:147], v[84:87], v[4:7], 0
    v_mfma_f32_32x32x16_bf16 v[164:179], v[100:103], v[4:7], 0
    v_mfma_f32_32x32x16_bf16 v[132:147], v[116:119], v[36:39], v[132:147]
    v_mfma_f32_32x32x16_bf16 v[164:179], v[84:87], v[36:39], v[164:179]
    v_mfma_f32_32x32x16_bf16 v[132:147], v[88:91], v[8:11], v[132:147]
    v_mfma_f32_32x32x16_bf16 v[164:179], v[104:107], v[8:11], v[164:179]
    v_mfma_f32_32x32x16_bf16 v[132:147], v[120:123], v[40:43], v[132:147]
    v_mfma_f32_32x32x16_bf16 v[164:179], v[88:91], v[40:43], v[164:179]
    v_mfma_f32_32x32x16_bf16 v[132:147], v[92:95], v[12:15], v[132:147]
    v_mfma_f32_32x32x16_bf16 v[164:179], v[108:111], v[12:15], v[164:179]
    v_mfma_f32_32x32x16_bf16 v[132:147], v[124:127], v[44:47], v[132:147]
    v_mfma_f32_32x32x16_bf16 v[164:179], v[92:95], v[44:47], v[164:179]
    v_mfma_f32_32x32x16_bf16 v[132:147], v[96:99], v[16:19], v[132:147]
    v_mfma_f32_32x32x16_bf16 v[164:179], v[112:115], v[16:19], v[164:179]
    v_mfma_f32_32x32x16_bf16 v[132:147], v[128:131], v[48:51], v[132:147]
    v_mfma_f32_32x32x16_bf16 v[164:179], v[96:99], v[48:51], v[164:179]
    v_mfma_f32_32x32x16_bf16 v[148:163], v[84:87], v[20:23], 0
    v_mfma_f32_32x32x16_bf16 v[180:195], v[100:103], v[20:23], 0
    v_mfma_f32_32x32x16_bf16 v[148:163], v[116:119], v[52:55], v[148:163]
    v_mfma_f32_32x32x16_bf16 v[180:195], v[84:87], v[52:55], v[180:195]
    v_mfma_f32_32x32x16_bf16 v[148:163], v[88:91], v[24:27], v[148:163]
    v_mfma_f32_32x32x16_bf16 v[180:195], v[104:107], v[24:27], v[180:195]
    v_mfma_f32_32x32x16_bf16 v[148:163], v[120:123], v[56:59], v[148:163]
    v_mfma_f32_32x32x16_bf16 v[180:195], v[88:91], v[56:59], v[180:195]
    v_mfma_f32_32x32x16_bf16 v[148:163], v[92:95], v[28:31], v[148:163]
    v_mfma_f32_32x32x16_bf16 v[180:195], v[108:111], v[28:31], v[180:195]
    v_mfma_f32_32x32x16_bf16 v[148:163], v[124:127], v[60:63], v[148:163]
    v_mfma_f32_32x32x16_bf16 v[180:195], v[92:95], v[60:63], v[180:195]
    v_mfma_f32_32x32x16_bf16 v[148:163], v[96:99], v[32:35], v[148:163]
    v_mfma_f32_32x32x16_bf16 v[180:195], v[112:115], v[32:35], v[180:195]
    v_mfma_f32_32x32x16_bf16 v[148:163], v[128:131], v[64:67], v[148:163]
    v_mfma_f32_32x32x16_bf16 v[180:195], v[96:99], v[64:67], v[180:195]
    v_fmamk_f32 v243, v228, 0x0, v229
    v_cos_f32 v239, v243
    v_sin_f32 v240, v243
    v_mul_f32 v235, v132, v239
    v_mul_f32 v237, v164, v239
    v_fma_f32 v235, -v164, v240, v235
    v_fma_f32 v237, v132, v240, v237
    v_fmamk_f32 v243, v228, 0x3a000000, v229
    v_cos_f32 v241, v243
    v_sin_f32 v242, v243
    v_mul_f32 v236, v133, v241
    v_mul_f32 v238, v165, v241
    v_fma_f32 v236, -v165, v242, v236
    v_fma_f32 v238, v133, v242, v238
    v_cvt_pk_bf16_f32 v84, v235, v236
    v_cvt_pk_bf16_f32 v100, v237, v238
    v_cvt_pk_bf16_f32 v116, -v237, -v238
    v_fmamk_f32 v243, v228, 0x3a800000, v229
    v_cos_f32 v239, v243
    v_sin_f32 v240, v243
    v_mul_f32 v235, v134, v239
    v_mul_f32 v237, v166, v239
    v_fma_f32 v235, -v166, v240, v235
    v_fma_f32 v237, v134, v240, v237
    v_fmamk_f32 v243, v228, 0x3ac00000, v229
    v_cos_f32 v241, v243
    v_sin_f32 v242, v243
    v_mul_f32 v236, v135, v241
    v_mul_f32 v238, v167, v241
    v_fma_f32 v236, -v167, v242, v236
    v_fma_f32 v238, v135, v242, v238
    v_cvt_pk_bf16_f32 v85, v235, v236
    v_cvt_pk_bf16_f32 v101, v237, v238
    v_cvt_pk_bf16_f32 v117, -v237, -v238
    v_fmamk_f32 v243, v228, 0x3b800000, v229
    v_cos_f32 v239, v243
    v_sin_f32 v240, v243
    v_mul_f32 v235, v136, v239
    v_mul_f32 v237, v168, v239
    v_fma_f32 v235, -v168, v240, v235
    v_fma_f32 v237, v136, v240, v237
    v_fmamk_f32 v243, v228, 0x3b900000, v229
    v_cos_f32 v241, v243
    v_sin_f32 v242, v243
    v_mul_f32 v236, v137, v241
    v_mul_f32 v238, v169, v241
    v_fma_f32 v236, -v169, v242, v236
    v_fma_f32 v238, v137, v242, v238
    v_cvt_pk_bf16_f32 v86, v235, v236
    v_cvt_pk_bf16_f32 v102, v237, v238
    v_cvt_pk_bf16_f32 v118, -v237, -v238
    v_fmamk_f32 v243, v228, 0x3ba00000, v229
    v_cos_f32 v239, v243
    v_sin_f32 v240, v243
    v_mul_f32 v235, v138, v239
    v_mul_f32 v237, v170, v239
    v_fma_f32 v235, -v170, v240, v235
    v_fma_f32 v237, v138, v240, v237
    v_fmamk_f32 v243, v228, 0x3bb00000, v229
    v_cos_f32 v241, v243
    v_sin_f32 v242, v243
    v_mul_f32 v236, v139, v241
    v_mul_f32 v238, v171, v241
    v_fma_f32 v236, -v171, v242, v236
    v_fma_f32 v238, v139, v242, v238
    v_cvt_pk_bf16_f32 v87, v235, v236
    v_cvt_pk_bf16_f32 v103, v237, v238
    v_cvt_pk_bf16_f32 v119, -v237, -v238
    v_fmamk_f32 v243, v228, 0x3c000000, v229
    v_cos_f32 v239, v243
    v_sin_f32 v240, v243
    v_mul_f32 v235, v140, v239
    v_mul_f32 v237, v172, v239
    v_fma_f32 v235, -v172, v240, v235
    v_fma_f32 v237, v140, v240, v237
    v_fmamk_f32 v243, v228, 0x3c080000, v229
    v_cos_f32 v241, v243
    v_sin_f32 v242, v243
    v_mul_f32 v236, v141, v241
    v_mul_f32 v238, v173, v241
    v_fma_f32 v236, -v173, v242, v236
    v_fma_f32 v238, v141, v242, v238
    v_cvt_pk_bf16_f32 v88, v235, v236
    v_cvt_pk_bf16_f32 v104, v237, v238
    v_cvt_pk_bf16_f32 v120, -v237, -v238
    v_fmamk_f32 v243, v228, 0x3c100000, v229
    v_cos_f32 v239, v243
    v_sin_f32 v240, v243
    v_mul_f32 v235, v142, v239
    v_mul_f32 v237, v174, v239
    v_fma_f32 v235, -v174, v240, v235
    v_fma_f32 v237, v142, v240, v237
    v_fmamk_f32 v243, v228, 0x3c180000, v229
    v_cos_f32 v241, v243
    v_sin_f32 v242, v243
    v_mul_f32 v236, v143, v241
    v_mul_f32 v238, v175, v241
    v_fma_f32 v236, -v175, v242, v236
    v_fma_f32 v238, v143, v242, v238
    v_cvt_pk_bf16_f32 v89, v235, v236
    v_cvt_pk_bf16_f32 v105, v237, v238
    v_cvt_pk_bf16_f32 v121, -v237, -v238
    v_fmamk_f32 v243, v228, 0x3c400000, v229
    v_cos_f32 v239, v243
    v_sin_f32 v240, v243
    v_mul_f32 v235, v144, v239
    v_mul_f32 v237, v176, v239
    v_fma_f32 v235, -v176, v240, v235
    v_fma_f32 v237, v144, v240, v237
    v_fmamk_f32 v243, v228, 0x3c480000, v229
    v_cos_f32 v241, v243
    v_sin_f32 v242, v243
    v_mul_f32 v236, v145, v241
    v_mul_f32 v238, v177, v241
    v_fma_f32 v236, -v177, v242, v236
    v_fma_f32 v238, v145, v242, v238
    v_cvt_pk_bf16_f32 v90, v235, v236
    v_cvt_pk_bf16_f32 v106, v237, v238
    v_cvt_pk_bf16_f32 v122, -v237, -v238
    v_fmamk_f32 v243, v228, 0x3c500000, v229
    v_cos_f32 v239, v243
    v_sin_f32 v240, v243
    v_mul_f32 v235, v146, v239
    v_mul_f32 v237, v178, v239
    v_fma_f32 v235, -v178, v240, v235
    v_fma_f32 v237, v146, v240, v237
    v_fmamk_f32 v243, v228, 0x3c580000, v229
    v_cos_f32 v241, v243
    v_sin_f32 v242, v243
    v_mul_f32 v236, v147, v241
    v_mul_f32 v238, v179, v241
    v_fma_f32 v236, -v179, v242, v236
    v_fma_f32 v238, v147, v242, v238
    v_cvt_pk_bf16_f32 v91, v235, v236
    v_cvt_pk_bf16_f32 v107, v237, v238
    v_cvt_pk_bf16_f32 v123, -v237, -v238
    v_add_f32 v228, 0x42000000, v228
    v_mov_b32 v229, v230
    v_fmamk_f32 v243, v228, 0x0, v229
    v_cos_f32 v239, v243
    v_sin_f32 v240, v243
    v_mul_f32 v235, v148, v239
    v_mul_f32 v237, v180, v239
    v_fma_f32 v235, -v180, v240, v235
    v_fma_f32 v237, v148, v240, v237
    v_fmamk_f32 v243, v228, 0x3a000000, v229
    v_cos_f32 v241, v243
    v_sin_f32 v242, v243
    v_mul_f32 v236, v149, v241
    v_mul_f32 v238, v181, v241
    v_fma_f32 v236, -v181, v242, v236
    v_fma_f32 v238, v149, v242, v238
    v_cvt_pk_bf16_f32 v92, v235, v236
    v_cvt_pk_bf16_f32 v108, v237, v238
    v_cvt_pk_bf16_f32 v124, -v237, -v238
    v_fmamk_f32 v243, v228, 0x3a800000, v229
    v_cos_f32 v239, v243
    v_sin_f32 v240, v243
    v_mul_f32 v235, v150, v239
    v_mul_f32 v237, v182, v239
    v_fma_f32 v235, -v182, v240, v235
    v_fma_f32 v237, v150, v240, v237
    v_fmamk_f32 v243, v228, 0x3ac00000, v229
    v_cos_f32 v241, v243
    v_sin_f32 v242, v243
    v_mul_f32 v236, v151, v241
    v_mul_f32 v238, v183, v241
    v_fma_f32 v236, -v183, v242, v236
    v_fma_f32 v238, v151, v242, v238
    v_cvt_pk_bf16_f32 v93, v235, v236
    v_cvt_pk_bf16_f32 v109, v237, v238
    v_cvt_pk_bf16_f32 v125, -v237, -v238
    v_fmamk_f32 v243, v228, 0x3b800000, v229
    v_cos_f32 v239, v243
    v_sin_f32 v240, v243
    v_mul_f32 v235, v152, v239
    v_mul_f32 v237, v184, v239
    v_fma_f32 v235, -v184, v240, v235
    v_fma_f32 v237, v152, v240, v237
    v_fmamk_f32 v243, v228, 0x3b900000, v229
    v_cos_f32 v241, v243
    v_sin_f32 v242, v243
    v_mul_f32 v236, v153, v241
    v_mul_f32 v238, v185, v241
    v_fma_f32 v236, -v185, v242, v236
    v_fma_f32 v238, v153, v242, v238
    v_cvt_pk_bf16_f32 v94, v235, v236
    v_cvt_pk_bf16_f32 v110, v237, v238
    v_cvt_pk_bf16_f32 v126, -v237, -v238
    v_fmamk_f32 v243, v228, 0x3ba00000, v229
    v_cos_f32 v239, v243
    v_sin_f32 v240, v243
    v_mul_f32 v235, v154, v239
    v_mul_f32 v237, v186, v239
    v_fma_f32 v235, -v186, v240, v235
    v_fma_f32 v237, v154, v240, v237
    v_fmamk_f32 v243, v228, 0x3bb00000, v229
    v_cos_f32 v241, v243
    v_sin_f32 v242, v243
    v_mul_f32 v236, v155, v241
    v_mul_f32 v238, v187, v241
    v_fma_f32 v236, -v187, v242, v236
    v_fma_f32 v238, v155, v242, v238
    v_cvt_pk_bf16_f32 v95, v235, v236
    v_cvt_pk_bf16_f32 v111, v237, v238
    v_cvt_pk_bf16_f32 v127, -v237, -v238
    v_fmamk_f32 v243, v228, 0x3c000000, v229
    v_cos_f32 v239, v243
    v_sin_f32 v240, v243
    v_mul_f32 v235, v156, v239
    v_mul_f32 v237, v188, v239
    v_fma_f32 v235, -v188, v240, v235
    v_fma_f32 v237, v156, v240, v237
    v_fmamk_f32 v243, v228, 0x3c080000, v229
    v_cos_f32 v241, v243
    v_sin_f32 v242, v243
    v_mul_f32 v236, v157, v241
    v_mul_f32 v238, v189, v241
    v_fma_f32 v236, -v189, v242, v236
    v_fma_f32 v238, v157, v242, v238
    v_cvt_pk_bf16_f32 v96, v235, v236
    v_cvt_pk_bf16_f32 v112, v237, v238
    v_cvt_pk_bf16_f32 v128, -v237, -v238
    v_fmamk_f32 v243, v228, 0x3c100000, v229
    v_cos_f32 v239, v243
    v_sin_f32 v240, v243
    v_mul_f32 v235, v158, v239
    v_mul_f32 v237, v190, v239
    v_fma_f32 v235, -v190, v240, v235
    v_fma_f32 v237, v158, v240, v237
    v_fmamk_f32 v243, v228, 0x3c180000, v229
    v_cos_f32 v241, v243
    v_sin_f32 v242, v243
    v_mul_f32 v236, v159, v241
    v_mul_f32 v238, v191, v241
    v_fma_f32 v236, -v191, v242, v236
    v_fma_f32 v238, v159, v242, v238
    v_cvt_pk_bf16_f32 v97, v235, v236
    v_cvt_pk_bf16_f32 v113, v237, v238
    v_cvt_pk_bf16_f32 v129, -v237, -v238
    v_fmamk_f32 v243, v228, 0x3c400000, v229
    v_cos_f32 v239, v243
    v_sin_f32 v240, v243
    v_mul_f32 v235, v160, v239
    v_mul_f32 v237, v192, v239
    v_fma_f32 v235, -v192, v240, v235
    v_fma_f32 v237, v160, v240, v237
    v_fmamk_f32 v243, v228, 0x3c480000, v229
    v_cos_f32 v241, v243
    v_sin_f32 v242, v243
    v_mul_f32 v236, v161, v241
    v_mul_f32 v238, v193, v241
    v_fma_f32 v236, -v193, v242, v236
    v_fma_f32 v238, v161, v242, v238
    v_cvt_pk_bf16_f32 v98, v235, v236
    v_cvt_pk_bf16_f32 v114, v237, v238
    v_cvt_pk_bf16_f32 v130, -v237, -v238
    v_fmamk_f32 v243, v228, 0x3c500000, v229
    v_cos_f32 v239, v243
    v_sin_f32 v240, v243
    v_mul_f32 v235, v162, v239
    v_mul_f32 v237, v194, v239
    v_fma_f32 v235, -v194, v240, v235
    v_fma_f32 v237, v162, v240, v237
    v_fmamk_f32 v243, v228, 0x3c580000, v229
    v_cos_f32 v241, v243
    v_sin_f32 v242, v243
    v_mul_f32 v236, v163, v241
    v_mul_f32 v238, v195, v241
    v_fma_f32 v236, -v195, v242, v236
    v_fma_f32 v238, v163, v242, v238
    v_cvt_pk_bf16_f32 v99, v235, v236
    v_cvt_pk_bf16_f32 v115, v237, v238
    v_cvt_pk_bf16_f32 v131, -v237, -v238
    v_mfma_f32_32x32x16_bf16 v[132:147], v[68:71], v[84:87], 0
    v_mfma_f32_32x32x16_bf16 v[164:179], v[68:71], v[100:103], 0
    v_mfma_f32_32x32x16_bf16 v[132:147], v[76:79], v[116:119], v[132:147]
    v_mfma_f32_32x32x16_bf16 v[164:179], v[76:79], v[84:87], v[164:179]
    v_mfma_f32_32x32x16_bf16 v[132:147], v[72:75], v[88:91], v[132:147]
    v_mfma_f32_32x32x16_bf16 v[164:179], v[72:75], v[104:107], v[164:179]
    v_mfma_f32_32x32x16_bf16 v[132:147], v[80:83], v[120:123], v[132:147]
    v_mfma_f32_32x32x16_bf16 v[164:179], v[80:83], v[88:91], v[164:179]
    v_mfma_f32_32x32x16_bf16 v[148:163], v[68:71], v[92:95], 0
    v_mfma_f32_32x32x16_bf16 v[180:195], v[68:71], v[108:111], 0
    v_mfma_f32_32x32x16_bf16 v[148:163], v[76:79], v[124:127], v[148:163]
    v_mfma_f32_32x32x16_bf16 v[180:195], v[76:79], v[92:95], v[180:195]
    v_mfma_f32_32x32x16_bf16 v[148:163], v[72:75], v[96:99], v[148:163]
    v_mfma_f32_32x32x16_bf16 v[180:195], v[72:75], v[112:115], v[180:195]
    v_mfma_f32_32x32x16_bf16 v[148:163], v[80:83], v[128:131], v[148:163]
    v_mfma_f32_32x32x16_bf16 v[180:195], v[80:83], v[96:99], v[180:195]
    v_lshlrev_b32 v231, 4, v1
    v_add_u32 v232, s6, v231
    s_lshl_b32 s5, s3, 12
    s_add_u32 s5, s5, 0x5800000
    s_add_u32 s2, s5, 4096
    v_cvt_pk_bf16_f32 v84, v132, v133
    v_cvt_pk_bf16_f32 v85, v134, v135
    v_cvt_pk_bf16_f32 v86, v136, v137
    v_cvt_pk_bf16_f32 v87, v138, v139
    buffer_store_dwordx4 v[84:87], v231, s[8:11], s5 offen offset:0 sc1
    v_cvt_pk_bf16_f32 v88, v140, v141
    v_cvt_pk_bf16_f32 v89, v142, v143
    v_cvt_pk_bf16_f32 v90, v144, v145
    v_cvt_pk_bf16_f32 v91, v146, v147
    buffer_store_dwordx4 v[88:91], v231, s[8:11], s5 offen offset:1024 sc1
    v_cvt_pk_bf16_f32 v92, v148, v149
    v_cvt_pk_bf16_f32 v93, v150, v151
    v_cvt_pk_bf16_f32 v94, v152, v153
    v_cvt_pk_bf16_f32 v95, v154, v155
    buffer_store_dwordx4 v[92:95], v231, s[8:11], s5 offen offset:2048 sc1
    v_cvt_pk_bf16_f32 v96, v156, v157
    v_cvt_pk_bf16_f32 v97, v158, v159
    v_cvt_pk_bf16_f32 v98, v160, v161
    v_cvt_pk_bf16_f32 v99, v162, v163
    buffer_store_dwordx4 v[96:99], v231, s[8:11], s5 offen offset:3072 sc1
    v_cvt_pk_bf16_f32 v100, v164, v165
    v_cvt_pk_bf16_f32 v101, v166, v167
    v_cvt_pk_bf16_f32 v102, v168, v169
    v_cvt_pk_bf16_f32 v103, v170, v171
    buffer_store_dwordx4 v[100:103], v232, s[8:11], s2 offen offset:0 sc1
    v_cvt_pk_bf16_f32 v104, v172, v173
    v_cvt_pk_bf16_f32 v105, v174, v175
    v_cvt_pk_bf16_f32 v106, v176, v177
    v_cvt_pk_bf16_f32 v107, v178, v179
    buffer_store_dwordx4 v[104:107], v232, s[8:11], s2 offen offset:1024 sc1
    v_cvt_pk_bf16_f32 v108, v180, v181
    v_cvt_pk_bf16_f32 v109, v182, v183
    v_cvt_pk_bf16_f32 v110, v184, v185
    v_cvt_pk_bf16_f32 v111, v186, v187
    buffer_store_dwordx4 v[108:111], v232, s[8:11], s2 offen offset:2048 sc1
    v_cvt_pk_bf16_f32 v112, v188, v189
    v_cvt_pk_bf16_f32 v113, v190, v191
    v_cvt_pk_bf16_f32 v114, v192, v193
    v_cvt_pk_bf16_f32 v115, v194, v195
    buffer_store_dwordx4 v[112:115], v232, s[8:11], s2 offen offset:3072 sc1
    s_add_u32 s7, s7, 8
    s_cmp_lt_u32 s7, 16
    s_cbranch_scc1 colloop_88
    s_cmp_eq_u32 s3, 1008
    s_cbranch_scc1 colloop_88
    s_mov_b32 s83, 44
    s_branch next_46
p3_71:
    s_mov_b32 s84, 0
    s_mov_b64 s[60:61], s[8:9]
    s_mov_b32 s62, 0x10000000
    s_mov_b32 s63, 0x20000
    s_mov_b64 s[64:65], s[8:9]
    s_mov_b32 s66, 0x10000000
    s_mov_b32 s67, 0x20000
    v_lshrrev_b32 v76, 4, v1
    v_sub_u32 v76, 0, v76
    v_xor_b32 v76, v76, v1
    v_and_b32 v76, 3, v76
    s_mul_i32 s74, s58, 32
    v_lshrrev_b32 v77, 2, v1
    v_add3_u32 v77, v77, s74, 0
    v_bfe_u32 v68, v77, 0, 2
    v_lshlrev_b32 v68, 11, v68
    v_bfe_u32 v75, v77, 4, 1
    v_lshl_or_b32 v68, v75, 13, v68
    v_bfe_u32 v75, v77, 2, 2
    v_lshl_or_b32 v68, v75, 14, v68
    v_bfe_u32 v75, v77, 5, 3
    v_lshl_or_b32 v68, v75, 16, v68
    v_lshl_add_u32 v68, v76, 4, v68
    v_lshrrev_b32 v77, 2, v1
    v_add3_u32 v77, v77, s74, 16
    v_bfe_u32 v69, v77, 0, 2
    v_lshlrev_b32 v69, 11, v69
    v_bfe_u32 v75, v77, 4, 1
    v_lshl_or_b32 v69, v75, 13, v69
    v_bfe_u32 v75, v77, 2, 2
    v_lshl_or_b32 v69, v75, 14, v69
    v_bfe_u32 v75, v77, 5, 3
    v_lshl_or_b32 v69, v75, 16, v69
    v_lshl_add_u32 v69, v76, 4, v69
    s_and_b32 s74, s58, 2
    v_bfe_u32 v76, v1, 0, 5
    v_bfe_u32 v77, v1, 5, 1
    v_lshlrev_b32 v77, 2, v77
    v_xor_b32 v76, v76, v77
    v_xor_b32 v76, s74, v76
    v_lshlrev_b32 v77, 4, v76
    v_lshrrev_b32 v76, 5, v1
    v_lshl_add_u32 v70, v76, 12, v77
    v_bfe_u32 v76, v1, 0, 5
    v_bfe_u32 v77, v1, 5, 1
    v_lshlrev_b32 v77, 2, v77
    v_xor_b32 v76, v76, v77
    v_xor_b32 v76, s74, v76
    v_xor_b32 v76, 8, v76
    v_lshlrev_b32 v77, 4, v76
    v_lshrrev_b32 v76, 5, v1
    v_lshl_add_u32 v71, v76, 12, v77
    v_add_u32 v71, 8192, v71
    s_lshl_b32 s74, s58, 14
    v_add_u32 v70, s74, v70
    v_add_u32 v71, s74, v71
    s_mov_b32 s70, 131072
    s_and_b32 s79, s57, 3
    s_bfe_u32 s80, s76, 0x10002
    s_bfe_u32 s85, s76, 0x20005
    s_lshl_b32 s85, s85, 1
    s_or_b32 s80, s80, s85
    s_lshl_b32 s68, s79, 19
    s_add_u32 s68, s68, 0x5200000
    s_lshl_b32 s69, s80, 9
    s_add_u32 s69, s69, 0x5800000
    s_cmp_lg_u32 s58, 0
    s_cbranch_scc1 wall_90
    v_mov_b32 v76, 44
wctr_91:
    buffer_load_dword v75, v76, s[12:15], 0 offen sc1
    s_waitcnt vmcnt(0)
    v_cmp_gt_u16 vcc, 32, v75
    s_cbranch_vccz wctr_ok_92
    s_sub_u32 s77, s77, 1
    s_cbranch_scc0 wctr_91
    s_mov_b32 s77, 0
wctr_ok_92:
wall_90:
    s_barrier
    s_mul_i32 s71, s58, 2048
    s_mov_b32 m0, s71
    s_nop 0
    buffer_load_dwordx4 v68, s[60:63], s68 offen lds
    s_add_u32 m0, s71, 1024
    s_nop 0
    buffer_load_dwordx4 v69, s[60:63], s68 offen lds
    s_add_u32 m0, s71, 16384
    s_nop 0
    buffer_load_dwordx4 v70, s[64:67], s69 offen lds
    s_add_u32 m0, s71, 17408
    s_nop 0
    buffer_load_dwordx4 v71, s[64:67], s69 offen lds
    s_add_u32 s68, s68, 64
    s_add_u32 s69, s69, s70
    s_add_u32 s71, s71, 32768
    s_and_b32 s71, s71, 0x1ffff
    s_mov_b32 m0, s71
    s_nop 0
    buffer_load_dwordx4 v68, s[60:63], s68 offen lds
    s_add_u32 m0, s71, 1024
    s_nop 0
    buffer_load_dwordx4 v69, s[60:63], s68 offen lds
    s_add_u32 m0, s71, 16384
    s_nop 0
    buffer_load_dwordx4 v70, s[64:67], s69 offen lds
    s_add_u32 m0, s71, 17408
    s_nop 0
    buffer_load_dwordx4 v71, s[64:67], s69 offen lds
    s_add_u32 s68, s68, 64
    s_add_u32 s69, s69, s70
    s_add_u32 s71, s71, 32768
    s_and_b32 s71, s71, 0x1ffff
    s_mov_b32 m0, s71
    s_nop 0
    buffer_load_dwordx4 v68, s[60:63], s68 offen lds
    s_add_u32 m0, s71, 1024
    s_nop 0
    buffer_load_dwordx4 v69, s[60:63], s68 offen lds
    s_add_u32 m0, s71, 16384
    s_nop 0
    buffer_load_dwordx4 v70, s[64:67], s69 offen lds
    s_add_u32 m0, s71, 17408
    s_nop 0
    buffer_load_dwordx4 v71, s[64:67], s69 offen lds
    s_add_u32 s68, s68, 64
    s_add_u32 s69, s69, s70
    s_add_u32 s71, s71, 32768
    s_and_b32 s71, s71, 0x1ffff
    s_mov_b32 m0, s71
    s_nop 0
    buffer_load_dwordx4 v68, s[60:63], s68 offen lds
    s_add_u32 m0, s71, 1024
    s_nop 0
    buffer_load_dwordx4 v69, s[60:63], s68 offen lds
    s_add_u32 m0, s71, 16384
    s_nop 0
    buffer_load_dwordx4 v70, s[64:67], s69 offen lds
    s_add_u32 m0, s71, 17408
    s_nop 0
    buffer_load_dwordx4 v71, s[64:67], s69 offen lds
    s_add_u32 s68, s68, 64
    s_add_u32 s69, s69, s70
    s_add_u32 s71, s71, 32768
    s_and_b32 s71, s71, 0x1ffff
    s_branch t256_45
p3e_48:
    s_lshl_b32 s85, s80, 2
    s_and_b32 s81, s58, 3
    s_add_u32 s85, s85, s81
    s_lshl_b32 s85, s85, 6
    v_and_b32 v77, 15, v1
    v_add_u32 v77, s85, v77
    v_bfe_u32 v76, v77, 3, 5
    v_lshlrev_b32 v76, 12, v76
    v_bfe_u32 v75, v77, 10, 1
    v_lshl_or_b32 v76, v75, 17, v76
    v_bfe_u32 v75, v77, 0, 2
    v_lshl_or_b32 v76, v75, 18, v76
    v_bfe_u32 v75, v77, 8, 1
    v_lshl_or_b32 v76, v75, 20, v76
    v_bfe_u32 v75, v77, 2, 1
    v_lshl_or_b32 v76, v75, 21, v76
    v_bfe_u32 v75, v77, 9, 1
    v_lshl_or_b32 v76, v75, 22, v76
    v_bfe_u32 v77, v1, 4, 2
    v_lshlrev_b32 v77, 4, v77
    v_add_u32 v76, v76, v77
    s_lshl_b32 s81, s79, 9
    s_lshr_b32 s85, s58, 2
    s_lshl_b32 s85, s85, 8
    s_add_u32 s81, s81, s85
    v_cvt_pk_bf16_f32 v4, v80, v81
    v_cvt_pk_bf16_f32 v5, v82, v83
    v_cvt_pk_bf16_f32 v6, v96, v97
    v_cvt_pk_bf16_f32 v7, v98, v99
    buffer_store_dwordx4 v[4:7], v76, s[16:19], s81 offen offset:0
    v_cvt_pk_bf16_f32 v8, v112, v113
    v_cvt_pk_bf16_f32 v9, v114, v115
    v_cvt_pk_bf16_f32 v10, v128, v129
    v_cvt_pk_bf16_f32 v11, v130, v131
    buffer_store_dwordx4 v[8:11], v76, s[16:19], s81 offen offset:64
    v_cvt_pk_bf16_f32 v12, v144, v145
    v_cvt_pk_bf16_f32 v13, v146, v147
    v_cvt_pk_bf16_f32 v14, v160, v161
    v_cvt_pk_bf16_f32 v15, v162, v163
    buffer_store_dwordx4 v[12:15], v76, s[16:19], s81 offen offset:128
    v_cvt_pk_bf16_f32 v16, v176, v177
    v_cvt_pk_bf16_f32 v17, v178, v179
    v_cvt_pk_bf16_f32 v18, v192, v193
    v_cvt_pk_bf16_f32 v19, v194, v195
    buffer_store_dwordx4 v[16:19], v76, s[16:19], s81 offen offset:192
    s_add_u32 s81, s81, 8192
    v_cvt_pk_bf16_f32 v20, v84, v85
    v_cvt_pk_bf16_f32 v21, v86, v87
    v_cvt_pk_bf16_f32 v22, v100, v101
    v_cvt_pk_bf16_f32 v23, v102, v103
    buffer_store_dwordx4 v[20:23], v76, s[16:19], s81 offen offset:0
    v_cvt_pk_bf16_f32 v24, v116, v117
    v_cvt_pk_bf16_f32 v25, v118, v119
    v_cvt_pk_bf16_f32 v26, v132, v133
    v_cvt_pk_bf16_f32 v27, v134, v135
    buffer_store_dwordx4 v[24:27], v76, s[16:19], s81 offen offset:64
    v_cvt_pk_bf16_f32 v28, v148, v149
    v_cvt_pk_bf16_f32 v29, v150, v151
    v_cvt_pk_bf16_f32 v30, v164, v165
    v_cvt_pk_bf16_f32 v31, v166, v167
    buffer_store_dwordx4 v[28:31], v76, s[16:19], s81 offen offset:128
    v_cvt_pk_bf16_f32 v32, v180, v181
    v_cvt_pk_bf16_f32 v33, v182, v183
    v_cvt_pk_bf16_f32 v34, v196, v197
    v_cvt_pk_bf16_f32 v35, v198, v199
    buffer_store_dwordx4 v[32:35], v76, s[16:19], s81 offen offset:192
    s_add_u32 s81, s81, 8192
    v_cvt_pk_bf16_f32 v36, v88, v89
    v_cvt_pk_bf16_f32 v37, v90, v91
    v_cvt_pk_bf16_f32 v38, v104, v105
    v_cvt_pk_bf16_f32 v39, v106, v107
    buffer_store_dwordx4 v[36:39], v76, s[16:19], s81 offen offset:0
    v_cvt_pk_bf16_f32 v40, v120, v121
    v_cvt_pk_bf16_f32 v41, v122, v123
    v_cvt_pk_bf16_f32 v42, v136, v137
    v_cvt_pk_bf16_f32 v43, v138, v139
    buffer_store_dwordx4 v[40:43], v76, s[16:19], s81 offen offset:64
    v_cvt_pk_bf16_f32 v44, v152, v153
    v_cvt_pk_bf16_f32 v45, v154, v155
    v_cvt_pk_bf16_f32 v46, v168, v169
    v_cvt_pk_bf16_f32 v47, v170, v171
    buffer_store_dwordx4 v[44:47], v76, s[16:19], s81 offen offset:128
    v_cvt_pk_bf16_f32 v48, v184, v185
    v_cvt_pk_bf16_f32 v49, v186, v187
    v_cvt_pk_bf16_f32 v50, v200, v201
    v_cvt_pk_bf16_f32 v51, v202, v203
    buffer_store_dwordx4 v[48:51], v76, s[16:19], s81 offen offset:192
    s_add_u32 s81, s81, 8192
    v_cvt_pk_bf16_f32 v52, v92, v93
    v_cvt_pk_bf16_f32 v53, v94, v95
    v_cvt_pk_bf16_f32 v54, v108, v109
    v_cvt_pk_bf16_f32 v55, v110, v111
    buffer_store_dwordx4 v[52:55], v76, s[16:19], s81 offen offset:0
    v_cvt_pk_bf16_f32 v56, v124, v125
    v_cvt_pk_bf16_f32 v57, v126, v127
    v_cvt_pk_bf16_f32 v58, v140, v141
    v_cvt_pk_bf16_f32 v59, v142, v143
    buffer_store_dwordx4 v[56:59], v76, s[16:19], s81 offen offset:64
    v_cvt_pk_bf16_f32 v60, v156, v157
    v_cvt_pk_bf16_f32 v61, v158, v159
    v_cvt_pk_bf16_f32 v62, v172, v173
    v_cvt_pk_bf16_f32 v63, v174, v175
    buffer_store_dwordx4 v[60:63], v76, s[16:19], s81 offen offset:128
    v_cvt_pk_bf16_f32 v64, v188, v189
    v_cvt_pk_bf16_f32 v65, v190, v191
    v_cvt_pk_bf16_f32 v66, v204, v205
    v_cvt_pk_bf16_f32 v67, v206, v207
    buffer_store_dwordx4 v[64:67], v76, s[16:19], s81 offen offset:192
    s_add_u32 s81, s81, 8192
    s_branch end_76
r5_77:
    s_cmp_lt_u32 s57, 16
    s_cbranch_scc1 end_76
fol_73:
    s_bitcmp1_b32 s57, 3
    s_cbranch_scc1 nowo_93
    v_bfe_u32 v2, v1, 4, 2
    v_lshlrev_b32 v2, 2, v2
    v_xor_b32 v2, v2, v1
    v_bfe_u32 v4, v2, 0, 4
    v_lshlrev_b32 v4, 4, v4
    v_bfe_u32 v3, v2, 4, 2
    v_lshl_or_b32 v4, v3, 11, v4
    s_bfe_u32 s2, s58, 0x20000
    s_lshl_b32 s2, s2, 17
    s_bfe_u32 s4, s58, 0x10002
    s_lshl_b32 s4, s4, 20
    s_or_b32 s2, s2, s4
    s_lshl_b32 s4, s75, 21
    s_add_u32 s2, s2, s4
    s_bfe_u32 s4, s57, 0x30000
    s_lshl_b32 s4, s4, 8
    s_add_u32 s2, s2, s4
    s_lshl_b32 s3, s58, 14
    s_add_u32 m0, s3, 0
    s_nop 0
    buffer_load_dwordx4 v4, s[32:35], s2 offen lds
    s_add_u32 s2, s2, 0x2000
    s_add_u32 m0, s3, 1024
    s_nop 0
    buffer_load_dwordx4 v4, s[32:35], s2 offen lds
    s_add_u32 s2, s2, 0x2000
    s_add_u32 m0, s3, 2048
    s_nop 0
    buffer_load_dwordx4 v4, s[32:35], s2 offen lds
    s_add_u32 s2, s2, 0x2000
    s_add_u32 m0, s3, 3072
    s_nop 0
    buffer_load_dwordx4 v4, s[32:35], s2 offen lds
    s_add_u32 s2, s2, 0x2000
    s_add_u32 m0, s3, 4096
    s_nop 0
    buffer_load_dwordx4 v4, s[32:35], s2 offen lds
    s_add_u32 s2, s2, 0x2000
    s_add_u32 m0, s3, 5120
    s_nop 0
    buffer_load_dwordx4 v4, s[32:35], s2 offen lds
    s_add_u32 s2, s2, 0x2000
    s_add_u32 m0, s3, 6144
    s_nop 0
    buffer_load_dwordx4 v4, s[32:35], s2 offen lds
    s_add_u32 s2, s2, 0x2000
    s_add_u32 m0, s3, 7168
    s_nop 0
    buffer_load_dwordx4 v4, s[32:35], s2 offen lds
    s_add_u32 s2, s2, 0x2000
    s_add_u32 m0, s3, 8192
    s_nop 0
    buffer_load_dwordx4 v4, s[32:35], s2 offen lds
    s_add_u32 s2, s2, 0x2000
    s_add_u32 m0, s3, 9216
    s_nop 0
    buffer_load_dwordx4 v4, s[32:35], s2 offen lds
    s_add_u32 s2, s2, 0x2000
    s_add_u32 m0, s3, 10240
    s_nop 0
    buffer_load_dwordx4 v4, s[32:35], s2 offen lds
    s_add_u32 s2, s2, 0x2000
    s_add_u32 m0, s3, 11264
    s_nop 0
    buffer_load_dwordx4 v4, s[32:35], s2 offen lds
    s_add_u32 s2, s2, 0x2000
    s_add_u32 m0, s3, 12288
    s_nop 0
    buffer_load_dwordx4 v4, s[32:35], s2 offen lds
    s_add_u32 s2, s2, 0x2000
    s_add_u32 m0, s3, 13312
    s_nop 0
    buffer_load_dwordx4 v4, s[32:35], s2 offen lds
    s_add_u32 s2, s2, 0x2000
    s_add_u32 m0, s3, 14336
    s_nop 0
    buffer_load_dwordx4 v4, s[32:35], s2 offen lds
    s_add_u32 s2, s2, 0x2000
    s_add_u32 m0, s3, 15360
    s_nop 0
    buffer_load_dwordx4 v4, s[32:35], s2 offen lds
    s_add_u32 s2, s2, 0x2000
nowo_93:
    v_mov_b32 v75, 163760
    v_mov_b32 v76, 0
    ds_write_b32 v75, v76
    s_waitcnt lgkmcnt(0)
    s_cmp_lg_u32 s58, 0
    s_cbranch_scc1 wall_94
    v_mov_b32 v76, 144
wctr_95:
    buffer_load_dword v75, v76, s[12:15], 0 offen sc1
    s_waitcnt vmcnt(0)
    v_cmp_gt_u16 vcc, 128, v75
    s_cbranch_vccz wctr_ok_96
    s_sub_u32 s77, s77, 1
    s_cbranch_scc0 wctr_95
    s_mov_b32 s77, 0
wctr_ok_96:
wall_94:
    s_cmp_lg_u32 s58, 0
    s_cbranch_scc1 wall_97
    v_mov_b32 v76, 148
wctr_98:
    buffer_load_dword v75, v76, s[12:15], 0 offen sc1
    s_waitcnt vmcnt(0)
    v_cmp_gt_u16 vcc, 128, v75
    s_cbranch_vccz wctr_ok_99
    s_sub_u32 s77, s77, 1
    s_cbranch_scc0 wctr_98
    s_mov_b32 s77, 0
wctr_ok_99:
wall_97:
    s_barrier
    s_cmp_ge_u32 s57, 16
    s_cbranch_scc1 wo_78
    v_lshlrev_b32 v5, 4, v1
    v_bfe_u32 v6, v1, 0, 3
    v_lshlrev_b32 v6, 4, v6
    v_bfe_u32 v3, v1, 5, 1
    v_lshl_or_b32 v6, v3, 7, v6
    v_lshlrev_b32 v7, 3, v1
    v_bfe_u32 v2, v1, 5, 1
    v_lshlrev_b32 v2, 2, v2
    v_and_b32 v8, 31, v1
    v_sub_u32 v8, v8, v2
    s_mov_b32 s89, 0x3e0293ee
    s_and_b32 s86, s57, 8
    s_cselect_b32 s92, 4, 8
    s_cselect_b32 s93, 64, 16
    s_add_u32 s86, s86, s57
    s_mov_b32 s91, 0
    s_mov_b32 s94, 0
    v_mov_b32 v9, 163760
    s_add_u32 s94, s94, 1
    s_cmp_lg_u32 s58, 0
    s_cbranch_scc1 at_f_103
    s_and_b32 s88, s86, s92
    s_cmp_eq_u32 s88, 4
    s_cbranch_scc1 at_rb_105
    s_and_b32 s88, s86, 56
pollrb_106:
    buffer_load_dword v2, off, s[12:15], s88 offset:128 sc1
    s_waitcnt vmcnt(0)
    v_lshrrev_b32 v3, 15, v2
    v_and_b32 v2, 0x7fff, v2
    v_min_u32 v2, v2, v3
    v_cmp_gt_u32 vcc, 32, v2
    s_cbranch_vccz pollrb_ok_107
    s_sub_u32 s77, s77, 1
    s_cbranch_scc0 pollrb_106
    s_mov_b32 s77, 0
pollrb_ok_107:
at_rb_105:
    v_mov_b32 v2, s94
    ds_write_b32 v9, v2
at_f_103:
    ds_read_b32 v2, v9
    s_waitcnt lgkmcnt(0)
    v_cmp_gt_u32 vcc, s94, v2
    s_cbranch_vccz at_d_104
    s_sub_u32 s77, s77, 1
    s_cbranch_scc0 at_f_103
    s_mov_b32 s77, 0
at_d_104:
    s_lshl_b32 s95, s86, 2
    s_add_u32 s95, s95, s75
    s_lshl_b32 s95, s95, 3
    s_add_u32 s95, s95, s58
    s_lshl_b32 s95, s95, 13
    s_add_u32 s88, s95, 0x0
    buffer_load_dwordx4 v[12:15], v5, s[8:11], s88 offen offset:0 sc1
    buffer_load_dwordx4 v[16:19], v5, s[8:11], s88 offen offset:1024 sc1
    buffer_load_dwordx4 v[20:23], v5, s[8:11], s88 offen offset:2048 sc1
    buffer_load_dwordx4 v[24:27], v5, s[8:11], s88 offen offset:3072 sc1
    s_add_u32 s88, s88, 4096
    buffer_load_dwordx4 v[28:31], v5, s[8:11], s88 offen offset:0 sc1
    buffer_load_dwordx4 v[32:35], v5, s[8:11], s88 offen offset:1024 sc1
    buffer_load_dwordx4 v[36:39], v5, s[8:11], s88 offen offset:2048 sc1
    buffer_load_dwordx4 v[40:43], v5, s[8:11], s88 offen offset:3072 sc1
    s_add_u32 s88, s95, 0x1000000
    buffer_load_dwordx4 v[44:47], v5, s[8:11], s88 offen offset:0 sc1
    buffer_load_dwordx4 v[48:51], v5, s[8:11], s88 offen offset:1024 sc1
    buffer_load_dwordx4 v[52:55], v5, s[8:11], s88 offen offset:2048 sc1
    buffer_load_dwordx4 v[56:59], v5, s[8:11], s88 offen offset:3072 sc1
    s_add_u32 s88, s88, 4096
    buffer_load_dwordx4 v[60:63], v5, s[8:11], s88 offen offset:0 sc1
    buffer_load_dwordx4 v[64:67], v5, s[8:11], s88 offen offset:1024 sc1
    buffer_load_dwordx4 v[68:71], v5, s[8:11], s88 offen offset:2048 sc1
    buffer_load_dwordx4 v[72:75], v5, s[8:11], s88 offen offset:3072 sc1
    s_add_u32 s88, s95, 0x2000000
    buffer_load_dwordx4 v[76:79], v5, s[8:11], s88 offen offset:0 sc1
    buffer_load_dwordx4 v[80:83], v5, s[8:11], s88 offen offset:1024 sc1
    buffer_load_dwordx4 v[84:87], v5, s[8:11], s88 offen offset:2048 sc1
    buffer_load_dwordx4 v[88:91], v5, s[8:11], s88 offen offset:3072 sc1
    s_add_u32 s88, s88, 4096
    buffer_load_dwordx4 v[92:95], v5, s[8:11], s88 offen offset:0 sc1
    buffer_load_dwordx4 v[96:99], v5, s[8:11], s88 offen offset:1024 sc1
    buffer_load_dwordx4 v[100:103], v5, s[8:11], s88 offen offset:2048 sc1
    buffer_load_dwordx4 v[104:107], v5, s[8:11], s88 offen offset:3072 sc1
at_loop_100:
    s_mov_b32 s90, s95
    s_add_u32 s94, s94, 1
    s_cmp_lg_u32 s58, 0
    s_cbranch_scc1 at_f_108
    s_cmp_ge_u32 s86, 48
    s_cselect_b32 s88, 1, 2
    s_add_u32 s88, s88, s86
    s_min_u32 s88, s88, 62
    s_cmp_ge_u32 s91, s88
    s_cbranch_scc1 at_go_102
pollprog_110:
    buffer_load_dword v4, off, s[12:15], 0 offset:64 sc1
    s_waitcnt vmcnt(0)
    v_cmp_gt_u32 vcc, s88, v4
    s_cbranch_vccz pollprog_ok_111
    s_sub_u32 s77, s77, 1
    s_cbranch_scc0 pollprog_110
    s_mov_b32 s77, 0
pollprog_ok_111:
    v_readfirstlane_b32 s91, v4
at_go_102:
    v_mov_b32 v2, s94
    ds_write_b32 v9, v2
at_f_108:
    ds_read_b32 v2, v9
    s_waitcnt lgkmcnt(0)
    v_cmp_gt_u32 vcc, s94, v2
    s_cbranch_vccz at_d_109
    s_sub_u32 s77, s77, 1
    s_cbranch_scc0 at_f_108
    s_mov_b32 s77, 0
at_d_109:
    s_lshr_b32 s88, s90, 2
    s_add_u32 s87, s88, 0x4400000
    s_add_u32 s88, s88, 0x4000000
    buffer_load_dwordx4 v[108:111], v6, s[8:11], s88 offen offset:0 sc1
    buffer_load_dwordx4 v[112:115], v6, s[8:11], s88 offen offset:256 sc1
    buffer_load_dwordx4 v[116:119], v6, s[8:11], s88 offen offset:512 sc1
    buffer_load_dwordx4 v[120:123], v6, s[8:11], s88 offen offset:768 sc1
    buffer_load_dwordx4 v[124:127], v6, s[8:11], s88 offen offset:1024 sc1
    buffer_load_dwordx4 v[128:131], v6, s[8:11], s88 offen offset:1280 sc1
    buffer_load_dwordx4 v[132:135], v6, s[8:11], s88 offen offset:1536 sc1
    buffer_load_dwordx4 v[136:139], v6, s[8:11], s88 offen offset:1792 sc1
    buffer_load_dwordx2 v[236:237], v7, s[8:11], s87 offen offset:0 sc1
    buffer_load_dwordx2 v[238:239], v7, s[8:11], s87 offen offset:512 sc1
    buffer_load_dwordx2 v[240:241], v7, s[8:11], s87 offen offset:1024 sc1
    buffer_load_dwordx2 v[242:243], v7, s[8:11], s87 offen offset:1536 sc1
    s_waitcnt vmcnt(27)
    v_mfma_f32_32x32x16_bf16 v[140:155], v[44:47], v[12:15], 0
    s_waitcnt vmcnt(26)
    v_mfma_f32_32x32x16_bf16 v[140:155], v[48:51], v[16:19], v[140:155]
    s_waitcnt vmcnt(25)
    v_mfma_f32_32x32x16_bf16 v[140:155], v[52:55], v[20:23], v[140:155]
    s_waitcnt vmcnt(24)
    v_mfma_f32_32x32x16_bf16 v[140:155], v[56:59], v[24:27], v[140:155]
    s_waitcnt vmcnt(23)
    v_mfma_f32_32x32x16_bf16 v[140:155], v[60:63], v[28:31], v[140:155]
    s_waitcnt vmcnt(22)
    v_mfma_f32_32x32x16_bf16 v[140:155], v[64:67], v[32:35], v[140:155]
    s_waitcnt vmcnt(21)
    v_mfma_f32_32x32x16_bf16 v[140:155], v[68:71], v[36:39], v[140:155]
    s_waitcnt vmcnt(20)
    v_mfma_f32_32x32x16_bf16 v[140:155], v[72:75], v[40:43], v[140:155]
    v_mov_b32 v3, 0xff800000
    v_cmp_le_i32 vcc, 0, v8
    s_nop 9
    v_cndmask_b32 v140, v3, v140, vcc
    v_cmp_le_i32 vcc, 1, v8
    s_nop 1
    v_cndmask_b32 v141, v3, v141, vcc
    v_cmp_le_i32 vcc, 2, v8
    s_nop 1
    v_cndmask_b32 v142, v3, v142, vcc
    v_cmp_le_i32 vcc, 3, v8
    s_nop 1
    v_cndmask_b32 v143, v3, v143, vcc
    v_cmp_le_i32 vcc, 8, v8
    s_nop 1
    v_cndmask_b32 v144, v3, v144, vcc
    v_cmp_le_i32 vcc, 9, v8
    s_nop 1
    v_cndmask_b32 v145, v3, v145, vcc
    v_cmp_le_i32 vcc, 10, v8
    s_nop 1
    v_cndmask_b32 v146, v3, v146, vcc
    v_cmp_le_i32 vcc, 11, v8
    s_nop 1
    v_cndmask_b32 v147, v3, v147, vcc
    v_cmp_le_i32 vcc, 16, v8
    s_nop 1
    v_cndmask_b32 v148, v3, v148, vcc
    v_cmp_le_i32 vcc, 17, v8
    s_nop 1
    v_cndmask_b32 v149, v3, v149, vcc
    v_cmp_le_i32 vcc, 18, v8
    s_nop 1
    v_cndmask_b32 v150, v3, v150, vcc
    v_cmp_le_i32 vcc, 19, v8
    s_nop 1
    v_cndmask_b32 v151, v3, v151, vcc
    v_cmp_le_i32 vcc, 24, v8
    s_nop 1
    v_cndmask_b32 v152, v3, v152, vcc
    v_cmp_le_i32 vcc, 25, v8
    s_nop 1
    v_cndmask_b32 v153, v3, v153, vcc
    v_cmp_le_i32 vcc, 26, v8
    s_nop 1
    v_cndmask_b32 v154, v3, v154, vcc
    v_cmp_le_i32 vcc, 27, v8
    s_nop 1
    v_cndmask_b32 v155, v3, v155, vcc
    v_max3_f32 v244, v140, v141, v142
    v_max3_f32 v244, v244, v143, v144
    v_max3_f32 v244, v244, v145, v146
    v_max3_f32 v244, v244, v147, v148
    v_max3_f32 v244, v244, v149, v150
    v_max3_f32 v244, v244, v151, v152
    v_max3_f32 v244, v244, v153, v154
    s_waitcnt vmcnt(0)
    v_max3_u32 v2, v108, v112, v116
    v_max3_u32 v2, v2, v120, v124
    v_max3_u32 v2, v2, v128, v132
    v_max_u32 v2, v2, v136
    v_cmp_eq_u32 vcc, -1, v2
    s_cbranch_vccz pollkm_ok_113
pollkm_112:
    buffer_load_dwordx4 v[108:111], v6, s[8:11], s88 offen offset:0 sc1
    buffer_load_dwordx4 v[112:115], v6, s[8:11], s88 offen offset:256 sc1
    buffer_load_dwordx4 v[116:119], v6, s[8:11], s88 offen offset:512 sc1
    buffer_load_dwordx4 v[120:123], v6, s[8:11], s88 offen offset:768 sc1
    buffer_load_dwordx4 v[124:127], v6, s[8:11], s88 offen offset:1024 sc1
    buffer_load_dwordx4 v[128:131], v6, s[8:11], s88 offen offset:1280 sc1
    buffer_load_dwordx4 v[132:135], v6, s[8:11], s88 offen offset:1536 sc1
    buffer_load_dwordx4 v[136:139], v6, s[8:11], s88 offen offset:1792 sc1
    buffer_load_dwordx2 v[236:237], v7, s[8:11], s87 offen offset:0 sc1
    buffer_load_dwordx2 v[238:239], v7, s[8:11], s87 offen offset:512 sc1
    buffer_load_dwordx2 v[240:241], v7, s[8:11], s87 offen offset:1024 sc1
    buffer_load_dwordx2 v[242:243], v7, s[8:11], s87 offen offset:1536 sc1
    s_waitcnt vmcnt(0)
    v_max3_u32 v2, v108, v112, v116
    v_max3_u32 v2, v2, v120, v124
    v_max3_u32 v2, v2, v128, v132
    v_max_u32 v2, v2, v136
    v_cmp_eq_u32 vcc, -1, v2
    s_cbranch_vccz pollkm_ok_113
    s_sub_u32 s77, s77, 1
    s_cbranch_scc0 pollkm_112
    s_mov_b32 s77, 0
pollkm_ok_113:
    v_mfma_f32_32x32x16_bf16 v[172:187], v[108:111], v[12:15], 0
    v_mfma_f32_32x32x16_bf16 v[156:171], v[112:115], v[16:19], 0
    v_mfma_f32_32x32x16_bf16 v[172:187], v[116:119], v[20:23], v[172:187]
    v_mfma_f32_32x32x16_bf16 v[156:171], v[120:123], v[24:27], v[156:171]
    v_mfma_f32_32x32x16_bf16 v[172:187], v[124:127], v[28:31], v[172:187]
    v_mfma_f32_32x32x16_bf16 v[156:171], v[128:131], v[32:35], v[156:171]
    v_mfma_f32_32x32x16_bf16 v[172:187], v[132:135], v[36:39], v[172:187]
    v_mfma_f32_32x32x16_bf16 v[156:171], v[136:139], v[40:43], v[156:171]
    v_max3_u32 v3, v236, v238, v240
    v_max_u32 v3, v3, v242
    v_cmp_eq_u32 vcc, -1, v3
    s_cbranch_vccz at_v_114
    buffer_load_dwordx2 v[236:237], v7, s[8:11], s87 offen offset:0 sc1
    buffer_load_dwordx2 v[238:239], v7, s[8:11], s87 offen offset:512 sc1
    buffer_load_dwordx2 v[240:241], v7, s[8:11], s87 offen offset:1024 sc1
    buffer_load_dwordx2 v[242:243], v7, s[8:11], s87 offen offset:1536 sc1
at_v_114:
    s_mov_b64 s[2:3], vcc
    s_add_u32 s86, s86, s92
    s_mov_b32 s95, 0x5ffffff0
    s_cmp_ge_u32 s86, s93
    s_cbranch_scc1 at_nf_115
    s_add_u32 s94, s94, 1
    s_cmp_lg_u32 s58, 0
    s_cbranch_scc1 at_f_116
    s_and_b32 s88, s86, s92
    s_cmp_eq_u32 s88, 4
    s_cbranch_scc1 at_rb_118
    s_and_b32 s88, s86, 56
pollrb_119:
    buffer_load_dword v2, off, s[12:15], s88 offset:128 sc1
    s_waitcnt vmcnt(0)
    v_lshrrev_b32 v3, 15, v2
    v_and_b32 v2, 0x7fff, v2
    v_min_u32 v2, v2, v3
    v_cmp_gt_u32 vcc, 32, v2
    s_cbranch_vccz pollrb_ok_120
    s_sub_u32 s77, s77, 1
    s_cbranch_scc0 pollrb_119
    s_mov_b32 s77, 0
pollrb_ok_120:
at_rb_118:
    v_mov_b32 v2, s94
    ds_write_b32 v9, v2
at_f_116:
    ds_read_b32 v2, v9
    s_waitcnt lgkmcnt(0)
    v_cmp_gt_u32 vcc, s94, v2
    s_cbranch_vccz at_d_117
    s_sub_u32 s77, s77, 1
    s_cbranch_scc0 at_f_116
    s_mov_b32 s77, 0
at_d_117:
    s_lshl_b32 s95, s86, 2
    s_add_u32 s95, s95, s75
    s_lshl_b32 s95, s95, 3
    s_add_u32 s95, s95, s58
    s_lshl_b32 s95, s95, 13
    s_add_u32 s88, s95, 0x0
    buffer_load_dwordx4 v[12:15], v5, s[8:11], s88 offen offset:0 sc1
    buffer_load_dwordx4 v[16:19], v5, s[8:11], s88 offen offset:1024 sc1
    buffer_load_dwordx4 v[20:23], v5, s[8:11], s88 offen offset:2048 sc1
    buffer_load_dwordx4 v[24:27], v5, s[8:11], s88 offen offset:3072 sc1
    s_add_u32 s88, s88, 4096
    buffer_load_dwordx4 v[28:31], v5, s[8:11], s88 offen offset:0 sc1
    buffer_load_dwordx4 v[32:35], v5, s[8:11], s88 offen offset:1024 sc1
    buffer_load_dwordx4 v[36:39], v5, s[8:11], s88 offen offset:2048 sc1
    buffer_load_dwordx4 v[40:43], v5, s[8:11], s88 offen offset:3072 sc1
    s_add_u32 s88, s95, 0x1000000
    buffer_load_dwordx4 v[44:47], v5, s[8:11], s88 offen offset:0 sc1
    buffer_load_dwordx4 v[48:51], v5, s[8:11], s88 offen offset:1024 sc1
    buffer_load_dwordx4 v[52:55], v5, s[8:11], s88 offen offset:2048 sc1
    buffer_load_dwordx4 v[56:59], v5, s[8:11], s88 offen offset:3072 sc1
    s_add_u32 s88, s88, 4096
    buffer_load_dwordx4 v[60:63], v5, s[8:11], s88 offen offset:0 sc1
    buffer_load_dwordx4 v[64:67], v5, s[8:11], s88 offen offset:1024 sc1
    buffer_load_dwordx4 v[68:71], v5, s[8:11], s88 offen offset:2048 sc1
    buffer_load_dwordx4 v[72:75], v5, s[8:11], s88 offen offset:3072 sc1
at_nf_115:
    s_nop 2
    v_pk_add_f32 v[156:157], v[156:157], v[172:173]
    v_pk_add_f32 v[158:159], v[158:159], v[174:175]
    v_max3_f32 v2, v244, v155, v156
    v_max3_f32 v2, v2, v157, v158
    v_max_f32 v2, v2, v159
    v_mov_b32 v3, v2
    s_nop 1
    v_permlane32_swap_b32 v2, v3
    v_max_f32 v2, v2, v3
    v_mul_f32 v2, s89, v2
    v_fma_f32 v140, v140, s89, -v2
    v_fma_f32 v141, v141, s89, -v2
    v_exp_f32 v140, v140
    v_exp_f32 v141, v141
    v_fma_f32 v142, v142, s89, -v2
    v_fma_f32 v143, v143, s89, -v2
    v_exp_f32 v142, v142
    v_exp_f32 v143, v143
    v_cvt_pk_bf16_f32 v244, v140, v141
    v_fma_f32 v144, v144, s89, -v2
    v_fma_f32 v145, v145, s89, -v2
    v_exp_f32 v144, v144
    v_exp_f32 v145, v145
    v_cvt_pk_bf16_f32 v245, v142, v143
    v_fma_f32 v146, v146, s89, -v2
    v_fma_f32 v147, v147, s89, -v2
    v_exp_f32 v146, v146
    v_exp_f32 v147, v147
    v_cvt_pk_bf16_f32 v246, v144, v145
    v_fma_f32 v148, v148, s89, -v2
    v_fma_f32 v149, v149, s89, -v2
    v_exp_f32 v148, v148
    v_exp_f32 v149, v149
    v_cvt_pk_bf16_f32 v247, v146, v147
    v_fma_f32 v150, v150, s89, -v2
    v_fma_f32 v151, v151, s89, -v2
    v_exp_f32 v150, v150
    v_exp_f32 v151, v151
    v_cvt_pk_bf16_f32 v248, v148, v149
    v_mfma_f32_32x32x16_bf16 v[172:187], v[76:79], v[244:247], 0
    v_fma_f32 v152, v152, s89, -v2
    v_fma_f32 v153, v153, s89, -v2
    v_exp_f32 v152, v152
    v_exp_f32 v153, v153
    v_cvt_pk_bf16_f32 v249, v150, v151
    v_mfma_f32_32x32x16_bf16 v[188:203], v[84:87], v[244:247], 0
    v_fma_f32 v154, v154, s89, -v2
    v_fma_f32 v155, v155, s89, -v2
    v_exp_f32 v154, v154
    v_exp_f32 v155, v155
    v_cvt_pk_bf16_f32 v250, v152, v153
    v_mfma_f32_32x32x16_bf16 v[204:219], v[92:95], v[244:247], 0
    v_fma_f32 v156, v156, s89, -v2
    v_fma_f32 v157, v157, s89, -v2
    v_exp_f32 v156, v156
    v_exp_f32 v157, v157
    v_cvt_pk_bf16_f32 v251, v154, v155
    v_mfma_f32_32x32x16_bf16 v[220:235], v[100:103], v[244:247], 0
    v_fma_f32 v158, v158, s89, -v2
    v_fma_f32 v159, v159, s89, -v2
    v_exp_f32 v158, v158
    v_exp_f32 v159, v159
    v_cvt_pk_bf16_f32 v252, v156, v157
    v_add_f32 v2, v140, v141
    v_cvt_pk_bf16_f32 v253, v158, v159
    v_mfma_f32_32x32x16_bf16 v[172:187], v[80:83], v[248:251], v[172:187]
    v_add_f32 v2, v2, v142
    v_add_f32 v2, v2, v143
    v_add_f32 v2, v2, v144
    v_add_f32 v2, v2, v145
    v_add_f32 v2, v2, v146
    v_mfma_f32_32x32x16_bf16 v[188:203], v[88:91], v[248:251], v[188:203]
    v_add_f32 v2, v2, v147
    v_add_f32 v2, v2, v148
    v_add_f32 v2, v2, v149
    v_add_f32 v2, v2, v150
    v_add_f32 v2, v2, v151
    v_mfma_f32_32x32x16_bf16 v[204:219], v[96:99], v[248:251], v[204:219]
    v_add_f32 v2, v2, v152
    v_add_f32 v2, v2, v153
    v_add_f32 v2, v2, v154
    v_add_f32 v2, v2, v155
    v_add_f32 v2, v2, v156
    v_mfma_f32_32x32x16_bf16 v[220:235], v[104:107], v[248:251], v[220:235]
    v_add_f32 v2, v2, v157
    v_add_f32 v2, v2, v158
    v_add_f32 v2, v2, v159
    s_cmp_eq_u64 s[2:3], 0
    s_cbranch_scc1 at_vok_121
    s_waitcnt vmcnt(0)
    v_max3_u32 v3, v236, v238, v240
    v_max_u32 v3, v3, v242
    v_cmp_eq_u32 vcc, -1, v3
    s_cbranch_vccz pollvm_ok_123
pollvm_122:
    buffer_load_dwordx2 v[236:237], v7, s[8:11], s87 offen offset:0 sc1
    buffer_load_dwordx2 v[238:239], v7, s[8:11], s87 offen offset:512 sc1
    buffer_load_dwordx2 v[240:241], v7, s[8:11], s87 offen offset:1024 sc1
    buffer_load_dwordx2 v[242:243], v7, s[8:11], s87 offen offset:1536 sc1
    s_waitcnt vmcnt(0)
    v_max3_u32 v3, v236, v238, v240
    v_max_u32 v3, v3, v242
    v_cmp_eq_u32 vcc, -1, v3
    s_cbranch_vccz pollvm_ok_123
    s_sub_u32 s77, s77, 1
    s_cbranch_scc0 pollvm_122
    s_mov_b32 s77, 0
pollvm_ok_123:
at_vok_121:
    v_mfma_f32_32x32x8_bf16 v[172:187], v[236:237], v[252:253], v[172:187]
    v_mov_b32 v3, v2
    s_add_u32 s87, s90, 0x3000000
    v_mfma_f32_32x32x8_bf16 v[188:203], v[238:239], v[252:253], v[188:203]
    v_permlane32_swap_b32 v2, v3
    v_add_f32 v2, v2, v3
    v_rcp_f32 v2, v2
    v_mfma_f32_32x32x8_bf16 v[204:219], v[240:241], v[252:253], v[204:219]
    v_mfma_f32_32x32x8_bf16 v[220:235], v[242:243], v[252:253], v[220:235]
    s_nop 3
    v_pk_mul_f32 v[172:173], v[172:173], v[2:3] op_sel_hi:[1,0]
    v_pk_mul_f32 v[174:175], v[174:175], v[2:3] op_sel_hi:[1,0]
    v_pk_mul_f32 v[176:177], v[176:177], v[2:3] op_sel_hi:[1,0]
    v_pk_mul_f32 v[178:179], v[178:179], v[2:3] op_sel_hi:[1,0]
    v_cvt_pk_bf16_f32 v108, v172, v173
    v_cvt_pk_bf16_f32 v109, v174, v175
    v_cvt_pk_bf16_f32 v110, v176, v177
    v_cvt_pk_bf16_f32 v111, v178, v179
    buffer_store_dwordx4 v[108:111], v5, s[8:11], s87 offen offset:0
    v_pk_mul_f32 v[180:181], v[180:181], v[2:3] op_sel_hi:[1,0]
    v_pk_mul_f32 v[182:183], v[182:183], v[2:3] op_sel_hi:[1,0]
    v_pk_mul_f32 v[184:185], v[184:185], v[2:3] op_sel_hi:[1,0]
    v_pk_mul_f32 v[186:187], v[186:187], v[2:3] op_sel_hi:[1,0]
    v_cvt_pk_bf16_f32 v112, v180, v181
    v_cvt_pk_bf16_f32 v113, v182, v183
    v_cvt_pk_bf16_f32 v114, v184, v185
    v_cvt_pk_bf16_f32 v115, v186, v187
    buffer_store_dwordx4 v[112:115], v5, s[8:11], s87 offen offset:1024
    v_pk_mul_f32 v[188:189], v[188:189], v[2:3] op_sel_hi:[1,0]
    v_pk_mul_f32 v[190:191], v[190:191], v[2:3] op_sel_hi:[1,0]
    v_pk_mul_f32 v[192:193], v[192:193], v[2:3] op_sel_hi:[1,0]
    v_pk_mul_f32 v[194:195], v[194:195], v[2:3] op_sel_hi:[1,0]
    v_cvt_pk_bf16_f32 v116, v188, v189
    v_cvt_pk_bf16_f32 v117, v190, v191
    v_cvt_pk_bf16_f32 v118, v192, v193
    v_cvt_pk_bf16_f32 v119, v194, v195
    buffer_store_dwordx4 v[116:119], v5, s[8:11], s87 offen offset:2048
    v_pk_mul_f32 v[196:197], v[196:197], v[2:3] op_sel_hi:[1,0]
    v_pk_mul_f32 v[198:199], v[198:199], v[2:3] op_sel_hi:[1,0]
    v_pk_mul_f32 v[200:201], v[200:201], v[2:3] op_sel_hi:[1,0]
    v_pk_mul_f32 v[202:203], v[202:203], v[2:3] op_sel_hi:[1,0]
    v_cvt_pk_bf16_f32 v120, v196, v197
    v_cvt_pk_bf16_f32 v121, v198, v199
    v_cvt_pk_bf16_f32 v122, v200, v201
    v_cvt_pk_bf16_f32 v123, v202, v203
    buffer_store_dwordx4 v[120:123], v5, s[8:11], s87 offen offset:3072
    v_pk_mul_f32 v[204:205], v[204:205], v[2:3] op_sel_hi:[1,0]
    v_pk_mul_f32 v[206:207], v[206:207], v[2:3] op_sel_hi:[1,0]
    v_pk_mul_f32 v[208:209], v[208:209], v[2:3] op_sel_hi:[1,0]
    v_pk_mul_f32 v[210:211], v[210:211], v[2:3] op_sel_hi:[1,0]
    v_cvt_pk_bf16_f32 v124, v204, v205
    v_cvt_pk_bf16_f32 v125, v206, v207
    v_cvt_pk_bf16_f32 v126, v208, v209
    v_cvt_pk_bf16_f32 v127, v210, v211
    s_add_u32 s87, s87, 4096
    buffer_store_dwordx4 v[124:127], v5, s[8:11], s87 offen offset:0
    v_pk_mul_f32 v[212:213], v[212:213], v[2:3] op_sel_hi:[1,0]
    v_pk_mul_f32 v[214:215], v[214:215], v[2:3] op_sel_hi:[1,0]
    v_pk_mul_f32 v[216:217], v[216:217], v[2:3] op_sel_hi:[1,0]
    v_pk_mul_f32 v[218:219], v[218:219], v[2:3] op_sel_hi:[1,0]
    v_cvt_pk_bf16_f32 v128, v212, v213
    v_cvt_pk_bf16_f32 v129, v214, v215
    v_cvt_pk_bf16_f32 v130, v216, v217
    v_cvt_pk_bf16_f32 v131, v218, v219
    buffer_store_dwordx4 v[128:131], v5, s[8:11], s87 offen offset:1024
    v_pk_mul_f32 v[220:221], v[220:221], v[2:3] op_sel_hi:[1,0]
    v_pk_mul_f32 v[222:223], v[222:223], v[2:3] op_sel_hi:[1,0]
    v_pk_mul_f32 v[224:225], v[224:225], v[2:3] op_sel_hi:[1,0]
    v_pk_mul_f32 v[226:227], v[226:227], v[2:3] op_sel_hi:[1,0]
    v_cvt_pk_bf16_f32 v132, v220, v221
    v_cvt_pk_bf16_f32 v133, v222, v223
    v_cvt_pk_bf16_f32 v134, v224, v225
    v_cvt_pk_bf16_f32 v135, v226, v227
    buffer_store_dwordx4 v[132:135], v5, s[8:11], s87 offen offset:2048
    v_pk_mul_f32 v[228:229], v[228:229], v[2:3] op_sel_hi:[1,0]
    v_pk_mul_f32 v[230:231], v[230:231], v[2:3] op_sel_hi:[1,0]
    v_pk_mul_f32 v[232:233], v[232:233], v[2:3] op_sel_hi:[1,0]
    v_pk_mul_f32 v[234:235], v[234:235], v[2:3] op_sel_hi:[1,0]
    v_cvt_pk_bf16_f32 v136, v228, v229
    v_cvt_pk_bf16_f32 v137, v230, v231
    v_cvt_pk_bf16_f32 v138, v232, v233
    v_cvt_pk_bf16_f32 v139, v234, v235
    buffer_store_dwordx4 v[136:139], v5, s[8:11], s87 offen offset:3072
    s_add_u32 s88, s95, 0x2000000
    buffer_load_dwordx4 v[76:79], v5, s[8:11], s88 offen offset:0 sc1
    buffer_load_dwordx4 v[80:83], v5, s[8:11], s88 offen offset:1024 sc1
    buffer_load_dwordx4 v[84:87], v5, s[8:11], s88 offen offset:2048 sc1
    buffer_load_dwordx4 v[88:91], v5, s[8:11], s88 offen offset:3072 sc1
    s_add_u32 s88, s88, 4096
    buffer_load_dwordx4 v[92:95], v5, s[8:11], s88 offen offset:0 sc1
    buffer_load_dwordx4 v[96:99], v5, s[8:11], s88 offen offset:1024 sc1
    buffer_load_dwordx4 v[100:103], v5, s[8:11], s88 offen offset:2048 sc1
    buffer_load_dwordx4 v[104:107], v5, s[8:11], s88 offen offset:3072 sc1
    s_bfe_u32 s87, s90, 0x3000d
    s_lshl_b32 s87, s87, 2
    s_bfe_u32 s88, s90, 0x80010
    s_lshl_b32 s88, s88, 7
    s_or_b32 s87, s87, s88
    s_add_u32 s87, s87, 0x5100000
    v_mov_b32 v2, 1
    s_waitcnt vmcnt(8)
    buffer_store_dword v2, off, s[8:11], s87
    s_cmp_lt_u32 s86, s93
    s_cbranch_scc1 at_loop_100
    s_cmp_ge_u32 s57, 8
    s_cbranch_scc1 end_76
wo_78:
    v_bfe_u32 v2, v1, 4, 2
    v_lshlrev_b32 v2, 2, v2
    v_xor_b32 v2, v2, v1
    v_bfe_u32 v4, v2, 0, 4
    v_lshlrev_b32 v4, 4, v4
    v_bfe_u32 v3, v2, 4, 2
    v_lshl_or_b32 v4, v3, 11, v4
    s_bfe_u32 s2, s58, 0x20000
    s_lshl_b32 s2, s2, 17
    s_bfe_u32 s4, s58, 0x10002
    s_lshl_b32 s4, s4, 20
    s_or_b32 s2, s2, s4
    s_lshl_b32 s4, s75, 21
    s_add_u32 s2, s2, s4
    s_bfe_u32 s4, s57, 0x30000
    s_lshl_b32 s4, s4, 8
    s_add_u32 s2, s2, s4
    s_lshl_b32 s3, s58, 14
    s_add_u32 s2, s2, 0x80000
    v_bfe_u32 v5, v1, 0, 2
    v_lshlrev_b32 v5, 3, v5
    v_bfe_u32 v3, v1, 4, 1
    v_lshl_or_b32 v5, v3, 5, v5
    v_bfe_u32 v3, v1, 2, 2
    v_lshl_or_b32 v5, v3, 6, v5
    v_bfe_u32 v3, v1, 2, 2
    v_lshl_or_b32 v5, v3, 8, v5
    v_bfe_u32 v3, v1, 5, 1
    v_lshl_or_b32 v5, v3, 10, v5
    s_bfe_u32 s4, s58, 0x20000
    s_lshl_b32 s4, s4, 6
    s_bfe_u32 s5, s58, 0x10002
    s_lshl_b32 s5, s5, 16
    s_or_b32 s4, s4, s5
    v_xor_b32 v5, s4, v5
    s_waitcnt vmcnt(0)
    s_barrier
    ds_read_b64_tr_b16 v[128:129], v5 offset:0
    ds_read_b64_tr_b16 v[130:131], v5 offset:2048
    ds_read_b64_tr_b16 v[132:133], v5 offset:4096
    ds_read_b64_tr_b16 v[134:135], v5 offset:6144
    ds_read_b64_tr_b16 v[136:137], v5 offset:8192
    ds_read_b64_tr_b16 v[138:139], v5 offset:10240
    ds_read_b64_tr_b16 v[140:141], v5 offset:12288
    ds_read_b64_tr_b16 v[142:143], v5 offset:14336
    s_waitcnt lgkmcnt(0)
    ds_read_b64_tr_b16 v[144:145], v5 offset:16384
    ds_read_b64_tr_b16 v[146:147], v5 offset:18432
    ds_read_b64_tr_b16 v[148:149], v5 offset:20480
    ds_read_b64_tr_b16 v[150:151], v5 offset:22528
    ds_read_b64_tr_b16 v[152:153], v5 offset:24576
    ds_read_b64_tr_b16 v[154:155], v5 offset:26624
    ds_read_b64_tr_b16 v[156:157], v5 offset:28672
    ds_read_b64_tr_b16 v[158:159], v5 offset:30720
    s_waitcnt lgkmcnt(0)
    ds_read_b64_tr_b16 v[160:161], v5 offset:32768
    ds_read_b64_tr_b16 v[162:163], v5 offset:34816
    ds_read_b64_tr_b16 v[164:165], v5 offset:36864
    ds_read_b64_tr_b16 v[166:167], v5 offset:38912
    ds_read_b64_tr_b16 v[168:169], v5 offset:40960
    ds_read_b64_tr_b16 v[170:171], v5 offset:43008
    ds_read_b64_tr_b16 v[172:173], v5 offset:45056
    ds_read_b64_tr_b16 v[174:175], v5 offset:47104
    s_waitcnt lgkmcnt(0)
    ds_read_b64_tr_b16 v[176:177], v5 offset:49152
    ds_read_b64_tr_b16 v[178:179], v5 offset:51200
    ds_read_b64_tr_b16 v[180:181], v5 offset:53248
    ds_read_b64_tr_b16 v[182:183], v5 offset:55296
    ds_read_b64_tr_b16 v[184:185], v5 offset:57344
    ds_read_b64_tr_b16 v[186:187], v5 offset:59392
    ds_read_b64_tr_b16 v[188:189], v5 offset:61440
    ds_read_b64_tr_b16 v[190:191], v5 offset:63488
    s_waitcnt lgkmcnt(0)
    s_barrier
    s_add_u32 m0, s3, 0
    s_nop 0
    buffer_load_dwordx4 v4, s[32:35], s2 offen lds
    s_add_u32 s2, s2, 0x2000
    s_add_u32 m0, s3, 1024
    s_nop 0
    buffer_load_dwordx4 v4, s[32:35], s2 offen lds
    s_add_u32 s2, s2, 0x2000
    s_add_u32 m0, s3, 2048
    s_nop 0
    buffer_load_dwordx4 v4, s[32:35], s2 offen lds
    s_add_u32 s2, s2, 0x2000
    s_add_u32 m0, s3, 3072
    s_nop 0
    buffer_load_dwordx4 v4, s[32:35], s2 offen lds
    s_add_u32 s2, s2, 0x2000
    s_add_u32 m0, s3, 4096
    s_nop 0
    buffer_load_dwordx4 v4, s[32:35], s2 offen lds
    s_add_u32 s2, s2, 0x2000
    s_add_u32 m0, s3, 5120
    s_nop 0
    buffer_load_dwordx4 v4, s[32:35], s2 offen lds
    s_add_u32 s2, s2, 0x2000
    s_add_u32 m0, s3, 6144
    s_nop 0
    buffer_load_dwordx4 v4, s[32:35], s2 offen lds
    s_add_u32 s2, s2, 0x2000
    s_add_u32 m0, s3, 7168
    s_nop 0
    buffer_load_dwordx4 v4, s[32:35], s2 offen lds
    s_add_u32 s2, s2, 0x2000
    s_add_u32 m0, s3, 8192
    s_nop 0
    buffer_load_dwordx4 v4, s[32:35], s2 offen lds
    s_add_u32 s2, s2, 0x2000
    s_add_u32 m0, s3, 9216
    s_nop 0
    buffer_load_dwordx4 v4, s[32:35], s2 offen lds
    s_add_u32 s2, s2, 0x2000
    s_add_u32 m0, s3, 10240
    s_nop 0
    buffer_load_dwordx4 v4, s[32:35], s2 offen lds
    s_add_u32 s2, s2, 0x2000
    s_add_u32 m0, s3, 11264
    s_nop 0
    buffer_load_dwordx4 v4, s[32:35], s2 offen lds
    s_add_u32 s2, s2, 0x2000
    s_add_u32 m0, s3, 12288
    s_nop 0
    buffer_load_dwordx4 v4, s[32:35], s2 offen lds
    s_add_u32 s2, s2, 0x2000
    s_add_u32 m0, s3, 13312
    s_nop 0
    buffer_load_dwordx4 v4, s[32:35], s2 offen lds
    s_add_u32 s2, s2, 0x2000
    s_add_u32 m0, s3, 14336
    s_nop 0
    buffer_load_dwordx4 v4, s[32:35], s2 offen lds
    s_add_u32 s2, s2, 0x2000
    s_add_u32 m0, s3, 15360
    s_nop 0
    buffer_load_dwordx4 v4, s[32:35], s2 offen lds
    s_add_u32 s2, s2, 0x2000
    s_waitcnt vmcnt(0)
    s_barrier
    ds_read_b64_tr_b16 v[192:193], v5 offset:0
    ds_read_b64_tr_b16 v[194:195], v5 offset:2048
    ds_read_b64_tr_b16 v[196:197], v5 offset:4096
    ds_read_b64_tr_b16 v[198:199], v5 offset:6144
    ds_read_b64_tr_b16 v[200:201], v5 offset:8192
    ds_read_b64_tr_b16 v[202:203], v5 offset:10240
    ds_read_b64_tr_b16 v[204:205], v5 offset:12288
    ds_read_b64_tr_b16 v[206:207], v5 offset:14336
    s_waitcnt lgkmcnt(0)
    ds_read_b64_tr_b16 v[208:209], v5 offset:16384
    ds_read_b64_tr_b16 v[210:211], v5 offset:18432
    ds_read_b64_tr_b16 v[212:213], v5 offset:20480
    ds_read_b64_tr_b16 v[214:215], v5 offset:22528
    ds_read_b64_tr_b16 v[216:217], v5 offset:24576
    ds_read_b64_tr_b16 v[218:219], v5 offset:26624
    ds_read_b64_tr_b16 v[220:221], v5 offset:28672
    ds_read_b64_tr_b16 v[222:223], v5 offset:30720
    s_waitcnt lgkmcnt(0)
    ds_read_b64_tr_b16 v[224:225], v5 offset:32768
    ds_read_b64_tr_b16 v[226:227], v5 offset:34816
    ds_read_b64_tr_b16 v[228:229], v5 offset:36864
    ds_read_b64_tr_b16 v[230:231], v5 offset:38912
    ds_read_b64_tr_b16 v[232:233], v5 offset:40960
    ds_read_b64_tr_b16 v[234:235], v5 offset:43008
    ds_read_b64_tr_b16 v[236:237], v5 offset:45056
    ds_read_b64_tr_b16 v[238:239], v5 offset:47104
    s_waitcnt lgkmcnt(0)
    ds_read_b64_tr_b16 v[240:241], v5 offset:49152
    ds_read_b64_tr_b16 v[242:243], v5 offset:51200
    ds_read_b64_tr_b16 v[244:245], v5 offset:53248
    ds_read_b64_tr_b16 v[246:247], v5 offset:55296
    ds_read_b64_tr_b16 v[248:249], v5 offset:57344
    ds_read_b64_tr_b16 v[250:251], v5 offset:59392
    ds_read_b64_tr_b16 v[252:253], v5 offset:61440
    ds_read_b64_tr_b16 v[254:255], v5 offset:63488
    s_waitcnt lgkmcnt(0)
    s_barrier
    v_lshlrev_b32 v5, 4, v1
    s_lshl_b32 s64, s75, 3
    s_add_u32 s64, s64, s58
    s_lshl_b32 s5, s64, 13
    s_add_u32 s5, s5, 0x3000000
    s_bfe_u32 s6, s64, 0x30000
    s_lshl_b32 s6, s6, 2
    s_bfe_u32 s71, s64, 0x20003
    s_lshl_b32 s71, s71, 7
    s_or_b32 s6, s6, s71
    s_add_u32 s6, s6, 0x5100000
    s_lshl_b32 s67, s58, 13
    s_bfe_u32 s64, s58, 0x10002
    s_lshl_b32 s64, s64, 15
    v_add_u32 v6, s64, v5
    v_bfe_u32 v2, v1, 5, 1
    v_lshlrev_b32 v2, 4, v2
    v_xor_b32 v2, v2, v5
    s_bfe_u32 s64, s58, 0x10000
    s_lshl_b32 s64, s64, 7
    s_bfe_u32 s62, s58, 0x30000
    s_lshl_b32 s62, s62, 12
    s_or_b32 s64, s64, s62
    s_or_b32 s64, s64, 131072
    v_xor_b32 v10, s64, v2
    v_bfe_u32 v2, v1, 0, 1
    v_lshlrev_b32 v2, 3, v2
    v_bfe_u32 v3, v1, 1, 4
    v_lshl_or_b32 v2, v3, 4, v2
    v_bfe_u32 v3, v1, 1, 5
    v_lshl_or_b32 v2, v3, 9, v2
    s_lshl_b32 s64, s58, 6
    s_or_b32 s64, s64, 131072
    v_xor_b32 v14, s64, v2
    v_xor_b32 v11, 1056, v10
    v_xor_b32 v15, 16, v14
    v_xor_b32 v12, 2112, v10
    v_xor_b32 v16, 32, v14
    v_xor_b32 v13, 3168, v10
    v_xor_b32 v17, 48, v14
    v_lshlrev_b32 v7, 2, v1
    s_bfe_u32 s7, s57, 0x30000
    s_lshl_b32 s7, s7, 8
    s_lshl_b32 s64, s58, 14
    s_add_u32 s7, s7, s64
    s_bfe_u32 s70, s57, 0x30000
    s_lshl_b32 s70, s70, 16
    s_bfe_u32 s64, s57, 0x10004
    s_lshl_b32 s64, s64, 21
    s_or_b32 s70, s70, s64
    s_add_u32 s70, s70, s67
    s_add_u32 s70, s70, 0x6000000
    s_lshl_b32 s64, s75, 11
    s_add_u32 s70, s70, s64
    s_xor_b32 s2, s70, 2048
    s_xor_b32 s3, s70, 4096
    s_xor_b32 s4, s70, 6144
    s_cmp_ge_u32 s57, 16
    s_cselect_b32 s64, 0, -1
    s_xor_b32 s60, s64, 0x0
    s_xor_b32 s61, s64, 0x5555ff00
    s_mov_b32 s71, -1
    v_add_u32 v8, 0x180000, v5
    s_ff1_i32_b64 s63, s[60:61]
    s_bitset0_b64 s[60:61], s63
    s_lshl_b32 s66, s63, 9
    s_add_u32 s66, s66, s6
wo_slow_124:
pollfl_129:
    buffer_load_dword v4, off, s[8:11], s66 sc1
    s_waitcnt vmcnt(0)
    v_cmp_eq_u32 vcc, 0, v4
    s_cbranch_vccz pollfl_ok_130
    s_sub_u32 s77, s77, 1
    s_cbranch_scc0 pollfl_129
    s_mov_b32 s77, 0
pollfl_ok_130:
    s_mov_b32 s73, s63
    s_lshl_b32 s65, s63, 18
    s_add_u32 s65, s65, s5
    s_ff1_i32_b64 s63, s[60:61]
    s_bitset0_b64 s[60:61], s63
    s_lshl_b32 s66, s63, 9
    s_add_u32 s66, s66, s6
    s_add_u32 m0, s67, 0
    s_nop 0
    buffer_load_dwordx4 v5, s[8:11], s65 offen offset:0 sc1 lds
    buffer_load_dwordx4 v5, s[8:11], s65 offen offset:1024 sc1 lds
    buffer_load_dwordx4 v5, s[8:11], s65 offen offset:2048 sc1 lds
    buffer_load_dwordx4 v5, s[8:11], s65 offen offset:3072 sc1 lds
    s_add_u32 s65, s65, 4096
    s_add_u32 m0, s67, 4096
    s_nop 0
    buffer_load_dwordx4 v5, s[8:11], s65 offen offset:0 sc1 lds
    buffer_load_dwordx4 v5, s[8:11], s65 offen offset:1024 sc1 lds
    buffer_load_dwordx4 v5, s[8:11], s65 offen offset:2048 sc1 lds
    buffer_load_dwordx4 v5, s[8:11], s65 offen offset:3072 sc1 lds
    buffer_load_dword v4, off, s[8:11], s66 sc1
    s_waitcnt vmcnt(0)
wo_loop_125:
    s_mov_b32 s62, s73
    s_xor_b32 s67, s67, 0x10000
    v_readfirstlane_b32 s69, v4
    s_cmp_lt_i32 s63, 0
    s_cselect_b32 s69, 0, s69
    s_mov_b32 s65, 0x5ffffff0
    s_cmp_eq_u32 s69, 0
    s_cbranch_scc1 wo_np_126
    s_mov_b32 s73, s63
    s_lshl_b32 s65, s63, 18
    s_add_u32 s65, s65, s5
    s_ff1_i32_b64 s63, s[60:61]
    s_bitset0_b64 s[60:61], s63
    s_lshl_b32 s66, s63, 9
    s_add_u32 s66, s66, s6
wo_np_126:
    s_waitcnt lgkmcnt(0)
    s_barrier
    ds_read_b128 v[52:55], v6 offset:0
    ds_read_b128 v[56:59], v6 offset:1024
    ds_read_b128 v[60:63], v6 offset:2048
    ds_read_b128 v[64:67], v6 offset:3072
    ds_read_b128 v[68:71], v6 offset:4096
    ds_read_b128 v[72:75], v6 offset:5120
    ds_read_b128 v[76:79], v6 offset:6144
    ds_read_b128 v[80:83], v6 offset:7168
    s_waitcnt lgkmcnt(7)
    v_mfma_f32_32x32x16_bf16 v[20:35], v[128:131], v[52:55], 0
    ds_read_b64 v[36:37], v14 offset:0
    ds_read_b128 v[52:55], v6 offset:8192
    s_lshr_b32 s64, s58, 1
    s_cmp_lg_u32 s64, s75
    s_cbranch_scc1 wo_j_131
    s_cmp_lt_i32 s71, 1
    s_cbranch_scc1 wo_j_131
    buffer_load_dwordx4 v[92:95], v9, s[8:11], s2 offen offset:0 sc1
    buffer_load_dwordx4 v[96:99], v9, s[8:11], s2 offen offset:1024 sc1
    buffer_load_dwordx4 v[100:103], v9, s[8:11], s3 offen offset:0 sc1
    buffer_load_dwordx4 v[104:107], v9, s[8:11], s3 offen offset:1024 sc1
    buffer_load_dwordx4 v[108:111], v9, s[8:11], s4 offen offset:0 sc1
    buffer_load_dwordx4 v[112:115], v9, s[8:11], s4 offen offset:1024 sc1
wo_j_131:
    s_waitcnt lgkmcnt(8)
    v_mfma_f32_32x32x16_bf16 v[20:35], v[132:135], v[56:59], v[20:35]
    ds_read_b64 v[44:45], v14 offset:16384
    ds_read_b128 v[56:59], v6 offset:9216
    s_add_u32 m0, s67, 0
    s_nop 0
    buffer_load_dwordx4 v5, s[8:11], s65 offen offset:0 sc1 lds
    s_waitcnt lgkmcnt(9)
    v_mfma_f32_32x32x16_bf16 v[20:35], v[136:139], v[60:63], v[20:35]
    ds_read_b64 v[38:39], v15 offset:0
    ds_read_b128 v[60:63], v6 offset:10240
    s_waitcnt lgkmcnt(10)
    v_mfma_f32_32x32x16_bf16 v[20:35], v[140:143], v[64:67], v[20:35]
    ds_read_b64 v[46:47], v15 offset:16384
    ds_read_b128 v[64:67], v6 offset:11264
    buffer_load_dwordx4 v5, s[8:11], s65 offen offset:1024 sc1 lds
    s_waitcnt lgkmcnt(11)
    v_mfma_f32_32x32x16_bf16 v[20:35], v[144:147], v[68:71], v[20:35]
    ds_read_b64 v[40:41], v16 offset:0
    ds_read_b128 v[68:71], v6 offset:12288
    s_waitcnt lgkmcnt(12)
    v_mfma_f32_32x32x16_bf16 v[20:35], v[148:151], v[72:75], v[20:35]
    ds_read_b64 v[48:49], v16 offset:16384
    ds_read_b128 v[72:75], v6 offset:13312
    buffer_load_dwordx4 v5, s[8:11], s65 offen offset:2048 sc1 lds
    s_waitcnt lgkmcnt(13)
    v_mfma_f32_32x32x16_bf16 v[20:35], v[152:155], v[76:79], v[20:35]
    ds_read_b64 v[42:43], v17 offset:0
    ds_read_b128 v[76:79], v6 offset:14336
    s_waitcnt lgkmcnt(13)
    v_mfma_f32_32x32x16_bf16 v[20:35], v[156:159], v[80:83], v[20:35]
    ds_read_b64 v[50:51], v17 offset:16384
    ds_read_b128 v[80:83], v6 offset:15360
    buffer_load_dwordx4 v5, s[8:11], s65 offen offset:3072 sc1 lds
    s_add_u32 s65, s65, 4096
    s_waitcnt lgkmcnt(13)
    v_mfma_f32_32x32x16_bf16 v[20:35], v[160:163], v[52:55], v[20:35]
    ds_read_b128 v[52:55], v6 offset:16384
    s_waitcnt lgkmcnt(13)
    v_mfma_f32_32x32x16_bf16 v[20:35], v[164:167], v[56:59], v[20:35]
    ds_read_b128 v[56:59], v6 offset:17408
    s_add_u32 m0, s67, 4096
    s_nop 0
    buffer_load_dwordx4 v5, s[8:11], s65 offen offset:0 sc1 lds
    s_waitcnt lgkmcnt(12)
    v_mfma_f32_32x32x16_bf16 v[20:35], v[168:171], v[60:63], v[20:35]
    ds_read_b128 v[60:63], v6 offset:18432
    s_waitcnt lgkmcnt(11)
    v_mfma_f32_32x32x16_bf16 v[20:35], v[172:175], v[64:67], v[20:35]
    ds_read_b128 v[64:67], v6 offset:19456
    buffer_load_dwordx4 v5, s[8:11], s65 offen offset:1024 sc1 lds
    s_waitcnt lgkmcnt(10)
    v_mfma_f32_32x32x16_bf16 v[20:35], v[176:179], v[68:71], v[20:35]
    ds_read_b128 v[68:71], v6 offset:20480
    s_waitcnt lgkmcnt(9)
    v_mfma_f32_32x32x16_bf16 v[20:35], v[180:183], v[72:75], v[20:35]
    ds_read_b128 v[72:75], v6 offset:21504
    buffer_load_dwordx4 v5, s[8:11], s65 offen offset:2048 sc1 lds
    s_waitcnt lgkmcnt(8)
    v_mfma_f32_32x32x16_bf16 v[20:35], v[184:187], v[76:79], v[20:35]
    ds_read_b128 v[76:79], v6 offset:22528
    s_waitcnt lgkmcnt(7)
    v_mfma_f32_32x32x16_bf16 v[20:35], v[188:191], v[80:83], v[20:35]
    ds_read_b128 v[80:83], v6 offset:23552
    buffer_load_dwordx4 v5, s[8:11], s65 offen offset:3072 sc1 lds
    s_waitcnt lgkmcnt(7)
    v_mfma_f32_32x32x16_bf16 v[20:35], v[192:195], v[52:55], v[20:35]
    ds_read_b128 v[52:55], v6 offset:24576
    buffer_load_dword v4, off, s[8:11], s66 sc1
    s_barrier
    s_waitcnt lgkmcnt(7)
    v_mfma_f32_32x32x16_bf16 v[20:35], v[196:199], v[56:59], v[20:35]
    ds_read_b128 v[56:59], v6 offset:25600
    s_lshr_b32 s64, s58, 1
    s_cmp_lg_u32 s64, s75
    s_cbranch_scc1 wo_s_132
    s_cmp_lt_i32 s71, 1
    s_cbranch_scc1 wo_k_135
    s_waitcnt vmcnt(9)
    v_bitop3_b32 v2, v92, v96, s72 bitop3:0x7e
    v_bitop3_b32 v3, v100, v104, s72 bitop3:0x7e
    v_or_b32 v2, v2, v3
    v_bitop3_b32 v3, v108, v112, s72 bitop3:0x7e
    v_bitop3_b32 v2, v2, v3, 1 bitop3:0xa8
    v_cmp_ne_u32 vcc, 0, v2
    s_cbranch_vccz pollpart_ok_137
pollpart_136:
    buffer_load_dwordx4 v[92:95], v9, s[8:11], s2 offen offset:0 sc1
    buffer_load_dwordx4 v[96:99], v9, s[8:11], s2 offen offset:1024 sc1
    buffer_load_dwordx4 v[100:103], v9, s[8:11], s3 offen offset:0 sc1
    buffer_load_dwordx4 v[104:107], v9, s[8:11], s3 offen offset:1024 sc1
    buffer_load_dwordx4 v[108:111], v9, s[8:11], s4 offen offset:0 sc1
    buffer_load_dwordx4 v[112:115], v9, s[8:11], s4 offen offset:1024 sc1
    s_waitcnt vmcnt(0)
    v_bitop3_b32 v2, v92, v96, s72 bitop3:0x7e
    v_bitop3_b32 v3, v100, v104, s72 bitop3:0x7e
    v_or_b32 v2, v2, v3
    v_bitop3_b32 v3, v108, v112, s72 bitop3:0x7e
    v_bitop3_b32 v2, v2, v3, 1 bitop3:0xa8
    v_cmp_ne_u32 vcc, 0, v2
    s_cbranch_vccz pollpart_ok_137
    s_sub_u32 s77, s77, 1
    s_cbranch_scc0 pollpart_136
    s_mov_b32 s77, 0
pollpart_ok_137:
    v_pk_add_f32 v[84:85], v[84:85], v[92:93]
    v_pk_add_f32 v[100:101], v[100:101], v[108:109]
    v_pk_add_f32 v[84:85], v[84:85], v[100:101]
    v_cvt_pk_bf16_f32 v92, v84, v85
    buffer_store_dword v92, v7, s[16:19], s68 offen offset:2048
    s_add_u32 s68, s68, 4096
    v_pk_add_f32 v[86:87], v[86:87], v[94:95]
    v_pk_add_f32 v[102:103], v[102:103], v[110:111]
    v_pk_add_f32 v[86:87], v[86:87], v[102:103]
    v_cvt_pk_bf16_f32 v93, v86, v87
    buffer_store_dword v93, v7, s[16:19], s68 offen offset:2048
    s_add_u32 s68, s68, 4096
    v_pk_add_f32 v[88:89], v[88:89], v[96:97]
    v_pk_add_f32 v[104:105], v[104:105], v[112:113]
    v_pk_add_f32 v[88:89], v[88:89], v[104:105]
    v_cvt_pk_bf16_f32 v94, v88, v89
    buffer_store_dword v94, v7, s[16:19], s68 offen offset:2048
    s_add_u32 s68, s68, 4096
    v_pk_add_f32 v[90:91], v[90:91], v[98:99]
    v_pk_add_f32 v[106:107], v[106:107], v[114:115]
    v_pk_add_f32 v[90:91], v[90:91], v[106:107]
    v_cvt_pk_bf16_f32 v95, v90, v91
    buffer_store_dword v95, v7, s[16:19], s68 offen offset:2048
    s_add_u32 s68, s68, 4096
    v_pk_add_f32 v[84:85], v[36:37], v[44:45]
    v_pk_add_f32 v[86:87], v[38:39], v[46:47]
    v_pk_add_f32 v[88:89], v[40:41], v[48:49]
    v_pk_add_f32 v[90:91], v[42:43], v[50:51]
    s_bfe_u32 s72, s71, 0x10002
    v_mov_b32 v9, v8
    s_lshl_b32 s68, s59, 17
    s_add_u32 s68, s68, s7
    s_branch wo_j_133
wo_k_135:
    v_pk_add_f32 v[84:85], v[36:37], v[44:45]
    v_pk_add_f32 v[86:87], v[38:39], v[46:47]
    v_pk_add_f32 v[88:89], v[40:41], v[48:49]
    v_pk_add_f32 v[90:91], v[42:43], v[50:51]
    s_bfe_u32 s72, s71, 0x10002
    v_mov_b32 v9, v8
    s_lshl_b32 s68, s59, 17
    s_add_u32 s68, s68, s7
wo_w_134:
    s_waitcnt vmcnt(0)
    s_branch wo_j_133
wo_s_132:
    s_cmp_lt_i32 s71, 0
    s_cbranch_scc1 wo_w_134
    s_bfe_u32 s72, s71, 0x10002
    v_pk_add_f32 v[84:85], v[36:37], v[44:45]
    v_bfi_b32 v84, 1, s72, v84
    v_pk_add_f32 v[86:87], v[38:39], v[46:47]
    buffer_store_dwordx4 v[84:87], v8, s[8:11], s70 offen offset:0 sc1
    v_pk_add_f32 v[88:89], v[40:41], v[48:49]
    v_bfi_b32 v88, 1, s72, v88
    v_pk_add_f32 v[90:91], v[42:43], v[50:51]
    buffer_store_dwordx4 v[88:91], v8, s[8:11], s70 offen offset:1024 sc1
wo_j_133:
    s_waitcnt lgkmcnt(7)
    v_mfma_f32_32x32x16_bf16 v[20:35], v[200:203], v[60:63], v[20:35]
    ds_read_b128 v[60:63], v6 offset:26624
    s_waitcnt lgkmcnt(7)
    v_mfma_f32_32x32x16_bf16 v[20:35], v[204:207], v[64:67], v[20:35]
    ds_read_b128 v[64:67], v6 offset:27648
    s_waitcnt lgkmcnt(7)
    v_mfma_f32_32x32x16_bf16 v[20:35], v[208:211], v[68:71], v[20:35]
    ds_read_b128 v[68:71], v6 offset:28672
    s_waitcnt lgkmcnt(7)
    v_mfma_f32_32x32x16_bf16 v[20:35], v[212:215], v[72:75], v[20:35]
    ds_read_b128 v[72:75], v6 offset:29696
    s_waitcnt lgkmcnt(7)
    v_mfma_f32_32x32x16_bf16 v[20:35], v[216:219], v[76:79], v[20:35]
    ds_read_b128 v[76:79], v6 offset:30720
    s_waitcnt lgkmcnt(7)
    v_mfma_f32_32x32x16_bf16 v[20:35], v[220:223], v[80:83], v[20:35]
    ds_read_b128 v[80:83], v6 offset:31744
    s_waitcnt lgkmcnt(7)
    v_mfma_f32_32x32x16_bf16 v[20:35], v[224:227], v[52:55], v[20:35]
    s_waitcnt lgkmcnt(6)
    v_mfma_f32_32x32x16_bf16 v[20:35], v[228:231], v[56:59], v[20:35]
    s_waitcnt lgkmcnt(5)
    v_mfma_f32_32x32x16_bf16 v[20:35], v[232:235], v[60:63], v[20:35]
    s_waitcnt lgkmcnt(4)
    v_mfma_f32_32x32x16_bf16 v[20:35], v[236:239], v[64:67], v[20:35]
    s_waitcnt lgkmcnt(3)
    v_mfma_f32_32x32x16_bf16 v[20:35], v[240:243], v[68:71], v[20:35]
    s_waitcnt lgkmcnt(2)
    v_mfma_f32_32x32x16_bf16 v[20:35], v[244:247], v[72:75], v[20:35]
    s_waitcnt lgkmcnt(1)
    v_mfma_f32_32x32x16_bf16 v[20:35], v[248:251], v[76:79], v[20:35]
    s_waitcnt lgkmcnt(0)
    v_mfma_f32_32x32x16_bf16 v[20:35], v[252:255], v[80:83], v[20:35]
    v_xor_b32 v6, 0x10000, v6
    s_waitcnt vmcnt(4)
    s_lshr_b32 s64, s58, 1
    s_cmp_eq_u32 s64, s75
    s_cbranch_scc1 wo_j_138
    s_waitcnt vmcnt(2)
wo_j_138:
    s_nop 6
    ds_write_b128 v10, v[20:23]
    ds_write_b128 v11, v[24:27]
    ds_write_b128 v12, v[28:31]
    ds_write_b128 v13, v[32:35]
    v_add_u32 v8, 0x80000, v8
    v_and_b32 v8, 0x1fffff, v8
    s_add_u32 s71, s71, 1
    s_mov_b32 s59, s62
    s_cmp_lg_u32 s69, 0
    s_cbranch_scc1 wo_loop_125
    s_cmp_ge_i32 s63, 0
    s_cbranch_scc1 wo_slow_124
wo_end_127:
    s_waitcnt lgkmcnt(0)
    s_barrier
    ds_read_b64 v[36:37], v14 offset:0
    ds_read_b64 v[44:45], v14 offset:16384
    ds_read_b64 v[38:39], v15 offset:0
    ds_read_b64 v[46:47], v15 offset:16384
    ds_read_b64 v[40:41], v16 offset:0
    ds_read_b64 v[48:49], v16 offset:16384
    ds_read_b64 v[42:43], v17 offset:0
    ds_read_b64 v[50:51], v17 offset:16384
    s_lshr_b32 s64, s58, 1
    s_cmp_lg_u32 s64, s75
    s_cbranch_scc1 wo_s_139
pollpart_140:
    buffer_load_dwordx4 v[92:95], v9, s[8:11], s2 offen offset:0 sc1
    buffer_load_dwordx4 v[96:99], v9, s[8:11], s2 offen offset:1024 sc1
    buffer_load_dwordx4 v[100:103], v9, s[8:11], s3 offen offset:0 sc1
    buffer_load_dwordx4 v[104:107], v9, s[8:11], s3 offen offset:1024 sc1
    buffer_load_dwordx4 v[108:111], v9, s[8:11], s4 offen offset:0 sc1
    buffer_load_dwordx4 v[112:115], v9, s[8:11], s4 offen offset:1024 sc1
    s_waitcnt vmcnt(0)
    v_bitop3_b32 v2, v92, v96, s72 bitop3:0x7e
    v_bitop3_b32 v3, v100, v104, s72 bitop3:0x7e
    v_or_b32 v2, v2, v3
    v_bitop3_b32 v3, v108, v112, s72 bitop3:0x7e
    v_bitop3_b32 v2, v2, v3, 1 bitop3:0xa8
    v_cmp_ne_u32 vcc, 0, v2
    s_cbranch_vccz pollpart_ok_141
    s_sub_u32 s77, s77, 1
    s_cbranch_scc0 pollpart_140
    s_mov_b32 s77, 0
pollpart_ok_141:
    v_pk_add_f32 v[84:85], v[84:85], v[92:93]
    v_pk_add_f32 v[100:101], v[100:101], v[108:109]
    v_pk_add_f32 v[84:85], v[84:85], v[100:101]
    v_cvt_pk_bf16_f32 v92, v84, v85
    buffer_store_dword v92, v7, s[16:19], s68 offen offset:2048
    s_add_u32 s68, s68, 4096
    v_pk_add_f32 v[86:87], v[86:87], v[94:95]
    v_pk_add_f32 v[102:103], v[102:103], v[110:111]
    v_pk_add_f32 v[86:87], v[86:87], v[102:103]
    v_cvt_pk_bf16_f32 v93, v86, v87
    buffer_store_dword v93, v7, s[16:19], s68 offen offset:2048
    s_add_u32 s68, s68, 4096
    v_pk_add_f32 v[88:89], v[88:89], v[96:97]
    v_pk_add_f32 v[104:105], v[104:105], v[112:113]
    v_pk_add_f32 v[88:89], v[88:89], v[104:105]
    v_cvt_pk_bf16_f32 v94, v88, v89
    buffer_store_dword v94, v7, s[16:19], s68 offen offset:2048
    s_add_u32 s68, s68, 4096
    v_pk_add_f32 v[90:91], v[90:91], v[98:99]
    v_pk_add_f32 v[106:107], v[106:107], v[114:115]
    v_pk_add_f32 v[90:91], v[90:91], v[106:107]
    v_cvt_pk_bf16_f32 v95, v90, v91
    buffer_store_dword v95, v7, s[16:19], s68 offen offset:2048
    s_add_u32 s68, s68, 4096
    s_waitcnt lgkmcnt(0)
    v_pk_add_f32 v[84:85], v[36:37], v[44:45]
    v_pk_add_f32 v[86:87], v[38:39], v[46:47]
    v_pk_add_f32 v[88:89], v[40:41], v[48:49]
    v_pk_add_f32 v[90:91], v[42:43], v[50:51]
    s_bfe_u32 s72, s71, 0x10002
    v_mov_b32 v9, v8
    s_lshl_b32 s68, s59, 17
    s_add_u32 s68, s68, s7
pollpart_142:
    buffer_load_dwordx4 v[92:95], v9, s[8:11], s2 offen offset:0 sc1
    buffer_load_dwordx4 v[96:99], v9, s[8:11], s2 offen offset:1024 sc1
    buffer_load_dwordx4 v[100:103], v9, s[8:11], s3 offen offset:0 sc1
    buffer_load_dwordx4 v[104:107], v9, s[8:11], s3 offen offset:1024 sc1
    buffer_load_dwordx4 v[108:111], v9, s[8:11], s4 offen offset:0 sc1
    buffer_load_dwordx4 v[112:115], v9, s[8:11], s4 offen offset:1024 sc1
    s_waitcnt vmcnt(0)
    v_bitop3_b32 v2, v92, v96, s72 bitop3:0x7e
    v_bitop3_b32 v3, v100, v104, s72 bitop3:0x7e
    v_or_b32 v2, v2, v3
    v_bitop3_b32 v3, v108, v112, s72 bitop3:0x7e
    v_bitop3_b32 v2, v2, v3, 1 bitop3:0xa8
    v_cmp_ne_u32 vcc, 0, v2
    s_cbranch_vccz pollpart_ok_143
    s_sub_u32 s77, s77, 1
    s_cbranch_scc0 pollpart_142
    s_mov_b32 s77, 0
pollpart_ok_143:
    v_pk_add_f32 v[84:85], v[84:85], v[92:93]
    v_pk_add_f32 v[100:101], v[100:101], v[108:109]
    v_pk_add_f32 v[84:85], v[84:85], v[100:101]
    v_cvt_pk_bf16_f32 v92, v84, v85
    buffer_store_dword v92, v7, s[16:19], s68 offen offset:2048
    s_add_u32 s68, s68, 4096
    v_pk_add_f32 v[86:87], v[86:87], v[94:95]
    v_pk_add_f32 v[102:103], v[102:103], v[110:111]
    v_pk_add_f32 v[86:87], v[86:87], v[102:103]
    v_cvt_pk_bf16_f32 v93, v86, v87
    buffer_store_dword v93, v7, s[16:19], s68 offen offset:2048
    s_add_u32 s68, s68, 4096
    v_pk_add_f32 v[88:89], v[88:89], v[96:97]
    v_pk_add_f32 v[104:105], v[104:105], v[112:113]
    v_pk_add_f32 v[88:89], v[88:89], v[104:105]
    v_cvt_pk_bf16_f32 v94, v88, v89
    buffer_store_dword v94, v7, s[16:19], s68 offen offset:2048
    s_add_u32 s68, s68, 4096
    v_pk_add_f32 v[90:91], v[90:91], v[98:99]
    v_pk_add_f32 v[106:107], v[106:107], v[114:115]
    v_pk_add_f32 v[90:91], v[90:91], v[106:107]
    v_cvt_pk_bf16_f32 v95, v90, v91
    buffer_store_dword v95, v7, s[16:19], s68 offen offset:2048
    s_add_u32 s68, s68, 4096
    s_branch wo_out_128
wo_s_139:
    s_waitcnt lgkmcnt(0)
    s_bfe_u32 s72, s71, 0x10002
    v_pk_add_f32 v[84:85], v[36:37], v[44:45]
    v_bfi_b32 v84, 1, s72, v84
    v_pk_add_f32 v[86:87], v[38:39], v[46:47]
    buffer_store_dwordx4 v[84:87], v8, s[8:11], s70 offen offset:0 sc1
    v_pk_add_f32 v[88:89], v[40:41], v[48:49]
    v_bfi_b32 v88, 1, s72, v88
    v_pk_add_f32 v[90:91], v[42:43], v[50:51]
    buffer_store_dwordx4 v[88:91], v8, s[8:11], s70 offen offset:1024 sc1
wo_out_128:
end_76:
    s_waitcnt vmcnt(0)
    s_endpgm
.section .rodata,"a"
.p2align 6
.amdhsa_kernel concat_heads__spectral_gfnet__memory_aug_recurrent_mem_tr__prompt_kernel
  .amdhsa_next_free_vgpr 256
  .amdhsa_next_free_sgpr 102
  .amdhsa_accum_offset 256
  .amdhsa_group_segment_fixed_size 0
  .amdhsa_kernarg_size 104
  .amdhsa_user_sgpr_count 2
  .amdhsa_user_sgpr_kernarg_segment_ptr 1
  .amdhsa_system_sgpr_workgroup_id_x 1
  .amdhsa_float_denorm_mode_32 3
  .amdhsa_float_denorm_mode_16_64 3
.end_amdhsa_kernel
```

```asm
; @launch grid=(256,1,1) block=(512,1,1) lds=163840
.amdgcn_target "amdgcn-amd-amdhsa--gfx950"
.text
.globl concat_heads__spectral_gfnet__memory_aug_recurrent_mem_tr__prompt_kernel
.p2align 8
.type concat_heads__spectral_gfnet__memory_aug_recurrent_mem_tr__prompt_kernel,@function
concat_heads__spectral_gfnet__memory_aug_recurrent_mem_tr__prompt_kernel:
    s_load_dwordx2 s[8:9], s[0:1], 96
    s_load_dwordx2 s[12:13], s[0:1], 88
    s_load_dwordx2 s[16:17], s[0:1], 80
    s_load_dwordx2 s[20:21], s[0:1], 40
    s_load_dwordx2 s[24:25], s[0:1], 48
    s_load_dwordx2 s[28:29], s[0:1], 56
    s_load_dwordx2 s[32:33], s[0:1], 64
    s_load_dwordx2 s[36:37], s[0:1], 24
    s_load_dwordx2 s[40:41], s[0:1], 32
    s_load_dwordx2 s[44:45], s[0:1], 0
    s_load_dwordx2 s[48:49], s[0:1], 8
    s_load_dwordx2 s[52:53], s[0:1], 16
    s_mov_b32 s10, 0x10000000
    s_mov_b32 s11, 0x20000
    s_mov_b32 s14, 0x100
    s_mov_b32 s15, 0x20000
    s_mov_b32 s18, 0x800000
    s_mov_b32 s19, 0x20000
    s_mov_b32 s22, 0x800000
    s_mov_b32 s23, 0x20000
    s_mov_b32 s26, 0x800000
    s_mov_b32 s27, 0x20000
    s_mov_b32 s30, 0x800000
    s_mov_b32 s31, 0x20000
    s_mov_b32 s34, 0x800000
    s_mov_b32 s35, 0x20000
    s_mov_b32 s38, 0x400000
    s_mov_b32 s39, 0x20000
    s_mov_b32 s42, 0x4000
    s_mov_b32 s43, 0x20000
    s_mov_b32 s46, 0x400000
    s_mov_b32 s47, 0x20000
    s_mov_b32 s50, 0x201000
    s_mov_b32 s51, 0x20000
    s_mov_b32 s54, 0x201000
    s_mov_b32 s55, 0x20000
    s_waitcnt lgkmcnt(0)
    s_getreg_b32 s56, hwreg(HW_REG_XCC_ID, 0, 3)
    v_lshrrev_b32 v2, 6, v0
    v_and_b32 v1, 63, v0
    v_readfirstlane_b32 s58, v2
    s_nop 0
    s_cmp_lg_u32 s58, 0
    s_cbranch_scc1 notw0_1
    s_lshl_b32 s57, s56, 5
    s_add_u32 s57, s57, 28
    v_mov_b32 v2, s57
    v_mov_b32 v3, 0x5ffffff0
    v_cmp_eq_u32 vcc, 0, v1
    s_nop 1
    v_cndmask_b32 v2, v3, v2, vcc
    v_mov_b32 v3, 1
    buffer_atomic_add v3, v2, s[12:15], 0 offen sc0 sc1
    v_mov_b32 v4, 0x27ff0
    s_waitcnt vmcnt(0)
    v_readfirstlane_b32 s3, v3
    s_nop 1
    v_mov_b32 v3, s3
    ds_write_b32 v4, v3
    s_waitcnt lgkmcnt(0)
notw0_1:
    s_barrier
    v_mov_b32 v4, 0x27ff0
    ds_read_b32 v3, v4
    s_waitcnt lgkmcnt(0)
    v_readfirstlane_b32 s57, v3
    s_nop 0
    s_cmp_lt_u32 s57, 32
    s_cbranch_scc1 go_3
    s_endpgm
go_3:
    s_cmp_ge_u32 s56, 4
    s_cbranch_scc1 bulk_2
    s_and_b32 s64, s57, 3
    s_lshr_b32 s65, s57, 2
    s_lshl_b32 s66, s56, 3
    s_add_u32 s66, s66, s65
    s_and_b32 s67, s58, 3
    s_mov_b32 s69, 0x40000
    v_and_b32 v6, 15, v1
    v_lshlrev_b32 v8, 4, v1
    v_mov_b32 v14, -1
    v_mov_b32 v15, -1
    v_mov_b32 v16, -1
    v_mov_b32 v17, -1
    s_mov_b32 s86, 0
    s_mov_b32 s87, 0
    s_mov_b32 s88, 0
    s_mov_b32 s89, 0
    s_mov_b32 s90, 0
    s_mov_b32 s91, 0
    s_mov_b32 s92, 0
    s_mov_b32 s93, 0
    s_mov_b32 s94, 0
    s_mov_b32 s95, 0
    s_mov_b32 s96, 0
    s_mov_b32 s97, 0
    s_mov_b32 s98, 0
    v_mov_b32 v2, 0x4444
    v_mov_b32 v3, 0xeeee
    v_and_b32 v4, 2, v1
    v_cmp_eq_u32 vcc, 0, v4
    s_nop 1
    v_cndmask_b32 v7, v3, v2, vcc
    v_bfe_u32 v36, v1, 0, 2
    v_lshlrev_b32 v36, 4, v36
    v_bfe_u32 v2, v1, 5, 1
    v_lshl_or_b32 v36, v2, 6, v36
    v_bfe_u32 v2, v1, 2, 2
    v_lshl_or_b32 v36, v2, 10, v36
    v_bfe_u32 v2, v1, 4, 1
    v_lshl_or_b32 v36, v2, 12, v36
    s_lshl_b32 s70, s56, 2
    s_add_u32 s70, s70, s64
    s_lshl_b32 s70, s70, 15
    s_add_u32 s70, s70, 0x4a00000
    s_lshl_b32 s71, s65, 2
    s_add_u32 s71, s71, s67
    s_lshl_b32 s72, s71, 10
    s_add_u32 s78, s70, s72
    s_lshl_b32 s72, s67, 13
    s_add_u32 s79, s70, s72
    s_lshl_b32 s72, s65, 7
    s_add_u32 s79, s79, s72
    s_bfe_u32 s77, s71, 0x20001
    s_lshl_b32 s77, s77, 7
    s_bfe_u32 s72, s71, 0x10000
    s_lshl_b32 s72, s72, 11
    s_or_b32 s77, s77, s72
    s_bfe_u32 s72, s71, 0x10003
    s_lshl_b32 s72, s72, 12
    s_or_b32 s77, s77, s72
    s_bfe_u32 s72, s71, 0x10004
    s_lshl_b32 s72, s72, 14
    s_or_b32 s77, s77, s72
    s_lshl_b32 s72, s56, 9
    s_add_u32 s77, s77, s72
    s_bfe_u32 s76, s58, 0x10000
    s_lshl_b32 s76, s76, 12
    s_bfe_u32 s72, s58, 0x10001
    s_lshl_b32 s72, s72, 14
    s_or_b32 s76, s76, s72
    s_lshl_b32 s72, s64, 15
    s_add_u32 s76, s76, s72
    s_add_u32 s72, s72, 0x20000
    s_add_u32 s77, s77, s72
    s_sub_u32 s7, 0, s8
    s_and_b32 s7, s7, 0x1fffff
    s_add_u32 s7, s7, 0x6c00000
    v_bfe_u32 v37, v1, 0, 2
    v_lshlrev_b32 v37, 4, v37
    v_bfe_u32 v2, v1, 4, 1
    v_lshl_or_b32 v37, v2, 6, v37
    v_bfe_u32 v2, v1, 2, 2
    v_lshl_or_b32 v37, v2, 7, v37
    v_bfe_u32 v2, v1, 5, 1
    v_lshl_or_b32 v37, v2, 9, v37
    v_add_u32 v37, s7, v37
    v_mov_b32 v5, 0x5ffffff0
    v_add_u32 v3, s7, v8
    v_cmp_gt_u32 vcc, 8, v1
    s_nop 1
    v_cndmask_b32 v35, v5, v3, vcc
    s_lshl_b32 s70, s66, 2
    s_add_u32 s70, s70, s67
    s_lshl_b32 s74, s70, 11
    s_add_u32 s74, s74, 0x4900000
    s_cmp_ge_u32 s58, 4
    s_cbranch_scc1 vo_arm_4
    s_lshl_b32 s73, s70, 12
    s_add_u32 s73, s73, 0x4800000
    s_lshl_b32 s71, s64, 10
    v_add_u32 v34, s71, v8
    s_add_u32 s71, s73, 0x80000
    buffer_store_dwordx4 v[14:17], v34, s[8:11], s73 offen
    buffer_store_dwordx4 v[14:17], v34, s[8:11], s71 offen
    v_bfe_u32 v2, v1, 0, 3
    v_lshlrev_b32 v2, 4, v2
    v_bfe_u32 v3, v1, 3, 1
    v_lshl_or_b32 v2, v3, 13, v2
    v_bfe_u32 v3, v1, 4, 2
    v_lshl_or_b32 v2, v3, 17, v2
    v_add_u32 v2, s7, v2
    buffer_store_dwordx4 v[14:17], v2, s[8:11], s77 offen sc1
    s_add_u32 s77, s77, 0x80000
    s_branch arm_done_5
vo_arm_4:
    s_mov_b32 s73, s74
    v_bfe_u32 v34, v1, 0, 4
    v_lshlrev_b32 v34, 4, v34
    v_bfe_u32 v2, v1, 5, 1
    v_lshl_or_b32 v34, v2, 8, v34
    v_bfe_u32 v2, v1, 4, 1
    v_lshl_or_b32 v34, v2, 10, v34
    s_bfe_u32 s71, s64, 0x10000
    s_lshl_b32 s71, s71, 3
    s_bfe_u32 s72, s64, 0x10001
    s_lshl_b32 s72, s72, 9
    s_or_b32 s71, s71, s72
    v_add_u32 v34, s71, v34
    s_add_u32 s71, s73, 0x40000
    buffer_store_dwordx2 v[14:15], v34, s[8:11], s73 offen
    buffer_store_dwordx2 v[14:15], v34, s[8:11], s71 offen
    s_add_u32 s71, s79, 0x80000
    buffer_store_dwordx4 v[14:17], v36, s[8:11], s79 offen
    buffer_store_dwordx4 v[14:17], v36, s[8:11], s71 offen
    s_add_u32 s2, s77, s7
    s_add_u32 s2, s2, 0x1c0000
    v_bfe_u32 v2, v1, 0, 2
    v_lshlrev_b32 v2, 21, v2
    v_bfe_u32 v3, v1, 2, 1
    v_lshl_or_b32 v2, v3, 13, v2
    s_cmp_lg_u32 s58, 4
    s_cbranch_scc1 arm_done_5
    buffer_store_dword v14, v2, s[8:11], s2 offen sc1
arm_done_5:
    v_bfe_u32 v2, v1, 0, 1
    v_lshlrev_b32 v2, 11, v2
    v_bfe_u32 v3, v1, 2, 2
    v_lshl_or_b32 v2, v3, 12, v2
    v_bfe_u32 v3, v1, 1, 1
    v_lshl_or_b32 v2, v3, 8, v2
    v_bfe_u32 v3, v1, 4, 2
    v_lshl_or_b32 v2, v3, 4, v2
    s_lshl_b32 s70, s64, 9
    s_lshl_b32 s71, s67, 6
    s_add_u32 s70, s70, s71
    buffer_load_dwordx4 v[10:13], v2, s[40:43], s70 offen
    v_bfe_u32 v2, v1, 4, 1
    v_lshlrev_b32 v2, 4, v2
    v_bfe_u32 v3, v1, 5, 1
    v_lshl_or_b32 v2, v3, 6, v2
    v_bfe_u32 v3, v1, 4, 2
    v_lshl_or_b32 v2, v3, 13, v2
    v_lshlrev_b32 v3, 4, v6
    v_xor_b32 v38, v2, v3
    v_xor_b32 v39, 0x80, v38
    v_bfe_u32 v2, v1, 5, 1
    v_lshlrev_b32 v2, 5, v2
    v_bfe_u32 v3, v1, 5, 1
    v_lshl_or_b32 v2, v3, 11, v2
    v_bfe_u32 v3, v1, 0, 5
    v_lshlrev_b32 v3, 4, v3
    v_xor_b32 v40, v2, v3
    s_lshl_b32 s71, s67, 6
    v_bfe_u32 v4, v1, 0, 1
    v_lshlrev_b32 v4, 3, v4
    v_bfe_u32 v2, v1, 2, 1
    v_lshl_or_b32 v4, v2, 4, v4
    v_bfe_u32 v2, v1, 1, 1
    v_lshl_or_b32 v4, v2, 5, v4
    v_bfe_u32 v2, v1, 5, 1
    v_lshl_or_b32 v4, v2, 7, v4
    v_bfe_u32 v2, v1, 2, 1
    v_lshl_or_b32 v4, v2, 8, v4
    v_bfe_u32 v2, v1, 4, 2
    v_lshl_or_b32 v4, v2, 10, v4
    v_bfe_u32 v2, v1, 3, 1
    v_lshl_or_b32 v4, v2, 15, v4
    s_lshl_b32 s70, s58, 13
    s_cmp_ge_u32 s58, 4
    s_cselect_b32 s70, 0, s70
    s_or_b32 s70, s70, s71
    v_xor_b32 v41, s70, v4
    v_bfe_u32 v4, v1, 0, 1
    v_lshlrev_b32 v4, 3, v4
    v_bfe_u32 v2, v1, 1, 1
    v_lshl_or_b32 v4, v2, 4, v4
    v_bfe_u32 v2, v1, 2, 1
    v_lshl_or_b32 v4, v2, 5, v4
    v_bfe_u32 v2, v1, 5, 1
    v_lshl_or_b32 v4, v2, 7, v4
    v_bfe_u32 v2, v1, 2, 1
    v_lshl_or_b32 v4, v2, 9, v4
    v_bfe_u32 v2, v1, 5, 1
    v_lshl_or_b32 v4, v2, 11, v4
    v_bfe_u32 v2, v1, 4, 1
    v_lshl_or_b32 v4, v2, 12, v4
    v_bfe_u32 v2, v1, 3, 1
    v_lshl_or_b32 v4, v2, 14, v4
    s_or_b32 s71, s71, 0x10000
    v_xor_b32 v42, s71, v4
    s_lshl_b32 s70, s64, 21
    s_lshl_b32 s71, s58, 18
    s_add_u32 s70, s70, s71
    s_lshl_b32 s71, s66, 8
    s_add_u32 s70, s70, s71
    s_lshl_b32 s71, s58, 13
    s_add_u32 s71, s71, 0
    s_mov_b32 m0, s71
    s_nop 0
    buffer_load_dwordx4 v38, s[24:27], s70 offen lds
    s_add_u32 s71, s71, 0x400
    s_add_u32 s70, s70, 0x8000
    s_mov_b32 m0, s71
    s_nop 0
    buffer_load_dwordx4 v38, s[24:27], s70 offen lds
    s_add_u32 s71, s71, 0x400
    s_add_u32 s70, s70, 0x8000
    s_mov_b32 m0, s71
    s_nop 0
    buffer_load_dwordx4 v39, s[24:27], s70 offen lds
    s_add_u32 s71, s71, 0x400
    s_add_u32 s70, s70, 0x8000
    s_mov_b32 m0, s71
    s_nop 0
    buffer_load_dwordx4 v39, s[24:27], s70 offen lds
    s_add_u32 s71, s71, 0x400
    s_add_u32 s70, s70, 0x8000
    s_mov_b32 m0, s71
    s_nop 0
    buffer_load_dwordx4 v38, s[24:27], s70 offen lds
    s_add_u32 s71, s71, 0x400
    s_add_u32 s70, s70, 0x8000
    s_mov_b32 m0, s71
    s_nop 0
    buffer_load_dwordx4 v38, s[24:27], s70 offen lds
    s_add_u32 s71, s71, 0x400
    s_add_u32 s70, s70, 0x8000
    s_mov_b32 m0, s71
    s_nop 0
    buffer_load_dwordx4 v39, s[24:27], s70 offen lds
    s_add_u32 s71, s71, 0x400
    s_add_u32 s70, s70, 0x8000
    s_mov_b32 m0, s71
    s_nop 0
    buffer_load_dwordx4 v39, s[24:27], s70 offen lds
    s_add_u32 s71, s71, 0x400
    s_add_u32 s70, s70, 0x8000
    s_lshl_b32 s70, s64, 21
    s_lshl_b32 s71, s58, 18
    s_add_u32 s70, s70, s71
    s_lshl_b32 s71, s66, 8
    s_add_u32 s70, s70, s71
    s_lshl_b32 s71, s58, 13
    s_add_u32 s71, s71, 65536
    s_mov_b32 m0, s71
    s_nop 0
    buffer_load_dwordx4 v38, s[28:31], s70 offen lds
    s_add_u32 s71, s71, 0x400
    s_add_u32 s70, s70, 0x8000
    s_mov_b32 m0, s71
    s_nop 0
    buffer_load_dwordx4 v38, s[28:31], s70 offen lds
    s_add_u32 s71, s71, 0x400
    s_add_u32 s70, s70, 0x8000
    s_mov_b32 m0, s71
    s_nop 0
    buffer_load_dwordx4 v39, s[28:31], s70 offen lds
    s_add_u32 s71, s71, 0x400
    s_add_u32 s70, s70, 0x8000
    s_mov_b32 m0, s71
    s_nop 0
    buffer_load_dwordx4 v39, s[28:31], s70 offen lds
    s_add_u32 s71, s71, 0x400
    s_add_u32 s70, s70, 0x8000
    s_mov_b32 m0, s71
    s_nop 0
    buffer_load_dwordx4 v38, s[28:31], s70 offen lds
    s_add_u32 s71, s71, 0x400
    s_add_u32 s70, s70, 0x8000
    s_mov_b32 m0, s71
    s_nop 0
    buffer_load_dwordx4 v38, s[28:31], s70 offen lds
    s_add_u32 s71, s71, 0x400
    s_add_u32 s70, s70, 0x8000
    s_mov_b32 m0, s71
    s_nop 0
    buffer_load_dwordx4 v39, s[28:31], s70 offen lds
    s_add_u32 s71, s71, 0x400
    s_add_u32 s70, s70, 0x8000
    s_mov_b32 m0, s71
    s_nop 0
    buffer_load_dwordx4 v39, s[28:31], s70 offen lds
    s_add_u32 s71, s71, 0x400
    s_add_u32 s70, s70, 0x8000
    s_cmp_lg_u32 s58, 4
    s_cbranch_scc1 novote_6
    s_waitcnt vmcnt(16)
    s_mov_b32 s3, 1
    s_mov_b32 s59, 0
    s_bitcmp1_b32 s57, 0
    s_cselect_b32 s60, -1, 1
    s_cselect_b32 s70, 0x2000, 0
    s_cselect_b32 s71, 0, 0x2000
    s_add_u32 s70, s70, s2
    s_add_u32 s71, s71, s2
    s_mov_b64 s[4:5], 0
    s_buffer_load_dword s4, s[8:11], s70
    s_buffer_load_dword s5, s[8:11], s71
    s_waitcnt lgkmcnt(1)
    s_sub_u32 s72, s4, s5
    s_waitcnt lgkmcnt(0)
    s_mul_i32 s72, s72, s60
    s_add_u32 s72, s72, 1
    s_min_u32 s72, s72, 2
    s_lshl_b32 s72, s72, 10
    s_add_u32 s3, s3, s72
    s_add_u32 s70, s70, 0x200000
    s_add_u32 s71, s71, 0x200000
    s_mov_b64 s[4:5], 0
    s_buffer_load_dword s4, s[8:11], s70
    s_buffer_load_dword s5, s[8:11], s71
    s_waitcnt lgkmcnt(1)
    s_sub_u32 s72, s4, s5
    s_waitcnt lgkmcnt(0)
    s_mul_i32 s72, s72, s60
    s_add_u32 s72, s72, 1
    s_min_u32 s72, s72, 2
    s_lshl_b32 s72, s72, 20
    s_add_u32 s3, s3, s72
    s_add_u32 s70, s70, 0x200000
    s_add_u32 s71, s71, 0x200000
    s_mov_b64 s[4:5], 0
    s_buffer_load_dword s4, s[8:11], s70
    s_buffer_load_dword s5, s[8:11], s71
    s_waitcnt lgkmcnt(1)
    s_sub_u32 s72, s4, s5
    s_waitcnt lgkmcnt(0)
    s_mul_i32 s72, s72, s60
    s_add_u32 s72, s72, 1
    s_min_u32 s72, s72, 2
    s_lshl_b32 s72, s72, 10
    s_add_u32 s59, s59, s72
    s_add_u32 s70, s70, 0x200000
    s_add_u32 s71, s71, 0x200000
    s_mov_b64 s[4:5], 0
    s_buffer_load_dword s4, s[8:11], s70
    s_buffer_load_dword s5, s[8:11], s71
    s_waitcnt lgkmcnt(1)
    s_sub_u32 s72, s4, s5
    s_waitcnt lgkmcnt(0)
    s_mul_i32 s72, s72, s60
    s_add_u32 s72, s72, 1
    s_min_u32 s72, s72, 2
    s_lshl_b32 s72, s72, 20
    s_add_u32 s59, s59, s72
    s_add_u32 s70, s70, 0x200000
    s_add_u32 s71, s71, 0x200000
novote_6:
    s_waitcnt vmcnt(0)
    s_barrier
    s_cmp_lg_u32 s58, 4
    s_cbranch_scc1 nosig_7
    v_mov_b32 v2, s3
    v_mov_b32 v3, s59
    v_cmp_eq_u32 vcc, 0, v1
    v_mov_b32 v5, 32
    v_mov_b32 v4, 0x5ffffff0
    v_cndmask_b32 v4, v4, v5, vcc
    buffer_atomic_add_x2 v[2:3], v4, s[12:15], 0 offen sc1
nosig_7:
    s_cmp_ge_u32 s58, 4
    s_cbranch_scc1 skip_8
    v_xor_b32 v2, 0x0, v41
    v_xor_b32 v3, 0x40, v41
    ds_read_b64_tr_b16 v[192:193], v2 offset:0
    ds_read_b64_tr_b16 v[194:195], v3 offset:512
    ds_read_b64_tr_b16 v[196:197], v2 offset:4096
    ds_read_b64_tr_b16 v[198:199], v3 offset:4608
    v_xor_b32 v2, 0x2000, v41
    v_xor_b32 v3, 0x2040, v41
    ds_read_b64_tr_b16 v[200:201], v2 offset:0
    ds_read_b64_tr_b16 v[202:203], v3 offset:512
    ds_read_b64_tr_b16 v[204:205], v2 offset:4096
    ds_read_b64_tr_b16 v[206:207], v3 offset:4608
    v_xor_b32 v2, 0x4000, v41
    v_xor_b32 v3, 0x4040, v41
    ds_read_b64_tr_b16 v[208:209], v2 offset:0
    ds_read_b64_tr_b16 v[210:211], v3 offset:512
    ds_read_b64_tr_b16 v[212:213], v2 offset:4096
    ds_read_b64_tr_b16 v[214:215], v3 offset:4608
    v_xor_b32 v2, 0x6000, v41
    v_xor_b32 v3, 0x6040, v41
    ds_read_b64_tr_b16 v[216:217], v2 offset:0
    ds_read_b64_tr_b16 v[218:219], v3 offset:512
    ds_read_b64_tr_b16 v[220:221], v2 offset:4096
    ds_read_b64_tr_b16 v[222:223], v3 offset:4608
    s_waitcnt lgkmcnt(0)
    v_xor_b32 v2, 0x10, v41
    v_xor_b32 v3, 0x50, v41
    ds_read_b64_tr_b16 v[224:225], v2 offset:0
    ds_read_b64_tr_b16 v[226:227], v3 offset:512
    ds_read_b64_tr_b16 v[228:229], v2 offset:4096
    ds_read_b64_tr_b16 v[230:231], v3 offset:4608
    v_xor_b32 v2, 0x2010, v41
    v_xor_b32 v3, 0x2050, v41
    ds_read_b64_tr_b16 v[232:233], v2 offset:0
    ds_read_b64_tr_b16 v[234:235], v3 offset:512
    ds_read_b64_tr_b16 v[236:237], v2 offset:4096
    ds_read_b64_tr_b16 v[238:239], v3 offset:4608
    v_xor_b32 v2, 0x4010, v41
    v_xor_b32 v3, 0x4050, v41
    ds_read_b64_tr_b16 v[240:241], v2 offset:0
    ds_read_b64_tr_b16 v[242:243], v3 offset:512
    ds_read_b64_tr_b16 v[244:245], v2 offset:4096
    ds_read_b64_tr_b16 v[246:247], v3 offset:4608
    v_xor_b32 v2, 0x6010, v41
    v_xor_b32 v3, 0x6050, v41
    ds_read_b64_tr_b16 v[248:249], v2 offset:0
    ds_read_b64_tr_b16 v[250:251], v3 offset:512
    ds_read_b64_tr_b16 v[252:253], v2 offset:4096
    ds_read_b64_tr_b16 v[254:255], v3 offset:4608
    s_waitcnt lgkmcnt(0)
skip_8:
    s_cmp_ge_u32 s58, 4
    s_cbranch_scc0 skip_9
    v_xor_b32 v2, 0x10000, v41
    v_xor_b32 v3, 0x10040, v41
    ds_read_b64_tr_b16 v[128:129], v2 offset:0
    ds_read_b64_tr_b16 v[130:131], v3 offset:512
    ds_read_b64_tr_b16 v[132:133], v2 offset:4096
    ds_read_b64_tr_b16 v[134:135], v3 offset:4608
    v_xor_b32 v2, 0x12000, v41
    v_xor_b32 v3, 0x12040, v41
    ds_read_b64_tr_b16 v[136:137], v2 offset:0
    ds_read_b64_tr_b16 v[138:139], v3 offset:512
    ds_read_b64_tr_b16 v[140:141], v2 offset:4096
    ds_read_b64_tr_b16 v[142:143], v3 offset:4608
    v_xor_b32 v2, 0x14000, v41
    v_xor_b32 v3, 0x14040, v41
    ds_read_b64_tr_b16 v[144:145], v2 offset:0
    ds_read_b64_tr_b16 v[146:147], v3 offset:512
    ds_read_b64_tr_b16 v[148:149], v2 offset:4096
    ds_read_b64_tr_b16 v[150:151], v3 offset:4608
    v_xor_b32 v2, 0x16000, v41
    v_xor_b32 v3, 0x16040, v41
    ds_read_b64_tr_b16 v[152:153], v2 offset:0
    ds_read_b64_tr_b16 v[154:155], v3 offset:512
    ds_read_b64_tr_b16 v[156:157], v2 offset:4096
    ds_read_b64_tr_b16 v[158:159], v3 offset:4608
    s_waitcnt lgkmcnt(0)
    v_xor_b32 v2, 0x10010, v41
    v_xor_b32 v3, 0x10050, v41
    ds_read_b64_tr_b16 v[160:161], v2 offset:0
    ds_read_b64_tr_b16 v[162:163], v3 offset:512
    ds_read_b64_tr_b16 v[164:165], v2 offset:4096
    ds_read_b64_tr_b16 v[166:167], v3 offset:4608
    v_xor_b32 v2, 0x12010, v41
    v_xor_b32 v3, 0x12050, v41
    ds_read_b64_tr_b16 v[168:169], v2 offset:0
    ds_read_b64_tr_b16 v[170:171], v3 offset:512
    ds_read_b64_tr_b16 v[172:173], v2 offset:4096
    ds_read_b64_tr_b16 v[174:175], v3 offset:4608
    v_xor_b32 v2, 0x14010, v41
    v_xor_b32 v3, 0x14050, v41
    ds_read_b64_tr_b16 v[176:177], v2 offset:0
    ds_read_b64_tr_b16 v[178:179], v3 offset:512
    ds_read_b64_tr_b16 v[180:181], v2 offset:4096
    ds_read_b64_tr_b16 v[182:183], v3 offset:4608
    v_xor_b32 v2, 0x16010, v41
    v_xor_b32 v3, 0x16050, v41
    ds_read_b64_tr_b16 v[184:185], v2 offset:0
    ds_read_b64_tr_b16 v[186:187], v3 offset:512
    ds_read_b64_tr_b16 v[188:189], v2 offset:4096
    ds_read_b64_tr_b16 v[190:191], v3 offset:4608
    s_waitcnt lgkmcnt(0)
skip_9:
    s_barrier
    s_lshl_b32 s70, s64, 21
    s_lshl_b32 s71, s58, 18
    s_add_u32 s70, s70, s71
    s_lshl_b32 s71, s66, 8
    s_add_u32 s70, s70, s71
    s_lshl_b32 s71, s58, 13
    s_add_u32 s71, s71, 0
    s_mov_b32 m0, s71
    s_nop 0
    buffer_load_dwordx4 v38, s[20:23], s70 offen lds
    s_add_u32 s71, s71, 0x400
    s_add_u32 s70, s70, 0x8000
    s_mov_b32 m0, s71
    s_nop 0
    buffer_load_dwordx4 v38, s[20:23], s70 offen lds
    s_add_u32 s71, s71, 0x400
    s_add_u32 s70, s70, 0x8000
    s_mov_b32 m0, s71
    s_nop 0
    buffer_load_dwordx4 v39, s[20:23], s70 offen lds
    s_add_u32 s71, s71, 0x400
    s_add_u32 s70, s70, 0x8000
    s_mov_b32 m0, s71
    s_nop 0
    buffer_load_dwordx4 v39, s[20:23], s70 offen lds
    s_add_u32 s71, s71, 0x400
    s_add_u32 s70, s70, 0x8000
    s_mov_b32 m0, s71
    s_nop 0
    buffer_load_dwordx4 v38, s[20:23], s70 offen lds
    s_add_u32 s71, s71, 0x400
    s_add_u32 s70, s70, 0x8000
    s_mov_b32 m0, s71
    s_nop 0
    buffer_load_dwordx4 v38, s[20:23], s70 offen lds
    s_add_u32 s71, s71, 0x400
    s_add_u32 s70, s70, 0x8000
    s_mov_b32 m0, s71
    s_nop 0
    buffer_load_dwordx4 v39, s[20:23], s70 offen lds
    s_add_u32 s71, s71, 0x400
    s_add_u32 s70, s70, 0x8000
    s_mov_b32 m0, s71
    s_nop 0
    buffer_load_dwordx4 v39, s[20:23], s70 offen lds
    s_add_u32 s71, s71, 0x400
    s_add_u32 s70, s70, 0x8000
    s_lshl_b32 s70, s66, 18
    s_lshl_b32 s71, s58, 15
    s_add_u32 s70, s70, s71
    s_lshl_b32 s71, s64, 9
    s_add_u32 s70, s70, s71
    s_lshl_b32 s71, s58, 13
    s_add_u32 s71, s71, 65536
    v_xor_b32 v2, 0, v40
    s_mov_b32 m0, s71
    s_nop 0
    buffer_load_dwordx4 v2, s[32:35], s70 offen lds
    s_add_u32 s71, s71, 0x400
    s_add_u32 s70, s70, 0x1000
    v_xor_b32 v2, 64, v40
    s_mov_b32 m0, s71
    s_nop 0
    buffer_load_dwordx4 v2, s[32:35], s70 offen lds
    s_add_u32 s71, s71, 0x400
    s_add_u32 s70, s70, 0x1000
    v_xor_b32 v2, 128, v40
    s_mov_b32 m0, s71
    s_nop 0
    buffer_load_dwordx4 v2, s[32:35], s70 offen lds
    s_add_u32 s71, s71, 0x400
    s_add_u32 s70, s70, 0x1000
    v_xor_b32 v2, 192, v40
    s_mov_b32 m0, s71
    s_nop 0
    buffer_load_dwordx4 v2, s[32:35], s70 offen lds
    s_add_u32 s71, s71, 0x400
    s_add_u32 s70, s70, 0x1000
    v_xor_b32 v2, 0, v40
    s_mov_b32 m0, s71
    s_nop 0
    buffer_load_dwordx4 v2, s[32:35], s70 offen lds
    s_add_u32 s71, s71, 0x400
    s_add_u32 s70, s70, 0x1000
    v_xor_b32 v2, 64, v40
    s_mov_b32 m0, s71
    s_nop 0
    buffer_load_dwordx4 v2, s[32:35], s70 offen lds
    s_add_u32 s71, s71, 0x400
    s_add_u32 s70, s70, 0x1000
    v_xor_b32 v2, 128, v40
    s_mov_b32 m0, s71
    s_nop 0
    buffer_load_dwordx4 v2, s[32:35], s70 offen lds
    s_add_u32 s71, s71, 0x400
    s_add_u32 s70, s70, 0x1000
    v_xor_b32 v2, 192, v40
    s_mov_b32 m0, s71
    s_nop 0
    buffer_load_dwordx4 v2, s[32:35], s70 offen lds
    s_add_u32 s71, s71, 0x400
    s_add_u32 s70, s70, 0x1000
    s_waitcnt vmcnt(0)
    s_barrier
    s_cmp_ge_u32 s58, 4
    s_cbranch_scc1 skip_10
    v_xor_b32 v2, 0x0, v41
    v_xor_b32 v3, 0x40, v41
    ds_read_b64_tr_b16 v[128:129], v2 offset:0
    ds_read_b64_tr_b16 v[130:131], v3 offset:512
    ds_read_b64_tr_b16 v[132:133], v2 offset:4096
    ds_read_b64_tr_b16 v[134:135], v3 offset:4608
    v_xor_b32 v2, 0x2000, v41
    v_xor_b32 v3, 0x2040, v41
    ds_read_b64_tr_b16 v[136:137], v2 offset:0
    ds_read_b64_tr_b16 v[138:139], v3 offset:512
    ds_read_b64_tr_b16 v[140:141], v2 offset:4096
    ds_read_b64_tr_b16 v[142:143], v3 offset:4608
    v_xor_b32 v2, 0x4000, v41
    v_xor_b32 v3, 0x4040, v41
    ds_read_b64_tr_b16 v[144:145], v2 offset:0
    ds_read_b64_tr_b16 v[146:147], v3 offset:512
    ds_read_b64_tr_b16 v[148:149], v2 offset:4096
    ds_read_b64_tr_b16 v[150:151], v3 offset:4608
    v_xor_b32 v2, 0x6000, v41
    v_xor_b32 v3, 0x6040, v41
    ds_read_b64_tr_b16 v[152:153], v2 offset:0
    ds_read_b64_tr_b16 v[154:155], v3 offset:512
    ds_read_b64_tr_b16 v[156:157], v2 offset:4096
    ds_read_b64_tr_b16 v[158:159], v3 offset:4608
    s_waitcnt lgkmcnt(0)
    v_xor_b32 v2, 0x10, v41
    v_xor_b32 v3, 0x50, v41
    ds_read_b64_tr_b16 v[160:161], v2 offset:0
    ds_read_b64_tr_b16 v[162:163], v3 offset:512
    ds_read_b64_tr_b16 v[164:165], v2 offset:4096
    ds_read_b64_tr_b16 v[166:167], v3 offset:4608
    v_xor_b32 v2, 0x2010, v41
    v_xor_b32 v3, 0x2050, v41
    ds_read_b64_tr_b16 v[168:169], v2 offset:0
    ds_read_b64_tr_b16 v[170:171], v3 offset:512
    ds_read_b64_tr_b16 v[172:173], v2 offset:4096
    ds_read_b64_tr_b16 v[174:175], v3 offset:4608
    v_xor_b32 v2, 0x4010, v41
    v_xor_b32 v3, 0x4050, v41
    ds_read_b64_tr_b16 v[176:177], v2 offset:0
    ds_read_b64_tr_b16 v[178:179], v3 offset:512
    ds_read_b64_tr_b16 v[180:181], v2 offset:4096
    ds_read_b64_tr_b16 v[182:183], v3 offset:4608
    v_xor_b32 v2, 0x6010, v41
    v_xor_b32 v3, 0x6050, v41
    ds_read_b64_tr_b16 v[184:185], v2 offset:0
    ds_read_b64_tr_b16 v[186:187], v3 offset:512
    ds_read_b64_tr_b16 v[188:189], v2 offset:4096
    ds_read_b64_tr_b16 v[190:191], v3 offset:4608
    s_waitcnt lgkmcnt(0)
skip_10:
    s_cmp_ge_u32 s58, 4
    s_cbranch_scc0 skip_11
    v_xor_b32 v2, 0, v42
    v_xor_b32 v3, 64, v42
    ds_read_b64_tr_b16 v[192:193], v2 offset:0
    ds_read_b64_tr_b16 v[194:195], v3 offset:1024
    ds_read_b64_tr_b16 v[196:197], v2 offset:8192
    ds_read_b64_tr_b16 v[198:199], v3 offset:9216
    ds_read_b64_tr_b16 v[200:201], v2 offset:32768
    ds_read_b64_tr_b16 v[202:203], v3 offset:33792
    ds_read_b64_tr_b16 v[204:205], v2 offset:40960
    ds_read_b64_tr_b16 v[206:207], v3 offset:41984
    ds_read_b64_tr_b16 v[224:225], v2 offset:256
    ds_read_b64_tr_b16 v[226:227], v3 offset:1280
    ds_read_b64_tr_b16 v[228:229], v2 offset:8448
    ds_read_b64_tr_b16 v[230:231], v3 offset:9472
    ds_read_b64_tr_b16 v[232:233], v2 offset:33024
    ds_read_b64_tr_b16 v[234:235], v3 offset:34048
    ds_read_b64_tr_b16 v[236:237], v2 offset:41216
    ds_read_b64_tr_b16 v[238:239], v3 offset:42240
    s_waitcnt lgkmcnt(0)
    v_xor_b32 v2, 32, v42
    v_xor_b32 v3, 96, v42
    ds_read_b64_tr_b16 v[208:209], v2 offset:0
    ds_read_b64_tr_b16 v[210:211], v3 offset:1024
    ds_read_b64_tr_b16 v[212:213], v2 offset:8192
    ds_read_b64_tr_b16 v[214:215], v3 offset:9216
    ds_read_b64_tr_b16 v[216:217], v2 offset:32768
    ds_read_b64_tr_b16 v[218:219], v3 offset:33792
    ds_read_b64_tr_b16 v[220:221], v2 offset:40960
    ds_read_b64_tr_b16 v[222:223], v3 offset:41984
    ds_read_b64_tr_b16 v[240:241], v2 offset:256
    ds_read_b64_tr_b16 v[242:243], v3 offset:1280
    ds_read_b64_tr_b16 v[244:245], v2 offset:8448
    ds_read_b64_tr_b16 v[246:247], v3 offset:9472
    ds_read_b64_tr_b16 v[248:249], v2 offset:33024
    ds_read_b64_tr_b16 v[250:251], v3 offset:34048
    ds_read_b64_tr_b16 v[252:253], v2 offset:41216
    ds_read_b64_tr_b16 v[254:255], v3 offset:42240
    s_waitcnt lgkmcnt(0)
skip_11:
    v_mov_b32 v4, 0x27ff0
    s_cmp_lg_u32 s58, 4
    s_cbranch_scc1 armw_12
armwait_13:
    buffer_load_dwordx2 v[2:3], off, s[12:15], 0 offset:32 sc1
    s_waitcnt vmcnt(0)
    v_and_b32 v5, 0x3ff, v2
    v_cmp_gt_u32 vcc, 128, v5
    s_cbranch_vccz armwait_ok_14
    s_sub_u32 s69, s69, 1
    s_cbranch_scc0 armwait_13
    s_mov_b32 s69, 0
armwait_ok_14:
    ds_write_b64 v4, v[2:3]
    s_waitcnt lgkmcnt(0)
armw_12:
    s_barrier
    ds_read_b64 v[2:3], v4
    s_mov_b32 s59, 0
    s_waitcnt lgkmcnt(0)
    v_readfirstlane_b32 s70, v2
    v_readfirstlane_b32 s71, v3
    s_bfe_u32 s72, s70, 0xa000a
    s_cmp_gt_u32 s72, 128
    s_cselect_b32 s72, 1, 0
    s_or_b32 s59, s59, s72
    s_bfe_u32 s72, s70, 0xa0014
    s_cmp_gt_u32 s72, 128
    s_cselect_b32 s72, 2, 0
    s_or_b32 s59, s59, s72
    s_bfe_u32 s72, s71, 0xa000a
    s_cmp_gt_u32 s72, 128
    s_cselect_b32 s72, 4, 0
    s_or_b32 s59, s59, s72
    s_bfe_u32 s72, s71, 0xa0014
    s_cmp_gt_u32 s72, 128
    s_cselect_b32 s72, 8, 0
    s_or_b32 s59, s59, s72
    s_and_b32 s70, s59, 1
    s_lshl_b32 s70, s70, 13
    s_add_u32 s77, s77, s70
    s_add_u32 s76, s76, s70
    s_mov_b32 s68, 0
    s_mov_b32 s82, 0
    s_lshl_b32 s80, s66, 11
    s_lshl_b32 s70, s67, 9
    s_add_u32 s80, s80, s70
    s_cmp_ge_u32 s58, 4
    s_cbranch_scc1 vo_main_15
    s_setprio 3
    v_bfe_u32 v111, v1, 0, 3
    v_lshlrev_b32 v111, 4, v111
    v_bfe_u32 v2, v1, 3, 1
    v_lshl_or_b32 v111, v2, 8, v111
    v_bfe_u32 v2, v1, 4, 2
    v_lshl_or_b32 v111, v2, 9, v111
    s_lshl_b32 s75, s66, 13
    s_lshl_b32 s70, s67, 11
    s_add_u32 s75, s75, s70
    s_add_u32 s75, s75, 0x1000000
    s_add_u32 s78, s70, 13312
    v_mov_b32 v113, 128
    s_mov_b32 s2, 128
    s_lshl_b32 s70, s66, 4
    s_lshl_b32 s71, s64, 2
    s_add_u32 s71, s71, s67
    s_add_u32 s3, s70, s71
    s_add_u32 s80, s80, 0x4000000
    s_lshl_b32 s70, s67, 10
    v_add_u32 v108, s70, v8
    v_lshrrev_b32 v109, 2, v108
    v_bfe_u32 v2, v1, 0, 3
    v_lshlrev_b32 v2, 4, v2
    v_bfe_u32 v3, v1, 4, 2
    v_lshl_or_b32 v2, v3, 7, v2
    v_mov_b32 v3, 0x5ffffff0
    v_cmp_le_u32 vcc, 8, v6
    s_nop 1
    v_cndmask_b32 v110, v3, v2, vcc
    v_xor_b32 v106, 1024, v108
    v_xor_b32 v107, 2048, v108
    v_xor_b32 v36, 3072, v108
    v_xor_b32 v116, 0x400, v34
    v_bfe_u32 v115, v1, 0, 4
    v_lshlrev_b32 v115, 4, v115
    v_bfe_u32 v2, v1, 4, 2
    v_lshl_or_b32 v115, v2, 9, v115
    s_lshl_b32 s70, s64, 10
    s_xor_b32 s70, s70, 0x800
    v_xor_b32 v115, s70, v115
    v_and_b32 v2, 1, v1
    v_lshlrev_b32 v2, 4, v2
    v_mov_b32 v3, 0x3f80
    v_lshlrev_b32 v2, v2, v3
    v_bfe_u32 v3, v1, 1, 1
    v_bfe_u32 v4, v1, 3, 1
    v_lshl_or_b32 v3, v4, 1, v3
    v_bfe_u32 v4, v1, 2, 1
    v_lshl_or_b32 v3, v4, 2, v3
    v_bfe_u32 v4, v1, 4, 1
    v_lshlrev_b32 v4, 2, v4
    v_xor_b32 v3, v3, v4
    v_cmp_eq_u32 vcc, 0, v3
    s_nop 1
    v_cndmask_b32 v26, 0, v2, vcc
    v_cmp_eq_u32 vcc, 1, v3
    s_nop 1
    v_cndmask_b32 v27, 0, v2, vcc
    v_cmp_eq_u32 vcc, 2, v3
    s_nop 1
    v_cndmask_b32 v28, 0, v2, vcc
    v_cmp_eq_u32 vcc, 3, v3
    s_nop 1
    v_cndmask_b32 v29, 0, v2, vcc
    v_bfe_u32 v3, v1, 1, 1
    v_bfe_u32 v4, v1, 3, 1
    v_lshl_or_b32 v3, v4, 1, v3
    v_bfe_u32 v4, v1, 4, 1
    v_lshl_or_b32 v3, v4, 2, v3
    v_bfe_u32 v4, v1, 2, 1
    v_lshl_or_b32 v3, v4, 3, v3
    v_bfe_u32 v4, v1, 5, 1
    v_lshlrev_b32 v4, 3, v4
    v_xor_b32 v3, v3, v4
    v_cmp_eq_u32 vcc, 0, v3
    s_nop 1
    v_cndmask_b32 v98, 0, v2, vcc
    v_cmp_eq_u32 vcc, 1, v3
    s_nop 1
    v_cndmask_b32 v99, 0, v2, vcc
    v_cmp_eq_u32 vcc, 2, v3
    s_nop 1
    v_cndmask_b32 v100, 0, v2, vcc
    v_cmp_eq_u32 vcc, 3, v3
    s_nop 1
    v_cndmask_b32 v101, 0, v2, vcc
    v_cmp_eq_u32 vcc, 4, v3
    s_nop 1
    v_cndmask_b32 v102, 0, v2, vcc
    v_cmp_eq_u32 vcc, 5, v3
    s_nop 1
    v_cndmask_b32 v103, 0, v2, vcc
    v_cmp_eq_u32 vcc, 6, v3
    s_nop 1
    v_cndmask_b32 v104, 0, v2, vcc
    v_cmp_eq_u32 vcc, 7, v3
    s_nop 1
    v_cndmask_b32 v105, 0, v2, vcc
    v_bfe_u32 v3, v1, 2, 1
    v_bfe_u32 v4, v1, 1, 1
    v_lshl_or_b32 v3, v4, 1, v3
    v_bfe_u32 v4, v1, 3, 1
    v_lshl_or_b32 v3, v4, 2, v3
    v_bfe_u32 v4, v1, 4, 1
    v_lshlrev_b32 v4, 2, v4
    v_xor_b32 v3, v3, v4
    v_cmp_eq_u32 vcc, 0, v3
    s_nop 1
    v_cndmask_b32 v30, 0, v2, vcc
    v_cmp_eq_u32 vcc, 1, v3
    s_nop 1
    v_cndmask_b32 v31, 0, v2, vcc
    v_cmp_eq_u32 vcc, 2, v3
    s_nop 1
    v_cndmask_b32 v32, 0, v2, vcc
    v_cmp_eq_u32 vcc, 3, v3
    s_nop 1
    v_cndmask_b32 v33, 0, v2, vcc
    v_mov_b32 v38, 0
    v_mov_b32 v39, 0
    v_mov_b32 v40, 0
    v_mov_b32 v41, 0
    v_mov_b32 v42, 0
    v_mov_b32 v43, 0
    v_mov_b32 v44, 0
    v_mov_b32 v45, 0
    v_mov_b32 v46, 0
    v_mov_b32 v47, 0
    v_mov_b32 v48, 0
    v_mov_b32 v49, 0
    v_mov_b32 v50, 0
    v_mov_b32 v51, 0
    v_mov_b32 v52, 0
    v_mov_b32 v53, 0
    s_barrier
    s_add_u32 s70, s75, 0x1000000
    s_mov_b32 m0, s78
    buffer_load_dwordx4 v[90:93], v111, s[8:11], s75 offen
    buffer_load_dwordx4 v111, s[8:11], s70 offen lds
    s_add_u32 m0, s78, 896
    buffer_load_dwordx4 v[94:97], v111, s[8:11], s75 offen offset:128
    buffer_load_dwordx4 v111, s[8:11], s70 offen offset:128 lds
    s_add_u32 s75, s75, 0x40000
    s_lshl_b32 s70, s64, 9
    s_add_u32 s70, s70, s75
    s_add_u32 s71, s70, 0x1000000
    s_buffer_load_dword s4, s[8:11], s70 offset:0
    s_buffer_load_dword s5, s[8:11], s71 offset:0
    s_buffer_load_dword s4, s[8:11], s70 offset:128
    s_buffer_load_dword s5, s[8:11], s71 offset:128
    s_buffer_load_dword s4, s[8:11], s70 offset:256
    s_buffer_load_dword s5, s[8:11], s71 offset:256
    s_buffer_load_dword s4, s[8:11], s70 offset:384
    s_buffer_load_dword s5, s[8:11], s71 offset:384
    s_waitcnt vmcnt(0)
qk_loop_17:
    ds_write_b128 v108, v[10:13] offset:0
    s_waitcnt lgkmcnt(0)
    s_barrier
    ds_read_b128 v[14:17], v106 offset:0
    ds_read_b128 v[18:21], v107 offset:0
    ds_read_b128 v[22:25], v36 offset:0
    v_smfmac_f32_16x16x64_bf16 v[38:41], v[10:13], v[128:135], v7
    v_smfmac_f32_16x16x64_bf16 v[42:45], v[10:13], v[160:167], v7
    v_smfmac_f32_16x16x64_bf16 v[46:49], v[10:13], v[192:199], v7
    v_smfmac_f32_16x16x64_bf16 v[50:53], v[10:13], v[224:231], v7
    s_waitcnt lgkmcnt(2)
    v_smfmac_f32_16x16x64_bf16 v[38:41], v[14:17], v[136:143], v7
    v_smfmac_f32_16x16x64_bf16 v[42:45], v[14:17], v[168:175], v7
    s_waitcnt lgkmcnt(1)
    v_smfmac_f32_16x16x64_bf16 v[38:41], v[18:21], v[144:151], v7
    v_smfmac_f32_16x16x64_bf16 v[42:45], v[18:21], v[176:183], v7
    s_waitcnt lgkmcnt(0)
    v_smfmac_f32_16x16x64_bf16 v[38:41], v[22:25], v[152:159], v7
    v_smfmac_f32_16x16x64_bf16 v[42:45], v[22:25], v[184:191], v7
    v_smfmac_f32_16x16x64_bf16 v[46:49], v[14:17], v[200:207], v7
    v_smfmac_f32_16x16x64_bf16 v[46:49], v[18:21], v[208:215], v7
    v_smfmac_f32_16x16x64_bf16 v[46:49], v[22:25], v[216:223], v7
    v_smfmac_f32_16x16x64_bf16 v[50:53], v[14:17], v[232:239], v7
    s_nop 1
    v_smfmac_f32_16x16x64_bf16 v[50:53], v[18:21], v[240:247], v7
    v_pk_add_f32 v[38:39], v[38:39], v[40:41]
    v_cvt_pk_bf16_f32 v86, v38, v39
    v_smfmac_f32_16x16x64_bf16 v[50:53], v[22:25], v[248:255], v7
    v_pk_add_f32 v[42:43], v[42:43], v[44:45]
    v_cvt_pk_bf16_f32 v87, v42, v43
    v_pk_add_f32 v[46:47], v[46:47], v[48:49]
    v_cvt_pk_bf16_f32 v88, v46, v47
    v_permlane16_swap_b32 v86, v87
    v_bfi_b32 v86, 1, s82, v86
    s_nop 1
    v_pk_add_f32 v[50:51], v[50:51], v[52:53]
    v_cvt_pk_bf16_f32 v89, v50, v51
    s_nop 1
    v_permlane16_swap_b32 v88, v89
    buffer_store_dwordx4 v[86:89], v34, s[8:11], s73 offen
    s_nop 15
    buffer_load_dwordx4 v[54:57], v116, s[8:11], s73 offen sc1
    buffer_load_dwordx4 v[58:61], v115, s[8:11], s73 offen sc1
    buffer_load_dwordx4 v[62:65], v115, s[8:11], s73 offen offset:256 sc1
    v_mfma_f32_16x16x32_bf16 v[78:81], v[86:89], v[98:101], 0
    v_mfma_f32_16x16x32_bf16 v[82:85], v[86:89], v[102:105], 0
    v_mov_b32 v38, 0
    v_mov_b32 v39, 0
    v_mov_b32 v40, 0
    v_mov_b32 v41, 0
    v_mov_b32 v42, 0
    v_mov_b32 v43, 0
    v_mov_b32 v44, 0
    v_mov_b32 v45, 0
    v_mov_b32 v46, 0
    v_mov_b32 v47, 0
    v_mov_b32 v48, 0
    v_mov_b32 v49, 0
    v_mov_b32 v50, 0
    v_mov_b32 v51, 0
    v_mov_b32 v52, 0
    v_mov_b32 v53, 0
    s_nop 15
    buffer_load_dwordx4 v[66:69], v116, s[8:11], s73 offen sc1
    buffer_load_dwordx4 v[70:73], v115, s[8:11], s73 offen sc1
    buffer_load_dwordx4 v[74:77], v115, s[8:11], s73 offen offset:256 sc1
    s_waitcnt vmcnt(5)
    v_mfma_f32_16x16x32_bf16 v[18:21], v[54:57], v[98:101], v[78:81]
    v_mfma_f32_16x16x32_bf16 v[22:25], v[54:57], v[102:105], v[82:85]
    s_waitcnt vmcnt(4)
    v_mfma_f32_16x16x32_bf16 v[18:21], v[58:61], v[26:29], v[18:21]
    s_waitcnt vmcnt(3)
    v_mfma_f32_16x16x32_bf16 v[22:25], v[62:65], v[26:29], v[22:25]
    v_bitop3_b32 v2, v54, v58, s82 bitop3:0x7e
    v_xor_b32 v3, s82, v62
    v_bitop3_b32 v2, v2, v3, 1 bitop3:0xa8
    v_cmp_ne_u32 vcc, 0, v2
    s_cbranch_vccnz x_s_18
x_j_19:
    s_nop 1
    v_cvt_pk_bf16_f32 v86, v18, v19
    v_cvt_pk_bf16_f32 v87, v20, v21
    v_cvt_pk_bf16_f32 v88, v22, v23
    v_cvt_pk_bf16_f32 v89, v24, v25
    s_nop 1
    v_mfma_f32_16x16x32_bf16 v[18:21], v[86:89], v[86:89], 0
    s_nop 1
    v_mfma_f32_16x16x32_bf16 v[14:17], v[94:97], v[86:89], 0
    s_nop 1
    v_mfma_f32_16x16x32_bf16 v[10:13], v[90:93], v[86:89], 0
    s_nop 1
    v_mov_b32_dpp v18, v20 row_shr:8 row_mask:0xf bank_mask:0xc
    v_mov_b32_dpp v19, v21 row_shr:8 row_mask:0xf bank_mask:0xc
    s_nop 1
    v_permlane32_swap_b32 v18, v19
    ds_write_b32 v109, v19 offset:8192
    v_mov_b32_dpp v10, v14 row_shr:8 row_mask:0xf bank_mask:0xc
    v_mov_b32_dpp v11, v15 row_shr:8 row_mask:0xf bank_mask:0xc
    v_mov_b32_dpp v12, v16 row_shr:8 row_mask:0xf bank_mask:0xc
    v_mov_b32_dpp v13, v17 row_shr:8 row_mask:0xf bank_mask:0xc
    ds_write_b128 v108, v[10:13] offset:4096
    s_and_b32 s72, s68, 3
    s_waitcnt lgkmcnt(0)
    s_barrier
    s_setprio 0
    s_cmp_lg_u32 s72, s64
    s_cbranch_scc1 nokm_20
    v_min_u32 v86, -2, v86
    buffer_store_dwordx4 v[86:89], v110, s[8:11], s80 offen sc1
nokm_20:
    s_cmp_eq_u32 s68, 63
    s_cbranch_scc1 chain_end_16
    s_cmp_lg_u32 s72, 3
    s_cbranch_scc1 kv7_22
    v_cmp_gt_u16 vcc, s2, v112
    s_cbranch_vccz kv8_23
kvw_26:
    buffer_load_dword v112, v113, s[12:15], 0 offen sc1
    s_waitcnt vmcnt(0)
    v_cmp_gt_u16 vcc, s2, v112
    s_cbranch_vccz kvw_ok_27
    s_sub_u32 s69, s69, 1
    s_cbranch_scc0 kvw_26
    s_mov_b32 s69, 0
kvw_ok_27:
kv8_23:
    s_cmp_ge_u32 s68, 19
    s_cselect_b32 s70, 32, 128
    s_min_u32 s2, s2, s70
kv7_22:
    s_add_u32 s70, s75, 0x1000000
    s_mov_b32 m0, s78
    buffer_load_dwordx4 v[90:93], v111, s[8:11], s75 offen
    buffer_load_dwordx4 v111, s[8:11], s70 offen lds
    s_add_u32 m0, s78, 896
    buffer_load_dwordx4 v[94:97], v111, s[8:11], s75 offen offset:128
    buffer_load_dwordx4 v111, s[8:11], s70 offen offset:128 lds
    s_add_u32 s75, s75, 0x40000
    v_mov_b32 v10, -1
    v_mov_b32 v11, -1
    v_mov_b32 v12, -1
    v_mov_b32 v13, -1
    buffer_store_dwordx4 v[10:13], v35, s[8:11], s77 offen sc1
    s_add_u32 s77, s77, 0x20000
    s_lshr_b32 s60, s77, 21
    s_bitcmp1_b32 s59, s60
    s_cselect_b32 s60, 0x2000, 0
    s_bitset0_b32 s77, 13
    s_or_b32 s77, s77, s60
    s_cmp_lg_u32 s3, 1
    s_cbranch_scc1 noprog_24
    v_mov_b32 v2, s68
    buffer_store_dword v2, off, s[12:15], 0 offset:64 sc1
noprog_24:
    s_cmp_lg_u32 s72, 1
    s_cbranch_scc1 kv6_21
    s_cmp_ge_u32 s68, 21
    s_cselect_b32 s70, -8, -4
    s_add_u32 s71, s68, 131
    s_and_b32 s70, s70, s71
    v_mov_b32 v113, s70
    buffer_load_dword v112, v113, s[12:15], 0 offen sc1
kv6_21:
    s_barrier
    s_add_u32 s80, s80, 0x10000
    s_cmp_lg_u32 s72, 2
    s_cbranch_scc1 pf_28
    v_cmp_gt_u16 vcc, s2, v112
    s_cbranch_vccnz nopf_29
pf_28:
    s_lshl_b32 s70, s64, 9
    s_add_u32 s70, s70, s75
    s_add_u32 s71, s70, 0x1000000
    s_buffer_load_dword s4, s[8:11], s70 offset:0
    s_buffer_load_dword s5, s[8:11], s71 offset:0
    s_buffer_load_dword s4, s[8:11], s70 offset:128
    s_buffer_load_dword s5, s[8:11], s71 offset:128
    s_buffer_load_dword s4, s[8:11], s70 offset:256
    s_buffer_load_dword s5, s[8:11], s71 offset:256
    s_buffer_load_dword s4, s[8:11], s70 offset:384
    s_buffer_load_dword s5, s[8:11], s71 offset:384
nopf_29:
    s_add_u32 s76, s76, 0x20000
    s_lshr_b32 s60, s76, 21
    s_bitcmp1_b32 s59, s60
    s_cselect_b32 s60, 0x2000, 0
    s_bitset0_b32 s76, 13
    s_or_b32 s76, s76, s60
    s_add_u32 s68, s68, 1
    s_bfe_u32 s82, s68, 0x10001
    s_xor_b32 s73, s73, 0x80000
    s_setprio 3
    s_barrier
    s_nop 15
    s_nop 15
    s_nop 15
    s_nop 15
    s_nop 15
    s_nop 15
    s_nop 15
    buffer_load_dwordx4 v[54:57], v37, s[8:11], s76 offen offset:0 sc1
    buffer_load_dwordx4 v[58:61], v37, s[8:11], s76 offen offset:1024 sc1
    buffer_load_dwordx4 v[62:65], v37, s[8:11], s76 offen offset:2048 sc1
    buffer_load_dwordx4 v[66:69], v37, s[8:11], s76 offen offset:3072 sc1
    s_waitcnt vmcnt(3)
    v_mfma_f32_16x16x32_bf16 v[78:81], v[54:57], v[30:33], 0
    s_waitcnt vmcnt(2)
    v_mfma_f32_16x16x32_bf16 v[78:81], v[58:61], v[30:33], v[78:81]
    s_waitcnt vmcnt(1)
    v_mfma_f32_16x16x32_bf16 v[82:85], v[62:65], v[30:33], 0
    s_waitcnt vmcnt(0)
    v_mfma_f32_16x16x32_bf16 v[82:85], v[66:69], v[30:33], v[82:85]
    v_max3_u32 v2, v54, v58, v62
    v_max_u32 v2, v2, v66
    v_cmp_eq_u32 vcc, -1, v2
    s_cbranch_vccnz c_s_30
c_j_31:
    s_nop 1
    v_cvt_pk_bf16_f32 v10, v78, v79
    v_cvt_pk_bf16_f32 v11, v80, v81
    v_cvt_pk_bf16_f32 v12, v82, v83
    v_cvt_pk_bf16_f32 v13, v84, v85
    s_branch qk_loop_17
x_s_18:
    buffer_load_dwordx4 v[54:57], v116, s[8:11], s73 offen sc1
    buffer_load_dwordx4 v[58:61], v115, s[8:11], s73 offen sc1
    buffer_load_dwordx4 v[62:65], v115, s[8:11], s73 offen offset:256 sc1
    s_waitcnt vmcnt(3)
    v_mfma_f32_16x16x32_bf16 v[18:21], v[66:69], v[98:101], v[78:81]
    v_mfma_f32_16x16x32_bf16 v[22:25], v[66:69], v[102:105], v[82:85]
    v_mfma_f32_16x16x32_bf16 v[18:21], v[70:73], v[26:29], v[18:21]
    v_mfma_f32_16x16x32_bf16 v[22:25], v[74:77], v[26:29], v[22:25]
    v_bitop3_b32 v2, v66, v70, s82 bitop3:0x7e
    v_xor_b32 v3, s82, v74
    v_bitop3_b32 v2, v2, v3, 1 bitop3:0xa8
    v_cmp_ne_u32 vcc, 0, v2
    s_cbranch_vccz x_j_19
    buffer_load_dwordx4 v[66:69], v116, s[8:11], s73 offen sc1
    buffer_load_dwordx4 v[70:73], v115, s[8:11], s73 offen sc1
    buffer_load_dwordx4 v[74:77], v115, s[8:11], s73 offen offset:256 sc1
    s_waitcnt vmcnt(3)
    v_mfma_f32_16x16x32_bf16 v[18:21], v[54:57], v[98:101], v[78:81]
    v_mfma_f32_16x16x32_bf16 v[22:25], v[54:57], v[102:105], v[82:85]
    v_mfma_f32_16x16x32_bf16 v[18:21], v[58:61], v[26:29], v[18:21]
    v_mfma_f32_16x16x32_bf16 v[22:25], v[62:65], v[26:29], v[22:25]
    v_bitop3_b32 v2, v54, v58, s82 bitop3:0x7e
    v_xor_b32 v3, s82, v62
    v_bitop3_b32 v2, v2, v3, 1 bitop3:0xa8
    v_cmp_ne_u32 vcc, 0, v2
    s_cbranch_vccz x_j_19
    s_sub_u32 s69, s69, 1
    s_cbranch_scc0 x_s_18
    s_mov_b32 s69, 0
    s_branch x_j_19
c_s_30:
    buffer_load_dwordx4 v[54:57], v37, s[8:11], s76 offen offset:0 sc1
    buffer_load_dwordx4 v[58:61], v37, s[8:11], s76 offen offset:1024 sc1
    buffer_load_dwordx4 v[62:65], v37, s[8:11], s76 offen offset:2048 sc1
    buffer_load_dwordx4 v[66:69], v37, s[8:11], s76 offen offset:3072 sc1
    s_waitcnt vmcnt(0)
    v_mfma_f32_16x16x32_bf16 v[78:81], v[54:57], v[30:33], 0
    v_mfma_f32_16x16x32_bf16 v[78:81], v[58:61], v[30:33], v[78:81]
    v_mfma_f32_16x16x32_bf16 v[82:85], v[62:65], v[30:33], 0
    v_mfma_f32_16x16x32_bf16 v[82:85], v[66:69], v[30:33], v[82:85]
    v_max3_u32 v2, v54, v58, v62
    v_max_u32 v2, v2, v66
    v_cmp_eq_u32 vcc, -1, v2
    s_cbranch_vccz c_j_31
    s_sub_u32 s69, s69, 1
    s_cbranch_scc0 c_s_30
    s_mov_b32 s69, 0
    s_branch c_j_31
vo_main_15:
    s_setprio 1
    v_mov_b32 v86, 0x3f803f80
    v_mov_b32 v90, 0x3e803e80
    v_mov_b32 v87, 0x3f803f80
    v_mov_b32 v91, 0x3e803e80
    v_mov_b32 v88, 0x3f803f80
    v_mov_b32 v92, 0x3e803e80
    v_mov_b32 v89, 0x3f803f80
    v_mov_b32 v93, 0x3e803e80
    v_and_b32 v2, 1, v1
    v_lshlrev_b32 v2, 4, v2
    v_mov_b32 v3, 0x3f80
    v_lshlrev_b32 v2, v2, v3
    v_lshrrev_b32 v3, 1, v6
    v_cmp_eq_u32 vcc, 0, v3
    s_nop 1
    v_cndmask_b32 v26, 0, v2, vcc
    v_cmp_eq_u32 vcc, 1, v3
    s_nop 1
    v_cndmask_b32 v27, 0, v2, vcc
    v_cmp_eq_u32 vcc, 2, v3
    s_nop 1
    v_cndmask_b32 v28, 0, v2, vcc
    v_cmp_eq_u32 vcc, 3, v3
    s_nop 1
    v_cndmask_b32 v29, 0, v2, vcc
    v_bfe_u32 v118, v1, 0, 3
    v_lshlrev_b32 v118, 3, v118
    v_bfe_u32 v3, v1, 3, 1
    v_lshl_or_b32 v118, v3, 7, v118
    v_bfe_u32 v3, v1, 5, 1
    v_lshl_or_b32 v118, v3, 6, v118
    v_bfe_u32 v3, v1, 4, 1
    v_lshl_or_b32 v118, v3, 8, v118
    v_bfe_u32 v3, v1, 1, 3
    v_bfe_u32 v4, v1, 4, 1
    v_lshlrev_b32 v4, 1, v4
    v_xor_b32 v3, v3, v4
    v_cmp_eq_u32 vcc, 0, v3
    s_nop 1
    v_cndmask_b32 v98, 0, v2, vcc
    v_cndmask_b32 v100, 0, v2, vcc
    v_cmp_eq_u32 vcc, 1, v3
    s_nop 1
    v_cndmask_b32 v99, 0, v2, vcc
    v_cndmask_b32 v101, 0, v2, vcc
    v_cmp_eq_u32 vcc, 4, v3
    s_nop 1
    v_cndmask_b32 v102, 0, v2, vcc
    v_cndmask_b32 v104, 0, v2, vcc
    v_cmp_eq_u32 vcc, 5, v3
    s_nop 1
    v_cndmask_b32 v103, 0, v2, vcc
    v_cndmask_b32 v105, 0, v2, vcc
    s_add_u32 s80, s80, 0x4400000
    s_mov_b32 s81, 0x3e0293ee
    v_lshlrev_b32 v114, 2, v1
    v_add_u32 v114, 8192, v114
    v_bfe_u32 v117, v1, 0, 1
    v_lshlrev_b32 v117, 4, v117
    v_bfe_u32 v2, v1, 2, 2
    v_lshl_or_b32 v117, v2, 5, v117
    v_bfe_u32 v2, v1, 1, 1
    v_lshl_or_b32 v117, v2, 7, v117
    v_bfe_u32 v2, v1, 4, 2
    v_lshl_or_b32 v117, v2, 8, v117
    v_bfe_u32 v2, v1, 1, 1
    v_lshl_or_b32 v117, v2, 10, v117
    v_bfe_u32 v119, v1, 4, 2
    v_lshlrev_b32 v119, 3, v119
    s_lshl_b32 s70, s67, 11
    v_add_u32 v116, s70, v8
    s_bfe_u32 s70, s67, 0x10000
    s_lshl_b32 s70, s70, 7
    s_bfe_u32 s71, s67, 0x20000
    s_lshl_b32 s71, s71, 10
    s_or_b32 s70, s70, s71
    v_xor_b32 v115, s70, v8
    s_cmp_lg_u32 s58, 4
    s_cbranch_scc1 kv0w_32
kv0_33:
    buffer_load_dword v5, off, s[12:15], 0 offset:128 sc1
    s_waitcnt vmcnt(0)
    v_cmp_gt_u16 vcc, 128, v5
    s_cbranch_vccz kv0_ok_34
    s_sub_u32 s69, s69, 1
    s_cbranch_scc0 kv0_33
    s_mov_b32 s69, 0
kv0_ok_34:
kv0w_32:
    s_barrier
vo_loop_35:
    v_mov_b32 v38, 0
    v_mov_b32 v39, 0
    v_mov_b32 v40, 0
    v_mov_b32 v41, 0
    v_mov_b32 v42, 0
    v_mov_b32 v43, 0
    v_mov_b32 v44, 0
    v_mov_b32 v45, 0
    s_barrier
    v_mov_b32 v46, 0
    v_mov_b32 v47, 0
    v_mov_b32 v48, 0
    v_mov_b32 v49, 0
    v_mov_b32 v50, 0
    v_mov_b32 v51, 0
    v_mov_b32 v52, 0
    v_mov_b32 v53, 0
    v_mov_b32 v54, 0
    v_mov_b32 v55, 0
    v_mov_b32 v56, 0
    v_mov_b32 v57, 0
    v_mov_b32 v58, 0
    v_mov_b32 v59, 0
    v_mov_b32 v60, 0
    v_mov_b32 v61, 0
    ds_read_b128 v[10:13], v8 offset:0
    ds_read_b128 v[14:17], v8 offset:1024
    ds_read_b128 v[18:21], v8 offset:2048
    ds_read_b128 v[22:25], v8 offset:3072
    ds_read_b128 v[70:73], v116 offset:13312
    ds_read_b128 v[74:77], v116 offset:14336
    s_waitcnt lgkmcnt(5)
    v_smfmac_f32_16x16x64_bf16 v[38:41], v[10:13], v[128:135], v7
    v_smfmac_f32_16x16x64_bf16 v[42:45], v[10:13], v[160:167], v7
    s_waitcnt lgkmcnt(4)
    v_smfmac_f32_16x16x64_bf16 v[38:41], v[14:17], v[136:143], v7
    v_smfmac_f32_16x16x64_bf16 v[42:45], v[14:17], v[168:175], v7
    s_waitcnt lgkmcnt(3)
    v_smfmac_f32_16x16x64_bf16 v[38:41], v[18:21], v[144:151], v7
    v_smfmac_f32_16x16x64_bf16 v[42:45], v[18:21], v[176:183], v7
    s_waitcnt lgkmcnt(2)
    v_smfmac_f32_16x16x64_bf16 v[38:41], v[22:25], v[152:159], v7
    v_smfmac_f32_16x16x64_bf16 v[42:45], v[22:25], v[184:191], v7
    s_nop 6
    v_pk_add_f32 v[38:39], v[38:39], v[40:41]
    v_cvt_pk_bf16_f32 v78, v38, v39
    v_pk_add_f32 v[42:43], v[42:43], v[44:45]
    v_cvt_pk_bf16_f32 v79, v42, v43
    s_nop 1
    v_permlane16_swap_b32 v78, v79
    v_bfi_b32 v78, 1, s82, v78
    buffer_store_dwordx2 v[78:79], v34, s[8:11], s73 offen
    s_and_b32 s70, s68, 1
    s_lshl_b32 s70, s70, 19
    s_add_u32 s71, s70, s79
    s_add_u32 s70, s70, s78
    s_cmp_eq_u32 s68, 63
    s_cbranch_scc1 vo_last_36
    s_waitcnt lgkmcnt(0)
    s_barrier
    ds_read_b128 v[10:13], v8 offset:4096
    ds_read_b128 v[14:17], v8 offset:5120
    ds_read2st64_b32 v[30:31], v114 offset0:0 offset1:1
    ds_read_b128 v[18:21], v8 offset:6144
    ds_read_b128 v[22:25], v8 offset:7168
    ds_read2st64_b32 v[32:33], v114 offset0:2 offset1:3
    buffer_load_dwordx4 v[62:65], v8, s[8:11], s73 offen offset:0 sc1
    buffer_load_dwordx4 v[66:69], v8, s[8:11], s73 offen offset:1024 sc1
    s_waitcnt lgkmcnt(4)
    v_pk_add_f32 v[10:11], v[10:11], v[14:15]
    v_pk_add_f32 v[12:13], v[12:13], v[16:17]
    s_waitcnt lgkmcnt(2)
    v_pk_add_f32 v[10:11], v[10:11], v[18:19]
    v_pk_add_f32 v[12:13], v[12:13], v[20:21]
    s_waitcnt lgkmcnt(0)
    v_pk_add_f32 v[30:31], v[30:31], v[32:33]
    v_pk_add_f32 v[10:11], v[10:11], v[22:23]
    v_pk_add_f32 v[12:13], v[12:13], v[24:25]
    v_add_f32 v14, v30, v31
    v_max3_f32 v2, v10, v11, v12
    v_max3_f32 v3, v2, v13, v14
    v_max3_f32 v2, v2, v13, v14
    s_nop 1
    v_permlane32_swap_b32 v2, v3
    v_max_f32 v4, v2, v3
    v_max_f32 v3, v2, v3
    s_nop 1
    v_permlane16_swap_b32 v4, v3
    v_max_f32 v2, v4, v3
    v_mul_f32 v2, s81, v2
    s_nop 1
    v_max_f32_dpp v2, v2, v2 row_ror:8 row_mask:0xf bank_mask:0xf
    v_fma_f32 v10, v10, s81, -v2
    v_fma_f32 v11, v11, s81, -v2
    v_fma_f32 v12, v12, s81, -v2
    v_fma_f32 v13, v13, s81, -v2
    v_fma_f32 v14, v14, s81, -v2
    v_exp_f32 v10, v10
    v_exp_f32 v11, v11
    v_exp_f32 v12, v12
    v_exp_f32 v13, v13
    v_exp_f32 v15, v14
    v_cvt_pk_bf16_f32 v78, v10, v11
    v_cvt_pk_bf16_f32 v79, v12, v13
    v_mov_b32 v14, v15
    v_mov_b32_dpp v80, v78 row_ror:8 row_mask:0xf bank_mask:0xf
    v_mov_b32_dpp v81, v79 row_ror:8 row_mask:0xf bank_mask:0xf
    v_permlane32_swap_b32 v14, v15
    v_cvt_pk_bf16_f32 v82, v14, v15
    v_mfma_f32_16x16x32_bf16 v[106:109], v[70:73], v[78:81], 0
    v_mov_b32 v84, v82
    v_mov_b32_dpp v83, v82 row_ror:8 row_mask:0xf bank_mask:0xf
    v_mov_b32_dpp v85, v82 row_ror:8 row_mask:0xf bank_mask:0xf
    v_mfma_f32_16x16x32_bf16 v[110:113], v[74:77], v[78:81], 0
    s_waitcnt vmcnt(0)
    v_mfma_f32_16x16x32_bf16 v[18:21], v[62:65], v[82:85], v[106:109]
    v_bitop3_b32 v2, v62, v64, s82 bitop3:0x7e
    v_bitop3_b32 v3, v66, v68, s82 bitop3:0x7e
    v_mfma_f32_16x16x32_bf16 v[22:25], v[66:69], v[82:85], v[110:113]
    v_bitop3_b32 v2, v2, v3, 1 bitop3:0xa8
    v_cmp_ne_u32 vcc, 0, v2
    s_cbranch_vccnz xv_s_37
xv_j_38:
    v_mfma_f32_16x16x32_bf16 v[94:97], v[86:89], v[78:81], 0
    s_nop 0
    v_cvt_pk_bf16_f32 v106, v18, v19
    v_cvt_pk_bf16_f32 v107, v20, v21
    s_nop 0
    v_cvt_pk_bf16_f32 v108, v22, v23
    v_cvt_pk_bf16_f32 v109, v24, v25
    ds_write_b128 v115, v[106:109] offset:9216
    v_mfma_f32_16x16x32_bf16 v[94:97], v[90:93], v[82:85], v[94:97]
    s_nop 3
    s_waitcnt lgkmcnt(0)
    s_barrier
    ds_read_b128 v[10:13], v117 offset:9216
    ds_read_b128 v[14:17], v117 offset:11264
    v_rcp_f32 v96, v94
    s_nop 0
    ds_bpermute_b32 v94, v119, v96 offset:0
    ds_bpermute_b32 v95, v119, v96 offset:4
    s_waitcnt lgkmcnt(3)
    v_smfmac_f32_16x16x64_bf16 v[46:49], v[10:13], v[192:199], v7
    v_smfmac_f32_16x16x64_bf16 v[50:53], v[10:13], v[208:215], v7
    s_waitcnt lgkmcnt(2)
    v_smfmac_f32_16x16x64_bf16 v[46:49], v[14:17], v[200:207], v7
    s_nop 1
    v_smfmac_f32_16x16x64_bf16 v[50:53], v[14:17], v[216:223], v7
    s_nop 1
    v_smfmac_f32_16x16x64_bf16 v[54:57], v[10:13], v[224:231], v7
    s_waitcnt lgkmcnt(0)
    v_smfmac_f32_16x16x64_bf16 v[54:57], v[14:17], v[232:239], v7
    v_pk_add_f32 v[46:47], v[46:47], v[48:49]
    v_smfmac_f32_16x16x64_bf16 v[58:61], v[10:13], v[240:247], v7
    v_pk_mul_f32 v[46:47], v[46:47], v[94:95]
    v_cvt_pk_bf16_f32 v78, v46, v47
    v_smfmac_f32_16x16x64_bf16 v[58:61], v[14:17], v[248:255], v7
    v_pk_add_f32 v[50:51], v[50:51], v[52:53]
    v_pk_mul_f32 v[50:51], v[50:51], v[94:95]
    v_cvt_pk_bf16_f32 v79, v50, v51
    v_pk_add_f32 v[54:55], v[54:55], v[56:57]
    v_pk_mul_f32 v[54:55], v[54:55], v[94:95]
    v_cvt_pk_bf16_f32 v80, v54, v55
    v_permlane16_swap_b32 v78, v79
    v_bfi_b32 v78, 1, s82, v78
    v_pk_add_f32 v[58:59], v[58:59], v[60:61]
    v_pk_mul_f32 v[58:59], v[58:59], v[94:95]
    v_cvt_pk_bf16_f32 v81, v58, v59
    s_nop 1
    v_permlane16_swap_b32 v80, v81
    buffer_store_dwordx4 v[78:81], v36, s[8:11], s71 offen
    s_nop 15
    s_nop 15
    buffer_load_dwordx4 v[10:13], v8, s[8:11], s70 offen sc1
    s_nop 15
    buffer_load_dwordx4 v[14:17], v8, s[8:11], s70 offen sc1
    s_nop 15
    buffer_load_dwordx4 v[18:21], v8, s[8:11], s70 offen sc1
    s_waitcnt vmcnt(2)
    v_mfma_f32_16x16x32_bf16 v[30:33], v[26:29], v[10:13], 0
    v_bitop3_b32 v2, v10, s82, 1 bitop3:0x28
    v_cmp_ne_u32 vcc, 0, v2
    s_cbranch_vccnz b_s_39
b_j_40:
    s_nop 4
    v_add_f32_dpp v30, v30, v30 row_ror:8 row_mask:0xf bank_mask:0xf
    v_add_f32_dpp v31, v31, v31 row_ror:8 row_mask:0xf bank_mask:0xf
    v_add_f32_dpp v32, v32, v32 row_ror:8 row_mask:0xf bank_mask:0xf
    v_add_f32_dpp v33, v33, v33 row_ror:8 row_mask:0xf bank_mask:0xf
    v_cvt_pk_bf16_f32 v30, v30, v31
    v_cvt_pk_bf16_f32 v31, v32, v33
    v_min_u32 v30, -2, v30
    s_nop 0
    v_permlane16_swap_b32 v31, v33
    v_permlane16_swap_b32 v30, v32
    buffer_store_dwordx4 v[30:33], v35, s[8:11], s77 offen sc1
    s_barrier
    s_add_u32 s68, s68, 1
    s_bfe_u32 s82, s68, 0x10001
    s_xor_b32 s73, s73, 0x40000
    s_add_u32 s77, s77, 0x20000
    s_lshr_b32 s60, s77, 21
    s_bitcmp1_b32 s59, s60
    s_cselect_b32 s60, 0x2000, 0
    s_bitset0_b32 s77, 13
    s_or_b32 s77, s77, s60
    s_waitcnt vmcnt(1)
    s_and_b32 s72, s68, 3
    s_cmp_lg_u32 s72, s64
    s_cbranch_scc1 novm_41
    v_mfma_f32_16x16x32_bf16 v[106:109], v[98:101], v[62:65], 0
    v_mfma_f32_16x16x32_bf16 v[106:109], v[102:105], v[66:69], v[106:109]
    s_nop 7
    v_cvt_pk_bf16_f32 v106, v106, v107
    v_cvt_pk_bf16_f32 v107, v108, v109
    v_min_u32 v106, -2, v106
    buffer_store_dwordx2 v[106:107], v118, s[8:11], s80 offen sc1
novm_41:
    s_add_u32 s80, s80, 0x10000
    s_branch vo_loop_35
xv_s_37:
    buffer_load_dwordx4 v[62:65], v8, s[8:11], s73 offen offset:0 sc1
    buffer_load_dwordx4 v[66:69], v8, s[8:11], s73 offen offset:1024 sc1
    s_waitcnt vmcnt(0)
    v_mfma_f32_16x16x32_bf16 v[18:21], v[62:65], v[82:85], v[106:109]
    v_bitop3_b32 v2, v62, v64, s82 bitop3:0x7e
    v_bitop3_b32 v3, v66, v68, s82 bitop3:0x7e
    v_mfma_f32_16x16x32_bf16 v[22:25], v[66:69], v[82:85], v[110:113]
    v_bitop3_b32 v2, v2, v3, 1 bitop3:0xa8
    v_cmp_ne_u32 vcc, 0, v2
    s_cbranch_vccz xv_j_38
    s_sub_u32 s69, s69, 1
    s_cbranch_scc0 xv_s_37
    s_mov_b32 s69, 0
    s_branch xv_j_38
b_s_39:
    buffer_load_dwordx4 v[10:13], v8, s[8:11], s70 offen sc1
    s_waitcnt vmcnt(2)
    s_nop 0
    v_mfma_f32_16x16x32_bf16 v[30:33], v[26:29], v[14:17], 0
    v_bitop3_b32 v2, v14, s82, 1 bitop3:0x28
    v_cmp_ne_u32 vcc, 0, v2
    s_cbranch_vccz b_j_40
    buffer_load_dwordx4 v[14:17], v8, s[8:11], s70 offen sc1
    s_waitcnt vmcnt(2)
    s_nop 0
    v_mfma_f32_16x16x32_bf16 v[30:33], v[26:29], v[18:21], 0
    v_bitop3_b32 v2, v18, s82, 1 bitop3:0x28
    v_cmp_ne_u32 vcc, 0, v2
    s_cbranch_vccz b_j_40
    buffer_load_dwordx4 v[18:21], v8, s[8:11], s70 offen sc1
    s_waitcnt vmcnt(2)
    s_nop 0
    v_mfma_f32_16x16x32_bf16 v[30:33], v[26:29], v[10:13], 0
    v_bitop3_b32 v2, v10, s82, 1 bitop3:0x28
    v_cmp_ne_u32 vcc, 0, v2
    s_cbranch_vccz b_j_40
    s_sub_u32 s69, s69, 1
    s_cbranch_scc0 b_s_39
    s_mov_b32 s69, 0
    s_branch b_j_40
vo_last_36:
    s_cmp_lg_u32 s64, 0
    s_cbranch_scc1 chain_end_16
pollvm_42:
    buffer_load_dwordx4 v[62:65], v8, s[8:11], s73 offen offset:0 sc1
    buffer_load_dwordx4 v[66:69], v8, s[8:11], s73 offen offset:1024 sc1
    s_waitcnt vmcnt(0)
    v_bitop3_b32 v2, v62, v64, s82 bitop3:0x7e
    v_bitop3_b32 v3, v66, v68, s82 bitop3:0x7e
    v_bitop3_b32 v2, v2, v3, 1 bitop3:0xa8
    v_cmp_ne_u32 vcc, 0, v2
    s_cbranch_vccz pollvm_ok_43
    s_sub_u32 s69, s69, 1
    s_cbranch_scc0 pollvm_42
    s_mov_b32 s69, 0
pollvm_ok_43:
    v_mfma_f32_16x16x32_bf16 v[106:109], v[98:101], v[62:65], 0
    v_mfma_f32_16x16x32_bf16 v[106:109], v[102:105], v[66:69], v[106:109]
    s_nop 7
    v_cvt_pk_bf16_f32 v106, v106, v107
    v_cvt_pk_bf16_f32 v107, v108, v109
    v_min_u32 v106, -2, v106
    buffer_store_dwordx2 v[106:107], v118, s[8:11], s80 offen sc1
chain_end_16:
    s_waitcnt vmcnt(0)
    s_endpgm
bulk_2:
    s_and_b32 s75, s56, 3
    s_lshl_b32 s76, s75, 5
    s_add_u32 s76, s76, s57
    s_mov_b32 s77, 0x40000
    s_mov_b32 s78, 0
    s_cmp_ge_u32 s75, 2
    s_cbranch_scc1 v0_47
    v_bfe_u32 v208, v1, 4, 1
    v_lshlrev_b32 v208, 1, v208
    s_and_b32 s85, s58, 4
    v_xor_b32 v208, s85, v208
    v_xor_b32 v208, v208, v1
    v_bfe_u32 v70, v208, 0, 1
    v_lshlrev_b32 v70, 5, v70
    v_bfe_u32 v209, v208, 1, 1
    v_lshl_or_b32 v70, v209, 4, v70
    v_bfe_u32 v209, v208, 2, 1
    v_lshl_or_b32 v70, v209, 6, v70
    v_bfe_u32 v209, v208, 3, 3
    v_lshl_or_b32 v70, v209, 13, v70
    s_bfe_u32 s69, s76, 0x60000
    s_lshl_b32 s69, s69, 7
    s_lshl_b32 s85, s58, 16
    s_add_u32 s69, s69, s85
    s_lshl_b32 s71, s58, 10
    s_mov_b32 m0, s71
    s_nop 0
    buffer_load_dwordx4 v70, s[24:27], s69 offen lds
    s_add_u32 s69, s69, 0x80000
    s_add_u32 s71, s71, 0x2000
    s_mov_b32 m0, s71
    s_nop 0
    buffer_load_dwordx4 v70, s[24:27], s69 offen lds
    s_add_u32 s69, s69, 0x80000
    s_add_u32 s71, s71, 0x2000
    s_mov_b32 m0, s71
    s_nop 0
    buffer_load_dwordx4 v70, s[24:27], s69 offen lds
    s_add_u32 s69, s69, 0x80000
    s_add_u32 s71, s71, 0x2000
    s_mov_b32 m0, s71
    s_nop 0
    buffer_load_dwordx4 v70, s[24:27], s69 offen lds
    s_add_u32 s69, s69, 0x80000
    s_add_u32 s71, s71, 0x2000
    s_mov_b32 m0, s71
    s_nop 0
    buffer_load_dwordx4 v70, s[24:27], s69 offen lds
    s_add_u32 s69, s69, 0x80000
    s_add_u32 s71, s71, 0x2000
    s_mov_b32 m0, s71
    s_nop 0
    buffer_load_dwordx4 v70, s[24:27], s69 offen lds
    s_add_u32 s69, s69, 0x80000
    s_add_u32 s71, s71, 0x2000
    s_mov_b32 m0, s71
    s_nop 0
    buffer_load_dwordx4 v70, s[24:27], s69 offen lds
    s_add_u32 s69, s69, 0x80000
    s_add_u32 s71, s71, 0x2000
    s_mov_b32 m0, s71
    s_nop 0
    buffer_load_dwordx4 v70, s[24:27], s69 offen lds
    s_add_u32 s69, s69, 0x80000
    s_add_u32 s71, s71, 0x2000
    s_mov_b32 m0, s71
    s_nop 0
    buffer_load_dwordx4 v70, s[24:27], s69 offen lds
    s_add_u32 s69, s69, 0x80000
    s_add_u32 s71, s71, 0x2000
    s_mov_b32 m0, s71
    s_nop 0
    buffer_load_dwordx4 v70, s[24:27], s69 offen lds
    s_add_u32 s69, s69, 0x80000
    s_add_u32 s71, s71, 0x2000
    s_mov_b32 m0, s71
    s_nop 0
    buffer_load_dwordx4 v70, s[24:27], s69 offen lds
    s_add_u32 s69, s69, 0x80000
    s_add_u32 s71, s71, 0x2000
    s_mov_b32 m0, s71
    s_nop 0
    buffer_load_dwordx4 v70, s[24:27], s69 offen lds
    s_add_u32 s69, s69, 0x80000
    s_add_u32 s71, s71, 0x2000
    s_mov_b32 m0, s71
    s_nop 0
    buffer_load_dwordx4 v70, s[24:27], s69 offen lds
    s_add_u32 s69, s69, 0x80000
    s_add_u32 s71, s71, 0x2000
    s_mov_b32 m0, s71
    s_nop 0
    buffer_load_dwordx4 v70, s[24:27], s69 offen lds
    s_add_u32 s69, s69, 0x80000
    s_add_u32 s71, s71, 0x2000
    s_mov_b32 m0, s71
    s_nop 0
    buffer_load_dwordx4 v70, s[24:27], s69 offen lds
    s_add_u32 s69, s69, 0x80000
    s_add_u32 s71, s71, 0x2000
    s_mov_b32 m0, s71
    s_nop 0
    buffer_load_dwordx4 v70, s[24:27], s69 offen lds
    s_add_u32 s69, s69, 0x80000
    s_add_u32 s71, s71, 0x2000
    s_add_u32 s74, s58, s57
    s_and_b32 s74, s74, 3
    s_and_b32 s85, s58, 4
    s_or_b32 s74, s74, s85
    s_lshl_b32 s74, s74, 8
    s_bfe_u32 s85, s58, 0x20000
    s_lshl_b32 s85, s85, 5
    v_bfe_u32 v209, v1, 0, 2
    v_lshlrev_b32 v209, 4, v209
    v_bfe_u32 v210, v1, 4, 2
    v_lshl_or_b32 v209, v210, 6, v209
    v_and_b32 v208, 12, v1
    v_add3_u32 v208, v208, s85, 0
    v_lshlrev_b32 v68, 11, v208
    v_add3_u32 v68, v68, v209, s74
    v_add_u32 v71, 4096, v68
    v_and_b32 v208, 12, v1
    v_add3_u32 v208, v208, s85, 16
    v_lshlrev_b32 v69, 11, v208
    v_add3_u32 v69, v69, v209, s74
    v_add_u32 v72, 4096, v69
    s_mov_b32 s68, 0
    s_barrier
    buffer_load_dwordx4 v[80:83], v68, s[36:39], s68 offen offset:0
    buffer_load_dwordx4 v[96:99], v69, s[36:39], s68 offen offset:0
    buffer_load_dwordx4 v[84:87], v68, s[36:39], s68 offen offset:2048
    buffer_load_dwordx4 v[100:103], v69, s[36:39], s68 offen offset:2048
    buffer_load_dwordx4 v[88:91], v71, s[36:39], s68 offen offset:0
    buffer_load_dwordx4 v[104:107], v72, s[36:39], s68 offen offset:0
    buffer_load_dwordx4 v[92:95], v71, s[36:39], s68 offen offset:2048
    buffer_load_dwordx4 v[108:111], v72, s[36:39], s68 offen offset:2048
    v_xor_b32 v68, 0x100, v68
    v_xor_b32 v69, 0x100, v69
    v_xor_b32 v71, 0x100, v71
    v_xor_b32 v72, 0x100, v72
    buffer_load_dwordx4 v[112:115], v68, s[36:39], s68 offen offset:0
    buffer_load_dwordx4 v[128:131], v69, s[36:39], s68 offen offset:0
    buffer_load_dwordx4 v[116:119], v68, s[36:39], s68 offen offset:2048
    buffer_load_dwordx4 v[132:135], v69, s[36:39], s68 offen offset:2048
    buffer_load_dwordx4 v[120:123], v71, s[36:39], s68 offen offset:0
    buffer_load_dwordx4 v[136:139], v72, s[36:39], s68 offen offset:0
    buffer_load_dwordx4 v[124:127], v71, s[36:39], s68 offen offset:2048
    buffer_load_dwordx4 v[140:143], v72, s[36:39], s68 offen offset:2048
    v_xor_b32 v68, 0x300, v68
    v_xor_b32 v69, 0x300, v69
    v_xor_b32 v71, 0x300, v71
    v_xor_b32 v72, 0x300, v72
    buffer_load_dwordx4 v[144:147], v68, s[36:39], s68 offen offset:0
    buffer_load_dwordx4 v[160:163], v69, s[36:39], s68 offen offset:0
    buffer_load_dwordx4 v[148:151], v68, s[36:39], s68 offen offset:2048
    buffer_load_dwordx4 v[164:167], v69, s[36:39], s68 offen offset:2048
    buffer_load_dwordx4 v[152:155], v71, s[36:39], s68 offen offset:0
    buffer_load_dwordx4 v[168:171], v72, s[36:39], s68 offen offset:0
    buffer_load_dwordx4 v[156:159], v71, s[36:39], s68 offen offset:2048
    buffer_load_dwordx4 v[172:175], v72, s[36:39], s68 offen offset:2048
    v_xor_b32 v68, 0x100, v68
    v_xor_b32 v69, 0x100, v69
    v_xor_b32 v71, 0x100, v71
    v_xor_b32 v72, 0x100, v72
    buffer_load_dwordx4 v[176:179], v68, s[36:39], s68 offen offset:0
    buffer_load_dwordx4 v[192:195], v69, s[36:39], s68 offen offset:0
    buffer_load_dwordx4 v[180:183], v68, s[36:39], s68 offen offset:2048
    buffer_load_dwordx4 v[196:199], v69, s[36:39], s68 offen offset:2048
    buffer_load_dwordx4 v[184:187], v71, s[36:39], s68 offen offset:0
    buffer_load_dwordx4 v[200:203], v72, s[36:39], s68 offen offset:0
    buffer_load_dwordx4 v[188:191], v71, s[36:39], s68 offen offset:2048
    buffer_load_dwordx4 v[204:207], v72, s[36:39], s68 offen offset:2048
    v_xor_b32 v68, 0x300, v68
    v_xor_b32 v69, 0x300, v69
    v_xor_b32 v71, 0x300, v71
    v_xor_b32 v72, 0x300, v72
    v_bfe_u32 v79, v1, 0, 4
    v_lshlrev_b32 v79, 4, v79
    v_bfe_u32 v75, v1, 4, 2
    v_lshl_or_b32 v79, v75, 9, v79
    v_bfe_u32 v75, v1, 0, 2
    v_lshlrev_b32 v75, 3, v75
    v_bfe_u32 v208, v1, 3, 1
    v_lshl_or_b32 v75, v208, 5, v75
    v_bfe_u32 v208, v1, 4, 1
    v_lshl_or_b32 v75, v208, 6, v75
    v_bfe_u32 v208, v1, 2, 2
    v_lshl_or_b32 v75, v208, 7, v75
    v_bfe_u32 v208, v1, 4, 2
    v_lshl_or_b32 v75, v208, 12, v75
    v_lshl_or_b32 v75, s74, 6, v75
    s_bfe_u32 s85, s58, 0x10002
    s_lshl_b32 s85, s85, 6
    v_xor_b32 v75, s85, v75
    v_xor_b32 v76, 32, v75
    v_xor_b32 v77, 64, v75
    v_xor_b32 v78, 96, v75
    s_lshl_b32 s85, s58, 12
    s_or_b32 s85, s85, 0x20000
    v_lshl_add_u32 v73, v1, 4, s85
    v_xor_b32 v74, 0x4000, v73
    s_bfe_u32 s81, s76, 0x60000
    s_lshl_b32 s81, s81, 12
    s_bfe_u32 s85, s58, 0x10002
    s_lshl_b32 s85, s85, 11
    s_bfe_u32 s73, s58, 0x20000
    s_lshl_b32 s73, s73, 18
    s_or_b32 s85, s85, s73
    s_add_u32 s81, s81, s85
    s_add_u32 s81, s81, 0x1000000
    s_mov_b32 s83, 128
    s_mov_b32 s84, 1
    s_mov_b32 s73, 0
    s_mov_b32 s68, 0x40000
    s_waitcnt vmcnt(24)
    s_mov_b32 vcc_lo, 0x55555555
    s_mov_b32 vcc_hi, 0x55555555
    v_cndmask_b32_dpp v224, v84, v80, vcc quad_perm:[1,0,3,2] row_mask:0xf bank_mask:0xf
    v_cndmask_b32_dpp v225, v85, v81, vcc quad_perm:[1,0,3,2] row_mask:0xf bank_mask:0xf
    v_cndmask_b32_dpp v226, v86, v82, vcc quad_perm:[1,0,3,2] row_mask:0xf bank_mask:0xf
    v_cndmask_b32_dpp v227, v87, v83, vcc quad_perm:[1,0,3,2] row_mask:0xf bank_mask:0xf
    v_cndmask_b32_dpp v232, v92, v88, vcc quad_perm:[1,0,3,2] row_mask:0xf bank_mask:0xf
    v_cndmask_b32_dpp v233, v93, v89, vcc quad_perm:[1,0,3,2] row_mask:0xf bank_mask:0xf
    v_cndmask_b32_dpp v234, v94, v90, vcc quad_perm:[1,0,3,2] row_mask:0xf bank_mask:0xf
    v_cndmask_b32_dpp v235, v95, v91, vcc quad_perm:[1,0,3,2] row_mask:0xf bank_mask:0xf
    s_mov_b32 vcc_lo, 0xaaaaaaaa
    s_mov_b32 vcc_hi, 0xaaaaaaaa
    v_cndmask_b32_dpp v228, v80, v84, vcc quad_perm:[1,0,3,2] row_mask:0xf bank_mask:0xf
    v_cndmask_b32_dpp v229, v81, v85, vcc quad_perm:[1,0,3,2] row_mask:0xf bank_mask:0xf
    v_cndmask_b32_dpp v230, v82, v86, vcc quad_perm:[1,0,3,2] row_mask:0xf bank_mask:0xf
    v_cndmask_b32_dpp v231, v83, v87, vcc quad_perm:[1,0,3,2] row_mask:0xf bank_mask:0xf
    v_cndmask_b32_dpp v236, v88, v92, vcc quad_perm:[1,0,3,2] row_mask:0xf bank_mask:0xf
    v_cndmask_b32_dpp v237, v89, v93, vcc quad_perm:[1,0,3,2] row_mask:0xf bank_mask:0xf
    v_cndmask_b32_dpp v238, v90, v94, vcc quad_perm:[1,0,3,2] row_mask:0xf bank_mask:0xf
    v_cndmask_b32_dpp v239, v91, v95, vcc quad_perm:[1,0,3,2] row_mask:0xf bank_mask:0xf
    s_mov_b32 vcc_lo, 0x33333333
    s_mov_b32 vcc_hi, 0x33333333
    v_cndmask_b32_dpp v80, v232, v224, vcc quad_perm:[2,3,0,1] row_mask:0xf bank_mask:0xf
    v_cndmask_b32_dpp v81, v233, v225, vcc quad_perm:[2,3,0,1] row_mask:0xf bank_mask:0xf
    v_cndmask_b32_dpp v82, v234, v226, vcc quad_perm:[2,3,0,1] row_mask:0xf bank_mask:0xf
    v_cndmask_b32_dpp v83, v235, v227, vcc quad_perm:[2,3,0,1] row_mask:0xf bank_mask:0xf
    v_cndmask_b32_dpp v84, v236, v228, vcc quad_perm:[2,3,0,1] row_mask:0xf bank_mask:0xf
    v_cndmask_b32_dpp v85, v237, v229, vcc quad_perm:[2,3,0,1] row_mask:0xf bank_mask:0xf
    v_cndmask_b32_dpp v86, v238, v230, vcc quad_perm:[2,3,0,1] row_mask:0xf bank_mask:0xf
    v_cndmask_b32_dpp v87, v239, v231, vcc quad_perm:[2,3,0,1] row_mask:0xf bank_mask:0xf
    s_mov_b32 vcc_lo, 0xcccccccc
    s_mov_b32 vcc_hi, 0xcccccccc
    v_cndmask_b32_dpp v88, v224, v232, vcc quad_perm:[2,3,0,1] row_mask:0xf bank_mask:0xf
    v_cndmask_b32_dpp v89, v225, v233, vcc quad_perm:[2,3,0,1] row_mask:0xf bank_mask:0xf
    v_cndmask_b32_dpp v90, v226, v234, vcc quad_perm:[2,3,0,1] row_mask:0xf bank_mask:0xf
    v_cndmask_b32_dpp v91, v227, v235, vcc quad_perm:[2,3,0,1] row_mask:0xf bank_mask:0xf
    v_cndmask_b32_dpp v92, v228, v236, vcc quad_perm:[2,3,0,1] row_mask:0xf bank_mask:0xf
    v_cndmask_b32_dpp v93, v229, v237, vcc quad_perm:[2,3,0,1] row_mask:0xf bank_mask:0xf
    v_cndmask_b32_dpp v94, v230, v238, vcc quad_perm:[2,3,0,1] row_mask:0xf bank_mask:0xf
    v_cndmask_b32_dpp v95, v231, v239, vcc quad_perm:[2,3,0,1] row_mask:0xf bank_mask:0xf
    s_mov_b32 vcc_lo, 0x55555555
    s_mov_b32 vcc_hi, 0x55555555
    v_cndmask_b32_dpp v224, v100, v96, vcc quad_perm:[1,0,3,2] row_mask:0xf bank_mask:0xf
    v_cndmask_b32_dpp v225, v101, v97, vcc quad_perm:[1,0,3,2] row_mask:0xf bank_mask:0xf
    v_cndmask_b32_dpp v226, v102, v98, vcc quad_perm:[1,0,3,2] row_mask:0xf bank_mask:0xf
    v_cndmask_b32_dpp v227, v103, v99, vcc quad_perm:[1,0,3,2] row_mask:0xf bank_mask:0xf
    v_cndmask_b32_dpp v232, v108, v104, vcc quad_perm:[1,0,3,2] row_mask:0xf bank_mask:0xf
    v_cndmask_b32_dpp v233, v109, v105, vcc quad_perm:[1,0,3,2] row_mask:0xf bank_mask:0xf
    v_cndmask_b32_dpp v234, v110, v106, vcc quad_perm:[1,0,3,2] row_mask:0xf bank_mask:0xf
    v_cndmask_b32_dpp v235, v111, v107, vcc quad_perm:[1,0,3,2] row_mask:0xf bank_mask:0xf
    s_mov_b32 vcc_lo, 0xaaaaaaaa
    s_mov_b32 vcc_hi, 0xaaaaaaaa
    v_cndmask_b32_dpp v228, v96, v100, vcc quad_perm:[1,0,3,2] row_mask:0xf bank_mask:0xf
    v_cndmask_b32_dpp v229, v97, v101, vcc quad_perm:[1,0,3,2] row_mask:0xf bank_mask:0xf
    v_cndmask_b32_dpp v230, v98, v102, vcc quad_perm:[1,0,3,2] row_mask:0xf bank_mask:0xf
    v_cndmask_b32_dpp v231, v99, v103, vcc quad_perm:[1,0,3,2] row_mask:0xf bank_mask:0xf
    v_cndmask_b32_dpp v236, v104, v108, vcc quad_perm:[1,0,3,2] row_mask:0xf bank_mask:0xf
    v_cndmask_b32_dpp v237, v105, v109, vcc quad_perm:[1,0,3,2] row_mask:0xf bank_mask:0xf
    v_cndmask_b32_dpp v238, v106, v110, vcc quad_perm:[1,0,3,2] row_mask:0xf bank_mask:0xf
    v_cndmask_b32_dpp v239, v107, v111, vcc quad_perm:[1,0,3,2] row_mask:0xf bank_mask:0xf
    s_mov_b32 vcc_lo, 0x33333333
    s_mov_b32 vcc_hi, 0x33333333
    v_cndmask_b32_dpp v96, v232, v224, vcc quad_perm:[2,3,0,1] row_mask:0xf bank_mask:0xf
    v_cndmask_b32_dpp v97, v233, v225, vcc quad_perm:[2,3,0,1] row_mask:0xf bank_mask:0xf
    v_cndmask_b32_dpp v98, v234, v226, vcc quad_perm:[2,3,0,1] row_mask:0xf bank_mask:0xf
    v_cndmask_b32_dpp v99, v235, v227, vcc quad_perm:[2,3,0,1] row_mask:0xf bank_mask:0xf
    v_cndmask_b32_dpp v100, v236, v228, vcc quad_perm:[2,3,0,1] row_mask:0xf bank_mask:0xf
    v_cndmask_b32_dpp v101, v237, v229, vcc quad_perm:[2,3,0,1] row_mask:0xf bank_mask:0xf
    v_cndmask_b32_dpp v102, v238, v230, vcc quad_perm:[2,3,0,1] row_mask:0xf bank_mask:0xf
    v_cndmask_b32_dpp v103, v239, v231, vcc quad_perm:[2,3,0,1] row_mask:0xf bank_mask:0xf
    s_mov_b32 vcc_lo, 0xcccccccc
    s_mov_b32 vcc_hi, 0xcccccccc
    v_cndmask_b32_dpp v104, v224, v232, vcc quad_perm:[2,3,0,1] row_mask:0xf bank_mask:0xf
    v_cndmask_b32_dpp v105, v225, v233, vcc quad_perm:[2,3,0,1] row_mask:0xf bank_mask:0xf
    v_cndmask_b32_dpp v106, v226, v234, vcc quad_perm:[2,3,0,1] row_mask:0xf bank_mask:0xf
    v_cndmask_b32_dpp v107, v227, v235, vcc quad_perm:[2,3,0,1] row_mask:0xf bank_mask:0xf
    v_cndmask_b32_dpp v108, v228, v236, vcc quad_perm:[2,3,0,1] row_mask:0xf bank_mask:0xf
    v_cndmask_b32_dpp v109, v229, v237, vcc quad_perm:[2,3,0,1] row_mask:0xf bank_mask:0xf
    v_cndmask_b32_dpp v110, v230, v238, vcc quad_perm:[2,3,0,1] row_mask:0xf bank_mask:0xf
    v_cndmask_b32_dpp v111, v231, v239, vcc quad_perm:[2,3,0,1] row_mask:0xf bank_mask:0xf
    s_barrier
    ds_read_b64_tr_b16 v[36:37], v75 offset:0
    ds_read_b64_tr_b16 v[38:39], v75 offset:512
    ds_read_b64_tr_b16 v[40:41], v76 offset:0
    ds_read_b64_tr_b16 v[42:43], v76 offset:512
    ds_read_b64_tr_b16 v[44:45], v77 offset:0
    ds_read_b64_tr_b16 v[46:47], v77 offset:512
    ds_read_b64_tr_b16 v[48:49], v78 offset:0
    ds_read_b64_tr_b16 v[50:51], v78 offset:512
p0_54:
    s_waitcnt vmcnt(16) lgkmcnt(0)
    v_mfma_f32_16x16x32_bf16 v[12:15], v[44:47], v[80:83], 0
    ds_read_b64_tr_b16 v[52:53], v75 offset:1024
    ds_read_b64_tr_b16 v[54:55], v75 offset:1536
    s_mov_b32 vcc_lo, 0x55555555
    s_mov_b32 vcc_hi, 0x55555555
    v_cndmask_b32_dpp v224, v116, v112, vcc quad_perm:[1,0,3,2] row_mask:0xf bank_mask:0xf
    v_cndmask_b32_dpp v225, v117, v113, vcc quad_perm:[1,0,3,2] row_mask:0xf bank_mask:0xf
    v_mfma_f32_16x16x32_bf16 v[16:19], v[48:51], v[80:83], 0
    ds_read_b64_tr_b16 v[56:57], v76 offset:1024
    ds_read_b64_tr_b16 v[58:59], v76 offset:1536
    v_cndmask_b32_dpp v226, v118, v114, vcc quad_perm:[1,0,3,2] row_mask:0xf bank_mask:0xf
    v_cndmask_b32_dpp v227, v119, v115, vcc quad_perm:[1,0,3,2] row_mask:0xf bank_mask:0xf
    v_mfma_f32_16x16x32_bf16 v[4:7], v[36:39], v[80:83], 0
    ds_read_b64_tr_b16 v[60:61], v77 offset:1024
    ds_read_b64_tr_b16 v[62:63], v77 offset:1536
    v_cndmask_b32_dpp v232, v124, v120, vcc quad_perm:[1,0,3,2] row_mask:0xf bank_mask:0xf
    v_cndmask_b32_dpp v233, v125, v121, vcc quad_perm:[1,0,3,2] row_mask:0xf bank_mask:0xf
    v_mfma_f32_16x16x32_bf16 v[8:11], v[40:43], v[80:83], 0
    ds_read_b64_tr_b16 v[64:65], v78 offset:1024
    ds_read_b64_tr_b16 v[66:67], v78 offset:1536
    v_cndmask_b32_dpp v234, v126, v122, vcc quad_perm:[1,0,3,2] row_mask:0xf bank_mask:0xf
    v_cndmask_b32_dpp v235, v127, v123, vcc quad_perm:[1,0,3,2] row_mask:0xf bank_mask:0xf
    buffer_load_dwordx4 v[80:83], v68, s[36:39], s68 offen offset:0
    v_mfma_f32_16x16x32_bf16 v[28:31], v[44:47], v[96:99], 0
    s_mov_b32 vcc_lo, 0xaaaaaaaa
    s_mov_b32 vcc_hi, 0xaaaaaaaa
    v_cndmask_b32_dpp v228, v112, v116, vcc quad_perm:[1,0,3,2] row_mask:0xf bank_mask:0xf
    v_cndmask_b32_dpp v229, v113, v117, vcc quad_perm:[1,0,3,2] row_mask:0xf bank_mask:0xf
    v_mfma_f32_16x16x32_bf16 v[32:35], v[48:51], v[96:99], 0
    v_cndmask_b32_dpp v230, v114, v118, vcc quad_perm:[1,0,3,2] row_mask:0xf bank_mask:0xf
    v_cndmask_b32_dpp v231, v115, v119, vcc quad_perm:[1,0,3,2] row_mask:0xf bank_mask:0xf
    v_mfma_f32_16x16x32_bf16 v[20:23], v[36:39], v[96:99], 0
    v_cndmask_b32_dpp v236, v120, v124, vcc quad_perm:[1,0,3,2] row_mask:0xf bank_mask:0xf
    v_cndmask_b32_dpp v237, v121, v125, vcc quad_perm:[1,0,3,2] row_mask:0xf bank_mask:0xf
    v_mfma_f32_16x16x32_bf16 v[24:27], v[40:43], v[96:99], 0
    v_cndmask_b32_dpp v238, v122, v126, vcc quad_perm:[1,0,3,2] row_mask:0xf bank_mask:0xf
    v_cndmask_b32_dpp v239, v123, v127, vcc quad_perm:[1,0,3,2] row_mask:0xf bank_mask:0xf
    buffer_load_dwordx4 v[96:99], v69, s[36:39], s68 offen offset:0
    s_waitcnt lgkmcnt(0)
    v_mfma_f32_16x16x32_bf16 v[12:15], v[60:63], v[84:87], v[12:15]
    ds_read_b64_tr_b16 v[36:37], v75 offset:2048
    ds_read_b64_tr_b16 v[38:39], v75 offset:2560
    s_mov_b32 vcc_lo, 0x33333333
    s_mov_b32 vcc_hi, 0x33333333
    v_cndmask_b32_dpp v112, v232, v224, vcc quad_perm:[2,3,0,1] row_mask:0xf bank_mask:0xf
    v_cndmask_b32_dpp v113, v233, v225, vcc quad_perm:[2,3,0,1] row_mask:0xf bank_mask:0xf
    v_mfma_f32_16x16x32_bf16 v[16:19], v[64:67], v[84:87], v[16:19]
    ds_read_b64_tr_b16 v[40:41], v76 offset:2048
    ds_read_b64_tr_b16 v[42:43], v76 offset:2560
    v_cndmask_b32_dpp v114, v234, v226, vcc quad_perm:[2,3,0,1] row_mask:0xf bank_mask:0xf
    v_cndmask_b32_dpp v115, v235, v227, vcc quad_perm:[2,3,0,1] row_mask:0xf bank_mask:0xf
    v_mfma_f32_16x16x32_bf16 v[4:7], v[52:55], v[84:87], v[4:7]
    ds_read_b64_tr_b16 v[44:45], v77 offset:2048
    ds_read_b64_tr_b16 v[46:47], v77 offset:2560
    v_cndmask_b32_dpp v116, v236, v228, vcc quad_perm:[2,3,0,1] row_mask:0xf bank_mask:0xf
    v_cndmask_b32_dpp v117, v237, v229, vcc quad_perm:[2,3,0,1] row_mask:0xf bank_mask:0xf
    v_mfma_f32_16x16x32_bf16 v[8:11], v[56:59], v[84:87], v[8:11]
    ds_read_b64_tr_b16 v[48:49], v78 offset:2048
    ds_read_b64_tr_b16 v[50:51], v78 offset:2560
    v_cndmask_b32_dpp v118, v238, v230, vcc quad_perm:[2,3,0,1] row_mask:0xf bank_mask:0xf
    v_cndmask_b32_dpp v119, v239, v231, vcc quad_perm:[2,3,0,1] row_mask:0xf bank_mask:0xf
    buffer_load_dwordx4 v[84:87], v68, s[36:39], s68 offen offset:2048
    v_mfma_f32_16x16x32_bf16 v[28:31], v[60:63], v[100:103], v[28:31]
    s_mov_b32 vcc_lo, 0xcccccccc
    s_mov_b32 vcc_hi, 0xcccccccc
    v_cndmask_b32_dpp v120, v224, v232, vcc quad_perm:[2,3,0,1] row_mask:0xf bank_mask:0xf
    v_cndmask_b32_dpp v121, v225, v233, vcc quad_perm:[2,3,0,1] row_mask:0xf bank_mask:0xf
    v_mfma_f32_16x16x32_bf16 v[32:35], v[64:67], v[100:103], v[32:35]
    v_cndmask_b32_dpp v122, v226, v234, vcc quad_perm:[2,3,0,1] row_mask:0xf bank_mask:0xf
    v_cndmask_b32_dpp v123, v227, v235, vcc quad_perm:[2,3,0,1] row_mask:0xf bank_mask:0xf
    v_mfma_f32_16x16x32_bf16 v[20:23], v[52:55], v[100:103], v[20:23]
    v_cndmask_b32_dpp v124, v228, v236, vcc quad_perm:[2,3,0,1] row_mask:0xf bank_mask:0xf
    v_cndmask_b32_dpp v125, v229, v237, vcc quad_perm:[2,3,0,1] row_mask:0xf bank_mask:0xf
    v_mfma_f32_16x16x32_bf16 v[24:27], v[56:59], v[100:103], v[24:27]
    v_cndmask_b32_dpp v126, v230, v238, vcc quad_perm:[2,3,0,1] row_mask:0xf bank_mask:0xf
    v_cndmask_b32_dpp v127, v231, v239, vcc quad_perm:[2,3,0,1] row_mask:0xf bank_mask:0xf
    buffer_load_dwordx4 v[100:103], v69, s[36:39], s68 offen offset:2048
    s_cmp_lg_u32 s73, 0
    s_cbranch_scc1 p0sig_51
p0retf_52:
    s_waitcnt lgkmcnt(0)
    v_mfma_f32_16x16x32_bf16 v[12:15], v[44:47], v[88:91], v[12:15]
    ds_read_b64_tr_b16 v[52:53], v75 offset:3072
    ds_read_b64_tr_b16 v[54:55], v75 offset:3584
    s_mov_b32 vcc_lo, 0x55555555
    s_mov_b32 vcc_hi, 0x55555555
    v_cndmask_b32_dpp v224, v132, v128, vcc quad_perm:[1,0,3,2] row_mask:0xf bank_mask:0xf
    v_cndmask_b32_dpp v225, v133, v129, vcc quad_perm:[1,0,3,2] row_mask:0xf bank_mask:0xf
    v_mfma_f32_16x16x32_bf16 v[16:19], v[48:51], v[88:91], v[16:19]
    ds_read_b64_tr_b16 v[56:57], v76 offset:3072
    ds_read_b64_tr_b16 v[58:59], v76 offset:3584
    v_cndmask_b32_dpp v226, v134, v130, vcc quad_perm:[1,0,3,2] row_mask:0xf bank_mask:0xf
    v_cndmask_b32_dpp v227, v135, v131, vcc quad_perm:[1,0,3,2] row_mask:0xf bank_mask:0xf
    v_mfma_f32_16x16x32_bf16 v[4:7], v[36:39], v[88:91], v[4:7]
    ds_read_b64_tr_b16 v[60:61], v77 offset:3072
    ds_read_b64_tr_b16 v[62:63], v77 offset:3584
    v_cndmask_b32_dpp v232, v140, v136, vcc quad_perm:[1,0,3,2] row_mask:0xf bank_mask:0xf
    v_cndmask_b32_dpp v233, v141, v137, vcc quad_perm:[1,0,3,2] row_mask:0xf bank_mask:0xf
    v_mfma_f32_16x16x32_bf16 v[8:11], v[40:43], v[88:91], v[8:11]
    ds_read_b64_tr_b16 v[64:65], v78 offset:3072
    ds_read_b64_tr_b16 v[66:67], v78 offset:3584
    v_cndmask_b32_dpp v234, v142, v138, vcc quad_perm:[1,0,3,2] row_mask:0xf bank_mask:0xf
    v_cndmask_b32_dpp v235, v143, v139, vcc quad_perm:[1,0,3,2] row_mask:0xf bank_mask:0xf
    buffer_load_dwordx4 v[88:91], v71, s[36:39], s68 offen offset:0
    v_mfma_f32_16x16x32_bf16 v[28:31], v[44:47], v[104:107], v[28:31]
    s_mov_b32 vcc_lo, 0xaaaaaaaa
    s_mov_b32 vcc_hi, 0xaaaaaaaa
    v_cndmask_b32_dpp v228, v128, v132, vcc quad_perm:[1,0,3,2] row_mask:0xf bank_mask:0xf
    v_cndmask_b32_dpp v229, v129, v133, vcc quad_perm:[1,0,3,2] row_mask:0xf bank_mask:0xf
    v_mfma_f32_16x16x32_bf16 v[32:35], v[48:51], v[104:107], v[32:35]
    v_cndmask_b32_dpp v230, v130, v134, vcc quad_perm:[1,0,3,2] row_mask:0xf bank_mask:0xf
    v_cndmask_b32_dpp v231, v131, v135, vcc quad_perm:[1,0,3,2] row_mask:0xf bank_mask:0xf
    v_mfma_f32_16x16x32_bf16 v[20:23], v[36:39], v[104:107], v[20:23]
    v_cndmask_b32_dpp v236, v136, v140, vcc quad_perm:[1,0,3,2] row_mask:0xf bank_mask:0xf
    v_cndmask_b32_dpp v237, v137, v141, vcc quad_perm:[1,0,3,2] row_mask:0xf bank_mask:0xf
    v_mfma_f32_16x16x32_bf16 v[24:27], v[40:43], v[104:107], v[24:27]
    v_cndmask_b32_dpp v238, v138, v142, vcc quad_perm:[1,0,3,2] row_mask:0xf bank_mask:0xf
    v_cndmask_b32_dpp v239, v139, v143, vcc quad_perm:[1,0,3,2] row_mask:0xf bank_mask:0xf
    buffer_load_dwordx4 v[104:107], v72, s[36:39], s68 offen offset:0
    s_waitcnt lgkmcnt(0)
    v_xor_b32 v75, 0x4000, v75
    v_xor_b32 v76, 0x4000, v76
    v_xor_b32 v77, 0x4000, v77
    v_xor_b32 v78, 0x4000, v78
    v_mfma_f32_16x16x32_bf16 v[12:15], v[60:63], v[92:95], v[12:15]
    ds_read_b64_tr_b16 v[36:37], v75 offset:0
    ds_read_b64_tr_b16 v[38:39], v75 offset:512
    s_mov_b32 vcc_lo, 0x33333333
    s_mov_b32 vcc_hi, 0x33333333
    v_cndmask_b32_dpp v128, v232, v224, vcc quad_perm:[2,3,0,1] row_mask:0xf bank_mask:0xf
    v_cndmask_b32_dpp v129, v233, v225, vcc quad_perm:[2,3,0,1] row_mask:0xf bank_mask:0xf
    v_mfma_f32_16x16x32_bf16 v[16:19], v[64:67], v[92:95], v[16:19]
    ds_read_b64_tr_b16 v[40:41], v76 offset:0
    ds_read_b64_tr_b16 v[42:43], v76 offset:512
    v_cndmask_b32_dpp v130, v234, v226, vcc quad_perm:[2,3,0,1] row_mask:0xf bank_mask:0xf
    v_cndmask_b32_dpp v131, v235, v227, vcc quad_perm:[2,3,0,1] row_mask:0xf bank_mask:0xf
    v_mfma_f32_16x16x32_bf16 v[4:7], v[52:55], v[92:95], v[4:7]
    ds_read_b64_tr_b16 v[44:45], v77 offset:0
    ds_read_b64_tr_b16 v[46:47], v77 offset:512
    v_cndmask_b32_dpp v132, v236, v228, vcc quad_perm:[2,3,0,1] row_mask:0xf bank_mask:0xf
    v_cndmask_b32_dpp v133, v237, v229, vcc quad_perm:[2,3,0,1] row_mask:0xf bank_mask:0xf
    v_mfma_f32_16x16x32_bf16 v[8:11], v[56:59], v[92:95], v[8:11]
    ds_read_b64_tr_b16 v[48:49], v78 offset:0
    ds_read_b64_tr_b16 v[50:51], v78 offset:512
    v_cndmask_b32_dpp v134, v238, v230, vcc quad_perm:[2,3,0,1] row_mask:0xf bank_mask:0xf
    v_cndmask_b32_dpp v135, v239, v231, vcc quad_perm:[2,3,0,1] row_mask:0xf bank_mask:0xf
    buffer_load_dwordx4 v[92:95], v71, s[36:39], s68 offen offset:2048
    v_mfma_f32_16x16x32_bf16 v[28:31], v[60:63], v[108:111], v[28:31]
    s_mov_b32 vcc_lo, 0xcccccccc
    s_mov_b32 vcc_hi, 0xcccccccc
    v_cndmask_b32_dpp v136, v224, v232, vcc quad_perm:[2,3,0,1] row_mask:0xf bank_mask:0xf
    v_cndmask_b32_dpp v137, v225, v233, vcc quad_perm:[2,3,0,1] row_mask:0xf bank_mask:0xf
    v_mfma_f32_16x16x32_bf16 v[32:35], v[64:67], v[108:111], v[32:35]
    v_cndmask_b32_dpp v138, v226, v234, vcc quad_perm:[2,3,0,1] row_mask:0xf bank_mask:0xf
    v_cndmask_b32_dpp v139, v227, v235, vcc quad_perm:[2,3,0,1] row_mask:0xf bank_mask:0xf
    v_mfma_f32_16x16x32_bf16 v[20:23], v[52:55], v[108:111], v[20:23]
    v_cndmask_b32_dpp v140, v228, v236, vcc quad_perm:[2,3,0,1] row_mask:0xf bank_mask:0xf
    v_cndmask_b32_dpp v141, v229, v237, vcc quad_perm:[2,3,0,1] row_mask:0xf bank_mask:0xf
    v_mfma_f32_16x16x32_bf16 v[24:27], v[56:59], v[108:111], v[24:27]
    v_cndmask_b32_dpp v142, v230, v238, vcc quad_perm:[2,3,0,1] row_mask:0xf bank_mask:0xf
    v_cndmask_b32_dpp v143, v231, v239, vcc quad_perm:[2,3,0,1] row_mask:0xf bank_mask:0xf
    buffer_load_dwordx4 v[108:111], v72, s[36:39], s68 offen offset:2048
    v_xor_b32 v68, 0x100, v68
    v_xor_b32 v69, 0x100, v69
    v_xor_b32 v71, 0x100, v71
    v_xor_b32 v72, 0x100, v72
    s_waitcnt vmcnt(16) lgkmcnt(0)
    v_mfma_f32_16x16x32_bf16 v[12:15], v[44:47], v[112:115], v[12:15]
    ds_read_b64_tr_b16 v[52:53], v75 offset:1024
    ds_read_b64_tr_b16 v[54:55], v75 offset:1536
    s_mov_b32 vcc_lo, 0x55555555
    s_mov_b32 vcc_hi, 0x55555555
    v_cndmask_b32_dpp v224, v148, v144, vcc quad_perm:[1,0,3,2] row_mask:0xf bank_mask:0xf
    v_cndmask_b32_dpp v225, v149, v145, vcc quad_perm:[1,0,3,2] row_mask:0xf bank_mask:0xf
    v_mfma_f32_16x16x32_bf16 v[16:19], v[48:51], v[112:115], v[16:19]
    ds_read_b64_tr_b16 v[56:57], v76 offset:1024
    ds_read_b64_tr_b16 v[58:59], v76 offset:1536
    v_cndmask_b32_dpp v226, v150, v146, vcc quad_perm:[1,0,3,2] row_mask:0xf bank_mask:0xf
    v_cndmask_b32_dpp v227, v151, v147, vcc quad_perm:[1,0,3,2] row_mask:0xf bank_mask:0xf
    v_mfma_f32_16x16x32_bf16 v[4:7], v[36:39], v[112:115], v[4:7]
    ds_read_b64_tr_b16 v[60:61], v77 offset:1024
    ds_read_b64_tr_b16 v[62:63], v77 offset:1536
    v_cndmask_b32_dpp v232, v156, v152, vcc quad_perm:[1,0,3,2] row_mask:0xf bank_mask:0xf
    v_cndmask_b32_dpp v233, v157, v153, vcc quad_perm:[1,0,3,2] row_mask:0xf bank_mask:0xf
    v_mfma_f32_16x16x32_bf16 v[8:11], v[40:43], v[112:115], v[8:11]
    ds_read_b64_tr_b16 v[64:65], v78 offset:1024
    ds_read_b64_tr_b16 v[66:67], v78 offset:1536
    v_cndmask_b32_dpp v234, v158, v154, vcc quad_perm:[1,0,3,2] row_mask:0xf bank_mask:0xf
    v_cndmask_b32_dpp v235, v159, v155, vcc quad_perm:[1,0,3,2] row_mask:0xf bank_mask:0xf
    buffer_load_dwordx4 v[112:115], v68, s[36:39], s68 offen offset:0
    v_mfma_f32_16x16x32_bf16 v[28:31], v[44:47], v[128:131], v[28:31]
    s_mov_b32 vcc_lo, 0xaaaaaaaa
    s_mov_b32 vcc_hi, 0xaaaaaaaa
    v_cndmask_b32_dpp v228, v144, v148, vcc quad_perm:[1,0,3,2] row_mask:0xf bank_mask:0xf
    v_cndmask_b32_dpp v229, v145, v149, vcc quad_perm:[1,0,3,2] row_mask:0xf bank_mask:0xf
    v_mfma_f32_16x16x32_bf16 v[32:35], v[48:51], v[128:131], v[32:35]
    v_cndmask_b32_dpp v230, v146, v150, vcc quad_perm:[1,0,3,2] row_mask:0xf bank_mask:0xf
    v_cndmask_b32_dpp v231, v147, v151, vcc quad_perm:[1,0,3,2] row_mask:0xf bank_mask:0xf
    v_mfma_f32_16x16x32_bf16 v[20:23], v[36:39], v[128:131], v[20:23]
    v_cndmask_b32_dpp v236, v152, v156, vcc quad_perm:[1,0,3,2] row_mask:0xf bank_mask:0xf
    v_cndmask_b32_dpp v237, v153, v157, vcc quad_perm:[1,0,3,2] row_mask:0xf bank_mask:0xf
    v_mfma_f32_16x16x32_bf16 v[24:27], v[40:43], v[128:131], v[24:27]
    v_cndmask_b32_dpp v238, v154, v158, vcc quad_perm:[1,0,3,2] row_mask:0xf bank_mask:0xf
    v_cndmask_b32_dpp v239, v155, v159, vcc quad_perm:[1,0,3,2] row_mask:0xf bank_mask:0xf
    buffer_load_dwordx4 v[128:131], v69, s[36:39], s68 offen offset:0
    s_waitcnt lgkmcnt(0)
    v_mfma_f32_16x16x32_bf16 v[12:15], v[60:63], v[116:119], v[12:15]
    ds_read_b64_tr_b16 v[36:37], v75 offset:2048
    ds_read_b64_tr_b16 v[38:39], v75 offset:2560
    s_mov_b32 vcc_lo, 0x33333333
    s_mov_b32 vcc_hi, 0x33333333
    v_cndmask_b32_dpp v144, v232, v224, vcc quad_perm:[2,3,0,1] row_mask:0xf bank_mask:0xf
    v_cndmask_b32_dpp v145, v233, v225, vcc quad_perm:[2,3,0,1] row_mask:0xf bank_mask:0xf
    v_mfma_f32_16x16x32_bf16 v[16:19], v[64:67], v[116:119], v[16:19]
    ds_read_b64_tr_b16 v[40:41], v76 offset:2048
    ds_read_b64_tr_b16 v[42:43], v76 offset:2560
    v_cndmask_b32_dpp v146, v234, v226, vcc quad_perm:[2,3,0,1] row_mask:0xf bank_mask:0xf
    v_cndmask_b32_dpp v147, v235, v227, vcc quad_perm:[2,3,0,1] row_mask:0xf bank_mask:0xf
    v_mfma_f32_16x16x32_bf16 v[4:7], v[52:55], v[116:119], v[4:7]
    ds_read_b64_tr_b16 v[44:45], v77 offset:2048
    ds_read_b64_tr_b16 v[46:47], v77 offset:2560
    v_cndmask_b32_dpp v148, v236, v228, vcc quad_perm:[2,3,0,1] row_mask:0xf bank_mask:0xf
    v_cndmask_b32_dpp v149, v237, v229, vcc quad_perm:[2,3,0,1] row_mask:0xf bank_mask:0xf
    v_mfma_f32_16x16x32_bf16 v[8:11], v[56:59], v[116:119], v[8:11]
    ds_read_b64_tr_b16 v[48:49], v78 offset:2048
    ds_read_b64_tr_b16 v[50:51], v78 offset:2560
    v_cndmask_b32_dpp v150, v238, v230, vcc quad_perm:[2,3,0,1] row_mask:0xf bank_mask:0xf
    v_cndmask_b32_dpp v151, v239, v231, vcc quad_perm:[2,3,0,1] row_mask:0xf bank_mask:0xf
    buffer_load_dwordx4 v[116:119], v68, s[36:39], s68 offen offset:2048
    v_mfma_f32_16x16x32_bf16 v[28:31], v[60:63], v[132:135], v[28:31]
    s_mov_b32 vcc_lo, 0xcccccccc
    s_mov_b32 vcc_hi, 0xcccccccc
    v_cndmask_b32_dpp v152, v224, v232, vcc quad_perm:[2,3,0,1] row_mask:0xf bank_mask:0xf
    v_cndmask_b32_dpp v153, v225, v233, vcc quad_perm:[2,3,0,1] row_mask:0xf bank_mask:0xf
    v_mfma_f32_16x16x32_bf16 v[32:35], v[64:67], v[132:135], v[32:35]
    v_cndmask_b32_dpp v154, v226, v234, vcc quad_perm:[2,3,0,1] row_mask:0xf bank_mask:0xf
    v_cndmask_b32_dpp v155, v227, v235, vcc quad_perm:[2,3,0,1] row_mask:0xf bank_mask:0xf
    v_mfma_f32_16x16x32_bf16 v[20:23], v[52:55], v[132:135], v[20:23]
    v_cndmask_b32_dpp v156, v228, v236, vcc quad_perm:[2,3,0,1] row_mask:0xf bank_mask:0xf
    v_cndmask_b32_dpp v157, v229, v237, vcc quad_perm:[2,3,0,1] row_mask:0xf bank_mask:0xf
    v_mfma_f32_16x16x32_bf16 v[24:27], v[56:59], v[132:135], v[24:27]
    v_cndmask_b32_dpp v158, v230, v238, vcc quad_perm:[2,3,0,1] row_mask:0xf bank_mask:0xf
    v_cndmask_b32_dpp v159, v231, v239, vcc quad_perm:[2,3,0,1] row_mask:0xf bank_mask:0xf
    buffer_load_dwordx4 v[132:135], v69, s[36:39], s68 offen offset:2048
    s_waitcnt lgkmcnt(0)
    v_mfma_f32_16x16x32_bf16 v[12:15], v[44:47], v[120:123], v[12:15]
    ds_read_b64_tr_b16 v[52:53], v75 offset:3072
    ds_read_b64_tr_b16 v[54:55], v75 offset:3584
    s_mov_b32 vcc_lo, 0x55555555
    s_mov_b32 vcc_hi, 0x55555555
    v_cndmask_b32_dpp v224, v164, v160, vcc quad_perm:[1,0,3,2] row_mask:0xf bank_mask:0xf
    v_cndmask_b32_dpp v225, v165, v161, vcc quad_perm:[1,0,3,2] row_mask:0xf bank_mask:0xf
    v_mfma_f32_16x16x32_bf16 v[16:19], v[48:51], v[120:123], v[16:19]
    ds_read_b64_tr_b16 v[56:57], v76 offset:3072
    ds_read_b64_tr_b16 v[58:59], v76 offset:3584
    v_cndmask_b32_dpp v226, v166, v162, vcc quad_perm:[1,0,3,2] row_mask:0xf bank_mask:0xf
    v_cndmask_b32_dpp v227, v167, v163, vcc quad_perm:[1,0,3,2] row_mask:0xf bank_mask:0xf
    v_mfma_f32_16x16x32_bf16 v[4:7], v[36:39], v[120:123], v[4:7]
    ds_read_b64_tr_b16 v[60:61], v77 offset:3072
    ds_read_b64_tr_b16 v[62:63], v77 offset:3584
    v_cndmask_b32_dpp v232, v172, v168, vcc quad_perm:[1,0,3,2] row_mask:0xf bank_mask:0xf
    v_cndmask_b32_dpp v233, v173, v169, vcc quad_perm:[1,0,3,2] row_mask:0xf bank_mask:0xf
    v_mfma_f32_16x16x32_bf16 v[8:11], v[40:43], v[120:123], v[8:11]
    ds_read_b64_tr_b16 v[64:65], v78 offset:3072
    ds_read_b64_tr_b16 v[66:67], v78 offset:3584
    v_cndmask_b32_dpp v234, v174, v170, vcc quad_perm:[1,0,3,2] row_mask:0xf bank_mask:0xf
    v_cndmask_b32_dpp v235, v175, v171, vcc quad_perm:[1,0,3,2] row_mask:0xf bank_mask:0xf
    buffer_load_dwordx4 v[120:123], v71, s[36:39], s68 offen offset:0
    v_mfma_f32_16x16x32_bf16 v[28:31], v[44:47], v[136:139], v[28:31]
    s_mov_b32 vcc_lo, 0xaaaaaaaa
    s_mov_b32 vcc_hi, 0xaaaaaaaa
    v_cndmask_b32_dpp v228, v160, v164, vcc quad_perm:[1,0,3,2] row_mask:0xf bank_mask:0xf
    v_cndmask_b32_dpp v229, v161, v165, vcc quad_perm:[1,0,3,2] row_mask:0xf bank_mask:0xf
    v_mfma_f32_16x16x32_bf16 v[32:35], v[48:51], v[136:139], v[32:35]
    v_cndmask_b32_dpp v230, v162, v166, vcc quad_perm:[1,0,3,2] row_mask:0xf bank_mask:0xf
    v_cndmask_b32_dpp v231, v163, v167, vcc quad_perm:[1,0,3,2] row_mask:0xf bank_mask:0xf
    v_mfma_f32_16x16x32_bf16 v[20:23], v[36:39], v[136:139], v[20:23]
    v_cndmask_b32_dpp v236, v168, v172, vcc quad_perm:[1,0,3,2] row_mask:0xf bank_mask:0xf
    v_cndmask_b32_dpp v237, v169, v173, vcc quad_perm:[1,0,3,2] row_mask:0xf bank_mask:0xf
    v_mfma_f32_16x16x32_bf16 v[24:27], v[40:43], v[136:139], v[24:27]
    v_cndmask_b32_dpp v238, v170, v174, vcc quad_perm:[1,0,3,2] row_mask:0xf bank_mask:0xf
    v_cndmask_b32_dpp v239, v171, v175, vcc quad_perm:[1,0,3,2] row_mask:0xf bank_mask:0xf
    buffer_load_dwordx4 v[136:139], v72, s[36:39], s68 offen offset:0
    s_waitcnt lgkmcnt(0)
    v_xor_b32 v75, 0xc000, v75
    v_xor_b32 v76, 0xc000, v76
    v_xor_b32 v77, 0xc000, v77
    v_xor_b32 v78, 0xc000, v78
    v_mfma_f32_16x16x32_bf16 v[12:15], v[60:63], v[124:127], v[12:15]
    ds_read_b64_tr_b16 v[36:37], v75 offset:0
    ds_read_b64_tr_b16 v[38:39], v75 offset:512
    s_mov_b32 vcc_lo, 0x33333333
    s_mov_b32 vcc_hi, 0x33333333
    v_cndmask_b32_dpp v160, v232, v224, vcc quad_perm:[2,3,0,1] row_mask:0xf bank_mask:0xf
    v_cndmask_b32_dpp v161, v233, v225, vcc quad_perm:[2,3,0,1] row_mask:0xf bank_mask:0xf
    v_mfma_f32_16x16x32_bf16 v[16:19], v[64:67], v[124:127], v[16:19]
    ds_read_b64_tr_b16 v[40:41], v76 offset:0
    ds_read_b64_tr_b16 v[42:43], v76 offset:512
    v_cndmask_b32_dpp v162, v234, v226, vcc quad_perm:[2,3,0,1] row_mask:0xf bank_mask:0xf
    v_cndmask_b32_dpp v163, v235, v227, vcc quad_perm:[2,3,0,1] row_mask:0xf bank_mask:0xf
    v_mfma_f32_16x16x32_bf16 v[4:7], v[52:55], v[124:127], v[4:7]
    ds_read_b64_tr_b16 v[44:45], v77 offset:0
    ds_read_b64_tr_b16 v[46:47], v77 offset:512
    v_cndmask_b32_dpp v164, v236, v228, vcc quad_perm:[2,3,0,1] row_mask:0xf bank_mask:0xf
    v_cndmask_b32_dpp v165, v237, v229, vcc quad_perm:[2,3,0,1] row_mask:0xf bank_mask:0xf
    v_mfma_f32_16x16x32_bf16 v[8:11], v[56:59], v[124:127], v[8:11]
    ds_read_b64_tr_b16 v[48:49], v78 offset:0
    ds_read_b64_tr_b16 v[50:51], v78 offset:512
    v_cndmask_b32_dpp v166, v238, v230, vcc quad_perm:[2,3,0,1] row_mask:0xf bank_mask:0xf
    v_cndmask_b32_dpp v167, v239, v231, vcc quad_perm:[2,3,0,1] row_mask:0xf bank_mask:0xf
    buffer_load_dwordx4 v[124:127], v71, s[36:39], s68 offen offset:2048
    v_mfma_f32_16x16x32_bf16 v[28:31], v[60:63], v[140:143], v[28:31]
    s_mov_b32 vcc_lo, 0xcccccccc
    s_mov_b32 vcc_hi, 0xcccccccc
    v_cndmask_b32_dpp v168, v224, v232, vcc quad_perm:[2,3,0,1] row_mask:0xf bank_mask:0xf
    v_cndmask_b32_dpp v169, v225, v233, vcc quad_perm:[2,3,0,1] row_mask:0xf bank_mask:0xf
    v_mfma_f32_16x16x32_bf16 v[32:35], v[64:67], v[140:143], v[32:35]
    v_cndmask_b32_dpp v170, v226, v234, vcc quad_perm:[2,3,0,1] row_mask:0xf bank_mask:0xf
    v_cndmask_b32_dpp v171, v227, v235, vcc quad_perm:[2,3,0,1] row_mask:0xf bank_mask:0xf
    v_mfma_f32_16x16x32_bf16 v[20:23], v[52:55], v[140:143], v[20:23]
    v_cndmask_b32_dpp v172, v228, v236, vcc quad_perm:[2,3,0,1] row_mask:0xf bank_mask:0xf
    v_cndmask_b32_dpp v173, v229, v237, vcc quad_perm:[2,3,0,1] row_mask:0xf bank_mask:0xf
    v_mfma_f32_16x16x32_bf16 v[24:27], v[56:59], v[140:143], v[24:27]
    v_cndmask_b32_dpp v174, v230, v238, vcc quad_perm:[2,3,0,1] row_mask:0xf bank_mask:0xf
    v_cndmask_b32_dpp v175, v231, v239, vcc quad_perm:[2,3,0,1] row_mask:0xf bank_mask:0xf
    buffer_load_dwordx4 v[140:143], v72, s[36:39], s68 offen offset:2048
    v_xor_b32 v68, 0x300, v68
    v_xor_b32 v69, 0x300, v69
    v_xor_b32 v71, 0x300, v71
    v_xor_b32 v72, 0x300, v72
    s_waitcnt vmcnt(16) lgkmcnt(0)
    v_mfma_f32_16x16x32_bf16 v[12:15], v[44:47], v[144:147], v[12:15]
    ds_read_b64_tr_b16 v[52:53], v75 offset:1024
    ds_read_b64_tr_b16 v[54:55], v75 offset:1536
    s_mov_b32 vcc_lo, 0x55555555
    s_mov_b32 vcc_hi, 0x55555555
    v_cndmask_b32_dpp v224, v180, v176, vcc quad_perm:[1,0,3,2] row_mask:0xf bank_mask:0xf
    v_cndmask_b32_dpp v225, v181, v177, vcc quad_perm:[1,0,3,2] row_mask:0xf bank_mask:0xf
    v_mfma_f32_16x16x32_bf16 v[16:19], v[48:51], v[144:147], v[16:19]
    ds_read_b64_tr_b16 v[56:57], v76 offset:1024
    ds_read_b64_tr_b16 v[58:59], v76 offset:1536
    v_cndmask_b32_dpp v226, v182, v178, vcc quad_perm:[1,0,3,2] row_mask:0xf bank_mask:0xf
    v_cndmask_b32_dpp v227, v183, v179, vcc quad_perm:[1,0,3,2] row_mask:0xf bank_mask:0xf
    v_mfma_f32_16x16x32_bf16 v[4:7], v[36:39], v[144:147], v[4:7]
    ds_read_b64_tr_b16 v[60:61], v77 offset:1024
    ds_read_b64_tr_b16 v[62:63], v77 offset:1536
    v_cndmask_b32_dpp v232, v188, v184, vcc quad_perm:[1,0,3,2] row_mask:0xf bank_mask:0xf
    v_cndmask_b32_dpp v233, v189, v185, vcc quad_perm:[1,0,3,2] row_mask:0xf bank_mask:0xf
    v_mfma_f32_16x16x32_bf16 v[8:11], v[40:43], v[144:147], v[8:11]
    ds_read_b64_tr_b16 v[64:65], v78 offset:1024
    ds_read_b64_tr_b16 v[66:67], v78 offset:1536
    v_cndmask_b32_dpp v234, v190, v186, vcc quad_perm:[1,0,3,2] row_mask:0xf bank_mask:0xf
    v_cndmask_b32_dpp v235, v191, v187, vcc quad_perm:[1,0,3,2] row_mask:0xf bank_mask:0xf
    buffer_load_dwordx4 v[144:147], v68, s[36:39], s68 offen offset:0
    v_mfma_f32_16x16x32_bf16 v[28:31], v[44:47], v[160:163], v[28:31]
    s_mov_b32 vcc_lo, 0xaaaaaaaa
    s_mov_b32 vcc_hi, 0xaaaaaaaa
    v_cndmask_b32_dpp v228, v176, v180, vcc quad_perm:[1,0,3,2] row_mask:0xf bank_mask:0xf
    v_cndmask_b32_dpp v229, v177, v181, vcc quad_perm:[1,0,3,2] row_mask:0xf bank_mask:0xf
    v_mfma_f32_16x16x32_bf16 v[32:35], v[48:51], v[160:163], v[32:35]
    v_cndmask_b32_dpp v230, v178, v182, vcc quad_perm:[1,0,3,2] row_mask:0xf bank_mask:0xf
    v_cndmask_b32_dpp v231, v179, v183, vcc quad_perm:[1,0,3,2] row_mask:0xf bank_mask:0xf
    v_mfma_f32_16x16x32_bf16 v[20:23], v[36:39], v[160:163], v[20:23]
    v_cndmask_b32_dpp v236, v184, v188, vcc quad_perm:[1,0,3,2] row_mask:0xf bank_mask:0xf
    v_cndmask_b32_dpp v237, v185, v189, vcc quad_perm:[1,0,3,2] row_mask:0xf bank_mask:0xf
    v_mfma_f32_16x16x32_bf16 v[24:27], v[40:43], v[160:163], v[24:27]
    v_cndmask_b32_dpp v238, v186, v190, vcc quad_perm:[1,0,3,2] row_mask:0xf bank_mask:0xf
    v_cndmask_b32_dpp v239, v187, v191, vcc quad_perm:[1,0,3,2] row_mask:0xf bank_mask:0xf
    buffer_load_dwordx4 v[160:163], v69, s[36:39], s68 offen offset:0
    s_waitcnt lgkmcnt(0)
    v_mfma_f32_16x16x32_bf16 v[12:15], v[60:63], v[148:151], v[12:15]
    ds_read_b64_tr_b16 v[36:37], v75 offset:2048
    ds_read_b64_tr_b16 v[38:39], v75 offset:2560
    s_mov_b32 vcc_lo, 0x33333333
    s_mov_b32 vcc_hi, 0x33333333
    v_cndmask_b32_dpp v176, v232, v224, vcc quad_perm:[2,3,0,1] row_mask:0xf bank_mask:0xf
    v_cndmask_b32_dpp v177, v233, v225, vcc quad_perm:[2,3,0,1] row_mask:0xf bank_mask:0xf
    v_mfma_f32_16x16x32_bf16 v[16:19], v[64:67], v[148:151], v[16:19]
    ds_read_b64_tr_b16 v[40:41], v76 offset:2048
    ds_read_b64_tr_b16 v[42:43], v76 offset:2560
    v_cndmask_b32_dpp v178, v234, v226, vcc quad_perm:[2,3,0,1] row_mask:0xf bank_mask:0xf
    v_cndmask_b32_dpp v179, v235, v227, vcc quad_perm:[2,3,0,1] row_mask:0xf bank_mask:0xf
    v_mfma_f32_16x16x32_bf16 v[4:7], v[52:55], v[148:151], v[4:7]
    ds_read_b64_tr_b16 v[44:45], v77 offset:2048
    ds_read_b64_tr_b16 v[46:47], v77 offset:2560
    v_cndmask_b32_dpp v180, v236, v228, vcc quad_perm:[2,3,0,1] row_mask:0xf bank_mask:0xf
    v_cndmask_b32_dpp v181, v237, v229, vcc quad_perm:[2,3,0,1] row_mask:0xf bank_mask:0xf
    v_mfma_f32_16x16x32_bf16 v[8:11], v[56:59], v[148:151], v[8:11]
    ds_read_b64_tr_b16 v[48:49], v78 offset:2048
    ds_read_b64_tr_b16 v[50:51], v78 offset:2560
    v_cndmask_b32_dpp v182, v238, v230, vcc quad_perm:[2,3,0,1] row_mask:0xf bank_mask:0xf
    v_cndmask_b32_dpp v183, v239, v231, vcc quad_perm:[2,3,0,1] row_mask:0xf bank_mask:0xf
    buffer_load_dwordx4 v[148:151], v68, s[36:39], s68 offen offset:2048
    v_mfma_f32_16x16x32_bf16 v[28:31], v[60:63], v[164:167], v[28:31]
    s_mov_b32 vcc_lo, 0xcccccccc
    s_mov_b32 vcc_hi, 0xcccccccc
    v_cndmask_b32_dpp v184, v224, v232, vcc quad_perm:[2,3,0,1] row_mask:0xf bank_mask:0xf
    v_cndmask_b32_dpp v185, v225, v233, vcc quad_perm:[2,3,0,1] row_mask:0xf bank_mask:0xf
    v_mfma_f32_16x16x32_bf16 v[32:35], v[64:67], v[164:167], v[32:35]
    v_cndmask_b32_dpp v186, v226, v234, vcc quad_perm:[2,3,0,1] row_mask:0xf bank_mask:0xf
    v_cndmask_b32_dpp v187, v227, v235, vcc quad_perm:[2,3,0,1] row_mask:0xf bank_mask:0xf
    v_mfma_f32_16x16x32_bf16 v[20:23], v[52:55], v[164:167], v[20:23]
    v_cndmask_b32_dpp v188, v228, v236, vcc quad_perm:[2,3,0,1] row_mask:0xf bank_mask:0xf
    v_cndmask_b32_dpp v189, v229, v237, vcc quad_perm:[2,3,0,1] row_mask:0xf bank_mask:0xf
    v_mfma_f32_16x16x32_bf16 v[24:27], v[56:59], v[164:167], v[24:27]
    v_cndmask_b32_dpp v190, v230, v238, vcc quad_perm:[2,3,0,1] row_mask:0xf bank_mask:0xf
    v_cndmask_b32_dpp v191, v231, v239, vcc quad_perm:[2,3,0,1] row_mask:0xf bank_mask:0xf
    buffer_load_dwordx4 v[164:167], v69, s[36:39], s68 offen offset:2048
    s_waitcnt lgkmcnt(0)
    v_mfma_f32_16x16x32_bf16 v[12:15], v[44:47], v[152:155], v[12:15]
    ds_read_b64_tr_b16 v[52:53], v75 offset:3072
    ds_read_b64_tr_b16 v[54:55], v75 offset:3584
    s_mov_b32 vcc_lo, 0x55555555
    s_mov_b32 vcc_hi, 0x55555555
    v_cndmask_b32_dpp v224, v196, v192, vcc quad_perm:[1,0,3,2] row_mask:0xf bank_mask:0xf
    v_cndmask_b32_dpp v225, v197, v193, vcc quad_perm:[1,0,3,2] row_mask:0xf bank_mask:0xf
    v_mfma_f32_16x16x32_bf16 v[16:19], v[48:51], v[152:155], v[16:19]
    ds_read_b64_tr_b16 v[56:57], v76 offset:3072
    ds_read_b64_tr_b16 v[58:59], v76 offset:3584
    v_cndmask_b32_dpp v226, v198, v194, vcc quad_perm:[1,0,3,2] row_mask:0xf bank_mask:0xf
    v_cndmask_b32_dpp v227, v199, v195, vcc quad_perm:[1,0,3,2] row_mask:0xf bank_mask:0xf
    v_mfma_f32_16x16x32_bf16 v[4:7], v[36:39], v[152:155], v[4:7]
    ds_read_b64_tr_b16 v[60:61], v77 offset:3072
    ds_read_b64_tr_b16 v[62:63], v77 offset:3584
    v_cndmask_b32_dpp v232, v204, v200, vcc quad_perm:[1,0,3,2] row_mask:0xf bank_mask:0xf
    v_cndmask_b32_dpp v233, v205, v201, vcc quad_perm:[1,0,3,2] row_mask:0xf bank_mask:0xf
    v_mfma_f32_16x16x32_bf16 v[8:11], v[40:43], v[152:155], v[8:11]
    ds_read_b64_tr_b16 v[64:65], v78 offset:3072
    ds_read_b64_tr_b16 v[66:67], v78 offset:3584
    v_cndmask_b32_dpp v234, v206, v202, vcc quad_perm:[1,0,3,2] row_mask:0xf bank_mask:0xf
    v_cndmask_b32_dpp v235, v207, v203, vcc quad_perm:[1,0,3,2] row_mask:0xf bank_mask:0xf
    buffer_load_dwordx4 v[152:155], v71, s[36:39], s68 offen offset:0
    v_mfma_f32_16x16x32_bf16 v[28:31], v[44:47], v[168:171], v[28:31]
    s_mov_b32 vcc_lo, 0xaaaaaaaa
    s_mov_b32 vcc_hi, 0xaaaaaaaa
    v_cndmask_b32_dpp v228, v192, v196, vcc quad_perm:[1,0,3,2] row_mask:0xf bank_mask:0xf
    v_cndmask_b32_dpp v229, v193, v197, vcc quad_perm:[1,0,3,2] row_mask:0xf bank_mask:0xf
    v_mfma_f32_16x16x32_bf16 v[32:35], v[48:51], v[168:171], v[32:35]
    v_cndmask_b32_dpp v230, v194, v198, vcc quad_perm:[1,0,3,2] row_mask:0xf bank_mask:0xf
    v_cndmask_b32_dpp v231, v195, v199, vcc quad_perm:[1,0,3,2] row_mask:0xf bank_mask:0xf
    v_mfma_f32_16x16x32_bf16 v[20:23], v[36:39], v[168:171], v[20:23]
    v_cndmask_b32_dpp v236, v200, v204, vcc quad_perm:[1,0,3,2] row_mask:0xf bank_mask:0xf
    v_cndmask_b32_dpp v237, v201, v205, vcc quad_perm:[1,0,3,2] row_mask:0xf bank_mask:0xf
    v_mfma_f32_16x16x32_bf16 v[24:27], v[40:43], v[168:171], v[24:27]
    v_cndmask_b32_dpp v238, v202, v206, vcc quad_perm:[1,0,3,2] row_mask:0xf bank_mask:0xf
    v_cndmask_b32_dpp v239, v203, v207, vcc quad_perm:[1,0,3,2] row_mask:0xf bank_mask:0xf
    buffer_load_dwordx4 v[168:171], v72, s[36:39], s68 offen offset:0
    s_waitcnt lgkmcnt(0)
    v_xor_b32 v75, 0x4000, v75
    v_xor_b32 v76, 0x4000, v76
    v_xor_b32 v77, 0x4000, v77
    v_xor_b32 v78, 0x4000, v78
    v_mfma_f32_16x16x32_bf16 v[12:15], v[60:63], v[156:159], v[12:15]
    ds_read_b64_tr_b16 v[36:37], v75 offset:0
    ds_read_b64_tr_b16 v[38:39], v75 offset:512
    s_mov_b32 vcc_lo, 0x33333333
    s_mov_b32 vcc_hi, 0x33333333
    v_cndmask_b32_dpp v192, v232, v224, vcc quad_perm:[2,3,0,1] row_mask:0xf bank_mask:0xf
    v_cndmask_b32_dpp v193, v233, v225, vcc quad_perm:[2,3,0,1] row_mask:0xf bank_mask:0xf
    v_mfma_f32_16x16x32_bf16 v[16:19], v[64:67], v[156:159], v[16:19]
    ds_read_b64_tr_b16 v[40:41], v76 offset:0
    ds_read_b64_tr_b16 v[42:43], v76 offset:512
    v_cndmask_b32_dpp v194, v234, v226, vcc quad_perm:[2,3,0,1] row_mask:0xf bank_mask:0xf
    v_cndmask_b32_dpp v195, v235, v227, vcc quad_perm:[2,3,0,1] row_mask:0xf bank_mask:0xf
    v_mfma_f32_16x16x32_bf16 v[4:7], v[52:55], v[156:159], v[4:7]
    ds_read_b64_tr_b16 v[44:45], v77 offset:0
    ds_read_b64_tr_b16 v[46:47], v77 offset:512
    v_cndmask_b32_dpp v196, v236, v228, vcc quad_perm:[2,3,0,1] row_mask:0xf bank_mask:0xf
    v_cndmask_b32_dpp v197, v237, v229, vcc quad_perm:[2,3,0,1] row_mask:0xf bank_mask:0xf
    v_mfma_f32_16x16x32_bf16 v[8:11], v[56:59], v[156:159], v[8:11]
    ds_read_b64_tr_b16 v[48:49], v78 offset:0
    ds_read_b64_tr_b16 v[50:51], v78 offset:512
    v_cndmask_b32_dpp v198, v238, v230, vcc quad_perm:[2,3,0,1] row_mask:0xf bank_mask:0xf
    v_cndmask_b32_dpp v199, v239, v231, vcc quad_perm:[2,3,0,1] row_mask:0xf bank_mask:0xf
    buffer_load_dwordx4 v[156:159], v71, s[36:39], s68 offen offset:2048
    v_mfma_f32_16x16x32_bf16 v[28:31], v[60:63], v[172:175], v[28:31]
    s_mov_b32 vcc_lo, 0xcccccccc
    s_mov_b32 vcc_hi, 0xcccccccc
    v_cndmask_b32_dpp v200, v224, v232, vcc quad_perm:[2,3,0,1] row_mask:0xf bank_mask:0xf
    v_cndmask_b32_dpp v201, v225, v233, vcc quad_perm:[2,3,0,1] row_mask:0xf bank_mask:0xf
    v_mfma_f32_16x16x32_bf16 v[32:35], v[64:67], v[172:175], v[32:35]
    v_cndmask_b32_dpp v202, v226, v234, vcc quad_perm:[2,3,0,1] row_mask:0xf bank_mask:0xf
    v_cndmask_b32_dpp v203, v227, v235, vcc quad_perm:[2,3,0,1] row_mask:0xf bank_mask:0xf
    v_mfma_f32_16x16x32_bf16 v[20:23], v[52:55], v[172:175], v[20:23]
    v_cndmask_b32_dpp v204, v228, v236, vcc quad_perm:[2,3,0,1] row_mask:0xf bank_mask:0xf
    v_cndmask_b32_dpp v205, v229, v237, vcc quad_perm:[2,3,0,1] row_mask:0xf bank_mask:0xf
    v_mfma_f32_16x16x32_bf16 v[24:27], v[56:59], v[172:175], v[24:27]
    v_cndmask_b32_dpp v206, v230, v238, vcc quad_perm:[2,3,0,1] row_mask:0xf bank_mask:0xf
    v_cndmask_b32_dpp v207, v231, v239, vcc quad_perm:[2,3,0,1] row_mask:0xf bank_mask:0xf
    buffer_load_dwordx4 v[172:175], v72, s[36:39], s68 offen offset:2048
    v_xor_b32 v68, 0x100, v68
    v_xor_b32 v69, 0x100, v69
    v_xor_b32 v71, 0x100, v71
    v_xor_b32 v72, 0x100, v72
    s_waitcnt vmcnt(16) lgkmcnt(0)
    v_mfma_f32_16x16x32_bf16 v[12:15], v[44:47], v[176:179], v[12:15]
    ds_read_b64_tr_b16 v[52:53], v75 offset:1024
    ds_read_b64_tr_b16 v[54:55], v75 offset:1536
    s_mov_b32 vcc_lo, 0x55555555
    s_mov_b32 vcc_hi, 0x55555555
    v_cndmask_b32_dpp v224, v84, v80, vcc quad_perm:[1,0,3,2] row_mask:0xf bank_mask:0xf
    v_cndmask_b32_dpp v225, v85, v81, vcc quad_perm:[1,0,3,2] row_mask:0xf bank_mask:0xf
    v_mfma_f32_16x16x32_bf16 v[16:19], v[48:51], v[176:179], v[16:19]
    ds_read_b64_tr_b16 v[56:57], v76 offset:1024
    ds_read_b64_tr_b16 v[58:59], v76 offset:1536
    v_cndmask_b32_dpp v226, v86, v82, vcc quad_perm:[1,0,3,2] row_mask:0xf bank_mask:0xf
    v_cndmask_b32_dpp v227, v87, v83, vcc quad_perm:[1,0,3,2] row_mask:0xf bank_mask:0xf
    v_mfma_f32_16x16x32_bf16 v[4:7], v[36:39], v[176:179], v[4:7]
    ds_read_b64_tr_b16 v[60:61], v77 offset:1024
    ds_read_b64_tr_b16 v[62:63], v77 offset:1536
    v_cndmask_b32_dpp v232, v92, v88, vcc quad_perm:[1,0,3,2] row_mask:0xf bank_mask:0xf
    v_cndmask_b32_dpp v233, v93, v89, vcc quad_perm:[1,0,3,2] row_mask:0xf bank_mask:0xf
    v_mfma_f32_16x16x32_bf16 v[8:11], v[40:43], v[176:179], v[8:11]
    ds_read_b64_tr_b16 v[64:65], v78 offset:1024
    ds_read_b64_tr_b16 v[66:67], v78 offset:1536
    v_cndmask_b32_dpp v234, v94, v90, vcc quad_perm:[1,0,3,2] row_mask:0xf bank_mask:0xf
    v_cndmask_b32_dpp v235, v95, v91, vcc quad_perm:[1,0,3,2] row_mask:0xf bank_mask:0xf
    buffer_load_dwordx4 v[176:179], v68, s[36:39], s68 offen offset:0
    v_mfma_f32_16x16x32_bf16 v[28:31], v[44:47], v[192:195], v[28:31]
    s_mov_b32 vcc_lo, 0xaaaaaaaa
    s_mov_b32 vcc_hi, 0xaaaaaaaa
    v_cndmask_b32_dpp v228, v80, v84, vcc quad_perm:[1,0,3,2] row_mask:0xf bank_mask:0xf
    v_cndmask_b32_dpp v229, v81, v85, vcc quad_perm:[1,0,3,2] row_mask:0xf bank_mask:0xf
    v_mfma_f32_16x16x32_bf16 v[32:35], v[48:51], v[192:195], v[32:35]
    v_cndmask_b32_dpp v230, v82, v86, vcc quad_perm:[1,0,3,2] row_mask:0xf bank_mask:0xf
    v_cndmask_b32_dpp v231, v83, v87, vcc quad_perm:[1,0,3,2] row_mask:0xf bank_mask:0xf
    v_mfma_f32_16x16x32_bf16 v[20:23], v[36:39], v[192:195], v[20:23]
    v_cndmask_b32_dpp v236, v88, v92, vcc quad_perm:[1,0,3,2] row_mask:0xf bank_mask:0xf
    v_cndmask_b32_dpp v237, v89, v93, vcc quad_perm:[1,0,3,2] row_mask:0xf bank_mask:0xf
    v_mfma_f32_16x16x32_bf16 v[24:27], v[40:43], v[192:195], v[24:27]
    v_cndmask_b32_dpp v238, v90, v94, vcc quad_perm:[1,0,3,2] row_mask:0xf bank_mask:0xf
    v_cndmask_b32_dpp v239, v91, v95, vcc quad_perm:[1,0,3,2] row_mask:0xf bank_mask:0xf
    buffer_load_dwordx4 v[192:195], v69, s[36:39], s68 offen offset:0
    s_waitcnt lgkmcnt(0)
    v_mfma_f32_16x16x32_bf16 v[12:15], v[60:63], v[180:183], v[12:15]
    ds_read_b64_tr_b16 v[36:37], v75 offset:2048
    ds_read_b64_tr_b16 v[38:39], v75 offset:2560
    s_mov_b32 vcc_lo, 0x33333333
    s_mov_b32 vcc_hi, 0x33333333
    v_cndmask_b32_dpp v80, v232, v224, vcc quad_perm:[2,3,0,1] row_mask:0xf bank_mask:0xf
    v_cndmask_b32_dpp v81, v233, v225, vcc quad_perm:[2,3,0,1] row_mask:0xf bank_mask:0xf
    v_mfma_f32_16x16x32_bf16 v[16:19], v[64:67], v[180:183], v[16:19]
    ds_read_b64_tr_b16 v[40:41], v76 offset:2048
    ds_read_b64_tr_b16 v[42:43], v76 offset:2560
    v_cndmask_b32_dpp v82, v234, v226, vcc quad_perm:[2,3,0,1] row_mask:0xf bank_mask:0xf
    v_cndmask_b32_dpp v83, v235, v227, vcc quad_perm:[2,3,0,1] row_mask:0xf bank_mask:0xf
    v_mfma_f32_16x16x32_bf16 v[4:7], v[52:55], v[180:183], v[4:7]
    ds_read_b64_tr_b16 v[44:45], v77 offset:2048
    ds_read_b64_tr_b16 v[46:47], v77 offset:2560
    v_cndmask_b32_dpp v84, v236, v228, vcc quad_perm:[2,3,0,1] row_mask:0xf bank_mask:0xf
    v_cndmask_b32_dpp v85, v237, v229, vcc quad_perm:[2,3,0,1] row_mask:0xf bank_mask:0xf
    v_mfma_f32_16x16x32_bf16 v[8:11], v[56:59], v[180:183], v[8:11]
    ds_read_b64_tr_b16 v[48:49], v78 offset:2048
    ds_read_b64_tr_b16 v[50:51], v78 offset:2560
    v_cndmask_b32_dpp v86, v238, v230, vcc quad_perm:[2,3,0,1] row_mask:0xf bank_mask:0xf
    v_cndmask_b32_dpp v87, v239, v231, vcc quad_perm:[2,3,0,1] row_mask:0xf bank_mask:0xf
    buffer_load_dwordx4 v[180:183], v68, s[36:39], s68 offen offset:2048
    v_mfma_f32_16x16x32_bf16 v[28:31], v[60:63], v[196:199], v[28:31]
    s_mov_b32 vcc_lo, 0xcccccccc
    s_mov_b32 vcc_hi, 0xcccccccc
    v_cndmask_b32_dpp v88, v224, v232, vcc quad_perm:[2,3,0,1] row_mask:0xf bank_mask:0xf
    v_cndmask_b32_dpp v89, v225, v233, vcc quad_perm:[2,3,0,1] row_mask:0xf bank_mask:0xf
    v_mfma_f32_16x16x32_bf16 v[32:35], v[64:67], v[196:199], v[32:35]
    v_cndmask_b32_dpp v90, v226, v234, vcc quad_perm:[2,3,0,1] row_mask:0xf bank_mask:0xf
    v_cndmask_b32_dpp v91, v227, v235, vcc quad_perm:[2,3,0,1] row_mask:0xf bank_mask:0xf
    v_mfma_f32_16x16x32_bf16 v[20:23], v[52:55], v[196:199], v[20:23]
    v_cndmask_b32_dpp v92, v228, v236, vcc quad_perm:[2,3,0,1] row_mask:0xf bank_mask:0xf
    v_cndmask_b32_dpp v93, v229, v237, vcc quad_perm:[2,3,0,1] row_mask:0xf bank_mask:0xf
    v_mfma_f32_16x16x32_bf16 v[24:27], v[56:59], v[196:199], v[24:27]
    v_cndmask_b32_dpp v94, v230, v238, vcc quad_perm:[2,3,0,1] row_mask:0xf bank_mask:0xf
    v_cndmask_b32_dpp v95, v231, v239, vcc quad_perm:[2,3,0,1] row_mask:0xf bank_mask:0xf
    buffer_load_dwordx4 v[196:199], v69, s[36:39], s68 offen offset:2048
    s_waitcnt lgkmcnt(0)
    v_mfma_f32_16x16x32_bf16 v[12:15], v[44:47], v[184:187], v[12:15]
    ds_read_b64_tr_b16 v[52:53], v75 offset:3072
    ds_read_b64_tr_b16 v[54:55], v75 offset:3584
    s_mov_b32 vcc_lo, 0x55555555
    s_mov_b32 vcc_hi, 0x55555555
    v_cndmask_b32_dpp v224, v100, v96, vcc quad_perm:[1,0,3,2] row_mask:0xf bank_mask:0xf
    v_cndmask_b32_dpp v225, v101, v97, vcc quad_perm:[1,0,3,2] row_mask:0xf bank_mask:0xf
    v_mfma_f32_16x16x32_bf16 v[16:19], v[48:51], v[184:187], v[16:19]
    ds_read_b64_tr_b16 v[56:57], v76 offset:3072
    ds_read_b64_tr_b16 v[58:59], v76 offset:3584
    v_cndmask_b32_dpp v226, v102, v98, vcc quad_perm:[1,0,3,2] row_mask:0xf bank_mask:0xf
    v_cndmask_b32_dpp v227, v103, v99, vcc quad_perm:[1,0,3,2] row_mask:0xf bank_mask:0xf
    v_mfma_f32_16x16x32_bf16 v[4:7], v[36:39], v[184:187], v[4:7]
    ds_read_b64_tr_b16 v[60:61], v77 offset:3072
    ds_read_b64_tr_b16 v[62:63], v77 offset:3584
    v_cndmask_b32_dpp v232, v108, v104, vcc quad_perm:[1,0,3,2] row_mask:0xf bank_mask:0xf
    v_cndmask_b32_dpp v233, v109, v105, vcc quad_perm:[1,0,3,2] row_mask:0xf bank_mask:0xf
    v_mfma_f32_16x16x32_bf16 v[8:11], v[40:43], v[184:187], v[8:11]
    ds_read_b64_tr_b16 v[64:65], v78 offset:3072
    ds_read_b64_tr_b16 v[66:67], v78 offset:3584
    v_cndmask_b32_dpp v234, v110, v106, vcc quad_perm:[1,0,3,2] row_mask:0xf bank_mask:0xf
    v_cndmask_b32_dpp v235, v111, v107, vcc quad_perm:[1,0,3,2] row_mask:0xf bank_mask:0xf
    buffer_load_dwordx4 v[184:187], v71, s[36:39], s68 offen offset:0
    v_mfma_f32_16x16x32_bf16 v[28:31], v[44:47], v[200:203], v[28:31]
    s_mov_b32 vcc_lo, 0xaaaaaaaa
    s_mov_b32 vcc_hi, 0xaaaaaaaa
    v_cndmask_b32_dpp v228, v96, v100, vcc quad_perm:[1,0,3,2] row_mask:0xf bank_mask:0xf
    v_cndmask_b32_dpp v229, v97, v101, vcc quad_perm:[1,0,3,2] row_mask:0xf bank_mask:0xf
    v_mfma_f32_16x16x32_bf16 v[32:35], v[48:51], v[200:203], v[32:35]
    v_cndmask_b32_dpp v230, v98, v102, vcc quad_perm:[1,0,3,2] row_mask:0xf bank_mask:0xf
    v_cndmask_b32_dpp v231, v99, v103, vcc quad_perm:[1,0,3,2] row_mask:0xf bank_mask:0xf
    v_mfma_f32_16x16x32_bf16 v[20:23], v[36:39], v[200:203], v[20:23]
    v_cndmask_b32_dpp v236, v104, v108, vcc quad_perm:[1,0,3,2] row_mask:0xf bank_mask:0xf
    v_cndmask_b32_dpp v237, v105, v109, vcc quad_perm:[1,0,3,2] row_mask:0xf bank_mask:0xf
    v_mfma_f32_16x16x32_bf16 v[24:27], v[40:43], v[200:203], v[24:27]
    v_cndmask_b32_dpp v238, v106, v110, vcc quad_perm:[1,0,3,2] row_mask:0xf bank_mask:0xf
    v_cndmask_b32_dpp v239, v107, v111, vcc quad_perm:[1,0,3,2] row_mask:0xf bank_mask:0xf
    buffer_load_dwordx4 v[200:203], v72, s[36:39], s68 offen offset:0
    s_waitcnt lgkmcnt(0)
    v_xor_b32 v75, 0xc000, v75
    v_xor_b32 v76, 0xc000, v76
    v_xor_b32 v77, 0xc000, v77
    v_xor_b32 v78, 0xc000, v78
    v_mfma_f32_16x16x32_bf16 v[12:15], v[60:63], v[188:191], v[12:15]
    ds_read_b64_tr_b16 v[36:37], v75 offset:0
    ds_read_b64_tr_b16 v[38:39], v75 offset:512
    s_mov_b32 vcc_lo, 0x33333333
    s_mov_b32 vcc_hi, 0x33333333
    v_cndmask_b32_dpp v96, v232, v224, vcc quad_perm:[2,3,0,1] row_mask:0xf bank_mask:0xf
    v_cndmask_b32_dpp v97, v233, v225, vcc quad_perm:[2,3,0,1] row_mask:0xf bank_mask:0xf
    v_mfma_f32_16x16x32_bf16 v[16:19], v[64:67], v[188:191], v[16:19]
    ds_read_b64_tr_b16 v[40:41], v76 offset:0
    ds_read_b64_tr_b16 v[42:43], v76 offset:512
    v_cndmask_b32_dpp v98, v234, v226, vcc quad_perm:[2,3,0,1] row_mask:0xf bank_mask:0xf
    v_cndmask_b32_dpp v99, v235, v227, vcc quad_perm:[2,3,0,1] row_mask:0xf bank_mask:0xf
    v_mfma_f32_16x16x32_bf16 v[4:7], v[52:55], v[188:191], v[4:7]
    ds_read_b64_tr_b16 v[44:45], v77 offset:0
    ds_read_b64_tr_b16 v[46:47], v77 offset:512
    v_cndmask_b32_dpp v100, v236, v228, vcc quad_perm:[2,3,0,1] row_mask:0xf bank_mask:0xf
    v_cndmask_b32_dpp v101, v237, v229, vcc quad_perm:[2,3,0,1] row_mask:0xf bank_mask:0xf
    v_mfma_f32_16x16x32_bf16 v[8:11], v[56:59], v[188:191], v[8:11]
    ds_read_b64_tr_b16 v[48:49], v78 offset:0
    ds_read_b64_tr_b16 v[50:51], v78 offset:512
    v_cndmask_b32_dpp v102, v238, v230, vcc quad_perm:[2,3,0,1] row_mask:0xf bank_mask:0xf
    v_cndmask_b32_dpp v103, v239, v231, vcc quad_perm:[2,3,0,1] row_mask:0xf bank_mask:0xf
    buffer_load_dwordx4 v[188:191], v71, s[36:39], s68 offen offset:2048
    v_mfma_f32_16x16x32_bf16 v[28:31], v[60:63], v[204:207], v[28:31]
    s_mov_b32 vcc_lo, 0xcccccccc
    s_mov_b32 vcc_hi, 0xcccccccc
    v_cndmask_b32_dpp v104, v224, v232, vcc quad_perm:[2,3,0,1] row_mask:0xf bank_mask:0xf
    v_cndmask_b32_dpp v105, v225, v233, vcc quad_perm:[2,3,0,1] row_mask:0xf bank_mask:0xf
    v_mfma_f32_16x16x32_bf16 v[32:35], v[64:67], v[204:207], v[32:35]
    v_cndmask_b32_dpp v106, v226, v234, vcc quad_perm:[2,3,0,1] row_mask:0xf bank_mask:0xf
    v_cndmask_b32_dpp v107, v227, v235, vcc quad_perm:[2,3,0,1] row_mask:0xf bank_mask:0xf
    v_mfma_f32_16x16x32_bf16 v[20:23], v[52:55], v[204:207], v[20:23]
    v_cndmask_b32_dpp v108, v228, v236, vcc quad_perm:[2,3,0,1] row_mask:0xf bank_mask:0xf
    v_cndmask_b32_dpp v109, v229, v237, vcc quad_perm:[2,3,0,1] row_mask:0xf bank_mask:0xf
    v_mfma_f32_16x16x32_bf16 v[24:27], v[56:59], v[204:207], v[24:27]
    v_cndmask_b32_dpp v110, v230, v238, vcc quad_perm:[2,3,0,1] row_mask:0xf bank_mask:0xf
    v_cndmask_b32_dpp v111, v231, v239, vcc quad_perm:[2,3,0,1] row_mask:0xf bank_mask:0xf
    buffer_load_dwordx4 v[204:207], v72, s[36:39], s68 offen offset:2048
    v_xor_b32 v68, 0x300, v68
    v_xor_b32 v69, 0x300, v69
    v_xor_b32 v71, 0x300, v71
    v_xor_b32 v72, 0x300, v72
    ds_write_b128 v73, v[12:15] offset:0
    ds_write_b128 v73, v[16:19] offset:1024
    ds_write_b128 v73, v[28:31] offset:2048
    ds_write_b128 v73, v[32:35] offset:3072
    s_add_u32 s73, s73, 1
    s_add_u32 s68, s68, 0x40000
    s_cmp_ge_u32 s73, 5
    s_cselect_b32 s68, 0x5ffffff0, s68
    s_waitcnt lgkmcnt(0)
    s_barrier
    ds_read_b128 v[208:211], v74 offset:0
    ds_read_b128 v[212:215], v74 offset:1024
    ds_read_b128 v[216:219], v74 offset:2048
    ds_read_b128 v[220:223], v74 offset:3072
    s_waitcnt lgkmcnt(3)
    v_pk_add_f32 v[4:5], v[4:5], v[208:209]
    v_pk_add_f32 v[6:7], v[6:7], v[210:211]
    s_waitcnt lgkmcnt(2)
    v_pk_add_f32 v[8:9], v[8:9], v[212:213]
    v_pk_add_f32 v[10:11], v[10:11], v[214:215]
    s_waitcnt lgkmcnt(1)
    v_pk_add_f32 v[20:21], v[20:21], v[216:217]
    v_pk_add_f32 v[22:23], v[22:23], v[218:219]
    s_waitcnt lgkmcnt(0)
    v_pk_add_f32 v[24:25], v[24:25], v[220:221]
    v_pk_add_f32 v[26:27], v[26:27], v[222:223]
    v_cvt_pk_bf16_f32 v208, v4, v5
    v_cvt_pk_bf16_f32 v209, v6, v7
    v_cvt_pk_bf16_f32 v210, v8, v9
    v_cvt_pk_bf16_f32 v211, v10, v11
    buffer_store_dwordx4 v[208:211], v79, s[8:11], s81 offen offset:0 sc1
    v_cvt_pk_bf16_f32 v212, v20, v21
    v_cvt_pk_bf16_f32 v213, v22, v23
    v_cvt_pk_bf16_f32 v214, v24, v25
    v_cvt_pk_bf16_f32 v215, v26, v27
    buffer_store_dwordx4 v[212:215], v79, s[8:11], s81 offen offset:256 sc1
    s_add_u32 s81, s81, 0x100000
    s_cmp_lt_u32 s73, 6
    s_cbranch_scc1 p0_54
    s_branch next_46
p0sig_51:
    s_waitcnt vmcnt(4) lgkmcnt(0)
    s_barrier
    s_cmp_lg_u32 s58, 0
    s_cbranch_scc1 sig_55
    v_mov_b32 v208, 0x5ffffff0
    v_mov_b32 v209, s83
    v_cmp_eq_u32 vcc, 0, v1
    s_nop 1
    v_cndmask_b32 v209, v208, v209, vcc
    v_mov_b32 v208, 1
    buffer_atomic_add v208, v209, s[12:15], 0 offen sc1
sig_55:
    s_add_u32 s83, s83, 4
    s_cmp_lg_u32 s73, 2
    s_cbranch_scc1 xtra_56
    s_lshl_b32 s85, s76, 3
    s_add_u32 s85, s85, s58
    s_lshl_b32 s74, s85, 12
    v_lshlrev_b32 v210, 6, v1
    buffer_load_dword v240, v210, s[36:39], s74 offen
    v_mov_b32 v212, -1
    v_mov_b32 v213, -1
    v_mov_b32 v214, -1
    v_mov_b32 v215, -1
    v_mov_b32 v216, 0
    v_mov_b32 v217, 0
    v_mov_b32 v218, 0
    v_mov_b32 v219, 0
    v_bfe_u32 v210, v1, 0, 4
    v_lshlrev_b32 v210, 4, v210
    v_bfe_u32 v211, v1, 4, 1
    v_lshl_or_b32 v210, v211, 18, v210
    v_bfe_u32 v211, v1, 5, 1
    v_lshl_or_b32 v210, v211, 22, v210
    s_lshl_b32 s74, s85, 5
    s_lshl_b32 s85, s85, 8
    s_add_u32 s85, s85, 0x4300000
    buffer_store_dwordx4 v[212:215], v210, s[8:11], s85 offen sc1
    s_add_u32 s85, s85, 0x80000
    buffer_store_dwordx4 v[212:215], v210, s[8:11], s85 offen sc1
    s_add_u32 s85, s85, 0x80000
    s_add_u32 s74, s74, 0x5100000
    v_and_b32 v211, 16, v210
    buffer_store_dwordx4 v[216:219], v211, s[8:11], s74 offen sc1
xtra_56:
    s_cmp_lg_u32 s73, 3
    s_cbranch_scc1 xtra_57
    s_lshl_b32 s85, s76, 3
    s_add_u32 s85, s85, s58
    s_lshl_b32 s74, s85, 12
    v_lshlrev_b32 v210, 4, v1
    v_mov_b32 v212, -1
    v_mov_b32 v213, -1
    v_mov_b32 v214, -1
    v_mov_b32 v215, -1
    s_add_u32 s74, s74, 0x6000000
    buffer_store_dwordx4 v[212:215], v210, s[8:11], s74 offen offset:0 sc1
    buffer_store_dwordx4 v[212:215], v210, s[8:11], s74 offen offset:1024 sc1
    buffer_store_dwordx4 v[212:215], v210, s[8:11], s74 offen offset:2048 sc1
    buffer_store_dwordx4 v[212:215], v210, s[8:11], s74 offen offset:3072 sc1
xtra_57:
    s_cmp_lg_u32 s73, 4
    s_cbranch_scc1 xtra_58
    s_lshl_b32 s85, s76, 3
    s_add_u32 s85, s85, s58
    v_lshlrev_b32 v210, 3, v1
    v_mul_u32_u24 v210, s85, v210
    v_and_b32 v211, 0x3ff, v210
    v_cvt_f32_u32 v211, v211
    v_mul_f32 v211, 0x3a800000, v211
    v_cos_f32 v212, v211
    v_sin_f32 v213, -v211
    v_add_u32 v210, s85, v210
    v_cvt_pk_bf16_f32 v216, v212, v213
    v_and_b32 v211, 0x3ff, v210
    v_cvt_f32_u32 v211, v211
    v_mul_f32 v211, 0x3a800000, v211
    v_cos_f32 v212, v211
    v_sin_f32 v213, -v211
    v_add_u32 v210, s85, v210
    v_cvt_pk_bf16_f32 v217, v212, v213
    v_and_b32 v211, 0x3ff, v210
    v_cvt_f32_u32 v211, v211
    v_mul_f32 v211, 0x3a800000, v211
    v_cos_f32 v212, v211
    v_sin_f32 v213, -v211
    v_add_u32 v210, s85, v210
    v_cvt_pk_bf16_f32 v218, v212, v213
    v_and_b32 v211, 0x3ff, v210
    v_cvt_f32_u32 v211, v211
    v_mul_f32 v211, 0x3a800000, v211
    v_cos_f32 v212, v211
    v_sin_f32 v213, -v211
    v_add_u32 v210, s85, v210
    v_cvt_pk_bf16_f32 v219, v212, v213
    v_and_b32 v211, 0x3ff, v210
    v_cvt_f32_u32 v211, v211
    v_mul_f32 v211, 0x3a800000, v211
    v_cos_f32 v212, v211
    v_sin_f32 v213, -v211
    v_add_u32 v210, s85, v210
    v_cvt_pk_bf16_f32 v220, v212, v213
    v_and_b32 v211, 0x3ff, v210
    v_cvt_f32_u32 v211, v211
    v_mul_f32 v211, 0x3a800000, v211
    v_cos_f32 v212, v211
    v_sin_f32 v213, -v211
    v_add_u32 v210, s85, v210
    v_cvt_pk_bf16_f32 v221, v212, v213
    v_and_b32 v211, 0x3ff, v210
    v_cvt_f32_u32 v211, v211
    v_mul_f32 v211, 0x3a800000, v211
    v_cos_f32 v212, v211
    v_sin_f32 v213, -v211
    v_add_u32 v210, s85, v210
    v_cvt_pk_bf16_f32 v222, v212, v213
    v_and_b32 v211, 0x3ff, v210
    v_cvt_f32_u32 v211, v211
    v_mul_f32 v211, 0x3a800000, v211
    v_cos_f32 v212, v211
    v_sin_f32 v213, -v211
    v_add_u32 v210, s85, v210
    v_cvt_pk_bf16_f32 v223, v212, v213
    v_mov_b32 v211, s85
    v_lshlrev_b32 v211, 31, v211
    v_or_b32 v211, 0x3f803f80, v211
    v_cmp_eq_u32 vcc, 0, v1
    s_nop 1
    v_cndmask_b32 v216, v216, v211, vcc
    v_lshlrev_b32 v214, 5, v1
    s_lshl_b32 s85, s85, 11
    s_add_u32 s85, s85, 0x5200000
    buffer_store_dwordx4 v[216:219], v214, s[8:11], s85 offen sc1
    buffer_store_dwordx4 v[220:223], v214, s[8:11], s85 offen offset:16 sc1
xtra_58:
    s_cmp_lg_u32 s73, 5
    s_cbranch_scc1 xtra_59
    s_lshl_b32 s85, s76, 3
    s_add_u32 s85, s85, s58
    s_lshl_b32 s74, s85, 12
    v_lshlrev_b32 v210, 6, v1
    buffer_load_dword v240, v210, s[44:47], s74 offen
    buffer_load_dword v241, v210, s[48:51], s74 offen
    buffer_load_dword v242, v210, s[52:55], s74 offen
xtra_59:
    s_cmp_ge_u32 s75, 2
    s_cbranch_scc1 p0rett_53
    s_branch p0retf_52
v0_47:
    v_bfe_u32 v208, v1, 4, 1
    v_lshlrev_b32 v208, 1, v208
    s_and_b32 s85, s58, 4
    v_xor_b32 v208, s85, v208
    v_xor_b32 v208, v208, v1
    v_bfe_u32 v70, v208, 0, 2
    v_lshlrev_b32 v70, 4, v70
    v_bfe_u32 v209, v208, 2, 1
    v_lshl_or_b32 v70, v209, 6, v70
    v_bfe_u32 v209, v208, 3, 3
    v_lshl_or_b32 v70, v209, 13, v70
    s_bfe_u32 s69, s76, 0x60000
    s_lshl_b32 s69, s69, 7
    s_lshl_b32 s85, s58, 16
    s_add_u32 s69, s69, s85
    s_lshl_b32 s71, s58, 10
    s_mov_b32 m0, s71
    s_nop 0
    buffer_load_dwordx4 v70, s[28:31], s69 offen lds
    s_add_u32 s69, s69, 0x80000
    s_add_u32 s71, s71, 0x2000
    s_mov_b32 m0, s71
    s_nop 0
    buffer_load_dwordx4 v70, s[28:31], s69 offen lds
    s_add_u32 s69, s69, 0x80000
    s_add_u32 s71, s71, 0x2000
    s_mov_b32 m0, s71
    s_nop 0
    buffer_load_dwordx4 v70, s[28:31], s69 offen lds
    s_add_u32 s69, s69, 0x80000
    s_add_u32 s71, s71, 0x2000
    s_mov_b32 m0, s71
    s_nop 0
    buffer_load_dwordx4 v70, s[28:31], s69 offen lds
    s_add_u32 s69, s69, 0x80000
    s_add_u32 s71, s71, 0x2000
    s_mov_b32 m0, s71
    s_nop 0
    buffer_load_dwordx4 v70, s[28:31], s69 offen lds
    s_add_u32 s69, s69, 0x80000
    s_add_u32 s71, s71, 0x2000
    s_mov_b32 m0, s71
    s_nop 0
    buffer_load_dwordx4 v70, s[28:31], s69 offen lds
    s_add_u32 s69, s69, 0x80000
    s_add_u32 s71, s71, 0x2000
    s_mov_b32 m0, s71
    s_nop 0
    buffer_load_dwordx4 v70, s[28:31], s69 offen lds
    s_add_u32 s69, s69, 0x80000
    s_add_u32 s71, s71, 0x2000
    s_mov_b32 m0, s71
    s_nop 0
    buffer_load_dwordx4 v70, s[28:31], s69 offen lds
    s_add_u32 s69, s69, 0x80000
    s_add_u32 s71, s71, 0x2000
    s_mov_b32 m0, s71
    s_nop 0
    buffer_load_dwordx4 v70, s[28:31], s69 offen lds
    s_add_u32 s69, s69, 0x80000
    s_add_u32 s71, s71, 0x2000
    s_mov_b32 m0, s71
    s_nop 0
    buffer_load_dwordx4 v70, s[28:31], s69 offen lds
    s_add_u32 s69, s69, 0x80000
    s_add_u32 s71, s71, 0x2000
    s_mov_b32 m0, s71
    s_nop 0
    buffer_load_dwordx4 v70, s[28:31], s69 offen lds
    s_add_u32 s69, s69, 0x80000
    s_add_u32 s71, s71, 0x2000
    s_mov_b32 m0, s71
    s_nop 0
    buffer_load_dwordx4 v70, s[28:31], s69 offen lds
    s_add_u32 s69, s69, 0x80000
    s_add_u32 s71, s71, 0x2000
    s_mov_b32 m0, s71
    s_nop 0
    buffer_load_dwordx4 v70, s[28:31], s69 offen lds
    s_add_u32 s69, s69, 0x80000
    s_add_u32 s71, s71, 0x2000
    s_mov_b32 m0, s71
    s_nop 0
    buffer_load_dwordx4 v70, s[28:31], s69 offen lds
    s_add_u32 s69, s69, 0x80000
    s_add_u32 s71, s71, 0x2000
    s_mov_b32 m0, s71
    s_nop 0
    buffer_load_dwordx4 v70, s[28:31], s69 offen lds
    s_add_u32 s69, s69, 0x80000
    s_add_u32 s71, s71, 0x2000
    s_mov_b32 m0, s71
    s_nop 0
    buffer_load_dwordx4 v70, s[28:31], s69 offen lds
    s_add_u32 s69, s69, 0x80000
    s_add_u32 s71, s71, 0x2000
    s_add_u32 s74, s58, s57
    s_and_b32 s74, s74, 3
    s_and_b32 s85, s58, 4
    s_or_b32 s74, s74, s85
    s_lshl_b32 s74, s74, 8
    s_bfe_u32 s85, s58, 0x20000
    s_lshl_b32 s85, s85, 5
    v_bfe_u32 v209, v1, 0, 2
    v_lshlrev_b32 v209, 4, v209
    v_bfe_u32 v210, v1, 4, 2
    v_lshl_or_b32 v209, v210, 6, v209
    v_and_b32 v208, 12, v1
    v_add3_u32 v208, v208, s85, 0
    v_bfe_u32 v68, v208, 0, 3
    v_lshlrev_b32 v68, 11, v68
    v_bfe_u32 v210, v208, 3, 1
    v_lshl_or_b32 v68, v210, 15, v68
    v_bfe_u32 v210, v208, 4, 1
    v_lshl_or_b32 v68, v210, 14, v68
    v_bfe_u32 v210, v208, 5, 3
    v_lshl_or_b32 v68, v210, 16, v68
    v_add3_u32 v68, v68, v209, s74
    v_add_u32 v71, 4096, v68
    v_and_b32 v208, 12, v1
    v_add3_u32 v208, v208, s85, 16
    v_bfe_u32 v69, v208, 0, 3
    v_lshlrev_b32 v69, 11, v69
    v_bfe_u32 v210, v208, 3, 1
    v_lshl_or_b32 v69, v210, 15, v69
    v_bfe_u32 v210, v208, 4, 1
    v_lshl_or_b32 v69, v210, 14, v69
    v_bfe_u32 v210, v208, 5, 3
    v_lshl_or_b32 v69, v210, 16, v69
    v_add3_u32 v69, v69, v209, s74
    v_add_u32 v72, 4096, v69
    s_mov_b32 s68, 0
    s_barrier
    buffer_load_dwordx4 v[80:83], v68, s[36:39], s68 offen offset:0
    buffer_load_dwordx4 v[96:99], v69, s[36:39], s68 offen offset:0
    buffer_load_dwordx4 v[84:87], v68, s[36:39], s68 offen offset:2048
    buffer_load_dwordx4 v[100:103], v69, s[36:39], s68 offen offset:2048
    buffer_load_dwordx4 v[88:91], v71, s[36:39], s68 offen offset:0
    buffer_load_dwordx4 v[104:107], v72, s[36:39], s68 offen offset:0
    buffer_load_dwordx4 v[92:95], v71, s[36:39], s68 offen offset:2048
    buffer_load_dwordx4 v[108:111], v72, s[36:39], s68 offen offset:2048
    v_xor_b32 v68, 0x100, v68
    v_xor_b32 v69, 0x100, v69
    v_xor_b32 v71, 0x100, v71
    v_xor_b32 v72, 0x100, v72
    buffer_load_dwordx4 v[112:115], v68, s[36:39], s68 offen offset:0
    buffer_load_dwordx4 v[128:131], v69, s[36:39], s68 offen offset:0
    buffer_load_dwordx4 v[116:119], v68, s[36:39], s68 offen offset:2048
    buffer_load_dwordx4 v[132:135], v69, s[36:39], s68 offen offset:2048
    buffer_load_dwordx4 v[120:123], v71, s[36:39], s68 offen offset:0
    buffer_load_dwordx4 v[136:139], v72, s[36:39], s68 offen offset:0
    buffer_load_dwordx4 v[124:127], v71, s[36:39], s68 offen offset:2048
    buffer_load_dwordx4 v[140:143], v72, s[36:39], s68 offen offset:2048
    v_xor_b32 v68, 0x300, v68
    v_xor_b32 v69, 0x300, v69
    v_xor_b32 v71, 0x300, v71
    v_xor_b32 v72, 0x300, v72
    buffer_load_dwordx4 v[144:147], v68, s[36:39], s68 offen offset:0
    buffer_load_dwordx4 v[160:163], v69, s[36:39], s68 offen offset:0
    buffer_load_dwordx4 v[148:151], v68, s[36:39], s68 offen offset:2048
    buffer_load_dwordx4 v[164:167], v69, s[36:39], s68 offen offset:2048
    buffer_load_dwordx4 v[152:155], v71, s[36:39], s68 offen offset:0
    buffer_load_dwordx4 v[168:171], v72, s[36:39], s68 offen offset:0
    buffer_load_dwordx4 v[156:159], v71, s[36:39], s68 offen offset:2048
    buffer_load_dwordx4 v[172:175], v72, s[36:39], s68 offen offset:2048
    v_xor_b32 v68, 0x100, v68
    v_xor_b32 v69, 0x100, v69
    v_xor_b32 v71, 0x100, v71
    v_xor_b32 v72, 0x100, v72
    buffer_load_dwordx4 v[176:179], v68, s[36:39], s68 offen offset:0
    buffer_load_dwordx4 v[192:195], v69, s[36:39], s68 offen offset:0
    buffer_load_dwordx4 v[180:183], v68, s[36:39], s68 offen offset:2048
    buffer_load_dwordx4 v[196:199], v69, s[36:39], s68 offen offset:2048
    buffer_load_dwordx4 v[184:187], v71, s[36:39], s68 offen offset:0
    buffer_load_dwordx4 v[200:203], v72, s[36:39], s68 offen offset:0
    buffer_load_dwordx4 v[188:191], v71, s[36:39], s68 offen offset:2048
    buffer_load_dwordx4 v[204:207], v72, s[36:39], s68 offen offset:2048
    v_xor_b32 v68, 0x300, v68
    v_xor_b32 v69, 0x300, v69
    v_xor_b32 v71, 0x300, v71
    v_xor_b32 v72, 0x300, v72
    v_bfe_u32 v79, v1, 0, 4
    v_lshlrev_b32 v79, 4, v79
    v_bfe_u32 v75, v1, 4, 2
    v_lshl_or_b32 v79, v75, 9, v79
    v_bfe_u32 v75, v1, 0, 2
    v_lshlrev_b32 v75, 3, v75
    v_bfe_u32 v208, v1, 3, 1
    v_lshl_or_b32 v75, v208, 5, v75
    v_bfe_u32 v208, v1, 4, 1
    v_lshl_or_b32 v75, v208, 6, v75
    v_bfe_u32 v208, v1, 2, 2
    v_lshl_or_b32 v75, v208, 7, v75
    v_bfe_u32 v208, v1, 4, 2
    v_lshl_or_b32 v75, v208, 12, v75
    v_lshl_or_b32 v75, s74, 6, v75
    s_bfe_u32 s85, s58, 0x10002
    s_lshl_b32 s85, s85, 6
    v_xor_b32 v75, s85, v75
    v_xor_b32 v76, 32, v75
    v_xor_b32 v77, 64, v75
    v_xor_b32 v78, 96, v75
    s_lshl_b32 s85, s58, 12
    s_or_b32 s85, s85, 0x20000
    v_lshl_add_u32 v73, v1, 4, s85
    v_xor_b32 v74, 0x4000, v73
    s_bfe_u32 s81, s76, 0x60000
    s_lshl_b32 s81, s81, 12
    s_bfe_u32 s85, s58, 0x10002
    s_lshl_b32 s85, s85, 11
    s_bfe_u32 s73, s58, 0x20000
    s_lshl_b32 s73, s73, 18
    s_or_b32 s85, s85, s73
    s_add_u32 s81, s81, s85
    s_add_u32 s81, s81, 0x2000000
    s_mov_b32 s83, 128
    s_mov_b32 s84, 1
    s_mov_b32 s73, 0
    s_mov_b32 s68, 0x40000
    s_waitcnt vmcnt(24)
    s_mov_b32 vcc_lo, 0x55555555
    s_mov_b32 vcc_hi, 0x55555555
    v_cndmask_b32_dpp v224, v84, v80, vcc quad_perm:[1,0,3,2] row_mask:0xf bank_mask:0xf
    v_cndmask_b32_dpp v225, v85, v81, vcc quad_perm:[1,0,3,2] row_mask:0xf bank_mask:0xf
    v_cndmask_b32_dpp v226, v86, v82, vcc quad_perm:[1,0,3,2] row_mask:0xf bank_mask:0xf
    v_cndmask_b32_dpp v227, v87, v83, vcc quad_perm:[1,0,3,2] row_mask:0xf bank_mask:0xf
    v_cndmask_b32_dpp v232, v92, v88, vcc quad_perm:[1,0,3,2] row_mask:0xf bank_mask:0xf
    v_cndmask_b32_dpp v233, v93, v89, vcc quad_perm:[1,0,3,2] row_mask:0xf bank_mask:0xf
    v_cndmask_b32_dpp v234, v94, v90, vcc quad_perm:[1,0,3,2] row_mask:0xf bank_mask:0xf
    v_cndmask_b32_dpp v235, v95, v91, vcc quad_perm:[1,0,3,2] row_mask:0xf bank_mask:0xf
    s_mov_b32 vcc_lo, 0xaaaaaaaa
    s_mov_b32 vcc_hi, 0xaaaaaaaa
    v_cndmask_b32_dpp v228, v80, v84, vcc quad_perm:[1,0,3,2] row_mask:0xf bank_mask:0xf
    v_cndmask_b32_dpp v229, v81, v85, vcc quad_perm:[1,0,3,2] row_mask:0xf bank_mask:0xf
    v_cndmask_b32_dpp v230, v82, v86, vcc quad_perm:[1,0,3,2] row_mask:0xf bank_mask:0xf
    v_cndmask_b32_dpp v231, v83, v87, vcc quad_perm:[1,0,3,2] row_mask:0xf bank_mask:0xf
    v_cndmask_b32_dpp v236, v88, v92, vcc quad_perm:[1,0,3,2] row_mask:0xf bank_mask:0xf
    v_cndmask_b32_dpp v237, v89, v93, vcc quad_perm:[1,0,3,2] row_mask:0xf bank_mask:0xf
    v_cndmask_b32_dpp v238, v90, v94, vcc quad_perm:[1,0,3,2] row_mask:0xf bank_mask:0xf
    v_cndmask_b32_dpp v239, v91, v95, vcc quad_perm:[1,0,3,2] row_mask:0xf bank_mask:0xf
    s_mov_b32 vcc_lo, 0x33333333
    s_mov_b32 vcc_hi, 0x33333333
    v_cndmask_b32_dpp v80, v232, v224, vcc quad_perm:[2,3,0,1] row_mask:0xf bank_mask:0xf
    v_cndmask_b32_dpp v81, v233, v225, vcc quad_perm:[2,3,0,1] row_mask:0xf bank_mask:0xf
    v_cndmask_b32_dpp v82, v234, v226, vcc quad_perm:[2,3,0,1] row_mask:0xf bank_mask:0xf
    v_cndmask_b32_dpp v83, v235, v227, vcc quad_perm:[2,3,0,1] row_mask:0xf bank_mask:0xf
    v_cndmask_b32_dpp v84, v236, v228, vcc quad_perm:[2,3,0,1] row_mask:0xf bank_mask:0xf
    v_cndmask_b32_dpp v85, v237, v229, vcc quad_perm:[2,3,0,1] row_mask:0xf bank_mask:0xf
    v_cndmask_b32_dpp v86, v238, v230, vcc quad_perm:[2,3,0,1] row_mask:0xf bank_mask:0xf
    v_cndmask_b32_dpp v87, v239, v231, vcc quad_perm:[2,3,0,1] row_mask:0xf bank_mask:0xf
    s_mov_b32 vcc_lo, 0xcccccccc
    s_mov_b32 vcc_hi, 0xcccccccc
    v_cndmask_b32_dpp v88, v224, v232, vcc quad_perm:[2,3,0,1] row_mask:0xf bank_mask:0xf
    v_cndmask_b32_dpp v89, v225, v233, vcc quad_perm:[2,3,0,1] row_mask:0xf bank_mask:0xf
    v_cndmask_b32_dpp v90, v226, v234, vcc quad_perm:[2,3,0,1] row_mask:0xf bank_mask:0xf
    v_cndmask_b32_dpp v91, v227, v235, vcc quad_perm:[2,3,0,1] row_mask:0xf bank_mask:0xf
    v_cndmask_b32_dpp v92, v228, v236, vcc quad_perm:[2,3,0,1] row_mask:0xf bank_mask:0xf
    v_cndmask_b32_dpp v93, v229, v237, vcc quad_perm:[2,3,0,1] row_mask:0xf bank_mask:0xf
    v_cndmask_b32_dpp v94, v230, v238, vcc quad_perm:[2,3,0,1] row_mask:0xf bank_mask:0xf
    v_cndmask_b32_dpp v95, v231, v239, vcc quad_perm:[2,3,0,1] row_mask:0xf bank_mask:0xf
    s_mov_b32 vcc_lo, 0x55555555
    s_mov_b32 vcc_hi, 0x55555555
    v_cndmask_b32_dpp v224, v100, v96, vcc quad_perm:[1,0,3,2] row_mask:0xf bank_mask:0xf
    v_cndmask_b32_dpp v225, v101, v97, vcc quad_perm:[1,0,3,2] row_mask:0xf bank_mask:0xf
    v_cndmask_b32_dpp v226, v102, v98, vcc quad_perm:[1,0,3,2] row_mask:0xf bank_mask:0xf
    v_cndmask_b32_dpp v227, v103, v99, vcc quad_perm:[1,0,3,2] row_mask:0xf bank_mask:0xf
    v_cndmask_b32_dpp v232, v108, v104, vcc quad_perm:[1,0,3,2] row_mask:0xf bank_mask:0xf
    v_cndmask_b32_dpp v233, v109, v105, vcc quad_perm:[1,0,3,2] row_mask:0xf bank_mask:0xf
    v_cndmask_b32_dpp v234, v110, v106, vcc quad_perm:[1,0,3,2] row_mask:0xf bank_mask:0xf
    v_cndmask_b32_dpp v235, v111, v107, vcc quad_perm:[1,0,3,2] row_mask:0xf bank_mask:0xf
    s_mov_b32 vcc_lo, 0xaaaaaaaa
    s_mov_b32 vcc_hi, 0xaaaaaaaa
    v_cndmask_b32_dpp v228, v96, v100, vcc quad_perm:[1,0,3,2] row_mask:0xf bank_mask:0xf
    v_cndmask_b32_dpp v229, v97, v101, vcc quad_perm:[1,0,3,2] row_mask:0xf bank_mask:0xf
    v_cndmask_b32_dpp v230, v98, v102, vcc quad_perm:[1,0,3,2] row_mask:0xf bank_mask:0xf
    v_cndmask_b32_dpp v231, v99, v103, vcc quad_perm:[1,0,3,2] row_mask:0xf bank_mask:0xf
    v_cndmask_b32_dpp v236, v104, v108, vcc quad_perm:[1,0,3,2] row_mask:0xf bank_mask:0xf
    v_cndmask_b32_dpp v237, v105, v109, vcc quad_perm:[1,0,3,2] row_mask:0xf bank_mask:0xf
    v_cndmask_b32_dpp v238, v106, v110, vcc quad_perm:[1,0,3,2] row_mask:0xf bank_mask:0xf
    v_cndmask_b32_dpp v239, v107, v111, vcc quad_perm:[1,0,3,2] row_mask:0xf bank_mask:0xf
    s_mov_b32 vcc_lo, 0x33333333
    s_mov_b32 vcc_hi, 0x33333333
    v_cndmask_b32_dpp v96, v232, v224, vcc quad_perm:[2,3,0,1] row_mask:0xf bank_mask:0xf
    v_cndmask_b32_dpp v97, v233, v225, vcc quad_perm:[2,3,0,1] row_mask:0xf bank_mask:0xf
    v_cndmask_b32_dpp v98, v234, v226, vcc quad_perm:[2,3,0,1] row_mask:0xf bank_mask:0xf
    v_cndmask_b32_dpp v99, v235, v227, vcc quad_perm:[2,3,0,1] row_mask:0xf bank_mask:0xf
    v_cndmask_b32_dpp v100, v236, v228, vcc quad_perm:[2,3,0,1] row_mask:0xf bank_mask:0xf
    v_cndmask_b32_dpp v101, v237, v229, vcc quad_perm:[2,3,0,1] row_mask:0xf bank_mask:0xf
    v_cndmask_b32_dpp v102, v238, v230, vcc quad_perm:[2,3,0,1] row_mask:0xf bank_mask:0xf
    v_cndmask_b32_dpp v103, v239, v231, vcc quad_perm:[2,3,0,1] row_mask:0xf bank_mask:0xf
    s_mov_b32 vcc_lo, 0xcccccccc
    s_mov_b32 vcc_hi, 0xcccccccc
    v_cndmask_b32_dpp v104, v224, v232, vcc quad_perm:[2,3,0,1] row_mask:0xf bank_mask:0xf
    v_cndmask_b32_dpp v105, v225, v233, vcc quad_perm:[2,3,0,1] row_mask:0xf bank_mask:0xf
    v_cndmask_b32_dpp v106, v226, v234, vcc quad_perm:[2,3,0,1] row_mask:0xf bank_mask:0xf
    v_cndmask_b32_dpp v107, v227, v235, vcc quad_perm:[2,3,0,1] row_mask:0xf bank_mask:0xf
    v_cndmask_b32_dpp v108, v228, v236, vcc quad_perm:[2,3,0,1] row_mask:0xf bank_mask:0xf
    v_cndmask_b32_dpp v109, v229, v237, vcc quad_perm:[2,3,0,1] row_mask:0xf bank_mask:0xf
    v_cndmask_b32_dpp v110, v230, v238, vcc quad_perm:[2,3,0,1] row_mask:0xf bank_mask:0xf
    v_cndmask_b32_dpp v111, v231, v239, vcc quad_perm:[2,3,0,1] row_mask:0xf bank_mask:0xf
    s_barrier
    ds_read_b64_tr_b16 v[36:37], v75 offset:0
    ds_read_b64_tr_b16 v[38:39], v75 offset:512
    ds_read_b64_tr_b16 v[40:41], v76 offset:0
    ds_read_b64_tr_b16 v[42:43], v76 offset:512
    ds_read_b64_tr_b16 v[44:45], v77 offset:0
    ds_read_b64_tr_b16 v[46:47], v77 offset:512
    ds_read_b64_tr_b16 v[48:49], v78 offset:0
    ds_read_b64_tr_b16 v[50:51], v78 offset:512
p0_60:
    s_waitcnt vmcnt(16) lgkmcnt(0)
    v_mfma_f32_16x16x32_bf16 v[12:15], v[80:83], v[44:47], 0
    ds_read_b64_tr_b16 v[52:53], v75 offset:1024
    ds_read_b64_tr_b16 v[54:55], v75 offset:1536
    s_mov_b32 vcc_lo, 0x55555555
    s_mov_b32 vcc_hi, 0x55555555
    v_cndmask_b32_dpp v224, v116, v112, vcc quad_perm:[1,0,3,2] row_mask:0xf bank_mask:0xf
    v_cndmask_b32_dpp v225, v117, v113, vcc quad_perm:[1,0,3,2] row_mask:0xf bank_mask:0xf
    v_mfma_f32_16x16x32_bf16 v[16:19], v[80:83], v[48:51], 0
    ds_read_b64_tr_b16 v[56:57], v76 offset:1024
    ds_read_b64_tr_b16 v[58:59], v76 offset:1536
    v_cndmask_b32_dpp v226, v118, v114, vcc quad_perm:[1,0,3,2] row_mask:0xf bank_mask:0xf
    v_cndmask_b32_dpp v227, v119, v115, vcc quad_perm:[1,0,3,2] row_mask:0xf bank_mask:0xf
    v_mfma_f32_16x16x32_bf16 v[4:7], v[80:83], v[36:39], 0
    ds_read_b64_tr_b16 v[60:61], v77 offset:1024
    ds_read_b64_tr_b16 v[62:63], v77 offset:1536
    v_cndmask_b32_dpp v232, v124, v120, vcc quad_perm:[1,0,3,2] row_mask:0xf bank_mask:0xf
    v_cndmask_b32_dpp v233, v125, v121, vcc quad_perm:[1,0,3,2] row_mask:0xf bank_mask:0xf
    v_mfma_f32_16x16x32_bf16 v[8:11], v[80:83], v[40:43], 0
    ds_read_b64_tr_b16 v[64:65], v78 offset:1024
    ds_read_b64_tr_b16 v[66:67], v78 offset:1536
    v_cndmask_b32_dpp v234, v126, v122, vcc quad_perm:[1,0,3,2] row_mask:0xf bank_mask:0xf
    v_cndmask_b32_dpp v235, v127, v123, vcc quad_perm:[1,0,3,2] row_mask:0xf bank_mask:0xf
    buffer_load_dwordx4 v[80:83], v68, s[36:39], s68 offen offset:0
    v_mfma_f32_16x16x32_bf16 v[28:31], v[96:99], v[44:47], 0
    s_mov_b32 vcc_lo, 0xaaaaaaaa
    s_mov_b32 vcc_hi, 0xaaaaaaaa
    v_cndmask_b32_dpp v228, v112, v116, vcc quad_perm:[1,0,3,2] row_mask:0xf bank_mask:0xf
    v_cndmask_b32_dpp v229, v113, v117, vcc quad_perm:[1,0,3,2] row_mask:0xf bank_mask:0xf
    v_mfma_f32_16x16x32_bf16 v[32:35], v[96:99], v[48:51], 0
    v_cndmask_b32_dpp v230, v114, v118, vcc quad_perm:[1,0,3,2] row_mask:0xf bank_mask:0xf
    v_cndmask_b32_dpp v231, v115, v119, vcc quad_perm:[1,0,3,2] row_mask:0xf bank_mask:0xf
    v_mfma_f32_16x16x32_bf16 v[20:23], v[96:99], v[36:39], 0
    v_cndmask_b32_dpp v236, v120, v124, vcc quad_perm:[1,0,3,2] row_mask:0xf bank_mask:0xf
    v_cndmask_b32_dpp v237, v121, v125, vcc quad_perm:[1,0,3,2] row_mask:0xf bank_mask:0xf
    v_mfma_f32_16x16x32_bf16 v[24:27], v[96:99], v[40:43], 0
    v_cndmask_b32_dpp v238, v122, v126, vcc quad_perm:[1,0,3,2] row_mask:0xf bank_mask:0xf
    v_cndmask_b32_dpp v239, v123, v127, vcc quad_perm:[1,0,3,2] row_mask:0xf bank_mask:0xf
    buffer_load_dwordx4 v[96:99], v69, s[36:39], s68 offen offset:0
    s_waitcnt lgkmcnt(0)
    v_mfma_f32_16x16x32_bf16 v[12:15], v[84:87], v[60:63], v[12:15]
    ds_read_b64_tr_b16 v[36:37], v75 offset:2048
    ds_read_b64_tr_b16 v[38:39], v75 offset:2560
    s_mov_b32 vcc_lo, 0x33333333
    s_mov_b32 vcc_hi, 0x33333333
    v_cndmask_b32_dpp v112, v232, v224, vcc quad_perm:[2,3,0,1] row_mask:0xf bank_mask:0xf
    v_cndmask_b32_dpp v113, v233, v225, vcc quad_perm:[2,3,0,1] row_mask:0xf bank_mask:0xf
    v_mfma_f32_16x16x32_bf16 v[16:19], v[84:87], v[64:67], v[16:19]
    ds_read_b64_tr_b16 v[40:41], v76 offset:2048
    ds_read_b64_tr_b16 v[42:43], v76 offset:2560
    v_cndmask_b32_dpp v114, v234, v226, vcc quad_perm:[2,3,0,1] row_mask:0xf bank_mask:0xf
    v_cndmask_b32_dpp v115, v235, v227, vcc quad_perm:[2,3,0,1] row_mask:0xf bank_mask:0xf
    v_mfma_f32_16x16x32_bf16 v[4:7], v[84:87], v[52:55], v[4:7]
    ds_read_b64_tr_b16 v[44:45], v77 offset:2048
    ds_read_b64_tr_b16 v[46:47], v77 offset:2560
    v_cndmask_b32_dpp v116, v236, v228, vcc quad_perm:[2,3,0,1] row_mask:0xf bank_mask:0xf
    v_cndmask_b32_dpp v117, v237, v229, vcc quad_perm:[2,3,0,1] row_mask:0xf bank_mask:0xf
    v_mfma_f32_16x16x32_bf16 v[8:11], v[84:87], v[56:59], v[8:11]
    ds_read_b64_tr_b16 v[48:49], v78 offset:2048
    ds_read_b64_tr_b16 v[50:51], v78 offset:2560
    v_cndmask_b32_dpp v118, v238, v230, vcc quad_perm:[2,3,0,1] row_mask:0xf bank_mask:0xf
    v_cndmask_b32_dpp v119, v239, v231, vcc quad_perm:[2,3,0,1] row_mask:0xf bank_mask:0xf
    buffer_load_dwordx4 v[84:87], v68, s[36:39], s68 offen offset:2048
    v_mfma_f32_16x16x32_bf16 v[28:31], v[100:103], v[60:63], v[28:31]
    s_mov_b32 vcc_lo, 0xcccccccc
    s_mov_b32 vcc_hi, 0xcccccccc
    v_cndmask_b32_dpp v120, v224, v232, vcc quad_perm:[2,3,0,1] row_mask:0xf bank_mask:0xf
    v_cndmask_b32_dpp v121, v225, v233, vcc quad_perm:[2,3,0,1] row_mask:0xf bank_mask:0xf
    v_mfma_f32_16x16x32_bf16 v[32:35], v[100:103], v[64:67], v[32:35]
    v_cndmask_b32_dpp v122, v226, v234, vcc quad_perm:[2,3,0,1] row_mask:0xf bank_mask:0xf
    v_cndmask_b32_dpp v123, v227, v235, vcc quad_perm:[2,3,0,1] row_mask:0xf bank_mask:0xf
    v_mfma_f32_16x16x32_bf16 v[20:23], v[100:103], v[52:55], v[20:23]
    v_cndmask_b32_dpp v124, v228, v236, vcc quad_perm:[2,3,0,1] row_mask:0xf bank_mask:0xf
    v_cndmask_b32_dpp v125, v229, v237, vcc quad_perm:[2,3,0,1] row_mask:0xf bank_mask:0xf
    v_mfma_f32_16x16x32_bf16 v[24:27], v[100:103], v[56:59], v[24:27]
    v_cndmask_b32_dpp v126, v230, v238, vcc quad_perm:[2,3,0,1] row_mask:0xf bank_mask:0xf
    v_cndmask_b32_dpp v127, v231, v239, vcc quad_perm:[2,3,0,1] row_mask:0xf bank_mask:0xf
    buffer_load_dwordx4 v[100:103], v69, s[36:39], s68 offen offset:2048
    s_cmp_lg_u32 s73, 0
    s_cbranch_scc1 p0sig_51
p0rett_53:
    s_waitcnt lgkmcnt(0)
    v_mfma_f32_16x16x32_bf16 v[12:15], v[88:91], v[44:47], v[12:15]
    ds_read_b64_tr_b16 v[52:53], v75 offset:3072
    ds_read_b64_tr_b16 v[54:55], v75 offset:3584
    s_mov_b32 vcc_lo, 0x55555555
    s_mov_b32 vcc_hi, 0x55555555
    v_cndmask_b32_dpp v224, v132, v128, vcc quad_perm:[1,0,3,2] row_mask:0xf bank_mask:0xf
    v_cndmask_b32_dpp v225, v133, v129, vcc quad_perm:[1,0,3,2] row_mask:0xf bank_mask:0xf
    v_mfma_f32_16x16x32_bf16 v[16:19], v[88:91], v[48:51], v[16:19]
    ds_read_b64_tr_b16 v[56:57], v76 offset:3072
    ds_read_b64_tr_b16 v[58:59], v76 offset:3584
    v_cndmask_b32_dpp v226, v134, v130, vcc quad_perm:[1,0,3,2] row_mask:0xf bank_mask:0xf
    v_cndmask_b32_dpp v227, v135, v131, vcc quad_perm:[1,0,3,2] row_mask:0xf bank_mask:0xf
    v_mfma_f32_16x16x32_bf16 v[4:7], v[88:91], v[36:39], v[4:7]
    ds_read_b64_tr_b16 v[60:61], v77 offset:3072
    ds_read_b64_tr_b16 v[62:63], v77 offset:3584
    v_cndmask_b32_dpp v232, v140, v136, vcc quad_perm:[1,0,3,2] row_mask:0xf bank_mask:0xf
    v_cndmask_b32_dpp v233, v141, v137, vcc quad_perm:[1,0,3,2] row_mask:0xf bank_mask:0xf
    v_mfma_f32_16x16x32_bf16 v[8:11], v[88:91], v[40:43], v[8:11]
    ds_read_b64_tr_b16 v[64:65], v78 offset:3072
    ds_read_b64_tr_b16 v[66:67], v78 offset:3584
    v_cndmask_b32_dpp v234, v142, v138, vcc quad_perm:[1,0,3,2] row_mask:0xf bank_mask:0xf
    v_cndmask_b32_dpp v235, v143, v139, vcc quad_perm:[1,0,3,2] row_mask:0xf bank_mask:0xf
    buffer_load_dwordx4 v[88:91], v71, s[36:39], s68 offen offset:0
    v_mfma_f32_16x16x32_bf16 v[28:31], v[104:107], v[44:47], v[28:31]
    s_mov_b32 vcc_lo, 0xaaaaaaaa
    s_mov_b32 vcc_hi, 0xaaaaaaaa
    v_cndmask_b32_dpp v228, v128, v132, vcc quad_perm:[1,0,3,2] row_mask:0xf bank_mask:0xf
    v_cndmask_b32_dpp v229, v129, v133, vcc quad_perm:[1,0,3,2] row_mask:0xf bank_mask:0xf
    v_mfma_f32_16x16x32_bf16 v[32:35], v[104:107], v[48:51], v[32:35]
    v_cndmask_b32_dpp v230, v130, v134, vcc quad_perm:[1,0,3,2] row_mask:0xf bank_mask:0xf
    v_cndmask_b32_dpp v231, v131, v135, vcc quad_perm:[1,0,3,2] row_mask:0xf bank_mask:0xf
    v_mfma_f32_16x16x32_bf16 v[20:23], v[104:107], v[36:39], v[20:23]
    v_cndmask_b32_dpp v236, v136, v140, vcc quad_perm:[1,0,3,2] row_mask:0xf bank_mask:0xf
    v_cndmask_b32_dpp v237, v137, v141, vcc quad_perm:[1,0,3,2] row_mask:0xf bank_mask:0xf
    v_mfma_f32_16x16x32_bf16 v[24:27], v[104:107], v[40:43], v[24:27]
    v_cndmask_b32_dpp v238, v138, v142, vcc quad_perm:[1,0,3,2] row_mask:0xf bank_mask:0xf
    v_cndmask_b32_dpp v239, v139, v143, vcc quad_perm:[1,0,3,2] row_mask:0xf bank_mask:0xf
    buffer_load_dwordx4 v[104:107], v72, s[36:39], s68 offen offset:0
    s_waitcnt lgkmcnt(0)
    v_xor_b32 v75, 0x4000, v75
    v_xor_b32 v76, 0x4000, v76
    v_xor_b32 v77, 0x4000, v77
    v_xor_b32 v78, 0x4000, v78
    v_mfma_f32_16x16x32_bf16 v[12:15], v[92:95], v[60:63], v[12:15]
    ds_read_b64_tr_b16 v[36:37], v75 offset:0
    ds_read_b64_tr_b16 v[38:39], v75 offset:512
    s_mov_b32 vcc_lo, 0x33333333
    s_mov_b32 vcc_hi, 0x33333333
    v_cndmask_b32_dpp v128, v232, v224, vcc quad_perm:[2,3,0,1] row_mask:0xf bank_mask:0xf
    v_cndmask_b32_dpp v129, v233, v225, vcc quad_perm:[2,3,0,1] row_mask:0xf bank_mask:0xf
    v_mfma_f32_16x16x32_bf16 v[16:19], v[92:95], v[64:67], v[16:19]
    ds_read_b64_tr_b16 v[40:41], v76 offset:0
    ds_read_b64_tr_b16 v[42:43], v76 offset:512
    v_cndmask_b32_dpp v130, v234, v226, vcc quad_perm:[2,3,0,1] row_mask:0xf bank_mask:0xf
    v_cndmask_b32_dpp v131, v235, v227, vcc quad_perm:[2,3,0,1] row_mask:0xf bank_mask:0xf
    v_mfma_f32_16x16x32_bf16 v[4:7], v[92:95], v[52:55], v[4:7]
    ds_read_b64_tr_b16 v[44:45], v77 offset:0
    ds_read_b64_tr_b16 v[46:47], v77 offset:512
    v_cndmask_b32_dpp v132, v236, v228, vcc quad_perm:[2,3,0,1] row_mask:0xf bank_mask:0xf
    v_cndmask_b32_dpp v133, v237, v229, vcc quad_perm:[2,3,0,1] row_mask:0xf bank_mask:0xf
    v_mfma_f32_16x16x32_bf16 v[8:11], v[92:95], v[56:59], v[8:11]
    ds_read_b64_tr_b16 v[48:49], v78 offset:0
    ds_read_b64_tr_b16 v[50:51], v78 offset:512
    v_cndmask_b32_dpp v134, v238, v230, vcc quad_perm:[2,3,0,1] row_mask:0xf bank_mask:0xf
    v_cndmask_b32_dpp v135, v239, v231, vcc quad_perm:[2,3,0,1] row_mask:0xf bank_mask:0xf
    buffer_load_dwordx4 v[92:95], v71, s[36:39], s68 offen offset:2048
    v_mfma_f32_16x16x32_bf16 v[28:31], v[108:111], v[60:63], v[28:31]
    s_mov_b32 vcc_lo, 0xcccccccc
    s_mov_b32 vcc_hi, 0xcccccccc
    v_cndmask_b32_dpp v136, v224, v232, vcc quad_perm:[2,3,0,1] row_mask:0xf bank_mask:0xf
    v_cndmask_b32_dpp v137, v225, v233, vcc quad_perm:[2,3,0,1] row_mask:0xf bank_mask:0xf
    v_mfma_f32_16x16x32_bf16 v[32:35], v[108:111], v[64:67], v[32:35]
    v_cndmask_b32_dpp v138, v226, v234, vcc quad_perm:[2,3,0,1] row_mask:0xf bank_mask:0xf
    v_cndmask_b32_dpp v139, v227, v235, vcc quad_perm:[2,3,0,1] row_mask:0xf bank_mask:0xf
    v_mfma_f32_16x16x32_bf16 v[20:23], v[108:111], v[52:55], v[20:23]
    v_cndmask_b32_dpp v140, v228, v236, vcc quad_perm:[2,3,0,1] row_mask:0xf bank_mask:0xf
    v_cndmask_b32_dpp v141, v229, v237, vcc quad_perm:[2,3,0,1] row_mask:0xf bank_mask:0xf
    v_mfma_f32_16x16x32_bf16 v[24:27], v[108:111], v[56:59], v[24:27]
    v_cndmask_b32_dpp v142, v230, v238, vcc quad_perm:[2,3,0,1] row_mask:0xf bank_mask:0xf
    v_cndmask_b32_dpp v143, v231, v239, vcc quad_perm:[2,3,0,1] row_mask:0xf bank_mask:0xf
    buffer_load_dwordx4 v[108:111], v72, s[36:39], s68 offen offset:2048
    v_xor_b32 v68, 0x100, v68
    v_xor_b32 v69, 0x100, v69
    v_xor_b32 v71, 0x100, v71
    v_xor_b32 v72, 0x100, v72
    s_waitcnt vmcnt(16) lgkmcnt(0)
    v_mfma_f32_16x16x32_bf16 v[12:15], v[112:115], v[44:47], v[12:15]
    ds_read_b64_tr_b16 v[52:53], v75 offset:1024
    ds_read_b64_tr_b16 v[54:55], v75 offset:1536
    s_mov_b32 vcc_lo, 0x55555555
    s_mov_b32 vcc_hi, 0x55555555
    v_cndmask_b32_dpp v224, v148, v144, vcc quad_perm:[1,0,3,2] row_mask:0xf bank_mask:0xf
    v_cndmask_b32_dpp v225, v149, v145, vcc quad_perm:[1,0,3,2] row_mask:0xf bank_mask:0xf
    v_mfma_f32_16x16x32_bf16 v[16:19], v[112:115], v[48:51], v[16:19]
    ds_read_b64_tr_b16 v[56:57], v76 offset:1024
    ds_read_b64_tr_b16 v[58:59], v76 offset:1536
    v_cndmask_b32_dpp v226, v150, v146, vcc quad_perm:[1,0,3,2] row_mask:0xf bank_mask:0xf
    v_cndmask_b32_dpp v227, v151, v147, vcc quad_perm:[1,0,3,2] row_mask:0xf bank_mask:0xf
    v_mfma_f32_16x16x32_bf16 v[4:7], v[112:115], v[36:39], v[4:7]
    ds_read_b64_tr_b16 v[60:61], v77 offset:1024
    ds_read_b64_tr_b16 v[62:63], v77 offset:1536
    v_cndmask_b32_dpp v232, v156, v152, vcc quad_perm:[1,0,3,2] row_mask:0xf bank_mask:0xf
    v_cndmask_b32_dpp v233, v157, v153, vcc quad_perm:[1,0,3,2] row_mask:0xf bank_mask:0xf
    v_mfma_f32_16x16x32_bf16 v[8:11], v[112:115], v[40:43], v[8:11]
    ds_read_b64_tr_b16 v[64:65], v78 offset:1024
    ds_read_b64_tr_b16 v[66:67], v78 offset:1536
    v_cndmask_b32_dpp v234, v158, v154, vcc quad_perm:[1,0,3,2] row_mask:0xf bank_mask:0xf
    v_cndmask_b32_dpp v235, v159, v155, vcc quad_perm:[1,0,3,2] row_mask:0xf bank_mask:0xf
    buffer_load_dwordx4 v[112:115], v68, s[36:39], s68 offen offset:0
    v_mfma_f32_16x16x32_bf16 v[28:31], v[128:131], v[44:47], v[28:31]
    s_mov_b32 vcc_lo, 0xaaaaaaaa
    s_mov_b32 vcc_hi, 0xaaaaaaaa
    v_cndmask_b32_dpp v228, v144, v148, vcc quad_perm:[1,0,3,2] row_mask:0xf bank_mask:0xf
    v_cndmask_b32_dpp v229, v145, v149, vcc quad_perm:[1,0,3,2] row_mask:0xf bank_mask:0xf
    v_mfma_f32_16x16x32_bf16 v[32:35], v[128:131], v[48:51], v[32:35]
    v_cndmask_b32_dpp v230, v146, v150, vcc quad_perm:[1,0,3,2] row_mask:0xf bank_mask:0xf
    v_cndmask_b32_dpp v231, v147, v151, vcc quad_perm:[1,0,3,2] row_mask:0xf bank_mask:0xf
    v_mfma_f32_16x16x32_bf16 v[20:23], v[128:131], v[36:39], v[20:23]
    v_cndmask_b32_dpp v236, v152, v156, vcc quad_perm:[1,0,3,2] row_mask:0xf bank_mask:0xf
    v_cndmask_b32_dpp v237, v153, v157, vcc quad_perm:[1,0,3,2] row_mask:0xf bank_mask:0xf
    v_mfma_f32_16x16x32_bf16 v[24:27], v[128:131], v[40:43], v[24:27]
    v_cndmask_b32_dpp v238, v154, v158, vcc quad_perm:[1,0,3,2] row_mask:0xf bank_mask:0xf
    v_cndmask_b32_dpp v239, v155, v159, vcc quad_perm:[1,0,3,2] row_mask:0xf bank_mask:0xf
    buffer_load_dwordx4 v[128:131], v69, s[36:39], s68 offen offset:0
    s_waitcnt lgkmcnt(0)
    v_mfma_f32_16x16x32_bf16 v[12:15], v[116:119], v[60:63], v[12:15]
    ds_read_b64_tr_b16 v[36:37], v75 offset:2048
    ds_read_b64_tr_b16 v[38:39], v75 offset:2560
    s_mov_b32 vcc_lo, 0x33333333
    s_mov_b32 vcc_hi, 0x33333333
    v_cndmask_b32_dpp v144, v232, v224, vcc quad_perm:[2,3,0,1] row_mask:0xf bank_mask:0xf
    v_cndmask_b32_dpp v145, v233, v225, vcc quad_perm:[2,3,0,1] row_mask:0xf bank_mask:0xf
    v_mfma_f32_16x16x32_bf16 v[16:19], v[116:119], v[64:67], v[16:19]
    ds_read_b64_tr_b16 v[40:41], v76 offset:2048
    ds_read_b64_tr_b16 v[42:43], v76 offset:2560
    v_cndmask_b32_dpp v146, v234, v226, vcc quad_perm:[2,3,0,1] row_mask:0xf bank_mask:0xf
    v_cndmask_b32_dpp v147, v235, v227, vcc quad_perm:[2,3,0,1] row_mask:0xf bank_mask:0xf
    v_mfma_f32_16x16x32_bf16 v[4:7], v[116:119], v[52:55], v[4:7]
    ds_read_b64_tr_b16 v[44:45], v77 offset:2048
    ds_read_b64_tr_b16 v[46:47], v77 offset:2560
    v_cndmask_b32_dpp v148, v236, v228, vcc quad_perm:[2,3,0,1] row_mask:0xf bank_mask:0xf
    v_cndmask_b32_dpp v149, v237, v229, vcc quad_perm:[2,3,0,1] row_mask:0xf bank_mask:0xf
    v_mfma_f32_16x16x32_bf16 v[8:11], v[116:119], v[56:59], v[8:11]
    ds_read_b64_tr_b16 v[48:49], v78 offset:2048
    ds_read_b64_tr_b16 v[50:51], v78 offset:2560
    v_cndmask_b32_dpp v150, v238, v230, vcc quad_perm:[2,3,0,1] row_mask:0xf bank_mask:0xf
    v_cndmask_b32_dpp v151, v239, v231, vcc quad_perm:[2,3,0,1] row_mask:0xf bank_mask:0xf
    buffer_load_dwordx4 v[116:119], v68, s[36:39], s68 offen offset:2048
    v_mfma_f32_16x16x32_bf16 v[28:31], v[132:135], v[60:63], v[28:31]
    s_mov_b32 vcc_lo, 0xcccccccc
    s_mov_b32 vcc_hi, 0xcccccccc
    v_cndmask_b32_dpp v152, v224, v232, vcc quad_perm:[2,3,0,1] row_mask:0xf bank_mask:0xf
    v_cndmask_b32_dpp v153, v225, v233, vcc quad_perm:[2,3,0,1] row_mask:0xf bank_mask:0xf
    v_mfma_f32_16x16x32_bf16 v[32:35], v[132:135], v[64:67], v[32:35]
    v_cndmask_b32_dpp v154, v226, v234, vcc quad_perm:[2,3,0,1] row_mask:0xf bank_mask:0xf
    v_cndmask_b32_dpp v155, v227, v235, vcc quad_perm:[2,3,0,1] row_mask:0xf bank_mask:0xf
    v_mfma_f32_16x16x32_bf16 v[20:23], v[132:135], v[52:55], v[20:23]
    v_cndmask_b32_dpp v156, v228, v236, vcc quad_perm:[2,3,0,1] row_mask:0xf bank_mask:0xf
    v_cndmask_b32_dpp v157, v229, v237, vcc quad_perm:[2,3,0,1] row_mask:0xf bank_mask:0xf
    v_mfma_f32_16x16x32_bf16 v[24:27], v[132:135], v[56:59], v[24:27]
    v_cndmask_b32_dpp v158, v230, v238, vcc quad_perm:[2,3,0,1] row_mask:0xf bank_mask:0xf
    v_cndmask_b32_dpp v159, v231, v239, vcc quad_perm:[2,3,0,1] row_mask:0xf bank_mask:0xf
    buffer_load_dwordx4 v[132:135], v69, s[36:39], s68 offen offset:2048
    s_waitcnt lgkmcnt(0)
    v_mfma_f32_16x16x32_bf16 v[12:15], v[120:123], v[44:47], v[12:15]
    ds_read_b64_tr_b16 v[52:53], v75 offset:3072
    ds_read_b64_tr_b16 v[54:55], v75 offset:3584
    s_mov_b32 vcc_lo, 0x55555555
    s_mov_b32 vcc_hi, 0x55555555
    v_cndmask_b32_dpp v224, v164, v160, vcc quad_perm:[1,0,3,2] row_mask:0xf bank_mask:0xf
    v_cndmask_b32_dpp v225, v165, v161, vcc quad_perm:[1,0,3,2] row_mask:0xf bank_mask:0xf
    v_mfma_f32_16x16x32_bf16 v[16:19], v[120:123], v[48:51], v[16:19]
    ds_read_b64_tr_b16 v[56:57], v76 offset:3072
    ds_read_b64_tr_b16 v[58:59], v76 offset:3584
    v_cndmask_b32_dpp v226, v166, v162, vcc quad_perm:[1,0,3,2] row_mask:0xf bank_mask:0xf
    v_cndmask_b32_dpp v227, v167, v163, vcc quad_perm:[1,0,3,2] row_mask:0xf bank_mask:0xf
    v_mfma_f32_16x16x32_bf16 v[4:7], v[120:123], v[36:39], v[4:7]
    ds_read_b64_tr_b16 v[60:61], v77 offset:3072
    ds_read_b64_tr_b16 v[62:63], v77 offset:3584
    v_cndmask_b32_dpp v232, v172, v168, vcc quad_perm:[1,0,3,2] row_mask:0xf bank_mask:0xf
    v_cndmask_b32_dpp v233, v173, v169, vcc quad_perm:[1,0,3,2] row_mask:0xf bank_mask:0xf
    v_mfma_f32_16x16x32_bf16 v[8:11], v[120:123], v[40:43], v[8:11]
    ds_read_b64_tr_b16 v[64:65], v78 offset:3072
    ds_read_b64_tr_b16 v[66:67], v78 offset:3584
    v_cndmask_b32_dpp v234, v174, v170, vcc quad_perm:[1,0,3,2] row_mask:0xf bank_mask:0xf
    v_cndmask_b32_dpp v235, v175, v171, vcc quad_perm:[1,0,3,2] row_mask:0xf bank_mask:0xf
    buffer_load_dwordx4 v[120:123], v71, s[36:39], s68 offen offset:0
    v_mfma_f32_16x16x32_bf16 v[28:31], v[136:139], v[44:47], v[28:31]
    s_mov_b32 vcc_lo, 0xaaaaaaaa
    s_mov_b32 vcc_hi, 0xaaaaaaaa
    v_cndmask_b32_dpp v228, v160, v164, vcc quad_perm:[1,0,3,2] row_mask:0xf bank_mask:0xf
    v_cndmask_b32_dpp v229, v161, v165, vcc quad_perm:[1,0,3,2] row_mask:0xf bank_mask:0xf
    v_mfma_f32_16x16x32_bf16 v[32:35], v[136:139], v[48:51], v[32:35]
    v_cndmask_b32_dpp v230, v162, v166, vcc quad_perm:[1,0,3,2] row_mask:0xf bank_mask:0xf
    v_cndmask_b32_dpp v231, v163, v167, vcc quad_perm:[1,0,3,2] row_mask:0xf bank_mask:0xf
    v_mfma_f32_16x16x32_bf16 v[20:23], v[136:139], v[36:39], v[20:23]
    v_cndmask_b32_dpp v236, v168, v172, vcc quad_perm:[1,0,3,2] row_mask:0xf bank_mask:0xf
    v_cndmask_b32_dpp v237, v169, v173, vcc quad_perm:[1,0,3,2] row_mask:0xf bank_mask:0xf
    v_mfma_f32_16x16x32_bf16 v[24:27], v[136:139], v[40:43], v[24:27]
    v_cndmask_b32_dpp v238, v170, v174, vcc quad_perm:[1,0,3,2] row_mask:0xf bank_mask:0xf
    v_cndmask_b32_dpp v239, v171, v175, vcc quad_perm:[1,0,3,2] row_mask:0xf bank_mask:0xf
    buffer_load_dwordx4 v[136:139], v72, s[36:39], s68 offen offset:0
    s_waitcnt lgkmcnt(0)
    v_xor_b32 v75, 0xc000, v75
    v_xor_b32 v76, 0xc000, v76
    v_xor_b32 v77, 0xc000, v77
    v_xor_b32 v78, 0xc000, v78
    v_mfma_f32_16x16x32_bf16 v[12:15], v[124:127], v[60:63], v[12:15]
    ds_read_b64_tr_b16 v[36:37], v75 offset:0
    ds_read_b64_tr_b16 v[38:39], v75 offset:512
    s_mov_b32 vcc_lo, 0x33333333
    s_mov_b32 vcc_hi, 0x33333333
    v_cndmask_b32_dpp v160, v232, v224, vcc quad_perm:[2,3,0,1] row_mask:0xf bank_mask:0xf
    v_cndmask_b32_dpp v161, v233, v225, vcc quad_perm:[2,3,0,1] row_mask:0xf bank_mask:0xf
    v_mfma_f32_16x16x32_bf16 v[16:19], v[124:127], v[64:67], v[16:19]
    ds_read_b64_tr_b16 v[40:41], v76 offset:0
    ds_read_b64_tr_b16 v[42:43], v76 offset:512
    v_cndmask_b32_dpp v162, v234, v226, vcc quad_perm:[2,3,0,1] row_mask:0xf bank_mask:0xf
    v_cndmask_b32_dpp v163, v235, v227, vcc quad_perm:[2,3,0,1] row_mask:0xf bank_mask:0xf
    v_mfma_f32_16x16x32_bf16 v[4:7], v[124:127], v[52:55], v[4:7]
    ds_read_b64_tr_b16 v[44:45], v77 offset:0
    ds_read_b64_tr_b16 v[46:47], v77 offset:512
    v_cndmask_b32_dpp v164, v236, v228, vcc quad_perm:[2,3,0,1] row_mask:0xf bank_mask:0xf
    v_cndmask_b32_dpp v165, v237, v229, vcc quad_perm:[2,3,0,1] row_mask:0xf bank_mask:0xf
    v_mfma_f32_16x16x32_bf16 v[8:11], v[124:127], v[56:59], v[8:11]
    ds_read_b64_tr_b16 v[48:49], v78 offset:0
    ds_read_b64_tr_b16 v[50:51], v78 offset:512
    v_cndmask_b32_dpp v166, v238, v230, vcc quad_perm:[2,3,0,1] row_mask:0xf bank_mask:0xf
    v_cndmask_b32_dpp v167, v239, v231, vcc quad_perm:[2,3,0,1] row_mask:0xf bank_mask:0xf
    buffer_load_dwordx4 v[124:127], v71, s[36:39], s68 offen offset:2048
    v_mfma_f32_16x16x32_bf16 v[28:31], v[140:143], v[60:63], v[28:31]
    s_mov_b32 vcc_lo, 0xcccccccc
    s_mov_b32 vcc_hi, 0xcccccccc
    v_cndmask_b32_dpp v168, v224, v232, vcc quad_perm:[2,3,0,1] row_mask:0xf bank_mask:0xf
    v_cndmask_b32_dpp v169, v225, v233, vcc quad_perm:[2,3,0,1] row_mask:0xf bank_mask:0xf
    v_mfma_f32_16x16x32_bf16 v[32:35], v[140:143], v[64:67], v[32:35]
    v_cndmask_b32_dpp v170, v226, v234, vcc quad_perm:[2,3,0,1] row_mask:0xf bank_mask:0xf
    v_cndmask_b32_dpp v171, v227, v235, vcc quad_perm:[2,3,0,1] row_mask:0xf bank_mask:0xf
    v_mfma_f32_16x16x32_bf16 v[20:23], v[140:143], v[52:55], v[20:23]
    v_cndmask_b32_dpp v172, v228, v236, vcc quad_perm:[2,3,0,1] row_mask:0xf bank_mask:0xf
    v_cndmask_b32_dpp v173, v229, v237, vcc quad_perm:[2,3,0,1] row_mask:0xf bank_mask:0xf
    v_mfma_f32_16x16x32_bf16 v[24:27], v[140:143], v[56:59], v[24:27]
    v_cndmask_b32_dpp v174, v230, v238, vcc quad_perm:[2,3,0,1] row_mask:0xf bank_mask:0xf
    v_cndmask_b32_dpp v175, v231, v239, vcc quad_perm:[2,3,0,1] row_mask:0xf bank_mask:0xf
    buffer_load_dwordx4 v[140:143], v72, s[36:39], s68 offen offset:2048
    v_xor_b32 v68, 0x300, v68
    v_xor_b32 v69, 0x300, v69
    v_xor_b32 v71, 0x300, v71
    v_xor_b32 v72, 0x300, v72
    s_waitcnt vmcnt(16) lgkmcnt(0)
    v_mfma_f32_16x16x32_bf16 v[12:15], v[144:147], v[44:47], v[12:15]
    ds_read_b64_tr_b16 v[52:53], v75 offset:1024
    ds_read_b64_tr_b16 v[54:55], v75 offset:1536
    s_mov_b32 vcc_lo, 0x55555555
    s_mov_b32 vcc_hi, 0x55555555
    v_cndmask_b32_dpp v224, v180, v176, vcc quad_perm:[1,0,3,2] row_mask:0xf bank_mask:0xf
    v_cndmask_b32_dpp v225, v181, v177, vcc quad_perm:[1,0,3,2] row_mask:0xf bank_mask:0xf
    v_mfma_f32_16x16x32_bf16 v[16:19], v[144:147], v[48:51], v[16:19]
    ds_read_b64_tr_b16 v[56:57], v76 offset:1024
    ds_read_b64_tr_b16 v[58:59], v76 offset:1536
    v_cndmask_b32_dpp v226, v182, v178, vcc quad_perm:[1,0,3,2] row_mask:0xf bank_mask:0xf
    v_cndmask_b32_dpp v227, v183, v179, vcc quad_perm:[1,0,3,2] row_mask:0xf bank_mask:0xf
    v_mfma_f32_16x16x32_bf16 v[4:7], v[144:147], v[36:39], v[4:7]
    ds_read_b64_tr_b16 v[60:61], v77 offset:1024
    ds_read_b64_tr_b16 v[62:63], v77 offset:1536
    v_cndmask_b32_dpp v232, v188, v184, vcc quad_perm:[1,0,3,2] row_mask:0xf bank_mask:0xf
    v_cndmask_b32_dpp v233, v189, v185, vcc quad_perm:[1,0,3,2] row_mask:0xf bank_mask:0xf
    v_mfma_f32_16x16x32_bf16 v[8:11], v[144:147], v[40:43], v[8:11]
    ds_read_b64_tr_b16 v[64:65], v78 offset:1024
    ds_read_b64_tr_b16 v[66:67], v78 offset:1536
    v_cndmask_b32_dpp v234, v190, v186, vcc quad_perm:[1,0,3,2] row_mask:0xf bank_mask:0xf
    v_cndmask_b32_dpp v235, v191, v187, vcc quad_perm:[1,0,3,2] row_mask:0xf bank_mask:0xf
    buffer_load_dwordx4 v[144:147], v68, s[36:39], s68 offen offset:0
    v_mfma_f32_16x16x32_bf16 v[28:31], v[160:163], v[44:47], v[28:31]
    s_mov_b32 vcc_lo, 0xaaaaaaaa
    s_mov_b32 vcc_hi, 0xaaaaaaaa
    v_cndmask_b32_dpp v228, v176, v180, vcc quad_perm:[1,0,3,2] row_mask:0xf bank_mask:0xf
    v_cndmask_b32_dpp v229, v177, v181, vcc quad_perm:[1,0,3,2] row_mask:0xf bank_mask:0xf
    v_mfma_f32_16x16x32_bf16 v[32:35], v[160:163], v[48:51], v[32:35]
    v_cndmask_b32_dpp v230, v178, v182, vcc quad_perm:[1,0,3,2] row_mask:0xf bank_mask:0xf
    v_cndmask_b32_dpp v231, v179, v183, vcc quad_perm:[1,0,3,2] row_mask:0xf bank_mask:0xf
    v_mfma_f32_16x16x32_bf16 v[20:23], v[160:163], v[36:39], v[20:23]
    v_cndmask_b32_dpp v236, v184, v188, vcc quad_perm:[1,0,3,2] row_mask:0xf bank_mask:0xf
    v_cndmask_b32_dpp v237, v185, v189, vcc quad_perm:[1,0,3,2] row_mask:0xf bank_mask:0xf
    v_mfma_f32_16x16x32_bf16 v[24:27], v[160:163], v[40:43], v[24:27]
    v_cndmask_b32_dpp v238, v186, v190, vcc quad_perm:[1,0,3,2] row_mask:0xf bank_mask:0xf
    v_cndmask_b32_dpp v239, v187, v191, vcc quad_perm:[1,0,3,2] row_mask:0xf bank_mask:0xf
    buffer_load_dwordx4 v[160:163], v69, s[36:39], s68 offen offset:0
    s_waitcnt lgkmcnt(0)
    v_mfma_f32_16x16x32_bf16 v[12:15], v[148:151], v[60:63], v[12:15]
    ds_read_b64_tr_b16 v[36:37], v75 offset:2048
    ds_read_b64_tr_b16 v[38:39], v75 offset:2560
    s_mov_b32 vcc_lo, 0x33333333
    s_mov_b32 vcc_hi, 0x33333333
    v_cndmask_b32_dpp v176, v232, v224, vcc quad_perm:[2,3,0,1] row_mask:0xf bank_mask:0xf
    v_cndmask_b32_dpp v177, v233, v225, vcc quad_perm:[2,3,0,1] row_mask:0xf bank_mask:0xf
    v_mfma_f32_16x16x32_bf16 v[16:19], v[148:151], v[64:67], v[16:19]
    ds_read_b64_tr_b16 v[40:41], v76 offset:2048
    ds_read_b64_tr_b16 v[42:43], v76 offset:2560
    v_cndmask_b32_dpp v178, v234, v226, vcc quad_perm:[2,3,0,1] row_mask:0xf bank_mask:0xf
    v_cndmask_b32_dpp v179, v235, v227, vcc quad_perm:[2,3,0,1] row_mask:0xf bank_mask:0xf
    v_mfma_f32_16x16x32_bf16 v[4:7], v[148:151], v[52:55], v[4:7]
    ds_read_b64_tr_b16 v[44:45], v77 offset:2048
    ds_read_b64_tr_b16 v[46:47], v77 offset:2560
    v_cndmask_b32_dpp v180, v236, v228, vcc quad_perm:[2,3,0,1] row_mask:0xf bank_mask:0xf
    v_cndmask_b32_dpp v181, v237, v229, vcc quad_perm:[2,3,0,1] row_mask:0xf bank_mask:0xf
    v_mfma_f32_16x16x32_bf16 v[8:11], v[148:151], v[56:59], v[8:11]
    ds_read_b64_tr_b16 v[48:49], v78 offset:2048
    ds_read_b64_tr_b16 v[50:51], v78 offset:2560
    v_cndmask_b32_dpp v182, v238, v230, vcc quad_perm:[2,3,0,1] row_mask:0xf bank_mask:0xf
    v_cndmask_b32_dpp v183, v239, v231, vcc quad_perm:[2,3,0,1] row_mask:0xf bank_mask:0xf
    buffer_load_dwordx4 v[148:151], v68, s[36:39], s68 offen offset:2048
    v_mfma_f32_16x16x32_bf16 v[28:31], v[164:167], v[60:63], v[28:31]
    s_mov_b32 vcc_lo, 0xcccccccc
    s_mov_b32 vcc_hi, 0xcccccccc
    v_cndmask_b32_dpp v184, v224, v232, vcc quad_perm:[2,3,0,1] row_mask:0xf bank_mask:0xf
    v_cndmask_b32_dpp v185, v225, v233, vcc quad_perm:[2,3,0,1] row_mask:0xf bank_mask:0xf
    v_mfma_f32_16x16x32_bf16 v[32:35], v[164:167], v[64:67], v[32:35]
    v_cndmask_b32_dpp v186, v226, v234, vcc quad_perm:[2,3,0,1] row_mask:0xf bank_mask:0xf
    v_cndmask_b32_dpp v187, v227, v235, vcc quad_perm:[2,3,0,1] row_mask:0xf bank_mask:0xf
    v_mfma_f32_16x16x32_bf16 v[20:23], v[164:167], v[52:55], v[20:23]
    v_cndmask_b32_dpp v188, v228, v236, vcc quad_perm:[2,3,0,1] row_mask:0xf bank_mask:0xf
    v_cndmask_b32_dpp v189, v229, v237, vcc quad_perm:[2,3,0,1] row_mask:0xf bank_mask:0xf
    v_mfma_f32_16x16x32_bf16 v[24:27], v[164:167], v[56:59], v[24:27]
    v_cndmask_b32_dpp v190, v230, v238, vcc quad_perm:[2,3,0,1] row_mask:0xf bank_mask:0xf
    v_cndmask_b32_dpp v191, v231, v239, vcc quad_perm:[2,3,0,1] row_mask:0xf bank_mask:0xf
    buffer_load_dwordx4 v[164:167], v69, s[36:39], s68 offen offset:2048
    s_waitcnt lgkmcnt(0)
    v_mfma_f32_16x16x32_bf16 v[12:15], v[152:155], v[44:47], v[12:15]
    ds_read_b64_tr_b16 v[52:53], v75 offset:3072
    ds_read_b64_tr_b16 v[54:55], v75 offset:3584
    s_mov_b32 vcc_lo, 0x55555555
    s_mov_b32 vcc_hi, 0x55555555
    v_cndmask_b32_dpp v224, v196, v192, vcc quad_perm:[1,0,3,2] row_mask:0xf bank_mask:0xf
    v_cndmask_b32_dpp v225, v197, v193, vcc quad_perm:[1,0,3,2] row_mask:0xf bank_mask:0xf
    v_mfma_f32_16x16x32_bf16 v[16:19], v[152:155], v[48:51], v[16:19]
    ds_read_b64_tr_b16 v[56:57], v76 offset:3072
    ds_read_b64_tr_b16 v[58:59], v76 offset:3584
    v_cndmask_b32_dpp v226, v198, v194, vcc quad_perm:[1,0,3,2] row_mask:0xf bank_mask:0xf
    v_cndmask_b32_dpp v227, v199, v195, vcc quad_perm:[1,0,3,2] row_mask:0xf bank_mask:0xf
    v_mfma_f32_16x16x32_bf16 v[4:7], v[152:155], v[36:39], v[4:7]
    ds_read_b64_tr_b16 v[60:61], v77 offset:3072
    ds_read_b64_tr_b16 v[62:63], v77 offset:3584
    v_cndmask_b32_dpp v232, v204, v200, vcc quad_perm:[1,0,3,2] row_mask:0xf bank_mask:0xf
    v_cndmask_b32_dpp v233, v205, v201, vcc quad_perm:[1,0,3,2] row_mask:0xf bank_mask:0xf
    v_mfma_f32_16x16x32_bf16 v[8:11], v[152:155], v[40:43], v[8:11]
    ds_read_b64_tr_b16 v[64:65], v78 offset:3072
    ds_read_b64_tr_b16 v[66:67], v78 offset:3584
    v_cndmask_b32_dpp v234, v206, v202, vcc quad_perm:[1,0,3,2] row_mask:0xf bank_mask:0xf
    v_cndmask_b32_dpp v235, v207, v203, vcc quad_perm:[1,0,3,2] row_mask:0xf bank_mask:0xf
    buffer_load_dwordx4 v[152:155], v71, s[36:39], s68 offen offset:0
    v_mfma_f32_16x16x32_bf16 v[28:31], v[168:171], v[44:47], v[28:31]
    s_mov_b32 vcc_lo, 0xaaaaaaaa
    s_mov_b32 vcc_hi, 0xaaaaaaaa
    v_cndmask_b32_dpp v228, v192, v196, vcc quad_perm:[1,0,3,2] row_mask:0xf bank_mask:0xf
    v_cndmask_b32_dpp v229, v193, v197, vcc quad_perm:[1,0,3,2] row_mask:0xf bank_mask:0xf
    v_mfma_f32_16x16x32_bf16 v[32:35], v[168:171], v[48:51], v[32:35]
    v_cndmask_b32_dpp v230, v194, v198, vcc quad_perm:[1,0,3,2] row_mask:0xf bank_mask:0xf
    v_cndmask_b32_dpp v231, v195, v199, vcc quad_perm:[1,0,3,2] row_mask:0xf bank_mask:0xf
    v_mfma_f32_16x16x32_bf16 v[20:23], v[168:171], v[36:39], v[20:23]
    v_cndmask_b32_dpp v236, v200, v204, vcc quad_perm:[1,0,3,2] row_mask:0xf bank_mask:0xf
    v_cndmask_b32_dpp v237, v201, v205, vcc quad_perm:[1,0,3,2] row_mask:0xf bank_mask:0xf
    v_mfma_f32_16x16x32_bf16 v[24:27], v[168:171], v[40:43], v[24:27]
    v_cndmask_b32_dpp v238, v202, v206, vcc quad_perm:[1,0,3,2] row_mask:0xf bank_mask:0xf
    v_cndmask_b32_dpp v239, v203, v207, vcc quad_perm:[1,0,3,2] row_mask:0xf bank_mask:0xf
    buffer_load_dwordx4 v[168:171], v72, s[36:39], s68 offen offset:0
    s_waitcnt lgkmcnt(0)
    v_xor_b32 v75, 0x4000, v75
    v_xor_b32 v76, 0x4000, v76
    v_xor_b32 v77, 0x4000, v77
    v_xor_b32 v78, 0x4000, v78
    v_mfma_f32_16x16x32_bf16 v[12:15], v[156:159], v[60:63], v[12:15]
    ds_read_b64_tr_b16 v[36:37], v75 offset:0
    ds_read_b64_tr_b16 v[38:39], v75 offset:512
    s_mov_b32 vcc_lo, 0x33333333
    s_mov_b32 vcc_hi, 0x33333333
    v_cndmask_b32_dpp v192, v232, v224, vcc quad_perm:[2,3,0,1] row_mask:0xf bank_mask:0xf
    v_cndmask_b32_dpp v193, v233, v225, vcc quad_perm:[2,3,0,1] row_mask:0xf bank_mask:0xf
    v_mfma_f32_16x16x32_bf16 v[16:19], v[156:159], v[64:67], v[16:19]
    ds_read_b64_tr_b16 v[40:41], v76 offset:0
    ds_read_b64_tr_b16 v[42:43], v76 offset:512
    v_cndmask_b32_dpp v194, v234, v226, vcc quad_perm:[2,3,0,1] row_mask:0xf bank_mask:0xf
    v_cndmask_b32_dpp v195, v235, v227, vcc quad_perm:[2,3,0,1] row_mask:0xf bank_mask:0xf
    v_mfma_f32_16x16x32_bf16 v[4:7], v[156:159], v[52:55], v[4:7]
    ds_read_b64_tr_b16 v[44:45], v77 offset:0
    ds_read_b64_tr_b16 v[46:47], v77 offset:512
    v_cndmask_b32_dpp v196, v236, v228, vcc quad_perm:[2,3,0,1] row_mask:0xf bank_mask:0xf
    v_cndmask_b32_dpp v197, v237, v229, vcc quad_perm:[2,3,0,1] row_mask:0xf bank_mask:0xf
    v_mfma_f32_16x16x32_bf16 v[8:11], v[156:159], v[56:59], v[8:11]
    ds_read_b64_tr_b16 v[48:49], v78 offset:0
    ds_read_b64_tr_b16 v[50:51], v78 offset:512
    v_cndmask_b32_dpp v198, v238, v230, vcc quad_perm:[2,3,0,1] row_mask:0xf bank_mask:0xf
    v_cndmask_b32_dpp v199, v239, v231, vcc quad_perm:[2,3,0,1] row_mask:0xf bank_mask:0xf
    buffer_load_dwordx4 v[156:159], v71, s[36:39], s68 offen offset:2048
    v_mfma_f32_16x16x32_bf16 v[28:31], v[172:175], v[60:63], v[28:31]
    s_mov_b32 vcc_lo, 0xcccccccc
    s_mov_b32 vcc_hi, 0xcccccccc
    v_cndmask_b32_dpp v200, v224, v232, vcc quad_perm:[2,3,0,1] row_mask:0xf bank_mask:0xf
    v_cndmask_b32_dpp v201, v225, v233, vcc quad_perm:[2,3,0,1] row_mask:0xf bank_mask:0xf
    v_mfma_f32_16x16x32_bf16 v[32:35], v[172:175], v[64:67], v[32:35]
    v_cndmask_b32_dpp v202, v226, v234, vcc quad_perm:[2,3,0,1] row_mask:0xf bank_mask:0xf
    v_cndmask_b32_dpp v203, v227, v235, vcc quad_perm:[2,3,0,1] row_mask:0xf bank_mask:0xf
    v_mfma_f32_16x16x32_bf16 v[20:23], v[172:175], v[52:55], v[20:23]
    v_cndmask_b32_dpp v204, v228, v236, vcc quad_perm:[2,3,0,1] row_mask:0xf bank_mask:0xf
    v_cndmask_b32_dpp v205, v229, v237, vcc quad_perm:[2,3,0,1] row_mask:0xf bank_mask:0xf
    v_mfma_f32_16x16x32_bf16 v[24:27], v[172:175], v[56:59], v[24:27]
    v_cndmask_b32_dpp v206, v230, v238, vcc quad_perm:[2,3,0,1] row_mask:0xf bank_mask:0xf
    v_cndmask_b32_dpp v207, v231, v239, vcc quad_perm:[2,3,0,1] row_mask:0xf bank_mask:0xf
    buffer_load_dwordx4 v[172:175], v72, s[36:39], s68 offen offset:2048
    v_xor_b32 v68, 0x100, v68
    v_xor_b32 v69, 0x100, v69
    v_xor_b32 v71, 0x100, v71
    v_xor_b32 v72, 0x100, v72
    s_waitcnt vmcnt(16) lgkmcnt(0)
    v_mfma_f32_16x16x32_bf16 v[12:15], v[176:179], v[44:47], v[12:15]
    ds_read_b64_tr_b16 v[52:53], v75 offset:1024
    ds_read_b64_tr_b16 v[54:55], v75 offset:1536
    s_mov_b32 vcc_lo, 0x55555555
    s_mov_b32 vcc_hi, 0x55555555
    v_cndmask_b32_dpp v224, v84, v80, vcc quad_perm:[1,0,3,2] row_mask:0xf bank_mask:0xf
    v_cndmask_b32_dpp v225, v85, v81, vcc quad_perm:[1,0,3,2] row_mask:0xf bank_mask:0xf
    v_mfma_f32_16x16x32_bf16 v[16:19], v[176:179], v[48:51], v[16:19]
    ds_read_b64_tr_b16 v[56:57], v76 offset:1024
    ds_read_b64_tr_b16 v[58:59], v76 offset:1536
    v_cndmask_b32_dpp v226, v86, v82, vcc quad_perm:[1,0,3,2] row_mask:0xf bank_mask:0xf
    v_cndmask_b32_dpp v227, v87, v83, vcc quad_perm:[1,0,3,2] row_mask:0xf bank_mask:0xf
    v_mfma_f32_16x16x32_bf16 v[4:7], v[176:179], v[36:39], v[4:7]
    ds_read_b64_tr_b16 v[60:61], v77 offset:1024
    ds_read_b64_tr_b16 v[62:63], v77 offset:1536
    v_cndmask_b32_dpp v232, v92, v88, vcc quad_perm:[1,0,3,2] row_mask:0xf bank_mask:0xf
    v_cndmask_b32_dpp v233, v93, v89, vcc quad_perm:[1,0,3,2] row_mask:0xf bank_mask:0xf
    v_mfma_f32_16x16x32_bf16 v[8:11], v[176:179], v[40:43], v[8:11]
    ds_read_b64_tr_b16 v[64:65], v78 offset:1024
    ds_read_b64_tr_b16 v[66:67], v78 offset:1536
    v_cndmask_b32_dpp v234, v94, v90, vcc quad_perm:[1,0,3,2] row_mask:0xf bank_mask:0xf
    v_cndmask_b32_dpp v235, v95, v91, vcc quad_perm:[1,0,3,2] row_mask:0xf bank_mask:0xf
    buffer_load_dwordx4 v[176:179], v68, s[36:39], s68 offen offset:0
    v_mfma_f32_16x16x32_bf16 v[28:31], v[192:195], v[44:47], v[28:31]
    s_mov_b32 vcc_lo, 0xaaaaaaaa
    s_mov_b32 vcc_hi, 0xaaaaaaaa
    v_cndmask_b32_dpp v228, v80, v84, vcc quad_perm:[1,0,3,2] row_mask:0xf bank_mask:0xf
    v_cndmask_b32_dpp v229, v81, v85, vcc quad_perm:[1,0,3,2] row_mask:0xf bank_mask:0xf
    v_mfma_f32_16x16x32_bf16 v[32:35], v[192:195], v[48:51], v[32:35]
    v_cndmask_b32_dpp v230, v82, v86, vcc quad_perm:[1,0,3,2] row_mask:0xf bank_mask:0xf
    v_cndmask_b32_dpp v231, v83, v87, vcc quad_perm:[1,0,3,2] row_mask:0xf bank_mask:0xf
    v_mfma_f32_16x16x32_bf16 v[20:23], v[192:195], v[36:39], v[20:23]
    v_cndmask_b32_dpp v236, v88, v92, vcc quad_perm:[1,0,3,2] row_mask:0xf bank_mask:0xf
    v_cndmask_b32_dpp v237, v89, v93, vcc quad_perm:[1,0,3,2] row_mask:0xf bank_mask:0xf
    v_mfma_f32_16x16x32_bf16 v[24:27], v[192:195], v[40:43], v[24:27]
    v_cndmask_b32_dpp v238, v90, v94, vcc quad_perm:[1,0,3,2] row_mask:0xf bank_mask:0xf
    v_cndmask_b32_dpp v239, v91, v95, vcc quad_perm:[1,0,3,2] row_mask:0xf bank_mask:0xf
    buffer_load_dwordx4 v[192:195], v69, s[36:39], s68 offen offset:0
    s_waitcnt lgkmcnt(0)
    v_mfma_f32_16x16x32_bf16 v[12:15], v[180:183], v[60:63], v[12:15]
    ds_read_b64_tr_b16 v[36:37], v75 offset:2048
    ds_read_b64_tr_b16 v[38:39], v75 offset:2560
    s_mov_b32 vcc_lo, 0x33333333
    s_mov_b32 vcc_hi, 0x33333333
    v_cndmask_b32_dpp v80, v232, v224, vcc quad_perm:[2,3,0,1] row_mask:0xf bank_mask:0xf
    v_cndmask_b32_dpp v81, v233, v225, vcc quad_perm:[2,3,0,1] row_mask:0xf bank_mask:0xf
    v_mfma_f32_16x16x32_bf16 v[16:19], v[180:183], v[64:67], v[16:19]
    ds_read_b64_tr_b16 v[40:41], v76 offset:2048
    ds_read_b64_tr_b16 v[42:43], v76 offset:2560
    v_cndmask_b32_dpp v82, v234, v226, vcc quad_perm:[2,3,0,1] row_mask:0xf bank_mask:0xf
    v_cndmask_b32_dpp v83, v235, v227, vcc quad_perm:[2,3,0,1] row_mask:0xf bank_mask:0xf
    v_mfma_f32_16x16x32_bf16 v[4:7], v[180:183], v[52:55], v[4:7]
    ds_read_b64_tr_b16 v[44:45], v77 offset:2048
    ds_read_b64_tr_b16 v[46:47], v77 offset:2560
    v_cndmask_b32_dpp v84, v236, v228, vcc quad_perm:[2,3,0,1] row_mask:0xf bank_mask:0xf
    v_cndmask_b32_dpp v85, v237, v229, vcc quad_perm:[2,3,0,1] row_mask:0xf bank_mask:0xf
    v_mfma_f32_16x16x32_bf16 v[8:11], v[180:183], v[56:59], v[8:11]
    ds_read_b64_tr_b16 v[48:49], v78 offset:2048
    ds_read_b64_tr_b16 v[50:51], v78 offset:2560
    v_cndmask_b32_dpp v86, v238, v230, vcc quad_perm:[2,3,0,1] row_mask:0xf bank_mask:0xf
    v_cndmask_b32_dpp v87, v239, v231, vcc quad_perm:[2,3,0,1] row_mask:0xf bank_mask:0xf
    buffer_load_dwordx4 v[180:183], v68, s[36:39], s68 offen offset:2048
    v_mfma_f32_16x16x32_bf16 v[28:31], v[196:199], v[60:63], v[28:31]
    s_mov_b32 vcc_lo, 0xcccccccc
    s_mov_b32 vcc_hi, 0xcccccccc
    v_cndmask_b32_dpp v88, v224, v232, vcc quad_perm:[2,3,0,1] row_mask:0xf bank_mask:0xf
    v_cndmask_b32_dpp v89, v225, v233, vcc quad_perm:[2,3,0,1] row_mask:0xf bank_mask:0xf
    v_mfma_f32_16x16x32_bf16 v[32:35], v[196:199], v[64:67], v[32:35]
    v_cndmask_b32_dpp v90, v226, v234, vcc quad_perm:[2,3,0,1] row_mask:0xf bank_mask:0xf
    v_cndmask_b32_dpp v91, v227, v235, vcc quad_perm:[2,3,0,1] row_mask:0xf bank_mask:0xf
    v_mfma_f32_16x16x32_bf16 v[20:23], v[196:199], v[52:55], v[20:23]
    v_cndmask_b32_dpp v92, v228, v236, vcc quad_perm:[2,3,0,1] row_mask:0xf bank_mask:0xf
    v_cndmask_b32_dpp v93, v229, v237, vcc quad_perm:[2,3,0,1] row_mask:0xf bank_mask:0xf
    v_mfma_f32_16x16x32_bf16 v[24:27], v[196:199], v[56:59], v[24:27]
    v_cndmask_b32_dpp v94, v230, v238, vcc quad_perm:[2,3,0,1] row_mask:0xf bank_mask:0xf
    v_cndmask_b32_dpp v95, v231, v239, vcc quad_perm:[2,3,0,1] row_mask:0xf bank_mask:0xf
    buffer_load_dwordx4 v[196:199], v69, s[36:39], s68 offen offset:2048
    s_waitcnt lgkmcnt(0)
    v_mfma_f32_16x16x32_bf16 v[12:15], v[184:187], v[44:47], v[12:15]
    ds_read_b64_tr_b16 v[52:53], v75 offset:3072
    ds_read_b64_tr_b16 v[54:55], v75 offset:3584
    s_mov_b32 vcc_lo, 0x55555555
    s_mov_b32 vcc_hi, 0x55555555
    v_cndmask_b32_dpp v224, v100, v96, vcc quad_perm:[1,0,3,2] row_mask:0xf bank_mask:0xf
    v_cndmask_b32_dpp v225, v101, v97, vcc quad_perm:[1,0,3,2] row_mask:0xf bank_mask:0xf
    v_mfma_f32_16x16x32_bf16 v[16:19], v[184:187], v[48:51], v[16:19]
    ds_read_b64_tr_b16 v[56:57], v76 offset:3072
    ds_read_b64_tr_b16 v[58:59], v76 offset:3584
    v_cndmask_b32_dpp v226, v102, v98, vcc quad_perm:[1,0,3,2] row_mask:0xf bank_mask:0xf
    v_cndmask_b32_dpp v227, v103, v99, vcc quad_perm:[1,0,3,2] row_mask:0xf bank_mask:0xf
    v_mfma_f32_16x16x32_bf16 v[4:7], v[184:187], v[36:39], v[4:7]
    ds_read_b64_tr_b16 v[60:61], v77 offset:3072
    ds_read_b64_tr_b16 v[62:63], v77 offset:3584
    v_cndmask_b32_dpp v232, v108, v104, vcc quad_perm:[1,0,3,2] row_mask:0xf bank_mask:0xf
    v_cndmask_b32_dpp v233, v109, v105, vcc quad_perm:[1,0,3,2] row_mask:0xf bank_mask:0xf
    v_mfma_f32_16x16x32_bf16 v[8:11], v[184:187], v[40:43], v[8:11]
    ds_read_b64_tr_b16 v[64:65], v78 offset:3072
    ds_read_b64_tr_b16 v[66:67], v78 offset:3584
    v_cndmask_b32_dpp v234, v110, v106, vcc quad_perm:[1,0,3,2] row_mask:0xf bank_mask:0xf
    v_cndmask_b32_dpp v235, v111, v107, vcc quad_perm:[1,0,3,2] row_mask:0xf bank_mask:0xf
    buffer_load_dwordx4 v[184:187], v71, s[36:39], s68 offen offset:0
    v_mfma_f32_16x16x32_bf16 v[28:31], v[200:203], v[44:47], v[28:31]
    s_mov_b32 vcc_lo, 0xaaaaaaaa
    s_mov_b32 vcc_hi, 0xaaaaaaaa
    v_cndmask_b32_dpp v228, v96, v100, vcc quad_perm:[1,0,3,2] row_mask:0xf bank_mask:0xf
    v_cndmask_b32_dpp v229, v97, v101, vcc quad_perm:[1,0,3,2] row_mask:0xf bank_mask:0xf
    v_mfma_f32_16x16x32_bf16 v[32:35], v[200:203], v[48:51], v[32:35]
    v_cndmask_b32_dpp v230, v98, v102, vcc quad_perm:[1,0,3,2] row_mask:0xf bank_mask:0xf
    v_cndmask_b32_dpp v231, v99, v103, vcc quad_perm:[1,0,3,2] row_mask:0xf bank_mask:0xf
    v_mfma_f32_16x16x32_bf16 v[20:23], v[200:203], v[36:39], v[20:23]
    v_cndmask_b32_dpp v236, v104, v108, vcc quad_perm:[1,0,3,2] row_mask:0xf bank_mask:0xf
    v_cndmask_b32_dpp v237, v105, v109, vcc quad_perm:[1,0,3,2] row_mask:0xf bank_mask:0xf
    v_mfma_f32_16x16x32_bf16 v[24:27], v[200:203], v[40:43], v[24:27]
    v_cndmask_b32_dpp v238, v106, v110, vcc quad_perm:[1,0,3,2] row_mask:0xf bank_mask:0xf
    v_cndmask_b32_dpp v239, v107, v111, vcc quad_perm:[1,0,3,2] row_mask:0xf bank_mask:0xf
    buffer_load_dwordx4 v[200:203], v72, s[36:39], s68 offen offset:0
    s_waitcnt lgkmcnt(0)
    v_xor_b32 v75, 0xc000, v75
    v_xor_b32 v76, 0xc000, v76
    v_xor_b32 v77, 0xc000, v77
    v_xor_b32 v78, 0xc000, v78
    v_mfma_f32_16x16x32_bf16 v[12:15], v[188:191], v[60:63], v[12:15]
    ds_read_b64_tr_b16 v[36:37], v75 offset:0
    ds_read_b64_tr_b16 v[38:39], v75 offset:512
    s_mov_b32 vcc_lo, 0x33333333
    s_mov_b32 vcc_hi, 0x33333333
    v_cndmask_b32_dpp v96, v232, v224, vcc quad_perm:[2,3,0,1] row_mask:0xf bank_mask:0xf
    v_cndmask_b32_dpp v97, v233, v225, vcc quad_perm:[2,3,0,1] row_mask:0xf bank_mask:0xf
    v_mfma_f32_16x16x32_bf16 v[16:19], v[188:191], v[64:67], v[16:19]
    ds_read_b64_tr_b16 v[40:41], v76 offset:0
    ds_read_b64_tr_b16 v[42:43], v76 offset:512
    v_cndmask_b32_dpp v98, v234, v226, vcc quad_perm:[2,3,0,1] row_mask:0xf bank_mask:0xf
    v_cndmask_b32_dpp v99, v235, v227, vcc quad_perm:[2,3,0,1] row_mask:0xf bank_mask:0xf
    v_mfma_f32_16x16x32_bf16 v[4:7], v[188:191], v[52:55], v[4:7]
    ds_read_b64_tr_b16 v[44:45], v77 offset:0
    ds_read_b64_tr_b16 v[46:47], v77 offset:512
    v_cndmask_b32_dpp v100, v236, v228, vcc quad_perm:[2,3,0,1] row_mask:0xf bank_mask:0xf
    v_cndmask_b32_dpp v101, v237, v229, vcc quad_perm:[2,3,0,1] row_mask:0xf bank_mask:0xf
    v_mfma_f32_16x16x32_bf16 v[8:11], v[188:191], v[56:59], v[8:11]
    ds_read_b64_tr_b16 v[48:49], v78 offset:0
    ds_read_b64_tr_b16 v[50:51], v78 offset:512
    v_cndmask_b32_dpp v102, v238, v230, vcc quad_perm:[2,3,0,1] row_mask:0xf bank_mask:0xf
    v_cndmask_b32_dpp v103, v239, v231, vcc quad_perm:[2,3,0,1] row_mask:0xf bank_mask:0xf
    buffer_load_dwordx4 v[188:191], v71, s[36:39], s68 offen offset:2048
    v_mfma_f32_16x16x32_bf16 v[28:31], v[204:207], v[60:63], v[28:31]
    s_mov_b32 vcc_lo, 0xcccccccc
    s_mov_b32 vcc_hi, 0xcccccccc
    v_cndmask_b32_dpp v104, v224, v232, vcc quad_perm:[2,3,0,1] row_mask:0xf bank_mask:0xf
    v_cndmask_b32_dpp v105, v225, v233, vcc quad_perm:[2,3,0,1] row_mask:0xf bank_mask:0xf
    v_mfma_f32_16x16x32_bf16 v[32:35], v[204:207], v[64:67], v[32:35]
    v_cndmask_b32_dpp v106, v226, v234, vcc quad_perm:[2,3,0,1] row_mask:0xf bank_mask:0xf
    v_cndmask_b32_dpp v107, v227, v235, vcc quad_perm:[2,3,0,1] row_mask:0xf bank_mask:0xf
    v_mfma_f32_16x16x32_bf16 v[20:23], v[204:207], v[52:55], v[20:23]
    v_cndmask_b32_dpp v108, v228, v236, vcc quad_perm:[2,3,0,1] row_mask:0xf bank_mask:0xf
    v_cndmask_b32_dpp v109, v229, v237, vcc quad_perm:[2,3,0,1] row_mask:0xf bank_mask:0xf
    v_mfma_f32_16x16x32_bf16 v[24:27], v[204:207], v[56:59], v[24:27]
    v_cndmask_b32_dpp v110, v230, v238, vcc quad_perm:[2,3,0,1] row_mask:0xf bank_mask:0xf
    v_cndmask_b32_dpp v111, v231, v239, vcc quad_perm:[2,3,0,1] row_mask:0xf bank_mask:0xf
    buffer_load_dwordx4 v[204:207], v72, s[36:39], s68 offen offset:2048
    v_xor_b32 v68, 0x300, v68
    v_xor_b32 v69, 0x300, v69
    v_xor_b32 v71, 0x300, v71
    v_xor_b32 v72, 0x300, v72
    ds_write_b128 v73, v[12:15] offset:0
    ds_write_b128 v73, v[16:19] offset:1024
    ds_write_b128 v73, v[28:31] offset:2048
    ds_write_b128 v73, v[32:35] offset:3072
    s_add_u32 s73, s73, 1
    s_add_u32 s68, s68, 0x40000
    s_cmp_ge_u32 s73, 5
    s_cselect_b32 s68, 0x5ffffff0, s68
    s_waitcnt lgkmcnt(0)
    s_barrier
    ds_read_b128 v[208:211], v74 offset:0
    ds_read_b128 v[212:215], v74 offset:1024
    ds_read_b128 v[216:219], v74 offset:2048
    ds_read_b128 v[220:223], v74 offset:3072
    s_waitcnt lgkmcnt(3)
    v_pk_add_f32 v[4:5], v[4:5], v[208:209]
    v_pk_add_f32 v[6:7], v[6:7], v[210:211]
    s_waitcnt lgkmcnt(2)
    v_pk_add_f32 v[8:9], v[8:9], v[212:213]
    v_pk_add_f32 v[10:11], v[10:11], v[214:215]
    s_waitcnt lgkmcnt(1)
    v_pk_add_f32 v[20:21], v[20:21], v[216:217]
    v_pk_add_f32 v[22:23], v[22:23], v[218:219]
    s_waitcnt lgkmcnt(0)
    v_pk_add_f32 v[24:25], v[24:25], v[220:221]
    v_pk_add_f32 v[26:27], v[26:27], v[222:223]
    v_cvt_pk_bf16_f32 v208, v4, v5
    v_cvt_pk_bf16_f32 v209, v6, v7
    v_cvt_pk_bf16_f32 v210, v20, v21
    v_cvt_pk_bf16_f32 v211, v22, v23
    buffer_store_dwordx4 v[208:211], v79, s[8:11], s81 offen offset:0 sc1
    v_cvt_pk_bf16_f32 v212, v8, v9
    v_cvt_pk_bf16_f32 v213, v10, v11
    v_cvt_pk_bf16_f32 v214, v24, v25
    v_cvt_pk_bf16_f32 v215, v26, v27
    buffer_store_dwordx4 v[212:215], v79, s[8:11], s81 offen offset:256 sc1
    s_add_u32 s81, s81, 0x100000
    s_cmp_lt_u32 s73, 6
    s_cbranch_scc1 p0_60
    s_branch next_46
f256_44:
    s_mov_b32 s72, 0
    s_waitcnt vmcnt(12)
    s_barrier
    v_add_u32 v74, s72, v72
    v_add_u32 v75, s72, v73
    v_xor_b32 v76, 32, v75
    v_xor_b32 v77, 64, v75
    v_xor_b32 v78, 96, v75
    s_add_u32 s72, s72, 32768
    s_and_b32 s72, s72, 0x1ffff
    ds_read_b128 v[4:7], v74 offset:0
    ds_read_b128 v[8:11], v74 offset:1024
    ds_read_b128 v[12:15], v74 offset:2048
    ds_read_b128 v[16:19], v74 offset:3072
    ds_read_b64_tr_b16 v[36:37], v75 offset:0
    ds_read_b64_tr_b16 v[38:39], v75 offset:2048
    ds_read_b64_tr_b16 v[40:41], v76 offset:0
    ds_read_b64_tr_b16 v[42:43], v76 offset:2048
    ds_read_b64_tr_b16 v[44:45], v77 offset:0
    ds_read_b64_tr_b16 v[46:47], v77 offset:2048
    ds_read_b64_tr_b16 v[48:49], v78 offset:0
    ds_read_b64_tr_b16 v[50:51], v78 offset:2048
    s_waitcnt lgkmcnt(0)
    v_mfma_f32_16x16x32_bf16 v[80:83], v[36:39], v[4:7], 0
    ds_read_b128 v[20:23], v74 offset:4096
    v_mfma_f32_16x16x32_bf16 v[84:87], v[40:43], v[4:7], 0
    v_mfma_f32_16x16x32_bf16 v[88:91], v[44:47], v[4:7], 0
    ds_read_b128 v[24:27], v74 offset:5120
    v_mfma_f32_16x16x32_bf16 v[92:95], v[48:51], v[4:7], 0
    v_mfma_f32_16x16x32_bf16 v[96:99], v[36:39], v[8:11], 0
    ds_read_b128 v[28:31], v74 offset:6144
    v_mfma_f32_16x16x32_bf16 v[100:103], v[40:43], v[8:11], 0
    v_mfma_f32_16x16x32_bf16 v[104:107], v[44:47], v[8:11], 0
    ds_read_b128 v[32:35], v74 offset:7168
    v_mfma_f32_16x16x32_bf16 v[108:111], v[48:51], v[8:11], 0
    v_mfma_f32_16x16x32_bf16 v[112:115], v[36:39], v[12:15], 0
    v_mfma_f32_16x16x32_bf16 v[116:119], v[40:43], v[12:15], 0
    v_mfma_f32_16x16x32_bf16 v[120:123], v[44:47], v[12:15], 0
    v_mfma_f32_16x16x32_bf16 v[124:127], v[48:51], v[12:15], 0
    v_mfma_f32_16x16x32_bf16 v[128:131], v[36:39], v[16:19], 0
    v_mfma_f32_16x16x32_bf16 v[132:135], v[40:43], v[16:19], 0
    v_mfma_f32_16x16x32_bf16 v[136:139], v[44:47], v[16:19], 0
    v_mfma_f32_16x16x32_bf16 v[140:143], v[48:51], v[16:19], 0
    s_waitcnt vmcnt(8) lgkmcnt(0)
    s_barrier
    v_mfma_f32_16x16x32_bf16 v[144:147], v[36:39], v[20:23], 0
    v_add_u32 v74, s72, v72
    v_add_u32 v75, s72, v73
    v_xor_b32 v76, 32, v75
    v_xor_b32 v77, 64, v75
    v_xor_b32 v78, 96, v75
    v_mfma_f32_16x16x32_bf16 v[148:151], v[40:43], v[20:23], 0
    s_add_u32 s72, s72, 32768
    s_and_b32 s72, s72, 0x1ffff
    ds_read_b128 v[4:7], v74 offset:0
    v_mfma_f32_16x16x32_bf16 v[152:155], v[44:47], v[20:23], 0
    ds_read_b64_tr_b16 v[52:53], v75 offset:0
    v_mfma_f32_16x16x32_bf16 v[156:159], v[48:51], v[20:23], 0
    ds_read_b64_tr_b16 v[54:55], v75 offset:2048
    ds_read_b64_tr_b16 v[56:57], v76 offset:0
    v_mfma_f32_16x16x32_bf16 v[160:163], v[36:39], v[24:27], 0
    ds_read_b64_tr_b16 v[58:59], v76 offset:2048
    v_mfma_f32_16x16x32_bf16 v[164:167], v[40:43], v[24:27], 0
    ds_read_b64_tr_b16 v[60:61], v77 offset:0
    ds_read_b64_tr_b16 v[62:63], v77 offset:2048
    v_mfma_f32_16x16x32_bf16 v[168:171], v[44:47], v[24:27], 0
    ds_read_b64_tr_b16 v[64:65], v78 offset:0
    v_mfma_f32_16x16x32_bf16 v[172:175], v[48:51], v[24:27], 0
    ds_read_b64_tr_b16 v[66:67], v78 offset:2048
    ds_read_b128 v[8:11], v74 offset:1024
    v_mfma_f32_16x16x32_bf16 v[176:179], v[36:39], v[28:31], 0
    ds_read_b128 v[12:15], v74 offset:2048
    ds_read_b128 v[16:19], v74 offset:3072
    v_mfma_f32_16x16x32_bf16 v[180:183], v[40:43], v[28:31], 0
    s_mov_b32 m0, s71
    v_mfma_f32_16x16x32_bf16 v[184:187], v[44:47], v[28:31], 0
    buffer_load_dwordx4 v68, s[60:63], s68 offen lds
    s_add_u32 m0, s71, 1024
    v_mfma_f32_16x16x32_bf16 v[188:191], v[48:51], v[28:31], 0
    buffer_load_dwordx4 v69, s[60:63], s68 offen lds
    v_mfma_f32_16x16x32_bf16 v[192:195], v[36:39], v[32:35], 0
    s_add_u32 m0, s71, 16384
    s_nop 0
    buffer_load_dwordx4 v70, s[64:67], s69 offen lds
    v_mfma_f32_16x16x32_bf16 v[196:199], v[40:43], v[32:35], 0
    s_add_u32 m0, s71, 17408
    v_mfma_f32_16x16x32_bf16 v[200:203], v[44:47], v[32:35], 0
    buffer_load_dwordx4 v71, s[64:67], s69 offen lds
    s_add_u32 s68, s68, 64
    s_add_u32 s69, s69, s70
    v_mfma_f32_16x16x32_bf16 v[204:207], v[48:51], v[32:35], 0
    s_add_u32 s71, s71, 32768
    s_and_b32 s71, s71, 0x1ffff
    s_waitcnt lgkmcnt(0)
    v_mfma_f32_16x16x32_bf16 v[80:83], v[52:55], v[4:7], v[80:83]
    ds_read_b128 v[20:23], v74 offset:4096
    v_mfma_f32_16x16x32_bf16 v[84:87], v[56:59], v[4:7], v[84:87]
    v_mfma_f32_16x16x32_bf16 v[88:91], v[60:63], v[4:7], v[88:91]
    ds_read_b128 v[24:27], v74 offset:5120
    v_mfma_f32_16x16x32_bf16 v[92:95], v[64:67], v[4:7], v[92:95]
    v_mfma_f32_16x16x32_bf16 v[96:99], v[52:55], v[8:11], v[96:99]
    ds_read_b128 v[28:31], v74 offset:6144
    v_mfma_f32_16x16x32_bf16 v[100:103], v[56:59], v[8:11], v[100:103]
    v_mfma_f32_16x16x32_bf16 v[104:107], v[60:63], v[8:11], v[104:107]
    ds_read_b128 v[32:35], v74 offset:7168
    v_mfma_f32_16x16x32_bf16 v[108:111], v[64:67], v[8:11], v[108:111]
    v_mfma_f32_16x16x32_bf16 v[112:115], v[52:55], v[12:15], v[112:115]
    v_mfma_f32_16x16x32_bf16 v[116:119], v[56:59], v[12:15], v[116:119]
    v_mfma_f32_16x16x32_bf16 v[120:123], v[60:63], v[12:15], v[120:123]
    v_mfma_f32_16x16x32_bf16 v[124:127], v[64:67], v[12:15], v[124:127]
    v_mfma_f32_16x16x32_bf16 v[128:131], v[52:55], v[16:19], v[128:131]
    v_mfma_f32_16x16x32_bf16 v[132:135], v[56:59], v[16:19], v[132:135]
    v_mfma_f32_16x16x32_bf16 v[136:139], v[60:63], v[16:19], v[136:139]
    v_mfma_f32_16x16x32_bf16 v[140:143], v[64:67], v[16:19], v[140:143]
    s_waitcnt vmcnt(8) lgkmcnt(0)
    s_barrier
    v_mfma_f32_16x16x32_bf16 v[144:147], v[52:55], v[20:23], v[144:147]
    v_add_u32 v74, s72, v72
    v_add_u32 v75, s72, v73
    v_xor_b32 v76, 32, v75
    v_xor_b32 v77, 64, v75
    v_xor_b32 v78, 96, v75
    v_mfma_f32_16x16x32_bf16 v[148:151], v[56:59], v[20:23], v[148:151]
    s_add_u32 s72, s72, 32768
    s_and_b32 s72, s72, 0x1ffff
    ds_read_b128 v[4:7], v74 offset:0
    v_mfma_f32_16x16x32_bf16 v[152:155], v[60:63], v[20:23], v[152:155]
    ds_read_b64_tr_b16 v[36:37], v75 offset:0
    v_mfma_f32_16x16x32_bf16 v[156:159], v[64:67], v[20:23], v[156:159]
    ds_read_b64_tr_b16 v[38:39], v75 offset:2048
    ds_read_b64_tr_b16 v[40:41], v76 offset:0
    v_mfma_f32_16x16x32_bf16 v[160:163], v[52:55], v[24:27], v[160:163]
    ds_read_b64_tr_b16 v[42:43], v76 offset:2048
    v_mfma_f32_16x16x32_bf16 v[164:167], v[56:59], v[24:27], v[164:167]
    ds_read_b64_tr_b16 v[44:45], v77 offset:0
    ds_read_b64_tr_b16 v[46:47], v77 offset:2048
    v_mfma_f32_16x16x32_bf16 v[168:171], v[60:63], v[24:27], v[168:171]
    ds_read_b64_tr_b16 v[48:49], v78 offset:0
    v_mfma_f32_16x16x32_bf16 v[172:175], v[64:67], v[24:27], v[172:175]
    ds_read_b64_tr_b16 v[50:51], v78 offset:2048
    ds_read_b128 v[8:11], v74 offset:1024
    v_mfma_f32_16x16x32_bf16 v[176:179], v[52:55], v[28:31], v[176:179]
    ds_read_b128 v[12:15], v74 offset:2048
    ds_read_b128 v[16:19], v74 offset:3072
    v_mfma_f32_16x16x32_bf16 v[180:183], v[56:59], v[28:31], v[180:183]
    s_mov_b32 m0, s71
    v_mfma_f32_16x16x32_bf16 v[184:187], v[60:63], v[28:31], v[184:187]
    buffer_load_dwordx4 v68, s[60:63], s68 offen lds
    s_add_u32 m0, s71, 1024
    v_mfma_f32_16x16x32_bf16 v[188:191], v[64:67], v[28:31], v[188:191]
    buffer_load_dwordx4 v69, s[60:63], s68 offen lds
    v_mfma_f32_16x16x32_bf16 v[192:195], v[52:55], v[32:35], v[192:195]
    s_add_u32 m0, s71, 16384
    s_nop 0
    buffer_load_dwordx4 v70, s[64:67], s69 offen lds
    v_mfma_f32_16x16x32_bf16 v[196:199], v[56:59], v[32:35], v[196:199]
    s_add_u32 m0, s71, 17408
    v_mfma_f32_16x16x32_bf16 v[200:203], v[60:63], v[32:35], v[200:203]
    buffer_load_dwordx4 v71, s[64:67], s69 offen lds
    s_add_u32 s68, s68, 64
    s_add_u32 s69, s69, s70
    v_mfma_f32_16x16x32_bf16 v[204:207], v[64:67], v[32:35], v[204:207]
    s_add_u32 s71, s71, 32768
    s_and_b32 s71, s71, 0x1ffff
    s_mov_b32 s73, 13
gl_61:
    s_waitcnt lgkmcnt(0)
    v_mfma_f32_16x16x32_bf16 v[80:83], v[36:39], v[4:7], v[80:83]
    ds_read_b128 v[20:23], v74 offset:4096
    v_mfma_f32_16x16x32_bf16 v[84:87], v[40:43], v[4:7], v[84:87]
    v_mfma_f32_16x16x32_bf16 v[88:91], v[44:47], v[4:7], v[88:91]
    ds_read_b128 v[24:27], v74 offset:5120
    v_mfma_f32_16x16x32_bf16 v[92:95], v[48:51], v[4:7], v[92:95]
    v_mfma_f32_16x16x32_bf16 v[96:99], v[36:39], v[8:11], v[96:99]
    ds_read_b128 v[28:31], v74 offset:6144
    v_mfma_f32_16x16x32_bf16 v[100:103], v[40:43], v[8:11], v[100:103]
    v_mfma_f32_16x16x32_bf16 v[104:107], v[44:47], v[8:11], v[104:107]
    ds_read_b128 v[32:35], v74 offset:7168
    v_mfma_f32_16x16x32_bf16 v[108:111], v[48:51], v[8:11], v[108:111]
    v_mfma_f32_16x16x32_bf16 v[112:115], v[36:39], v[12:15], v[112:115]
    v_mfma_f32_16x16x32_bf16 v[116:119], v[40:43], v[12:15], v[116:119]
    v_mfma_f32_16x16x32_bf16 v[120:123], v[44:47], v[12:15], v[120:123]
    v_mfma_f32_16x16x32_bf16 v[124:127], v[48:51], v[12:15], v[124:127]
    v_mfma_f32_16x16x32_bf16 v[128:131], v[36:39], v[16:19], v[128:131]
    v_mfma_f32_16x16x32_bf16 v[132:135], v[40:43], v[16:19], v[132:135]
    v_mfma_f32_16x16x32_bf16 v[136:139], v[44:47], v[16:19], v[136:139]
    v_mfma_f32_16x16x32_bf16 v[140:143], v[48:51], v[16:19], v[140:143]
    s_waitcnt vmcnt(8) lgkmcnt(0)
    s_barrier
    v_mfma_f32_16x16x32_bf16 v[144:147], v[36:39], v[20:23], v[144:147]
    v_add_u32 v74, s72, v72
    v_add_u32 v75, s72, v73
    v_xor_b32 v76, 32, v75
    v_xor_b32 v77, 64, v75
    v_xor_b32 v78, 96, v75
    v_mfma_f32_16x16x32_bf16 v[148:151], v[40:43], v[20:23], v[148:151]
    s_add_u32 s72, s72, 32768
    s_and_b32 s72, s72, 0x1ffff
    ds_read_b128 v[4:7], v74 offset:0
    v_mfma_f32_16x16x32_bf16 v[152:155], v[44:47], v[20:23], v[152:155]
    ds_read_b64_tr_b16 v[52:53], v75 offset:0
    v_mfma_f32_16x16x32_bf16 v[156:159], v[48:51], v[20:23], v[156:159]
    ds_read_b64_tr_b16 v[54:55], v75 offset:2048
    ds_read_b64_tr_b16 v[56:57], v76 offset:0
    v_mfma_f32_16x16x32_bf16 v[160:163], v[36:39], v[24:27], v[160:163]
    ds_read_b64_tr_b16 v[58:59], v76 offset:2048
    v_mfma_f32_16x16x32_bf16 v[164:167], v[40:43], v[24:27], v[164:167]
    ds_read_b64_tr_b16 v[60:61], v77 offset:0
    ds_read_b64_tr_b16 v[62:63], v77 offset:2048
    v_mfma_f32_16x16x32_bf16 v[168:171], v[44:47], v[24:27], v[168:171]
    ds_read_b64_tr_b16 v[64:65], v78 offset:0
    v_mfma_f32_16x16x32_bf16 v[172:175], v[48:51], v[24:27], v[172:175]
    ds_read_b64_tr_b16 v[66:67], v78 offset:2048
    ds_read_b128 v[8:11], v74 offset:1024
    v_mfma_f32_16x16x32_bf16 v[176:179], v[36:39], v[28:31], v[176:179]
    ds_read_b128 v[12:15], v74 offset:2048
    ds_read_b128 v[16:19], v74 offset:3072
    v_mfma_f32_16x16x32_bf16 v[180:183], v[40:43], v[28:31], v[180:183]
    s_mov_b32 m0, s71
    v_mfma_f32_16x16x32_bf16 v[184:187], v[44:47], v[28:31], v[184:187]
    buffer_load_dwordx4 v68, s[60:63], s68 offen lds
    s_add_u32 m0, s71, 1024
    v_mfma_f32_16x16x32_bf16 v[188:191], v[48:51], v[28:31], v[188:191]
    buffer_load_dwordx4 v69, s[60:63], s68 offen lds
    v_mfma_f32_16x16x32_bf16 v[192:195], v[36:39], v[32:35], v[192:195]
    s_add_u32 m0, s71, 16384
    s_nop 0
    buffer_load_dwordx4 v70, s[64:67], s69 offen lds
    v_mfma_f32_16x16x32_bf16 v[196:199], v[40:43], v[32:35], v[196:199]
    s_add_u32 m0, s71, 17408
    v_mfma_f32_16x16x32_bf16 v[200:203], v[44:47], v[32:35], v[200:203]
    buffer_load_dwordx4 v71, s[64:67], s69 offen lds
    s_add_u32 s68, s68, 64
    s_add_u32 s69, s69, s70
    v_mfma_f32_16x16x32_bf16 v[204:207], v[48:51], v[32:35], v[204:207]
    s_add_u32 s71, s71, 32768
    s_and_b32 s71, s71, 0x1ffff
    s_waitcnt lgkmcnt(0)
    v_mfma_f32_16x16x32_bf16 v[80:83], v[52:55], v[4:7], v[80:83]
    ds_read_b128 v[20:23], v74 offset:4096
    v_mfma_f32_16x16x32_bf16 v[84:87], v[56:59], v[4:7], v[84:87]
    v_mfma_f32_16x16x32_bf16 v[88:91], v[60:63], v[4:7], v[88:91]
    ds_read_b128 v[24:27], v74 offset:5120
    v_mfma_f32_16x16x32_bf16 v[92:95], v[64:67], v[4:7], v[92:95]
    v_mfma_f32_16x16x32_bf16 v[96:99], v[52:55], v[8:11], v[96:99]
    ds_read_b128 v[28:31], v74 offset:6144
    v_mfma_f32_16x16x32_bf16 v[100:103], v[56:59], v[8:11], v[100:103]
    v_mfma_f32_16x16x32_bf16 v[104:107], v[60:63], v[8:11], v[104:107]
    ds_read_b128 v[32:35], v74 offset:7168
    v_mfma_f32_16x16x32_bf16 v[108:111], v[64:67], v[8:11], v[108:111]
    v_mfma_f32_16x16x32_bf16 v[112:115], v[52:55], v[12:15], v[112:115]
    v_mfma_f32_16x16x32_bf16 v[116:119], v[56:59], v[12:15], v[116:119]
    v_mfma_f32_16x16x32_bf16 v[120:123], v[60:63], v[12:15], v[120:123]
    v_mfma_f32_16x16x32_bf16 v[124:127], v[64:67], v[12:15], v[124:127]
    v_mfma_f32_16x16x32_bf16 v[128:131], v[52:55], v[16:19], v[128:131]
    v_mfma_f32_16x16x32_bf16 v[132:135], v[56:59], v[16:19], v[132:135]
    v_mfma_f32_16x16x32_bf16 v[136:139], v[60:63], v[16:19], v[136:139]
    v_mfma_f32_16x16x32_bf16 v[140:143], v[64:67], v[16:19], v[140:143]
    s_waitcnt vmcnt(8) lgkmcnt(0)
    s_barrier
    v_mfma_f32_16x16x32_bf16 v[144:147], v[52:55], v[20:23], v[144:147]
    v_add_u32 v74, s72, v72
    v_add_u32 v75, s72, v73
    v_xor_b32 v76, 32, v75
    v_xor_b32 v77, 64, v75
    v_xor_b32 v78, 96, v75
    v_mfma_f32_16x16x32_bf16 v[148:151], v[56:59], v[20:23], v[148:151]
    s_add_u32 s72, s72, 32768
    s_and_b32 s72, s72, 0x1ffff
    ds_read_b128 v[4:7], v74 offset:0
    v_mfma_f32_16x16x32_bf16 v[152:155], v[60:63], v[20:23], v[152:155]
    ds_read_b64_tr_b16 v[36:37], v75 offset:0
    v_mfma_f32_16x16x32_bf16 v[156:159], v[64:67], v[20:23], v[156:159]
    ds_read_b64_tr_b16 v[38:39], v75 offset:2048
    ds_read_b64_tr_b16 v[40:41], v76 offset:0
    v_mfma_f32_16x16x32_bf16 v[160:163], v[52:55], v[24:27], v[160:163]
    ds_read_b64_tr_b16 v[42:43], v76 offset:2048
    v_mfma_f32_16x16x32_bf16 v[164:167], v[56:59], v[24:27], v[164:167]
    ds_read_b64_tr_b16 v[44:45], v77 offset:0
    ds_read_b64_tr_b16 v[46:47], v77 offset:2048
    v_mfma_f32_16x16x32_bf16 v[168:171], v[60:63], v[24:27], v[168:171]
    ds_read_b64_tr_b16 v[48:49], v78 offset:0
    v_mfma_f32_16x16x32_bf16 v[172:175], v[64:67], v[24:27], v[172:175]
    ds_read_b64_tr_b16 v[50:51], v78 offset:2048
    ds_read_b128 v[8:11], v74 offset:1024
    v_mfma_f32_16x16x32_bf16 v[176:179], v[52:55], v[28:31], v[176:179]
    ds_read_b128 v[12:15], v74 offset:2048
    ds_read_b128 v[16:19], v74 offset:3072
    v_mfma_f32_16x16x32_bf16 v[180:183], v[56:59], v[28:31], v[180:183]
    s_mov_b32 m0, s71
    v_mfma_f32_16x16x32_bf16 v[184:187], v[60:63], v[28:31], v[184:187]
    buffer_load_dwordx4 v68, s[60:63], s68 offen lds
    s_add_u32 m0, s71, 1024
    v_mfma_f32_16x16x32_bf16 v[188:191], v[64:67], v[28:31], v[188:191]
    buffer_load_dwordx4 v69, s[60:63], s68 offen lds
    v_mfma_f32_16x16x32_bf16 v[192:195], v[52:55], v[32:35], v[192:195]
    s_add_u32 m0, s71, 16384
    s_nop 0
    buffer_load_dwordx4 v70, s[64:67], s69 offen lds
    v_mfma_f32_16x16x32_bf16 v[196:199], v[56:59], v[32:35], v[196:199]
    s_add_u32 m0, s71, 17408
    v_mfma_f32_16x16x32_bf16 v[200:203], v[60:63], v[32:35], v[200:203]
    buffer_load_dwordx4 v71, s[64:67], s69 offen lds
    s_add_u32 s68, s68, 64
    s_add_u32 s69, s69, s70
    v_mfma_f32_16x16x32_bf16 v[204:207], v[64:67], v[32:35], v[204:207]
    s_add_u32 s71, s71, 32768
    s_and_b32 s71, s71, 0x1ffff
    s_sub_u32 s73, s73, 1
    s_cmp_lg_u32 s73, 0
    s_cbranch_scc1 gl_61
    s_waitcnt lgkmcnt(0)
    v_mfma_f32_16x16x32_bf16 v[80:83], v[36:39], v[4:7], v[80:83]
    ds_read_b128 v[20:23], v74 offset:4096
    v_mfma_f32_16x16x32_bf16 v[84:87], v[40:43], v[4:7], v[84:87]
    v_mfma_f32_16x16x32_bf16 v[88:91], v[44:47], v[4:7], v[88:91]
    ds_read_b128 v[24:27], v74 offset:5120
    v_mfma_f32_16x16x32_bf16 v[92:95], v[48:51], v[4:7], v[92:95]
    v_mfma_f32_16x16x32_bf16 v[96:99], v[36:39], v[8:11], v[96:99]
    ds_read_b128 v[28:31], v74 offset:6144
    v_mfma_f32_16x16x32_bf16 v[100:103], v[40:43], v[8:11], v[100:103]
    v_mfma_f32_16x16x32_bf16 v[104:107], v[44:47], v[8:11], v[104:107]
    ds_read_b128 v[32:35], v74 offset:7168
    v_mfma_f32_16x16x32_bf16 v[108:111], v[48:51], v[8:11], v[108:111]
    v_mfma_f32_16x16x32_bf16 v[112:115], v[36:39], v[12:15], v[112:115]
    v_mfma_f32_16x16x32_bf16 v[116:119], v[40:43], v[12:15], v[116:119]
    v_mfma_f32_16x16x32_bf16 v[120:123], v[44:47], v[12:15], v[120:123]
    v_mfma_f32_16x16x32_bf16 v[124:127], v[48:51], v[12:15], v[124:127]
    v_mfma_f32_16x16x32_bf16 v[128:131], v[36:39], v[16:19], v[128:131]
    v_mfma_f32_16x16x32_bf16 v[132:135], v[40:43], v[16:19], v[132:135]
    v_mfma_f32_16x16x32_bf16 v[136:139], v[44:47], v[16:19], v[136:139]
    v_mfma_f32_16x16x32_bf16 v[140:143], v[48:51], v[16:19], v[140:143]
    s_waitcnt vmcnt(8) lgkmcnt(0)
    s_barrier
    v_mfma_f32_16x16x32_bf16 v[144:147], v[36:39], v[20:23], v[144:147]
    v_add_u32 v74, s72, v72
    v_add_u32 v75, s72, v73
    v_mfma_f32_16x16x32_bf16 v[148:151], v[40:43], v[20:23], v[148:151]
    v_xor_b32 v76, 32, v75
    v_xor_b32 v77, 64, v75
    v_xor_b32 v78, 96, v75
    v_mfma_f32_16x16x32_bf16 v[152:155], v[44:47], v[20:23], v[152:155]
    s_add_u32 s72, s72, 32768
    s_and_b32 s72, s72, 0x1ffff
    v_mfma_f32_16x16x32_bf16 v[156:159], v[48:51], v[20:23], v[156:159]
    ds_read_b128 v[4:7], v74 offset:0
    v_mfma_f32_16x16x32_bf16 v[160:163], v[36:39], v[24:27], v[160:163]
    ds_read_b64_tr_b16 v[52:53], v75 offset:0
    v_mfma_f32_16x16x32_bf16 v[164:167], v[40:43], v[24:27], v[164:167]
    ds_read_b64_tr_b16 v[54:55], v75 offset:2048
    v_mfma_f32_16x16x32_bf16 v[168:171], v[44:47], v[24:27], v[168:171]
    ds_read_b64_tr_b16 v[56:57], v76 offset:0
    v_mfma_f32_16x16x32_bf16 v[172:175], v[48:51], v[24:27], v[172:175]
    ds_read_b64_tr_b16 v[58:59], v76 offset:2048
    v_mfma_f32_16x16x32_bf16 v[176:179], v[36:39], v[28:31], v[176:179]
    ds_read_b64_tr_b16 v[60:61], v77 offset:0
    v_mfma_f32_16x16x32_bf16 v[180:183], v[40:43], v[28:31], v[180:183]
    ds_read_b64_tr_b16 v[62:63], v77 offset:2048
    v_mfma_f32_16x16x32_bf16 v[184:187], v[44:47], v[28:31], v[184:187]
    ds_read_b64_tr_b16 v[64:65], v78 offset:0
    v_mfma_f32_16x16x32_bf16 v[188:191], v[48:51], v[28:31], v[188:191]
    ds_read_b64_tr_b16 v[66:67], v78 offset:2048
    v_mfma_f32_16x16x32_bf16 v[192:195], v[36:39], v[32:35], v[192:195]
    ds_read_b128 v[8:11], v74 offset:1024
    v_mfma_f32_16x16x32_bf16 v[196:199], v[40:43], v[32:35], v[196:199]
    ds_read_b128 v[12:15], v74 offset:2048
    v_mfma_f32_16x16x32_bf16 v[200:203], v[44:47], v[32:35], v[200:203]
    ds_read_b128 v[16:19], v74 offset:3072
    v_mfma_f32_16x16x32_bf16 v[204:207], v[48:51], v[32:35], v[204:207]
    s_waitcnt lgkmcnt(0)
    v_mfma_f32_16x16x32_bf16 v[80:83], v[52:55], v[4:7], v[80:83]
    ds_read_b128 v[20:23], v74 offset:4096
    v_mfma_f32_16x16x32_bf16 v[84:87], v[56:59], v[4:7], v[84:87]
    v_mfma_f32_16x16x32_bf16 v[88:91], v[60:63], v[4:7], v[88:91]
    ds_read_b128 v[24:27], v74 offset:5120
    v_mfma_f32_16x16x32_bf16 v[92:95], v[64:67], v[4:7], v[92:95]
    v_mfma_f32_16x16x32_bf16 v[96:99], v[52:55], v[8:11], v[96:99]
    ds_read_b128 v[28:31], v74 offset:6144
    v_mfma_f32_16x16x32_bf16 v[100:103], v[56:59], v[8:11], v[100:103]
    v_mfma_f32_16x16x32_bf16 v[104:107], v[60:63], v[8:11], v[104:107]
    ds_read_b128 v[32:35], v74 offset:7168
    v_mfma_f32_16x16x32_bf16 v[108:111], v[64:67], v[8:11], v[108:111]
    v_mfma_f32_16x16x32_bf16 v[112:115], v[52:55], v[12:15], v[112:115]
    v_mfma_f32_16x16x32_bf16 v[116:119], v[56:59], v[12:15], v[116:119]
    v_mfma_f32_16x16x32_bf16 v[120:123], v[60:63], v[12:15], v[120:123]
    v_mfma_f32_16x16x32_bf16 v[124:127], v[64:67], v[12:15], v[124:127]
    v_mfma_f32_16x16x32_bf16 v[128:131], v[52:55], v[16:19], v[128:131]
    v_mfma_f32_16x16x32_bf16 v[132:135], v[56:59], v[16:19], v[132:135]
    v_mfma_f32_16x16x32_bf16 v[136:139], v[60:63], v[16:19], v[136:139]
    v_mfma_f32_16x16x32_bf16 v[140:143], v[64:67], v[16:19], v[140:143]
    s_waitcnt vmcnt(4) lgkmcnt(0)
    s_barrier
    v_mfma_f32_16x16x32_bf16 v[144:147], v[52:55], v[20:23], v[144:147]
    v_add_u32 v74, s72, v72
    v_add_u32 v75, s72, v73
    v_mfma_f32_16x16x32_bf16 v[148:151], v[56:59], v[20:23], v[148:151]
    v_xor_b32 v76, 32, v75
    v_xor_b32 v77, 64, v75
    v_xor_b32 v78, 96, v75
    v_mfma_f32_16x16x32_bf16 v[152:155], v[60:63], v[20:23], v[152:155]
    s_add_u32 s72, s72, 32768
    s_and_b32 s72, s72, 0x1ffff
    v_mfma_f32_16x16x32_bf16 v[156:159], v[64:67], v[20:23], v[156:159]
    ds_read_b128 v[4:7], v74 offset:0
    v_mfma_f32_16x16x32_bf16 v[160:163], v[52:55], v[24:27], v[160:163]
    ds_read_b64_tr_b16 v[36:37], v75 offset:0
    v_mfma_f32_16x16x32_bf16 v[164:167], v[56:59], v[24:27], v[164:167]
    ds_read_b64_tr_b16 v[38:39], v75 offset:2048
    v_mfma_f32_16x16x32_bf16 v[168:171], v[60:63], v[24:27], v[168:171]
    ds_read_b64_tr_b16 v[40:41], v76 offset:0
    v_mfma_f32_16x16x32_bf16 v[172:175], v[64:67], v[24:27], v[172:175]
    ds_read_b64_tr_b16 v[42:43], v76 offset:2048
    v_mfma_f32_16x16x32_bf16 v[176:179], v[52:55], v[28:31], v[176:179]
    ds_read_b64_tr_b16 v[44:45], v77 offset:0
    v_mfma_f32_16x16x32_bf16 v[180:183], v[56:59], v[28:31], v[180:183]
    ds_read_b64_tr_b16 v[46:47], v77 offset:2048
    v_mfma_f32_16x16x32_bf16 v[184:187], v[60:63], v[28:31], v[184:187]
    ds_read_b64_tr_b16 v[48:49], v78 offset:0
    v_mfma_f32_16x16x32_bf16 v[188:191], v[64:67], v[28:31], v[188:191]
    ds_read_b64_tr_b16 v[50:51], v78 offset:2048
    v_mfma_f32_16x16x32_bf16 v[192:195], v[52:55], v[32:35], v[192:195]
    ds_read_b128 v[8:11], v74 offset:1024
    v_mfma_f32_16x16x32_bf16 v[196:199], v[56:59], v[32:35], v[196:199]
    ds_read_b128 v[12:15], v74 offset:2048
    v_mfma_f32_16x16x32_bf16 v[200:203], v[60:63], v[32:35], v[200:203]
    ds_read_b128 v[16:19], v74 offset:3072
    v_mfma_f32_16x16x32_bf16 v[204:207], v[64:67], v[32:35], v[204:207]
    s_waitcnt lgkmcnt(0)
    v_mfma_f32_16x16x32_bf16 v[80:83], v[36:39], v[4:7], v[80:83]
    ds_read_b128 v[20:23], v74 offset:4096
    v_mfma_f32_16x16x32_bf16 v[84:87], v[40:43], v[4:7], v[84:87]
    v_mfma_f32_16x16x32_bf16 v[88:91], v[44:47], v[4:7], v[88:91]
    ds_read_b128 v[24:27], v74 offset:5120
    v_mfma_f32_16x16x32_bf16 v[92:95], v[48:51], v[4:7], v[92:95]
    v_mfma_f32_16x16x32_bf16 v[96:99], v[36:39], v[8:11], v[96:99]
    ds_read_b128 v[28:31], v74 offset:6144
    v_mfma_f32_16x16x32_bf16 v[100:103], v[40:43], v[8:11], v[100:103]
    v_mfma_f32_16x16x32_bf16 v[104:107], v[44:47], v[8:11], v[104:107]
    ds_read_b128 v[32:35], v74 offset:7168
    v_mfma_f32_16x16x32_bf16 v[108:111], v[48:51], v[8:11], v[108:111]
    v_mfma_f32_16x16x32_bf16 v[112:115], v[36:39], v[12:15], v[112:115]
    v_mfma_f32_16x16x32_bf16 v[116:119], v[40:43], v[12:15], v[116:119]
    v_mfma_f32_16x16x32_bf16 v[120:123], v[44:47], v[12:15], v[120:123]
    v_mfma_f32_16x16x32_bf16 v[124:127], v[48:51], v[12:15], v[124:127]
    v_mfma_f32_16x16x32_bf16 v[128:131], v[36:39], v[16:19], v[128:131]
    v_mfma_f32_16x16x32_bf16 v[132:135], v[40:43], v[16:19], v[132:135]
    v_mfma_f32_16x16x32_bf16 v[136:139], v[44:47], v[16:19], v[136:139]
    v_mfma_f32_16x16x32_bf16 v[140:143], v[48:51], v[16:19], v[140:143]
    s_waitcnt vmcnt(0) lgkmcnt(0)
    s_barrier
    v_mfma_f32_16x16x32_bf16 v[144:147], v[36:39], v[20:23], v[144:147]
    v_add_u32 v74, s72, v72
    v_add_u32 v75, s72, v73
    v_mfma_f32_16x16x32_bf16 v[148:151], v[40:43], v[20:23], v[148:151]
    v_xor_b32 v76, 32, v75
    v_xor_b32 v77, 64, v75
    v_xor_b32 v78, 96, v75
    v_mfma_f32_16x16x32_bf16 v[152:155], v[44:47], v[20:23], v[152:155]
    s_add_u32 s72, s72, 32768
    s_and_b32 s72, s72, 0x1ffff
    v_mfma_f32_16x16x32_bf16 v[156:159], v[48:51], v[20:23], v[156:159]
    ds_read_b128 v[4:7], v74 offset:0
    v_mfma_f32_16x16x32_bf16 v[160:163], v[36:39], v[24:27], v[160:163]
    ds_read_b64_tr_b16 v[52:53], v75 offset:0
    v_mfma_f32_16x16x32_bf16 v[164:167], v[40:43], v[24:27], v[164:167]
    ds_read_b64_tr_b16 v[54:55], v75 offset:2048
    v_mfma_f32_16x16x32_bf16 v[168:171], v[44:47], v[24:27], v[168:171]
    ds_read_b64_tr_b16 v[56:57], v76 offset:0
    v_mfma_f32_16x16x32_bf16 v[172:175], v[48:51], v[24:27], v[172:175]
    ds_read_b64_tr_b16 v[58:59], v76 offset:2048
    v_mfma_f32_16x16x32_bf16 v[176:179], v[36:39], v[28:31], v[176:179]
    ds_read_b64_tr_b16 v[60:61], v77 offset:0
    v_mfma_f32_16x16x32_bf16 v[180:183], v[40:43], v[28:31], v[180:183]
    ds_read_b64_tr_b16 v[62:63], v77 offset:2048
    v_mfma_f32_16x16x32_bf16 v[184:187], v[44:47], v[28:31], v[184:187]
    ds_read_b64_tr_b16 v[64:65], v78 offset:0
    v_mfma_f32_16x16x32_bf16 v[188:191], v[48:51], v[28:31], v[188:191]
    ds_read_b64_tr_b16 v[66:67], v78 offset:2048
    v_mfma_f32_16x16x32_bf16 v[192:195], v[36:39], v[32:35], v[192:195]
    ds_read_b128 v[8:11], v74 offset:1024
    v_mfma_f32_16x16x32_bf16 v[196:199], v[40:43], v[32:35], v[196:199]
    ds_read_b128 v[12:15], v74 offset:2048
    v_mfma_f32_16x16x32_bf16 v[200:203], v[44:47], v[32:35], v[200:203]
    ds_read_b128 v[16:19], v74 offset:3072
    v_mfma_f32_16x16x32_bf16 v[204:207], v[48:51], v[32:35], v[204:207]
    s_waitcnt lgkmcnt(0)
    v_mfma_f32_16x16x32_bf16 v[80:83], v[52:55], v[4:7], v[80:83]
    ds_read_b128 v[20:23], v74 offset:4096
    v_mfma_f32_16x16x32_bf16 v[84:87], v[56:59], v[4:7], v[84:87]
    v_mfma_f32_16x16x32_bf16 v[88:91], v[60:63], v[4:7], v[88:91]
    ds_read_b128 v[24:27], v74 offset:5120
    v_mfma_f32_16x16x32_bf16 v[92:95], v[64:67], v[4:7], v[92:95]
    v_mfma_f32_16x16x32_bf16 v[96:99], v[52:55], v[8:11], v[96:99]
    ds_read_b128 v[28:31], v74 offset:6144
    v_mfma_f32_16x16x32_bf16 v[100:103], v[56:59], v[8:11], v[100:103]
    v_mfma_f32_16x16x32_bf16 v[104:107], v[60:63], v[8:11], v[104:107]
    ds_read_b128 v[32:35], v74 offset:7168
    v_mfma_f32_16x16x32_bf16 v[108:111], v[64:67], v[8:11], v[108:111]
    v_mfma_f32_16x16x32_bf16 v[112:115], v[52:55], v[12:15], v[112:115]
    v_mfma_f32_16x16x32_bf16 v[116:119], v[56:59], v[12:15], v[116:119]
    v_mfma_f32_16x16x32_bf16 v[120:123], v[60:63], v[12:15], v[120:123]
    v_mfma_f32_16x16x32_bf16 v[124:127], v[64:67], v[12:15], v[124:127]
    v_mfma_f32_16x16x32_bf16 v[128:131], v[52:55], v[16:19], v[128:131]
    v_mfma_f32_16x16x32_bf16 v[132:135], v[56:59], v[16:19], v[132:135]
    v_mfma_f32_16x16x32_bf16 v[136:139], v[60:63], v[16:19], v[136:139]
    v_mfma_f32_16x16x32_bf16 v[140:143], v[64:67], v[16:19], v[140:143]
    s_waitcnt lgkmcnt(0)
    v_mfma_f32_16x16x32_bf16 v[144:147], v[52:55], v[20:23], v[144:147]
    v_mfma_f32_16x16x32_bf16 v[148:151], v[56:59], v[20:23], v[148:151]
    v_mfma_f32_16x16x32_bf16 v[152:155], v[60:63], v[20:23], v[152:155]
    v_mfma_f32_16x16x32_bf16 v[156:159], v[64:67], v[20:23], v[156:159]
    v_mfma_f32_16x16x32_bf16 v[160:163], v[52:55], v[24:27], v[160:163]
    v_mfma_f32_16x16x32_bf16 v[164:167], v[56:59], v[24:27], v[164:167]
    v_mfma_f32_16x16x32_bf16 v[168:171], v[60:63], v[24:27], v[168:171]
    v_mfma_f32_16x16x32_bf16 v[172:175], v[64:67], v[24:27], v[172:175]
    v_mfma_f32_16x16x32_bf16 v[176:179], v[52:55], v[28:31], v[176:179]
    v_mfma_f32_16x16x32_bf16 v[180:183], v[56:59], v[28:31], v[180:183]
    v_mfma_f32_16x16x32_bf16 v[184:187], v[60:63], v[28:31], v[184:187]
    v_mfma_f32_16x16x32_bf16 v[188:191], v[64:67], v[28:31], v[188:191]
    v_mfma_f32_16x16x32_bf16 v[192:195], v[52:55], v[32:35], v[192:195]
    v_mfma_f32_16x16x32_bf16 v[196:199], v[56:59], v[32:35], v[196:199]
    v_mfma_f32_16x16x32_bf16 v[200:203], v[60:63], v[32:35], v[200:203]
    v_mfma_f32_16x16x32_bf16 v[204:207], v[64:67], v[32:35], v[204:207]
    v_cvt_pk_bf16_f32 v4, v80, v81
    v_cvt_pk_bf16_f32 v5, v82, v83
    v_cvt_pk_bf16_f32 v6, v84, v85
    v_cvt_pk_bf16_f32 v7, v86, v87
    buffer_store_dwordx4 v[4:7], v79, s[8:11], s81 offen offset:0 sc1
    v_cvt_pk_bf16_f32 v8, v96, v97
    v_cvt_pk_bf16_f32 v9, v98, v99
    v_cvt_pk_bf16_f32 v10, v100, v101
    v_cvt_pk_bf16_f32 v11, v102, v103
    buffer_store_dwordx4 v[8:11], v79, s[8:11], s81 offen offset:256 sc1
    v_cvt_pk_bf16_f32 v12, v88, v89
    v_cvt_pk_bf16_f32 v13, v90, v91
    v_cvt_pk_bf16_f32 v14, v92, v93
    v_cvt_pk_bf16_f32 v15, v94, v95
    buffer_store_dwordx4 v[12:15], v79, s[8:11], s81 offen offset:2048 sc1
    v_cvt_pk_bf16_f32 v16, v104, v105
    v_cvt_pk_bf16_f32 v17, v106, v107
    v_cvt_pk_bf16_f32 v18, v108, v109
    v_cvt_pk_bf16_f32 v19, v110, v111
    buffer_store_dwordx4 v[16:19], v79, s[8:11], s81 offen offset:2304 sc1
    s_add_u32 s81, s81, s82
    v_cvt_pk_bf16_f32 v20, v112, v113
    v_cvt_pk_bf16_f32 v21, v114, v115
    v_cvt_pk_bf16_f32 v22, v116, v117
    v_cvt_pk_bf16_f32 v23, v118, v119
    buffer_store_dwordx4 v[20:23], v79, s[8:11], s81 offen offset:0 sc1
    v_cvt_pk_bf16_f32 v24, v128, v129
    v_cvt_pk_bf16_f32 v25, v130, v131
    v_cvt_pk_bf16_f32 v26, v132, v133
    v_cvt_pk_bf16_f32 v27, v134, v135
    buffer_store_dwordx4 v[24:27], v79, s[8:11], s81 offen offset:256 sc1
    v_cvt_pk_bf16_f32 v28, v120, v121
    v_cvt_pk_bf16_f32 v29, v122, v123
    v_cvt_pk_bf16_f32 v30, v124, v125
    v_cvt_pk_bf16_f32 v31, v126, v127
    buffer_store_dwordx4 v[28:31], v79, s[8:11], s81 offen offset:2048 sc1
    v_cvt_pk_bf16_f32 v32, v136, v137
    v_cvt_pk_bf16_f32 v33, v138, v139
    v_cvt_pk_bf16_f32 v34, v140, v141
    v_cvt_pk_bf16_f32 v35, v142, v143
    buffer_store_dwordx4 v[32:35], v79, s[8:11], s81 offen offset:2304 sc1
    s_add_u32 s81, s81, s82
    v_cvt_pk_bf16_f32 v36, v144, v145
    v_cvt_pk_bf16_f32 v37, v146, v147
    v_cvt_pk_bf16_f32 v38, v148, v149
    v_cvt_pk_bf16_f32 v39, v150, v151
    buffer_store_dwordx4 v[36:39], v79, s[8:11], s81 offen offset:0 sc1
    v_cvt_pk_bf16_f32 v40, v160, v161
    v_cvt_pk_bf16_f32 v41, v162, v163
    v_cvt_pk_bf16_f32 v42, v164, v165
    v_cvt_pk_bf16_f32 v43, v166, v167
    buffer_store_dwordx4 v[40:43], v79, s[8:11], s81 offen offset:256 sc1
    v_cvt_pk_bf16_f32 v44, v152, v153
    v_cvt_pk_bf16_f32 v45, v154, v155
    v_cvt_pk_bf16_f32 v46, v156, v157
    v_cvt_pk_bf16_f32 v47, v158, v159
    buffer_store_dwordx4 v[44:47], v79, s[8:11], s81 offen offset:2048 sc1
    v_cvt_pk_bf16_f32 v48, v168, v169
    v_cvt_pk_bf16_f32 v49, v170, v171
    v_cvt_pk_bf16_f32 v50, v172, v173
    v_cvt_pk_bf16_f32 v51, v174, v175
    buffer_store_dwordx4 v[48:51], v79, s[8:11], s81 offen offset:2304 sc1
    s_add_u32 s81, s81, s82
    v_cvt_pk_bf16_f32 v52, v176, v177
    v_cvt_pk_bf16_f32 v53, v178, v179
    v_cvt_pk_bf16_f32 v54, v180, v181
    v_cvt_pk_bf16_f32 v55, v182, v183
    buffer_store_dwordx4 v[52:55], v79, s[8:11], s81 offen offset:0 sc1
    v_cvt_pk_bf16_f32 v56, v192, v193
    v_cvt_pk_bf16_f32 v57, v194, v195
    v_cvt_pk_bf16_f32 v58, v196, v197
    v_cvt_pk_bf16_f32 v59, v198, v199
    buffer_store_dwordx4 v[56:59], v79, s[8:11], s81 offen offset:256 sc1
    v_cvt_pk_bf16_f32 v60, v184, v185
    v_cvt_pk_bf16_f32 v61, v186, v187
    v_cvt_pk_bf16_f32 v62, v188, v189
    v_cvt_pk_bf16_f32 v63, v190, v191
    buffer_store_dwordx4 v[60:63], v79, s[8:11], s81 offen offset:2048 sc1
    v_cvt_pk_bf16_f32 v64, v200, v201
    v_cvt_pk_bf16_f32 v65, v202, v203
    v_cvt_pk_bf16_f32 v66, v204, v205
    v_cvt_pk_bf16_f32 v67, v206, v207
    buffer_store_dwordx4 v[64:67], v79, s[8:11], s81 offen offset:2304 sc1
    s_branch next_46
t256_45:
    s_mov_b32 s72, 0
    s_waitcnt vmcnt(12)
    s_barrier
    v_add_u32 v74, s72, v72
    v_add_u32 v75, s72, v73
    v_xor_b32 v76, 32, v75
    v_xor_b32 v77, 64, v75
    v_xor_b32 v78, 96, v75
    s_add_u32 s72, s72, 32768
    s_and_b32 s72, s72, 0x1ffff
    ds_read_b128 v[4:7], v74 offset:0
    ds_read_b128 v[8:11], v74 offset:1024
    ds_read_b128 v[12:15], v74 offset:2048
    ds_read_b128 v[16:19], v74 offset:3072
    ds_read_b64_tr_b16 v[36:37], v75 offset:0
    ds_read_b64_tr_b16 v[38:39], v75 offset:2048
    ds_read_b64_tr_b16 v[40:41], v76 offset:0
    ds_read_b64_tr_b16 v[42:43], v76 offset:2048
    ds_read_b64_tr_b16 v[44:45], v77 offset:0
    ds_read_b64_tr_b16 v[46:47], v77 offset:2048
    ds_read_b64_tr_b16 v[48:49], v78 offset:0
    ds_read_b64_tr_b16 v[50:51], v78 offset:2048
    s_waitcnt lgkmcnt(0)
    v_mfma_f32_16x16x32_bf16 v[80:83], v[4:7], v[36:39], 0
    ds_read_b128 v[20:23], v74 offset:4096
    v_mfma_f32_16x16x32_bf16 v[84:87], v[4:7], v[40:43], 0
    v_mfma_f32_16x16x32_bf16 v[88:91], v[4:7], v[44:47], 0
    ds_read_b128 v[24:27], v74 offset:5120
    v_mfma_f32_16x16x32_bf16 v[92:95], v[4:7], v[48:51], 0
    v_mfma_f32_16x16x32_bf16 v[96:99], v[8:11], v[36:39], 0
    ds_read_b128 v[28:31], v74 offset:6144
    v_mfma_f32_16x16x32_bf16 v[100:103], v[8:11], v[40:43], 0
    v_mfma_f32_16x16x32_bf16 v[104:107], v[8:11], v[44:47], 0
    ds_read_b128 v[32:35], v74 offset:7168
    v_mfma_f32_16x16x32_bf16 v[108:111], v[8:11], v[48:51], 0
    v_mfma_f32_16x16x32_bf16 v[112:115], v[12:15], v[36:39], 0
    v_mfma_f32_16x16x32_bf16 v[116:119], v[12:15], v[40:43], 0
    v_mfma_f32_16x16x32_bf16 v[120:123], v[12:15], v[44:47], 0
    v_mfma_f32_16x16x32_bf16 v[124:127], v[12:15], v[48:51], 0
    v_mfma_f32_16x16x32_bf16 v[128:131], v[16:19], v[36:39], 0
    v_mfma_f32_16x16x32_bf16 v[132:135], v[16:19], v[40:43], 0
    v_mfma_f32_16x16x32_bf16 v[136:139], v[16:19], v[44:47], 0
    v_mfma_f32_16x16x32_bf16 v[140:143], v[16:19], v[48:51], 0
    s_waitcnt vmcnt(8) lgkmcnt(0)
    s_barrier
    v_mfma_f32_16x16x32_bf16 v[144:147], v[20:23], v[36:39], 0
    v_add_u32 v74, s72, v72
    v_add_u32 v75, s72, v73
    v_xor_b32 v76, 32, v75
    v_xor_b32 v77, 64, v75
    v_xor_b32 v78, 96, v75
    v_mfma_f32_16x16x32_bf16 v[148:151], v[20:23], v[40:43], 0
    s_add_u32 s72, s72, 32768
    s_and_b32 s72, s72, 0x1ffff
    ds_read_b128 v[4:7], v74 offset:0
    v_mfma_f32_16x16x32_bf16 v[152:155], v[20:23], v[44:47], 0
    ds_read_b64_tr_b16 v[52:53], v75 offset:0
    v_mfma_f32_16x16x32_bf16 v[156:159], v[20:23], v[48:51], 0
    ds_read_b64_tr_b16 v[54:55], v75 offset:2048
    ds_read_b64_tr_b16 v[56:57], v76 offset:0
    v_mfma_f32_16x16x32_bf16 v[160:163], v[24:27], v[36:39], 0
    ds_read_b64_tr_b16 v[58:59], v76 offset:2048
    v_mfma_f32_16x16x32_bf16 v[164:167], v[24:27], v[40:43], 0
    ds_read_b64_tr_b16 v[60:61], v77 offset:0
    ds_read_b64_tr_b16 v[62:63], v77 offset:2048
    v_mfma_f32_16x16x32_bf16 v[168:171], v[24:27], v[44:47], 0
    ds_read_b64_tr_b16 v[64:65], v78 offset:0
    v_mfma_f32_16x16x32_bf16 v[172:175], v[24:27], v[48:51], 0
    ds_read_b64_tr_b16 v[66:67], v78 offset:2048
    ds_read_b128 v[8:11], v74 offset:1024
    v_mfma_f32_16x16x32_bf16 v[176:179], v[28:31], v[36:39], 0
    ds_read_b128 v[12:15], v74 offset:2048
    ds_read_b128 v[16:19], v74 offset:3072
    v_mfma_f32_16x16x32_bf16 v[180:183], v[28:31], v[40:43], 0
    s_mov_b32 m0, s71
    v_mfma_f32_16x16x32_bf16 v[184:187], v[28:31], v[44:47], 0
    buffer_load_dwordx4 v68, s[60:63], s68 offen lds
    s_add_u32 m0, s71, 1024
    v_mfma_f32_16x16x32_bf16 v[188:191], v[28:31], v[48:51], 0
    buffer_load_dwordx4 v69, s[60:63], s68 offen lds
    v_mfma_f32_16x16x32_bf16 v[192:195], v[32:35], v[36:39], 0
    s_add_u32 m0, s71, 16384
    s_nop 0
    buffer_load_dwordx4 v70, s[64:67], s69 offen lds
    v_mfma_f32_16x16x32_bf16 v[196:199], v[32:35], v[40:43], 0
    s_add_u32 m0, s71, 17408
    v_mfma_f32_16x16x32_bf16 v[200:203], v[32:35], v[44:47], 0
    buffer_load_dwordx4 v71, s[64:67], s69 offen lds
    s_add_u32 s68, s68, 64
    s_add_u32 s69, s69, s70
    v_mfma_f32_16x16x32_bf16 v[204:207], v[32:35], v[48:51], 0
    s_add_u32 s71, s71, 32768
    s_and_b32 s71, s71, 0x1ffff
    s_waitcnt lgkmcnt(0)
    v_mfma_f32_16x16x32_bf16 v[80:83], v[4:7], v[52:55], v[80:83]
    ds_read_b128 v[20:23], v74 offset:4096
    v_mfma_f32_16x16x32_bf16 v[84:87], v[4:7], v[56:59], v[84:87]
    v_mfma_f32_16x16x32_bf16 v[88:91], v[4:7], v[60:63], v[88:91]
    ds_read_b128 v[24:27], v74 offset:5120
    v_mfma_f32_16x16x32_bf16 v[92:95], v[4:7], v[64:67], v[92:95]
    v_mfma_f32_16x16x32_bf16 v[96:99], v[8:11], v[52:55], v[96:99]
    ds_read_b128 v[28:31], v74 offset:6144
    v_mfma_f32_16x16x32_bf16 v[100:103], v[8:11], v[56:59], v[100:103]
    v_mfma_f32_16x16x32_bf16 v[104:107], v[8:11], v[60:63], v[104:107]
    ds_read_b128 v[32:35], v74 offset:7168
    v_mfma_f32_16x16x32_bf16 v[108:111], v[8:11], v[64:67], v[108:111]
    v_mfma_f32_16x16x32_bf16 v[112:115], v[12:15], v[52:55], v[112:115]
    v_mfma_f32_16x16x32_bf16 v[116:119], v[12:15], v[56:59], v[116:119]
    v_mfma_f32_16x16x32_bf16 v[120:123], v[12:15], v[60:63], v[120:123]
    v_mfma_f32_16x16x32_bf16 v[124:127], v[12:15], v[64:67], v[124:127]
    v_mfma_f32_16x16x32_bf16 v[128:131], v[16:19], v[52:55], v[128:131]
    v_mfma_f32_16x16x32_bf16 v[132:135], v[16:19], v[56:59], v[132:135]
    v_mfma_f32_16x16x32_bf16 v[136:139], v[16:19], v[60:63], v[136:139]
    v_mfma_f32_16x16x32_bf16 v[140:143], v[16:19], v[64:67], v[140:143]
    s_waitcnt vmcnt(8) lgkmcnt(0)
    s_barrier
    v_mfma_f32_16x16x32_bf16 v[144:147], v[20:23], v[52:55], v[144:147]
    v_add_u32 v74, s72, v72
    v_add_u32 v75, s72, v73
    v_xor_b32 v76, 32, v75
    v_xor_b32 v77, 64, v75
    v_xor_b32 v78, 96, v75
    v_mfma_f32_16x16x32_bf16 v[148:151], v[20:23], v[56:59], v[148:151]
    s_add_u32 s72, s72, 32768
    s_and_b32 s72, s72, 0x1ffff
    ds_read_b128 v[4:7], v74 offset:0
    v_mfma_f32_16x16x32_bf16 v[152:155], v[20:23], v[60:63], v[152:155]
    ds_read_b64_tr_b16 v[36:37], v75 offset:0
    v_mfma_f32_16x16x32_bf16 v[156:159], v[20:23], v[64:67], v[156:159]
    ds_read_b64_tr_b16 v[38:39], v75 offset:2048
    ds_read_b64_tr_b16 v[40:41], v76 offset:0
    v_mfma_f32_16x16x32_bf16 v[160:163], v[24:27], v[52:55], v[160:163]
    ds_read_b64_tr_b16 v[42:43], v76 offset:2048
    v_mfma_f32_16x16x32_bf16 v[164:167], v[24:27], v[56:59], v[164:167]
    ds_read_b64_tr_b16 v[44:45], v77 offset:0
    ds_read_b64_tr_b16 v[46:47], v77 offset:2048
    v_mfma_f32_16x16x32_bf16 v[168:171], v[24:27], v[60:63], v[168:171]
    ds_read_b64_tr_b16 v[48:49], v78 offset:0
    v_mfma_f32_16x16x32_bf16 v[172:175], v[24:27], v[64:67], v[172:175]
    ds_read_b64_tr_b16 v[50:51], v78 offset:2048
    ds_read_b128 v[8:11], v74 offset:1024
    v_mfma_f32_16x16x32_bf16 v[176:179], v[28:31], v[52:55], v[176:179]
    ds_read_b128 v[12:15], v74 offset:2048
    ds_read_b128 v[16:19], v74 offset:3072
    v_mfma_f32_16x16x32_bf16 v[180:183], v[28:31], v[56:59], v[180:183]
    s_mov_b32 m0, s71
    v_mfma_f32_16x16x32_bf16 v[184:187], v[28:31], v[60:63], v[184:187]
    buffer_load_dwordx4 v68, s[60:63], s68 offen lds
    s_add_u32 m0, s71, 1024
    v_mfma_f32_16x16x32_bf16 v[188:191], v[28:31], v[64:67], v[188:191]
    buffer_load_dwordx4 v69, s[60:63], s68 offen lds
    v_mfma_f32_16x16x32_bf16 v[192:195], v[32:35], v[52:55], v[192:195]
    s_add_u32 m0, s71, 16384
    s_nop 0
    buffer_load_dwordx4 v70, s[64:67], s69 offen lds
    v_mfma_f32_16x16x32_bf16 v[196:199], v[32:35], v[56:59], v[196:199]
    s_add_u32 m0, s71, 17408
    v_mfma_f32_16x16x32_bf16 v[200:203], v[32:35], v[60:63], v[200:203]
    buffer_load_dwordx4 v71, s[64:67], s69 offen lds
    s_add_u32 s68, s68, 64
    s_add_u32 s69, s69, s70
    v_mfma_f32_16x16x32_bf16 v[204:207], v[32:35], v[64:67], v[204:207]
    s_add_u32 s71, s71, 32768
    s_and_b32 s71, s71, 0x1ffff
    s_mov_b32 s73, 13
gl_62:
    s_waitcnt lgkmcnt(0)
    v_mfma_f32_16x16x32_bf16 v[80:83], v[4:7], v[36:39], v[80:83]
    ds_read_b128 v[20:23], v74 offset:4096
    v_mfma_f32_16x16x32_bf16 v[84:87], v[4:7], v[40:43], v[84:87]
    v_mfma_f32_16x16x32_bf16 v[88:91], v[4:7], v[44:47], v[88:91]
    ds_read_b128 v[24:27], v74 offset:5120
    v_mfma_f32_16x16x32_bf16 v[92:95], v[4:7], v[48:51], v[92:95]
    v_mfma_f32_16x16x32_bf16 v[96:99], v[8:11], v[36:39], v[96:99]
    ds_read_b128 v[28:31], v74 offset:6144
    v_mfma_f32_16x16x32_bf16 v[100:103], v[8:11], v[40:43], v[100:103]
    v_mfma_f32_16x16x32_bf16 v[104:107], v[8:11], v[44:47], v[104:107]
    ds_read_b128 v[32:35], v74 offset:7168
    v_mfma_f32_16x16x32_bf16 v[108:111], v[8:11], v[48:51], v[108:111]
    v_mfma_f32_16x16x32_bf16 v[112:115], v[12:15], v[36:39], v[112:115]
    v_mfma_f32_16x16x32_bf16 v[116:119], v[12:15], v[40:43], v[116:119]
    v_mfma_f32_16x16x32_bf16 v[120:123], v[12:15], v[44:47], v[120:123]
    v_mfma_f32_16x16x32_bf16 v[124:127], v[12:15], v[48:51], v[124:127]
    v_mfma_f32_16x16x32_bf16 v[128:131], v[16:19], v[36:39], v[128:131]
    v_mfma_f32_16x16x32_bf16 v[132:135], v[16:19], v[40:43], v[132:135]
    v_mfma_f32_16x16x32_bf16 v[136:139], v[16:19], v[44:47], v[136:139]
    v_mfma_f32_16x16x32_bf16 v[140:143], v[16:19], v[48:51], v[140:143]
    s_waitcnt vmcnt(8) lgkmcnt(0)
    s_barrier
    v_mfma_f32_16x16x32_bf16 v[144:147], v[20:23], v[36:39], v[144:147]
    v_add_u32 v74, s72, v72
    v_add_u32 v75, s72, v73
    v_xor_b32 v76, 32, v75
    v_xor_b32 v77, 64, v75
    v_xor_b32 v78, 96, v75
    v_mfma_f32_16x16x32_bf16 v[148:151], v[20:23], v[40:43], v[148:151]
    s_add_u32 s72, s72, 32768
    s_and_b32 s72, s72, 0x1ffff
    ds_read_b128 v[4:7], v74 offset:0
    v_mfma_f32_16x16x32_bf16 v[152:155], v[20:23], v[44:47], v[152:155]
    ds_read_b64_tr_b16 v[52:53], v75 offset:0
    v_mfma_f32_16x16x32_bf16 v[156:159], v[20:23], v[48:51], v[156:159]
    ds_read_b64_tr_b16 v[54:55], v75 offset:2048
    ds_read_b64_tr_b16 v[56:57], v76 offset:0
    v_mfma_f32_16x16x32_bf16 v[160:163], v[24:27], v[36:39], v[160:163]
    ds_read_b64_tr_b16 v[58:59], v76 offset:2048
    v_mfma_f32_16x16x32_bf16 v[164:167], v[24:27], v[40:43], v[164:167]
    ds_read_b64_tr_b16 v[60:61], v77 offset:0
    ds_read_b64_tr_b16 v[62:63], v77 offset:2048
    v_mfma_f32_16x16x32_bf16 v[168:171], v[24:27], v[44:47], v[168:171]
    ds_read_b64_tr_b16 v[64:65], v78 offset:0
    v_mfma_f32_16x16x32_bf16 v[172:175], v[24:27], v[48:51], v[172:175]
    ds_read_b64_tr_b16 v[66:67], v78 offset:2048
    ds_read_b128 v[8:11], v74 offset:1024
    v_mfma_f32_16x16x32_bf16 v[176:179], v[28:31], v[36:39], v[176:179]
    ds_read_b128 v[12:15], v74 offset:2048
    ds_read_b128 v[16:19], v74 offset:3072
    v_mfma_f32_16x16x32_bf16 v[180:183], v[28:31], v[40:43], v[180:183]
    s_mov_b32 m0, s71
    v_mfma_f32_16x16x32_bf16 v[184:187], v[28:31], v[44:47], v[184:187]
    buffer_load_dwordx4 v68, s[60:63], s68 offen lds
    s_add_u32 m0, s71, 1024
    v_mfma_f32_16x16x32_bf16 v[188:191], v[28:31], v[48:51], v[188:191]
    buffer_load_dwordx4 v69, s[60:63], s68 offen lds
    v_mfma_f32_16x16x32_bf16 v[192:195], v[32:35], v[36:39], v[192:195]
    s_add_u32 m0, s71, 16384
    s_nop 0
    buffer_load_dwordx4 v70, s[64:67], s69 offen lds
    v_mfma_f32_16x16x32_bf16 v[196:199], v[32:35], v[40:43], v[196:199]
    s_add_u32 m0, s71, 17408
    v_mfma_f32_16x16x32_bf16 v[200:203], v[32:35], v[44:47], v[200:203]
    buffer_load_dwordx4 v71, s[64:67], s69 offen lds
    s_add_u32 s68, s68, 64
    s_add_u32 s69, s69, s70
    v_mfma_f32_16x16x32_bf16 v[204:207], v[32:35], v[48:51], v[204:207]
    s_add_u32 s71, s71, 32768
    s_and_b32 s71, s71, 0x1ffff
    s_waitcnt lgkmcnt(0)
    v_mfma_f32_16x16x32_bf16 v[80:83], v[4:7], v[52:55], v[80:83]
    ds_read_b128 v[20:23], v74 offset:4096
    v_mfma_f32_16x16x32_bf16 v[84:87], v[4:7], v[56:59], v[84:87]
    v_mfma_f32_16x16x32_bf16 v[88:91], v[4:7], v[60:63], v[88:91]
    ds_read_b128 v[24:27], v74 offset:5120
    v_mfma_f32_16x16x32_bf16 v[92:95], v[4:7], v[64:67], v[92:95]
    v_mfma_f32_16x16x32_bf16 v[96:99], v[8:11], v[52:55], v[96:99]
    ds_read_b128 v[28:31], v74 offset:6144
    v_mfma_f32_16x16x32_bf16 v[100:103], v[8:11], v[56:59], v[100:103]
    v_mfma_f32_16x16x32_bf16 v[104:107], v[8:11], v[60:63], v[104:107]
    ds_read_b128 v[32:35], v74 offset:7168
    v_mfma_f32_16x16x32_bf16 v[108:111], v[8:11], v[64:67], v[108:111]
    v_mfma_f32_16x16x32_bf16 v[112:115], v[12:15], v[52:55], v[112:115]
    v_mfma_f32_16x16x32_bf16 v[116:119], v[12:15], v[56:59], v[116:119]
    v_mfma_f32_16x16x32_bf16 v[120:123], v[12:15], v[60:63], v[120:123]
    v_mfma_f32_16x16x32_bf16 v[124:127], v[12:15], v[64:67], v[124:127]
    v_mfma_f32_16x16x32_bf16 v[128:131], v[16:19], v[52:55], v[128:131]
    v_mfma_f32_16x16x32_bf16 v[132:135], v[16:19], v[56:59], v[132:135]
    v_mfma_f32_16x16x32_bf16 v[136:139], v[16:19], v[60:63], v[136:139]
    v_mfma_f32_16x16x32_bf16 v[140:143], v[16:19], v[64:67], v[140:143]
    s_waitcnt vmcnt(8) lgkmcnt(0)
    s_barrier
    v_mfma_f32_16x16x32_bf16 v[144:147], v[20:23], v[52:55], v[144:147]
    v_add_u32 v74, s72, v72
    v_add_u32 v75, s72, v73
    v_xor_b32 v76, 32, v75
    v_xor_b32 v77, 64, v75
    v_xor_b32 v78, 96, v75
    v_mfma_f32_16x16x32_bf16 v[148:151], v[20:23], v[56:59], v[148:151]
    s_add_u32 s72, s72, 32768
    s_and_b32 s72, s72, 0x1ffff
    ds_read_b128 v[4:7], v74 offset:0
    v_mfma_f32_16x16x32_bf16 v[152:155], v[20:23], v[60:63], v[152:155]
    ds_read_b64_tr_b16 v[36:37], v75 offset:0
    v_mfma_f32_16x16x32_bf16 v[156:159], v[20:23], v[64:67], v[156:159]
    ds_read_b64_tr_b16 v[38:39], v75 offset:2048
    ds_read_b64_tr_b16 v[40:41], v76 offset:0
    v_mfma_f32_16x16x32_bf16 v[160:163], v[24:27], v[52:55], v[160:163]
    ds_read_b64_tr_b16 v[42:43], v76 offset:2048
    v_mfma_f32_16x16x32_bf16 v[164:167], v[24:27], v[56:59], v[164:167]
    ds_read_b64_tr_b16 v[44:45], v77 offset:0
    ds_read_b64_tr_b16 v[46:47], v77 offset:2048
    v_mfma_f32_16x16x32_bf16 v[168:171], v[24:27], v[60:63], v[168:171]
    ds_read_b64_tr_b16 v[48:49], v78 offset:0
    v_mfma_f32_16x16x32_bf16 v[172:175], v[24:27], v[64:67], v[172:175]
    ds_read_b64_tr_b16 v[50:51], v78 offset:2048
    ds_read_b128 v[8:11], v74 offset:1024
    v_mfma_f32_16x16x32_bf16 v[176:179], v[28:31], v[52:55], v[176:179]
    ds_read_b128 v[12:15], v74 offset:2048
    ds_read_b128 v[16:19], v74 offset:3072
    v_mfma_f32_16x16x32_bf16 v[180:183], v[28:31], v[56:59], v[180:183]
    s_mov_b32 m0, s71
    v_mfma_f32_16x16x32_bf16 v[184:187], v[28:31], v[60:63], v[184:187]
    buffer_load_dwordx4 v68, s[60:63], s68 offen lds
    s_add_u32 m0, s71, 1024
    v_mfma_f32_16x16x32_bf16 v[188:191], v[28:31], v[64:67], v[188:191]
    buffer_load_dwordx4 v69, s[60:63], s68 offen lds
    v_mfma_f32_16x16x32_bf16 v[192:195], v[32:35], v[52:55], v[192:195]
    s_add_u32 m0, s71, 16384
    s_nop 0
    buffer_load_dwordx4 v70, s[64:67], s69 offen lds
    v_mfma_f32_16x16x32_bf16 v[196:199], v[32:35], v[56:59], v[196:199]
    s_add_u32 m0, s71, 17408
    v_mfma_f32_16x16x32_bf16 v[200:203], v[32:35], v[60:63], v[200:203]
    buffer_load_dwordx4 v71, s[64:67], s69 offen lds
    s_add_u32 s68, s68, 64
    s_add_u32 s69, s69, s70
    v_mfma_f32_16x16x32_bf16 v[204:207], v[32:35], v[64:67], v[204:207]
    s_add_u32 s71, s71, 32768
    s_and_b32 s71, s71, 0x1ffff
    s_sub_u32 s73, s73, 1
    s_cmp_lg_u32 s73, 0
    s_cbranch_scc1 gl_62
    s_waitcnt lgkmcnt(0)
    v_mfma_f32_16x16x32_bf16 v[80:83], v[4:7], v[36:39], v[80:83]
    ds_read_b128 v[20:23], v74 offset:4096
    v_mfma_f32_16x16x32_bf16 v[84:87], v[4:7], v[40:43], v[84:87]
    v_mfma_f32_16x16x32_bf16 v[88:91], v[4:7], v[44:47], v[88:91]
    ds_read_b128 v[24:27], v74 offset:5120
    v_mfma_f32_16x16x32_bf16 v[92:95], v[4:7], v[48:51], v[92:95]
    v_mfma_f32_16x16x32_bf16 v[96:99], v[8:11], v[36:39], v[96:99]
    ds_read_b128 v[28:31], v74 offset:6144
    v_mfma_f32_16x16x32_bf16 v[100:103], v[8:11], v[40:43], v[100:103]
    v_mfma_f32_16x16x32_bf16 v[104:107], v[8:11], v[44:47], v[104:107]
    ds_read_b128 v[32:35], v74 offset:7168
    v_mfma_f32_16x16x32_bf16 v[108:111], v[8:11], v[48:51], v[108:111]
    v_mfma_f32_16x16x32_bf16 v[112:115], v[12:15], v[36:39], v[112:115]
    v_mfma_f32_16x16x32_bf16 v[116:119], v[12:15], v[40:43], v[116:119]
    v_mfma_f32_16x16x32_bf16 v[120:123], v[12:15], v[44:47], v[120:123]
    v_mfma_f32_16x16x32_bf16 v[124:127], v[12:15], v[48:51], v[124:127]
    v_mfma_f32_16x16x32_bf16 v[128:131], v[16:19], v[36:39], v[128:131]
    v_mfma_f32_16x16x32_bf16 v[132:135], v[16:19], v[40:43], v[132:135]
    v_mfma_f32_16x16x32_bf16 v[136:139], v[16:19], v[44:47], v[136:139]
    v_mfma_f32_16x16x32_bf16 v[140:143], v[16:19], v[48:51], v[140:143]
    s_waitcnt vmcnt(8) lgkmcnt(0)
    s_barrier
    v_mfma_f32_16x16x32_bf16 v[144:147], v[20:23], v[36:39], v[144:147]
    v_add_u32 v74, s72, v72
    v_add_u32 v75, s72, v73
    v_mfma_f32_16x16x32_bf16 v[148:151], v[20:23], v[40:43], v[148:151]
    v_xor_b32 v76, 32, v75
    v_xor_b32 v77, 64, v75
    v_xor_b32 v78, 96, v75
    v_mfma_f32_16x16x32_bf16 v[152:155], v[20:23], v[44:47], v[152:155]
    s_add_u32 s72, s72, 32768
    s_and_b32 s72, s72, 0x1ffff
    v_mfma_f32_16x16x32_bf16 v[156:159], v[20:23], v[48:51], v[156:159]
    ds_read_b128 v[4:7], v74 offset:0
    v_mfma_f32_16x16x32_bf16 v[160:163], v[24:27], v[36:39], v[160:163]
    ds_read_b64_tr_b16 v[52:53], v75 offset:0
    v_mfma_f32_16x16x32_bf16 v[164:167], v[24:27], v[40:43], v[164:167]
    ds_read_b64_tr_b16 v[54:55], v75 offset:2048
    v_mfma_f32_16x16x32_bf16 v[168:171], v[24:27], v[44:47], v[168:171]
    ds_read_b64_tr_b16 v[56:57], v76 offset:0
    v_mfma_f32_16x16x32_bf16 v[172:175], v[24:27], v[48:51], v[172:175]
    ds_read_b64_tr_b16 v[58:59], v76 offset:2048
    v_mfma_f32_16x16x32_bf16 v[176:179], v[28:31], v[36:39], v[176:179]
    ds_read_b64_tr_b16 v[60:61], v77 offset:0
    v_mfma_f32_16x16x32_bf16 v[180:183], v[28:31], v[40:43], v[180:183]
    ds_read_b64_tr_b16 v[62:63], v77 offset:2048
    v_mfma_f32_16x16x32_bf16 v[184:187], v[28:31], v[44:47], v[184:187]
    ds_read_b64_tr_b16 v[64:65], v78 offset:0
    v_mfma_f32_16x16x32_bf16 v[188:191], v[28:31], v[48:51], v[188:191]
    ds_read_b64_tr_b16 v[66:67], v78 offset:2048
    v_mfma_f32_16x16x32_bf16 v[192:195], v[32:35], v[36:39], v[192:195]
    ds_read_b128 v[8:11], v74 offset:1024
    v_mfma_f32_16x16x32_bf16 v[196:199], v[32:35], v[40:43], v[196:199]
    ds_read_b128 v[12:15], v74 offset:2048
    v_mfma_f32_16x16x32_bf16 v[200:203], v[32:35], v[44:47], v[200:203]
    ds_read_b128 v[16:19], v74 offset:3072
    v_mfma_f32_16x16x32_bf16 v[204:207], v[32:35], v[48:51], v[204:207]
    s_waitcnt lgkmcnt(0)
    v_mfma_f32_16x16x32_bf16 v[80:83], v[4:7], v[52:55], v[80:83]
    ds_read_b128 v[20:23], v74 offset:4096
    v_mfma_f32_16x16x32_bf16 v[84:87], v[4:7], v[56:59], v[84:87]
    v_mfma_f32_16x16x32_bf16 v[88:91], v[4:7], v[60:63], v[88:91]
    ds_read_b128 v[24:27], v74 offset:5120
    v_mfma_f32_16x16x32_bf16 v[92:95], v[4:7], v[64:67], v[92:95]
    v_mfma_f32_16x16x32_bf16 v[96:99], v[8:11], v[52:55], v[96:99]
    ds_read_b128 v[28:31], v74 offset:6144
    v_mfma_f32_16x16x32_bf16 v[100:103], v[8:11], v[56:59], v[100:103]
    v_mfma_f32_16x16x32_bf16 v[104:107], v[8:11], v[60:63], v[104:107]
    ds_read_b128 v[32:35], v74 offset:7168
    v_mfma_f32_16x16x32_bf16 v[108:111], v[8:11], v[64:67], v[108:111]
    v_mfma_f32_16x16x32_bf16 v[112:115], v[12:15], v[52:55], v[112:115]
    v_mfma_f32_16x16x32_bf16 v[116:119], v[12:15], v[56:59], v[116:119]
    v_mfma_f32_16x16x32_bf16 v[120:123], v[12:15], v[60:63], v[120:123]
    v_mfma_f32_16x16x32_bf16 v[124:127], v[12:15], v[64:67], v[124:127]
    v_mfma_f32_16x16x32_bf16 v[128:131], v[16:19], v[52:55], v[128:131]
    v_mfma_f32_16x16x32_bf16 v[132:135], v[16:19], v[56:59], v[132:135]
    v_mfma_f32_16x16x32_bf16 v[136:139], v[16:19], v[60:63], v[136:139]
    v_mfma_f32_16x16x32_bf16 v[140:143], v[16:19], v[64:67], v[140:143]
    s_waitcnt vmcnt(4) lgkmcnt(0)
    s_barrier
    v_mfma_f32_16x16x32_bf16 v[144:147], v[20:23], v[52:55], v[144:147]
    v_add_u32 v74, s72, v72
    v_add_u32 v75, s72, v73
    v_mfma_f32_16x16x32_bf16 v[148:151], v[20:23], v[56:59], v[148:151]
    v_xor_b32 v76, 32, v75
    v_xor_b32 v77, 64, v75
    v_xor_b32 v78, 96, v75
    v_mfma_f32_16x16x32_bf16 v[152:155], v[20:23], v[60:63], v[152:155]
    s_add_u32 s72, s72, 32768
    s_and_b32 s72, s72, 0x1ffff
    v_mfma_f32_16x16x32_bf16 v[156:159], v[20:23], v[64:67], v[156:159]
    ds_read_b128 v[4:7], v74 offset:0
    v_mfma_f32_16x16x32_bf16 v[160:163], v[24:27], v[52:55], v[160:163]
    ds_read_b64_tr_b16 v[36:37], v75 offset:0
    v_mfma_f32_16x16x32_bf16 v[164:167], v[24:27], v[56:59], v[164:167]
    ds_read_b64_tr_b16 v[38:39], v75 offset:2048
    v_mfma_f32_16x16x32_bf16 v[168:171], v[24:27], v[60:63], v[168:171]
    ds_read_b64_tr_b16 v[40:41], v76 offset:0
    v_mfma_f32_16x16x32_bf16 v[172:175], v[24:27], v[64:67], v[172:175]
    ds_read_b64_tr_b16 v[42:43], v76 offset:2048
    v_mfma_f32_16x16x32_bf16 v[176:179], v[28:31], v[52:55], v[176:179]
    ds_read_b64_tr_b16 v[44:45], v77 offset:0
    v_mfma_f32_16x16x32_bf16 v[180:183], v[28:31], v[56:59], v[180:183]
    ds_read_b64_tr_b16 v[46:47], v77 offset:2048
    v_mfma_f32_16x16x32_bf16 v[184:187], v[28:31], v[60:63], v[184:187]
    ds_read_b64_tr_b16 v[48:49], v78 offset:0
    v_mfma_f32_16x16x32_bf16 v[188:191], v[28:31], v[64:67], v[188:191]
    ds_read_b64_tr_b16 v[50:51], v78 offset:2048
    v_mfma_f32_16x16x32_bf16 v[192:195], v[32:35], v[52:55], v[192:195]
    ds_read_b128 v[8:11], v74 offset:1024
    v_mfma_f32_16x16x32_bf16 v[196:199], v[32:35], v[56:59], v[196:199]
    ds_read_b128 v[12:15], v74 offset:2048
    v_mfma_f32_16x16x32_bf16 v[200:203], v[32:35], v[60:63], v[200:203]
    ds_read_b128 v[16:19], v74 offset:3072
    v_mfma_f32_16x16x32_bf16 v[204:207], v[32:35], v[64:67], v[204:207]
    s_waitcnt lgkmcnt(0)
    v_mfma_f32_16x16x32_bf16 v[80:83], v[4:7], v[36:39], v[80:83]
    ds_read_b128 v[20:23], v74 offset:4096
    v_mfma_f32_16x16x32_bf16 v[84:87], v[4:7], v[40:43], v[84:87]
    v_mfma_f32_16x16x32_bf16 v[88:91], v[4:7], v[44:47], v[88:91]
    ds_read_b128 v[24:27], v74 offset:5120
    v_mfma_f32_16x16x32_bf16 v[92:95], v[4:7], v[48:51], v[92:95]
    v_mfma_f32_16x16x32_bf16 v[96:99], v[8:11], v[36:39], v[96:99]
    ds_read_b128 v[28:31], v74 offset:6144
    v_mfma_f32_16x16x32_bf16 v[100:103], v[8:11], v[40:43], v[100:103]
    v_mfma_f32_16x16x32_bf16 v[104:107], v[8:11], v[44:47], v[104:107]
    ds_read_b128 v[32:35], v74 offset:7168
    v_mfma_f32_16x16x32_bf16 v[108:111], v[8:11], v[48:51], v[108:111]
    v_mfma_f32_16x16x32_bf16 v[112:115], v[12:15], v[36:39], v[112:115]
    v_mfma_f32_16x16x32_bf16 v[116:119], v[12:15], v[40:43], v[116:119]
    v_mfma_f32_16x16x32_bf16 v[120:123], v[12:15], v[44:47], v[120:123]
    v_mfma_f32_16x16x32_bf16 v[124:127], v[12:15], v[48:51], v[124:127]
    v_mfma_f32_16x16x32_bf16 v[128:131], v[16:19], v[36:39], v[128:131]
    v_mfma_f32_16x16x32_bf16 v[132:135], v[16:19], v[40:43], v[132:135]
    v_mfma_f32_16x16x32_bf16 v[136:139], v[16:19], v[44:47], v[136:139]
    v_mfma_f32_16x16x32_bf16 v[140:143], v[16:19], v[48:51], v[140:143]
    s_waitcnt vmcnt(0) lgkmcnt(0)
    s_barrier
    v_mfma_f32_16x16x32_bf16 v[144:147], v[20:23], v[36:39], v[144:147]
    v_add_u32 v74, s72, v72
    v_add_u32 v75, s72, v73
    v_mfma_f32_16x16x32_bf16 v[148:151], v[20:23], v[40:43], v[148:151]
    v_xor_b32 v76, 32, v75
    v_xor_b32 v77, 64, v75
    v_xor_b32 v78, 96, v75
    v_mfma_f32_16x16x32_bf16 v[152:155], v[20:23], v[44:47], v[152:155]
    s_add_u32 s72, s72, 32768
    s_and_b32 s72, s72, 0x1ffff
    v_mfma_f32_16x16x32_bf16 v[156:159], v[20:23], v[48:51], v[156:159]
    ds_read_b128 v[4:7], v74 offset:0
    v_mfma_f32_16x16x32_bf16 v[160:163], v[24:27], v[36:39], v[160:163]
    ds_read_b64_tr_b16 v[52:53], v75 offset:0
    v_mfma_f32_16x16x32_bf16 v[164:167], v[24:27], v[40:43], v[164:167]
    ds_read_b64_tr_b16 v[54:55], v75 offset:2048
    v_mfma_f32_16x16x32_bf16 v[168:171], v[24:27], v[44:47], v[168:171]
    ds_read_b64_tr_b16 v[56:57], v76 offset:0
    v_mfma_f32_16x16x32_bf16 v[172:175], v[24:27], v[48:51], v[172:175]
    ds_read_b64_tr_b16 v[58:59], v76 offset:2048
    v_mfma_f32_16x16x32_bf16 v[176:179], v[28:31], v[36:39], v[176:179]
    ds_read_b64_tr_b16 v[60:61], v77 offset:0
    v_mfma_f32_16x16x32_bf16 v[180:183], v[28:31], v[40:43], v[180:183]
    ds_read_b64_tr_b16 v[62:63], v77 offset:2048
    v_mfma_f32_16x16x32_bf16 v[184:187], v[28:31], v[44:47], v[184:187]
    ds_read_b64_tr_b16 v[64:65], v78 offset:0
    v_mfma_f32_16x16x32_bf16 v[188:191], v[28:31], v[48:51], v[188:191]
    ds_read_b64_tr_b16 v[66:67], v78 offset:2048
    v_mfma_f32_16x16x32_bf16 v[192:195], v[32:35], v[36:39], v[192:195]
    ds_read_b128 v[8:11], v74 offset:1024
    v_mfma_f32_16x16x32_bf16 v[196:199], v[32:35], v[40:43], v[196:199]
    ds_read_b128 v[12:15], v74 offset:2048
    v_mfma_f32_16x16x32_bf16 v[200:203], v[32:35], v[44:47], v[200:203]
    ds_read_b128 v[16:19], v74 offset:3072
    v_mfma_f32_16x16x32_bf16 v[204:207], v[32:35], v[48:51], v[204:207]
    s_waitcnt lgkmcnt(0)
    v_mfma_f32_16x16x32_bf16 v[80:83], v[4:7], v[52:55], v[80:83]
    ds_read_b128 v[20:23], v74 offset:4096
    v_mfma_f32_16x16x32_bf16 v[84:87], v[4:7], v[56:59], v[84:87]
    v_mfma_f32_16x16x32_bf16 v[88:91], v[4:7], v[60:63], v[88:91]
    ds_read_b128 v[24:27], v74 offset:5120
    v_mfma_f32_16x16x32_bf16 v[92:95], v[4:7], v[64:67], v[92:95]
    v_mfma_f32_16x16x32_bf16 v[96:99], v[8:11], v[52:55], v[96:99]
    ds_read_b128 v[28:31], v74 offset:6144
    v_mfma_f32_16x16x32_bf16 v[100:103], v[8:11], v[56:59], v[100:103]
    v_mfma_f32_16x16x32_bf16 v[104:107], v[8:11], v[60:63], v[104:107]
    ds_read_b128 v[32:35], v74 offset:7168
    v_mfma_f32_16x16x32_bf16 v[108:111], v[8:11], v[64:67], v[108:111]
    v_mfma_f32_16x16x32_bf16 v[112:115], v[12:15], v[52:55], v[112:115]
    v_mfma_f32_16x16x32_bf16 v[116:119], v[12:15], v[56:59], v[116:119]
    v_mfma_f32_16x16x32_bf16 v[120:123], v[12:15], v[60:63], v[120:123]
    v_mfma_f32_16x16x32_bf16 v[124:127], v[12:15], v[64:67], v[124:127]
    v_mfma_f32_16x16x32_bf16 v[128:131], v[16:19], v[52:55], v[128:131]
    v_mfma_f32_16x16x32_bf16 v[132:135], v[16:19], v[56:59], v[132:135]
    v_mfma_f32_16x16x32_bf16 v[136:139], v[16:19], v[60:63], v[136:139]
    v_mfma_f32_16x16x32_bf16 v[140:143], v[16:19], v[64:67], v[140:143]
    s_waitcnt lgkmcnt(0)
    v_mfma_f32_16x16x32_bf16 v[144:147], v[20:23], v[52:55], v[144:147]
    v_mfma_f32_16x16x32_bf16 v[148:151], v[20:23], v[56:59], v[148:151]
    v_mfma_f32_16x16x32_bf16 v[152:155], v[20:23], v[60:63], v[152:155]
    v_mfma_f32_16x16x32_bf16 v[156:159], v[20:23], v[64:67], v[156:159]
    v_mfma_f32_16x16x32_bf16 v[160:163], v[24:27], v[52:55], v[160:163]
    v_mfma_f32_16x16x32_bf16 v[164:167], v[24:27], v[56:59], v[164:167]
    v_mfma_f32_16x16x32_bf16 v[168:171], v[24:27], v[60:63], v[168:171]
    v_mfma_f32_16x16x32_bf16 v[172:175], v[24:27], v[64:67], v[172:175]
    v_mfma_f32_16x16x32_bf16 v[176:179], v[28:31], v[52:55], v[176:179]
    v_mfma_f32_16x16x32_bf16 v[180:183], v[28:31], v[56:59], v[180:183]
    v_mfma_f32_16x16x32_bf16 v[184:187], v[28:31], v[60:63], v[184:187]
    v_mfma_f32_16x16x32_bf16 v[188:191], v[28:31], v[64:67], v[188:191]
    v_mfma_f32_16x16x32_bf16 v[192:195], v[32:35], v[52:55], v[192:195]
    v_mfma_f32_16x16x32_bf16 v[196:199], v[32:35], v[56:59], v[196:199]
    v_mfma_f32_16x16x32_bf16 v[200:203], v[32:35], v[60:63], v[200:203]
    v_mfma_f32_16x16x32_bf16 v[204:207], v[32:35], v[64:67], v[204:207]
    s_cmp_eq_u32 s84, 0
    s_cbranch_scc1 p3e_48
    v_cvt_pk_bf16_f32 v4, v80, v81
    v_cvt_pk_bf16_f32 v5, v82, v83
    v_cvt_pk_bf16_f32 v6, v96, v97
    v_cvt_pk_bf16_f32 v7, v98, v99
    buffer_store_dwordx4 v[4:7], v79, s[8:11], s81 offen offset:0 sc1
    v_cvt_pk_bf16_f32 v8, v84, v85
    v_cvt_pk_bf16_f32 v9, v86, v87
    v_cvt_pk_bf16_f32 v10, v100, v101
    v_cvt_pk_bf16_f32 v11, v102, v103
    buffer_store_dwordx4 v[8:11], v79, s[8:11], s81 offen offset:256 sc1
    v_cvt_pk_bf16_f32 v12, v88, v89
    v_cvt_pk_bf16_f32 v13, v90, v91
    v_cvt_pk_bf16_f32 v14, v104, v105
    v_cvt_pk_bf16_f32 v15, v106, v107
    buffer_store_dwordx4 v[12:15], v79, s[8:11], s81 offen offset:2048 sc1
    v_cvt_pk_bf16_f32 v16, v92, v93
    v_cvt_pk_bf16_f32 v17, v94, v95
    v_cvt_pk_bf16_f32 v18, v108, v109
    v_cvt_pk_bf16_f32 v19, v110, v111
    buffer_store_dwordx4 v[16:19], v79, s[8:11], s81 offen offset:2304 sc1
    s_add_u32 s81, s81, s82
    v_cvt_pk_bf16_f32 v20, v112, v113
    v_cvt_pk_bf16_f32 v21, v114, v115
    v_cvt_pk_bf16_f32 v22, v128, v129
    v_cvt_pk_bf16_f32 v23, v130, v131
    buffer_store_dwordx4 v[20:23], v79, s[8:11], s81 offen offset:0 sc1
    v_cvt_pk_bf16_f32 v24, v116, v117
    v_cvt_pk_bf16_f32 v25, v118, v119
    v_cvt_pk_bf16_f32 v26, v132, v133
    v_cvt_pk_bf16_f32 v27, v134, v135
    buffer_store_dwordx4 v[24:27], v79, s[8:11], s81 offen offset:256 sc1
    v_cvt_pk_bf16_f32 v28, v120, v121
    v_cvt_pk_bf16_f32 v29, v122, v123
    v_cvt_pk_bf16_f32 v30, v136, v137
    v_cvt_pk_bf16_f32 v31, v138, v139
    buffer_store_dwordx4 v[28:31], v79, s[8:11], s81 offen offset:2048 sc1
    v_cvt_pk_bf16_f32 v32, v124, v125
    v_cvt_pk_bf16_f32 v33, v126, v127
    v_cvt_pk_bf16_f32 v34, v140, v141
    v_cvt_pk_bf16_f32 v35, v142, v143
    buffer_store_dwordx4 v[32:35], v79, s[8:11], s81 offen offset:2304 sc1
    s_add_u32 s81, s81, s82
    v_cvt_pk_bf16_f32 v36, v144, v145
    v_cvt_pk_bf16_f32 v37, v146, v147
    v_cvt_pk_bf16_f32 v38, v160, v161
    v_cvt_pk_bf16_f32 v39, v162, v163
    buffer_store_dwordx4 v[36:39], v79, s[8:11], s81 offen offset:0 sc1
    v_cvt_pk_bf16_f32 v40, v148, v149
    v_cvt_pk_bf16_f32 v41, v150, v151
    v_cvt_pk_bf16_f32 v42, v164, v165
    v_cvt_pk_bf16_f32 v43, v166, v167
    buffer_store_dwordx4 v[40:43], v79, s[8:11], s81 offen offset:256 sc1
    v_cvt_pk_bf16_f32 v44, v152, v153
    v_cvt_pk_bf16_f32 v45, v154, v155
    v_cvt_pk_bf16_f32 v46, v168, v169
    v_cvt_pk_bf16_f32 v47, v170, v171
    buffer_store_dwordx4 v[44:47], v79, s[8:11], s81 offen offset:2048 sc1
    v_cvt_pk_bf16_f32 v48, v156, v157
    v_cvt_pk_bf16_f32 v49, v158, v159
    v_cvt_pk_bf16_f32 v50, v172, v173
    v_cvt_pk_bf16_f32 v51, v174, v175
    buffer_store_dwordx4 v[48:51], v79, s[8:11], s81 offen offset:2304 sc1
    s_add_u32 s81, s81, s82
    v_cvt_pk_bf16_f32 v52, v176, v177
    v_cvt_pk_bf16_f32 v53, v178, v179
    v_cvt_pk_bf16_f32 v54, v192, v193
    v_cvt_pk_bf16_f32 v55, v194, v195
    buffer_store_dwordx4 v[52:55], v79, s[8:11], s81 offen offset:0 sc1
    v_cvt_pk_bf16_f32 v56, v180, v181
    v_cvt_pk_bf16_f32 v57, v182, v183
    v_cvt_pk_bf16_f32 v58, v196, v197
    v_cvt_pk_bf16_f32 v59, v198, v199
    buffer_store_dwordx4 v[56:59], v79, s[8:11], s81 offen offset:256 sc1
    v_cvt_pk_bf16_f32 v60, v184, v185
    v_cvt_pk_bf16_f32 v61, v186, v187
    v_cvt_pk_bf16_f32 v62, v200, v201
    v_cvt_pk_bf16_f32 v63, v202, v203
    buffer_store_dwordx4 v[60:63], v79, s[8:11], s81 offen offset:2048 sc1
    v_cvt_pk_bf16_f32 v64, v188, v189
    v_cvt_pk_bf16_f32 v65, v190, v191
    v_cvt_pk_bf16_f32 v66, v204, v205
    v_cvt_pk_bf16_f32 v67, v206, v207
    buffer_store_dwordx4 v[64:67], v79, s[8:11], s81 offen offset:2304 sc1
next_46:
    s_waitcnt vmcnt(0) lgkmcnt(0)
    s_barrier
    s_cmp_lg_u32 s58, 0
    s_cbranch_scc1 sig_63
    v_mov_b32 v75, 0x5ffffff0
    v_mov_b32 v76, s83
    v_cmp_eq_u32 vcc, 0, v1
    s_nop 1
    v_cndmask_b32 v76, v75, v76, vcc
    v_mov_b32 v75, s84
    buffer_atomic_add v75, v76, s[12:15], 0 offen sc1
sig_63:
    s_add_u32 s78, s78, 1
    v_bfe_u32 v79, v1, 0, 4
    v_lshlrev_b32 v79, 4, v79
    v_bfe_u32 v75, v1, 4, 2
    v_lshl_or_b32 v79, v75, 9, v79
    v_bfe_u32 v76, v1, 2, 2
    v_sub_u32 v76, 0, v76
    v_lshrrev_b32 v75, 4, v1
    v_xor_b32 v76, v76, v75
    v_and_b32 v76, 3, v76
    v_bfe_u32 v72, v1, 0, 4
    v_lshlrev_b32 v72, 6, v72
    v_lshl_or_b32 v72, v76, 4, v72
    s_lshr_b32 s74, s58, 2
    s_mul_i32 s74, s74, 8192
    v_add_u32 v72, s74, v72
    v_bfe_u32 v73, v1, 0, 2
    v_lshlrev_b32 v73, 3, v73
    v_bfe_u32 v75, v1, 4, 1
    v_lshl_or_b32 v73, v75, 5, v73
    v_bfe_u32 v75, v1, 2, 2
    v_lshl_or_b32 v73, v75, 6, v73
    v_bfe_u32 v75, v1, 2, 2
    v_lshl_or_b32 v73, v75, 9, v73
    v_bfe_u32 v75, v1, 4, 2
    v_lshl_or_b32 v73, v75, 12, v73
    s_and_b32 s74, s58, 3
    s_mul_i32 s74, s74, 128
    s_or_b32 s74, s74, 16384
    v_xor_b32 v73, s74, v73
    s_mov_b32 s84, 1
    s_cmp_eq_u32 s78, 1
    s_cbranch_scc1 r1_70
    s_cmp_eq_u32 s78, 2
    s_cselect_b32 s85, 8, 12
    s_cmp_lt_u32 s57, s85
    s_cbranch_scc1 fol_69
    s_cmp_ge_u32 s57, 24
    s_cbranch_scc1 fft_68
    s_cmp_eq_u32 s78, 5
    s_cbranch_scc1 r5_73
    s_cmp_ge_u32 s57, 12
    s_addc_u32 s79, s78, 2
    s_cmp_lt_u32 s57, 16
    s_cbranch_scc1 q_64
    s_branch kv_71
r1_70:
    s_lshr_b32 s79, s57, 2
    s_cmp_lt_u32 s57, 16
    s_cbranch_scc1 q_64
    s_lshr_b32 s79, s57, 3
    s_add_u32 s79, s79, 1
kv_71:
    s_bfe_u32 s80, s76, 0x30000
    s_bfe_u32 s85, s76, 0x10005
    s_lshl_b32 s85, s85, 3
    s_or_b32 s80, s80, s85
    s_lshl_b32 s83, s79, 3
    s_add_u32 s83, s83, 128
    s_cmp_ge_u32 s75, 2
    s_cbranch_scc1 v1_66
    s_mov_b64 s[60:61], s[36:37]
    s_mov_b32 s62, 0x400000
    s_mov_b32 s63, 0x20000
    s_mov_b64 s[64:65], s[24:25]
    s_mov_b32 s66, 0x800000
    s_mov_b32 s67, 0x20000
    v_lshrrev_b32 v76, 4, v1
    v_sub_u32 v76, 0, v76
    v_xor_b32 v76, v76, v1
    v_and_b32 v76, 3, v76
    s_mul_i32 s74, s58, 32
    v_lshrrev_b32 v77, 2, v1
    v_add3_u32 v77, v77, s74, 0
    v_lshlrev_b32 v68, 11, v77
    v_lshl_add_u32 v68, v76, 4, v68
    v_lshrrev_b32 v77, 2, v1
    v_add3_u32 v77, v77, s74, 16
    v_lshlrev_b32 v69, 11, v77
    v_lshl_add_u32 v69, v76, 4, v69
    s_and_b32 s74, s58, 2
    v_bfe_u32 v76, v1, 0, 5
    v_bfe_u32 v77, v1, 5, 1
    v_lshlrev_b32 v77, 2, v77
    v_xor_b32 v76, v76, v77
    v_xor_b32 v76, s74, v76
    v_bfe_u32 v77, v76, 0, 1
    v_lshlrev_b32 v77, 5, v77
    v_bfe_u32 v75, v76, 1, 1
    v_lshl_or_b32 v77, v75, 4, v77
    v_bfe_u32 v75, v76, 2, 3
    v_lshl_or_b32 v77, v75, 6, v77
    v_lshrrev_b32 v76, 5, v1
    v_lshl_add_u32 v70, v76, 13, v77
    v_bfe_u32 v76, v1, 0, 5
    v_bfe_u32 v77, v1, 5, 1
    v_lshlrev_b32 v77, 2, v77
    v_xor_b32 v76, v76, v77
    v_xor_b32 v76, s74, v76
    v_xor_b32 v76, 8, v76
    v_bfe_u32 v77, v76, 0, 1
    v_lshlrev_b32 v77, 5, v77
    v_bfe_u32 v75, v76, 1, 1
    v_lshl_or_b32 v77, v75, 4, v77
    v_bfe_u32 v75, v76, 2, 3
    v_lshl_or_b32 v77, v75, 6, v77
    v_lshrrev_b32 v76, 5, v1
    v_lshl_add_u32 v71, v76, 13, v77
    v_add_u32 v71, 16384, v71
    s_lshl_b32 s74, s58, 15
    v_add_u32 v70, s74, v70
    v_add_u32 v71, s74, v71
    s_mov_b32 s70, 262144
    s_mul_i32 s68, s79, 524288
    s_mul_i32 s69, s80, 512
    s_mov_b32 s82, 0x40000
    s_lshl_b32 s81, s79, 1
    s_lshr_b32 s85, s58, 2
    s_add_u32 s81, s81, s85
    s_mul_i32 s81, s81, s82
    s_mul_i32 s81, s81, 4
    s_lshl_b32 s74, s80, 2
    s_and_b32 s85, s58, 3
    s_add_u32 s85, s85, s74
    s_mul_i32 s85, s85, 4096
    s_add_u32 s81, s81, s85
    s_add_u32 s81, s81, 0x1000000
    s_mul_i32 s71, s58, 2048
    s_mov_b32 m0, s71
    s_nop 0
    buffer_load_dwordx4 v68, s[60:63], s68 offen lds
    s_add_u32 m0, s71, 1024
    s_nop 0
    buffer_load_dwordx4 v69, s[60:63], s68 offen lds
    s_add_u32 m0, s71, 16384
    s_nop 0
    buffer_load_dwordx4 v70, s[64:67], s69 offen lds
    s_add_u32 m0, s71, 17408
    s_nop 0
    buffer_load_dwordx4 v71, s[64:67], s69 offen lds
    s_add_u32 s68, s68, 64
    s_add_u32 s69, s69, s70
    s_add_u32 s71, s71, 32768
    s_and_b32 s71, s71, 0x1ffff
    s_mov_b32 m0, s71
    s_nop 0
    buffer_load_dwordx4 v68, s[60:63], s68 offen lds
    s_add_u32 m0, s71, 1024
    s_nop 0
    buffer_load_dwordx4 v69, s[60:63], s68 offen lds
    s_add_u32 m0, s71, 16384
    s_nop 0
    buffer_load_dwordx4 v70, s[64:67], s69 offen lds
    s_add_u32 m0, s71, 17408
    s_nop 0
    buffer_load_dwordx4 v71, s[64:67], s69 offen lds
    s_add_u32 s68, s68, 64
    s_add_u32 s69, s69, s70
    s_add_u32 s71, s71, 32768
    s_and_b32 s71, s71, 0x1ffff
    s_mov_b32 m0, s71
    s_nop 0
    buffer_load_dwordx4 v68, s[60:63], s68 offen lds
    s_add_u32 m0, s71, 1024
    s_nop 0
    buffer_load_dwordx4 v69, s[60:63], s68 offen lds
    s_add_u32 m0, s71, 16384
    s_nop 0
    buffer_load_dwordx4 v70, s[64:67], s69 offen lds
    s_add_u32 m0, s71, 17408
    s_nop 0
    buffer_load_dwordx4 v71, s[64:67], s69 offen lds
    s_add_u32 s68, s68, 64
    s_add_u32 s69, s69, s70
    s_add_u32 s71, s71, 32768
    s_and_b32 s71, s71, 0x1ffff
    s_mov_b32 m0, s71
    s_nop 0
    buffer_load_dwordx4 v68, s[60:63], s68 offen lds
    s_add_u32 m0, s71, 1024
    s_nop 0
    buffer_load_dwordx4 v69, s[60:63], s68 offen lds
    s_add_u32 m0, s71, 16384
    s_nop 0
    buffer_load_dwordx4 v70, s[64:67], s69 offen lds
    s_add_u32 m0, s71, 17408
    s_nop 0
    buffer_load_dwordx4 v71, s[64:67], s69 offen lds
    s_add_u32 s68, s68, 64
    s_add_u32 s69, s69, s70
    s_add_u32 s71, s71, 32768
    s_and_b32 s71, s71, 0x1ffff
    s_branch f256_44
v1_66:
    s_mov_b64 s[60:61], s[36:37]
    s_mov_b32 s62, 0x400000
    s_mov_b32 s63, 0x20000
    s_mov_b64 s[64:65], s[28:29]
    s_mov_b32 s66, 0x800000
    s_mov_b32 s67, 0x20000
    v_lshrrev_b32 v76, 4, v1
    v_sub_u32 v76, 0, v76
    v_xor_b32 v76, v76, v1
    v_and_b32 v76, 3, v76
    s_mul_i32 s74, s58, 32
    v_lshrrev_b32 v77, 2, v1
    v_add3_u32 v77, v77, s74, 0
    v_bfe_u32 v68, v77, 0, 3
    v_lshlrev_b32 v68, 11, v68
    v_bfe_u32 v75, v77, 3, 1
    v_lshl_or_b32 v68, v75, 15, v68
    v_bfe_u32 v75, v77, 4, 1
    v_lshl_or_b32 v68, v75, 14, v68
    v_bfe_u32 v75, v77, 5, 3
    v_lshl_or_b32 v68, v75, 16, v68
    v_lshl_add_u32 v68, v76, 4, v68
    v_lshrrev_b32 v77, 2, v1
    v_add3_u32 v77, v77, s74, 16
    v_bfe_u32 v69, v77, 0, 3
    v_lshlrev_b32 v69, 11, v69
    v_bfe_u32 v75, v77, 3, 1
    v_lshl_or_b32 v69, v75, 15, v69
    v_bfe_u32 v75, v77, 4, 1
    v_lshl_or_b32 v69, v75, 14, v69
    v_bfe_u32 v75, v77, 5, 3
    v_lshl_or_b32 v69, v75, 16, v69
    v_lshl_add_u32 v69, v76, 4, v69
    s_and_b32 s74, s58, 2
    v_bfe_u32 v76, v1, 0, 5
    v_bfe_u32 v77, v1, 5, 1
    v_lshlrev_b32 v77, 2, v77
    v_xor_b32 v76, v76, v77
    v_xor_b32 v76, s74, v76
    v_lshlrev_b32 v77, 4, v76
    v_lshrrev_b32 v76, 5, v1
    v_lshl_add_u32 v70, v76, 13, v77
    v_bfe_u32 v76, v1, 0, 5
    v_bfe_u32 v77, v1, 5, 1
    v_lshlrev_b32 v77, 2, v77
    v_xor_b32 v76, v76, v77
    v_xor_b32 v76, s74, v76
    v_xor_b32 v76, 8, v76
    v_lshlrev_b32 v77, 4, v76
    v_lshrrev_b32 v76, 5, v1
    v_lshl_add_u32 v71, v76, 13, v77
    v_add_u32 v71, 16384, v71
    s_lshl_b32 s74, s58, 15
    v_add_u32 v70, s74, v70
    v_add_u32 v71, s74, v71
    s_mov_b32 s70, 262144
    s_mul_i32 s68, s79, 524288
    s_mul_i32 s69, s80, 512
    s_mov_b32 s82, 0x40000
    s_lshl_b32 s81, s79, 1
    s_lshr_b32 s85, s58, 2
    s_add_u32 s81, s81, s85
    s_mul_i32 s81, s81, s82
    s_mul_i32 s81, s81, 4
    s_lshl_b32 s74, s80, 2
    s_and_b32 s85, s58, 3
    s_add_u32 s85, s85, s74
    s_mul_i32 s85, s85, 4096
    s_add_u32 s81, s81, s85
    s_add_u32 s81, s81, 0x2000000
    s_mul_i32 s71, s58, 2048
    s_mov_b32 m0, s71
    s_nop 0
    buffer_load_dwordx4 v68, s[60:63], s68 offen lds
    s_add_u32 m0, s71, 1024
    s_nop 0
    buffer_load_dwordx4 v69, s[60:63], s68 offen lds
    s_add_u32 m0, s71, 16384
    s_nop 0
    buffer_load_dwordx4 v70, s[64:67], s69 offen lds
    s_add_u32 m0, s71, 17408
    s_nop 0
    buffer_load_dwordx4 v71, s[64:67], s69 offen lds
    s_add_u32 s68, s68, 64
    s_add_u32 s69, s69, s70
    s_add_u32 s71, s71, 32768
    s_and_b32 s71, s71, 0x1ffff
    s_mov_b32 m0, s71
    s_nop 0
    buffer_load_dwordx4 v68, s[60:63], s68 offen lds
    s_add_u32 m0, s71, 1024
    s_nop 0
    buffer_load_dwordx4 v69, s[60:63], s68 offen lds
    s_add_u32 m0, s71, 16384
    s_nop 0
    buffer_load_dwordx4 v70, s[64:67], s69 offen lds
    s_add_u32 m0, s71, 17408
    s_nop 0
    buffer_load_dwordx4 v71, s[64:67], s69 offen lds
    s_add_u32 s68, s68, 64
    s_add_u32 s69, s69, s70
    s_add_u32 s71, s71, 32768
    s_and_b32 s71, s71, 0x1ffff
    s_mov_b32 m0, s71
    s_nop 0
    buffer_load_dwordx4 v68, s[60:63], s68 offen lds
    s_add_u32 m0, s71, 1024
    s_nop 0
    buffer_load_dwordx4 v69, s[60:63], s68 offen lds
    s_add_u32 m0, s71, 16384
    s_nop 0
    buffer_load_dwordx4 v70, s[64:67], s69 offen lds
    s_add_u32 m0, s71, 17408
    s_nop 0
    buffer_load_dwordx4 v71, s[64:67], s69 offen lds
    s_add_u32 s68, s68, 64
    s_add_u32 s69, s69, s70
    s_add_u32 s71, s71, 32768
    s_and_b32 s71, s71, 0x1ffff
    s_mov_b32 m0, s71
    s_nop 0
    buffer_load_dwordx4 v68, s[60:63], s68 offen lds
    s_add_u32 m0, s71, 1024
    s_nop 0
    buffer_load_dwordx4 v69, s[60:63], s68 offen lds
    s_add_u32 m0, s71, 16384
    s_nop 0
    buffer_load_dwordx4 v70, s[64:67], s69 offen lds
    s_add_u32 m0, s71, 17408
    s_nop 0
    buffer_load_dwordx4 v71, s[64:67], s69 offen lds
    s_add_u32 s68, s68, 64
    s_add_u32 s69, s69, s70
    s_add_u32 s71, s71, 32768
    s_and_b32 s71, s71, 0x1ffff
    s_branch t256_45
q_64:
    s_bfe_u32 s80, s76, 0x20000
    s_bfe_u32 s85, s76, 0x20005
    s_lshl_b32 s85, s85, 2
    s_or_b32 s80, s80, s85
    s_lshl_b32 s83, s79, 3
    s_add_u32 s83, s83, 128
    s_mov_b32 s84, 0x10000
    s_mov_b64 s[60:61], s[36:37]
    s_mov_b32 s62, 0x400000
    s_mov_b32 s63, 0x20000
    s_mov_b64 s[64:65], s[20:21]
    s_mov_b32 s66, 0x800000
    s_mov_b32 s67, 0x20000
    v_lshrrev_b32 v76, 4, v1
    v_sub_u32 v76, 0, v76
    v_xor_b32 v76, v76, v1
    v_and_b32 v76, 3, v76
    s_mul_i32 s74, s58, 32
    v_lshrrev_b32 v77, 2, v1
    v_add3_u32 v77, v77, s74, 0
    v_lshlrev_b32 v68, 11, v77
    v_lshl_add_u32 v68, v76, 4, v68
    v_lshrrev_b32 v77, 2, v1
    v_add3_u32 v77, v77, s74, 16
    v_lshlrev_b32 v69, 11, v77
    v_lshl_add_u32 v69, v76, 4, v69
    s_and_b32 s74, s58, 2
    v_bfe_u32 v76, v1, 0, 5
    v_bfe_u32 v77, v1, 5, 1
    v_lshlrev_b32 v77, 2, v77
    v_xor_b32 v76, v76, v77
    v_xor_b32 v76, s74, v76
    v_bfe_u32 v77, v76, 0, 1
    v_lshlrev_b32 v77, 5, v77
    v_bfe_u32 v75, v76, 1, 1
    v_lshl_or_b32 v77, v75, 4, v77
    v_bfe_u32 v75, v76, 2, 3
    v_lshl_or_b32 v77, v75, 6, v77
    v_lshrrev_b32 v76, 5, v1
    v_lshl_add_u32 v70, v76, 13, v77
    v_bfe_u32 v76, v1, 0, 5
    v_bfe_u32 v77, v1, 5, 1
    v_lshlrev_b32 v77, 2, v77
    v_xor_b32 v76, v76, v77
    v_xor_b32 v76, s74, v76
    v_xor_b32 v76, 8, v76
    v_bfe_u32 v77, v76, 0, 1
    v_lshlrev_b32 v77, 5, v77
    v_bfe_u32 v75, v76, 1, 1
    v_lshl_or_b32 v77, v75, 4, v77
    v_bfe_u32 v75, v76, 2, 3
    v_lshl_or_b32 v77, v75, 6, v77
    v_lshrrev_b32 v76, 5, v1
    v_lshl_add_u32 v71, v76, 13, v77
    v_add_u32 v71, 16384, v71
    s_lshl_b32 s74, s58, 15
    v_add_u32 v70, s74, v70
    v_add_u32 v71, s74, v71
    s_mov_b32 s70, 262144
    s_mul_i32 s68, s79, 524288
    s_mul_i32 s69, s80, 512
    s_mov_b32 s82, 0x40000
    s_lshl_b32 s81, s79, 1
    s_lshr_b32 s85, s58, 2
    s_add_u32 s81, s81, s85
    s_mul_i32 s81, s81, s82
    s_mul_i32 s81, s81, 4
    s_lshl_b32 s74, s80, 2
    s_and_b32 s85, s58, 3
    s_add_u32 s85, s85, s74
    s_mul_i32 s85, s85, 4096
    s_add_u32 s81, s81, s85
    s_add_u32 s81, s81, 0x0
    s_mul_i32 s71, s58, 2048
    s_mov_b32 m0, s71
    s_nop 0
    buffer_load_dwordx4 v68, s[60:63], s68 offen lds
    s_add_u32 m0, s71, 1024
    s_nop 0
    buffer_load_dwordx4 v69, s[60:63], s68 offen lds
    s_add_u32 m0, s71, 16384
    s_nop 0
    buffer_load_dwordx4 v70, s[64:67], s69 offen lds
    s_add_u32 m0, s71, 17408
    s_nop 0
    buffer_load_dwordx4 v71, s[64:67], s69 offen lds
    s_add_u32 s68, s68, 64
    s_add_u32 s69, s69, s70
    s_add_u32 s71, s71, 32768
    s_and_b32 s71, s71, 0x1ffff
    s_mov_b32 m0, s71
    s_nop 0
    buffer_load_dwordx4 v68, s[60:63], s68 offen lds
    s_add_u32 m0, s71, 1024
    s_nop 0
    buffer_load_dwordx4 v69, s[60:63], s68 offen lds
    s_add_u32 m0, s71, 16384
    s_nop 0
    buffer_load_dwordx4 v70, s[64:67], s69 offen lds
    s_add_u32 m0, s71, 17408
    s_nop 0
    buffer_load_dwordx4 v71, s[64:67], s69 offen lds
    s_add_u32 s68, s68, 64
    s_add_u32 s69, s69, s70
    s_add_u32 s71, s71, 32768
    s_and_b32 s71, s71, 0x1ffff
    s_mov_b32 m0, s71
    s_nop 0
    buffer_load_dwordx4 v68, s[60:63], s68 offen lds
    s_add_u32 m0, s71, 1024
    s_nop 0
    buffer_load_dwordx4 v69, s[60:63], s68 offen lds
    s_add_u32 m0, s71, 16384
    s_nop 0
    buffer_load_dwordx4 v70, s[64:67], s69 offen lds
    s_add_u32 m0, s71, 17408
    s_nop 0
    buffer_load_dwordx4 v71, s[64:67], s69 offen lds
    s_add_u32 s68, s68, 64
    s_add_u32 s69, s69, s70
    s_add_u32 s71, s71, 32768
    s_and_b32 s71, s71, 0x1ffff
    s_mov_b32 m0, s71
    s_nop 0
    buffer_load_dwordx4 v68, s[60:63], s68 offen lds
    s_add_u32 m0, s71, 1024
    s_nop 0
    buffer_load_dwordx4 v69, s[60:63], s68 offen lds
    s_add_u32 m0, s71, 16384
    s_nop 0
    buffer_load_dwordx4 v70, s[64:67], s69 offen lds
    s_add_u32 m0, s71, 17408
    s_nop 0
    buffer_load_dwordx4 v71, s[64:67], s69 offen lds
    s_add_u32 s68, s68, 64
    s_add_u32 s69, s69, s70
    s_add_u32 s71, s71, 32768
    s_and_b32 s71, s71, 0x1ffff
    s_branch f256_44
fft_68:
    s_cmp_eq_u32 s78, 3
    s_cbranch_scc1 col_65
    s_cmp_eq_u32 s78, 4
    s_cbranch_scc1 p3_67
    s_cmp_lg_u32 s58, 0
    s_cbranch_scc1 wall_75
    v_mov_b32 v76, 148
wctr_76:
    buffer_load_dword v75, v76, s[12:15], 0 offen sc1
    s_waitcnt vmcnt(0)
    v_cmp_gt_u16 vcc, 128, v75
    s_cbranch_vccz wctr_ok_77
    s_sub_u32 s77, s77, 1
    s_cbranch_scc0 wctr_76
    s_mov_b32 s77, 0
wctr_ok_77:
wall_75:
    s_barrier
    s_and_b32 s79, s57, 7
    s_mov_b32 s80, s75
    s_mov_b32 s83, 40
    s_mov_b64 s[60:61], s[44:45]
    s_mov_b32 s62, 0x400000
    s_mov_b32 s63, 0x20000
    s_mov_b64 s[64:65], s[8:9]
    s_mov_b32 s66, 0x10000000
    s_mov_b32 s67, 0x20000
    v_lshrrev_b32 v76, 4, v1
    v_sub_u32 v76, 0, v76
    v_xor_b32 v76, v76, v1
    v_and_b32 v76, 3, v76
    s_mul_i32 s74, s58, 32
    v_lshrrev_b32 v77, 2, v1
    v_add3_u32 v77, v77, s74, 0
    v_bfe_u32 v68, v77, 0, 3
    v_lshlrev_b32 v68, 17, v68
    v_bfe_u32 v75, v77, 3, 1
    v_lshl_or_b32 v68, v75, 21, v68
    v_bfe_u32 v75, v77, 4, 1
    v_lshl_or_b32 v68, v75, 20, v68
    v_bfe_u32 v75, v77, 5, 3
    v_lshl_or_b32 v68, v75, 11, v68
    v_lshl_add_u32 v68, v76, 4, v68
    v_lshrrev_b32 v77, 2, v1
    v_add3_u32 v77, v77, s74, 16
    v_bfe_u32 v69, v77, 0, 3
    v_lshlrev_b32 v69, 17, v69
    v_bfe_u32 v75, v77, 3, 1
    v_lshl_or_b32 v69, v75, 21, v69
    v_bfe_u32 v75, v77, 4, 1
    v_lshl_or_b32 v69, v75, 20, v69
    v_bfe_u32 v75, v77, 5, 3
    v_lshl_or_b32 v69, v75, 11, v69
    v_lshl_add_u32 v69, v76, 4, v69
    s_and_b32 s74, s58, 2
    v_bfe_u32 v76, v1, 0, 5
    v_bfe_u32 v77, v1, 5, 1
    v_lshlrev_b32 v77, 2, v77
    v_xor_b32 v76, v76, v77
    v_xor_b32 v76, s74, v76
    v_lshlrev_b32 v77, 4, v76
    v_lshrrev_b32 v76, 5, v1
    v_lshl_add_u32 v70, v76, 11, v77
    v_bfe_u32 v76, v1, 0, 5
    v_bfe_u32 v77, v1, 5, 1
    v_lshlrev_b32 v77, 2, v77
    v_xor_b32 v76, v76, v77
    v_xor_b32 v76, s74, v76
    v_xor_b32 v76, 8, v76
    v_lshlrev_b32 v77, 4, v76
    v_lshrrev_b32 v76, 5, v1
    v_lshl_add_u32 v71, v76, 11, v77
    v_add_u32 v71, 4096, v71
    s_lshl_b32 s74, s58, 13
    v_add_u32 v70, s74, v70
    v_add_u32 v71, s74, v71
    s_mov_b32 s70, 65536
    s_lshl_b32 s68, s79, 14
    s_lshl_b32 s69, s80, 9
    s_add_u32 s69, s69, 0x5200000
    s_mov_b32 s82, 0x10000
    s_lshl_b32 s81, s79, 1
    s_lshr_b32 s85, s58, 2
    s_add_u32 s81, s81, s85
    s_mul_i32 s81, s81, s82
    s_mul_i32 s81, s81, 4
    s_lshl_b32 s74, s80, 2
    s_and_b32 s85, s58, 3
    s_add_u32 s85, s85, s74
    s_mul_i32 s85, s85, 4096
    s_add_u32 s81, s81, s85
    s_add_u32 s81, s81, 0x5400000
    s_mul_i32 s71, s58, 2048
    s_mov_b32 m0, s71
    s_nop 0
    buffer_load_dwordx4 v68, s[60:63], s68 offen lds
    s_add_u32 m0, s71, 1024
    s_nop 0
    buffer_load_dwordx4 v69, s[60:63], s68 offen lds
    s_add_u32 m0, s71, 16384
    s_nop 0
    buffer_load_dwordx4 v70, s[64:67], s69 offen lds
    s_add_u32 m0, s71, 17408
    s_nop 0
    buffer_load_dwordx4 v71, s[64:67], s69 offen lds
    s_add_u32 s68, s68, 64
    s_add_u32 s69, s69, s70
    s_add_u32 s71, s71, 32768
    s_and_b32 s71, s71, 0x1ffff
    s_mov_b32 m0, s71
    s_nop 0
    buffer_load_dwordx4 v68, s[60:63], s68 offen lds
    s_add_u32 m0, s71, 1024
    s_nop 0
    buffer_load_dwordx4 v69, s[60:63], s68 offen lds
    s_add_u32 m0, s71, 16384
    s_nop 0
    buffer_load_dwordx4 v70, s[64:67], s69 offen lds
    s_add_u32 m0, s71, 17408
    s_nop 0
    buffer_load_dwordx4 v71, s[64:67], s69 offen lds
    s_add_u32 s68, s68, 64
    s_add_u32 s69, s69, s70
    s_add_u32 s71, s71, 32768
    s_and_b32 s71, s71, 0x1ffff
    s_mov_b32 m0, s71
    s_nop 0
    buffer_load_dwordx4 v68, s[60:63], s68 offen lds
    s_add_u32 m0, s71, 1024
    s_nop 0
    buffer_load_dwordx4 v69, s[60:63], s68 offen lds
    s_add_u32 m0, s71, 16384
    s_nop 0
    buffer_load_dwordx4 v70, s[64:67], s69 offen lds
    s_add_u32 m0, s71, 17408
    s_nop 0
    buffer_load_dwordx4 v71, s[64:67], s69 offen lds
    s_add_u32 s68, s68, 64
    s_add_u32 s69, s69, s70
    s_add_u32 s71, s71, 32768
    s_and_b32 s71, s71, 0x1ffff
    s_mov_b32 m0, s71
    s_nop 0
    buffer_load_dwordx4 v68, s[60:63], s68 offen lds
    s_add_u32 m0, s71, 1024
    s_nop 0
    buffer_load_dwordx4 v69, s[60:63], s68 offen lds
    s_add_u32 m0, s71, 16384
    s_nop 0
    buffer_load_dwordx4 v70, s[64:67], s69 offen lds
    s_add_u32 m0, s71, 17408
    s_nop 0
    buffer_load_dwordx4 v71, s[64:67], s69 offen lds
    s_add_u32 s68, s68, 64
    s_add_u32 s69, s69, s70
    s_add_u32 s71, s71, 32768
    s_and_b32 s71, s71, 0x1ffff
    s_branch t256_45
col_65:
    s_bfe_u32 s79, s76, 0x30000
    s_bfe_u32 s85, s76, 0x20005
    s_lshl_b32 s85, s85, 3
    s_or_b32 s79, s79, s85
    v_bfe_u32 v231, v1, 0, 5
    v_bfe_u32 v235, v1, 5, 1
    v_lshl_or_b32 v231, v235, 7, v231
    v_mul_u32_u24 v231, 1026, v231
    v_and_b32 v231, -4, v231
    s_mul_i32 s5, s58, 262656
    s_lshl_b32 s2, s79, 5
    s_add_u32 s5, s5, s2
    buffer_load_dwordx4 v[84:87], v231, s[48:51], s5 offen
    buffer_load_dwordx4 v[88:91], v231, s[48:51], s5 offen offset:16
    buffer_load_dword v92, v231, s[48:51], s5 offen offset:32
    buffer_load_dwordx4 v[94:97], v231, s[52:55], s5 offen
    buffer_load_dwordx4 v[98:101], v231, s[52:55], s5 offen offset:16
    buffer_load_dword v102, v231, s[52:55], s5 offen offset:32
    s_add_u32 s5, s5, 32832
    buffer_load_dwordx4 v[104:107], v231, s[48:51], s5 offen
    buffer_load_dwordx4 v[108:111], v231, s[48:51], s5 offen offset:16
    buffer_load_dword v112, v231, s[48:51], s5 offen offset:32
    buffer_load_dwordx4 v[114:117], v231, s[52:55], s5 offen
    buffer_load_dwordx4 v[118:121], v231, s[52:55], s5 offen offset:16
    buffer_load_dword v122, v231, s[52:55], s5 offen offset:32
    s_add_u32 s5, s5, 32832
    buffer_load_dwordx4 v[124:127], v231, s[48:51], s5 offen
    buffer_load_dwordx4 v[128:131], v231, s[48:51], s5 offen offset:16
    buffer_load_dword v132, v231, s[48:51], s5 offen offset:32
    buffer_load_dwordx4 v[134:137], v231, s[52:55], s5 offen
    buffer_load_dwordx4 v[138:141], v231, s[52:55], s5 offen offset:16
    buffer_load_dword v142, v231, s[52:55], s5 offen offset:32
    s_add_u32 s5, s5, 32832
    buffer_load_dwordx4 v[144:147], v231, s[48:51], s5 offen
    buffer_load_dwordx4 v[148:151], v231, s[48:51], s5 offen offset:16
    buffer_load_dword v152, v231, s[48:51], s5 offen offset:32
    buffer_load_dwordx4 v[154:157], v231, s[52:55], s5 offen
    buffer_load_dwordx4 v[158:161], v231, s[52:55], s5 offen offset:16
    buffer_load_dword v162, v231, s[52:55], s5 offen offset:32
    s_add_u32 s5, s5, 32832
    v_and_b32 v235, 31, v1
    v_cvt_f32_u32 v228, v235
    v_and_b32 v235, 32, v1
    v_cvt_f32_u32 v235, v235
    v_mul_f32 v229, v228, v235
    v_mul_f32 v229, 0x3b000000, v229
    v_mul_f32 v234, 0x3d000000, v229
    v_fmamk_f32 v230, v235, 0x3b000000, v234
    v_and_b32 v233, 1, v1
    v_lshlrev_b32 v232, 4, v233
    v_mul_u32_u24 v233, 0x8000, v233
    v_lshl_or_b32 v233, v233, 16, v233
    v_fmamk_f32 v243, v228, 0x0, v229
    v_add_f32 v244, v243, v243
    v_cos_f32 v235, v243
    v_sin_f32 v237, v243
    v_cos_f32 v239, v244
    v_sin_f32 v241, v244
    v_fmamk_f32 v243, v228, 0x3c800000, v229
    v_add_f32 v244, v243, v243
    v_cos_f32 v236, v243
    v_sin_f32 v238, v243
    v_cos_f32 v240, v244
    v_sin_f32 v242, v244
    v_cvt_pk_bf16_f32 v4, v235, v236
    v_cvt_pk_bf16_f32 v36, v237, v238
    v_cvt_pk_bf16_f32 v68, v239, v240
    v_cvt_pk_bf16_f32 v76, v241, v242
    v_fmamk_f32 v243, v228, 0x3d000000, v229
    v_add_f32 v244, v243, v243
    v_cos_f32 v235, v243
    v_sin_f32 v237, v243
    v_cos_f32 v239, v244
    v_sin_f32 v241, v244
    v_fmamk_f32 v243, v228, 0x3d400000, v229
    v_add_f32 v244, v243, v243
    v_cos_f32 v236, v243
    v_sin_f32 v238, v243
    v_cos_f32 v240, v244
    v_sin_f32 v242, v244
    v_cvt_pk_bf16_f32 v5, v235, v236
    v_cvt_pk_bf16_f32 v37, v237, v238
    v_cvt_pk_bf16_f32 v69, v239, v240
    v_cvt_pk_bf16_f32 v77, v241, v242
    v_fmamk_f32 v243, v228, 0x3e000000, v229
    v_add_f32 v244, v243, v243
    v_cos_f32 v235, v243
    v_sin_f32 v237, v243
    v_cos_f32 v239, v244
    v_sin_f32 v241, v244
    v_fmamk_f32 v243, v228, 0x3e100000, v229
    v_add_f32 v244, v243, v243
    v_cos_f32 v236, v243
    v_sin_f32 v238, v243
    v_cos_f32 v240, v244
    v_sin_f32 v242, v244
    v_cvt_pk_bf16_f32 v6, v235, v236
    v_cvt_pk_bf16_f32 v38, v237, v238
    v_cvt_pk_bf16_f32 v70, v239, v240
    v_cvt_pk_bf16_f32 v78, v241, v242
    v_fmamk_f32 v243, v228, 0x3e200000, v229
    v_add_f32 v244, v243, v243
    v_cos_f32 v235, v243
    v_sin_f32 v237, v243
    v_cos_f32 v239, v244
    v_sin_f32 v241, v244
    v_fmamk_f32 v243, v228, 0x3e300000, v229
    v_add_f32 v244, v243, v243
    v_cos_f32 v236, v243
    v_sin_f32 v238, v243
    v_cos_f32 v240, v244
    v_sin_f32 v242, v244
    v_cvt_pk_bf16_f32 v7, v235, v236
    v_cvt_pk_bf16_f32 v39, v237, v238
    v_cvt_pk_bf16_f32 v71, v239, v240
    v_cvt_pk_bf16_f32 v79, v241, v242
    v_fmamk_f32 v243, v228, 0x3e800000, v229
    v_add_f32 v244, v243, v243
    v_cos_f32 v235, v243
    v_sin_f32 v237, v243
    v_cos_f32 v239, v244
    v_sin_f32 v241, v244
    v_fmamk_f32 v243, v228, 0x3e880000, v229
    v_add_f32 v244, v243, v243
    v_cos_f32 v236, v243
    v_sin_f32 v238, v243
    v_cos_f32 v240, v244
    v_sin_f32 v242, v244
    v_cvt_pk_bf16_f32 v8, v235, v236
    v_cvt_pk_bf16_f32 v40, v237, v238
    v_cvt_pk_bf16_f32 v72, v239, v240
    v_cvt_pk_bf16_f32 v80, v241, v242
    v_fmamk_f32 v243, v228, 0x3e900000, v229
    v_add_f32 v244, v243, v243
    v_cos_f32 v235, v243
    v_sin_f32 v237, v243
    v_cos_f32 v239, v244
    v_sin_f32 v241, v244
    v_fmamk_f32 v243, v228, 0x3e980000, v229
    v_add_f32 v244, v243, v243
    v_cos_f32 v236, v243
    v_sin_f32 v238, v243
    v_cos_f32 v240, v244
    v_sin_f32 v242, v244
    v_cvt_pk_bf16_f32 v9, v235, v236
    v_cvt_pk_bf16_f32 v41, v237, v238
    v_cvt_pk_bf16_f32 v73, v239, v240
    v_cvt_pk_bf16_f32 v81, v241, v242
    v_fmamk_f32 v243, v228, 0x3ec00000, v229
    v_add_f32 v244, v243, v243
    v_cos_f32 v235, v243
    v_sin_f32 v237, v243
    v_cos_f32 v239, v244
    v_sin_f32 v241, v244
    v_fmamk_f32 v243, v228, 0x3ec80000, v229
    v_add_f32 v244, v243, v243
    v_cos_f32 v236, v243
    v_sin_f32 v238, v243
    v_cos_f32 v240, v244
    v_sin_f32 v242, v244
    v_cvt_pk_bf16_f32 v10, v235, v236
    v_cvt_pk_bf16_f32 v42, v237, v238
    v_cvt_pk_bf16_f32 v74, v239, v240
    v_cvt_pk_bf16_f32 v82, v241, v242
    v_fmamk_f32 v243, v228, 0x3ed00000, v229
    v_add_f32 v244, v243, v243
    v_cos_f32 v235, v243
    v_sin_f32 v237, v243
    v_cos_f32 v239, v244
    v_sin_f32 v241, v244
    v_fmamk_f32 v243, v228, 0x3ed80000, v229
    v_add_f32 v244, v243, v243
    v_cos_f32 v236, v243
    v_sin_f32 v238, v243
    v_cos_f32 v240, v244
    v_sin_f32 v242, v244
    v_cvt_pk_bf16_f32 v11, v235, v236
    v_cvt_pk_bf16_f32 v43, v237, v238
    v_cvt_pk_bf16_f32 v75, v239, v240
    v_cvt_pk_bf16_f32 v83, v241, v242
    v_xor_b32 v12, v233, v4
    v_xor_b32 v13, v233, v5
    v_xor_b32 v14, v233, v6
    v_xor_b32 v15, v233, v7
    v_xor_b32 v16, v233, v8
    v_xor_b32 v17, v233, v9
    v_xor_b32 v18, v233, v10
    v_xor_b32 v19, v233, v11
    v_xor_b32 v20, 0x80000000, v4
    v_xor_b32 v21, 0x80000000, v5
    v_xor_b32 v22, 0x80000000, v6
    v_xor_b32 v23, 0x80000000, v7
    v_xor_b32 v24, 0x80000000, v8
    v_xor_b32 v25, 0x80000000, v9
    v_xor_b32 v26, 0x80000000, v10
    v_xor_b32 v27, 0x80000000, v11
    v_xor_b32 v28, 0x80000000, v12
    v_xor_b32 v29, 0x80000000, v13
    v_xor_b32 v30, 0x80000000, v14
    v_xor_b32 v31, 0x80000000, v15
    v_xor_b32 v32, 0x80000000, v16
    v_xor_b32 v33, 0x80000000, v17
    v_xor_b32 v34, 0x80000000, v18
    v_xor_b32 v35, 0x80000000, v19
    v_xor_b32 v44, v233, v36
    v_xor_b32 v45, v233, v37
    v_xor_b32 v46, v233, v38
    v_xor_b32 v47, v233, v39
    v_xor_b32 v48, v233, v40
    v_xor_b32 v49, v233, v41
    v_xor_b32 v50, v233, v42
    v_xor_b32 v51, v233, v43
    v_xor_b32 v52, 0x80000000, v36
    v_xor_b32 v53, 0x80000000, v37
    v_xor_b32 v54, 0x80000000, v38
    v_xor_b32 v55, 0x80000000, v39
    v_xor_b32 v56, 0x80000000, v40
    v_xor_b32 v57, 0x80000000, v41
    v_xor_b32 v58, 0x80000000, v42
    v_xor_b32 v59, 0x80000000, v43
    v_xor_b32 v60, 0x80000000, v44
    v_xor_b32 v61, 0x80000000, v45
    v_xor_b32 v62, 0x80000000, v46
    v_xor_b32 v63, 0x80000000, v47
    v_xor_b32 v64, 0x80000000, v48
    v_xor_b32 v65, 0x80000000, v49
    v_xor_b32 v66, 0x80000000, v50
    v_xor_b32 v67, 0x80000000, v51
    s_mov_b32 s2, 0x05040100
    s_mov_b32 s3, 0x07060302
    s_lshl_b32 s5, s58, 10
    v_lshl_add_u32 v231, v1, 4, s5
    v_add_u32 v233, 0x10000, v231
    v_add_u32 v235, 0x20000, v231
    s_waitcnt vmcnt(0)
    v_alignbit_b32 v84, v85, v84, v232
    v_alignbit_b32 v94, v95, v94, v232
    v_alignbit_b32 v104, v105, v104, v232
    v_alignbit_b32 v114, v115, v114, v232
    v_alignbit_b32 v124, v125, v124, v232
    v_alignbit_b32 v134, v135, v134, v232
    v_alignbit_b32 v144, v145, v144, v232
    v_alignbit_b32 v154, v155, v154, v232
    v_perm_b32 v196, v94, v84, s2
    v_perm_b32 v197, v114, v104, s2
    v_perm_b32 v198, v134, v124, s2
    v_perm_b32 v199, v154, v144, s2
    ds_write_b128 v231, v[196:199] offset:0
    v_perm_b32 v200, v94, v84, s3
    v_perm_b32 v201, v114, v104, s3
    v_perm_b32 v202, v134, v124, s3
    v_perm_b32 v203, v154, v144, s3
    ds_write_b128 v231, v[200:203] offset:8192
    v_alignbit_b32 v85, v86, v85, v232
    v_alignbit_b32 v95, v96, v95, v232
    v_alignbit_b32 v105, v106, v105, v232
    v_alignbit_b32 v115, v116, v115, v232
    v_alignbit_b32 v125, v126, v125, v232
    v_alignbit_b32 v135, v136, v135, v232
    v_alignbit_b32 v145, v146, v145, v232
    v_alignbit_b32 v155, v156, v155, v232
    v_perm_b32 v204, v95, v85, s2
    v_perm_b32 v205, v115, v105, s2
    v_perm_b32 v206, v135, v125, s2
    v_perm_b32 v207, v155, v145, s2
    ds_write_b128 v231, v[204:207] offset:16384
    v_perm_b32 v208, v95, v85, s3
    v_perm_b32 v209, v115, v105, s3
    v_perm_b32 v210, v135, v125, s3
    v_perm_b32 v211, v155, v145, s3
    ds_write_b128 v231, v[208:211] offset:24576
    v_alignbit_b32 v86, v87, v86, v232
    v_alignbit_b32 v96, v97, v96, v232
    v_alignbit_b32 v106, v107, v106, v232
    v_alignbit_b32 v116, v117, v116, v232
    v_alignbit_b32 v126, v127, v126, v232
    v_alignbit_b32 v136, v137, v136, v232
    v_alignbit_b32 v146, v147, v146, v232
    v_alignbit_b32 v156, v157, v156, v232
    v_perm_b32 v212, v96, v86, s2
    v_perm_b32 v213, v116, v106, s2
    v_perm_b32 v214, v136, v126, s2
    v_perm_b32 v215, v156, v146, s2
    ds_write_b128 v231, v[212:215] offset:32768
    v_perm_b32 v216, v96, v86, s3
    v_perm_b32 v217, v116, v106, s3
    v_perm_b32 v218, v136, v126, s3
    v_perm_b32 v219, v156, v146, s3
    ds_write_b128 v231, v[216:219] offset:40960
    v_alignbit_b32 v87, v88, v87, v232
    v_alignbit_b32 v97, v98, v97, v232
    v_alignbit_b32 v107, v108, v107, v232
    v_alignbit_b32 v117, v118, v117, v232
    v_alignbit_b32 v127, v128, v127, v232
    v_alignbit_b32 v137, v138, v137, v232
    v_alignbit_b32 v147, v148, v147, v232
    v_alignbit_b32 v157, v158, v157, v232
    v_perm_b32 v220, v97, v87, s2
    v_perm_b32 v221, v117, v107, s2
    v_perm_b32 v222, v137, v127, s2
    v_perm_b32 v223, v157, v147, s2
    ds_write_b128 v231, v[220:223] offset:49152
    v_perm_b32 v224, v97, v87, s3
    v_perm_b32 v225, v117, v107, s3
    v_perm_b32 v226, v137, v127, s3
    v_perm_b32 v227, v157, v147, s3
    ds_write_b128 v231, v[224:227] offset:57344
    v_alignbit_b32 v88, v89, v88, v232
    v_alignbit_b32 v98, v99, v98, v232
    v_alignbit_b32 v108, v109, v108, v232
    v_alignbit_b32 v118, v119, v118, v232
    v_alignbit_b32 v128, v129, v128, v232
    v_alignbit_b32 v138, v139, v138, v232
    v_alignbit_b32 v148, v149, v148, v232
    v_alignbit_b32 v158, v159, v158, v232
    v_perm_b32 v196, v98, v88, s2
    v_perm_b32 v197, v118, v108, s2
    v_perm_b32 v198, v138, v128, s2
    v_perm_b32 v199, v158, v148, s2
    ds_write_b128 v233, v[196:199] offset:0
    v_perm_b32 v200, v98, v88, s3
    v_perm_b32 v201, v118, v108, s3
    v_perm_b32 v202, v138, v128, s3
    v_perm_b32 v203, v158, v148, s3
    ds_write_b128 v233, v[200:203] offset:8192
    v_alignbit_b32 v89, v90, v89, v232
    v_alignbit_b32 v99, v100, v99, v232
    v_alignbit_b32 v109, v110, v109, v232
    v_alignbit_b32 v119, v120, v119, v232
    v_alignbit_b32 v129, v130, v129, v232
    v_alignbit_b32 v139, v140, v139, v232
    v_alignbit_b32 v149, v150, v149, v232
    v_alignbit_b32 v159, v160, v159, v232
    v_perm_b32 v204, v99, v89, s2
    v_perm_b32 v205, v119, v109, s2
    v_perm_b32 v206, v139, v129, s2
    v_perm_b32 v207, v159, v149, s2
    ds_write_b128 v233, v[204:207] offset:16384
    v_perm_b32 v208, v99, v89, s3
    v_perm_b32 v209, v119, v109, s3
    v_perm_b32 v210, v139, v129, s3
    v_perm_b32 v211, v159, v149, s3
    ds_write_b128 v233, v[208:211] offset:24576
    v_alignbit_b32 v90, v91, v90, v232
    v_alignbit_b32 v100, v101, v100, v232
    v_alignbit_b32 v110, v111, v110, v232
    v_alignbit_b32 v120, v121, v120, v232
    v_alignbit_b32 v130, v131, v130, v232
    v_alignbit_b32 v140, v141, v140, v232
    v_alignbit_b32 v150, v151, v150, v232
    v_alignbit_b32 v160, v161, v160, v232
    v_perm_b32 v212, v100, v90, s2
    v_perm_b32 v213, v120, v110, s2
    v_perm_b32 v214, v140, v130, s2
    v_perm_b32 v215, v160, v150, s2
    ds_write_b128 v233, v[212:215] offset:32768
    v_perm_b32 v216, v100, v90, s3
    v_perm_b32 v217, v120, v110, s3
    v_perm_b32 v218, v140, v130, s3
    v_perm_b32 v219, v160, v150, s3
    ds_write_b128 v233, v[216:219] offset:40960
    v_alignbit_b32 v91, v92, v91, v232
    v_alignbit_b32 v101, v102, v101, v232
    v_alignbit_b32 v111, v112, v111, v232
    v_alignbit_b32 v121, v122, v121, v232
    v_alignbit_b32 v131, v132, v131, v232
    v_alignbit_b32 v141, v142, v141, v232
    v_alignbit_b32 v151, v152, v151, v232
    v_alignbit_b32 v161, v162, v161, v232
    v_perm_b32 v220, v101, v91, s2
    v_perm_b32 v221, v121, v111, s2
    v_perm_b32 v222, v141, v131, s2
    v_perm_b32 v223, v161, v151, s2
    ds_write_b128 v233, v[220:223] offset:49152
    v_perm_b32 v224, v101, v91, s3
    v_perm_b32 v225, v121, v111, s3
    v_perm_b32 v226, v141, v131, s3
    v_perm_b32 v227, v161, v151, s3
    ds_write_b128 v233, v[224:227] offset:57344
    v_alignbit_b32 v92, v92, v92, v232
    v_alignbit_b32 v102, v102, v102, v232
    v_alignbit_b32 v112, v112, v112, v232
    v_alignbit_b32 v122, v122, v122, v232
    v_alignbit_b32 v132, v132, v132, v232
    v_alignbit_b32 v142, v142, v142, v232
    v_alignbit_b32 v152, v152, v152, v232
    v_alignbit_b32 v162, v162, v162, v232
    v_perm_b32 v196, v102, v92, s2
    v_perm_b32 v197, v122, v112, s2
    v_perm_b32 v198, v142, v132, s2
    v_perm_b32 v199, v162, v152, s2
    ds_write_b128 v235, v[196:199] offset:0
    s_waitcnt lgkmcnt(0)
    s_cmp_lg_u32 s58, 0
    s_cbranch_scc1 wall_78
    v_mov_b32 v236, 40
wctr_79:
    buffer_load_dword v235, v236, s[12:15], 0 offen sc1
    s_waitcnt vmcnt(0)
    v_cmp_gt_u16 vcc, 32, v235
    s_cbranch_vccz wctr_ok_80
    s_sub_u32 s77, s77, 1
    s_cbranch_scc0 wctr_79
    s_mov_b32 s77, 0
wctr_ok_80:
wall_78:
    s_barrier
    s_mov_b32 s7, s58
colloop_81:
    s_lshl_b32 s3, s79, 4
    s_add_u32 s3, s3, s7
    s_lshl_b32 s3, s3, 1
    s_cmp_eq_u32 s3, 1024
    s_cselect_b32 s3, 1, s3
    s_cmp_lt_u32 s3, 2
    s_cselect_b32 s6, 0x5ffffff0, 0
    s_mov_b32 s4, 0x35800000
    s_cselect_b32 s4, 0x35000000, s4
    v_bfe_u32 v231, v1, 0, 5
    v_lshlrev_b32 v231, 16, v231
    v_bfe_u32 v235, v1, 5, 1
    v_lshl_or_b32 v231, v235, 9, v231
    v_add_u32 v232, s6, v231
    s_bfe_u32 s5, s3, 0x50000
    s_lshl_b32 s5, s5, 4
    s_bfe_u32 s2, s3, 0x50005
    s_lshl_b32 s2, s2, 11
    s_or_b32 s5, s5, s2
    s_add_u32 s5, s5, 0x5400000
    buffer_load_dwordx4 v[84:87], v231, s[8:11], s5 offen offset:0
    buffer_load_dwordx4 v[100:103], v232, s[8:11], s5 offen offset:16
    buffer_load_dwordx4 v[88:91], v231, s[8:11], s5 offen offset:1024
    buffer_load_dwordx4 v[104:107], v232, s[8:11], s5 offen offset:1040
    s_add_u32 s5, s5, 2097152
    buffer_load_dwordx4 v[92:95], v231, s[8:11], s5 offen offset:0
    buffer_load_dwordx4 v[108:111], v232, s[8:11], s5 offen offset:16
    buffer_load_dwordx4 v[96:99], v231, s[8:11], s5 offen offset:1024
    buffer_load_dwordx4 v[112:115], v232, s[8:11], s5 offen offset:1040
    s_add_u32 s5, s5, 2097152
    s_lshl_b32 s5, s7, 13
    v_lshl_add_u32 v235, v1, 4, s5
    ds_read_b128 v[196:199], v235 offset:0
    ds_read_b128 v[200:203], v235 offset:1024
    ds_read_b128 v[204:207], v235 offset:2048
    ds_read_b128 v[208:211], v235 offset:3072
    ds_read_b128 v[212:215], v235 offset:4096
    ds_read_b128 v[216:219], v235 offset:5120
    ds_read_b128 v[220:223], v235 offset:6144
    ds_read_b128 v[224:227], v235 offset:7168
    v_and_b32 v236, 31, v1
    v_cvt_f32_u32 v228, v236
    v_mov_b32 v229, v234
    s_waitcnt vmcnt(0) lgkmcnt(0)
    v_xor_b32 v116, 0x80008000, v84
    v_xor_b32 v117, 0x80008000, v85
    v_xor_b32 v118, 0x80008000, v86
    v_xor_b32 v119, 0x80008000, v87
    v_xor_b32 v120, 0x80008000, v88
    v_xor_b32 v121, 0x80008000, v89
    v_xor_b32 v122, 0x80008000, v90
    v_xor_b32 v123, 0x80008000, v91
    v_xor_b32 v124, 0x80008000, v92
    v_xor_b32 v125, 0x80008000, v93
    v_xor_b32 v126, 0x80008000, v94
    v_xor_b32 v127, 0x80008000, v95
    v_xor_b32 v128, 0x80008000, v96
    v_xor_b32 v129, 0x80008000, v97
    v_xor_b32 v130, 0x80008000, v98
    v_xor_b32 v131, 0x80008000, v99
    v_mfma_f32_32x32x16_bf16 v[132:147], v[84:87], v[68:71], 0
    v_mfma_f32_32x32x16_bf16 v[164:179], v[100:103], v[68:71], 0
    v_mfma_f32_32x32x16_bf16 v[132:147], v[100:103], v[76:79], v[132:147]
    v_mfma_f32_32x32x16_bf16 v[164:179], v[116:119], v[76:79], v[164:179]
    v_mfma_f32_32x32x16_bf16 v[132:147], v[88:91], v[72:75], v[132:147]
    v_mfma_f32_32x32x16_bf16 v[164:179], v[104:107], v[72:75], v[164:179]
    v_mfma_f32_32x32x16_bf16 v[132:147], v[104:107], v[80:83], v[132:147]
    v_mfma_f32_32x32x16_bf16 v[164:179], v[120:123], v[80:83], v[164:179]
    v_mfma_f32_32x32x16_bf16 v[148:163], v[92:95], v[68:71], 0
    v_mfma_f32_32x32x16_bf16 v[180:195], v[108:111], v[68:71], 0
    v_mfma_f32_32x32x16_bf16 v[148:163], v[108:111], v[76:79], v[148:163]
    v_mfma_f32_32x32x16_bf16 v[180:195], v[124:127], v[76:79], v[180:195]
    v_mfma_f32_32x32x16_bf16 v[148:163], v[96:99], v[72:75], v[148:163]
    v_mfma_f32_32x32x16_bf16 v[180:195], v[112:115], v[72:75], v[180:195]
    v_mfma_f32_32x32x16_bf16 v[148:163], v[112:115], v[80:83], v[148:163]
    v_mfma_f32_32x32x16_bf16 v[180:195], v[128:131], v[80:83], v[180:195]
    v_fmamk_f32 v243, v228, 0x0, v229
    v_cos_f32 v239, v243
    v_sin_f32 v240, v243
    v_mul_f32 v239, s4, v239
    v_mul_f32 v240, s4, v240
    v_mul_f32 v235, v132, v239
    v_mul_f32 v237, v164, v239
    v_fma_f32 v235, v164, v240, v235
    v_fma_f32 v237, -v132, v240, v237
    v_fmamk_f32 v243, v228, 0x3a000000, v229
    v_cos_f32 v241, v243
    v_sin_f32 v242, v243
    v_mul_f32 v241, s4, v241
    v_mul_f32 v242, s4, v242
    v_mul_f32 v236, v133, v241
    v_mul_f32 v238, v165, v241
    v_fma_f32 v236, v165, v242, v236
    v_fma_f32 v238, -v133, v242, v238
    v_cvt_pk_bf16_f32 v84, v235, v236
    v_cvt_pk_bf16_f32 v100, v237, v238
    v_cvt_pk_bf16_f32 v116, -v235, -v236
    v_fmamk_f32 v243, v228, 0x3a800000, v229
    v_cos_f32 v239, v243
    v_sin_f32 v240, v243
    v_mul_f32 v239, s4, v239
    v_mul_f32 v240, s4, v240
    v_mul_f32 v235, v134, v239
    v_mul_f32 v237, v166, v239
    v_fma_f32 v235, v166, v240, v235
    v_fma_f32 v237, -v134, v240, v237
    v_fmamk_f32 v243, v228, 0x3ac00000, v229
    v_cos_f32 v241, v243
    v_sin_f32 v242, v243
    v_mul_f32 v241, s4, v241
    v_mul_f32 v242, s4, v242
    v_mul_f32 v236, v135, v241
    v_mul_f32 v238, v167, v241
    v_fma_f32 v236, v167, v242, v236
    v_fma_f32 v238, -v135, v242, v238
    v_cvt_pk_bf16_f32 v85, v235, v236
    v_cvt_pk_bf16_f32 v101, v237, v238
    v_cvt_pk_bf16_f32 v117, -v235, -v236
    v_fmamk_f32 v243, v228, 0x3b800000, v229
    v_cos_f32 v239, v243
    v_sin_f32 v240, v243
    v_mul_f32 v239, s4, v239
    v_mul_f32 v240, s4, v240
    v_mul_f32 v235, v136, v239
    v_mul_f32 v237, v168, v239
    v_fma_f32 v235, v168, v240, v235
    v_fma_f32 v237, -v136, v240, v237
    v_fmamk_f32 v243, v228, 0x3b900000, v229
    v_cos_f32 v241, v243
    v_sin_f32 v242, v243
    v_mul_f32 v241, s4, v241
    v_mul_f32 v242, s4, v242
    v_mul_f32 v236, v137, v241
    v_mul_f32 v238, v169, v241
    v_fma_f32 v236, v169, v242, v236
    v_fma_f32 v238, -v137, v242, v238
    v_cvt_pk_bf16_f32 v86, v235, v236
    v_cvt_pk_bf16_f32 v102, v237, v238
    v_cvt_pk_bf16_f32 v118, -v235, -v236
    v_fmamk_f32 v243, v228, 0x3ba00000, v229
    v_cos_f32 v239, v243
    v_sin_f32 v240, v243
    v_mul_f32 v239, s4, v239
    v_mul_f32 v240, s4, v240
    v_mul_f32 v235, v138, v239
    v_mul_f32 v237, v170, v239
    v_fma_f32 v235, v170, v240, v235
    v_fma_f32 v237, -v138, v240, v237
    v_fmamk_f32 v243, v228, 0x3bb00000, v229
    v_cos_f32 v241, v243
    v_sin_f32 v242, v243
    v_mul_f32 v241, s4, v241
    v_mul_f32 v242, s4, v242
    v_mul_f32 v236, v139, v241
    v_mul_f32 v238, v171, v241
    v_fma_f32 v236, v171, v242, v236
    v_fma_f32 v238, -v139, v242, v238
    v_cvt_pk_bf16_f32 v87, v235, v236
    v_cvt_pk_bf16_f32 v103, v237, v238
    v_cvt_pk_bf16_f32 v119, -v235, -v236
    v_fmamk_f32 v243, v228, 0x3c000000, v229
    v_cos_f32 v239, v243
    v_sin_f32 v240, v243
    v_mul_f32 v239, s4, v239
    v_mul_f32 v240, s4, v240
    v_mul_f32 v235, v140, v239
    v_mul_f32 v237, v172, v239
    v_fma_f32 v235, v172, v240, v235
    v_fma_f32 v237, -v140, v240, v237
    v_fmamk_f32 v243, v228, 0x3c080000, v229
    v_cos_f32 v241, v243
    v_sin_f32 v242, v243
    v_mul_f32 v241, s4, v241
    v_mul_f32 v242, s4, v242
    v_mul_f32 v236, v141, v241
    v_mul_f32 v238, v173, v241
    v_fma_f32 v236, v173, v242, v236
    v_fma_f32 v238, -v141, v242, v238
    v_cvt_pk_bf16_f32 v88, v235, v236
    v_cvt_pk_bf16_f32 v104, v237, v238
    v_cvt_pk_bf16_f32 v120, -v235, -v236
    v_fmamk_f32 v243, v228, 0x3c100000, v229
    v_cos_f32 v239, v243
    v_sin_f32 v240, v243
    v_mul_f32 v239, s4, v239
    v_mul_f32 v240, s4, v240
    v_mul_f32 v235, v142, v239
    v_mul_f32 v237, v174, v239
    v_fma_f32 v235, v174, v240, v235
    v_fma_f32 v237, -v142, v240, v237
    v_fmamk_f32 v243, v228, 0x3c180000, v229
    v_cos_f32 v241, v243
    v_sin_f32 v242, v243
    v_mul_f32 v241, s4, v241
    v_mul_f32 v242, s4, v242
    v_mul_f32 v236, v143, v241
    v_mul_f32 v238, v175, v241
    v_fma_f32 v236, v175, v242, v236
    v_fma_f32 v238, -v143, v242, v238
    v_cvt_pk_bf16_f32 v89, v235, v236
    v_cvt_pk_bf16_f32 v105, v237, v238
    v_cvt_pk_bf16_f32 v121, -v235, -v236
    v_fmamk_f32 v243, v228, 0x3c400000, v229
    v_cos_f32 v239, v243
    v_sin_f32 v240, v243
    v_mul_f32 v239, s4, v239
    v_mul_f32 v240, s4, v240
    v_mul_f32 v235, v144, v239
    v_mul_f32 v237, v176, v239
    v_fma_f32 v235, v176, v240, v235
    v_fma_f32 v237, -v144, v240, v237
    v_fmamk_f32 v243, v228, 0x3c480000, v229
    v_cos_f32 v241, v243
    v_sin_f32 v242, v243
    v_mul_f32 v241, s4, v241
    v_mul_f32 v242, s4, v242
    v_mul_f32 v236, v145, v241
    v_mul_f32 v238, v177, v241
    v_fma_f32 v236, v177, v242, v236
    v_fma_f32 v238, -v145, v242, v238
    v_cvt_pk_bf16_f32 v90, v235, v236
    v_cvt_pk_bf16_f32 v106, v237, v238
    v_cvt_pk_bf16_f32 v122, -v235, -v236
    v_fmamk_f32 v243, v228, 0x3c500000, v229
    v_cos_f32 v239, v243
    v_sin_f32 v240, v243
    v_mul_f32 v239, s4, v239
    v_mul_f32 v240, s4, v240
    v_mul_f32 v235, v146, v239
    v_mul_f32 v237, v178, v239
    v_fma_f32 v235, v178, v240, v235
    v_fma_f32 v237, -v146, v240, v237
    v_fmamk_f32 v243, v228, 0x3c580000, v229
    v_cos_f32 v241, v243
    v_sin_f32 v242, v243
    v_mul_f32 v241, s4, v241
    v_mul_f32 v242, s4, v242
    v_mul_f32 v236, v147, v241
    v_mul_f32 v238, v179, v241
    v_fma_f32 v236, v179, v242, v236
    v_fma_f32 v238, -v147, v242, v238
    v_cvt_pk_bf16_f32 v91, v235, v236
    v_cvt_pk_bf16_f32 v107, v237, v238
    v_cvt_pk_bf16_f32 v123, -v235, -v236
    v_fmamk_f32 v243, v228, 0x3c800000, v229
    v_cos_f32 v239, v243
    v_sin_f32 v240, v243
    v_mul_f32 v239, s4, v239
    v_mul_f32 v240, s4, v240
    v_mul_f32 v235, v148, v239
    v_mul_f32 v237, v180, v239
    v_fma_f32 v235, v180, v240, v235
    v_fma_f32 v237, -v148, v240, v237
    v_fmamk_f32 v243, v228, 0x3c840000, v229
    v_cos_f32 v241, v243
    v_sin_f32 v242, v243
    v_mul_f32 v241, s4, v241
    v_mul_f32 v242, s4, v242
    v_mul_f32 v236, v149, v241
    v_mul_f32 v238, v181, v241
    v_fma_f32 v236, v181, v242, v236
    v_fma_f32 v238, -v149, v242, v238
    v_cvt_pk_bf16_f32 v92, v235, v236
    v_cvt_pk_bf16_f32 v108, v237, v238
    v_cvt_pk_bf16_f32 v124, -v235, -v236
    v_fmamk_f32 v243, v228, 0x3c880000, v229
    v_cos_f32 v239, v243
    v_sin_f32 v240, v243
    v_mul_f32 v239, s4, v239
    v_mul_f32 v240, s4, v240
    v_mul_f32 v235, v150, v239
    v_mul_f32 v237, v182, v239
    v_fma_f32 v235, v182, v240, v235
    v_fma_f32 v237, -v150, v240, v237
    v_fmamk_f32 v243, v228, 0x3c8c0000, v229
    v_cos_f32 v241, v243
    v_sin_f32 v242, v243
    v_mul_f32 v241, s4, v241
    v_mul_f32 v242, s4, v242
    v_mul_f32 v236, v151, v241
    v_mul_f32 v238, v183, v241
    v_fma_f32 v236, v183, v242, v236
    v_fma_f32 v238, -v151, v242, v238
    v_cvt_pk_bf16_f32 v93, v235, v236
    v_cvt_pk_bf16_f32 v109, v237, v238
    v_cvt_pk_bf16_f32 v125, -v235, -v236
    v_fmamk_f32 v243, v228, 0x3ca00000, v229
    v_cos_f32 v239, v243
    v_sin_f32 v240, v243
    v_mul_f32 v239, s4, v239
    v_mul_f32 v240, s4, v240
    v_mul_f32 v235, v152, v239
    v_mul_f32 v237, v184, v239
    v_fma_f32 v235, v184, v240, v235
    v_fma_f32 v237, -v152, v240, v237
    v_fmamk_f32 v243, v228, 0x3ca40000, v229
    v_cos_f32 v241, v243
    v_sin_f32 v242, v243
    v_mul_f32 v241, s4, v241
    v_mul_f32 v242, s4, v242
    v_mul_f32 v236, v153, v241
    v_mul_f32 v238, v185, v241
    v_fma_f32 v236, v185, v242, v236
    v_fma_f32 v238, -v153, v242, v238
    v_cvt_pk_bf16_f32 v94, v235, v236
    v_cvt_pk_bf16_f32 v110, v237, v238
    v_cvt_pk_bf16_f32 v126, -v235, -v236
    v_fmamk_f32 v243, v228, 0x3ca80000, v229
    v_cos_f32 v239, v243
    v_sin_f32 v240, v243
    v_mul_f32 v239, s4, v239
    v_mul_f32 v240, s4, v240
    v_mul_f32 v235, v154, v239
    v_mul_f32 v237, v186, v239
    v_fma_f32 v235, v186, v240, v235
    v_fma_f32 v237, -v154, v240, v237
    v_fmamk_f32 v243, v228, 0x3cac0000, v229
    v_cos_f32 v241, v243
    v_sin_f32 v242, v243
    v_mul_f32 v241, s4, v241
    v_mul_f32 v242, s4, v242
    v_mul_f32 v236, v155, v241
    v_mul_f32 v238, v187, v241
    v_fma_f32 v236, v187, v242, v236
    v_fma_f32 v238, -v155, v242, v238
    v_cvt_pk_bf16_f32 v95, v235, v236
    v_cvt_pk_bf16_f32 v111, v237, v238
    v_cvt_pk_bf16_f32 v127, -v235, -v236
    v_fmamk_f32 v243, v228, 0x3cc00000, v229
    v_cos_f32 v239, v243
    v_sin_f32 v240, v243
    v_mul_f32 v239, s4, v239
    v_mul_f32 v240, s4, v240
    v_mul_f32 v235, v156, v239
    v_mul_f32 v237, v188, v239
    v_fma_f32 v235, v188, v240, v235
    v_fma_f32 v237, -v156, v240, v237
    v_fmamk_f32 v243, v228, 0x3cc40000, v229
    v_cos_f32 v241, v243
    v_sin_f32 v242, v243
    v_mul_f32 v241, s4, v241
    v_mul_f32 v242, s4, v242
    v_mul_f32 v236, v157, v241
    v_mul_f32 v238, v189, v241
    v_fma_f32 v236, v189, v242, v236
    v_fma_f32 v238, -v157, v242, v238
    v_cvt_pk_bf16_f32 v96, v235, v236
    v_cvt_pk_bf16_f32 v112, v237, v238
    v_cvt_pk_bf16_f32 v128, -v235, -v236
    v_fmamk_f32 v243, v228, 0x3cc80000, v229
    v_cos_f32 v239, v243
    v_sin_f32 v240, v243
    v_mul_f32 v239, s4, v239
    v_mul_f32 v240, s4, v240
    v_mul_f32 v235, v158, v239
    v_mul_f32 v237, v190, v239
    v_fma_f32 v235, v190, v240, v235
    v_fma_f32 v237, -v158, v240, v237
    v_fmamk_f32 v243, v228, 0x3ccc0000, v229
    v_cos_f32 v241, v243
    v_sin_f32 v242, v243
    v_mul_f32 v241, s4, v241
    v_mul_f32 v242, s4, v242
    v_mul_f32 v236, v159, v241
    v_mul_f32 v238, v191, v241
    v_fma_f32 v236, v191, v242, v236
    v_fma_f32 v238, -v159, v242, v238
    v_cvt_pk_bf16_f32 v97, v235, v236
    v_cvt_pk_bf16_f32 v113, v237, v238
    v_cvt_pk_bf16_f32 v129, -v235, -v236
    v_fmamk_f32 v243, v228, 0x3ce00000, v229
    v_cos_f32 v239, v243
    v_sin_f32 v240, v243
    v_mul_f32 v239, s4, v239
    v_mul_f32 v240, s4, v240
    v_mul_f32 v235, v160, v239
    v_mul_f32 v237, v192, v239
    v_fma_f32 v235, v192, v240, v235
    v_fma_f32 v237, -v160, v240, v237
    v_fmamk_f32 v243, v228, 0x3ce40000, v229
    v_cos_f32 v241, v243
    v_sin_f32 v242, v243
    v_mul_f32 v241, s4, v241
    v_mul_f32 v242, s4, v242
    v_mul_f32 v236, v161, v241
    v_mul_f32 v238, v193, v241
    v_fma_f32 v236, v193, v242, v236
    v_fma_f32 v238, -v161, v242, v238
    v_cvt_pk_bf16_f32 v98, v235, v236
    v_cvt_pk_bf16_f32 v114, v237, v238
    v_cvt_pk_bf16_f32 v130, -v235, -v236
    v_fmamk_f32 v243, v228, 0x3ce80000, v229
    v_cos_f32 v239, v243
    v_sin_f32 v240, v243
    v_mul_f32 v239, s4, v239
    v_mul_f32 v240, s4, v240
    v_mul_f32 v235, v162, v239
    v_mul_f32 v237, v194, v239
    v_fma_f32 v235, v194, v240, v235
    v_fma_f32 v237, -v162, v240, v237
    v_fmamk_f32 v243, v228, 0x3cec0000, v229
    v_cos_f32 v241, v243
    v_sin_f32 v242, v243
    v_mul_f32 v241, s4, v241
    v_mul_f32 v242, s4, v242
    v_mul_f32 v236, v163, v241
    v_mul_f32 v238, v195, v241
    v_fma_f32 v236, v195, v242, v236
    v_fma_f32 v238, -v163, v242, v238
    v_cvt_pk_bf16_f32 v99, v235, v236
    v_cvt_pk_bf16_f32 v115, v237, v238
    v_cvt_pk_bf16_f32 v131, -v235, -v236
    v_mfma_f32_32x32x16_bf16 v[132:147], v[4:7], v[84:87], 0
    v_mfma_f32_32x32x16_bf16 v[164:179], v[4:7], v[100:103], 0
    v_mfma_f32_32x32x16_bf16 v[132:147], v[36:39], v[100:103], v[132:147]
    v_mfma_f32_32x32x16_bf16 v[164:179], v[36:39], v[116:119], v[164:179]
    v_mfma_f32_32x32x16_bf16 v[132:147], v[8:11], v[88:91], v[132:147]
    v_mfma_f32_32x32x16_bf16 v[164:179], v[8:11], v[104:107], v[164:179]
    v_mfma_f32_32x32x16_bf16 v[132:147], v[40:43], v[104:107], v[132:147]
    v_mfma_f32_32x32x16_bf16 v[164:179], v[40:43], v[120:123], v[164:179]
    v_mfma_f32_32x32x16_bf16 v[132:147], v[12:15], v[92:95], v[132:147]
    v_mfma_f32_32x32x16_bf16 v[164:179], v[12:15], v[108:111], v[164:179]
    v_mfma_f32_32x32x16_bf16 v[132:147], v[44:47], v[108:111], v[132:147]
    v_mfma_f32_32x32x16_bf16 v[164:179], v[44:47], v[124:127], v[164:179]
    v_mfma_f32_32x32x16_bf16 v[132:147], v[16:19], v[96:99], v[132:147]
    v_mfma_f32_32x32x16_bf16 v[164:179], v[16:19], v[112:115], v[164:179]
    v_mfma_f32_32x32x16_bf16 v[132:147], v[48:51], v[112:115], v[132:147]
    v_mfma_f32_32x32x16_bf16 v[164:179], v[48:51], v[128:131], v[164:179]
    v_mfma_f32_32x32x16_bf16 v[148:163], v[20:23], v[84:87], 0
    v_mfma_f32_32x32x16_bf16 v[180:195], v[20:23], v[100:103], 0
    v_mfma_f32_32x32x16_bf16 v[148:163], v[52:55], v[100:103], v[148:163]
    v_mfma_f32_32x32x16_bf16 v[180:195], v[52:55], v[116:119], v[180:195]
    v_mfma_f32_32x32x16_bf16 v[148:163], v[24:27], v[88:91], v[148:163]
    v_mfma_f32_32x32x16_bf16 v[180:195], v[24:27], v[104:107], v[180:195]
    v_mfma_f32_32x32x16_bf16 v[148:163], v[56:59], v[104:107], v[148:163]
    v_mfma_f32_32x32x16_bf16 v[180:195], v[56:59], v[120:123], v[180:195]
    v_mfma_f32_32x32x16_bf16 v[148:163], v[28:31], v[92:95], v[148:163]
    v_mfma_f32_32x32x16_bf16 v[180:195], v[28:31], v[108:111], v[180:195]
    v_mfma_f32_32x32x16_bf16 v[148:163], v[60:63], v[108:111], v[148:163]
    v_mfma_f32_32x32x16_bf16 v[180:195], v[60:63], v[124:127], v[180:195]
    v_mfma_f32_32x32x16_bf16 v[148:163], v[32:35], v[96:99], v[148:163]
    v_mfma_f32_32x32x16_bf16 v[180:195], v[32:35], v[112:115], v[180:195]
    v_mfma_f32_32x32x16_bf16 v[148:163], v[64:67], v[112:115], v[148:163]
    v_mfma_f32_32x32x16_bf16 v[180:195], v[64:67], v[128:131], v[180:195]
    v_lshlrev_b32 v239, 16, v196
    v_and_b32 v240, 0xffff0000, v196
    v_mul_f32 v235, v132, v239
    v_mul_f32 v237, v164, v239
    v_fma_f32 v235, -v164, v240, v235
    v_fma_f32 v237, v132, v240, v237
    v_lshlrev_b32 v241, 16, v197
    v_and_b32 v242, 0xffff0000, v197
    v_mul_f32 v236, v133, v241
    v_mul_f32 v238, v165, v241
    v_fma_f32 v236, -v165, v242, v236
    v_fma_f32 v238, v133, v242, v238
    v_cvt_pk_bf16_f32 v84, v235, v236
    v_cvt_pk_bf16_f32 v100, v237, v238
    v_cvt_pk_bf16_f32 v116, -v237, -v238
    v_lshlrev_b32 v239, 16, v198
    v_and_b32 v240, 0xffff0000, v198
    v_mul_f32 v235, v134, v239
    v_mul_f32 v237, v166, v239
    v_fma_f32 v235, -v166, v240, v235
    v_fma_f32 v237, v134, v240, v237
    v_lshlrev_b32 v241, 16, v199
    v_and_b32 v242, 0xffff0000, v199
    v_mul_f32 v236, v135, v241
    v_mul_f32 v238, v167, v241
    v_fma_f32 v236, -v167, v242, v236
    v_fma_f32 v238, v135, v242, v238
    v_cvt_pk_bf16_f32 v85, v235, v236
    v_cvt_pk_bf16_f32 v101, v237, v238
    v_cvt_pk_bf16_f32 v117, -v237, -v238
    v_lshlrev_b32 v239, 16, v200
    v_and_b32 v240, 0xffff0000, v200
    v_mul_f32 v235, v136, v239
    v_mul_f32 v237, v168, v239
    v_fma_f32 v235, -v168, v240, v235
    v_fma_f32 v237, v136, v240, v237
    v_lshlrev_b32 v241, 16, v201
    v_and_b32 v242, 0xffff0000, v201
    v_mul_f32 v236, v137, v241
    v_mul_f32 v238, v169, v241
    v_fma_f32 v236, -v169, v242, v236
    v_fma_f32 v238, v137, v242, v238
    v_cvt_pk_bf16_f32 v86, v235, v236
    v_cvt_pk_bf16_f32 v102, v237, v238
    v_cvt_pk_bf16_f32 v118, -v237, -v238
    v_lshlrev_b32 v239, 16, v202
    v_and_b32 v240, 0xffff0000, v202
    v_mul_f32 v235, v138, v239
    v_mul_f32 v237, v170, v239
    v_fma_f32 v235, -v170, v240, v235
    v_fma_f32 v237, v138, v240, v237
    v_lshlrev_b32 v241, 16, v203
    v_and_b32 v242, 0xffff0000, v203
    v_mul_f32 v236, v139, v241
    v_mul_f32 v238, v171, v241
    v_fma_f32 v236, -v171, v242, v236
    v_fma_f32 v238, v139, v242, v238
    v_cvt_pk_bf16_f32 v87, v235, v236
    v_cvt_pk_bf16_f32 v103, v237, v238
    v_cvt_pk_bf16_f32 v119, -v237, -v238
    v_lshlrev_b32 v239, 16, v204
    v_and_b32 v240, 0xffff0000, v204
    v_mul_f32 v235, v140, v239
    v_mul_f32 v237, v172, v239
    v_fma_f32 v235, -v172, v240, v235
    v_fma_f32 v237, v140, v240, v237
    v_lshlrev_b32 v241, 16, v205
    v_and_b32 v242, 0xffff0000, v205
    v_mul_f32 v236, v141, v241
    v_mul_f32 v238, v173, v241
    v_fma_f32 v236, -v173, v242, v236
    v_fma_f32 v238, v141, v242, v238
    v_cvt_pk_bf16_f32 v88, v235, v236
    v_cvt_pk_bf16_f32 v104, v237, v238
    v_cvt_pk_bf16_f32 v120, -v237, -v238
    v_lshlrev_b32 v239, 16, v206
    v_and_b32 v240, 0xffff0000, v206
    v_mul_f32 v235, v142, v239
    v_mul_f32 v237, v174, v239
    v_fma_f32 v235, -v174, v240, v235
    v_fma_f32 v237, v142, v240, v237
    v_lshlrev_b32 v241, 16, v207
    v_and_b32 v242, 0xffff0000, v207
    v_mul_f32 v236, v143, v241
    v_mul_f32 v238, v175, v241
    v_fma_f32 v236, -v175, v242, v236
    v_fma_f32 v238, v143, v242, v238
    v_cvt_pk_bf16_f32 v89, v235, v236
    v_cvt_pk_bf16_f32 v105, v237, v238
    v_cvt_pk_bf16_f32 v121, -v237, -v238
    v_lshlrev_b32 v239, 16, v208
    v_and_b32 v240, 0xffff0000, v208
    v_mul_f32 v235, v144, v239
    v_mul_f32 v237, v176, v239
    v_fma_f32 v235, -v176, v240, v235
    v_fma_f32 v237, v144, v240, v237
    v_lshlrev_b32 v241, 16, v209
    v_and_b32 v242, 0xffff0000, v209
    v_mul_f32 v236, v145, v241
    v_mul_f32 v238, v177, v241
    v_fma_f32 v236, -v177, v242, v236
    v_fma_f32 v238, v145, v242, v238
    v_cvt_pk_bf16_f32 v90, v235, v236
    v_cvt_pk_bf16_f32 v106, v237, v238
    v_cvt_pk_bf16_f32 v122, -v237, -v238
    v_lshlrev_b32 v239, 16, v210
    v_and_b32 v240, 0xffff0000, v210
    v_mul_f32 v235, v146, v239
    v_mul_f32 v237, v178, v239
    v_fma_f32 v235, -v178, v240, v235
    v_fma_f32 v237, v146, v240, v237
    v_lshlrev_b32 v241, 16, v211
    v_and_b32 v242, 0xffff0000, v211
    v_mul_f32 v236, v147, v241
    v_mul_f32 v238, v179, v241
    v_fma_f32 v236, -v179, v242, v236
    v_fma_f32 v238, v147, v242, v238
    v_cvt_pk_bf16_f32 v91, v235, v236
    v_cvt_pk_bf16_f32 v107, v237, v238
    v_cvt_pk_bf16_f32 v123, -v237, -v238
    v_lshlrev_b32 v239, 16, v212
    v_and_b32 v240, 0xffff0000, v212
    v_mul_f32 v235, v148, v239
    v_mul_f32 v237, v180, v239
    v_fma_f32 v235, -v180, v240, v235
    v_fma_f32 v237, v148, v240, v237
    v_lshlrev_b32 v241, 16, v213
    v_and_b32 v242, 0xffff0000, v213
    v_mul_f32 v236, v149, v241
    v_mul_f32 v238, v181, v241
    v_fma_f32 v236, -v181, v242, v236
    v_fma_f32 v238, v149, v242, v238
    v_cvt_pk_bf16_f32 v92, v235, v236
    v_cvt_pk_bf16_f32 v108, v237, v238
    v_cvt_pk_bf16_f32 v124, -v237, -v238
    v_lshlrev_b32 v239, 16, v214
    v_and_b32 v240, 0xffff0000, v214
    v_mul_f32 v235, v150, v239
    v_mul_f32 v237, v182, v239
    v_fma_f32 v235, -v182, v240, v235
    v_fma_f32 v237, v150, v240, v237
    v_lshlrev_b32 v241, 16, v215
    v_and_b32 v242, 0xffff0000, v215
    v_mul_f32 v236, v151, v241
    v_mul_f32 v238, v183, v241
    v_fma_f32 v236, -v183, v242, v236
    v_fma_f32 v238, v151, v242, v238
    v_cvt_pk_bf16_f32 v93, v235, v236
    v_cvt_pk_bf16_f32 v109, v237, v238
    v_cvt_pk_bf16_f32 v125, -v237, -v238
    v_lshlrev_b32 v239, 16, v216
    v_and_b32 v240, 0xffff0000, v216
    v_mul_f32 v235, v152, v239
    v_mul_f32 v237, v184, v239
    v_fma_f32 v235, -v184, v240, v235
    v_fma_f32 v237, v152, v240, v237
    v_lshlrev_b32 v241, 16, v217
    v_and_b32 v242, 0xffff0000, v217
    v_mul_f32 v236, v153, v241
    v_mul_f32 v238, v185, v241
    v_fma_f32 v236, -v185, v242, v236
    v_fma_f32 v238, v153, v242, v238
    v_cvt_pk_bf16_f32 v94, v235, v236
    v_cvt_pk_bf16_f32 v110, v237, v238
    v_cvt_pk_bf16_f32 v126, -v237, -v238
    v_lshlrev_b32 v239, 16, v218
    v_and_b32 v240, 0xffff0000, v218
    v_mul_f32 v235, v154, v239
    v_mul_f32 v237, v186, v239
    v_fma_f32 v235, -v186, v240, v235
    v_fma_f32 v237, v154, v240, v237
    v_lshlrev_b32 v241, 16, v219
    v_and_b32 v242, 0xffff0000, v219
    v_mul_f32 v236, v155, v241
    v_mul_f32 v238, v187, v241
    v_fma_f32 v236, -v187, v242, v236
    v_fma_f32 v238, v155, v242, v238
    v_cvt_pk_bf16_f32 v95, v235, v236
    v_cvt_pk_bf16_f32 v111, v237, v238
    v_cvt_pk_bf16_f32 v127, -v237, -v238
    v_lshlrev_b32 v239, 16, v220
    v_and_b32 v240, 0xffff0000, v220
    v_mul_f32 v235, v156, v239
    v_mul_f32 v237, v188, v239
    v_fma_f32 v235, -v188, v240, v235
    v_fma_f32 v237, v156, v240, v237
    v_lshlrev_b32 v241, 16, v221
    v_and_b32 v242, 0xffff0000, v221
    v_mul_f32 v236, v157, v241
    v_mul_f32 v238, v189, v241
    v_fma_f32 v236, -v189, v242, v236
    v_fma_f32 v238, v157, v242, v238
    v_cvt_pk_bf16_f32 v96, v235, v236
    v_cvt_pk_bf16_f32 v112, v237, v238
    v_cvt_pk_bf16_f32 v128, -v237, -v238
    v_lshlrev_b32 v239, 16, v222
    v_and_b32 v240, 0xffff0000, v222
    v_mul_f32 v235, v158, v239
    v_mul_f32 v237, v190, v239
    v_fma_f32 v235, -v190, v240, v235
    v_fma_f32 v237, v158, v240, v237
    v_lshlrev_b32 v241, 16, v223
    v_and_b32 v242, 0xffff0000, v223
    v_mul_f32 v236, v159, v241
    v_mul_f32 v238, v191, v241
    v_fma_f32 v236, -v191, v242, v236
    v_fma_f32 v238, v159, v242, v238
    v_cvt_pk_bf16_f32 v97, v235, v236
    v_cvt_pk_bf16_f32 v113, v237, v238
    v_cvt_pk_bf16_f32 v129, -v237, -v238
    v_lshlrev_b32 v239, 16, v224
    v_and_b32 v240, 0xffff0000, v224
    v_mul_f32 v235, v160, v239
    v_mul_f32 v237, v192, v239
    v_fma_f32 v235, -v192, v240, v235
    v_fma_f32 v237, v160, v240, v237
    v_lshlrev_b32 v241, 16, v225
    v_and_b32 v242, 0xffff0000, v225
    v_mul_f32 v236, v161, v241
    v_mul_f32 v238, v193, v241
    v_fma_f32 v236, -v193, v242, v236
    v_fma_f32 v238, v161, v242, v238
    v_cvt_pk_bf16_f32 v98, v235, v236
    v_cvt_pk_bf16_f32 v114, v237, v238
    v_cvt_pk_bf16_f32 v130, -v237, -v238
    v_lshlrev_b32 v239, 16, v226
    v_and_b32 v240, 0xffff0000, v226
    v_mul_f32 v235, v162, v239
    v_mul_f32 v237, v194, v239
    v_fma_f32 v235, -v194, v240, v235
    v_fma_f32 v237, v162, v240, v237
    v_lshlrev_b32 v241, 16, v227
    v_and_b32 v242, 0xffff0000, v227
    v_mul_f32 v236, v163, v241
    v_mul_f32 v238, v195, v241
    v_fma_f32 v236, -v195, v242, v236
    v_fma_f32 v238, v163, v242, v238
    v_cvt_pk_bf16_f32 v99, v235, v236
    v_cvt_pk_bf16_f32 v115, v237, v238
    v_cvt_pk_bf16_f32 v131, -v237, -v238
    v_mfma_f32_32x32x16_bf16 v[132:147], v[84:87], v[4:7], 0
    v_mfma_f32_32x32x16_bf16 v[164:179], v[100:103], v[4:7], 0
    v_mfma_f32_32x32x16_bf16 v[132:147], v[116:119], v[36:39], v[132:147]
    v_mfma_f32_32x32x16_bf16 v[164:179], v[84:87], v[36:39], v[164:179]
    v_mfma_f32_32x32x16_bf16 v[132:147], v[88:91], v[8:11], v[132:147]
    v_mfma_f32_32x32x16_bf16 v[164:179], v[104:107], v[8:11], v[164:179]
    v_mfma_f32_32x32x16_bf16 v[132:147], v[120:123], v[40:43], v[132:147]
    v_mfma_f32_32x32x16_bf16 v[164:179], v[88:91], v[40:43], v[164:179]
    v_mfma_f32_32x32x16_bf16 v[132:147], v[92:95], v[12:15], v[132:147]
    v_mfma_f32_32x32x16_bf16 v[164:179], v[108:111], v[12:15], v[164:179]
    v_mfma_f32_32x32x16_bf16 v[132:147], v[124:127], v[44:47], v[132:147]
    v_mfma_f32_32x32x16_bf16 v[164:179], v[92:95], v[44:47], v[164:179]
    v_mfma_f32_32x32x16_bf16 v[132:147], v[96:99], v[16:19], v[132:147]
    v_mfma_f32_32x32x16_bf16 v[164:179], v[112:115], v[16:19], v[164:179]
    v_mfma_f32_32x32x16_bf16 v[132:147], v[128:131], v[48:51], v[132:147]
    v_mfma_f32_32x32x16_bf16 v[164:179], v[96:99], v[48:51], v[164:179]
    v_mfma_f32_32x32x16_bf16 v[148:163], v[84:87], v[20:23], 0
    v_mfma_f32_32x32x16_bf16 v[180:195], v[100:103], v[20:23], 0
    v_mfma_f32_32x32x16_bf16 v[148:163], v[116:119], v[52:55], v[148:163]
    v_mfma_f32_32x32x16_bf16 v[180:195], v[84:87], v[52:55], v[180:195]
    v_mfma_f32_32x32x16_bf16 v[148:163], v[88:91], v[24:27], v[148:163]
    v_mfma_f32_32x32x16_bf16 v[180:195], v[104:107], v[24:27], v[180:195]
    v_mfma_f32_32x32x16_bf16 v[148:163], v[120:123], v[56:59], v[148:163]
    v_mfma_f32_32x32x16_bf16 v[180:195], v[88:91], v[56:59], v[180:195]
    v_mfma_f32_32x32x16_bf16 v[148:163], v[92:95], v[28:31], v[148:163]
    v_mfma_f32_32x32x16_bf16 v[180:195], v[108:111], v[28:31], v[180:195]
    v_mfma_f32_32x32x16_bf16 v[148:163], v[124:127], v[60:63], v[148:163]
    v_mfma_f32_32x32x16_bf16 v[180:195], v[92:95], v[60:63], v[180:195]
    v_mfma_f32_32x32x16_bf16 v[148:163], v[96:99], v[32:35], v[148:163]
    v_mfma_f32_32x32x16_bf16 v[180:195], v[112:115], v[32:35], v[180:195]
    v_mfma_f32_32x32x16_bf16 v[148:163], v[128:131], v[64:67], v[148:163]
    v_mfma_f32_32x32x16_bf16 v[180:195], v[96:99], v[64:67], v[180:195]
    v_fmamk_f32 v243, v228, 0x0, v229
    v_cos_f32 v239, v243
    v_sin_f32 v240, v243
    v_mul_f32 v235, v132, v239
    v_mul_f32 v237, v164, v239
    v_fma_f32 v235, -v164, v240, v235
    v_fma_f32 v237, v132, v240, v237
    v_fmamk_f32 v243, v228, 0x3a000000, v229
    v_cos_f32 v241, v243
    v_sin_f32 v242, v243
    v_mul_f32 v236, v133, v241
    v_mul_f32 v238, v165, v241
    v_fma_f32 v236, -v165, v242, v236
    v_fma_f32 v238, v133, v242, v238
    v_cvt_pk_bf16_f32 v84, v235, v236
    v_cvt_pk_bf16_f32 v100, v237, v238
    v_cvt_pk_bf16_f32 v116, -v237, -v238
    v_fmamk_f32 v243, v228, 0x3a800000, v229
    v_cos_f32 v239, v243
    v_sin_f32 v240, v243
    v_mul_f32 v235, v134, v239
    v_mul_f32 v237, v166, v239
    v_fma_f32 v235, -v166, v240, v235
    v_fma_f32 v237, v134, v240, v237
    v_fmamk_f32 v243, v228, 0x3ac00000, v229
    v_cos_f32 v241, v243
    v_sin_f32 v242, v243
    v_mul_f32 v236, v135, v241
    v_mul_f32 v238, v167, v241
    v_fma_f32 v236, -v167, v242, v236
    v_fma_f32 v238, v135, v242, v238
    v_cvt_pk_bf16_f32 v85, v235, v236
    v_cvt_pk_bf16_f32 v101, v237, v238
    v_cvt_pk_bf16_f32 v117, -v237, -v238
    v_fmamk_f32 v243, v228, 0x3b800000, v229
    v_cos_f32 v239, v243
    v_sin_f32 v240, v243
    v_mul_f32 v235, v136, v239
    v_mul_f32 v237, v168, v239
    v_fma_f32 v235, -v168, v240, v235
    v_fma_f32 v237, v136, v240, v237
    v_fmamk_f32 v243, v228, 0x3b900000, v229
    v_cos_f32 v241, v243
    v_sin_f32 v242, v243
    v_mul_f32 v236, v137, v241
    v_mul_f32 v238, v169, v241
    v_fma_f32 v236, -v169, v242, v236
    v_fma_f32 v238, v137, v242, v238
    v_cvt_pk_bf16_f32 v86, v235, v236
    v_cvt_pk_bf16_f32 v102, v237, v238
    v_cvt_pk_bf16_f32 v118, -v237, -v238
    v_fmamk_f32 v243, v228, 0x3ba00000, v229
    v_cos_f32 v239, v243
    v_sin_f32 v240, v243
    v_mul_f32 v235, v138, v239
    v_mul_f32 v237, v170, v239
    v_fma_f32 v235, -v170, v240, v235
    v_fma_f32 v237, v138, v240, v237
    v_fmamk_f32 v243, v228, 0x3bb00000, v229
    v_cos_f32 v241, v243
    v_sin_f32 v242, v243
    v_mul_f32 v236, v139, v241
    v_mul_f32 v238, v171, v241
    v_fma_f32 v236, -v171, v242, v236
    v_fma_f32 v238, v139, v242, v238
    v_cvt_pk_bf16_f32 v87, v235, v236
    v_cvt_pk_bf16_f32 v103, v237, v238
    v_cvt_pk_bf16_f32 v119, -v237, -v238
    v_fmamk_f32 v243, v228, 0x3c000000, v229
    v_cos_f32 v239, v243
    v_sin_f32 v240, v243
    v_mul_f32 v235, v140, v239
    v_mul_f32 v237, v172, v239
    v_fma_f32 v235, -v172, v240, v235
    v_fma_f32 v237, v140, v240, v237
    v_fmamk_f32 v243, v228, 0x3c080000, v229
    v_cos_f32 v241, v243
    v_sin_f32 v242, v243
    v_mul_f32 v236, v141, v241
    v_mul_f32 v238, v173, v241
    v_fma_f32 v236, -v173, v242, v236
    v_fma_f32 v238, v141, v242, v238
    v_cvt_pk_bf16_f32 v88, v235, v236
    v_cvt_pk_bf16_f32 v104, v237, v238
    v_cvt_pk_bf16_f32 v120, -v237, -v238
    v_fmamk_f32 v243, v228, 0x3c100000, v229
    v_cos_f32 v239, v243
    v_sin_f32 v240, v243
    v_mul_f32 v235, v142, v239
    v_mul_f32 v237, v174, v239
    v_fma_f32 v235, -v174, v240, v235
    v_fma_f32 v237, v142, v240, v237
    v_fmamk_f32 v243, v228, 0x3c180000, v229
    v_cos_f32 v241, v243
    v_sin_f32 v242, v243
    v_mul_f32 v236, v143, v241
    v_mul_f32 v238, v175, v241
    v_fma_f32 v236, -v175, v242, v236
    v_fma_f32 v238, v143, v242, v238
    v_cvt_pk_bf16_f32 v89, v235, v236
    v_cvt_pk_bf16_f32 v105, v237, v238
    v_cvt_pk_bf16_f32 v121, -v237, -v238
    v_fmamk_f32 v243, v228, 0x3c400000, v229
    v_cos_f32 v239, v243
    v_sin_f32 v240, v243
    v_mul_f32 v235, v144, v239
    v_mul_f32 v237, v176, v239
    v_fma_f32 v235, -v176, v240, v235
    v_fma_f32 v237, v144, v240, v237
    v_fmamk_f32 v243, v228, 0x3c480000, v229
    v_cos_f32 v241, v243
    v_sin_f32 v242, v243
    v_mul_f32 v236, v145, v241
    v_mul_f32 v238, v177, v241
    v_fma_f32 v236, -v177, v242, v236
    v_fma_f32 v238, v145, v242, v238
    v_cvt_pk_bf16_f32 v90, v235, v236
    v_cvt_pk_bf16_f32 v106, v237, v238
    v_cvt_pk_bf16_f32 v122, -v237, -v238
    v_fmamk_f32 v243, v228, 0x3c500000, v229
    v_cos_f32 v239, v243
    v_sin_f32 v240, v243
    v_mul_f32 v235, v146, v239
    v_mul_f32 v237, v178, v239
    v_fma_f32 v235, -v178, v240, v235
    v_fma_f32 v237, v146, v240, v237
    v_fmamk_f32 v243, v228, 0x3c580000, v229
    v_cos_f32 v241, v243
    v_sin_f32 v242, v243
    v_mul_f32 v236, v147, v241
    v_mul_f32 v238, v179, v241
    v_fma_f32 v236, -v179, v242, v236
    v_fma_f32 v238, v147, v242, v238
    v_cvt_pk_bf16_f32 v91, v235, v236
    v_cvt_pk_bf16_f32 v107, v237, v238
    v_cvt_pk_bf16_f32 v123, -v237, -v238
    v_add_f32 v228, 0x42000000, v228
    v_mov_b32 v229, v230
    v_fmamk_f32 v243, v228, 0x0, v229
    v_cos_f32 v239, v243
    v_sin_f32 v240, v243
    v_mul_f32 v235, v148, v239
    v_mul_f32 v237, v180, v239
    v_fma_f32 v235, -v180, v240, v235
    v_fma_f32 v237, v148, v240, v237
    v_fmamk_f32 v243, v228, 0x3a000000, v229
    v_cos_f32 v241, v243
    v_sin_f32 v242, v243
    v_mul_f32 v236, v149, v241
    v_mul_f32 v238, v181, v241
    v_fma_f32 v236, -v181, v242, v236
    v_fma_f32 v238, v149, v242, v238
    v_cvt_pk_bf16_f32 v92, v235, v236
    v_cvt_pk_bf16_f32 v108, v237, v238
    v_cvt_pk_bf16_f32 v124, -v237, -v238
    v_fmamk_f32 v243, v228, 0x3a800000, v229
    v_cos_f32 v239, v243
    v_sin_f32 v240, v243
    v_mul_f32 v235, v150, v239
    v_mul_f32 v237, v182, v239
    v_fma_f32 v235, -v182, v240, v235
    v_fma_f32 v237, v150, v240, v237
    v_fmamk_f32 v243, v228, 0x3ac00000, v229
    v_cos_f32 v241, v243
    v_sin_f32 v242, v243
    v_mul_f32 v236, v151, v241
    v_mul_f32 v238, v183, v241
    v_fma_f32 v236, -v183, v242, v236
    v_fma_f32 v238, v151, v242, v238
    v_cvt_pk_bf16_f32 v93, v235, v236
    v_cvt_pk_bf16_f32 v109, v237, v238
    v_cvt_pk_bf16_f32 v125, -v237, -v238
    v_fmamk_f32 v243, v228, 0x3b800000, v229
    v_cos_f32 v239, v243
    v_sin_f32 v240, v243
    v_mul_f32 v235, v152, v239
    v_mul_f32 v237, v184, v239
    v_fma_f32 v235, -v184, v240, v235
    v_fma_f32 v237, v152, v240, v237
    v_fmamk_f32 v243, v228, 0x3b900000, v229
    v_cos_f32 v241, v243
    v_sin_f32 v242, v243
    v_mul_f32 v236, v153, v241
    v_mul_f32 v238, v185, v241
    v_fma_f32 v236, -v185, v242, v236
    v_fma_f32 v238, v153, v242, v238
    v_cvt_pk_bf16_f32 v94, v235, v236
    v_cvt_pk_bf16_f32 v110, v237, v238
    v_cvt_pk_bf16_f32 v126, -v237, -v238
    v_fmamk_f32 v243, v228, 0x3ba00000, v229
    v_cos_f32 v239, v243
    v_sin_f32 v240, v243
    v_mul_f32 v235, v154, v239
    v_mul_f32 v237, v186, v239
    v_fma_f32 v235, -v186, v240, v235
    v_fma_f32 v237, v154, v240, v237
    v_fmamk_f32 v243, v228, 0x3bb00000, v229
    v_cos_f32 v241, v243
    v_sin_f32 v242, v243
    v_mul_f32 v236, v155, v241
    v_mul_f32 v238, v187, v241
    v_fma_f32 v236, -v187, v242, v236
    v_fma_f32 v238, v155, v242, v238
    v_cvt_pk_bf16_f32 v95, v235, v236
    v_cvt_pk_bf16_f32 v111, v237, v238
    v_cvt_pk_bf16_f32 v127, -v237, -v238
    v_fmamk_f32 v243, v228, 0x3c000000, v229
    v_cos_f32 v239, v243
    v_sin_f32 v240, v243
    v_mul_f32 v235, v156, v239
    v_mul_f32 v237, v188, v239
    v_fma_f32 v235, -v188, v240, v235
    v_fma_f32 v237, v156, v240, v237
    v_fmamk_f32 v243, v228, 0x3c080000, v229
    v_cos_f32 v241, v243
    v_sin_f32 v242, v243
    v_mul_f32 v236, v157, v241
    v_mul_f32 v238, v189, v241
    v_fma_f32 v236, -v189, v242, v236
    v_fma_f32 v238, v157, v242, v238
    v_cvt_pk_bf16_f32 v96, v235, v236
    v_cvt_pk_bf16_f32 v112, v237, v238
    v_cvt_pk_bf16_f32 v128, -v237, -v238
    v_fmamk_f32 v243, v228, 0x3c100000, v229
    v_cos_f32 v239, v243
    v_sin_f32 v240, v243
    v_mul_f32 v235, v158, v239
    v_mul_f32 v237, v190, v239
    v_fma_f32 v235, -v190, v240, v235
    v_fma_f32 v237, v158, v240, v237
    v_fmamk_f32 v243, v228, 0x3c180000, v229
    v_cos_f32 v241, v243
    v_sin_f32 v242, v243
    v_mul_f32 v236, v159, v241
    v_mul_f32 v238, v191, v241
    v_fma_f32 v236, -v191, v242, v236
    v_fma_f32 v238, v159, v242, v238
    v_cvt_pk_bf16_f32 v97, v235, v236
    v_cvt_pk_bf16_f32 v113, v237, v238
    v_cvt_pk_bf16_f32 v129, -v237, -v238
    v_fmamk_f32 v243, v228, 0x3c400000, v229
    v_cos_f32 v239, v243
    v_sin_f32 v240, v243
    v_mul_f32 v235, v160, v239
    v_mul_f32 v237, v192, v239
    v_fma_f32 v235, -v192, v240, v235
    v_fma_f32 v237, v160, v240, v237
    v_fmamk_f32 v243, v228, 0x3c480000, v229
    v_cos_f32 v241, v243
    v_sin_f32 v242, v243
    v_mul_f32 v236, v161, v241
    v_mul_f32 v238, v193, v241
    v_fma_f32 v236, -v193, v242, v236
    v_fma_f32 v238, v161, v242, v238
    v_cvt_pk_bf16_f32 v98, v235, v236
    v_cvt_pk_bf16_f32 v114, v237, v238
    v_cvt_pk_bf16_f32 v130, -v237, -v238
    v_fmamk_f32 v243, v228, 0x3c500000, v229
    v_cos_f32 v239, v243
    v_sin_f32 v240, v243
    v_mul_f32 v235, v162, v239
    v_mul_f32 v237, v194, v239
    v_fma_f32 v235, -v194, v240, v235
    v_fma_f32 v237, v162, v240, v237
    v_fmamk_f32 v243, v228, 0x3c580000, v229
    v_cos_f32 v241, v243
    v_sin_f32 v242, v243
    v_mul_f32 v236, v163, v241
    v_mul_f32 v238, v195, v241
    v_fma_f32 v236, -v195, v242, v236
    v_fma_f32 v238, v163, v242, v238
    v_cvt_pk_bf16_f32 v99, v235, v236
    v_cvt_pk_bf16_f32 v115, v237, v238
    v_cvt_pk_bf16_f32 v131, -v237, -v238
    v_mfma_f32_32x32x16_bf16 v[132:147], v[68:71], v[84:87], 0
    v_mfma_f32_32x32x16_bf16 v[164:179], v[68:71], v[100:103], 0
    v_mfma_f32_32x32x16_bf16 v[132:147], v[76:79], v[116:119], v[132:147]
    v_mfma_f32_32x32x16_bf16 v[164:179], v[76:79], v[84:87], v[164:179]
    v_mfma_f32_32x32x16_bf16 v[132:147], v[72:75], v[88:91], v[132:147]
    v_mfma_f32_32x32x16_bf16 v[164:179], v[72:75], v[104:107], v[164:179]
    v_mfma_f32_32x32x16_bf16 v[132:147], v[80:83], v[120:123], v[132:147]
    v_mfma_f32_32x32x16_bf16 v[164:179], v[80:83], v[88:91], v[164:179]
    v_mfma_f32_32x32x16_bf16 v[148:163], v[68:71], v[92:95], 0
    v_mfma_f32_32x32x16_bf16 v[180:195], v[68:71], v[108:111], 0
    v_mfma_f32_32x32x16_bf16 v[148:163], v[76:79], v[124:127], v[148:163]
    v_mfma_f32_32x32x16_bf16 v[180:195], v[76:79], v[92:95], v[180:195]
    v_mfma_f32_32x32x16_bf16 v[148:163], v[72:75], v[96:99], v[148:163]
    v_mfma_f32_32x32x16_bf16 v[180:195], v[72:75], v[112:115], v[180:195]
    v_mfma_f32_32x32x16_bf16 v[148:163], v[80:83], v[128:131], v[148:163]
    v_mfma_f32_32x32x16_bf16 v[180:195], v[80:83], v[96:99], v[180:195]
    v_lshlrev_b32 v231, 4, v1
    v_add_u32 v232, s6, v231
    s_lshl_b32 s5, s3, 12
    s_add_u32 s5, s5, 0x5800000
    s_add_u32 s2, s5, 4096
    v_cvt_pk_bf16_f32 v84, v132, v133
    v_cvt_pk_bf16_f32 v85, v134, v135
    v_cvt_pk_bf16_f32 v86, v136, v137
    v_cvt_pk_bf16_f32 v87, v138, v139
    buffer_store_dwordx4 v[84:87], v231, s[8:11], s5 offen offset:0 sc1
    v_cvt_pk_bf16_f32 v88, v140, v141
    v_cvt_pk_bf16_f32 v89, v142, v143
    v_cvt_pk_bf16_f32 v90, v144, v145
    v_cvt_pk_bf16_f32 v91, v146, v147
    buffer_store_dwordx4 v[88:91], v231, s[8:11], s5 offen offset:1024 sc1
    v_cvt_pk_bf16_f32 v92, v148, v149
    v_cvt_pk_bf16_f32 v93, v150, v151
    v_cvt_pk_bf16_f32 v94, v152, v153
    v_cvt_pk_bf16_f32 v95, v154, v155
    buffer_store_dwordx4 v[92:95], v231, s[8:11], s5 offen offset:2048 sc1
    v_cvt_pk_bf16_f32 v96, v156, v157
    v_cvt_pk_bf16_f32 v97, v158, v159
    v_cvt_pk_bf16_f32 v98, v160, v161
    v_cvt_pk_bf16_f32 v99, v162, v163
    buffer_store_dwordx4 v[96:99], v231, s[8:11], s5 offen offset:3072 sc1
    v_cvt_pk_bf16_f32 v100, v164, v165
    v_cvt_pk_bf16_f32 v101, v166, v167
    v_cvt_pk_bf16_f32 v102, v168, v169
    v_cvt_pk_bf16_f32 v103, v170, v171
    buffer_store_dwordx4 v[100:103], v232, s[8:11], s2 offen offset:0 sc1
    v_cvt_pk_bf16_f32 v104, v172, v173
    v_cvt_pk_bf16_f32 v105, v174, v175
    v_cvt_pk_bf16_f32 v106, v176, v177
    v_cvt_pk_bf16_f32 v107, v178, v179
    buffer_store_dwordx4 v[104:107], v232, s[8:11], s2 offen offset:1024 sc1
    v_cvt_pk_bf16_f32 v108, v180, v181
    v_cvt_pk_bf16_f32 v109, v182, v183
    v_cvt_pk_bf16_f32 v110, v184, v185
    v_cvt_pk_bf16_f32 v111, v186, v187
    buffer_store_dwordx4 v[108:111], v232, s[8:11], s2 offen offset:2048 sc1
    v_cvt_pk_bf16_f32 v112, v188, v189
    v_cvt_pk_bf16_f32 v113, v190, v191
    v_cvt_pk_bf16_f32 v114, v192, v193
    v_cvt_pk_bf16_f32 v115, v194, v195
    buffer_store_dwordx4 v[112:115], v232, s[8:11], s2 offen offset:3072 sc1
    s_add_u32 s7, s7, 8
    s_cmp_lt_u32 s7, 16
    s_cbranch_scc1 colloop_81
    s_cmp_eq_u32 s3, 1008
    s_cbranch_scc1 colloop_81
    s_mov_b32 s83, 44
    s_branch next_46
p3_67:
    s_mov_b32 s84, 0
    s_mov_b64 s[60:61], s[8:9]
    s_mov_b32 s62, 0x10000000
    s_mov_b32 s63, 0x20000
    s_mov_b64 s[64:65], s[8:9]
    s_mov_b32 s66, 0x10000000
    s_mov_b32 s67, 0x20000
    v_lshrrev_b32 v76, 4, v1
    v_sub_u32 v76, 0, v76
    v_xor_b32 v76, v76, v1
    v_and_b32 v76, 3, v76
    s_mul_i32 s74, s58, 32
    v_lshrrev_b32 v77, 2, v1
    v_add3_u32 v77, v77, s74, 0
    v_bfe_u32 v68, v77, 0, 2
    v_lshlrev_b32 v68, 11, v68
    v_bfe_u32 v75, v77, 4, 1
    v_lshl_or_b32 v68, v75, 13, v68
    v_bfe_u32 v75, v77, 2, 2
    v_lshl_or_b32 v68, v75, 14, v68
    v_bfe_u32 v75, v77, 5, 3
    v_lshl_or_b32 v68, v75, 16, v68
    v_lshl_add_u32 v68, v76, 4, v68
    v_lshrrev_b32 v77, 2, v1
    v_add3_u32 v77, v77, s74, 16
    v_bfe_u32 v69, v77, 0, 2
    v_lshlrev_b32 v69, 11, v69
    v_bfe_u32 v75, v77, 4, 1
    v_lshl_or_b32 v69, v75, 13, v69
    v_bfe_u32 v75, v77, 2, 2
    v_lshl_or_b32 v69, v75, 14, v69
    v_bfe_u32 v75, v77, 5, 3
    v_lshl_or_b32 v69, v75, 16, v69
    v_lshl_add_u32 v69, v76, 4, v69
    s_and_b32 s74, s58, 2
    v_bfe_u32 v76, v1, 0, 5
    v_bfe_u32 v77, v1, 5, 1
    v_lshlrev_b32 v77, 2, v77
    v_xor_b32 v76, v76, v77
    v_xor_b32 v76, s74, v76
    v_lshlrev_b32 v77, 4, v76
    v_lshrrev_b32 v76, 5, v1
    v_lshl_add_u32 v70, v76, 12, v77
    v_bfe_u32 v76, v1, 0, 5
    v_bfe_u32 v77, v1, 5, 1
    v_lshlrev_b32 v77, 2, v77
    v_xor_b32 v76, v76, v77
    v_xor_b32 v76, s74, v76
    v_xor_b32 v76, 8, v76
    v_lshlrev_b32 v77, 4, v76
    v_lshrrev_b32 v76, 5, v1
    v_lshl_add_u32 v71, v76, 12, v77
    v_add_u32 v71, 8192, v71
    s_lshl_b32 s74, s58, 14
    v_add_u32 v70, s74, v70
    v_add_u32 v71, s74, v71
    s_mov_b32 s70, 131072
    s_and_b32 s79, s57, 3
    s_bfe_u32 s80, s76, 0x10002
    s_bfe_u32 s85, s76, 0x20005
    s_lshl_b32 s85, s85, 1
    s_or_b32 s80, s80, s85
    s_lshl_b32 s68, s79, 19
    s_add_u32 s68, s68, 0x5200000
    s_lshl_b32 s69, s80, 9
    s_add_u32 s69, s69, 0x5800000
    s_cmp_lg_u32 s58, 0
    s_cbranch_scc1 wall_83
    v_mov_b32 v76, 44
wctr_84:
    buffer_load_dword v75, v76, s[12:15], 0 offen sc1
    s_waitcnt vmcnt(0)
    v_cmp_gt_u16 vcc, 32, v75
    s_cbranch_vccz wctr_ok_85
    s_sub_u32 s77, s77, 1
    s_cbranch_scc0 wctr_84
    s_mov_b32 s77, 0
wctr_ok_85:
wall_83:
    s_barrier
    s_mul_i32 s71, s58, 2048
    s_mov_b32 m0, s71
    s_nop 0
    buffer_load_dwordx4 v68, s[60:63], s68 offen lds
    s_add_u32 m0, s71, 1024
    s_nop 0
    buffer_load_dwordx4 v69, s[60:63], s68 offen lds
    s_add_u32 m0, s71, 16384
    s_nop 0
    buffer_load_dwordx4 v70, s[64:67], s69 offen lds
    s_add_u32 m0, s71, 17408
    s_nop 0
    buffer_load_dwordx4 v71, s[64:67], s69 offen lds
    s_add_u32 s68, s68, 64
    s_add_u32 s69, s69, s70
    s_add_u32 s71, s71, 32768
    s_and_b32 s71, s71, 0x1ffff
    s_mov_b32 m0, s71
    s_nop 0
    buffer_load_dwordx4 v68, s[60:63], s68 offen lds
    s_add_u32 m0, s71, 1024
    s_nop 0
    buffer_load_dwordx4 v69, s[60:63], s68 offen lds
    s_add_u32 m0, s71, 16384
    s_nop 0
    buffer_load_dwordx4 v70, s[64:67], s69 offen lds
    s_add_u32 m0, s71, 17408
    s_nop 0
    buffer_load_dwordx4 v71, s[64:67], s69 offen lds
    s_add_u32 s68, s68, 64
    s_add_u32 s69, s69, s70
    s_add_u32 s71, s71, 32768
    s_and_b32 s71, s71, 0x1ffff
    s_mov_b32 m0, s71
    s_nop 0
    buffer_load_dwordx4 v68, s[60:63], s68 offen lds
    s_add_u32 m0, s71, 1024
    s_nop 0
    buffer_load_dwordx4 v69, s[60:63], s68 offen lds
    s_add_u32 m0, s71, 16384
    s_nop 0
    buffer_load_dwordx4 v70, s[64:67], s69 offen lds
    s_add_u32 m0, s71, 17408
    s_nop 0
    buffer_load_dwordx4 v71, s[64:67], s69 offen lds
    s_add_u32 s68, s68, 64
    s_add_u32 s69, s69, s70
    s_add_u32 s71, s71, 32768
    s_and_b32 s71, s71, 0x1ffff
    s_mov_b32 m0, s71
    s_nop 0
    buffer_load_dwordx4 v68, s[60:63], s68 offen lds
    s_add_u32 m0, s71, 1024
    s_nop 0
    buffer_load_dwordx4 v69, s[60:63], s68 offen lds
    s_add_u32 m0, s71, 16384
    s_nop 0
    buffer_load_dwordx4 v70, s[64:67], s69 offen lds
    s_add_u32 m0, s71, 17408
    s_nop 0
    buffer_load_dwordx4 v71, s[64:67], s69 offen lds
    s_add_u32 s68, s68, 64
    s_add_u32 s69, s69, s70
    s_add_u32 s71, s71, 32768
    s_and_b32 s71, s71, 0x1ffff
    s_branch t256_45
p3e_48:
    s_lshl_b32 s85, s80, 2
    s_and_b32 s81, s58, 3
    s_add_u32 s85, s85, s81
    s_lshl_b32 s85, s85, 6
    v_and_b32 v77, 15, v1
    v_add_u32 v77, s85, v77
    v_bfe_u32 v76, v77, 3, 5
    v_lshlrev_b32 v76, 12, v76
    v_bfe_u32 v75, v77, 10, 1
    v_lshl_or_b32 v76, v75, 17, v76
    v_bfe_u32 v75, v77, 0, 2
    v_lshl_or_b32 v76, v75, 18, v76
    v_bfe_u32 v75, v77, 8, 1
    v_lshl_or_b32 v76, v75, 20, v76
    v_bfe_u32 v75, v77, 2, 1
    v_lshl_or_b32 v76, v75, 21, v76
    v_bfe_u32 v75, v77, 9, 1
    v_lshl_or_b32 v76, v75, 22, v76
    v_bfe_u32 v77, v1, 4, 2
    v_lshlrev_b32 v77, 4, v77
    v_add_u32 v76, v76, v77
    s_lshl_b32 s81, s79, 9
    s_lshr_b32 s85, s58, 2
    s_lshl_b32 s85, s85, 8
    s_add_u32 s81, s81, s85
    v_cvt_pk_bf16_f32 v4, v80, v81
    v_cvt_pk_bf16_f32 v5, v82, v83
    v_cvt_pk_bf16_f32 v6, v96, v97
    v_cvt_pk_bf16_f32 v7, v98, v99
    buffer_store_dwordx4 v[4:7], v76, s[16:19], s81 offen offset:0
    v_cvt_pk_bf16_f32 v8, v112, v113
    v_cvt_pk_bf16_f32 v9, v114, v115
    v_cvt_pk_bf16_f32 v10, v128, v129
    v_cvt_pk_bf16_f32 v11, v130, v131
    buffer_store_dwordx4 v[8:11], v76, s[16:19], s81 offen offset:64
    v_cvt_pk_bf16_f32 v12, v144, v145
    v_cvt_pk_bf16_f32 v13, v146, v147
    v_cvt_pk_bf16_f32 v14, v160, v161
    v_cvt_pk_bf16_f32 v15, v162, v163
    buffer_store_dwordx4 v[12:15], v76, s[16:19], s81 offen offset:128
    v_cvt_pk_bf16_f32 v16, v176, v177
    v_cvt_pk_bf16_f32 v17, v178, v179
    v_cvt_pk_bf16_f32 v18, v192, v193
    v_cvt_pk_bf16_f32 v19, v194, v195
    buffer_store_dwordx4 v[16:19], v76, s[16:19], s81 offen offset:192
    s_add_u32 s81, s81, 8192
    v_cvt_pk_bf16_f32 v20, v84, v85
    v_cvt_pk_bf16_f32 v21, v86, v87
    v_cvt_pk_bf16_f32 v22, v100, v101
    v_cvt_pk_bf16_f32 v23, v102, v103
    buffer_store_dwordx4 v[20:23], v76, s[16:19], s81 offen offset:0
    v_cvt_pk_bf16_f32 v24, v116, v117
    v_cvt_pk_bf16_f32 v25, v118, v119
    v_cvt_pk_bf16_f32 v26, v132, v133
    v_cvt_pk_bf16_f32 v27, v134, v135
    buffer_store_dwordx4 v[24:27], v76, s[16:19], s81 offen offset:64
    v_cvt_pk_bf16_f32 v28, v148, v149
    v_cvt_pk_bf16_f32 v29, v150, v151
    v_cvt_pk_bf16_f32 v30, v164, v165
    v_cvt_pk_bf16_f32 v31, v166, v167
    buffer_store_dwordx4 v[28:31], v76, s[16:19], s81 offen offset:128
    v_cvt_pk_bf16_f32 v32, v180, v181
    v_cvt_pk_bf16_f32 v33, v182, v183
    v_cvt_pk_bf16_f32 v34, v196, v197
    v_cvt_pk_bf16_f32 v35, v198, v199
    buffer_store_dwordx4 v[32:35], v76, s[16:19], s81 offen offset:192
    s_add_u32 s81, s81, 8192
    v_cvt_pk_bf16_f32 v36, v88, v89
    v_cvt_pk_bf16_f32 v37, v90, v91
    v_cvt_pk_bf16_f32 v38, v104, v105
    v_cvt_pk_bf16_f32 v39, v106, v107
    buffer_store_dwordx4 v[36:39], v76, s[16:19], s81 offen offset:0
    v_cvt_pk_bf16_f32 v40, v120, v121
    v_cvt_pk_bf16_f32 v41, v122, v123
    v_cvt_pk_bf16_f32 v42, v136, v137
    v_cvt_pk_bf16_f32 v43, v138, v139
    buffer_store_dwordx4 v[40:43], v76, s[16:19], s81 offen offset:64
    v_cvt_pk_bf16_f32 v44, v152, v153
    v_cvt_pk_bf16_f32 v45, v154, v155
    v_cvt_pk_bf16_f32 v46, v168, v169
    v_cvt_pk_bf16_f32 v47, v170, v171
    buffer_store_dwordx4 v[44:47], v76, s[16:19], s81 offen offset:128
    v_cvt_pk_bf16_f32 v48, v184, v185
    v_cvt_pk_bf16_f32 v49, v186, v187
    v_cvt_pk_bf16_f32 v50, v200, v201
    v_cvt_pk_bf16_f32 v51, v202, v203
    buffer_store_dwordx4 v[48:51], v76, s[16:19], s81 offen offset:192
    s_add_u32 s81, s81, 8192
    v_cvt_pk_bf16_f32 v52, v92, v93
    v_cvt_pk_bf16_f32 v53, v94, v95
    v_cvt_pk_bf16_f32 v54, v108, v109
    v_cvt_pk_bf16_f32 v55, v110, v111
    buffer_store_dwordx4 v[52:55], v76, s[16:19], s81 offen offset:0
    v_cvt_pk_bf16_f32 v56, v124, v125
    v_cvt_pk_bf16_f32 v57, v126, v127
    v_cvt_pk_bf16_f32 v58, v140, v141
    v_cvt_pk_bf16_f32 v59, v142, v143
    buffer_store_dwordx4 v[56:59], v76, s[16:19], s81 offen offset:64
    v_cvt_pk_bf16_f32 v60, v156, v157
    v_cvt_pk_bf16_f32 v61, v158, v159
    v_cvt_pk_bf16_f32 v62, v172, v173
    v_cvt_pk_bf16_f32 v63, v174, v175
    buffer_store_dwordx4 v[60:63], v76, s[16:19], s81 offen offset:128
    v_cvt_pk_bf16_f32 v64, v188, v189
    v_cvt_pk_bf16_f32 v65, v190, v191
    v_cvt_pk_bf16_f32 v66, v204, v205
    v_cvt_pk_bf16_f32 v67, v206, v207
    buffer_store_dwordx4 v[64:67], v76, s[16:19], s81 offen offset:192
    s_add_u32 s81, s81, 8192
    s_branch end_72
r5_73:
    s_cmp_lt_u32 s57, 16
    s_cbranch_scc1 end_72
fol_69:
    s_bitcmp1_b32 s57, 3
    s_cbranch_scc1 nowo_86
    v_bfe_u32 v2, v1, 4, 2
    v_lshlrev_b32 v2, 2, v2
    v_xor_b32 v2, v2, v1
    v_bfe_u32 v4, v2, 0, 4
    v_lshlrev_b32 v4, 4, v4
    v_bfe_u32 v3, v2, 4, 2
    v_lshl_or_b32 v4, v3, 11, v4
    s_bfe_u32 s2, s58, 0x20000
    s_lshl_b32 s2, s2, 17
    s_bfe_u32 s4, s58, 0x10002
    s_lshl_b32 s4, s4, 20
    s_or_b32 s2, s2, s4
    s_lshl_b32 s4, s75, 21
    s_add_u32 s2, s2, s4
    s_bfe_u32 s4, s57, 0x30000
    s_lshl_b32 s4, s4, 8
    s_add_u32 s2, s2, s4
    s_lshl_b32 s3, s58, 14
    s_add_u32 m0, s3, 0
    s_nop 0
    buffer_load_dwordx4 v4, s[32:35], s2 offen lds
    s_add_u32 s2, s2, 0x2000
    s_add_u32 m0, s3, 1024
    s_nop 0
    buffer_load_dwordx4 v4, s[32:35], s2 offen lds
    s_add_u32 s2, s2, 0x2000
    s_add_u32 m0, s3, 2048
    s_nop 0
    buffer_load_dwordx4 v4, s[32:35], s2 offen lds
    s_add_u32 s2, s2, 0x2000
    s_add_u32 m0, s3, 3072
    s_nop 0
    buffer_load_dwordx4 v4, s[32:35], s2 offen lds
    s_add_u32 s2, s2, 0x2000
    s_add_u32 m0, s3, 4096
    s_nop 0
    buffer_load_dwordx4 v4, s[32:35], s2 offen lds
    s_add_u32 s2, s2, 0x2000
    s_add_u32 m0, s3, 5120
    s_nop 0
    buffer_load_dwordx4 v4, s[32:35], s2 offen lds
    s_add_u32 s2, s2, 0x2000
    s_add_u32 m0, s3, 6144
    s_nop 0
    buffer_load_dwordx4 v4, s[32:35], s2 offen lds
    s_add_u32 s2, s2, 0x2000
    s_add_u32 m0, s3, 7168
    s_nop 0
    buffer_load_dwordx4 v4, s[32:35], s2 offen lds
    s_add_u32 s2, s2, 0x2000
    s_add_u32 m0, s3, 8192
    s_nop 0
    buffer_load_dwordx4 v4, s[32:35], s2 offen lds
    s_add_u32 s2, s2, 0x2000
    s_add_u32 m0, s3, 9216
    s_nop 0
    buffer_load_dwordx4 v4, s[32:35], s2 offen lds
    s_add_u32 s2, s2, 0x2000
    s_add_u32 m0, s3, 10240
    s_nop 0
    buffer_load_dwordx4 v4, s[32:35], s2 offen lds
    s_add_u32 s2, s2, 0x2000
    s_add_u32 m0, s3, 11264
    s_nop 0
    buffer_load_dwordx4 v4, s[32:35], s2 offen lds
    s_add_u32 s2, s2, 0x2000
    s_add_u32 m0, s3, 12288
    s_nop 0
    buffer_load_dwordx4 v4, s[32:35], s2 offen lds
    s_add_u32 s2, s2, 0x2000
    s_add_u32 m0, s3, 13312
    s_nop 0
    buffer_load_dwordx4 v4, s[32:35], s2 offen lds
    s_add_u32 s2, s2, 0x2000
    s_add_u32 m0, s3, 14336
    s_nop 0
    buffer_load_dwordx4 v4, s[32:35], s2 offen lds
    s_add_u32 s2, s2, 0x2000
    s_add_u32 m0, s3, 15360
    s_nop 0
    buffer_load_dwordx4 v4, s[32:35], s2 offen lds
    s_add_u32 s2, s2, 0x2000
nowo_86:
    v_mov_b32 v75, 163760
    v_mov_b32 v76, 0
    ds_write_b32 v75, v76
    s_waitcnt lgkmcnt(0)
    s_cmp_lg_u32 s58, 0
    s_cbranch_scc1 wall_87
    v_mov_b32 v76, 148
wctr_88:
    buffer_load_dword v75, v76, s[12:15], 0 offen sc1
    s_waitcnt vmcnt(0)
    v_cmp_gt_u16 vcc, 128, v75
    s_cbranch_vccz wctr_ok_89
    s_sub_u32 s77, s77, 1
    s_cbranch_scc0 wctr_88
    s_mov_b32 s77, 0
wctr_ok_89:
wall_87:
    s_barrier
    s_cmp_ge_u32 s57, 16
    s_cbranch_scc1 wo_74
    v_lshlrev_b32 v5, 4, v1
    v_bfe_u32 v6, v1, 0, 3
    v_lshlrev_b32 v6, 4, v6
    v_bfe_u32 v3, v1, 5, 1
    v_lshl_or_b32 v6, v3, 7, v6
    v_lshlrev_b32 v7, 3, v1
    v_bfe_u32 v2, v1, 5, 1
    v_lshlrev_b32 v2, 2, v2
    v_and_b32 v8, 31, v1
    v_sub_u32 v8, v8, v2
    s_mov_b32 s89, 0x3e0293ee
    s_and_b32 s86, s57, 8
    s_cselect_b32 s92, 4, 8
    s_cselect_b32 s93, 64, 16
    s_add_u32 s86, s86, s57
    s_mov_b32 s91, 0
    s_mov_b32 s94, 0
    v_mov_b32 v9, 163760
    s_add_u32 s94, s94, 1
    s_cmp_lg_u32 s58, 0
    s_cbranch_scc1 at_f_93
    s_and_b32 s88, s86, s92
    s_cmp_eq_u32 s88, 4
    s_cbranch_scc1 at_rb_95
    s_and_b32 s88, s86, 56
pollrb_96:
    buffer_load_dword v2, off, s[12:15], s88 offset:128 sc1
    s_waitcnt vmcnt(0)
    v_lshrrev_b32 v3, 15, v2
    v_and_b32 v2, 0x7fff, v2
    v_min_u32 v2, v2, v3
    v_cmp_gt_u32 vcc, 32, v2
    s_cbranch_vccz pollrb_ok_97
    s_sub_u32 s77, s77, 1
    s_cbranch_scc0 pollrb_96
    s_mov_b32 s77, 0
pollrb_ok_97:
at_rb_95:
    v_mov_b32 v2, s94
    ds_write_b32 v9, v2
at_f_93:
    ds_read_b32 v2, v9
    s_waitcnt lgkmcnt(0)
    v_cmp_gt_u32 vcc, s94, v2
    s_cbranch_vccz at_d_94
    s_sub_u32 s77, s77, 1
    s_cbranch_scc0 at_f_93
    s_mov_b32 s77, 0
at_d_94:
    s_lshl_b32 s95, s86, 2
    s_add_u32 s95, s95, s75
    s_lshl_b32 s95, s95, 3
    s_add_u32 s95, s95, s58
    s_lshl_b32 s95, s95, 13
    s_add_u32 s88, s95, 0x0
    buffer_load_dwordx4 v[12:15], v5, s[8:11], s88 offen offset:0 sc1
    buffer_load_dwordx4 v[16:19], v5, s[8:11], s88 offen offset:1024 sc1
    buffer_load_dwordx4 v[20:23], v5, s[8:11], s88 offen offset:2048 sc1
    buffer_load_dwordx4 v[24:27], v5, s[8:11], s88 offen offset:3072 sc1
    s_add_u32 s88, s88, 4096
    buffer_load_dwordx4 v[28:31], v5, s[8:11], s88 offen offset:0 sc1
    buffer_load_dwordx4 v[32:35], v5, s[8:11], s88 offen offset:1024 sc1
    buffer_load_dwordx4 v[36:39], v5, s[8:11], s88 offen offset:2048 sc1
    buffer_load_dwordx4 v[40:43], v5, s[8:11], s88 offen offset:3072 sc1
    s_add_u32 s88, s95, 0x1000000
    buffer_load_dwordx4 v[44:47], v5, s[8:11], s88 offen offset:0 sc1
    buffer_load_dwordx4 v[48:51], v5, s[8:11], s88 offen offset:1024 sc1
    buffer_load_dwordx4 v[52:55], v5, s[8:11], s88 offen offset:2048 sc1
    buffer_load_dwordx4 v[56:59], v5, s[8:11], s88 offen offset:3072 sc1
    s_add_u32 s88, s88, 4096
    buffer_load_dwordx4 v[60:63], v5, s[8:11], s88 offen offset:0 sc1
    buffer_load_dwordx4 v[64:67], v5, s[8:11], s88 offen offset:1024 sc1
    buffer_load_dwordx4 v[68:71], v5, s[8:11], s88 offen offset:2048 sc1
    buffer_load_dwordx4 v[72:75], v5, s[8:11], s88 offen offset:3072 sc1
    s_add_u32 s88, s95, 0x2000000
    buffer_load_dwordx4 v[76:79], v5, s[8:11], s88 offen offset:0 sc1
    buffer_load_dwordx4 v[80:83], v5, s[8:11], s88 offen offset:1024 sc1
    buffer_load_dwordx4 v[84:87], v5, s[8:11], s88 offen offset:2048 sc1
    buffer_load_dwordx4 v[88:91], v5, s[8:11], s88 offen offset:3072 sc1
    s_add_u32 s88, s88, 4096
    buffer_load_dwordx4 v[92:95], v5, s[8:11], s88 offen offset:0 sc1
    buffer_load_dwordx4 v[96:99], v5, s[8:11], s88 offen offset:1024 sc1
    buffer_load_dwordx4 v[100:103], v5, s[8:11], s88 offen offset:2048 sc1
    buffer_load_dwordx4 v[104:107], v5, s[8:11], s88 offen offset:3072 sc1
at_loop_90:
    s_mov_b32 s90, s95
    s_add_u32 s94, s94, 1
    s_cmp_lg_u32 s58, 0
    s_cbranch_scc1 at_f_98
    s_cmp_ge_u32 s86, 48
    s_cselect_b32 s88, 1, 2
    s_add_u32 s88, s88, s86
    s_min_u32 s88, s88, 62
    s_cmp_ge_u32 s91, s88
    s_cbranch_scc1 at_go_92
pollprog_100:
    buffer_load_dword v4, off, s[12:15], 0 offset:64 sc1
    s_waitcnt vmcnt(0)
    v_cmp_gt_u32 vcc, s88, v4
    s_cbranch_vccz pollprog_ok_101
    s_sub_u32 s77, s77, 1
    s_cbranch_scc0 pollprog_100
    s_mov_b32 s77, 0
pollprog_ok_101:
    v_readfirstlane_b32 s91, v4
at_go_92:
    v_mov_b32 v2, s94
    ds_write_b32 v9, v2
at_f_98:
    ds_read_b32 v2, v9
    s_waitcnt lgkmcnt(0)
    v_cmp_gt_u32 vcc, s94, v2
    s_cbranch_vccz at_d_99
    s_sub_u32 s77, s77, 1
    s_cbranch_scc0 at_f_98
    s_mov_b32 s77, 0
at_d_99:
    s_lshr_b32 s88, s90, 2
    s_add_u32 s87, s88, 0x4400000
    s_add_u32 s88, s88, 0x4000000
    buffer_load_dwordx4 v[108:111], v6, s[8:11], s88 offen offset:0 sc1
    buffer_load_dwordx4 v[112:115], v6, s[8:11], s88 offen offset:256 sc1
    buffer_load_dwordx4 v[116:119], v6, s[8:11], s88 offen offset:512 sc1
    buffer_load_dwordx4 v[120:123], v6, s[8:11], s88 offen offset:768 sc1
    buffer_load_dwordx4 v[124:127], v6, s[8:11], s88 offen offset:1024 sc1
    buffer_load_dwordx4 v[128:131], v6, s[8:11], s88 offen offset:1280 sc1
    buffer_load_dwordx4 v[132:135], v6, s[8:11], s88 offen offset:1536 sc1
    buffer_load_dwordx4 v[136:139], v6, s[8:11], s88 offen offset:1792 sc1
    buffer_load_dwordx2 v[236:237], v7, s[8:11], s87 offen offset:0 sc1
    buffer_load_dwordx2 v[238:239], v7, s[8:11], s87 offen offset:512 sc1
    buffer_load_dwordx2 v[240:241], v7, s[8:11], s87 offen offset:1024 sc1
    buffer_load_dwordx2 v[242:243], v7, s[8:11], s87 offen offset:1536 sc1
    s_waitcnt vmcnt(27)
    v_mfma_f32_32x32x16_bf16 v[140:155], v[44:47], v[12:15], 0
    s_waitcnt vmcnt(26)
    v_mfma_f32_32x32x16_bf16 v[140:155], v[48:51], v[16:19], v[140:155]
    s_waitcnt vmcnt(25)
    v_mfma_f32_32x32x16_bf16 v[140:155], v[52:55], v[20:23], v[140:155]
    s_waitcnt vmcnt(24)
    v_mfma_f32_32x32x16_bf16 v[140:155], v[56:59], v[24:27], v[140:155]
    s_waitcnt vmcnt(23)
    v_mfma_f32_32x32x16_bf16 v[140:155], v[60:63], v[28:31], v[140:155]
    s_waitcnt vmcnt(22)
    v_mfma_f32_32x32x16_bf16 v[140:155], v[64:67], v[32:35], v[140:155]
    s_waitcnt vmcnt(21)
    v_mfma_f32_32x32x16_bf16 v[140:155], v[68:71], v[36:39], v[140:155]
    s_waitcnt vmcnt(20)
    v_mfma_f32_32x32x16_bf16 v[140:155], v[72:75], v[40:43], v[140:155]
    v_mov_b32 v3, 0xff800000
    v_cmp_le_i32 vcc, 0, v8
    s_nop 9
    v_cndmask_b32 v140, v3, v140, vcc
    v_cmp_le_i32 vcc, 1, v8
    s_nop 1
    v_cndmask_b32 v141, v3, v141, vcc
    v_cmp_le_i32 vcc, 2, v8
    s_nop 1
    v_cndmask_b32 v142, v3, v142, vcc
    v_cmp_le_i32 vcc, 3, v8
    s_nop 1
    v_cndmask_b32 v143, v3, v143, vcc
    v_cmp_le_i32 vcc, 8, v8
    s_nop 1
    v_cndmask_b32 v144, v3, v144, vcc
    v_cmp_le_i32 vcc, 9, v8
    s_nop 1
    v_cndmask_b32 v145, v3, v145, vcc
    v_cmp_le_i32 vcc, 10, v8
    s_nop 1
    v_cndmask_b32 v146, v3, v146, vcc
    v_cmp_le_i32 vcc, 11, v8
    s_nop 1
    v_cndmask_b32 v147, v3, v147, vcc
    v_cmp_le_i32 vcc, 16, v8
    s_nop 1
    v_cndmask_b32 v148, v3, v148, vcc
    v_cmp_le_i32 vcc, 17, v8
    s_nop 1
    v_cndmask_b32 v149, v3, v149, vcc
    v_cmp_le_i32 vcc, 18, v8
    s_nop 1
    v_cndmask_b32 v150, v3, v150, vcc
    v_cmp_le_i32 vcc, 19, v8
    s_nop 1
    v_cndmask_b32 v151, v3, v151, vcc
    v_cmp_le_i32 vcc, 24, v8
    s_nop 1
    v_cndmask_b32 v152, v3, v152, vcc
    v_cmp_le_i32 vcc, 25, v8
    s_nop 1
    v_cndmask_b32 v153, v3, v153, vcc
    v_cmp_le_i32 vcc, 26, v8
    s_nop 1
    v_cndmask_b32 v154, v3, v154, vcc
    v_cmp_le_i32 vcc, 27, v8
    s_nop 1
    v_cndmask_b32 v155, v3, v155, vcc
    v_max3_f32 v244, v140, v141, v142
    v_max3_f32 v244, v244, v143, v144
    v_max3_f32 v244, v244, v145, v146
    v_max3_f32 v244, v244, v147, v148
    v_max3_f32 v244, v244, v149, v150
    v_max3_f32 v244, v244, v151, v152
    v_max3_f32 v244, v244, v153, v154
    s_waitcnt vmcnt(0)
    v_max3_u32 v2, v108, v112, v116
    v_max3_u32 v2, v2, v120, v124
    v_max3_u32 v2, v2, v128, v132
    v_max_u32 v2, v2, v136
    v_cmp_eq_u32 vcc, -1, v2
    s_cbranch_vccz pollkm_ok_103
pollkm_102:
    buffer_load_dwordx4 v[108:111], v6, s[8:11], s88 offen offset:0 sc1
    buffer_load_dwordx4 v[112:115], v6, s[8:11], s88 offen offset:256 sc1
    buffer_load_dwordx4 v[116:119], v6, s[8:11], s88 offen offset:512 sc1
    buffer_load_dwordx4 v[120:123], v6, s[8:11], s88 offen offset:768 sc1
    buffer_load_dwordx4 v[124:127], v6, s[8:11], s88 offen offset:1024 sc1
    buffer_load_dwordx4 v[128:131], v6, s[8:11], s88 offen offset:1280 sc1
    buffer_load_dwordx4 v[132:135], v6, s[8:11], s88 offen offset:1536 sc1
    buffer_load_dwordx4 v[136:139], v6, s[8:11], s88 offen offset:1792 sc1
    buffer_load_dwordx2 v[236:237], v7, s[8:11], s87 offen offset:0 sc1
    buffer_load_dwordx2 v[238:239], v7, s[8:11], s87 offen offset:512 sc1
    buffer_load_dwordx2 v[240:241], v7, s[8:11], s87 offen offset:1024 sc1
    buffer_load_dwordx2 v[242:243], v7, s[8:11], s87 offen offset:1536 sc1
    s_waitcnt vmcnt(0)
    v_max3_u32 v2, v108, v112, v116
    v_max3_u32 v2, v2, v120, v124
    v_max3_u32 v2, v2, v128, v132
    v_max_u32 v2, v2, v136
    v_cmp_eq_u32 vcc, -1, v2
    s_cbranch_vccz pollkm_ok_103
    s_sub_u32 s77, s77, 1
    s_cbranch_scc0 pollkm_102
    s_mov_b32 s77, 0
pollkm_ok_103:
    v_mfma_f32_32x32x16_bf16 v[172:187], v[108:111], v[12:15], 0
    v_mfma_f32_32x32x16_bf16 v[156:171], v[112:115], v[16:19], 0
    v_mfma_f32_32x32x16_bf16 v[172:187], v[116:119], v[20:23], v[172:187]
    v_mfma_f32_32x32x16_bf16 v[156:171], v[120:123], v[24:27], v[156:171]
    v_mfma_f32_32x32x16_bf16 v[172:187], v[124:127], v[28:31], v[172:187]
    v_mfma_f32_32x32x16_bf16 v[156:171], v[128:131], v[32:35], v[156:171]
    v_mfma_f32_32x32x16_bf16 v[172:187], v[132:135], v[36:39], v[172:187]
    v_mfma_f32_32x32x16_bf16 v[156:171], v[136:139], v[40:43], v[156:171]
    v_max3_u32 v3, v236, v238, v240
    v_max_u32 v3, v3, v242
    v_cmp_eq_u32 vcc, -1, v3
    s_cbranch_vccz at_v_104
    buffer_load_dwordx2 v[236:237], v7, s[8:11], s87 offen offset:0 sc1
    buffer_load_dwordx2 v[238:239], v7, s[8:11], s87 offen offset:512 sc1
    buffer_load_dwordx2 v[240:241], v7, s[8:11], s87 offen offset:1024 sc1
    buffer_load_dwordx2 v[242:243], v7, s[8:11], s87 offen offset:1536 sc1
at_v_104:
    s_mov_b64 s[2:3], vcc
    s_add_u32 s86, s86, s92
    s_mov_b32 s95, 0x5ffffff0
    s_cmp_ge_u32 s86, s93
    s_cbranch_scc1 at_nf_105
    s_add_u32 s94, s94, 1
    s_cmp_lg_u32 s58, 0
    s_cbranch_scc1 at_f_106
    s_and_b32 s88, s86, s92
    s_cmp_eq_u32 s88, 4
    s_cbranch_scc1 at_rb_108
    s_and_b32 s88, s86, 56
pollrb_109:
    buffer_load_dword v2, off, s[12:15], s88 offset:128 sc1
    s_waitcnt vmcnt(0)
    v_lshrrev_b32 v3, 15, v2
    v_and_b32 v2, 0x7fff, v2
    v_min_u32 v2, v2, v3
    v_cmp_gt_u32 vcc, 32, v2
    s_cbranch_vccz pollrb_ok_110
    s_sub_u32 s77, s77, 1
    s_cbranch_scc0 pollrb_109
    s_mov_b32 s77, 0
pollrb_ok_110:
at_rb_108:
    v_mov_b32 v2, s94
    ds_write_b32 v9, v2
at_f_106:
    ds_read_b32 v2, v9
    s_waitcnt lgkmcnt(0)
    v_cmp_gt_u32 vcc, s94, v2
    s_cbranch_vccz at_d_107
    s_sub_u32 s77, s77, 1
    s_cbranch_scc0 at_f_106
    s_mov_b32 s77, 0
at_d_107:
    s_lshl_b32 s95, s86, 2
    s_add_u32 s95, s95, s75
    s_lshl_b32 s95, s95, 3
    s_add_u32 s95, s95, s58
    s_lshl_b32 s95, s95, 13
    s_add_u32 s88, s95, 0x0
    buffer_load_dwordx4 v[12:15], v5, s[8:11], s88 offen offset:0 sc1
    buffer_load_dwordx4 v[16:19], v5, s[8:11], s88 offen offset:1024 sc1
    buffer_load_dwordx4 v[20:23], v5, s[8:11], s88 offen offset:2048 sc1
    buffer_load_dwordx4 v[24:27], v5, s[8:11], s88 offen offset:3072 sc1
    s_add_u32 s88, s88, 4096
    buffer_load_dwordx4 v[28:31], v5, s[8:11], s88 offen offset:0 sc1
    buffer_load_dwordx4 v[32:35], v5, s[8:11], s88 offen offset:1024 sc1
    buffer_load_dwordx4 v[36:39], v5, s[8:11], s88 offen offset:2048 sc1
    buffer_load_dwordx4 v[40:43], v5, s[8:11], s88 offen offset:3072 sc1
    s_add_u32 s88, s95, 0x1000000
    buffer_load_dwordx4 v[44:47], v5, s[8:11], s88 offen offset:0 sc1
    buffer_load_dwordx4 v[48:51], v5, s[8:11], s88 offen offset:1024 sc1
    buffer_load_dwordx4 v[52:55], v5, s[8:11], s88 offen offset:2048 sc1
    buffer_load_dwordx4 v[56:59], v5, s[8:11], s88 offen offset:3072 sc1
    s_add_u32 s88, s88, 4096
    buffer_load_dwordx4 v[60:63], v5, s[8:11], s88 offen offset:0 sc1
    buffer_load_dwordx4 v[64:67], v5, s[8:11], s88 offen offset:1024 sc1
    buffer_load_dwordx4 v[68:71], v5, s[8:11], s88 offen offset:2048 sc1
    buffer_load_dwordx4 v[72:75], v5, s[8:11], s88 offen offset:3072 sc1
at_nf_105:
    s_nop 2
    v_pk_add_f32 v[156:157], v[156:157], v[172:173]
    v_pk_add_f32 v[158:159], v[158:159], v[174:175]
    v_max3_f32 v2, v244, v155, v156
    v_max3_f32 v2, v2, v157, v158
    v_max_f32 v2, v2, v159
    v_mov_b32 v3, v2
    s_nop 1
    v_permlane32_swap_b32 v2, v3
    v_max_f32 v2, v2, v3
    v_mul_f32 v2, s89, v2
    v_fma_f32 v140, v140, s89, -v2
    v_fma_f32 v141, v141, s89, -v2
    v_exp_f32 v140, v140
    v_exp_f32 v141, v141
    v_fma_f32 v142, v142, s89, -v2
    v_fma_f32 v143, v143, s89, -v2
    v_exp_f32 v142, v142
    v_exp_f32 v143, v143
    v_cvt_pk_bf16_f32 v244, v140, v141
    v_fma_f32 v144, v144, s89, -v2
    v_fma_f32 v145, v145, s89, -v2
    v_exp_f32 v144, v144
    v_exp_f32 v145, v145
    v_cvt_pk_bf16_f32 v245, v142, v143
    v_fma_f32 v146, v146, s89, -v2
    v_fma_f32 v147, v147, s89, -v2
    v_exp_f32 v146, v146
    v_exp_f32 v147, v147
    v_cvt_pk_bf16_f32 v246, v144, v145
    v_fma_f32 v148, v148, s89, -v2
    v_fma_f32 v149, v149, s89, -v2
    v_exp_f32 v148, v148
    v_exp_f32 v149, v149
    v_cvt_pk_bf16_f32 v247, v146, v147
    v_fma_f32 v150, v150, s89, -v2
    v_fma_f32 v151, v151, s89, -v2
    v_exp_f32 v150, v150
    v_exp_f32 v151, v151
    v_cvt_pk_bf16_f32 v248, v148, v149
    v_mfma_f32_32x32x16_bf16 v[172:187], v[76:79], v[244:247], 0
    v_fma_f32 v152, v152, s89, -v2
    v_fma_f32 v153, v153, s89, -v2
    v_exp_f32 v152, v152
    v_exp_f32 v153, v153
    v_cvt_pk_bf16_f32 v249, v150, v151
    v_mfma_f32_32x32x16_bf16 v[188:203], v[84:87], v[244:247], 0
    v_fma_f32 v154, v154, s89, -v2
    v_fma_f32 v155, v155, s89, -v2
    v_exp_f32 v154, v154
    v_exp_f32 v155, v155
    v_cvt_pk_bf16_f32 v250, v152, v153
    v_mfma_f32_32x32x16_bf16 v[204:219], v[92:95], v[244:247], 0
    v_fma_f32 v156, v156, s89, -v2
    v_fma_f32 v157, v157, s89, -v2
    v_exp_f32 v156, v156
    v_exp_f32 v157, v157
    v_cvt_pk_bf16_f32 v251, v154, v155
    v_mfma_f32_32x32x16_bf16 v[220:235], v[100:103], v[244:247], 0
    v_fma_f32 v158, v158, s89, -v2
    v_fma_f32 v159, v159, s89, -v2
    v_exp_f32 v158, v158
    v_exp_f32 v159, v159
    v_cvt_pk_bf16_f32 v252, v156, v157
    v_add_f32 v2, v140, v141
    v_cvt_pk_bf16_f32 v253, v158, v159
    v_mfma_f32_32x32x16_bf16 v[172:187], v[80:83], v[248:251], v[172:187]
    v_add_f32 v2, v2, v142
    v_add_f32 v2, v2, v143
    v_add_f32 v2, v2, v144
    v_add_f32 v2, v2, v145
    v_add_f32 v2, v2, v146
    v_mfma_f32_32x32x16_bf16 v[188:203], v[88:91], v[248:251], v[188:203]
    v_add_f32 v2, v2, v147
    v_add_f32 v2, v2, v148
    v_add_f32 v2, v2, v149
    v_add_f32 v2, v2, v150
    v_add_f32 v2, v2, v151
    v_mfma_f32_32x32x16_bf16 v[204:219], v[96:99], v[248:251], v[204:219]
    v_add_f32 v2, v2, v152
    v_add_f32 v2, v2, v153
    v_add_f32 v2, v2, v154
    v_add_f32 v2, v2, v155
    v_add_f32 v2, v2, v156
    v_mfma_f32_32x32x16_bf16 v[220:235], v[104:107], v[248:251], v[220:235]
    v_add_f32 v2, v2, v157
    v_add_f32 v2, v2, v158
    v_add_f32 v2, v2, v159
    s_cmp_eq_u64 s[2:3], 0
    s_cbranch_scc1 at_vok_111
    s_waitcnt vmcnt(0)
    v_max3_u32 v3, v236, v238, v240
    v_max_u32 v3, v3, v242
    v_cmp_eq_u32 vcc, -1, v3
    s_cbranch_vccz pollvm_ok_113
pollvm_112:
    buffer_load_dwordx2 v[236:237], v7, s[8:11], s87 offen offset:0 sc1
    buffer_load_dwordx2 v[238:239], v7, s[8:11], s87 offen offset:512 sc1
    buffer_load_dwordx2 v[240:241], v7, s[8:11], s87 offen offset:1024 sc1
    buffer_load_dwordx2 v[242:243], v7, s[8:11], s87 offen offset:1536 sc1
    s_waitcnt vmcnt(0)
    v_max3_u32 v3, v236, v238, v240
    v_max_u32 v3, v3, v242
    v_cmp_eq_u32 vcc, -1, v3
    s_cbranch_vccz pollvm_ok_113
    s_sub_u32 s77, s77, 1
    s_cbranch_scc0 pollvm_112
    s_mov_b32 s77, 0
pollvm_ok_113:
at_vok_111:
    v_mfma_f32_32x32x8_bf16 v[172:187], v[236:237], v[252:253], v[172:187]
    v_mov_b32 v3, v2
    s_add_u32 s87, s90, 0x3000000
    v_mfma_f32_32x32x8_bf16 v[188:203], v[238:239], v[252:253], v[188:203]
    v_permlane32_swap_b32 v2, v3
    v_add_f32 v2, v2, v3
    v_rcp_f32 v2, v2
    v_mfma_f32_32x32x8_bf16 v[204:219], v[240:241], v[252:253], v[204:219]
    v_mfma_f32_32x32x8_bf16 v[220:235], v[242:243], v[252:253], v[220:235]
    s_nop 3
    v_pk_mul_f32 v[172:173], v[172:173], v[2:3] op_sel_hi:[1,0]
    v_pk_mul_f32 v[174:175], v[174:175], v[2:3] op_sel_hi:[1,0]
    v_pk_mul_f32 v[176:177], v[176:177], v[2:3] op_sel_hi:[1,0]
    v_pk_mul_f32 v[178:179], v[178:179], v[2:3] op_sel_hi:[1,0]
    v_cvt_pk_bf16_f32 v108, v172, v173
    v_cvt_pk_bf16_f32 v109, v174, v175
    v_cvt_pk_bf16_f32 v110, v176, v177
    v_cvt_pk_bf16_f32 v111, v178, v179
    buffer_store_dwordx4 v[108:111], v5, s[8:11], s87 offen offset:0
    v_pk_mul_f32 v[180:181], v[180:181], v[2:3] op_sel_hi:[1,0]
    v_pk_mul_f32 v[182:183], v[182:183], v[2:3] op_sel_hi:[1,0]
    v_pk_mul_f32 v[184:185], v[184:185], v[2:3] op_sel_hi:[1,0]
    v_pk_mul_f32 v[186:187], v[186:187], v[2:3] op_sel_hi:[1,0]
    v_cvt_pk_bf16_f32 v112, v180, v181
    v_cvt_pk_bf16_f32 v113, v182, v183
    v_cvt_pk_bf16_f32 v114, v184, v185
    v_cvt_pk_bf16_f32 v115, v186, v187
    buffer_store_dwordx4 v[112:115], v5, s[8:11], s87 offen offset:1024
    v_pk_mul_f32 v[188:189], v[188:189], v[2:3] op_sel_hi:[1,0]
    v_pk_mul_f32 v[190:191], v[190:191], v[2:3] op_sel_hi:[1,0]
    v_pk_mul_f32 v[192:193], v[192:193], v[2:3] op_sel_hi:[1,0]
    v_pk_mul_f32 v[194:195], v[194:195], v[2:3] op_sel_hi:[1,0]
    v_cvt_pk_bf16_f32 v116, v188, v189
    v_cvt_pk_bf16_f32 v117, v190, v191
    v_cvt_pk_bf16_f32 v118, v192, v193
    v_cvt_pk_bf16_f32 v119, v194, v195
    buffer_store_dwordx4 v[116:119], v5, s[8:11], s87 offen offset:2048
    v_pk_mul_f32 v[196:197], v[196:197], v[2:3] op_sel_hi:[1,0]
    v_pk_mul_f32 v[198:199], v[198:199], v[2:3] op_sel_hi:[1,0]
    v_pk_mul_f32 v[200:201], v[200:201], v[2:3] op_sel_hi:[1,0]
    v_pk_mul_f32 v[202:203], v[202:203], v[2:3] op_sel_hi:[1,0]
    v_cvt_pk_bf16_f32 v120, v196, v197
    v_cvt_pk_bf16_f32 v121, v198, v199
    v_cvt_pk_bf16_f32 v122, v200, v201
    v_cvt_pk_bf16_f32 v123, v202, v203
    buffer_store_dwordx4 v[120:123], v5, s[8:11], s87 offen offset:3072
    v_pk_mul_f32 v[204:205], v[204:205], v[2:3] op_sel_hi:[1,0]
    v_pk_mul_f32 v[206:207], v[206:207], v[2:3] op_sel_hi:[1,0]
    v_pk_mul_f32 v[208:209], v[208:209], v[2:3] op_sel_hi:[1,0]
    v_pk_mul_f32 v[210:211], v[210:211], v[2:3] op_sel_hi:[1,0]
    v_cvt_pk_bf16_f32 v124, v204, v205
    v_cvt_pk_bf16_f32 v125, v206, v207
    v_cvt_pk_bf16_f32 v126, v208, v209
    v_cvt_pk_bf16_f32 v127, v210, v211
    s_add_u32 s87, s87, 4096
    buffer_store_dwordx4 v[124:127], v5, s[8:11], s87 offen offset:0
    v_pk_mul_f32 v[212:213], v[212:213], v[2:3] op_sel_hi:[1,0]
    v_pk_mul_f32 v[214:215], v[214:215], v[2:3] op_sel_hi:[1,0]
    v_pk_mul_f32 v[216:217], v[216:217], v[2:3] op_sel_hi:[1,0]
    v_pk_mul_f32 v[218:219], v[218:219], v[2:3] op_sel_hi:[1,0]
    v_cvt_pk_bf16_f32 v128, v212, v213
    v_cvt_pk_bf16_f32 v129, v214, v215
    v_cvt_pk_bf16_f32 v130, v216, v217
    v_cvt_pk_bf16_f32 v131, v218, v219
    buffer_store_dwordx4 v[128:131], v5, s[8:11], s87 offen offset:1024
    v_pk_mul_f32 v[220:221], v[220:221], v[2:3] op_sel_hi:[1,0]
    v_pk_mul_f32 v[222:223], v[222:223], v[2:3] op_sel_hi:[1,0]
    v_pk_mul_f32 v[224:225], v[224:225], v[2:3] op_sel_hi:[1,0]
    v_pk_mul_f32 v[226:227], v[226:227], v[2:3] op_sel_hi:[1,0]
    v_cvt_pk_bf16_f32 v132, v220, v221
    v_cvt_pk_bf16_f32 v133, v222, v223
    v_cvt_pk_bf16_f32 v134, v224, v225
    v_cvt_pk_bf16_f32 v135, v226, v227
    buffer_store_dwordx4 v[132:135], v5, s[8:11], s87 offen offset:2048
    v_pk_mul_f32 v[228:229], v[228:229], v[2:3] op_sel_hi:[1,0]
    v_pk_mul_f32 v[230:231], v[230:231], v[2:3] op_sel_hi:[1,0]
    v_pk_mul_f32 v[232:233], v[232:233], v[2:3] op_sel_hi:[1,0]
    v_pk_mul_f32 v[234:235], v[234:235], v[2:3] op_sel_hi:[1,0]
    v_cvt_pk_bf16_f32 v136, v228, v229
    v_cvt_pk_bf16_f32 v137, v230, v231
    v_cvt_pk_bf16_f32 v138, v232, v233
    v_cvt_pk_bf16_f32 v139, v234, v235
    buffer_store_dwordx4 v[136:139], v5, s[8:11], s87 offen offset:3072
    s_add_u32 s88, s95, 0x2000000
    buffer_load_dwordx4 v[76:79], v5, s[8:11], s88 offen offset:0 sc1
    buffer_load_dwordx4 v[80:83], v5, s[8:11], s88 offen offset:1024 sc1
    buffer_load_dwordx4 v[84:87], v5, s[8:11], s88 offen offset:2048 sc1
    buffer_load_dwordx4 v[88:91], v5, s[8:11], s88 offen offset:3072 sc1
    s_add_u32 s88, s88, 4096
    buffer_load_dwordx4 v[92:95], v5, s[8:11], s88 offen offset:0 sc1
    buffer_load_dwordx4 v[96:99], v5, s[8:11], s88 offen offset:1024 sc1
    buffer_load_dwordx4 v[100:103], v5, s[8:11], s88 offen offset:2048 sc1
    buffer_load_dwordx4 v[104:107], v5, s[8:11], s88 offen offset:3072 sc1
    s_bfe_u32 s87, s90, 0x3000d
    s_lshl_b32 s87, s87, 2
    s_bfe_u32 s88, s90, 0x80010
    s_lshl_b32 s88, s88, 7
    s_or_b32 s87, s87, s88
    s_add_u32 s87, s87, 0x5100000
    v_mov_b32 v2, 1
    s_waitcnt vmcnt(8)
    buffer_store_dword v2, off, s[8:11], s87
    s_cmp_lt_u32 s86, s93
    s_cbranch_scc1 at_loop_90
    s_cmp_ge_u32 s57, 8
    s_cbranch_scc1 end_72
wo_74:
    v_bfe_u32 v2, v1, 4, 2
    v_lshlrev_b32 v2, 2, v2
    v_xor_b32 v2, v2, v1
    v_bfe_u32 v4, v2, 0, 4
    v_lshlrev_b32 v4, 4, v4
    v_bfe_u32 v3, v2, 4, 2
    v_lshl_or_b32 v4, v3, 11, v4
    s_bfe_u32 s2, s58, 0x20000
    s_lshl_b32 s2, s2, 17
    s_bfe_u32 s4, s58, 0x10002
    s_lshl_b32 s4, s4, 20
    s_or_b32 s2, s2, s4
    s_lshl_b32 s4, s75, 21
    s_add_u32 s2, s2, s4
    s_bfe_u32 s4, s57, 0x30000
    s_lshl_b32 s4, s4, 8
    s_add_u32 s2, s2, s4
    s_lshl_b32 s3, s58, 14
    s_add_u32 s2, s2, 0x80000
    v_bfe_u32 v5, v1, 0, 2
    v_lshlrev_b32 v5, 3, v5
    v_bfe_u32 v3, v1, 4, 1
    v_lshl_or_b32 v5, v3, 5, v5
    v_bfe_u32 v3, v1, 2, 2
    v_lshl_or_b32 v5, v3, 6, v5
    v_bfe_u32 v3, v1, 2, 2
    v_lshl_or_b32 v5, v3, 8, v5
    v_bfe_u32 v3, v1, 5, 1
    v_lshl_or_b32 v5, v3, 10, v5
    s_bfe_u32 s4, s58, 0x20000
    s_lshl_b32 s4, s4, 6
    s_bfe_u32 s5, s58, 0x10002
    s_lshl_b32 s5, s5, 16
    s_or_b32 s4, s4, s5
    v_xor_b32 v5, s4, v5
    s_waitcnt vmcnt(0)
    s_barrier
    ds_read_b64_tr_b16 v[128:129], v5 offset:0
    ds_read_b64_tr_b16 v[130:131], v5 offset:2048
    ds_read_b64_tr_b16 v[132:133], v5 offset:4096
    ds_read_b64_tr_b16 v[134:135], v5 offset:6144
    ds_read_b64_tr_b16 v[136:137], v5 offset:8192
    ds_read_b64_tr_b16 v[138:139], v5 offset:10240
    ds_read_b64_tr_b16 v[140:141], v5 offset:12288
    ds_read_b64_tr_b16 v[142:143], v5 offset:14336
    s_waitcnt lgkmcnt(0)
    ds_read_b64_tr_b16 v[144:145], v5 offset:16384
    ds_read_b64_tr_b16 v[146:147], v5 offset:18432
    ds_read_b64_tr_b16 v[148:149], v5 offset:20480
    ds_read_b64_tr_b16 v[150:151], v5 offset:22528
    ds_read_b64_tr_b16 v[152:153], v5 offset:24576
    ds_read_b64_tr_b16 v[154:155], v5 offset:26624
    ds_read_b64_tr_b16 v[156:157], v5 offset:28672
    ds_read_b64_tr_b16 v[158:159], v5 offset:30720
    s_waitcnt lgkmcnt(0)
    ds_read_b64_tr_b16 v[160:161], v5 offset:32768
    ds_read_b64_tr_b16 v[162:163], v5 offset:34816
    ds_read_b64_tr_b16 v[164:165], v5 offset:36864
    ds_read_b64_tr_b16 v[166:167], v5 offset:38912
    ds_read_b64_tr_b16 v[168:169], v5 offset:40960
    ds_read_b64_tr_b16 v[170:171], v5 offset:43008
    ds_read_b64_tr_b16 v[172:173], v5 offset:45056
    ds_read_b64_tr_b16 v[174:175], v5 offset:47104
    s_waitcnt lgkmcnt(0)
    ds_read_b64_tr_b16 v[176:177], v5 offset:49152
    ds_read_b64_tr_b16 v[178:179], v5 offset:51200
    ds_read_b64_tr_b16 v[180:181], v5 offset:53248
    ds_read_b64_tr_b16 v[182:183], v5 offset:55296
    ds_read_b64_tr_b16 v[184:185], v5 offset:57344
    ds_read_b64_tr_b16 v[186:187], v5 offset:59392
    ds_read_b64_tr_b16 v[188:189], v5 offset:61440
    ds_read_b64_tr_b16 v[190:191], v5 offset:63488
    s_waitcnt lgkmcnt(0)
    s_barrier
    s_add_u32 m0, s3, 0
    s_nop 0
    buffer_load_dwordx4 v4, s[32:35], s2 offen lds
    s_add_u32 s2, s2, 0x2000
    s_add_u32 m0, s3, 1024
    s_nop 0
    buffer_load_dwordx4 v4, s[32:35], s2 offen lds
    s_add_u32 s2, s2, 0x2000
    s_add_u32 m0, s3, 2048
    s_nop 0
    buffer_load_dwordx4 v4, s[32:35], s2 offen lds
    s_add_u32 s2, s2, 0x2000
    s_add_u32 m0, s3, 3072
    s_nop 0
    buffer_load_dwordx4 v4, s[32:35], s2 offen lds
    s_add_u32 s2, s2, 0x2000
    s_add_u32 m0, s3, 4096
    s_nop 0
    buffer_load_dwordx4 v4, s[32:35], s2 offen lds
    s_add_u32 s2, s2, 0x2000
    s_add_u32 m0, s3, 5120
    s_nop 0
    buffer_load_dwordx4 v4, s[32:35], s2 offen lds
    s_add_u32 s2, s2, 0x2000
    s_add_u32 m0, s3, 6144
    s_nop 0
    buffer_load_dwordx4 v4, s[32:35], s2 offen lds
    s_add_u32 s2, s2, 0x2000
    s_add_u32 m0, s3, 7168
    s_nop 0
    buffer_load_dwordx4 v4, s[32:35], s2 offen lds
    s_add_u32 s2, s2, 0x2000
    s_add_u32 m0, s3, 8192
    s_nop 0
    buffer_load_dwordx4 v4, s[32:35], s2 offen lds
    s_add_u32 s2, s2, 0x2000
    s_add_u32 m0, s3, 9216
    s_nop 0
    buffer_load_dwordx4 v4, s[32:35], s2 offen lds
    s_add_u32 s2, s2, 0x2000
    s_add_u32 m0, s3, 10240
    s_nop 0
    buffer_load_dwordx4 v4, s[32:35], s2 offen lds
    s_add_u32 s2, s2, 0x2000
    s_add_u32 m0, s3, 11264
    s_nop 0
    buffer_load_dwordx4 v4, s[32:35], s2 offen lds
    s_add_u32 s2, s2, 0x2000
    s_add_u32 m0, s3, 12288
    s_nop 0
    buffer_load_dwordx4 v4, s[32:35], s2 offen lds
    s_add_u32 s2, s2, 0x2000
    s_add_u32 m0, s3, 13312
    s_nop 0
    buffer_load_dwordx4 v4, s[32:35], s2 offen lds
    s_add_u32 s2, s2, 0x2000
    s_add_u32 m0, s3, 14336
    s_nop 0
    buffer_load_dwordx4 v4, s[32:35], s2 offen lds
    s_add_u32 s2, s2, 0x2000
    s_add_u32 m0, s3, 15360
    s_nop 0
    buffer_load_dwordx4 v4, s[32:35], s2 offen lds
    s_add_u32 s2, s2, 0x2000
    s_waitcnt vmcnt(0)
    s_barrier
    ds_read_b64_tr_b16 v[192:193], v5 offset:0
    ds_read_b64_tr_b16 v[194:195], v5 offset:2048
    ds_read_b64_tr_b16 v[196:197], v5 offset:4096
    ds_read_b64_tr_b16 v[198:199], v5 offset:6144
    ds_read_b64_tr_b16 v[200:201], v5 offset:8192
    ds_read_b64_tr_b16 v[202:203], v5 offset:10240
    ds_read_b64_tr_b16 v[204:205], v5 offset:12288
    ds_read_b64_tr_b16 v[206:207], v5 offset:14336
    s_waitcnt lgkmcnt(0)
    ds_read_b64_tr_b16 v[208:209], v5 offset:16384
    ds_read_b64_tr_b16 v[210:211], v5 offset:18432
    ds_read_b64_tr_b16 v[212:213], v5 offset:20480
    ds_read_b64_tr_b16 v[214:215], v5 offset:22528
    ds_read_b64_tr_b16 v[216:217], v5 offset:24576
    ds_read_b64_tr_b16 v[218:219], v5 offset:26624
    ds_read_b64_tr_b16 v[220:221], v5 offset:28672
    ds_read_b64_tr_b16 v[222:223], v5 offset:30720
    s_waitcnt lgkmcnt(0)
    ds_read_b64_tr_b16 v[224:225], v5 offset:32768
    ds_read_b64_tr_b16 v[226:227], v5 offset:34816
    ds_read_b64_tr_b16 v[228:229], v5 offset:36864
    ds_read_b64_tr_b16 v[230:231], v5 offset:38912
    ds_read_b64_tr_b16 v[232:233], v5 offset:40960
    ds_read_b64_tr_b16 v[234:235], v5 offset:43008
    ds_read_b64_tr_b16 v[236:237], v5 offset:45056
    ds_read_b64_tr_b16 v[238:239], v5 offset:47104
    s_waitcnt lgkmcnt(0)
    ds_read_b64_tr_b16 v[240:241], v5 offset:49152
    ds_read_b64_tr_b16 v[242:243], v5 offset:51200
    ds_read_b64_tr_b16 v[244:245], v5 offset:53248
    ds_read_b64_tr_b16 v[246:247], v5 offset:55296
    ds_read_b64_tr_b16 v[248:249], v5 offset:57344
    ds_read_b64_tr_b16 v[250:251], v5 offset:59392
    ds_read_b64_tr_b16 v[252:253], v5 offset:61440
    ds_read_b64_tr_b16 v[254:255], v5 offset:63488
    s_waitcnt lgkmcnt(0)
    s_barrier
    v_lshlrev_b32 v5, 4, v1
    s_lshl_b32 s64, s75, 3
    s_add_u32 s64, s64, s58
    s_lshl_b32 s5, s64, 13
    s_add_u32 s5, s5, 0x3000000
    s_bfe_u32 s6, s64, 0x30000
    s_lshl_b32 s6, s6, 2
    s_bfe_u32 s71, s64, 0x20003
    s_lshl_b32 s71, s71, 7
    s_or_b32 s6, s6, s71
    s_add_u32 s6, s6, 0x5100000
    s_lshl_b32 s67, s58, 13
    s_bfe_u32 s64, s58, 0x10002
    s_lshl_b32 s64, s64, 15
    v_add_u32 v6, s64, v5
    v_bfe_u32 v2, v1, 5, 1
    v_lshlrev_b32 v2, 4, v2
    v_xor_b32 v2, v2, v5
    s_bfe_u32 s64, s58, 0x10000
    s_lshl_b32 s64, s64, 7
    s_bfe_u32 s62, s58, 0x30000
    s_lshl_b32 s62, s62, 12
    s_or_b32 s64, s64, s62
    s_or_b32 s64, s64, 131072
    v_xor_b32 v10, s64, v2
    v_bfe_u32 v2, v1, 0, 1
    v_lshlrev_b32 v2, 3, v2
    v_bfe_u32 v3, v1, 1, 4
    v_lshl_or_b32 v2, v3, 4, v2
    v_bfe_u32 v3, v1, 1, 5
    v_lshl_or_b32 v2, v3, 9, v2
    s_lshl_b32 s64, s58, 6
    s_or_b32 s64, s64, 131072
    v_xor_b32 v14, s64, v2
    v_xor_b32 v11, 1056, v10
    v_xor_b32 v15, 16, v14
    v_xor_b32 v12, 2112, v10
    v_xor_b32 v16, 32, v14
    v_xor_b32 v13, 3168, v10
    v_xor_b32 v17, 48, v14
    v_lshlrev_b32 v7, 2, v1
    s_bfe_u32 s7, s57, 0x30000
    s_lshl_b32 s7, s7, 8
    s_lshl_b32 s64, s58, 14
    s_add_u32 s7, s7, s64
    s_bfe_u32 s70, s57, 0x30000
    s_lshl_b32 s70, s70, 16
    s_bfe_u32 s64, s57, 0x10004
    s_lshl_b32 s64, s64, 21
    s_or_b32 s70, s70, s64
    s_add_u32 s70, s70, s67
    s_add_u32 s70, s70, 0x6000000
    s_lshl_b32 s64, s75, 11
    s_add_u32 s70, s70, s64
    s_xor_b32 s2, s70, 2048
    s_xor_b32 s3, s70, 4096
    s_xor_b32 s4, s70, 6144
    s_cmp_ge_u32 s57, 16
    s_cselect_b32 s64, 0, -1
    s_xor_b32 s60, s64, 0x0
    s_xor_b32 s61, s64, 0x5555ff00
    s_mov_b32 s71, -1
    v_add_u32 v8, 0x180000, v5
    s_ff1_i32_b64 s63, s[60:61]
    s_bitset0_b64 s[60:61], s63
    s_lshl_b32 s66, s63, 9
    s_add_u32 s66, s66, s6
wo_slow_114:
pollfl_119:
    buffer_load_dword v4, off, s[8:11], s66 sc1
    s_waitcnt vmcnt(0)
    v_cmp_eq_u32 vcc, 0, v4
    s_cbranch_vccz pollfl_ok_120
    s_sub_u32 s77, s77, 1
    s_cbranch_scc0 pollfl_119
    s_mov_b32 s77, 0
pollfl_ok_120:
    s_mov_b32 s73, s63
    s_lshl_b32 s65, s63, 18
    s_add_u32 s65, s65, s5
    s_ff1_i32_b64 s63, s[60:61]
    s_bitset0_b64 s[60:61], s63
    s_lshl_b32 s66, s63, 9
    s_add_u32 s66, s66, s6
    s_add_u32 m0, s67, 0
    s_nop 0
    buffer_load_dwordx4 v5, s[8:11], s65 offen offset:0 sc1 lds
    buffer_load_dwordx4 v5, s[8:11], s65 offen offset:1024 sc1 lds
    buffer_load_dwordx4 v5, s[8:11], s65 offen offset:2048 sc1 lds
    buffer_load_dwordx4 v5, s[8:11], s65 offen offset:3072 sc1 lds
    s_add_u32 s65, s65, 4096
    s_add_u32 m0, s67, 4096
    s_nop 0
    buffer_load_dwordx4 v5, s[8:11], s65 offen offset:0 sc1 lds
    buffer_load_dwordx4 v5, s[8:11], s65 offen offset:1024 sc1 lds
    buffer_load_dwordx4 v5, s[8:11], s65 offen offset:2048 sc1 lds
    buffer_load_dwordx4 v5, s[8:11], s65 offen offset:3072 sc1 lds
    buffer_load_dword v4, off, s[8:11], s66 sc1
    s_waitcnt vmcnt(0)
wo_loop_115:
    s_mov_b32 s62, s73
    s_xor_b32 s67, s67, 0x10000
    v_readfirstlane_b32 s69, v4
    s_cmp_lt_i32 s63, 0
    s_cselect_b32 s69, 0, s69
    s_mov_b32 s65, 0x5ffffff0
    s_cmp_eq_u32 s69, 0
    s_cbranch_scc1 wo_np_116
    s_mov_b32 s73, s63
    s_lshl_b32 s65, s63, 18
    s_add_u32 s65, s65, s5
    s_ff1_i32_b64 s63, s[60:61]
    s_bitset0_b64 s[60:61], s63
    s_lshl_b32 s66, s63, 9
    s_add_u32 s66, s66, s6
wo_np_116:
    s_waitcnt lgkmcnt(0)
    s_barrier
    ds_read_b128 v[52:55], v6 offset:0
    ds_read_b128 v[56:59], v6 offset:1024
    ds_read_b128 v[60:63], v6 offset:2048
    ds_read_b128 v[64:67], v6 offset:3072
    ds_read_b128 v[68:71], v6 offset:4096
    ds_read_b128 v[72:75], v6 offset:5120
    ds_read_b128 v[76:79], v6 offset:6144
    ds_read_b128 v[80:83], v6 offset:7168
    s_waitcnt lgkmcnt(7)
    v_mfma_f32_32x32x16_bf16 v[20:35], v[128:131], v[52:55], 0
    ds_read_b64 v[36:37], v14 offset:0
    ds_read_b128 v[52:55], v6 offset:8192
    s_lshr_b32 s64, s58, 1
    s_cmp_lg_u32 s64, s75
    s_cbranch_scc1 wo_j_121
    s_cmp_lt_i32 s71, 1
    s_cbranch_scc1 wo_j_121
    buffer_load_dwordx4 v[92:95], v9, s[8:11], s2 offen offset:0 sc1
    buffer_load_dwordx4 v[96:99], v9, s[8:11], s2 offen offset:1024 sc1
    buffer_load_dwordx4 v[100:103], v9, s[8:11], s3 offen offset:0 sc1
    buffer_load_dwordx4 v[104:107], v9, s[8:11], s3 offen offset:1024 sc1
    buffer_load_dwordx4 v[108:111], v9, s[8:11], s4 offen offset:0 sc1
    buffer_load_dwordx4 v[112:115], v9, s[8:11], s4 offen offset:1024 sc1
wo_j_121:
    s_waitcnt lgkmcnt(8)
    v_mfma_f32_32x32x16_bf16 v[20:35], v[132:135], v[56:59], v[20:35]
    ds_read_b64 v[44:45], v14 offset:16384
    ds_read_b128 v[56:59], v6 offset:9216
    s_add_u32 m0, s67, 0
    s_nop 0
    buffer_load_dwordx4 v5, s[8:11], s65 offen offset:0 sc1 lds
    s_waitcnt lgkmcnt(9)
    v_mfma_f32_32x32x16_bf16 v[20:35], v[136:139], v[60:63], v[20:35]
    ds_read_b64 v[38:39], v15 offset:0
    ds_read_b128 v[60:63], v6 offset:10240
    s_waitcnt lgkmcnt(10)
    v_mfma_f32_32x32x16_bf16 v[20:35], v[140:143], v[64:67], v[20:35]
    ds_read_b64 v[46:47], v15 offset:16384
    ds_read_b128 v[64:67], v6 offset:11264
    buffer_load_dwordx4 v5, s[8:11], s65 offen offset:1024 sc1 lds
    s_waitcnt lgkmcnt(11)
    v_mfma_f32_32x32x16_bf16 v[20:35], v[144:147], v[68:71], v[20:35]
    ds_read_b64 v[40:41], v16 offset:0
    ds_read_b128 v[68:71], v6 offset:12288
    s_waitcnt lgkmcnt(12)
    v_mfma_f32_32x32x16_bf16 v[20:35], v[148:151], v[72:75], v[20:35]
    ds_read_b64 v[48:49], v16 offset:16384
    ds_read_b128 v[72:75], v6 offset:13312
    buffer_load_dwordx4 v5, s[8:11], s65 offen offset:2048 sc1 lds
    s_waitcnt lgkmcnt(13)
    v_mfma_f32_32x32x16_bf16 v[20:35], v[152:155], v[76:79], v[20:35]
    ds_read_b64 v[42:43], v17 offset:0
    ds_read_b128 v[76:79], v6 offset:14336
    s_waitcnt lgkmcnt(13)
    v_mfma_f32_32x32x16_bf16 v[20:35], v[156:159], v[80:83], v[20:35]
    ds_read_b64 v[50:51], v17 offset:16384
    ds_read_b128 v[80:83], v6 offset:15360
    buffer_load_dwordx4 v5, s[8:11], s65 offen offset:3072 sc1 lds
    s_add_u32 s65, s65, 4096
    s_waitcnt lgkmcnt(13)
    v_mfma_f32_32x32x16_bf16 v[20:35], v[160:163], v[52:55], v[20:35]
    ds_read_b128 v[52:55], v6 offset:16384
    s_waitcnt lgkmcnt(13)
    v_mfma_f32_32x32x16_bf16 v[20:35], v[164:167], v[56:59], v[20:35]
    ds_read_b128 v[56:59], v6 offset:17408
    s_add_u32 m0, s67, 4096
    s_nop 0
    buffer_load_dwordx4 v5, s[8:11], s65 offen offset:0 sc1 lds
    s_waitcnt lgkmcnt(12)
    v_mfma_f32_32x32x16_bf16 v[20:35], v[168:171], v[60:63], v[20:35]
    ds_read_b128 v[60:63], v6 offset:18432
    s_waitcnt lgkmcnt(11)
    v_mfma_f32_32x32x16_bf16 v[20:35], v[172:175], v[64:67], v[20:35]
    ds_read_b128 v[64:67], v6 offset:19456
    buffer_load_dwordx4 v5, s[8:11], s65 offen offset:1024 sc1 lds
    s_waitcnt lgkmcnt(10)
    v_mfma_f32_32x32x16_bf16 v[20:35], v[176:179], v[68:71], v[20:35]
    ds_read_b128 v[68:71], v6 offset:20480
    s_waitcnt lgkmcnt(9)
    v_mfma_f32_32x32x16_bf16 v[20:35], v[180:183], v[72:75], v[20:35]
    ds_read_b128 v[72:75], v6 offset:21504
    buffer_load_dwordx4 v5, s[8:11], s65 offen offset:2048 sc1 lds
    s_waitcnt lgkmcnt(8)
    v_mfma_f32_32x32x16_bf16 v[20:35], v[184:187], v[76:79], v[20:35]
    ds_read_b128 v[76:79], v6 offset:22528
    s_waitcnt lgkmcnt(7)
    v_mfma_f32_32x32x16_bf16 v[20:35], v[188:191], v[80:83], v[20:35]
    ds_read_b128 v[80:83], v6 offset:23552
    buffer_load_dwordx4 v5, s[8:11], s65 offen offset:3072 sc1 lds
    s_waitcnt lgkmcnt(7)
    v_mfma_f32_32x32x16_bf16 v[20:35], v[192:195], v[52:55], v[20:35]
    ds_read_b128 v[52:55], v6 offset:24576
    buffer_load_dword v4, off, s[8:11], s66 sc1
    s_barrier
    s_waitcnt lgkmcnt(7)
    v_mfma_f32_32x32x16_bf16 v[20:35], v[196:199], v[56:59], v[20:35]
    ds_read_b128 v[56:59], v6 offset:25600
    s_lshr_b32 s64, s58, 1
    s_cmp_lg_u32 s64, s75
    s_cbranch_scc1 wo_s_122
    s_cmp_lt_i32 s71, 1
    s_cbranch_scc1 wo_k_125
    s_waitcnt vmcnt(9)
    v_bitop3_b32 v2, v92, v96, s72 bitop3:0x7e
    v_bitop3_b32 v3, v100, v104, s72 bitop3:0x7e
    v_or_b32 v2, v2, v3
    v_bitop3_b32 v3, v108, v112, s72 bitop3:0x7e
    v_bitop3_b32 v2, v2, v3, 1 bitop3:0xa8
    v_cmp_ne_u32 vcc, 0, v2
    s_cbranch_vccz pollpart_ok_127
pollpart_126:
    buffer_load_dwordx4 v[92:95], v9, s[8:11], s2 offen offset:0 sc1
    buffer_load_dwordx4 v[96:99], v9, s[8:11], s2 offen offset:1024 sc1
    buffer_load_dwordx4 v[100:103], v9, s[8:11], s3 offen offset:0 sc1
    buffer_load_dwordx4 v[104:107], v9, s[8:11], s3 offen offset:1024 sc1
    buffer_load_dwordx4 v[108:111], v9, s[8:11], s4 offen offset:0 sc1
    buffer_load_dwordx4 v[112:115], v9, s[8:11], s4 offen offset:1024 sc1
    s_waitcnt vmcnt(0)
    v_bitop3_b32 v2, v92, v96, s72 bitop3:0x7e
    v_bitop3_b32 v3, v100, v104, s72 bitop3:0x7e
    v_or_b32 v2, v2, v3
    v_bitop3_b32 v3, v108, v112, s72 bitop3:0x7e
    v_bitop3_b32 v2, v2, v3, 1 bitop3:0xa8
    v_cmp_ne_u32 vcc, 0, v2
    s_cbranch_vccz pollpart_ok_127
    s_sub_u32 s77, s77, 1
    s_cbranch_scc0 pollpart_126
    s_mov_b32 s77, 0
pollpart_ok_127:
    v_pk_add_f32 v[84:85], v[84:85], v[92:93]
    v_pk_add_f32 v[100:101], v[100:101], v[108:109]
    v_pk_add_f32 v[84:85], v[84:85], v[100:101]
    v_cvt_pk_bf16_f32 v92, v84, v85
    buffer_store_dword v92, v7, s[16:19], s68 offen offset:2048
    s_add_u32 s68, s68, 4096
    v_pk_add_f32 v[86:87], v[86:87], v[94:95]
    v_pk_add_f32 v[102:103], v[102:103], v[110:111]
    v_pk_add_f32 v[86:87], v[86:87], v[102:103]
    v_cvt_pk_bf16_f32 v93, v86, v87
    buffer_store_dword v93, v7, s[16:19], s68 offen offset:2048
    s_add_u32 s68, s68, 4096
    v_pk_add_f32 v[88:89], v[88:89], v[96:97]
    v_pk_add_f32 v[104:105], v[104:105], v[112:113]
    v_pk_add_f32 v[88:89], v[88:89], v[104:105]
    v_cvt_pk_bf16_f32 v94, v88, v89
    buffer_store_dword v94, v7, s[16:19], s68 offen offset:2048
    s_add_u32 s68, s68, 4096
    v_pk_add_f32 v[90:91], v[90:91], v[98:99]
    v_pk_add_f32 v[106:107], v[106:107], v[114:115]
    v_pk_add_f32 v[90:91], v[90:91], v[106:107]
    v_cvt_pk_bf16_f32 v95, v90, v91
    buffer_store_dword v95, v7, s[16:19], s68 offen offset:2048
    s_add_u32 s68, s68, 4096
    v_pk_add_f32 v[84:85], v[36:37], v[44:45]
    v_pk_add_f32 v[86:87], v[38:39], v[46:47]
    v_pk_add_f32 v[88:89], v[40:41], v[48:49]
    v_pk_add_f32 v[90:91], v[42:43], v[50:51]
    s_bfe_u32 s72, s71, 0x10002
    v_mov_b32 v9, v8
    s_lshl_b32 s68, s59, 17
    s_add_u32 s68, s68, s7
    s_branch wo_j_123
wo_k_125:
    v_pk_add_f32 v[84:85], v[36:37], v[44:45]
    v_pk_add_f32 v[86:87], v[38:39], v[46:47]
    v_pk_add_f32 v[88:89], v[40:41], v[48:49]
    v_pk_add_f32 v[90:91], v[42:43], v[50:51]
    s_bfe_u32 s72, s71, 0x10002
    v_mov_b32 v9, v8
    s_lshl_b32 s68, s59, 17
    s_add_u32 s68, s68, s7
wo_w_124:
    s_waitcnt vmcnt(0)
    s_branch wo_j_123
wo_s_122:
    s_cmp_lt_i32 s71, 0
    s_cbranch_scc1 wo_w_124
    s_bfe_u32 s72, s71, 0x10002
    v_pk_add_f32 v[84:85], v[36:37], v[44:45]
    v_bfi_b32 v84, 1, s72, v84
    v_pk_add_f32 v[86:87], v[38:39], v[46:47]
    buffer_store_dwordx4 v[84:87], v8, s[8:11], s70 offen offset:0 sc1
    v_pk_add_f32 v[88:89], v[40:41], v[48:49]
    v_bfi_b32 v88, 1, s72, v88
    v_pk_add_f32 v[90:91], v[42:43], v[50:51]
    buffer_store_dwordx4 v[88:91], v8, s[8:11], s70 offen offset:1024 sc1
wo_j_123:
    s_waitcnt lgkmcnt(7)
    v_mfma_f32_32x32x16_bf16 v[20:35], v[200:203], v[60:63], v[20:35]
    ds_read_b128 v[60:63], v6 offset:26624
    s_waitcnt lgkmcnt(7)
    v_mfma_f32_32x32x16_bf16 v[20:35], v[204:207], v[64:67], v[20:35]
    ds_read_b128 v[64:67], v6 offset:27648
    s_waitcnt lgkmcnt(7)
    v_mfma_f32_32x32x16_bf16 v[20:35], v[208:211], v[68:71], v[20:35]
    ds_read_b128 v[68:71], v6 offset:28672
    s_waitcnt lgkmcnt(7)
    v_mfma_f32_32x32x16_bf16 v[20:35], v[212:215], v[72:75], v[20:35]
    ds_read_b128 v[72:75], v6 offset:29696
    s_waitcnt lgkmcnt(7)
    v_mfma_f32_32x32x16_bf16 v[20:35], v[216:219], v[76:79], v[20:35]
    ds_read_b128 v[76:79], v6 offset:30720
    s_waitcnt lgkmcnt(7)
    v_mfma_f32_32x32x16_bf16 v[20:35], v[220:223], v[80:83], v[20:35]
    ds_read_b128 v[80:83], v6 offset:31744
    s_waitcnt lgkmcnt(7)
    v_mfma_f32_32x32x16_bf16 v[20:35], v[224:227], v[52:55], v[20:35]
    s_waitcnt lgkmcnt(6)
    v_mfma_f32_32x32x16_bf16 v[20:35], v[228:231], v[56:59], v[20:35]
    s_waitcnt lgkmcnt(5)
    v_mfma_f32_32x32x16_bf16 v[20:35], v[232:235], v[60:63], v[20:35]
    s_waitcnt lgkmcnt(4)
    v_mfma_f32_32x32x16_bf16 v[20:35], v[236:239], v[64:67], v[20:35]
    s_waitcnt lgkmcnt(3)
    v_mfma_f32_32x32x16_bf16 v[20:35], v[240:243], v[68:71], v[20:35]
    s_waitcnt lgkmcnt(2)
    v_mfma_f32_32x32x16_bf16 v[20:35], v[244:247], v[72:75], v[20:35]
    s_waitcnt lgkmcnt(1)
    v_mfma_f32_32x32x16_bf16 v[20:35], v[248:251], v[76:79], v[20:35]
    s_waitcnt lgkmcnt(0)
    v_mfma_f32_32x32x16_bf16 v[20:35], v[252:255], v[80:83], v[20:35]
    v_xor_b32 v6, 0x10000, v6
    s_waitcnt vmcnt(4)
    s_lshr_b32 s64, s58, 1
    s_cmp_eq_u32 s64, s75
    s_cbranch_scc1 wo_j_128
    s_waitcnt vmcnt(2)
wo_j_128:
    s_nop 6
    ds_write_b128 v10, v[20:23]
    ds_write_b128 v11, v[24:27]
    ds_write_b128 v12, v[28:31]
    ds_write_b128 v13, v[32:35]
    v_add_u32 v8, 0x80000, v8
    v_and_b32 v8, 0x1fffff, v8
    s_add_u32 s71, s71, 1
    s_mov_b32 s59, s62
    s_cmp_lg_u32 s69, 0
    s_cbranch_scc1 wo_loop_115
    s_cmp_ge_i32 s63, 0
    s_cbranch_scc1 wo_slow_114
wo_end_117:
    s_waitcnt lgkmcnt(0)
    s_barrier
    ds_read_b64 v[36:37], v14 offset:0
    ds_read_b64 v[44:45], v14 offset:16384
    ds_read_b64 v[38:39], v15 offset:0
    ds_read_b64 v[46:47], v15 offset:16384
    ds_read_b64 v[40:41], v16 offset:0
    ds_read_b64 v[48:49], v16 offset:16384
    ds_read_b64 v[42:43], v17 offset:0
    ds_read_b64 v[50:51], v17 offset:16384
    s_lshr_b32 s64, s58, 1
    s_cmp_lg_u32 s64, s75
    s_cbranch_scc1 wo_s_129
pollpart_130:
    buffer_load_dwordx4 v[92:95], v9, s[8:11], s2 offen offset:0 sc1
    buffer_load_dwordx4 v[96:99], v9, s[8:11], s2 offen offset:1024 sc1
    buffer_load_dwordx4 v[100:103], v9, s[8:11], s3 offen offset:0 sc1
    buffer_load_dwordx4 v[104:107], v9, s[8:11], s3 offen offset:1024 sc1
    buffer_load_dwordx4 v[108:111], v9, s[8:11], s4 offen offset:0 sc1
    buffer_load_dwordx4 v[112:115], v9, s[8:11], s4 offen offset:1024 sc1
    s_waitcnt vmcnt(0)
    v_bitop3_b32 v2, v92, v96, s72 bitop3:0x7e
    v_bitop3_b32 v3, v100, v104, s72 bitop3:0x7e
    v_or_b32 v2, v2, v3
    v_bitop3_b32 v3, v108, v112, s72 bitop3:0x7e
    v_bitop3_b32 v2, v2, v3, 1 bitop3:0xa8
    v_cmp_ne_u32 vcc, 0, v2
    s_cbranch_vccz pollpart_ok_131
    s_sub_u32 s77, s77, 1
    s_cbranch_scc0 pollpart_130
    s_mov_b32 s77, 0
pollpart_ok_131:
    v_pk_add_f32 v[84:85], v[84:85], v[92:93]
    v_pk_add_f32 v[100:101], v[100:101], v[108:109]
    v_pk_add_f32 v[84:85], v[84:85], v[100:101]
    v_cvt_pk_bf16_f32 v92, v84, v85
    buffer_store_dword v92, v7, s[16:19], s68 offen offset:2048
    s_add_u32 s68, s68, 4096
    v_pk_add_f32 v[86:87], v[86:87], v[94:95]
    v_pk_add_f32 v[102:103], v[102:103], v[110:111]
    v_pk_add_f32 v[86:87], v[86:87], v[102:103]
    v_cvt_pk_bf16_f32 v93, v86, v87
    buffer_store_dword v93, v7, s[16:19], s68 offen offset:2048
    s_add_u32 s68, s68, 4096
    v_pk_add_f32 v[88:89], v[88:89], v[96:97]
    v_pk_add_f32 v[104:105], v[104:105], v[112:113]
    v_pk_add_f32 v[88:89], v[88:89], v[104:105]
    v_cvt_pk_bf16_f32 v94, v88, v89
    buffer_store_dword v94, v7, s[16:19], s68 offen offset:2048
    s_add_u32 s68, s68, 4096
    v_pk_add_f32 v[90:91], v[90:91], v[98:99]
    v_pk_add_f32 v[106:107], v[106:107], v[114:115]
    v_pk_add_f32 v[90:91], v[90:91], v[106:107]
    v_cvt_pk_bf16_f32 v95, v90, v91
    buffer_store_dword v95, v7, s[16:19], s68 offen offset:2048
    s_add_u32 s68, s68, 4096
    s_waitcnt lgkmcnt(0)
    v_pk_add_f32 v[84:85], v[36:37], v[44:45]
    v_pk_add_f32 v[86:87], v[38:39], v[46:47]
    v_pk_add_f32 v[88:89], v[40:41], v[48:49]
    v_pk_add_f32 v[90:91], v[42:43], v[50:51]
    s_bfe_u32 s72, s71, 0x10002
    v_mov_b32 v9, v8
    s_lshl_b32 s68, s59, 17
    s_add_u32 s68, s68, s7
pollpart_132:
    buffer_load_dwordx4 v[92:95], v9, s[8:11], s2 offen offset:0 sc1
    buffer_load_dwordx4 v[96:99], v9, s[8:11], s2 offen offset:1024 sc1
    buffer_load_dwordx4 v[100:103], v9, s[8:11], s3 offen offset:0 sc1
    buffer_load_dwordx4 v[104:107], v9, s[8:11], s3 offen offset:1024 sc1
    buffer_load_dwordx4 v[108:111], v9, s[8:11], s4 offen offset:0 sc1
    buffer_load_dwordx4 v[112:115], v9, s[8:11], s4 offen offset:1024 sc1
    s_waitcnt vmcnt(0)
    v_bitop3_b32 v2, v92, v96, s72 bitop3:0x7e
    v_bitop3_b32 v3, v100, v104, s72 bitop3:0x7e
    v_or_b32 v2, v2, v3
    v_bitop3_b32 v3, v108, v112, s72 bitop3:0x7e
    v_bitop3_b32 v2, v2, v3, 1 bitop3:0xa8
    v_cmp_ne_u32 vcc, 0, v2
    s_cbranch_vccz pollpart_ok_133
    s_sub_u32 s77, s77, 1
    s_cbranch_scc0 pollpart_132
    s_mov_b32 s77, 0
pollpart_ok_133:
    v_pk_add_f32 v[84:85], v[84:85], v[92:93]
    v_pk_add_f32 v[100:101], v[100:101], v[108:109]
    v_pk_add_f32 v[84:85], v[84:85], v[100:101]
    v_cvt_pk_bf16_f32 v92, v84, v85
    buffer_store_dword v92, v7, s[16:19], s68 offen offset:2048
    s_add_u32 s68, s68, 4096
    v_pk_add_f32 v[86:87], v[86:87], v[94:95]
    v_pk_add_f32 v[102:103], v[102:103], v[110:111]
    v_pk_add_f32 v[86:87], v[86:87], v[102:103]
    v_cvt_pk_bf16_f32 v93, v86, v87
    buffer_store_dword v93, v7, s[16:19], s68 offen offset:2048
    s_add_u32 s68, s68, 4096
    v_pk_add_f32 v[88:89], v[88:89], v[96:97]
    v_pk_add_f32 v[104:105], v[104:105], v[112:113]
    v_pk_add_f32 v[88:89], v[88:89], v[104:105]
    v_cvt_pk_bf16_f32 v94, v88, v89
    buffer_store_dword v94, v7, s[16:19], s68 offen offset:2048
    s_add_u32 s68, s68, 4096
    v_pk_add_f32 v[90:91], v[90:91], v[98:99]
    v_pk_add_f32 v[106:107], v[106:107], v[114:115]
    v_pk_add_f32 v[90:91], v[90:91], v[106:107]
    v_cvt_pk_bf16_f32 v95, v90, v91
    buffer_store_dword v95, v7, s[16:19], s68 offen offset:2048
    s_add_u32 s68, s68, 4096
    s_branch wo_out_118
wo_s_129:
    s_waitcnt lgkmcnt(0)
    s_bfe_u32 s72, s71, 0x10002
    v_pk_add_f32 v[84:85], v[36:37], v[44:45]
    v_bfi_b32 v84, 1, s72, v84
    v_pk_add_f32 v[86:87], v[38:39], v[46:47]
    buffer_store_dwordx4 v[84:87], v8, s[8:11], s70 offen offset:0 sc1
    v_pk_add_f32 v[88:89], v[40:41], v[48:49]
    v_bfi_b32 v88, 1, s72, v88
    v_pk_add_f32 v[90:91], v[42:43], v[50:51]
    buffer_store_dwordx4 v[88:91], v8, s[8:11], s70 offen offset:1024 sc1
wo_out_118:
end_72:
    s_waitcnt vmcnt(0)
    s_endpgm
.section .rodata,"a"
.p2align 6
.amdhsa_kernel concat_heads__spectral_gfnet__memory_aug_recurrent_mem_tr__prompt_kernel
  .amdhsa_next_free_vgpr 256
  .amdhsa_next_free_sgpr 102
  .amdhsa_accum_offset 256
  .amdhsa_group_segment_fixed_size 0
  .amdhsa_kernarg_size 104
  .amdhsa_user_sgpr_count 2
  .amdhsa_user_sgpr_kernarg_segment_ptr 1
  .amdhsa_system_sgpr_workgroup_id_x 1
  .amdhsa_float_denorm_mode_32 3
  .amdhsa_float_denorm_mode_16_64 3
.end_amdhsa_kernel
```

```asm
; @launch grid=(256,1,1) block=(512,1,1) lds=163840
.amdgcn_target "amdgcn-amd-amdhsa--gfx950"
.text
.globl concat_heads__spectral_gfnet__memory_aug_recurrent_mem_tr__prompt_kernel
.p2align 8
.type concat_heads__spectral_gfnet__memory_aug_recurrent_mem_tr__prompt_kernel,@function
concat_heads__spectral_gfnet__memory_aug_recurrent_mem_tr__prompt_kernel:
    s_load_dwordx2 s[8:9], s[0:1], 96
    s_load_dwordx2 s[12:13], s[0:1], 88
    s_load_dwordx2 s[16:17], s[0:1], 80
    s_load_dwordx2 s[20:21], s[0:1], 40
    s_load_dwordx2 s[24:25], s[0:1], 48
    s_load_dwordx2 s[28:29], s[0:1], 56
    s_load_dwordx2 s[32:33], s[0:1], 64
    s_load_dwordx2 s[36:37], s[0:1], 24
    s_load_dwordx2 s[40:41], s[0:1], 32
    s_load_dwordx2 s[44:45], s[0:1], 0
    s_load_dwordx2 s[48:49], s[0:1], 8
    s_load_dwordx2 s[52:53], s[0:1], 16
    s_mov_b32 s10, 0x10000000
    s_mov_b32 s11, 0x20000
    s_mov_b32 s14, 0x100
    s_mov_b32 s15, 0x20000
    s_mov_b32 s18, 0x800000
    s_mov_b32 s19, 0x20000
    s_mov_b32 s22, 0x800000
    s_mov_b32 s23, 0x20000
    s_mov_b32 s26, 0x800000
    s_mov_b32 s27, 0x20000
    s_mov_b32 s30, 0x800000
    s_mov_b32 s31, 0x20000
    s_mov_b32 s34, 0x800000
    s_mov_b32 s35, 0x20000
    s_mov_b32 s38, 0x400000
    s_mov_b32 s39, 0x20000
    s_mov_b32 s42, 0x4000
    s_mov_b32 s43, 0x20000
    s_mov_b32 s46, 0x400000
    s_mov_b32 s47, 0x20000
    s_mov_b32 s50, 0x201000
    s_mov_b32 s51, 0x20000
    s_mov_b32 s54, 0x201000
    s_mov_b32 s55, 0x20000
    s_waitcnt lgkmcnt(0)
    s_getreg_b32 s56, hwreg(HW_REG_XCC_ID, 0, 3)
    v_lshrrev_b32 v2, 6, v0
    v_and_b32 v1, 63, v0
    v_readfirstlane_b32 s58, v2
    s_nop 0
    s_cmp_lg_u32 s58, 0
    s_cbranch_scc1 notw0_1
    s_lshl_b32 s57, s56, 2
    v_mov_b32 v2, s57
    v_mov_b32 v3, 0x5ffffff0
    v_cmp_eq_u32 vcc, 0, v1
    s_nop 1
    v_cndmask_b32 v2, v3, v2, vcc
    v_mov_b32 v3, 1
    buffer_atomic_add v3, v2, s[12:15], 0 offen sc0 sc1
    v_mov_b32 v4, 0x27ff0
    s_waitcnt vmcnt(0)
    v_readfirstlane_b32 s3, v3
    s_nop 1
    v_mov_b32 v3, s3
    ds_write_b32 v4, v3
    s_waitcnt lgkmcnt(0)
notw0_1:
    s_barrier
    v_mov_b32 v4, 0x27ff0
    ds_read_b32 v3, v4
    s_waitcnt lgkmcnt(0)
    v_readfirstlane_b32 s57, v3
    s_nop 0
    s_cmp_lt_u32 s57, 32
    s_cbranch_scc1 go_3
    s_endpgm
go_3:
    s_cmp_ge_u32 s56, 4
    s_cbranch_scc1 bulk_2
    s_and_b32 s64, s57, 3
    s_lshr_b32 s65, s57, 2
    s_lshl_b32 s66, s56, 3
    s_add_u32 s66, s66, s65
    s_and_b32 s67, s58, 3
    s_mov_b32 s69, 0x40000
    v_and_b32 v6, 15, v1
    v_lshlrev_b32 v8, 4, v1
    v_mov_b32 v14, -1
    v_mov_b32 v15, -1
    v_mov_b32 v16, -1
    v_mov_b32 v17, -1
    s_mov_b32 s86, 0
    s_mov_b32 s87, 0
    s_mov_b32 s88, 0
    s_mov_b32 s89, 0
    s_mov_b32 s90, 0
    s_mov_b32 s91, 0
    s_mov_b32 s92, 0
    s_mov_b32 s93, 0
    s_mov_b32 s94, 0
    s_mov_b32 s95, 0
    s_mov_b32 s96, 0
    s_mov_b32 s97, 0
    s_mov_b32 s98, 0
    v_mov_b32 v2, 0x4444
    v_mov_b32 v3, 0xeeee
    v_and_b32 v4, 2, v1
    v_cmp_eq_u32 vcc, 0, v4
    s_nop 1
    v_cndmask_b32 v7, v3, v2, vcc
    v_bfe_u32 v36, v1, 0, 2
    v_lshlrev_b32 v36, 4, v36
    v_bfe_u32 v2, v1, 5, 1
    v_lshl_or_b32 v36, v2, 6, v36
    v_bfe_u32 v2, v1, 2, 2
    v_lshl_or_b32 v36, v2, 10, v36
    v_bfe_u32 v2, v1, 4, 1
    v_lshl_or_b32 v36, v2, 12, v36
    s_lshl_b32 s70, s56, 2
    s_add_u32 s70, s70, s64
    s_lshl_b32 s70, s70, 15
    s_add_u32 s70, s70, 0x4a00000
    s_lshl_b32 s71, s65, 2
    s_add_u32 s71, s71, s67
    s_lshl_b32 s72, s71, 10
    s_add_u32 s78, s70, s72
    s_lshl_b32 s72, s67, 13
    s_add_u32 s79, s70, s72
    s_lshl_b32 s72, s65, 7
    s_add_u32 s79, s79, s72
    s_bfe_u32 s77, s71, 0x20001
    s_lshl_b32 s77, s77, 7
    s_bfe_u32 s72, s71, 0x10000
    s_lshl_b32 s72, s72, 11
    s_or_b32 s77, s77, s72
    s_bfe_u32 s72, s71, 0x10003
    s_lshl_b32 s72, s72, 12
    s_or_b32 s77, s77, s72
    s_bfe_u32 s72, s71, 0x10004
    s_lshl_b32 s72, s72, 14
    s_or_b32 s77, s77, s72
    s_lshl_b32 s72, s56, 9
    s_add_u32 s77, s77, s72
    s_bfe_u32 s76, s58, 0x10000
    s_lshl_b32 s76, s76, 12
    s_bfe_u32 s72, s58, 0x10001
    s_lshl_b32 s72, s72, 14
    s_or_b32 s76, s76, s72
    s_lshl_b32 s72, s64, 15
    s_add_u32 s76, s76, s72
    s_add_u32 s72, s72, 0x20000
    s_add_u32 s77, s77, s72
    s_sub_u32 s7, 0, s8
    s_and_b32 s7, s7, 0x1fffff
    s_add_u32 s7, s7, 0x6c00000
    v_bfe_u32 v37, v1, 0, 2
    v_lshlrev_b32 v37, 4, v37
    v_bfe_u32 v2, v1, 4, 1
    v_lshl_or_b32 v37, v2, 6, v37
    v_bfe_u32 v2, v1, 2, 2
    v_lshl_or_b32 v37, v2, 7, v37
    v_bfe_u32 v2, v1, 5, 1
    v_lshl_or_b32 v37, v2, 9, v37
    v_add_u32 v37, s7, v37
    v_mov_b32 v5, 0x5ffffff0
    v_add_u32 v3, s7, v8
    v_cmp_gt_u32 vcc, 8, v1
    s_nop 1
    v_cndmask_b32 v35, v5, v3, vcc
    s_lshl_b32 s70, s66, 2
    s_add_u32 s70, s70, s67
    s_lshl_b32 s74, s70, 11
    s_add_u32 s74, s74, 0x4900000
    s_cmp_ge_u32 s58, 4
    s_cbranch_scc1 vo_arm_4
    s_lshl_b32 s73, s70, 12
    s_add_u32 s73, s73, 0x4800000
    s_lshl_b32 s71, s64, 10
    v_add_u32 v34, s71, v8
    s_add_u32 s71, s73, 0x80000
    buffer_store_dwordx4 v[14:17], v34, s[8:11], s73 offen
    buffer_store_dwordx4 v[14:17], v34, s[8:11], s71 offen
    v_bfe_u32 v2, v1, 0, 3
    v_lshlrev_b32 v2, 4, v2
    v_bfe_u32 v3, v1, 3, 1
    v_lshl_or_b32 v2, v3, 13, v2
    v_bfe_u32 v3, v1, 4, 2
    v_lshl_or_b32 v2, v3, 17, v2
    v_add_u32 v2, s7, v2
    buffer_store_dwordx4 v[14:17], v2, s[8:11], s77 offen sc1
    s_add_u32 s77, s77, 0x60000
    s_branch arm_done_5
vo_arm_4:
    s_mov_b32 s73, s74
    v_bfe_u32 v34, v1, 0, 4
    v_lshlrev_b32 v34, 4, v34
    v_bfe_u32 v2, v1, 5, 1
    v_lshl_or_b32 v34, v2, 8, v34
    v_bfe_u32 v2, v1, 4, 1
    v_lshl_or_b32 v34, v2, 10, v34
    s_bfe_u32 s71, s64, 0x10000
    s_lshl_b32 s71, s71, 3
    s_bfe_u32 s72, s64, 0x10001
    s_lshl_b32 s72, s72, 9
    s_or_b32 s71, s71, s72
    v_add_u32 v34, s71, v34
    s_add_u32 s71, s73, 0x40000
    buffer_store_dwordx2 v[14:15], v34, s[8:11], s73 offen
    buffer_store_dwordx2 v[14:15], v34, s[8:11], s71 offen
    s_add_u32 s71, s79, 0x80000
    buffer_store_dwordx4 v[14:17], v36, s[8:11], s79 offen
    buffer_store_dwordx4 v[14:17], v36, s[8:11], s71 offen
    s_add_u32 s2, s77, s7
    s_add_u32 s2, s2, 0x1c0000
    v_bfe_u32 v2, v1, 0, 2
    v_lshlrev_b32 v2, 21, v2
    v_bfe_u32 v3, v1, 2, 1
    v_lshl_or_b32 v2, v3, 13, v2
    s_cmp_lg_u32 s58, 4
    s_cbranch_scc1 arm_done_5
    buffer_store_dword v14, v2, s[8:11], s2 offen sc1
    s_lshl_b32 s71, s66, 7
    s_add_u32 s71, s71, 0x5110000
    buffer_store_dwordx2 v[14:15], off, s[8:11], s71 sc1
arm_done_5:
    v_bfe_u32 v2, v1, 0, 1
    v_lshlrev_b32 v2, 11, v2
    v_bfe_u32 v3, v1, 2, 2
    v_lshl_or_b32 v2, v3, 12, v2
    v_bfe_u32 v3, v1, 1, 1
    v_lshl_or_b32 v2, v3, 8, v2
    v_bfe_u32 v3, v1, 4, 2
    v_lshl_or_b32 v2, v3, 4, v2
    s_lshl_b32 s70, s64, 9
    s_lshl_b32 s71, s67, 6
    s_add_u32 s70, s70, s71
    buffer_load_dwordx4 v[10:13], v2, s[40:43], s70 offen
    v_bfe_u32 v2, v1, 4, 1
    v_lshlrev_b32 v2, 4, v2
    v_bfe_u32 v3, v1, 5, 1
    v_lshl_or_b32 v2, v3, 6, v2
    v_bfe_u32 v3, v1, 4, 2
    v_lshl_or_b32 v2, v3, 13, v2
    v_lshlrev_b32 v3, 4, v6
    v_xor_b32 v38, v2, v3
    v_xor_b32 v39, 0x80, v38
    v_bfe_u32 v2, v1, 5, 1
    v_lshlrev_b32 v2, 5, v2
    v_bfe_u32 v3, v1, 5, 1
    v_lshl_or_b32 v2, v3, 11, v2
    v_bfe_u32 v3, v1, 0, 5
    v_lshlrev_b32 v3, 4, v3
    v_xor_b32 v40, v2, v3
    s_lshl_b32 s71, s67, 6
    v_bfe_u32 v4, v1, 0, 1
    v_lshlrev_b32 v4, 3, v4
    v_bfe_u32 v2, v1, 2, 1
    v_lshl_or_b32 v4, v2, 4, v4
    v_bfe_u32 v2, v1, 1, 1
    v_lshl_or_b32 v4, v2, 5, v4
    v_bfe_u32 v2, v1, 5, 1
    v_lshl_or_b32 v4, v2, 7, v4
    v_bfe_u32 v2, v1, 2, 1
    v_lshl_or_b32 v4, v2, 8, v4
    v_bfe_u32 v2, v1, 4, 2
    v_lshl_or_b32 v4, v2, 10, v4
    v_bfe_u32 v2, v1, 3, 1
    v_lshl_or_b32 v4, v2, 15, v4
    s_lshl_b32 s70, s58, 13
    s_cmp_ge_u32 s58, 4
    s_cselect_b32 s70, 0, s70
    s_or_b32 s70, s70, s71
    v_xor_b32 v41, s70, v4
    v_bfe_u32 v4, v1, 0, 1
    v_lshlrev_b32 v4, 3, v4
    v_bfe_u32 v2, v1, 1, 1
    v_lshl_or_b32 v4, v2, 4, v4
    v_bfe_u32 v2, v1, 2, 1
    v_lshl_or_b32 v4, v2, 5, v4
    v_bfe_u32 v2, v1, 5, 1
    v_lshl_or_b32 v4, v2, 7, v4
    v_bfe_u32 v2, v1, 2, 1
    v_lshl_or_b32 v4, v2, 9, v4
    v_bfe_u32 v2, v1, 5, 1
    v_lshl_or_b32 v4, v2, 11, v4
    v_bfe_u32 v2, v1, 4, 1
    v_lshl_or_b32 v4, v2, 12, v4
    v_bfe_u32 v2, v1, 3, 1
    v_lshl_or_b32 v4, v2, 14, v4
    s_or_b32 s71, s71, 0x10000
    v_xor_b32 v42, s71, v4
    s_lshl_b32 s70, s64, 21
    s_lshl_b32 s71, s58, 18
    s_add_u32 s70, s70, s71
    s_lshl_b32 s71, s66, 8
    s_add_u32 s70, s70, s71
    s_lshl_b32 s71, s58, 13
    s_add_u32 s71, s71, 0
    s_mov_b32 m0, s71
    s_nop 0
    buffer_load_dwordx4 v38, s[24:27], s70 offen lds
    s_add_u32 s71, s71, 0x400
    s_add_u32 s70, s70, 0x8000
    s_mov_b32 m0, s71
    s_nop 0
    buffer_load_dwordx4 v38, s[24:27], s70 offen lds
    s_add_u32 s71, s71, 0x400
    s_add_u32 s70, s70, 0x8000
    s_mov_b32 m0, s71
    s_nop 0
    buffer_load_dwordx4 v39, s[24:27], s70 offen lds
    s_add_u32 s71, s71, 0x400
    s_add_u32 s70, s70, 0x8000
    s_mov_b32 m0, s71
    s_nop 0
    buffer_load_dwordx4 v39, s[24:27], s70 offen lds
    s_add_u32 s71, s71, 0x400
    s_add_u32 s70, s70, 0x8000
    s_mov_b32 m0, s71
    s_nop 0
    buffer_load_dwordx4 v38, s[24:27], s70 offen lds
    s_add_u32 s71, s71, 0x400
    s_add_u32 s70, s70, 0x8000
    s_mov_b32 m0, s71
    s_nop 0
    buffer_load_dwordx4 v38, s[24:27], s70 offen lds
    s_add_u32 s71, s71, 0x400
    s_add_u32 s70, s70, 0x8000
    s_mov_b32 m0, s71
    s_nop 0
    buffer_load_dwordx4 v39, s[24:27], s70 offen lds
    s_add_u32 s71, s71, 0x400
    s_add_u32 s70, s70, 0x8000
    s_mov_b32 m0, s71
    s_nop 0
    buffer_load_dwordx4 v39, s[24:27], s70 offen lds
    s_add_u32 s71, s71, 0x400
    s_add_u32 s70, s70, 0x8000
    s_lshl_b32 s70, s64, 21
    s_lshl_b32 s71, s58, 18
    s_add_u32 s70, s70, s71
    s_lshl_b32 s71, s66, 8
    s_add_u32 s70, s70, s71
    s_lshl_b32 s71, s58, 13
    s_add_u32 s71, s71, 65536
    s_mov_b32 m0, s71
    s_nop 0
    buffer_load_dwordx4 v38, s[28:31], s70 offen lds
    s_add_u32 s71, s71, 0x400
    s_add_u32 s70, s70, 0x8000
    s_mov_b32 m0, s71
    s_nop 0
    buffer_load_dwordx4 v38, s[28:31], s70 offen lds
    s_add_u32 s71, s71, 0x400
    s_add_u32 s70, s70, 0x8000
    s_mov_b32 m0, s71
    s_nop 0
    buffer_load_dwordx4 v39, s[28:31], s70 offen lds
    s_add_u32 s71, s71, 0x400
    s_add_u32 s70, s70, 0x8000
    s_mov_b32 m0, s71
    s_nop 0
    buffer_load_dwordx4 v39, s[28:31], s70 offen lds
    s_add_u32 s71, s71, 0x400
    s_add_u32 s70, s70, 0x8000
    s_mov_b32 m0, s71
    s_nop 0
    buffer_load_dwordx4 v38, s[28:31], s70 offen lds
    s_add_u32 s71, s71, 0x400
    s_add_u32 s70, s70, 0x8000
    s_mov_b32 m0, s71
    s_nop 0
    buffer_load_dwordx4 v38, s[28:31], s70 offen lds
    s_add_u32 s71, s71, 0x400
    s_add_u32 s70, s70, 0x8000
    s_mov_b32 m0, s71
    s_nop 0
    buffer_load_dwordx4 v39, s[28:31], s70 offen lds
    s_add_u32 s71, s71, 0x400
    s_add_u32 s70, s70, 0x8000
    s_mov_b32 m0, s71
    s_nop 0
    buffer_load_dwordx4 v39, s[28:31], s70 offen lds
    s_add_u32 s71, s71, 0x400
    s_add_u32 s70, s70, 0x8000
    s_cmp_lg_u32 s58, 4
    s_cbranch_scc1 novote_6
    s_waitcnt vmcnt(16)
    s_mov_b32 s3, 1
    s_mov_b32 s59, 0
    s_bitcmp1_b32 s57, 0
    s_cselect_b32 s60, -1, 1
    s_cselect_b32 s70, 0x2000, 0
    s_cselect_b32 s71, 0, 0x2000
    s_add_u32 s70, s70, s2
    s_add_u32 s71, s71, s2
    s_mov_b64 s[4:5], 0
    s_buffer_load_dword s4, s[8:11], s70
    s_buffer_load_dword s5, s[8:11], s71
    s_waitcnt lgkmcnt(1)
    s_sub_u32 s72, s4, s5
    s_waitcnt lgkmcnt(0)
    s_mul_i32 s72, s72, s60
    s_add_u32 s72, s72, 1
    s_min_u32 s72, s72, 2
    s_lshl_b32 s72, s72, 10
    s_add_u32 s3, s3, s72
    s_add_u32 s70, s70, 0x200000
    s_add_u32 s71, s71, 0x200000
    s_mov_b64 s[4:5], 0
    s_buffer_load_dword s4, s[8:11], s70
    s_buffer_load_dword s5, s[8:11], s71
    s_waitcnt lgkmcnt(1)
    s_sub_u32 s72, s4, s5
    s_waitcnt lgkmcnt(0)
    s_mul_i32 s72, s72, s60
    s_add_u32 s72, s72, 1
    s_min_u32 s72, s72, 2
    s_lshl_b32 s72, s72, 20
    s_add_u32 s3, s3, s72
    s_add_u32 s70, s70, 0x200000
    s_add_u32 s71, s71, 0x200000
    s_mov_b64 s[4:5], 0
    s_buffer_load_dword s4, s[8:11], s70
    s_buffer_load_dword s5, s[8:11], s71
    s_waitcnt lgkmcnt(1)
    s_sub_u32 s72, s4, s5
    s_waitcnt lgkmcnt(0)
    s_mul_i32 s72, s72, s60
    s_add_u32 s72, s72, 1
    s_min_u32 s72, s72, 2
    s_lshl_b32 s72, s72, 10
    s_add_u32 s59, s59, s72
    s_add_u32 s70, s70, 0x200000
    s_add_u32 s71, s71, 0x200000
    s_mov_b64 s[4:5], 0
    s_buffer_load_dword s4, s[8:11], s70
    s_buffer_load_dword s5, s[8:11], s71
    s_waitcnt lgkmcnt(1)
    s_sub_u32 s72, s4, s5
    s_waitcnt lgkmcnt(0)
    s_mul_i32 s72, s72, s60
    s_add_u32 s72, s72, 1
    s_min_u32 s72, s72, 2
    s_lshl_b32 s72, s72, 20
    s_add_u32 s59, s59, s72
    s_add_u32 s70, s70, 0x200000
    s_add_u32 s71, s71, 0x200000
novote_6:
    s_waitcnt vmcnt(0)
    s_barrier
    s_cmp_lg_u32 s58, 4
    s_cbranch_scc1 nosig_7
    v_mov_b32 v2, s3
    v_mov_b32 v3, s59
    v_cmp_eq_u32 vcc, 0, v1
    v_mov_b32 v5, 32
    v_mov_b32 v4, 0x5ffffff0
    v_cndmask_b32 v4, v4, v5, vcc
    buffer_atomic_add_x2 v[2:3], v4, s[12:15], 0 offen sc1
nosig_7:
    s_cmp_ge_u32 s58, 4
    s_cbranch_scc1 skip_8
    v_xor_b32 v2, 0x0, v41
    v_xor_b32 v3, 0x40, v41
    ds_read_b64_tr_b16 v[192:193], v2 offset:0
    ds_read_b64_tr_b16 v[194:195], v3 offset:512
    ds_read_b64_tr_b16 v[196:197], v2 offset:4096
    ds_read_b64_tr_b16 v[198:199], v3 offset:4608
    v_xor_b32 v2, 0x2000, v41
    v_xor_b32 v3, 0x2040, v41
    ds_read_b64_tr_b16 v[200:201], v2 offset:0
    ds_read_b64_tr_b16 v[202:203], v3 offset:512
    ds_read_b64_tr_b16 v[204:205], v2 offset:4096
    ds_read_b64_tr_b16 v[206:207], v3 offset:4608
    v_xor_b32 v2, 0x4000, v41
    v_xor_b32 v3, 0x4040, v41
    ds_read_b64_tr_b16 v[208:209], v2 offset:0
    ds_read_b64_tr_b16 v[210:211], v3 offset:512
    ds_read_b64_tr_b16 v[212:213], v2 offset:4096
    ds_read_b64_tr_b16 v[214:215], v3 offset:4608
    v_xor_b32 v2, 0x6000, v41
    v_xor_b32 v3, 0x6040, v41
    ds_read_b64_tr_b16 v[216:217], v2 offset:0
    ds_read_b64_tr_b16 v[218:219], v3 offset:512
    ds_read_b64_tr_b16 v[220:221], v2 offset:4096
    ds_read_b64_tr_b16 v[222:223], v3 offset:4608
    s_waitcnt lgkmcnt(0)
    v_xor_b32 v2, 0x10, v41
    v_xor_b32 v3, 0x50, v41
    ds_read_b64_tr_b16 v[224:225], v2 offset:0
    ds_read_b64_tr_b16 v[226:227], v3 offset:512
    ds_read_b64_tr_b16 v[228:229], v2 offset:4096
    ds_read_b64_tr_b16 v[230:231], v3 offset:4608
    v_xor_b32 v2, 0x2010, v41
    v_xor_b32 v3, 0x2050, v41
    ds_read_b64_tr_b16 v[232:233], v2 offset:0
    ds_read_b64_tr_b16 v[234:235], v3 offset:512
    ds_read_b64_tr_b16 v[236:237], v2 offset:4096
    ds_read_b64_tr_b16 v[238:239], v3 offset:4608
    v_xor_b32 v2, 0x4010, v41
    v_xor_b32 v3, 0x4050, v41
    ds_read_b64_tr_b16 v[240:241], v2 offset:0
    ds_read_b64_tr_b16 v[242:243], v3 offset:512
    ds_read_b64_tr_b16 v[244:245], v2 offset:4096
    ds_read_b64_tr_b16 v[246:247], v3 offset:4608
    v_xor_b32 v2, 0x6010, v41
    v_xor_b32 v3, 0x6050, v41
    ds_read_b64_tr_b16 v[248:249], v2 offset:0
    ds_read_b64_tr_b16 v[250:251], v3 offset:512
    ds_read_b64_tr_b16 v[252:253], v2 offset:4096
    ds_read_b64_tr_b16 v[254:255], v3 offset:4608
    s_waitcnt lgkmcnt(0)
skip_8:
    s_cmp_ge_u32 s58, 4
    s_cbranch_scc0 skip_9
    v_xor_b32 v2, 0x10000, v41
    v_xor_b32 v3, 0x10040, v41
    ds_read_b64_tr_b16 v[128:129], v2 offset:0
    ds_read_b64_tr_b16 v[130:131], v3 offset:512
    ds_read_b64_tr_b16 v[132:133], v2 offset:4096
    ds_read_b64_tr_b16 v[134:135], v3 offset:4608
    v_xor_b32 v2, 0x12000, v41
    v_xor_b32 v3, 0x12040, v41
    ds_read_b64_tr_b16 v[136:137], v2 offset:0
    ds_read_b64_tr_b16 v[138:139], v3 offset:512
    ds_read_b64_tr_b16 v[140:141], v2 offset:4096
    ds_read_b64_tr_b16 v[142:143], v3 offset:4608
    v_xor_b32 v2, 0x14000, v41
    v_xor_b32 v3, 0x14040, v41
    ds_read_b64_tr_b16 v[144:145], v2 offset:0
    ds_read_b64_tr_b16 v[146:147], v3 offset:512
    ds_read_b64_tr_b16 v[148:149], v2 offset:4096
    ds_read_b64_tr_b16 v[150:151], v3 offset:4608
    v_xor_b32 v2, 0x16000, v41
    v_xor_b32 v3, 0x16040, v41
    ds_read_b64_tr_b16 v[152:153], v2 offset:0
    ds_read_b64_tr_b16 v[154:155], v3 offset:512
    ds_read_b64_tr_b16 v[156:157], v2 offset:4096
    ds_read_b64_tr_b16 v[158:159], v3 offset:4608
    s_waitcnt lgkmcnt(0)
    v_xor_b32 v2, 0x10010, v41
    v_xor_b32 v3, 0x10050, v41
    ds_read_b64_tr_b16 v[160:161], v2 offset:0
    ds_read_b64_tr_b16 v[162:163], v3 offset:512
    ds_read_b64_tr_b16 v[164:165], v2 offset:4096
    ds_read_b64_tr_b16 v[166:167], v3 offset:4608
    v_xor_b32 v2, 0x12010, v41
    v_xor_b32 v3, 0x12050, v41
    ds_read_b64_tr_b16 v[168:169], v2 offset:0
    ds_read_b64_tr_b16 v[170:171], v3 offset:512
    ds_read_b64_tr_b16 v[172:173], v2 offset:4096
    ds_read_b64_tr_b16 v[174:175], v3 offset:4608
    v_xor_b32 v2, 0x14010, v41
    v_xor_b32 v3, 0x14050, v41
    ds_read_b64_tr_b16 v[176:177], v2 offset:0
    ds_read_b64_tr_b16 v[178:179], v3 offset:512
    ds_read_b64_tr_b16 v[180:181], v2 offset:4096
    ds_read_b64_tr_b16 v[182:183], v3 offset:4608
    v_xor_b32 v2, 0x16010, v41
    v_xor_b32 v3, 0x16050, v41
    ds_read_b64_tr_b16 v[184:185], v2 offset:0
    ds_read_b64_tr_b16 v[186:187], v3 offset:512
    ds_read_b64_tr_b16 v[188:189], v2 offset:4096
    ds_read_b64_tr_b16 v[190:191], v3 offset:4608
    s_waitcnt lgkmcnt(0)
skip_9:
    s_barrier
    s_lshl_b32 s70, s64, 21
    s_lshl_b32 s71, s58, 18
    s_add_u32 s70, s70, s71
    s_lshl_b32 s71, s66, 8
    s_add_u32 s70, s70, s71
    s_lshl_b32 s71, s58, 13
    s_add_u32 s71, s71, 0
    s_mov_b32 m0, s71
    s_nop 0
    buffer_load_dwordx4 v38, s[20:23], s70 offen lds
    s_add_u32 s71, s71, 0x400
    s_add_u32 s70, s70, 0x8000
    s_mov_b32 m0, s71
    s_nop 0
    buffer_load_dwordx4 v38, s[20:23], s70 offen lds
    s_add_u32 s71, s71, 0x400
    s_add_u32 s70, s70, 0x8000
    s_mov_b32 m0, s71
    s_nop 0
    buffer_load_dwordx4 v39, s[20:23], s70 offen lds
    s_add_u32 s71, s71, 0x400
    s_add_u32 s70, s70, 0x8000
    s_mov_b32 m0, s71
    s_nop 0
    buffer_load_dwordx4 v39, s[20:23], s70 offen lds
    s_add_u32 s71, s71, 0x400
    s_add_u32 s70, s70, 0x8000
    s_mov_b32 m0, s71
    s_nop 0
    buffer_load_dwordx4 v38, s[20:23], s70 offen lds
    s_add_u32 s71, s71, 0x400
    s_add_u32 s70, s70, 0x8000
    s_mov_b32 m0, s71
    s_nop 0
    buffer_load_dwordx4 v38, s[20:23], s70 offen lds
    s_add_u32 s71, s71, 0x400
    s_add_u32 s70, s70, 0x8000
    s_mov_b32 m0, s71
    s_nop 0
    buffer_load_dwordx4 v39, s[20:23], s70 offen lds
    s_add_u32 s71, s71, 0x400
    s_add_u32 s70, s70, 0x8000
    s_mov_b32 m0, s71
    s_nop 0
    buffer_load_dwordx4 v39, s[20:23], s70 offen lds
    s_add_u32 s71, s71, 0x400
    s_add_u32 s70, s70, 0x8000
    s_lshl_b32 s70, s66, 18
    s_lshl_b32 s71, s58, 15
    s_add_u32 s70, s70, s71
    s_lshl_b32 s71, s64, 9
    s_add_u32 s70, s70, s71
    s_lshl_b32 s71, s58, 13
    s_add_u32 s71, s71, 65536
    v_xor_b32 v2, 0, v40
    s_mov_b32 m0, s71
    s_nop 0
    buffer_load_dwordx4 v2, s[32:35], s70 offen lds
    s_add_u32 s71, s71, 0x400
    s_add_u32 s70, s70, 0x1000
    v_xor_b32 v2, 64, v40
    s_mov_b32 m0, s71
    s_nop 0
    buffer_load_dwordx4 v2, s[32:35], s70 offen lds
    s_add_u32 s71, s71, 0x400
    s_add_u32 s70, s70, 0x1000
    v_xor_b32 v2, 128, v40
    s_mov_b32 m0, s71
    s_nop 0
    buffer_load_dwordx4 v2, s[32:35], s70 offen lds
    s_add_u32 s71, s71, 0x400
    s_add_u32 s70, s70, 0x1000
    v_xor_b32 v2, 192, v40
    s_mov_b32 m0, s71
    s_nop 0
    buffer_load_dwordx4 v2, s[32:35], s70 offen lds
    s_add_u32 s71, s71, 0x400
    s_add_u32 s70, s70, 0x1000
    v_xor_b32 v2, 0, v40
    s_mov_b32 m0, s71
    s_nop 0
    buffer_load_dwordx4 v2, s[32:35], s70 offen lds
    s_add_u32 s71, s71, 0x400
    s_add_u32 s70, s70, 0x1000
    v_xor_b32 v2, 64, v40
    s_mov_b32 m0, s71
    s_nop 0
    buffer_load_dwordx4 v2, s[32:35], s70 offen lds
    s_add_u32 s71, s71, 0x400
    s_add_u32 s70, s70, 0x1000
    v_xor_b32 v2, 128, v40
    s_mov_b32 m0, s71
    s_nop 0
    buffer_load_dwordx4 v2, s[32:35], s70 offen lds
    s_add_u32 s71, s71, 0x400
    s_add_u32 s70, s70, 0x1000
    v_xor_b32 v2, 192, v40
    s_mov_b32 m0, s71
    s_nop 0
    buffer_load_dwordx4 v2, s[32:35], s70 offen lds
    s_add_u32 s71, s71, 0x400
    s_add_u32 s70, s70, 0x1000
    s_waitcnt vmcnt(0)
    s_barrier
    s_cmp_ge_u32 s58, 4
    s_cbranch_scc1 skip_10
    v_xor_b32 v2, 0x0, v41
    v_xor_b32 v3, 0x40, v41
    ds_read_b64_tr_b16 v[128:129], v2 offset:0
    ds_read_b64_tr_b16 v[130:131], v3 offset:512
    ds_read_b64_tr_b16 v[132:133], v2 offset:4096
    ds_read_b64_tr_b16 v[134:135], v3 offset:4608
    v_xor_b32 v2, 0x2000, v41
    v_xor_b32 v3, 0x2040, v41
    ds_read_b64_tr_b16 v[136:137], v2 offset:0
    ds_read_b64_tr_b16 v[138:139], v3 offset:512
    ds_read_b64_tr_b16 v[140:141], v2 offset:4096
    ds_read_b64_tr_b16 v[142:143], v3 offset:4608
    v_xor_b32 v2, 0x4000, v41
    v_xor_b32 v3, 0x4040, v41
    ds_read_b64_tr_b16 v[144:145], v2 offset:0
    ds_read_b64_tr_b16 v[146:147], v3 offset:512
    ds_read_b64_tr_b16 v[148:149], v2 offset:4096
    ds_read_b64_tr_b16 v[150:151], v3 offset:4608
    v_xor_b32 v2, 0x6000, v41
    v_xor_b32 v3, 0x6040, v41
    ds_read_b64_tr_b16 v[152:153], v2 offset:0
    ds_read_b64_tr_b16 v[154:155], v3 offset:512
    ds_read_b64_tr_b16 v[156:157], v2 offset:4096
    ds_read_b64_tr_b16 v[158:159], v3 offset:4608
    s_waitcnt lgkmcnt(0)
    v_xor_b32 v2, 0x10, v41
    v_xor_b32 v3, 0x50, v41
    ds_read_b64_tr_b16 v[160:161], v2 offset:0
    ds_read_b64_tr_b16 v[162:163], v3 offset:512
    ds_read_b64_tr_b16 v[164:165], v2 offset:4096
    ds_read_b64_tr_b16 v[166:167], v3 offset:4608
    v_xor_b32 v2, 0x2010, v41
    v_xor_b32 v3, 0x2050, v41
    ds_read_b64_tr_b16 v[168:169], v2 offset:0
    ds_read_b64_tr_b16 v[170:171], v3 offset:512
    ds_read_b64_tr_b16 v[172:173], v2 offset:4096
    ds_read_b64_tr_b16 v[174:175], v3 offset:4608
    v_xor_b32 v2, 0x4010, v41
    v_xor_b32 v3, 0x4050, v41
    ds_read_b64_tr_b16 v[176:177], v2 offset:0
    ds_read_b64_tr_b16 v[178:179], v3 offset:512
    ds_read_b64_tr_b16 v[180:181], v2 offset:4096
    ds_read_b64_tr_b16 v[182:183], v3 offset:4608
    v_xor_b32 v2, 0x6010, v41
    v_xor_b32 v3, 0x6050, v41
    ds_read_b64_tr_b16 v[184:185], v2 offset:0
    ds_read_b64_tr_b16 v[186:187], v3 offset:512
    ds_read_b64_tr_b16 v[188:189], v2 offset:4096
    ds_read_b64_tr_b16 v[190:191], v3 offset:4608
    s_waitcnt lgkmcnt(0)
skip_10:
    s_cmp_ge_u32 s58, 4
    s_cbranch_scc0 skip_11
    v_xor_b32 v2, 0, v42
    v_xor_b32 v3, 64, v42
    ds_read_b64_tr_b16 v[192:193], v2 offset:0
    ds_read_b64_tr_b16 v[194:195], v3 offset:1024
    ds_read_b64_tr_b16 v[196:197], v2 offset:8192
    ds_read_b64_tr_b16 v[198:199], v3 offset:9216
    ds_read_b64_tr_b16 v[200:201], v2 offset:32768
    ds_read_b64_tr_b16 v[202:203], v3 offset:33792
    ds_read_b64_tr_b16 v[204:205], v2 offset:40960
    ds_read_b64_tr_b16 v[206:207], v3 offset:41984
    ds_read_b64_tr_b16 v[224:225], v2 offset:256
    ds_read_b64_tr_b16 v[226:227], v3 offset:1280
    ds_read_b64_tr_b16 v[228:229], v2 offset:8448
    ds_read_b64_tr_b16 v[230:231], v3 offset:9472
    ds_read_b64_tr_b16 v[232:233], v2 offset:33024
    ds_read_b64_tr_b16 v[234:235], v3 offset:34048
    ds_read_b64_tr_b16 v[236:237], v2 offset:41216
    ds_read_b64_tr_b16 v[238:239], v3 offset:42240
    s_waitcnt lgkmcnt(0)
    v_xor_b32 v2, 32, v42
    v_xor_b32 v3, 96, v42
    ds_read_b64_tr_b16 v[208:209], v2 offset:0
    ds_read_b64_tr_b16 v[210:211], v3 offset:1024
    ds_read_b64_tr_b16 v[212:213], v2 offset:8192
    ds_read_b64_tr_b16 v[214:215], v3 offset:9216
    ds_read_b64_tr_b16 v[216:217], v2 offset:32768
    ds_read_b64_tr_b16 v[218:219], v3 offset:33792
    ds_read_b64_tr_b16 v[220:221], v2 offset:40960
    ds_read_b64_tr_b16 v[222:223], v3 offset:41984
    ds_read_b64_tr_b16 v[240:241], v2 offset:256
    ds_read_b64_tr_b16 v[242:243], v3 offset:1280
    ds_read_b64_tr_b16 v[244:245], v2 offset:8448
    ds_read_b64_tr_b16 v[246:247], v3 offset:9472
    ds_read_b64_tr_b16 v[248:249], v2 offset:33024
    ds_read_b64_tr_b16 v[250:251], v3 offset:34048
    ds_read_b64_tr_b16 v[252:253], v2 offset:41216
    ds_read_b64_tr_b16 v[254:255], v3 offset:42240
    s_waitcnt lgkmcnt(0)
skip_11:
    v_mov_b32 v4, 0x27ff0
    s_cmp_lg_u32 s58, 4
    s_cbranch_scc1 armw_12
armwait_13:
    buffer_load_dwordx2 v[2:3], off, s[12:15], 0 offset:32 sc1
    s_waitcnt vmcnt(0)
    v_and_b32 v5, 0x3ff, v2
    v_cmp_gt_u32 vcc, 128, v5
    s_cbranch_vccz armwait_ok_14
    s_sub_u32 s69, s69, 1
    s_cbranch_scc0 armwait_13
    s_mov_b32 s69, 0
armwait_ok_14:
    ds_write_b64 v4, v[2:3]
    s_waitcnt lgkmcnt(0)
armw_12:
    s_barrier
    ds_read_b64 v[2:3], v4
    s_mov_b32 s59, 0
    s_waitcnt lgkmcnt(0)
    v_readfirstlane_b32 s70, v2
    v_readfirstlane_b32 s71, v3
    s_bfe_u32 s72, s70, 0xa000a
    s_cmp_gt_u32 s72, 128
    s_cselect_b32 s72, 1, 0
    s_or_b32 s59, s59, s72
    s_bfe_u32 s72, s70, 0xa0014
    s_cmp_gt_u32 s72, 128
    s_cselect_b32 s72, 2, 0
    s_or_b32 s59, s59, s72
    s_bfe_u32 s72, s71, 0xa000a
    s_cmp_gt_u32 s72, 128
    s_cselect_b32 s72, 4, 0
    s_or_b32 s59, s59, s72
    s_bfe_u32 s72, s71, 0xa0014
    s_cmp_gt_u32 s72, 128
    s_cselect_b32 s72, 8, 0
    s_or_b32 s59, s59, s72
    s_and_b32 s70, s59, 1
    s_lshl_b32 s70, s70, 13
    s_add_u32 s77, s77, s70
    s_add_u32 s76, s76, s70
    s_mov_b32 s68, 0
    s_mov_b32 s82, 0
    s_lshl_b32 s80, s66, 11
    s_lshl_b32 s70, s67, 9
    s_add_u32 s80, s80, s70
    v_bfe_u32 v38, v1, 0, 3
    v_lshlrev_b32 v38, 4, v38
    v_bfe_u32 v2, v1, 3, 1
    v_lshl_or_b32 v38, v2, 8, v38
    v_bfe_u32 v2, v1, 4, 2
    v_lshl_or_b32 v38, v2, 9, v38
    s_lshl_b32 s75, s80, 2
    s_add_u32 s75, s75, 0x1000000
    s_cmp_ge_u32 s58, 4
    s_cbranch_scc1 vo_main_15
    s_setprio 3
    s_lshl_b32 s70, s66, 4
    s_lshl_b32 s71, s64, 2
    s_add_u32 s71, s71, s67
    s_add_u32 s3, s70, s71
    s_add_u32 s80, s80, 0x3ff0000
    s_lshl_b32 s70, s67, 10
    v_add_u32 v102, s70, v8
    v_lshrrev_b32 v103, 2, v102
    v_bfe_u32 v2, v1, 0, 3
    v_lshlrev_b32 v2, 4, v2
    v_bfe_u32 v3, v1, 4, 2
    v_lshl_or_b32 v2, v3, 7, v2
    v_mov_b32 v3, 0x5ffffff0
    v_cmp_le_u32 vcc, 8, v6
    s_nop 1
    v_cndmask_b32 v104, v3, v2, vcc
    v_xor_b32 v100, 1024, v102
    v_xor_b32 v101, 2048, v102
    v_xor_b32 v36, 3072, v102
    v_xor_b32 v106, 0x400, v34
    v_bfe_u32 v105, v1, 0, 4
    v_lshlrev_b32 v105, 4, v105
    v_bfe_u32 v2, v1, 4, 2
    v_lshl_or_b32 v105, v2, 9, v105
    s_lshl_b32 s70, s64, 10
    s_xor_b32 s70, s70, 0x800
    v_xor_b32 v105, s70, v105
    v_and_b32 v2, 1, v1
    v_lshlrev_b32 v2, 4, v2
    v_mov_b32 v3, 0x3f80
    v_lshlrev_b32 v2, v2, v3
    v_bfe_u32 v3, v1, 1, 1
    v_bfe_u32 v4, v1, 3, 1
    v_lshl_or_b32 v3, v4, 1, v3
    v_bfe_u32 v4, v1, 2, 1
    v_lshl_or_b32 v3, v4, 2, v3
    v_bfe_u32 v4, v1, 4, 1
    v_lshlrev_b32 v4, 2, v4
    v_xor_b32 v3, v3, v4
    v_cmp_eq_u32 vcc, 0, v3
    s_nop 1
    v_cndmask_b32 v26, 0, v2, vcc
    v_cmp_eq_u32 vcc, 1, v3
    s_nop 1
    v_cndmask_b32 v27, 0, v2, vcc
    v_cmp_eq_u32 vcc, 2, v3
    s_nop 1
    v_cndmask_b32 v28, 0, v2, vcc
    v_cmp_eq_u32 vcc, 3, v3
    s_nop 1
    v_cndmask_b32 v29, 0, v2, vcc
    v_bfe_u32 v3, v1, 1, 1
    v_bfe_u32 v4, v1, 3, 1
    v_lshl_or_b32 v3, v4, 1, v3
    v_bfe_u32 v4, v1, 4, 1
    v_lshl_or_b32 v3, v4, 2, v3
    v_bfe_u32 v4, v1, 2, 1
    v_lshl_or_b32 v3, v4, 3, v3
    v_bfe_u32 v4, v1, 5, 1
    v_lshlrev_b32 v4, 3, v4
    v_xor_b32 v3, v3, v4
    v_cmp_eq_u32 vcc, 0, v3
    s_nop 1
    v_cndmask_b32 v92, 0, v2, vcc
    v_cmp_eq_u32 vcc, 1, v3
    s_nop 1
    v_cndmask_b32 v93, 0, v2, vcc
    v_cmp_eq_u32 vcc, 2, v3
    s_nop 1
    v_cndmask_b32 v94, 0, v2, vcc
    v_cmp_eq_u32 vcc, 3, v3
    s_nop 1
    v_cndmask_b32 v95, 0, v2, vcc
    v_cmp_eq_u32 vcc, 4, v3
    s_nop 1
    v_cndmask_b32 v96, 0, v2, vcc
    v_cmp_eq_u32 vcc, 5, v3
    s_nop 1
    v_cndmask_b32 v97, 0, v2, vcc
    v_cmp_eq_u32 vcc, 6, v3
    s_nop 1
    v_cndmask_b32 v98, 0, v2, vcc
    v_cmp_eq_u32 vcc, 7, v3
    s_nop 1
    v_cndmask_b32 v99, 0, v2, vcc
    v_bfe_u32 v3, v1, 2, 1
    v_bfe_u32 v4, v1, 1, 1
    v_lshl_or_b32 v3, v4, 1, v3
    v_bfe_u32 v4, v1, 3, 1
    v_lshl_or_b32 v3, v4, 2, v3
    v_bfe_u32 v4, v1, 4, 1
    v_lshlrev_b32 v4, 2, v4
    v_xor_b32 v3, v3, v4
    v_cmp_eq_u32 vcc, 0, v3
    s_nop 1
    v_cndmask_b32 v30, 0, v2, vcc
    v_cmp_eq_u32 vcc, 1, v3
    s_nop 1
    v_cndmask_b32 v31, 0, v2, vcc
    v_cmp_eq_u32 vcc, 2, v3
    s_nop 1
    v_cndmask_b32 v32, 0, v2, vcc
    v_cmp_eq_u32 vcc, 3, v3
    s_nop 1
    v_cndmask_b32 v33, 0, v2, vcc
    v_mov_b32 v40, 0
    v_mov_b32 v41, 0
    v_mov_b32 v42, 0
    v_mov_b32 v43, 0
    v_mov_b32 v44, 0
    v_mov_b32 v45, 0
    v_mov_b32 v46, 0
    v_mov_b32 v47, 0
    v_mov_b32 v48, 0
    v_mov_b32 v49, 0
    v_mov_b32 v50, 0
    v_mov_b32 v51, 0
    v_mov_b32 v52, 0
    v_mov_b32 v53, 0
    v_mov_b32 v54, 0
    v_mov_b32 v55, 0
    s_branch qk_loop_17
.p2align 6
qk_c_18:
    s_barrier
    buffer_load_dwordx4 v[56:59], v37, s[8:11], s76 offen offset:0 sc1
    buffer_load_dwordx4 v[60:63], v37, s[8:11], s76 offen offset:1024 sc1
    buffer_load_dwordx4 v[64:67], v37, s[8:11], s76 offen offset:2048 sc1
    buffer_load_dwordx4 v[68:71], v37, s[8:11], s76 offen offset:3072 sc1
c_w_20:
    s_waitcnt vmcnt(3)
    v_mfma_f32_16x16x32_bf16 v[72:75], v[56:59], v[30:33], 0
    s_waitcnt vmcnt(2)
    v_mfma_f32_16x16x32_bf16 v[72:75], v[60:63], v[30:33], v[72:75]
    s_waitcnt vmcnt(1)
    v_mfma_f32_16x16x32_bf16 v[76:79], v[64:67], v[30:33], 0
    v_max3_u32 v2, v56, v60, v64
    s_waitcnt vmcnt(0)
    v_mfma_f32_16x16x32_bf16 v[76:79], v[68:71], v[30:33], v[76:79]
    v_max_u32 v2, v2, v68
    v_cmp_eq_u32 vcc, -1, v2
    s_cbranch_vccnz c_s_19
c_j_21:
    v_cvt_pk_bf16_f32 v10, v72, v73
    v_cvt_pk_bf16_f32 v11, v74, v75
    s_nop 2
    v_cvt_pk_bf16_f32 v12, v76, v77
    v_cvt_pk_bf16_f32 v13, v78, v79
qk_loop_17:
    ds_write_b128 v102, v[10:13] offset:0
    s_waitcnt lgkmcnt(0)
    s_barrier
    ds_read_b128 v[14:17], v100 offset:0
    ds_read_b128 v[18:21], v101 offset:0
    ds_read_b128 v[22:25], v36 offset:0
    v_smfmac_f32_16x16x64_bf16 v[40:43], v[10:13], v[128:135], v7
    v_smfmac_f32_16x16x64_bf16 v[44:47], v[10:13], v[160:167], v7
    v_smfmac_f32_16x16x64_bf16 v[48:51], v[10:13], v[192:199], v7
    v_smfmac_f32_16x16x64_bf16 v[52:55], v[10:13], v[224:231], v7
    s_waitcnt lgkmcnt(2)
    v_smfmac_f32_16x16x64_bf16 v[40:43], v[14:17], v[136:143], v7
    v_smfmac_f32_16x16x64_bf16 v[44:47], v[14:17], v[168:175], v7
    s_waitcnt lgkmcnt(1)
    v_smfmac_f32_16x16x64_bf16 v[40:43], v[18:21], v[144:151], v7
    v_smfmac_f32_16x16x64_bf16 v[44:47], v[18:21], v[176:183], v7
    s_waitcnt lgkmcnt(0)
    v_smfmac_f32_16x16x64_bf16 v[40:43], v[22:25], v[152:159], v7
    v_smfmac_f32_16x16x64_bf16 v[44:47], v[22:25], v[184:191], v7
    v_smfmac_f32_16x16x64_bf16 v[48:51], v[14:17], v[200:207], v7
    v_smfmac_f32_16x16x64_bf16 v[48:51], v[18:21], v[208:215], v7
    v_smfmac_f32_16x16x64_bf16 v[48:51], v[22:25], v[216:223], v7
    v_smfmac_f32_16x16x64_bf16 v[52:55], v[14:17], v[232:239], v7
    s_nop 1
    v_smfmac_f32_16x16x64_bf16 v[52:55], v[18:21], v[240:247], v7
    v_pk_add_f32 v[40:41], v[40:41], v[42:43]
    v_cvt_pk_bf16_f32 v80, v40, v41
    v_smfmac_f32_16x16x64_bf16 v[52:55], v[22:25], v[248:255], v7
    v_pk_add_f32 v[44:45], v[44:45], v[46:47]
    v_cvt_pk_bf16_f32 v81, v44, v45
    v_pk_add_f32 v[48:49], v[48:49], v[50:51]
    v_cvt_pk_bf16_f32 v82, v48, v49
    v_permlane16_swap_b32 v80, v81
    v_bfi_b32 v80, 1, s82, v80
    s_nop 1
    v_pk_add_f32 v[52:53], v[52:53], v[54:55]
    v_cvt_pk_bf16_f32 v83, v52, v53
    s_nop 1
    v_permlane16_swap_b32 v82, v83
    buffer_store_dwordx4 v[80:83], v34, s[8:11], s73 offen
    s_barrier
    s_cmp_eq_u32 s68, 0
    s_cbranch_scc1 kv0_22
kv0j_23:
    v_mfma_f32_16x16x32_bf16 v[72:75], v[80:83], v[92:95], 0
    v_mfma_f32_16x16x32_bf16 v[76:79], v[80:83], v[96:99], 0
    v_mov_b32 v40, 0
    v_mov_b32 v41, 0
    v_mov_b32 v42, 0
    v_mov_b32 v43, 0
    v_mov_b32 v44, 0
    v_mov_b32 v45, 0
    v_mov_b32 v46, 0
    v_mov_b32 v47, 0
    v_mov_b32 v48, 0
    v_mov_b32 v49, 0
    v_mov_b32 v50, 0
    v_mov_b32 v51, 0
    v_mov_b32 v52, 0
    v_mov_b32 v53, 0
    v_mov_b32 v54, 0
    v_mov_b32 v55, 0
    buffer_load_dwordx4 v[56:59], v106, s[8:11], s73 offen sc1
    buffer_load_dwordx4 v[60:63], v105, s[8:11], s73 offen sc1
    buffer_load_dwordx4 v[64:67], v105, s[8:11], s73 offen offset:256 sc1
x_w_25:
    s_waitcnt vmcnt(2)
    v_mfma_f32_16x16x32_bf16 v[18:21], v[56:59], v[92:95], v[72:75]
    v_mfma_f32_16x16x32_bf16 v[22:25], v[56:59], v[96:99], v[76:79]
    s_waitcnt vmcnt(1)
    v_mfma_f32_16x16x32_bf16 v[18:21], v[60:63], v[26:29], v[18:21]
    v_bitop3_b32 v2, v56, v60, s82 bitop3:0x7e
    s_waitcnt vmcnt(0)
    v_mfma_f32_16x16x32_bf16 v[22:25], v[64:67], v[26:29], v[22:25]
    v_xor_b32 v3, s82, v64
    v_bitop3_b32 v2, v2, v3, 1 bitop3:0xa8
    v_cmp_ne_u32 vcc, 0, v2
    s_cbranch_vccnz x_s_24
x_j_26:
    s_nop 0
    v_cvt_pk_bf16_f32 v80, v18, v19
    v_cvt_pk_bf16_f32 v81, v20, v21
    s_nop 0
    v_cvt_pk_bf16_f32 v82, v22, v23
    v_cvt_pk_bf16_f32 v83, v24, v25
    s_nop 1
    v_mfma_f32_16x16x32_bf16 v[18:21], v[80:83], v[80:83], 0
    s_nop 1
    v_mfma_f32_16x16x32_bf16 v[14:17], v[88:91], v[80:83], 0
    s_nop 1
    v_mfma_f32_16x16x32_bf16 v[10:13], v[84:87], v[80:83], 0
    s_nop 1
    v_mov_b32_dpp v18, v20 row_shr:8 row_mask:0xf bank_mask:0xc
    v_mov_b32_dpp v19, v21 row_shr:8 row_mask:0xf bank_mask:0xc
    s_nop 1
    v_permlane32_swap_b32 v18, v19
    ds_write_b32 v103, v19 offset:8192
    v_mov_b32_dpp v10, v14 row_shr:8 row_mask:0xf bank_mask:0xc
    v_mov_b32_dpp v11, v15 row_shr:8 row_mask:0xf bank_mask:0xc
    v_mov_b32_dpp v12, v16 row_shr:8 row_mask:0xf bank_mask:0xc
    v_mov_b32_dpp v13, v17 row_shr:8 row_mask:0xf bank_mask:0xc
    ds_write_b128 v102, v[10:13] offset:4096
    s_waitcnt lgkmcnt(0)
    s_barrier
    s_setprio 0
    s_add_u32 s77, s77, 0x20000
    s_lshr_b32 s60, s77, 21
    s_bitcmp1_b32 s59, s60
    s_cselect_b32 s60, 0x2000, 0
    s_bitset0_b32 s77, 13
    s_or_b32 s77, s77, s60
    s_add_u32 s76, s76, 0x20000
    s_lshr_b32 s60, s76, 21
    s_bitcmp1_b32 s59, s60
    s_cselect_b32 s60, 0x2000, 0
    s_bitset0_b32 s76, 13
    s_or_b32 s76, s76, s60
    s_add_u32 s80, s80, 0x10000
    s_and_b32 s72, s68, 3
    s_cmp_lg_u32 s72, s64
    s_cbranch_scc1 nokm_27
    v_min_u32 v80, -2, v80
    buffer_store_dwordx4 v[80:83], v104, s[8:11], s80 offen sc1
nokm_27:
    s_cmp_eq_u32 s68, 63
    s_cbranch_scc1 chain_end_16
    buffer_load_dwordx4 v[84:87], v38, s[8:11], s75 offen offset:0
    buffer_load_dwordx4 v[88:91], v38, s[8:11], s75 offen offset:128
    s_add_u32 s75, s75, 0x40000
    v_mov_b32 v10, -1
    v_mov_b32 v11, -1
    v_mov_b32 v12, -1
    v_mov_b32 v13, -1
    buffer_store_dwordx4 v[10:13], v35, s[8:11], s77 offen sc1
    s_cmp_lg_u32 s3, 1
    s_cbranch_scc1 noprog_28
    v_mov_b32 v2, s68
    buffer_store_dword v2, off, s[12:15], 0 offset:64 sc1
noprog_28:
    s_barrier
    s_add_u32 s68, s68, 1
    s_bfe_u32 s82, s68, 0x10001
    s_xor_b32 s73, s73, 0x80000
    s_setprio 3
    s_branch qk_c_18
c_s_19:
    buffer_load_dwordx4 v[56:59], v37, s[8:11], s76 offen offset:0 sc1
    buffer_load_dwordx4 v[60:63], v37, s[8:11], s76 offen offset:1024 sc1
    buffer_load_dwordx4 v[64:67], v37, s[8:11], s76 offen offset:2048 sc1
    buffer_load_dwordx4 v[68:71], v37, s[8:11], s76 offen offset:3072 sc1
    s_sub_u32 s69, s69, 1
    s_cbranch_scc0 c_w_20
    s_mov_b32 s69, 0
    s_branch c_j_21
kv0_22:
    buffer_load_dwordx4 v[84:87], v38, s[8:11], s75 offen offset:0
    buffer_load_dwordx4 v[88:91], v38, s[8:11], s75 offen offset:128
    s_add_u32 s75, s75, 0x40000
    s_branch kv0j_23
x_s_24:
    buffer_load_dwordx4 v[56:59], v106, s[8:11], s73 offen sc1
    buffer_load_dwordx4 v[60:63], v105, s[8:11], s73 offen sc1
    buffer_load_dwordx4 v[64:67], v105, s[8:11], s73 offen offset:256 sc1
    s_sub_u32 s69, s69, 1
    s_cbranch_scc0 x_w_25
    s_mov_b32 s69, 0
    s_branch x_j_26
vo_main_15:
    s_setprio 1
    v_mov_b32 v88, 0x3f803f80
    v_mov_b32 v92, 0x3e803e80
    v_mov_b32 v89, 0x3f803f80
    v_mov_b32 v93, 0x3e803e80
    v_mov_b32 v90, 0x3f803f80
    v_mov_b32 v94, 0x3e803e80
    v_mov_b32 v91, 0x3f803f80
    v_mov_b32 v95, 0x3e803e80
    v_and_b32 v2, 1, v1
    v_lshlrev_b32 v2, 4, v2
    v_mov_b32 v3, 0x3f80
    v_lshlrev_b32 v2, v2, v3
    v_lshrrev_b32 v3, 1, v6
    v_cmp_eq_u32 vcc, 0, v3
    s_nop 1
    v_cndmask_b32 v26, 0, v2, vcc
    v_cmp_eq_u32 vcc, 1, v3
    s_nop 1
    v_cndmask_b32 v27, 0, v2, vcc
    v_cmp_eq_u32 vcc, 2, v3
    s_nop 1
    v_cndmask_b32 v28, 0, v2, vcc
    v_cmp_eq_u32 vcc, 3, v3
    s_nop 1
    v_cndmask_b32 v29, 0, v2, vcc
    v_bfe_u32 v119, v1, 0, 3
    v_lshlrev_b32 v119, 3, v119
    v_bfe_u32 v3, v1, 3, 1
    v_lshl_or_b32 v119, v3, 7, v119
    v_bfe_u32 v3, v1, 5, 1
    v_lshl_or_b32 v119, v3, 6, v119
    v_bfe_u32 v3, v1, 4, 1
    v_lshl_or_b32 v119, v3, 8, v119
    v_bfe_u32 v3, v1, 1, 3
    v_bfe_u32 v4, v1, 4, 1
    v_lshlrev_b32 v4, 1, v4
    v_xor_b32 v3, v3, v4
    v_cmp_eq_u32 vcc, 0, v3
    s_nop 1
    v_cndmask_b32 v100, 0, v2, vcc
    v_cndmask_b32 v102, 0, v2, vcc
    v_cmp_eq_u32 vcc, 1, v3
    s_nop 1
    v_cndmask_b32 v101, 0, v2, vcc
    v_cndmask_b32 v103, 0, v2, vcc
    v_cmp_eq_u32 vcc, 4, v3
    s_nop 1
    v_cndmask_b32 v104, 0, v2, vcc
    v_cndmask_b32 v106, 0, v2, vcc
    v_cmp_eq_u32 vcc, 5, v3
    s_nop 1
    v_cndmask_b32 v105, 0, v2, vcc
    v_cndmask_b32 v107, 0, v2, vcc
    s_add_u32 s80, s80, 0x4400000
    s_mov_b32 s81, 0x3e0293ee
    v_lshlrev_b32 v116, 2, v1
    v_bfe_u32 v118, v1, 0, 1
    v_lshlrev_b32 v118, 4, v118
    v_bfe_u32 v2, v1, 2, 2
    v_lshl_or_b32 v118, v2, 5, v118
    v_bfe_u32 v2, v1, 1, 1
    v_lshl_or_b32 v118, v2, 7, v118
    v_bfe_u32 v2, v1, 4, 2
    v_lshl_or_b32 v118, v2, 8, v118
    v_bfe_u32 v2, v1, 1, 1
    v_lshl_or_b32 v118, v2, 10, v118
    v_bfe_u32 v120, v1, 4, 2
    v_lshlrev_b32 v120, 3, v120
    s_add_u32 s75, s75, 0x1000000
    s_bfe_u32 s70, s67, 0x10000
    s_lshl_b32 s70, s70, 7
    s_bfe_u32 s71, s67, 0x20000
    s_lshl_b32 s71, s71, 10
    s_or_b32 s70, s70, s71
    v_xor_b32 v117, s70, v8
    s_lshl_b32 s4, s66, 7
    s_add_u32 s4, s4, 0x5110000
    s_cmp_eq_u32 s58, 4
    s_cselect_b32 s2, 0, 99
    s_mov_b32 s3, 0
    v_mov_b32 v122, 0
    v_mov_b32 v40, 0
    v_mov_b32 v41, 0
    v_mov_b32 v42, 0
    v_mov_b32 v43, 0
    v_mov_b32 v44, 0
    v_mov_b32 v45, 0
    v_mov_b32 v46, 0
    v_mov_b32 v47, 0
    v_mov_b32 v48, 0
    v_mov_b32 v49, 0
    v_mov_b32 v50, 0
    v_mov_b32 v51, 0
    v_mov_b32 v52, 0
    v_mov_b32 v53, 0
    v_mov_b32 v54, 0
    v_mov_b32 v55, 0
    v_mov_b32 v56, 0
    v_mov_b32 v57, 0
    v_mov_b32 v58, 0
    v_mov_b32 v59, 0
    v_mov_b32 v60, 0
    v_mov_b32 v61, 0
    v_mov_b32 v62, 0
    v_mov_b32 v63, 0
    s_branch vo_loop_29
.p2align 6
vo_loop_29:
    s_barrier
    ds_read_b128 v[10:13], v8 offset:0
    ds_read_b128 v[14:17], v8 offset:1024
    ds_read_b128 v[18:21], v8 offset:2048
    ds_read_b128 v[22:25], v8 offset:3072
    s_cmp_ge_i32 s3, s2
    s_cbranch_scc1 kvg_31
kvj_33:
    s_add_u32 s3, s3, 1
    s_barrier
    s_cmp_eq_u32 s68, 0
    s_cbranch_scc1 kv0_34
kv0j_35:
    s_waitcnt lgkmcnt(3)
    v_smfmac_f32_16x16x64_bf16 v[40:43], v[10:13], v[128:135], v7
    v_smfmac_f32_16x16x64_bf16 v[44:47], v[10:13], v[160:167], v7
    s_waitcnt lgkmcnt(2)
    v_smfmac_f32_16x16x64_bf16 v[40:43], v[14:17], v[136:143], v7
    v_smfmac_f32_16x16x64_bf16 v[44:47], v[14:17], v[168:175], v7
    s_waitcnt lgkmcnt(1)
    v_smfmac_f32_16x16x64_bf16 v[40:43], v[18:21], v[144:151], v7
    v_smfmac_f32_16x16x64_bf16 v[44:47], v[18:21], v[176:183], v7
    s_waitcnt lgkmcnt(0)
    v_smfmac_f32_16x16x64_bf16 v[40:43], v[22:25], v[152:159], v7
    v_smfmac_f32_16x16x64_bf16 v[44:47], v[22:25], v[184:191], v7
    s_nop 6
    v_pk_add_f32 v[40:41], v[40:41], v[42:43]
    v_cvt_pk_bf16_f32 v80, v40, v41
    v_pk_add_f32 v[44:45], v[44:45], v[46:47]
    v_cvt_pk_bf16_f32 v81, v44, v45
    s_nop 1
    v_permlane16_swap_b32 v80, v81
    v_bfi_b32 v80, 1, s82, v80
    buffer_store_dwordx2 v[80:81], v34, s[8:11], s73 offen
    s_and_b32 s70, s68, 1
    s_lshl_b32 s70, s70, 19
    s_add_u32 s71, s70, s79
    s_add_u32 s70, s70, s78
    s_cmp_eq_u32 s68, 63
    s_cbranch_scc1 vo_last_30
    s_waitcnt vmcnt(1)
    s_cmp_ge_i32 s3, s2
    s_cbranch_scc1 kvg_36
kvj_38:
    s_barrier
    ds_read_b128 v[10:13], v8 offset:4096
    ds_read_b128 v[14:17], v8 offset:5120
    ds_read2st64_b32 v[30:31], v116 offset0:32 offset1:33
    ds_read_b128 v[18:21], v8 offset:6144
    ds_read_b128 v[22:25], v8 offset:7168
    ds_read2st64_b32 v[32:33], v116 offset0:34 offset1:35
    buffer_load_dwordx4 v[64:67], v8, s[8:11], s73 offen offset:0 sc1
    buffer_load_dwordx4 v[68:71], v8, s[8:11], s73 offen offset:1024 sc1
    s_waitcnt lgkmcnt(4)
    v_pk_add_f32 v[10:11], v[10:11], v[14:15]
    v_pk_add_f32 v[12:13], v[12:13], v[16:17]
    s_waitcnt lgkmcnt(2)
    v_pk_add_f32 v[10:11], v[10:11], v[18:19]
    v_pk_add_f32 v[12:13], v[12:13], v[20:21]
    s_waitcnt lgkmcnt(0)
    v_pk_add_f32 v[30:31], v[30:31], v[32:33]
    v_pk_add_f32 v[10:11], v[10:11], v[22:23]
    v_pk_add_f32 v[12:13], v[12:13], v[24:25]
    v_add_f32 v14, v30, v31
    v_max3_f32 v2, v10, v11, v12
    v_max3_f32 v3, v2, v13, v14
    v_max3_f32 v2, v2, v13, v14
    s_nop 1
    v_permlane32_swap_b32 v2, v3
    v_max_f32 v4, v2, v3
    v_max_f32 v3, v2, v3
    s_nop 1
    v_permlane16_swap_b32 v4, v3
    v_max_f32 v2, v4, v3
    v_mul_f32 v2, s81, v2
    s_nop 1
    v_max_f32_dpp v2, v2, v2 row_ror:8 row_mask:0xf bank_mask:0xf
    v_fma_f32 v10, v10, s81, -v2
    v_fma_f32 v11, v11, s81, -v2
    v_fma_f32 v12, v12, s81, -v2
    v_fma_f32 v13, v13, s81, -v2
    v_fma_f32 v14, v14, s81, -v2
    v_exp_f32 v10, v10
    v_exp_f32 v11, v11
    v_exp_f32 v12, v12
    v_exp_f32 v13, v13
    v_exp_f32 v15, v14
    v_cvt_pk_bf16_f32 v80, v10, v11
    v_cvt_pk_bf16_f32 v81, v12, v13
    v_mov_b32 v14, v15
    v_mov_b32_dpp v82, v80 row_ror:8 row_mask:0xf bank_mask:0xf
    v_mov_b32_dpp v83, v81 row_ror:8 row_mask:0xf bank_mask:0xf
    v_permlane32_swap_b32 v14, v15
    v_cvt_pk_bf16_f32 v84, v14, v15
    v_mfma_f32_16x16x32_bf16 v[108:111], v[72:75], v[80:83], 0
    v_mov_b32 v86, v84
    v_mov_b32_dpp v85, v84 row_ror:8 row_mask:0xf bank_mask:0xf
    v_mov_b32_dpp v87, v84 row_ror:8 row_mask:0xf bank_mask:0xf
    v_mfma_f32_16x16x32_bf16 v[112:115], v[76:79], v[80:83], 0
xv_w_40:
    s_waitcnt vmcnt(0)
    v_mfma_f32_16x16x32_bf16 v[18:21], v[64:67], v[84:87], v[108:111]
    v_bitop3_b32 v2, v64, v66, s82 bitop3:0x7e
    v_bitop3_b32 v3, v68, v70, s82 bitop3:0x7e
    v_mfma_f32_16x16x32_bf16 v[22:25], v[68:71], v[84:87], v[112:115]
    v_bitop3_b32 v2, v2, v3, 1 bitop3:0xa8
    v_cmp_ne_u32 vcc, 0, v2
    s_cbranch_vccnz xv_s_39
xv_j_41:
    v_mfma_f32_16x16x32_bf16 v[96:99], v[88:91], v[80:83], 0
    s_nop 0
    v_cvt_pk_bf16_f32 v108, v18, v19
    v_cvt_pk_bf16_f32 v109, v20, v21
    s_nop 0
    v_cvt_pk_bf16_f32 v110, v22, v23
    v_cvt_pk_bf16_f32 v111, v24, v25
    ds_write_b128 v117, v[108:111] offset:9216
    v_mfma_f32_16x16x32_bf16 v[96:99], v[92:95], v[84:87], v[96:99]
    s_nop 3
    s_waitcnt lgkmcnt(0)
    s_barrier
    ds_read_b128 v[10:13], v118 offset:9216
    ds_read_b128 v[14:17], v118 offset:11264
    v_rcp_f32 v98, v96
    s_nop 0
    ds_bpermute_b32 v96, v120, v98 offset:0
    ds_bpermute_b32 v97, v120, v98 offset:4
    s_waitcnt lgkmcnt(3)
    v_smfmac_f32_16x16x64_bf16 v[48:51], v[10:13], v[192:199], v7
    v_smfmac_f32_16x16x64_bf16 v[52:55], v[10:13], v[208:215], v7
    s_waitcnt lgkmcnt(2)
    v_smfmac_f32_16x16x64_bf16 v[48:51], v[14:17], v[200:207], v7
    s_nop 1
    v_smfmac_f32_16x16x64_bf16 v[52:55], v[14:17], v[216:223], v7
    s_nop 1
    v_smfmac_f32_16x16x64_bf16 v[56:59], v[10:13], v[224:231], v7
    s_waitcnt lgkmcnt(0)
    v_smfmac_f32_16x16x64_bf16 v[56:59], v[14:17], v[232:239], v7
    v_pk_add_f32 v[48:49], v[48:49], v[50:51]
    v_smfmac_f32_16x16x64_bf16 v[60:63], v[10:13], v[240:247], v7
    v_pk_mul_f32 v[48:49], v[48:49], v[96:97]
    v_cvt_pk_bf16_f32 v80, v48, v49
    v_smfmac_f32_16x16x64_bf16 v[60:63], v[14:17], v[248:255], v7
    v_pk_add_f32 v[52:53], v[52:53], v[54:55]
    v_pk_mul_f32 v[52:53], v[52:53], v[96:97]
    v_cvt_pk_bf16_f32 v81, v52, v53
    v_pk_add_f32 v[56:57], v[56:57], v[58:59]
    v_pk_mul_f32 v[56:57], v[56:57], v[96:97]
    v_cvt_pk_bf16_f32 v82, v56, v57
    v_permlane16_swap_b32 v80, v81
    v_bfi_b32 v80, 1, s82, v80
    v_pk_add_f32 v[60:61], v[60:61], v[62:63]
    v_pk_mul_f32 v[60:61], v[60:61], v[96:97]
    v_cvt_pk_bf16_f32 v83, v60, v61
    s_nop 1
    v_permlane16_swap_b32 v82, v83
    buffer_store_dwordx4 v[80:83], v36, s[8:11], s71 offen
    s_waitcnt vmcnt(0)
    buffer_load_dwordx4 v[10:13], v8, s[8:11], s70 offen sc1
b_w_43:
    s_waitcnt vmcnt(0)
    v_mfma_f32_16x16x32_bf16 v[30:33], v[26:29], v[10:13], 0
    v_bitop3_b32 v2, v10, s82, 1 bitop3:0x28
    v_cmp_ne_u32 vcc, 0, v2
    s_cbranch_vccnz b_s_42
b_j_44:
    s_nop 4
    v_add_f32_dpp v30, v30, v30 row_ror:8 row_mask:0xf bank_mask:0xf
    v_add_f32_dpp v31, v31, v31 row_ror:8 row_mask:0xf bank_mask:0xf
    v_add_f32_dpp v32, v32, v32 row_ror:8 row_mask:0xf bank_mask:0xf
    v_add_f32_dpp v33, v33, v33 row_ror:8 row_mask:0xf bank_mask:0xf
    v_cvt_pk_bf16_f32 v30, v30, v31
    v_cvt_pk_bf16_f32 v31, v32, v33
    v_min_u32 v30, -2, v30
    s_nop 0
    v_permlane16_swap_b32 v31, v33
    v_permlane16_swap_b32 v30, v32
    buffer_store_dwordx4 v[30:33], v35, s[8:11], s77 offen sc1
    s_add_u32 s68, s68, 1
    s_bfe_u32 s82, s68, 0x10001
    s_xor_b32 s73, s73, 0x40000
    s_add_u32 s77, s77, 0x20000
    s_lshr_b32 s60, s77, 21
    s_bitcmp1_b32 s59, s60
    s_cselect_b32 s60, 0x2000, 0
    s_bitset0_b32 s77, 13
    s_or_b32 s77, s77, s60
    v_mov_b32 v40, 0
    v_mov_b32 v41, 0
    v_mov_b32 v42, 0
    v_mov_b32 v43, 0
    v_mov_b32 v44, 0
    v_mov_b32 v45, 0
    v_mov_b32 v46, 0
    v_mov_b32 v47, 0
    v_mov_b32 v48, 0
    v_mov_b32 v49, 0
    v_mov_b32 v50, 0
    v_mov_b32 v51, 0
    v_mov_b32 v52, 0
    v_mov_b32 v53, 0
    v_mov_b32 v54, 0
    v_mov_b32 v55, 0
    v_mov_b32 v56, 0
    v_mov_b32 v57, 0
    v_mov_b32 v58, 0
    v_mov_b32 v59, 0
    v_mov_b32 v60, 0
    v_mov_b32 v61, 0
    v_mov_b32 v62, 0
    v_mov_b32 v63, 0
    buffer_load_dwordx4 v[72:75], v38, s[8:11], s75 offen offset:0
    buffer_load_dwordx4 v[76:79], v38, s[8:11], s75 offen offset:128
    s_add_u32 s75, s75, 0x40000
    s_waitcnt vmcnt(2)
    s_barrier
    s_and_b32 s72, s68, 3
    s_cmp_lg_u32 s72, s64
    s_cbranch_scc1 novm_45
    v_mfma_f32_16x16x32_bf16 v[108:111], v[100:103], v[64:67], 0
    v_mfma_f32_16x16x32_bf16 v[108:111], v[104:107], v[68:71], v[108:111]
    s_nop 7
    v_cvt_pk_bf16_f32 v108, v108, v109
    v_cvt_pk_bf16_f32 v109, v110, v111
    v_min_u32 v108, -2, v108
    buffer_store_dwordx2 v[108:109], v119, s[8:11], s80 offen sc1
novm_45:
    s_add_u32 s80, s80, 0x10000
    s_add_u32 s72, s3, 1
    s_cmp_lt_i32 s72, s2
    s_cbranch_scc1 vo_loop_29
    buffer_load_dwordx2 v[122:123], off, s[8:11], s4 sc1
    s_branch vo_loop_29
kvp_32:
    buffer_load_dwordx2 v[122:123], off, s[8:11], s4 sc1
    s_waitcnt vmcnt(0)
kvg_31:
    v_min_i32 v122, v122, v123
    s_nop 0
    v_readfirstlane_b32 s2, v122
    s_nop 0
    s_cmp_lt_i32 s3, s2
    s_cbranch_scc1 kvj_33
    s_sub_u32 s69, s69, 1
    s_cbranch_scc0 kvp_32
    s_mov_b32 s69, 0
    s_branch kvj_33
kv0_34:
    buffer_load_dwordx4 v[72:75], v38, s[8:11], s75 offen offset:0
    buffer_load_dwordx4 v[76:79], v38, s[8:11], s75 offen offset:128
    s_add_u32 s75, s75, 0x40000
    s_branch kv0j_35
kvp_37:
    buffer_load_dwordx2 v[122:123], off, s[8:11], s4 sc1
    s_waitcnt vmcnt(0)
kvg_36:
    v_min_i32 v122, v122, v123
    s_nop 0
    v_readfirstlane_b32 s2, v122
    s_nop 0
    s_cmp_lt_i32 s3, s2
    s_cbranch_scc1 kvj_38
    s_sub_u32 s69, s69, 1
    s_cbranch_scc0 kvp_37
    s_mov_b32 s69, 0
    s_branch kvj_38
xv_s_39:
    buffer_load_dwordx4 v[64:67], v8, s[8:11], s73 offen offset:0 sc1
    buffer_load_dwordx4 v[68:71], v8, s[8:11], s73 offen offset:1024 sc1
    s_sub_u32 s69, s69, 1
    s_cbranch_scc0 xv_w_40
    s_mov_b32 s69, 0
    s_branch xv_j_41
b_s_42:
    buffer_load_dwordx4 v[10:13], v8, s[8:11], s70 offen sc1
    s_sub_u32 s69, s69, 1
    s_cbranch_scc0 b_w_43
    s_mov_b32 s69, 0
    s_branch b_j_44
vo_last_30:
    s_cmp_lg_u32 s64, 0
    s_cbranch_scc1 chain_end_16
pollvm_46:
    buffer_load_dwordx4 v[64:67], v8, s[8:11], s73 offen offset:0 sc1
    buffer_load_dwordx4 v[68:71], v8, s[8:11], s73 offen offset:1024 sc1
    s_waitcnt vmcnt(0)
    v_bitop3_b32 v2, v64, v66, s82 bitop3:0x7e
    v_bitop3_b32 v3, v68, v70, s82 bitop3:0x7e
    v_bitop3_b32 v2, v2, v3, 1 bitop3:0xa8
    v_cmp_ne_u32 vcc, 0, v2
    s_cbranch_vccz pollvm_ok_47
    s_sub_u32 s69, s69, 1
    s_cbranch_scc0 pollvm_46
    s_mov_b32 s69, 0
pollvm_ok_47:
    v_mfma_f32_16x16x32_bf16 v[108:111], v[100:103], v[64:67], 0
    v_mfma_f32_16x16x32_bf16 v[108:111], v[104:107], v[68:71], v[108:111]
    s_nop 7
    v_cvt_pk_bf16_f32 v108, v108, v109
    v_cvt_pk_bf16_f32 v109, v110, v111
    v_min_u32 v108, -2, v108
    buffer_store_dwordx2 v[108:109], v119, s[8:11], s80 offen sc1
chain_end_16:
    s_waitcnt vmcnt(0)
    s_endpgm
bulk_2:
    s_and_b32 s75, s56, 3
    s_lshl_b32 s76, s75, 5
    s_add_u32 s76, s76, s57
    s_mov_b32 s77, 0x40000
    s_mov_b32 s84, 1
    s_cmp_ge_u32 s57, 24
    s_cbranch_scc1 fft_51
    s_mov_b32 s83, 128
    s_mov_b32 s6, 0x4444557e
    s_mov_b32 s7, 0x44444444
    s_mov_b64 s[60:61], s[36:37]
    s_mov_b32 s62, 0x400000
    s_mov_b32 s63, 0x20000
    s_bitcmp1_b32 s57, 3
    s_cbranch_scc1 sv_52
    s_mov_b64 s[64:65], s[24:25]
    s_mov_b32 s66, 0x800000
    s_mov_b32 s67, 0x20000
    s_mov_b32 s81, 0x1000000
    s_cmp_lt_u32 s57, 8
    s_cbranch_scc1 sf_53
    s_mov_b64 s[64:65], s[20:21]
    s_mov_b32 s66, 0x800000
    s_mov_b32 s67, 0x20000
    s_mov_b32 s81, 0x0
    s_mov_b32 s84, 0x10000
    s_add_u32 s79, s76, 8
    s_lshl_b32 s85, s79, 3
    s_add_u32 s85, s85, s58
    v_lshlrev_b32 v4, 2, v1
    v_mul_u32_u24 v4, s85, v4
    v_mov_b32 v8, 253
    v_and_b32 v5, 0x3ff, v4
    v_cvt_f32_u32 v5, v5
    v_mul_f32 v5, 0x3a800000, v5
    v_cos_f32 v6, v5
    v_sin_f32 v7, -v5
    v_add_u32 v4, s85, v4
    v_cvt_pk_bf16_f32 v10, v6, v7
    v_and_b32 v5, 0x3ff, v4
    v_cvt_f32_u32 v5, v5
    v_mul_f32 v5, 0x3a800000, v5
    v_cos_f32 v6, v5
    v_sin_f32 v7, -v5
    v_add_u32 v4, s85, v4
    v_cvt_pk_bf16_f32 v11, v6, v7
    v_and_b32 v5, 0x3ff, v4
    v_cvt_f32_u32 v5, v5
    v_mul_f32 v5, 0x3a800000, v5
    v_cos_f32 v6, v5
    v_sin_f32 v7, -v5
    v_add_u32 v4, s85, v4
    v_cvt_pk_bf16_f32 v12, v6, v7
    v_and_b32 v5, 0x3ff, v4
    v_cvt_f32_u32 v5, v5
    v_mul_f32 v5, 0x3a800000, v5
    v_cos_f32 v6, v5
    v_sin_f32 v7, -v5
    v_mad_u32_u24 v4, s85, v8, v4
    v_cvt_pk_bf16_f32 v13, v6, v7
    v_and_b32 v5, 0x3ff, v4
    v_cvt_f32_u32 v5, v5
    v_mul_f32 v5, 0x3a800000, v5
    v_cos_f32 v6, v5
    v_sin_f32 v7, -v5
    v_add_u32 v4, s85, v4
    v_cvt_pk_bf16_f32 v14, v6, v7
    v_and_b32 v5, 0x3ff, v4
    v_cvt_f32_u32 v5, v5
    v_mul_f32 v5, 0x3a800000, v5
    v_cos_f32 v6, v5
    v_sin_f32 v7, -v5
    v_add_u32 v4, s85, v4
    v_cvt_pk_bf16_f32 v15, v6, v7
    v_and_b32 v5, 0x3ff, v4
    v_cvt_f32_u32 v5, v5
    v_mul_f32 v5, 0x3a800000, v5
    v_cos_f32 v6, v5
    v_sin_f32 v7, -v5
    v_add_u32 v4, s85, v4
    v_cvt_pk_bf16_f32 v16, v6, v7
    v_and_b32 v5, 0x3ff, v4
    v_cvt_f32_u32 v5, v5
    v_mul_f32 v5, 0x3a800000, v5
    v_cos_f32 v6, v5
    v_sin_f32 v7, -v5
    v_add_u32 v4, s85, v4
    v_cvt_pk_bf16_f32 v17, v6, v7
    v_mov_b32 v5, s85
    v_lshlrev_b32 v5, 31, v5
    v_or_b32 v5, 0x3f803f80, v5
    v_cmp_eq_u32 vcc, 0, v1
    s_nop 1
    v_cndmask_b32 v10, v10, v5, vcc
    v_lshlrev_b32 v8, 4, v1
    s_lshl_b32 s85, s85, 11
    s_add_u32 s85, s85, 0x5200000
    buffer_store_dwordx4 v[10:13], v8, s[8:11], s85 offen sc1
    buffer_store_dwordx4 v[14:17], v8, s[8:11], s85 offen offset:1024 sc1
    s_sub_u32 s79, s79, 8
    s_lshl_b32 s85, s79, 3
    s_add_u32 s85, s85, s58
    v_lshlrev_b32 v20, 2, v1
    v_mul_u32_u24 v20, s85, v20
    v_mov_b32 v24, 253
    v_and_b32 v21, 0x3ff, v20
    v_cvt_f32_u32 v21, v21
    v_mul_f32 v21, 0x3a800000, v21
    v_cos_f32 v22, v21
    v_sin_f32 v23, -v21
    v_add_u32 v20, s85, v20
    v_cvt_pk_bf16_f32 v26, v22, v23
    v_and_b32 v21, 0x3ff, v20
    v_cvt_f32_u32 v21, v21
    v_mul_f32 v21, 0x3a800000, v21
    v_cos_f32 v22, v21
    v_sin_f32 v23, -v21
    v_add_u32 v20, s85, v20
    v_cvt_pk_bf16_f32 v27, v22, v23
    v_and_b32 v21, 0x3ff, v20
    v_cvt_f32_u32 v21, v21
    v_mul_f32 v21, 0x3a800000, v21
    v_cos_f32 v22, v21
    v_sin_f32 v23, -v21
    v_add_u32 v20, s85, v20
    v_cvt_pk_bf16_f32 v28, v22, v23
    v_and_b32 v21, 0x3ff, v20
    v_cvt_f32_u32 v21, v21
    v_mul_f32 v21, 0x3a800000, v21
    v_cos_f32 v22, v21
    v_sin_f32 v23, -v21
    v_mad_u32_u24 v20, s85, v24, v20
    v_cvt_pk_bf16_f32 v29, v22, v23
    v_and_b32 v21, 0x3ff, v20
    v_cvt_f32_u32 v21, v21
    v_mul_f32 v21, 0x3a800000, v21
    v_cos_f32 v22, v21
    v_sin_f32 v23, -v21
    v_add_u32 v20, s85, v20
    v_cvt_pk_bf16_f32 v30, v22, v23
    v_and_b32 v21, 0x3ff, v20
    v_cvt_f32_u32 v21, v21
    v_mul_f32 v21, 0x3a800000, v21
    v_cos_f32 v22, v21
    v_sin_f32 v23, -v21
    v_add_u32 v20, s85, v20
    v_cvt_pk_bf16_f32 v31, v22, v23
    v_and_b32 v21, 0x3ff, v20
    v_cvt_f32_u32 v21, v21
    v_mul_f32 v21, 0x3a800000, v21
    v_cos_f32 v22, v21
    v_sin_f32 v23, -v21
    v_add_u32 v20, s85, v20
    v_cvt_pk_bf16_f32 v32, v22, v23
    v_and_b32 v21, 0x3ff, v20
    v_cvt_f32_u32 v21, v21
    v_mul_f32 v21, 0x3a800000, v21
    v_cos_f32 v22, v21
    v_sin_f32 v23, -v21
    v_add_u32 v20, s85, v20
    v_cvt_pk_bf16_f32 v33, v22, v23
    v_mov_b32 v21, s85
    v_lshlrev_b32 v21, 31, v21
    v_or_b32 v21, 0x3f803f80, v21
    v_cmp_eq_u32 vcc, 0, v1
    s_nop 1
    v_cndmask_b32 v26, v26, v21, vcc
    v_lshlrev_b32 v24, 4, v1
    s_lshl_b32 s85, s85, 11
    s_add_u32 s85, s85, 0x5200000
    buffer_store_dwordx4 v[26:29], v24, s[8:11], s85 offen sc1
    buffer_store_dwordx4 v[30:33], v24, s[8:11], s85 offen offset:1024 sc1
    s_sub_u32 s79, s79, 8
    s_lshl_b32 s85, s79, 3
    s_add_u32 s85, s85, s58
    v_lshlrev_b32 v36, 2, v1
    v_mul_u32_u24 v36, s85, v36
    v_mov_b32 v40, 253
    v_and_b32 v37, 0x3ff, v36
    v_cvt_f32_u32 v37, v37
    v_mul_f32 v37, 0x3a800000, v37
    v_cos_f32 v38, v37
    v_sin_f32 v39, -v37
    v_add_u32 v36, s85, v36
    v_cvt_pk_bf16_f32 v42, v38, v39
    v_and_b32 v37, 0x3ff, v36
    v_cvt_f32_u32 v37, v37
    v_mul_f32 v37, 0x3a800000, v37
    v_cos_f32 v38, v37
    v_sin_f32 v39, -v37
    v_add_u32 v36, s85, v36
    v_cvt_pk_bf16_f32 v43, v38, v39
    v_and_b32 v37, 0x3ff, v36
    v_cvt_f32_u32 v37, v37
    v_mul_f32 v37, 0x3a800000, v37
    v_cos_f32 v38, v37
    v_sin_f32 v39, -v37
    v_add_u32 v36, s85, v36
    v_cvt_pk_bf16_f32 v44, v38, v39
    v_and_b32 v37, 0x3ff, v36
    v_cvt_f32_u32 v37, v37
    v_mul_f32 v37, 0x3a800000, v37
    v_cos_f32 v38, v37
    v_sin_f32 v39, -v37
    v_mad_u32_u24 v36, s85, v40, v36
    v_cvt_pk_bf16_f32 v45, v38, v39
    v_and_b32 v37, 0x3ff, v36
    v_cvt_f32_u32 v37, v37
    v_mul_f32 v37, 0x3a800000, v37
    v_cos_f32 v38, v37
    v_sin_f32 v39, -v37
    v_add_u32 v36, s85, v36
    v_cvt_pk_bf16_f32 v46, v38, v39
    v_and_b32 v37, 0x3ff, v36
    v_cvt_f32_u32 v37, v37
    v_mul_f32 v37, 0x3a800000, v37
    v_cos_f32 v38, v37
    v_sin_f32 v39, -v37
    v_add_u32 v36, s85, v36
    v_cvt_pk_bf16_f32 v47, v38, v39
    v_and_b32 v37, 0x3ff, v36
    v_cvt_f32_u32 v37, v37
    v_mul_f32 v37, 0x3a800000, v37
    v_cos_f32 v38, v37
    v_sin_f32 v39, -v37
    v_add_u32 v36, s85, v36
    v_cvt_pk_bf16_f32 v48, v38, v39
    v_and_b32 v37, 0x3ff, v36
    v_cvt_f32_u32 v37, v37
    v_mul_f32 v37, 0x3a800000, v37
    v_cos_f32 v38, v37
    v_sin_f32 v39, -v37
    v_add_u32 v36, s85, v36
    v_cvt_pk_bf16_f32 v49, v38, v39
    v_mov_b32 v37, s85
    v_lshlrev_b32 v37, 31, v37
    v_or_b32 v37, 0x3f803f80, v37
    v_cmp_eq_u32 vcc, 0, v1
    s_nop 1
    v_cndmask_b32 v42, v42, v37, vcc
    v_lshlrev_b32 v40, 4, v1
    s_lshl_b32 s85, s85, 11
    s_add_u32 s85, s85, 0x5200000
    buffer_store_dwordx4 v[42:45], v40, s[8:11], s85 offen sc1
    buffer_store_dwordx4 v[46:49], v40, s[8:11], s85 offen offset:1024 sc1
    s_sub_u32 s79, s79, 8
    s_lshl_b32 s85, s79, 3
    s_add_u32 s85, s85, s58
    v_lshlrev_b32 v52, 2, v1
    v_mul_u32_u24 v52, s85, v52
    v_mov_b32 v56, 253
    v_and_b32 v53, 0x3ff, v52
    v_cvt_f32_u32 v53, v53
    v_mul_f32 v53, 0x3a800000, v53
    v_cos_f32 v54, v53
    v_sin_f32 v55, -v53
    v_add_u32 v52, s85, v52
    v_cvt_pk_bf16_f32 v58, v54, v55
    v_and_b32 v53, 0x3ff, v52
    v_cvt_f32_u32 v53, v53
    v_mul_f32 v53, 0x3a800000, v53
    v_cos_f32 v54, v53
    v_sin_f32 v55, -v53
    v_add_u32 v52, s85, v52
    v_cvt_pk_bf16_f32 v59, v54, v55
    v_and_b32 v53, 0x3ff, v52
    v_cvt_f32_u32 v53, v53
    v_mul_f32 v53, 0x3a800000, v53
    v_cos_f32 v54, v53
    v_sin_f32 v55, -v53
    v_add_u32 v52, s85, v52
    v_cvt_pk_bf16_f32 v60, v54, v55
    v_and_b32 v53, 0x3ff, v52
    v_cvt_f32_u32 v53, v53
    v_mul_f32 v53, 0x3a800000, v53
    v_cos_f32 v54, v53
    v_sin_f32 v55, -v53
    v_mad_u32_u24 v52, s85, v56, v52
    v_cvt_pk_bf16_f32 v61, v54, v55
    v_and_b32 v53, 0x3ff, v52
    v_cvt_f32_u32 v53, v53
    v_mul_f32 v53, 0x3a800000, v53
    v_cos_f32 v54, v53
    v_sin_f32 v55, -v53
    v_add_u32 v52, s85, v52
    v_cvt_pk_bf16_f32 v62, v54, v55
    v_and_b32 v53, 0x3ff, v52
    v_cvt_f32_u32 v53, v53
    v_mul_f32 v53, 0x3a800000, v53
    v_cos_f32 v54, v53
    v_sin_f32 v55, -v53
    v_add_u32 v52, s85, v52
    v_cvt_pk_bf16_f32 v63, v54, v55
    v_and_b32 v53, 0x3ff, v52
    v_cvt_f32_u32 v53, v53
    v_mul_f32 v53, 0x3a800000, v53
    v_cos_f32 v54, v53
    v_sin_f32 v55, -v53
    v_add_u32 v52, s85, v52
    v_cvt_pk_bf16_f32 v64, v54, v55
    v_and_b32 v53, 0x3ff, v52
    v_cvt_f32_u32 v53, v53
    v_mul_f32 v53, 0x3a800000, v53
    v_cos_f32 v54, v53
    v_sin_f32 v55, -v53
    v_add_u32 v52, s85, v52
    v_cvt_pk_bf16_f32 v65, v54, v55
    v_mov_b32 v53, s85
    v_lshlrev_b32 v53, 31, v53
    v_or_b32 v53, 0x3f803f80, v53
    v_cmp_eq_u32 vcc, 0, v1
    s_nop 1
    v_cndmask_b32 v58, v58, v53, vcc
    v_lshlrev_b32 v56, 4, v1
    s_lshl_b32 s85, s85, 11
    s_add_u32 s85, s85, 0x5200000
    buffer_store_dwordx4 v[58:61], v56, s[8:11], s85 offen sc1
    buffer_store_dwordx4 v[62:65], v56, s[8:11], s85 offen offset:1024 sc1
    s_sub_u32 s79, s79, 8
    s_waitcnt vmcnt(0)
sf_53:
    v_bfe_u32 v4, v1, 4, 2
    v_lshlrev_b32 v4, 2, v4
    v_xor_b32 v4, v4, v1
    v_bfe_u32 v84, v4, 0, 1
    v_lshlrev_b32 v84, 5, v84
    v_bfe_u32 v5, v4, 1, 1
    v_lshl_or_b32 v84, v5, 4, v84
    v_bfe_u32 v5, v4, 2, 2
    v_lshl_or_b32 v84, v5, 6, v84
    v_bfe_u32 v5, v4, 4, 2
    v_lshl_or_b32 v84, v5, 13, v84
    v_xor_b32 v85, 16, v84
    s_bfe_u32 s68, s58, 0x20000
    s_lshl_b32 s68, s68, 19
    s_bfe_u32 s71, s58, 0x10002
    s_lshl_b32 s71, s71, 22
    s_or_b32 s68, s68, s71
    s_bfe_u32 s71, s57, 0x30000
    s_lshl_b32 s71, s71, 8
    s_bfe_u32 s72, s57, 0x10000
    s_lshl_b32 s72, s72, 21
    s_or_b32 s71, s71, s72
    s_add_u32 s68, s68, s71
    s_lshl_b32 s71, s75, 11
    s_add_u32 s68, s68, s71
    s_xor_b32 s69, s68, 0x200000
    s_lshl_b32 s70, s58, 14
    s_add_u32 m0, s70, 0
    s_nop 0
    buffer_load_dwordx4 v84, s[64:67], s68 offen lds
    s_add_u32 s68, s68, 0x8000
    s_add_u32 m0, s70, 1024
    s_nop 0
    buffer_load_dwordx4 v84, s[64:67], s68 offen lds
    s_add_u32 s68, s68, 0x8000
    s_add_u32 m0, s70, 2048
    s_nop 0
    buffer_load_dwordx4 v85, s[64:67], s68 offen lds
    s_add_u32 s68, s68, 0x8000
    s_add_u32 m0, s70, 3072
    s_nop 0
    buffer_load_dwordx4 v85, s[64:67], s68 offen lds
    s_add_u32 s68, s68, 0x8000
    s_add_u32 m0, s70, 4096
    s_nop 0
    buffer_load_dwordx4 v84, s[64:67], s68 offen lds
    s_add_u32 s68, s68, 0x8000
    s_add_u32 m0, s70, 5120
    s_nop 0
    buffer_load_dwordx4 v84, s[64:67], s68 offen lds
    s_add_u32 s68, s68, 0x8000
    s_add_u32 m0, s70, 6144
    s_nop 0
    buffer_load_dwordx4 v85, s[64:67], s68 offen lds
    s_add_u32 s68, s68, 0x8000
    s_add_u32 m0, s70, 7168
    s_nop 0
    buffer_load_dwordx4 v85, s[64:67], s68 offen lds
    s_add_u32 s68, s68, 0x8000
    s_add_u32 m0, s70, 8192
    s_nop 0
    buffer_load_dwordx4 v84, s[64:67], s68 offen lds
    s_add_u32 s68, s68, 0x8000
    s_add_u32 m0, s70, 9216
    s_nop 0
    buffer_load_dwordx4 v84, s[64:67], s68 offen lds
    s_add_u32 s68, s68, 0x8000
    s_add_u32 m0, s70, 10240
    s_nop 0
    buffer_load_dwordx4 v85, s[64:67], s68 offen lds
    s_add_u32 s68, s68, 0x8000
    s_add_u32 m0, s70, 11264
    s_nop 0
    buffer_load_dwordx4 v85, s[64:67], s68 offen lds
    s_add_u32 s68, s68, 0x8000
    s_add_u32 m0, s70, 12288
    s_nop 0
    buffer_load_dwordx4 v84, s[64:67], s68 offen lds
    s_add_u32 s68, s68, 0x8000
    s_add_u32 m0, s70, 13312
    s_nop 0
    buffer_load_dwordx4 v84, s[64:67], s68 offen lds
    s_add_u32 s68, s68, 0x8000
    s_add_u32 m0, s70, 14336
    s_nop 0
    buffer_load_dwordx4 v85, s[64:67], s68 offen lds
    s_add_u32 s68, s68, 0x8000
    s_add_u32 m0, s70, 15360
    s_nop 0
    buffer_load_dwordx4 v85, s[64:67], s68 offen lds
    s_add_u32 s68, s68, 0x8000
    s_cmp_lt_u32 s57, 16
    s_cbranch_scc1 sq_63
    s_waitcnt vmcnt(0)
sq_63:
    buffer_load_dwordx4 v[192:195], v84, s[64:67], s69 offen
    s_add_u32 s69, s69, 0x8000
    buffer_load_dwordx4 v[196:199], v84, s[64:67], s69 offen
    s_add_u32 s69, s69, 0x8000
    buffer_load_dwordx4 v[200:203], v85, s[64:67], s69 offen
    s_add_u32 s69, s69, 0x8000
    buffer_load_dwordx4 v[204:207], v85, s[64:67], s69 offen
    s_add_u32 s69, s69, 0x8000
    buffer_load_dwordx4 v[208:211], v84, s[64:67], s69 offen
    s_add_u32 s69, s69, 0x8000
    buffer_load_dwordx4 v[212:215], v84, s[64:67], s69 offen
    s_add_u32 s69, s69, 0x8000
    buffer_load_dwordx4 v[216:219], v85, s[64:67], s69 offen
    s_add_u32 s69, s69, 0x8000
    buffer_load_dwordx4 v[220:223], v85, s[64:67], s69 offen
    s_add_u32 s69, s69, 0x8000
    buffer_load_dwordx4 v[224:227], v84, s[64:67], s69 offen
    s_add_u32 s69, s69, 0x8000
    buffer_load_dwordx4 v[228:231], v84, s[64:67], s69 offen
    s_add_u32 s69, s69, 0x8000
    buffer_load_dwordx4 v[232:235], v85, s[64:67], s69 offen
    s_add_u32 s69, s69, 0x8000
    buffer_load_dwordx4 v[236:239], v85, s[64:67], s69 offen
    s_add_u32 s69, s69, 0x8000
    buffer_load_dwordx4 v[240:243], v84, s[64:67], s69 offen
    s_add_u32 s69, s69, 0x8000
    buffer_load_dwordx4 v[244:247], v84, s[64:67], s69 offen
    s_add_u32 s69, s69, 0x8000
    buffer_load_dwordx4 v[248:251], v85, s[64:67], s69 offen
    s_add_u32 s69, s69, 0x8000
    buffer_load_dwordx4 v[252:255], v85, s[64:67], s69 offen
    s_add_u32 s69, s69, 0x8000
    s_lshl_b32 s71, s57, 3
    s_add_u32 s71, s71, s58
    s_lshl_b32 s71, s71, 13
    s_cmp_lt_u32 s57, 3
    s_cselect_b32 s71, s71, 0x5ffffff0
    v_lshlrev_b32 v4, 7, v1
    buffer_load_dword v99, v4, s[36:39], s71 offen
    v_bfe_u32 v88, v1, 0, 2
    v_lshlrev_b32 v88, 3, v88
    v_bfe_u32 v5, v1, 4, 1
    v_lshl_or_b32 v88, v5, 5, v88
    v_bfe_u32 v5, v1, 2, 2
    v_lshl_or_b32 v88, v5, 6, v88
    v_bfe_u32 v5, v1, 2, 2
    v_lshl_or_b32 v88, v5, 8, v88
    v_bfe_u32 v5, v1, 4, 2
    v_lshl_or_b32 v88, v5, 11, v88
    s_bfe_u32 s71, s58, 0x20000
    s_lshl_b32 s71, s71, 6
    s_bfe_u32 s72, s58, 0x10002
    s_lshl_b32 s72, s72, 16
    s_or_b32 s71, s71, s72
    v_xor_b32 v88, s71, v88
    v_xor_b32 v89, 32, v88
    v_lshl_add_u32 v96, v1, 4, s70
    s_waitcnt vmcnt(17)
    s_barrier
    ds_read_b64_tr_b16 v[128:129], v88 offset:0
    ds_read_b64_tr_b16 v[130:131], v88 offset:1024
    ds_read_b64_tr_b16 v[132:133], v89 offset:0
    ds_read_b64_tr_b16 v[134:135], v89 offset:1024
    ds_read_b64_tr_b16 v[136:137], v88 offset:8192
    ds_read_b64_tr_b16 v[138:139], v88 offset:9216
    ds_read_b64_tr_b16 v[140:141], v89 offset:8192
    ds_read_b64_tr_b16 v[142:143], v89 offset:9216
    s_waitcnt lgkmcnt(4)
    ds_read_b64_tr_b16 v[144:145], v88 offset:16384
    ds_read_b64_tr_b16 v[146:147], v88 offset:17408
    ds_read_b64_tr_b16 v[148:149], v89 offset:16384
    ds_read_b64_tr_b16 v[150:151], v89 offset:17408
    ds_read_b64_tr_b16 v[152:153], v88 offset:24576
    ds_read_b64_tr_b16 v[154:155], v88 offset:25600
    ds_read_b64_tr_b16 v[156:157], v89 offset:24576
    ds_read_b64_tr_b16 v[158:159], v89 offset:25600
    s_waitcnt lgkmcnt(4)
    ds_read_b64_tr_b16 v[160:161], v88 offset:32768
    ds_read_b64_tr_b16 v[162:163], v88 offset:33792
    ds_read_b64_tr_b16 v[164:165], v89 offset:32768
    ds_read_b64_tr_b16 v[166:167], v89 offset:33792
    ds_read_b64_tr_b16 v[168:169], v88 offset:40960
    ds_read_b64_tr_b16 v[170:171], v88 offset:41984
    ds_read_b64_tr_b16 v[172:173], v89 offset:40960
    ds_read_b64_tr_b16 v[174:175], v89 offset:41984
    s_waitcnt lgkmcnt(4)
    ds_read_b64_tr_b16 v[176:177], v88 offset:49152
    ds_read_b64_tr_b16 v[178:179], v88 offset:50176
    ds_read_b64_tr_b16 v[180:181], v89 offset:49152
    ds_read_b64_tr_b16 v[182:183], v89 offset:50176
    ds_read_b64_tr_b16 v[184:185], v88 offset:57344
    ds_read_b64_tr_b16 v[186:187], v88 offset:58368
    ds_read_b64_tr_b16 v[188:189], v89 offset:57344
    ds_read_b64_tr_b16 v[190:191], v89 offset:58368
    s_waitcnt lgkmcnt(0)
    s_barrier
    s_waitcnt vmcnt(16)
    ds_write_b128 v96, v[192:195] offset:0
    s_waitcnt vmcnt(15)
    ds_write_b128 v96, v[196:199] offset:1024
    s_waitcnt vmcnt(14)
    ds_write_b128 v96, v[200:203] offset:2048
    s_waitcnt vmcnt(13)
    ds_write_b128 v96, v[204:207] offset:3072
    s_waitcnt vmcnt(12)
    ds_write_b128 v96, v[208:211] offset:4096
    s_waitcnt vmcnt(11)
    ds_write_b128 v96, v[212:215] offset:5120
    s_waitcnt vmcnt(10)
    ds_write_b128 v96, v[216:219] offset:6144
    s_waitcnt vmcnt(9)
    ds_write_b128 v96, v[220:223] offset:7168
    s_waitcnt vmcnt(8)
    ds_write_b128 v96, v[224:227] offset:8192
    s_waitcnt vmcnt(7)
    ds_write_b128 v96, v[228:231] offset:9216
    s_waitcnt vmcnt(6)
    ds_write_b128 v96, v[232:235] offset:10240
    s_waitcnt vmcnt(5)
    ds_write_b128 v96, v[236:239] offset:11264
    s_waitcnt vmcnt(4)
    ds_write_b128 v96, v[240:243] offset:12288
    s_waitcnt vmcnt(3)
    ds_write_b128 v96, v[244:247] offset:13312
    s_waitcnt vmcnt(2)
    ds_write_b128 v96, v[248:251] offset:14336
    s_waitcnt vmcnt(1)
    ds_write_b128 v96, v[252:255] offset:15360
    s_lshl_b32 s71, s75, 16
    s_add_u32 s81, s81, s71
    s_bfe_u32 s68, s57, 0x10000
    s_lshl_b32 s68, s68, 9
    s_lshl_b32 s71, s58, 2
    v_bfe_u32 v4, v1, 5, 1
    v_lshlrev_b32 v4, 4, v4
    v_xor_b32 v4, s71, v4
    v_lshlrev_b32 v4, 11, v4
    s_and_b32 s71, s71, 12
    v_xor_b32 v5, s71, v1
    v_bfe_u32 v84, v5, 0, 5
    v_lshlrev_b32 v84, 4, v84
    v_bfe_u32 v6, v5, 5, 1
    v_lshl_or_b32 v84, v6, 10, v84
    s_mov_b32 s72, 1024
    v_add_u32 v84, v84, v4
    v_xor_b32 v85, 16, v84
    v_add_u32 v85, s72, v85
    v_xor_b32 v86, 48, v85
    v_add_u32 v86, s72, v86
    v_xor_b32 v87, 16, v86
    v_add_u32 v87, s72, v87
    s_xor_b32 s69, s68, 512
    s_lshl_b32 s70, s58, 12
    s_waitcnt lgkmcnt(0)
    s_barrier
    ds_read_b64_tr_b16 v[192:193], v88 offset:0
    ds_read_b64_tr_b16 v[194:195], v88 offset:1024
    ds_read_b64_tr_b16 v[196:197], v89 offset:0
    ds_read_b64_tr_b16 v[198:199], v89 offset:1024
    ds_read_b64_tr_b16 v[200:201], v88 offset:8192
    ds_read_b64_tr_b16 v[202:203], v88 offset:9216
    ds_read_b64_tr_b16 v[204:205], v89 offset:8192
    ds_read_b64_tr_b16 v[206:207], v89 offset:9216
    s_waitcnt lgkmcnt(4)
    ds_read_b64_tr_b16 v[208:209], v88 offset:16384
    ds_read_b64_tr_b16 v[210:211], v88 offset:17408
    ds_read_b64_tr_b16 v[212:213], v89 offset:16384
    ds_read_b64_tr_b16 v[214:215], v89 offset:17408
    ds_read_b64_tr_b16 v[216:217], v88 offset:24576
    ds_read_b64_tr_b16 v[218:219], v88 offset:25600
    ds_read_b64_tr_b16 v[220:221], v89 offset:24576
    ds_read_b64_tr_b16 v[222:223], v89 offset:25600
    s_waitcnt lgkmcnt(4)
    ds_read_b64_tr_b16 v[224:225], v88 offset:32768
    ds_read_b64_tr_b16 v[226:227], v88 offset:33792
    ds_read_b64_tr_b16 v[228:229], v89 offset:32768
    ds_read_b64_tr_b16 v[230:231], v89 offset:33792
    ds_read_b64_tr_b16 v[232:233], v88 offset:40960
    ds_read_b64_tr_b16 v[234:235], v88 offset:41984
    ds_read_b64_tr_b16 v[236:237], v89 offset:40960
    ds_read_b64_tr_b16 v[238:239], v89 offset:41984
    s_waitcnt lgkmcnt(4)
    ds_read_b64_tr_b16 v[240:241], v88 offset:49152
    ds_read_b64_tr_b16 v[242:243], v88 offset:50176
    ds_read_b64_tr_b16 v[244:245], v89 offset:49152
    ds_read_b64_tr_b16 v[246:247], v89 offset:50176
    ds_read_b64_tr_b16 v[248:249], v88 offset:57344
    ds_read_b64_tr_b16 v[250:251], v88 offset:58368
    ds_read_b64_tr_b16 v[252:253], v89 offset:57344
    ds_read_b64_tr_b16 v[254:255], v89 offset:58368
    s_waitcnt lgkmcnt(0)
    s_barrier
    buffer_load_dword v99, off, s[12:15], s70 offset:32 sc1
    s_add_u32 m0, s70, 0
    s_nop 0
    buffer_load_dwordx4 v84, s[36:39], s68 offen offset:0 lds
    buffer_load_dwordx4 v85, s[36:39], s68 offen offset:1024 lds
    buffer_load_dwordx4 v86, s[36:39], s68 offen offset:2048 lds
    buffer_load_dwordx4 v87, s[36:39], s68 offen offset:3072 lds
    s_add_u32 s68, s68, 0x10000
    s_add_u32 m0, s70, 32768
    s_nop 0
    buffer_load_dwordx4 v84, s[36:39], s69 offen offset:0 lds
    buffer_load_dwordx4 v85, s[36:39], s69 offen offset:1024 lds
    buffer_load_dwordx4 v86, s[36:39], s69 offen offset:2048 lds
    buffer_load_dwordx4 v87, s[36:39], s69 offen offset:3072 lds
    s_add_u32 s69, s69, 0x10000
    s_add_u32 m0, s70, 65536
    s_nop 0
    buffer_load_dwordx4 v84, s[36:39], s68 offen offset:0 lds
    buffer_load_dwordx4 v85, s[36:39], s68 offen offset:1024 lds
    buffer_load_dwordx4 v86, s[36:39], s68 offen offset:2048 lds
    buffer_load_dwordx4 v87, s[36:39], s68 offen offset:3072 lds
    s_add_u32 s68, s68, 0x10000
    v_lshrrev_b32 v4, 4, v1
    v_xor_b32 v4, v4, v1
    v_bfe_u32 v5, v4, 0, 4
    v_lshlrev_b32 v5, 4, v5
    v_bfe_u32 v4, v1, 0, 4
    v_lshlrev_b32 v4, 10, v4
    s_bfe_u32 s71, s58, 0x10002
    s_lshl_b32 s71, s71, 9
    v_or3_b32 v88, v4, v5, s71
    v_xor_b32 v89, 0x40, v88
    v_xor_b32 v90, 0x80, v88
    v_xor_b32 v91, 0xc0, v88
    v_xor_b32 v92, 0x10000, v88
    v_xor_b32 v93, 0x10040, v88
    v_xor_b32 v94, 0x10080, v88
    v_xor_b32 v95, 0x100c0, v88
    s_lshl_b32 s71, s58, 11
    s_or_b32 s71, s71, 131072
    v_lshl_add_u32 v96, v1, 4, s71
    v_xor_b32 v97, 0x2000, v96
    v_bfe_u32 v98, v1, 0, 4
    v_lshlrev_b32 v98, 4, v98
    v_bfe_u32 v4, v1, 4, 2
    v_lshl_or_b32 v98, v4, 9, v98
    s_bfe_u32 s71, s57, 0x30000
    s_lshl_b32 s71, s71, 13
    s_add_u32 s81, s81, s71
    s_bfe_u32 s71, s58, 0x20000
    s_lshl_b32 s71, s71, 11
    s_bfe_u32 s72, s58, 0x10002
    s_lshl_b32 s72, s72, 8
    s_or_b32 s71, s71, s72
    s_add_u32 s81, s81, s71
    s_mov_b32 s73, 0x5ffffff0
    s_mov_b32 s82, 0
    s_waitcnt vmcnt(8)
    s_barrier
    ds_read_b128 v[52:55], v88 offset:0
    ds_read_b128 v[56:59], v88 offset:16384
    ds_read_b128 v[60:63], v89 offset:0
    ds_read_b128 v[64:67], v89 offset:16384
stream_64:
    s_waitcnt lgkmcnt(2)
    v_mfma_f32_16x16x32_bf16 v[20:23], v[128:131], v[52:55], 0
    ds_read_b128 v[68:71], v90 offset:0
    v_mfma_f32_16x16x32_bf16 v[24:27], v[132:135], v[52:55], 0
    ds_read_b128 v[72:75], v90 offset:16384
    v_mfma_f32_16x16x32_bf16 v[28:31], v[128:131], v[56:59], 0
    s_add_u32 m0, s70, 98304
    s_nop 0
    buffer_load_dwordx4 v84, s[36:39], s69 offen offset:0 lds
    v_mfma_f32_16x16x32_bf16 v[32:35], v[132:135], v[56:59], 0
    s_waitcnt lgkmcnt(2)
    v_mfma_f32_16x16x32_bf16 v[20:23], v[136:139], v[60:63], v[20:23]
    ds_read_b128 v[76:79], v91 offset:0
    v_mfma_f32_16x16x32_bf16 v[24:27], v[140:143], v[60:63], v[24:27]
    ds_read_b128 v[80:83], v91 offset:16384
    v_mfma_f32_16x16x32_bf16 v[28:31], v[136:139], v[64:67], v[28:31]
    buffer_load_dwordx4 v85, s[36:39], s69 offen offset:1024 lds
    v_mfma_f32_16x16x32_bf16 v[32:35], v[140:143], v[64:67], v[32:35]
    ds_write_b128 v96, v[44:47] offset:0
    s_waitcnt lgkmcnt(3)
    v_mfma_f32_16x16x32_bf16 v[20:23], v[144:147], v[68:71], v[20:23]
    ds_read_b128 v[52:55], v88 offset:256
    v_mfma_f32_16x16x32_bf16 v[24:27], v[148:151], v[68:71], v[24:27]
    ds_read_b128 v[56:59], v88 offset:16640
    v_mfma_f32_16x16x32_bf16 v[28:31], v[144:147], v[72:75], v[28:31]
    buffer_load_dwordx4 v86, s[36:39], s69 offen offset:2048 lds
    v_mfma_f32_16x16x32_bf16 v[32:35], v[148:151], v[72:75], v[32:35]
    ds_write_b128 v96, v[48:51] offset:1024
    s_waitcnt lgkmcnt(4)
    v_mfma_f32_16x16x32_bf16 v[20:23], v[152:155], v[76:79], v[20:23]
    ds_read_b128 v[60:63], v89 offset:256
    v_mfma_f32_16x16x32_bf16 v[24:27], v[156:159], v[76:79], v[24:27]
    ds_read_b128 v[64:67], v89 offset:16640
    v_mfma_f32_16x16x32_bf16 v[28:31], v[152:155], v[80:83], v[28:31]
    buffer_load_dwordx4 v87, s[36:39], s69 offen offset:3072 lds
    s_add_u32 s69, s69, 0x10000
    v_mfma_f32_16x16x32_bf16 v[32:35], v[156:159], v[80:83], v[32:35]
    s_waitcnt lgkmcnt(3)
    v_mfma_f32_16x16x32_bf16 v[20:23], v[160:163], v[52:55], v[20:23]
    ds_read_b128 v[68:71], v90 offset:256
    v_mfma_f32_16x16x32_bf16 v[24:27], v[164:167], v[52:55], v[24:27]
    ds_read_b128 v[72:75], v90 offset:16640
    v_mfma_f32_16x16x32_bf16 v[28:31], v[160:163], v[56:59], v[28:31]
    v_mfma_f32_16x16x32_bf16 v[32:35], v[164:167], v[56:59], v[32:35]
    s_waitcnt lgkmcnt(2)
    v_mfma_f32_16x16x32_bf16 v[20:23], v[168:171], v[60:63], v[20:23]
    ds_read_b128 v[76:79], v91 offset:256
    v_mfma_f32_16x16x32_bf16 v[24:27], v[172:175], v[60:63], v[24:27]
    ds_read_b128 v[80:83], v91 offset:16640
    v_mfma_f32_16x16x32_bf16 v[28:31], v[168:171], v[64:67], v[28:31]
    v_mfma_f32_16x16x32_bf16 v[32:35], v[172:175], v[64:67], v[32:35]
    s_waitcnt vmcnt(8) lgkmcnt(0)
    s_barrier
    v_mfma_f32_16x16x32_bf16 v[20:23], v[176:179], v[68:71], v[20:23]
    ds_read_b128 v[4:7], v97 offset:0
    ds_read_b128 v[8:11], v97 offset:1024
    ds_read_b128 v[52:55], v88 offset:32768
    v_mfma_f32_16x16x32_bf16 v[24:27], v[180:183], v[68:71], v[24:27]
    ds_read_b128 v[56:59], v88 offset:49152
    v_mfma_f32_16x16x32_bf16 v[28:31], v[176:179], v[72:75], v[28:31]
    v_mfma_f32_16x16x32_bf16 v[32:35], v[180:183], v[72:75], v[32:35]
    s_waitcnt lgkmcnt(2)
    v_mfma_f32_16x16x32_bf16 v[20:23], v[184:187], v[76:79], v[20:23]
    v_add_f32 v4, v4, v36
    v_add_f32 v5, v5, v37
    v_add_f32 v6, v6, v38
    v_add_f32 v7, v7, v39
    ds_read_b128 v[60:63], v89 offset:32768
    v_mfma_f32_16x16x32_bf16 v[24:27], v[188:191], v[76:79], v[24:27]
    v_cvt_pk_bf16_f32 v12, v4, v5
    v_cvt_pk_bf16_f32 v13, v6, v7
    ds_read_b128 v[64:67], v89 offset:49152
    v_mfma_f32_16x16x32_bf16 v[28:31], v[184:187], v[80:83], v[28:31]
    v_add_f32 v8, v8, v40
    v_add_f32 v9, v9, v41
    v_add_f32 v10, v10, v42
    v_add_f32 v11, v11, v43
    v_mfma_f32_16x16x32_bf16 v[32:35], v[188:191], v[80:83], v[32:35]
    v_cvt_pk_bf16_f32 v14, v8, v9
    v_cvt_pk_bf16_f32 v15, v10, v11
    buffer_store_dwordx4 v[12:15], v98, s[8:11], s73 offen sc1
    s_mov_b32 s73, s81
    s_add_u32 s81, s81, 0x40000
    s_waitcnt lgkmcnt(2)
    v_mfma_f32_16x16x32_bf16 v[20:23], v[192:195], v[52:55], v[20:23]
    ds_read_b128 v[68:71], v90 offset:32768
    v_mfma_f32_16x16x32_bf16 v[24:27], v[196:199], v[52:55], v[24:27]
    ds_read_b128 v[72:75], v90 offset:49152
    v_mfma_f32_16x16x32_bf16 v[28:31], v[192:195], v[56:59], v[28:31]
    s_add_u32 m0, s70, 0
    s_nop 0
    buffer_load_dwordx4 v84, s[36:39], s68 offen offset:0 lds
    v_mfma_f32_16x16x32_bf16 v[32:35], v[196:199], v[56:59], v[32:35]
    s_waitcnt lgkmcnt(2)
    v_mfma_f32_16x16x32_bf16 v[20:23], v[200:203], v[60:63], v[20:23]
    ds_read_b128 v[76:79], v91 offset:32768
    v_mfma_f32_16x16x32_bf16 v[24:27], v[204:207], v[60:63], v[24:27]
    ds_read_b128 v[80:83], v91 offset:49152
    v_mfma_f32_16x16x32_bf16 v[28:31], v[200:203], v[64:67], v[28:31]
    buffer_load_dwordx4 v85, s[36:39], s68 offen offset:1024 lds
    v_mfma_f32_16x16x32_bf16 v[32:35], v[204:207], v[64:67], v[32:35]
    s_waitcnt lgkmcnt(2)
    v_mfma_f32_16x16x32_bf16 v[20:23], v[208:211], v[68:71], v[20:23]
    ds_read_b128 v[52:55], v88 offset:33024
    v_mfma_f32_16x16x32_bf16 v[24:27], v[212:215], v[68:71], v[24:27]
    ds_read_b128 v[56:59], v88 offset:49408
    v_mfma_f32_16x16x32_bf16 v[28:31], v[208:211], v[72:75], v[28:31]
    buffer_load_dwordx4 v86, s[36:39], s68 offen offset:2048 lds
    v_mfma_f32_16x16x32_bf16 v[32:35], v[212:215], v[72:75], v[32:35]
    s_waitcnt lgkmcnt(2)
    v_mfma_f32_16x16x32_bf16 v[20:23], v[216:219], v[76:79], v[20:23]
    ds_read_b128 v[60:63], v89 offset:33024
    v_mfma_f32_16x16x32_bf16 v[24:27], v[220:223], v[76:79], v[24:27]
    ds_read_b128 v[64:67], v89 offset:49408
    v_mfma_f32_16x16x32_bf16 v[28:31], v[216:219], v[80:83], v[28:31]
    buffer_load_dwordx4 v87, s[36:39], s68 offen offset:3072 lds
    s_add_u32 s68, s68, 0x10000
    v_mfma_f32_16x16x32_bf16 v[32:35], v[220:223], v[80:83], v[32:35]
    s_waitcnt lgkmcnt(2)
    v_mfma_f32_16x16x32_bf16 v[20:23], v[224:227], v[52:55], v[20:23]
    ds_read_b128 v[68:71], v90 offset:33024
    v_mfma_f32_16x16x32_bf16 v[24:27], v[228:231], v[52:55], v[24:27]
    ds_read_b128 v[72:75], v90 offset:49408
    v_mfma_f32_16x16x32_bf16 v[28:31], v[224:227], v[56:59], v[28:31]
    v_mfma_f32_16x16x32_bf16 v[32:35], v[228:231], v[56:59], v[32:35]
    s_waitcnt lgkmcnt(2)
    v_mfma_f32_16x16x32_bf16 v[20:23], v[232:235], v[60:63], v[20:23]
    ds_read_b128 v[76:79], v91 offset:33024
    v_mfma_f32_16x16x32_bf16 v[24:27], v[236:239], v[60:63], v[24:27]
    ds_read_b128 v[80:83], v91 offset:49408
    v_mfma_f32_16x16x32_bf16 v[28:31], v[232:235], v[64:67], v[28:31]
    v_mfma_f32_16x16x32_bf16 v[32:35], v[236:239], v[64:67], v[32:35]
    s_bitcmp1_b64 s[6:7], s82
    s_cbranch_scc1 ssig_54
    s_waitcnt vmcnt(8) lgkmcnt(0)
    s_barrier
sretf_55:
    s_add_u32 s82, s82, 1
    v_mfma_f32_16x16x32_bf16 v[20:23], v[240:243], v[68:71], v[20:23]
    ds_read_b128 v[52:55], v92 offset:0
    v_mfma_f32_16x16x32_bf16 v[24:27], v[244:247], v[68:71], v[24:27]
    ds_read_b128 v[56:59], v92 offset:16384
    v_mfma_f32_16x16x32_bf16 v[28:31], v[240:243], v[72:75], v[28:31]
    v_mfma_f32_16x16x32_bf16 v[32:35], v[244:247], v[72:75], v[32:35]
    v_mfma_f32_16x16x32_bf16 v[20:23], v[248:251], v[76:79], v[20:23]
    ds_read_b128 v[60:63], v93 offset:0
    v_mfma_f32_16x16x32_bf16 v[24:27], v[252:255], v[76:79], v[24:27]
    ds_read_b128 v[64:67], v93 offset:16384
    v_mfma_f32_16x16x32_bf16 v[28:31], v[248:251], v[80:83], v[28:31]
    v_mfma_f32_16x16x32_bf16 v[32:35], v[252:255], v[80:83], v[32:35]
    s_waitcnt lgkmcnt(2)
    v_mfma_f32_16x16x32_bf16 v[36:39], v[128:131], v[52:55], 0
    ds_read_b128 v[68:71], v94 offset:0
    v_mfma_f32_16x16x32_bf16 v[40:43], v[132:135], v[52:55], 0
    ds_read_b128 v[72:75], v94 offset:16384
    v_mfma_f32_16x16x32_bf16 v[44:47], v[128:131], v[56:59], 0
    s_add_u32 m0, s70, 32768
    s_nop 0
    buffer_load_dwordx4 v84, s[36:39], s69 offen offset:0 lds
    v_mfma_f32_16x16x32_bf16 v[48:51], v[132:135], v[56:59], 0
    s_waitcnt lgkmcnt(2)
    v_mfma_f32_16x16x32_bf16 v[36:39], v[136:139], v[60:63], v[36:39]
    ds_read_b128 v[76:79], v95 offset:0
    v_mfma_f32_16x16x32_bf16 v[40:43], v[140:143], v[60:63], v[40:43]
    ds_read_b128 v[80:83], v95 offset:16384
    v_mfma_f32_16x16x32_bf16 v[44:47], v[136:139], v[64:67], v[44:47]
    buffer_load_dwordx4 v85, s[36:39], s69 offen offset:1024 lds
    v_mfma_f32_16x16x32_bf16 v[48:51], v[140:143], v[64:67], v[48:51]
    ds_write_b128 v96, v[28:31] offset:0
    s_waitcnt lgkmcnt(3)
    v_mfma_f32_16x16x32_bf16 v[36:39], v[144:147], v[68:71], v[36:39]
    ds_read_b128 v[52:55], v92 offset:256
    v_mfma_f32_16x16x32_bf16 v[40:43], v[148:151], v[68:71], v[40:43]
    ds_read_b128 v[56:59], v92 offset:16640
    v_mfma_f32_16x16x32_bf16 v[44:47], v[144:147], v[72:75], v[44:47]
    buffer_load_dwordx4 v86, s[36:39], s69 offen offset:2048 lds
    v_mfma_f32_16x16x32_bf16 v[48:51], v[148:151], v[72:75], v[48:51]
    ds_write_b128 v96, v[32:35] offset:1024
    s_waitcnt lgkmcnt(4)
    v_mfma_f32_16x16x32_bf16 v[36:39], v[152:155], v[76:79], v[36:39]
    ds_read_b128 v[60:63], v93 offset:256
    v_mfma_f32_16x16x32_bf16 v[40:43], v[156:159], v[76:79], v[40:43]
    ds_read_b128 v[64:67], v93 offset:16640
    v_mfma_f32_16x16x32_bf16 v[44:47], v[152:155], v[80:83], v[44:47]
    buffer_load_dwordx4 v87, s[36:39], s69 offen offset:3072 lds
    s_add_u32 s69, s69, 0x10000
    v_mfma_f32_16x16x32_bf16 v[48:51], v[156:159], v[80:83], v[48:51]
    s_waitcnt lgkmcnt(3)
    v_mfma_f32_16x16x32_bf16 v[36:39], v[160:163], v[52:55], v[36:39]
    ds_read_b128 v[68:71], v94 offset:256
    v_mfma_f32_16x16x32_bf16 v[40:43], v[164:167], v[52:55], v[40:43]
    ds_read_b128 v[72:75], v94 offset:16640
    v_mfma_f32_16x16x32_bf16 v[44:47], v[160:163], v[56:59], v[44:47]
    v_mfma_f32_16x16x32_bf16 v[48:51], v[164:167], v[56:59], v[48:51]
    s_waitcnt lgkmcnt(2)
    v_mfma_f32_16x16x32_bf16 v[36:39], v[168:171], v[60:63], v[36:39]
    ds_read_b128 v[76:79], v95 offset:256
    v_mfma_f32_16x16x32_bf16 v[40:43], v[172:175], v[60:63], v[40:43]
    ds_read_b128 v[80:83], v95 offset:16640
    v_mfma_f32_16x16x32_bf16 v[44:47], v[168:171], v[64:67], v[44:47]
    v_mfma_f32_16x16x32_bf16 v[48:51], v[172:175], v[64:67], v[48:51]
    s_waitcnt vmcnt(8) lgkmcnt(0)
    s_barrier
    v_mfma_f32_16x16x32_bf16 v[36:39], v[176:179], v[68:71], v[36:39]
    ds_read_b128 v[4:7], v97 offset:0
    ds_read_b128 v[8:11], v97 offset:1024
    ds_read_b128 v[52:55], v92 offset:32768
    v_mfma_f32_16x16x32_bf16 v[40:43], v[180:183], v[68:71], v[40:43]
    ds_read_b128 v[56:59], v92 offset:49152
    v_mfma_f32_16x16x32_bf16 v[44:47], v[176:179], v[72:75], v[44:47]
    v_mfma_f32_16x16x32_bf16 v[48:51], v[180:183], v[72:75], v[48:51]
    s_waitcnt lgkmcnt(2)
    v_mfma_f32_16x16x32_bf16 v[36:39], v[184:187], v[76:79], v[36:39]
    v_add_f32 v4, v4, v20
    v_add_f32 v5, v5, v21
    v_add_f32 v6, v6, v22
    v_add_f32 v7, v7, v23
    ds_read_b128 v[60:63], v93 offset:32768
    v_mfma_f32_16x16x32_bf16 v[40:43], v[188:191], v[76:79], v[40:43]
    v_cvt_pk_bf16_f32 v12, v4, v5
    v_cvt_pk_bf16_f32 v13, v6, v7
    ds_read_b128 v[64:67], v93 offset:49152
    v_mfma_f32_16x16x32_bf16 v[44:47], v[184:187], v[80:83], v[44:47]
    v_add_f32 v8, v8, v24
    v_add_f32 v9, v9, v25
    v_add_f32 v10, v10, v26
    v_add_f32 v11, v11, v27
    v_mfma_f32_16x16x32_bf16 v[48:51], v[188:191], v[80:83], v[48:51]
    v_cvt_pk_bf16_f32 v14, v8, v9
    v_cvt_pk_bf16_f32 v15, v10, v11
    buffer_store_dwordx4 v[12:15], v98, s[8:11], s73 offen sc1
    s_mov_b32 s73, s81
    s_add_u32 s81, s81, 0x40000
    s_waitcnt lgkmcnt(2)
    v_mfma_f32_16x16x32_bf16 v[36:39], v[192:195], v[52:55], v[36:39]
    ds_read_b128 v[68:71], v94 offset:32768
    v_mfma_f32_16x16x32_bf16 v[40:43], v[196:199], v[52:55], v[40:43]
    ds_read_b128 v[72:75], v94 offset:49152
    v_mfma_f32_16x16x32_bf16 v[44:47], v[192:195], v[56:59], v[44:47]
    s_add_u32 m0, s70, 65536
    s_nop 0
    buffer_load_dwordx4 v84, s[36:39], s68 offen offset:0 lds
    v_mfma_f32_16x16x32_bf16 v[48:51], v[196:199], v[56:59], v[48:51]
    s_waitcnt lgkmcnt(2)
    v_mfma_f32_16x16x32_bf16 v[36:39], v[200:203], v[60:63], v[36:39]
    ds_read_b128 v[76:79], v95 offset:32768
    v_mfma_f32_16x16x32_bf16 v[40:43], v[204:207], v[60:63], v[40:43]
    ds_read_b128 v[80:83], v95 offset:49152
    v_mfma_f32_16x16x32_bf16 v[44:47], v[200:203], v[64:67], v[44:47]
    buffer_load_dwordx4 v85, s[36:39], s68 offen offset:1024 lds
    v_mfma_f32_16x16x32_bf16 v[48:51], v[204:207], v[64:67], v[48:51]
    s_waitcnt lgkmcnt(2)
    v_mfma_f32_16x16x32_bf16 v[36:39], v[208:211], v[68:71], v[36:39]
    ds_read_b128 v[52:55], v92 offset:33024
    v_mfma_f32_16x16x32_bf16 v[40:43], v[212:215], v[68:71], v[40:43]
    ds_read_b128 v[56:59], v92 offset:49408
    v_mfma_f32_16x16x32_bf16 v[44:47], v[208:211], v[72:75], v[44:47]
    buffer_load_dwordx4 v86, s[36:39], s68 offen offset:2048 lds
    v_mfma_f32_16x16x32_bf16 v[48:51], v[212:215], v[72:75], v[48:51]
    s_waitcnt lgkmcnt(2)
    v_mfma_f32_16x16x32_bf16 v[36:39], v[216:219], v[76:79], v[36:39]
    ds_read_b128 v[60:63], v93 offset:33024
    v_mfma_f32_16x16x32_bf16 v[40:43], v[220:223], v[76:79], v[40:43]
    ds_read_b128 v[64:67], v93 offset:49408
    v_mfma_f32_16x16x32_bf16 v[44:47], v[216:219], v[80:83], v[44:47]
    buffer_load_dwordx4 v87, s[36:39], s68 offen offset:3072 lds
    s_add_u32 s68, s68, 0x10000
    v_mfma_f32_16x16x32_bf16 v[48:51], v[220:223], v[80:83], v[48:51]
    s_waitcnt lgkmcnt(2)
    v_mfma_f32_16x16x32_bf16 v[36:39], v[224:227], v[52:55], v[36:39]
    ds_read_b128 v[68:71], v94 offset:33024
    v_mfma_f32_16x16x32_bf16 v[40:43], v[228:231], v[52:55], v[40:43]
    ds_read_b128 v[72:75], v94 offset:49408
    v_mfma_f32_16x16x32_bf16 v[44:47], v[224:227], v[56:59], v[44:47]
    v_mfma_f32_16x16x32_bf16 v[48:51], v[228:231], v[56:59], v[48:51]
    s_waitcnt lgkmcnt(2)
    v_mfma_f32_16x16x32_bf16 v[36:39], v[232:235], v[60:63], v[36:39]
    ds_read_b128 v[76:79], v95 offset:33024
    v_mfma_f32_16x16x32_bf16 v[40:43], v[236:239], v[60:63], v[40:43]
    ds_read_b128 v[80:83], v95 offset:49408
    v_mfma_f32_16x16x32_bf16 v[44:47], v[232:235], v[64:67], v[44:47]
    v_mfma_f32_16x16x32_bf16 v[48:51], v[236:239], v[64:67], v[48:51]
    s_bitcmp1_b64 s[6:7], s82
    s_cbranch_scc1 ssig_54
    s_waitcnt vmcnt(8) lgkmcnt(0)
    s_barrier
sretf_61:
    s_add_u32 s82, s82, 1
    v_mfma_f32_16x16x32_bf16 v[36:39], v[240:243], v[68:71], v[36:39]
    ds_read_b128 v[52:55], v88 offset:0
    v_mfma_f32_16x16x32_bf16 v[40:43], v[244:247], v[68:71], v[40:43]
    ds_read_b128 v[56:59], v88 offset:16384
    v_mfma_f32_16x16x32_bf16 v[44:47], v[240:243], v[72:75], v[44:47]
    v_mfma_f32_16x16x32_bf16 v[48:51], v[244:247], v[72:75], v[48:51]
    v_mfma_f32_16x16x32_bf16 v[36:39], v[248:251], v[76:79], v[36:39]
    ds_read_b128 v[60:63], v89 offset:0
    v_mfma_f32_16x16x32_bf16 v[40:43], v[252:255], v[76:79], v[40:43]
    ds_read_b128 v[64:67], v89 offset:16384
    v_mfma_f32_16x16x32_bf16 v[44:47], v[248:251], v[80:83], v[44:47]
    v_mfma_f32_16x16x32_bf16 v[48:51], v[252:255], v[80:83], v[48:51]
    s_cmp_lt_u32 s82, 64
    s_cbranch_scc1 stream_64
    s_nop 4
    ds_write_b128 v96, v[44:47] offset:0
    ds_write_b128 v96, v[48:51] offset:1024
    s_waitcnt lgkmcnt(0)
    s_barrier
    ds_read_b128 v[4:7], v97 offset:0
    ds_read_b128 v[8:11], v97 offset:1024
    s_waitcnt lgkmcnt(0)
    v_add_f32 v4, v4, v36
    v_add_f32 v5, v5, v37
    v_add_f32 v6, v6, v38
    v_add_f32 v7, v7, v39
    v_cvt_pk_bf16_f32 v12, v4, v5
    v_cvt_pk_bf16_f32 v13, v6, v7
    v_add_f32 v8, v8, v40
    v_add_f32 v9, v9, v41
    v_add_f32 v10, v10, v42
    v_add_f32 v11, v11, v43
    v_cvt_pk_bf16_f32 v14, v8, v9
    v_cvt_pk_bf16_f32 v15, v10, v11
    buffer_store_dwordx4 v[12:15], v98, s[8:11], s73 offen sc1
    s_mov_b32 s73, s81
    s_add_u32 s81, s81, 0x40000
    s_branch send_57
ssig_54:
    s_waitcnt vmcnt(4) lgkmcnt(0)
    s_barrier
    s_cmp_lg_u32 s58, 0
    s_cbranch_scc1 sig_66
    s_cmp_ge_u32 s57, 16
    s_cbranch_scc1 sig_65
    s_waitcnt vmcnt(4)
    v_and_b32 v4, 0x3ff, v99
    v_cmp_gt_u32 vcc, 128, v4
    s_cbranch_vccz armd_ok_68
armd_67:
    buffer_load_dword v99, off, s[12:15], 0 offset:32 sc1
    s_waitcnt vmcnt(0)
    v_and_b32 v4, 0x3ff, v99
    v_cmp_gt_u32 vcc, 128, v4
    s_cbranch_vccz armd_ok_68
    s_sub_u32 s77, s77, 1
    s_cbranch_scc0 armd_67
    s_mov_b32 s77, 0
armd_ok_68:
    s_bfe_u32 s85, s76, 0x10003
    s_lshl_b32 s85, s85, 2
    s_bfe_u32 s79, s76, 0x30000
    s_lshl_b32 s79, s79, 7
    s_or_b32 s85, s85, s79
    s_bfe_u32 s79, s76, 0x20005
    s_lshl_b32 s79, s79, 10
    s_or_b32 s85, s85, s79
    s_add_u32 s85, s85, 0x5110000
    v_mov_b32 v4, s82
    buffer_store_dword v4, off, s[8:11], s85 sc1
sig_65:
    s_bitcmp0_b32 s82, 1
    s_cbranch_scc1 sig_66
    s_cmp_lt_u32 s82, 6
    s_cbranch_scc1 sig_66
    v_mov_b32 v5, s84
    s_mov_b64 exec, 1
    buffer_atomic_add v5, off, s[12:15], s83 sc1
    s_mov_b64 exec, -1
    s_add_u32 s83, s83, 4
sig_66:
    s_cmp_lt_u32 s57, 24
    s_cbranch_scc1 xtra_69
    s_bfe_u32 s79, s76, 0x30000
    s_lshl_b32 s79, s79, 16
    s_bfe_u32 s85, s76, 0x20005
    s_lshl_b32 s85, s85, 19
    s_or_b32 s79, s79, s85
    s_lshl_b32 s85, s58, 13
    s_add_u32 s85, s85, s79
    v_lshlrev_b32 v6, 7, v1
    buffer_load_dword v16, v6, s[36:39], s85 offen
    buffer_load_dword v17, v6, s[48:51], s85 offen
    buffer_load_dword v18, v6, s[52:55], s85 offen
    s_add_u32 s85, s85, 0x200000
    buffer_load_dword v19, v6, s[36:39], s85 offen
xtra_69:
    s_cmp_lg_u32 s82, 10
    s_cbranch_scc1 xtra_70
    v_mov_b32 v8, -1
    v_mov_b32 v16, 0
    v_mov_b32 v9, -1
    v_mov_b32 v17, 0
    v_mov_b32 v10, -1
    v_mov_b32 v18, 0
    v_mov_b32 v11, -1
    v_mov_b32 v19, 0
    v_lshlrev_b32 v6, 4, v1
    s_bfe_u32 s85, s76, 0x20005
    s_lshl_b32 s85, s85, 11
    s_bfe_u32 s79, s76, 0x30000
    s_lshl_b32 s79, s79, 16
    s_or_b32 s85, s85, s79
    s_bfe_u32 s79, s76, 0x20003
    s_lshl_b32 s79, s79, 21
    s_or_b32 s85, s85, s79
    s_lshl_b32 s79, s58, 13
    s_add_u32 s85, s85, s79
    s_add_u32 s85, s85, 0x6000000
    buffer_store_dwordx4 v[8:11], v6, s[8:11], s85 offen offset:0 sc1
    buffer_store_dwordx4 v[8:11], v6, s[8:11], s85 offen offset:1024 sc1
    s_add_u32 s85, s85, 0x80000
    buffer_store_dwordx4 v[8:11], v6, s[8:11], s85 offen offset:0 sc1
    buffer_store_dwordx4 v[8:11], v6, s[8:11], s85 offen offset:1024 sc1
    s_add_u32 s85, s85, 0x80000
    buffer_store_dwordx4 v[8:11], v6, s[8:11], s85 offen offset:0 sc1
    buffer_store_dwordx4 v[8:11], v6, s[8:11], s85 offen offset:1024 sc1
    s_add_u32 s85, s85, 0x80000
    buffer_store_dwordx4 v[8:11], v6, s[8:11], s85 offen offset:0 sc1
    buffer_store_dwordx4 v[8:11], v6, s[8:11], s85 offen offset:1024 sc1
    s_add_u32 s85, s85, 0x80000
    s_cmp_ge_u32 s57, 16
    s_cbranch_scc1 xtra_70
    s_bfe_u32 s79, s76, 0x40000
    s_lshl_b32 s79, s79, 3
    s_bfe_u32 s85, s76, 0x20005
    s_lshl_b32 s85, s85, 7
    s_or_b32 s79, s79, s85
    s_add_u32 s79, s79, s58
    s_bfe_u32 s85, s79, 0x30003
    s_lshl_b32 s85, s85, 11
    s_bfe_u32 s80, s79, 0x20007
    s_lshl_b32 s80, s80, 14
    s_or_b32 s85, s85, s80
    s_bfe_u32 s80, s79, 0x30000
    s_lshl_b32 s80, s80, 17
    s_or_b32 s85, s85, s80
    s_bfe_u32 s80, s79, 0x10006
    s_lshl_b32 s80, s80, 22
    s_or_b32 s85, s85, s80
    s_add_u32 s85, s85, 0x4300000
    buffer_store_dwordx4 v[8:11], v6, s[8:11], s85 offen offset:0 sc1
    buffer_store_dwordx4 v[8:11], v6, s[8:11], s85 offen offset:1024 sc1
    s_add_u32 s85, s85, 0x10000
    buffer_store_dwordx4 v[8:11], v6, s[8:11], s85 offen offset:0 sc1
    buffer_store_dwordx4 v[8:11], v6, s[8:11], s85 offen offset:1024 sc1
    s_lshl_b32 s85, s79, 6
    s_add_u32 s85, s85, 0x5100000
    v_and_b32 v7, 48, v6
    buffer_store_dwordx4 v[16:19], v7, s[8:11], s85 offen sc1
xtra_70:
    s_bitcmp1_b32 s82, 0
    s_cbranch_scc1 xtra_71
    s_bitcmp1_b32 s57, 3
    s_cbranch_scc1 srett_56
    s_branch sretf_55
xtra_71:
    s_bitcmp1_b32 s57, 3
    s_cbranch_scc1 srett_62
    s_branch sretf_61
sv_52:
    s_mov_b32 s81, 0x2000000
    v_bfe_u32 v4, v1, 4, 2
    v_lshlrev_b32 v4, 2, v4
    v_xor_b32 v4, v4, v1
    v_bfe_u32 v84, v4, 0, 2
    v_lshlrev_b32 v84, 4, v84
    v_bfe_u32 v5, v4, 2, 2
    v_lshl_or_b32 v84, v5, 6, v84
    v_bfe_u32 v5, v4, 4, 2
    v_lshl_or_b32 v84, v5, 13, v84
    v_xor_b32 v85, 32, v84
    s_bfe_u32 s68, s58, 0x20000
    s_lshl_b32 s68, s68, 19
    s_bfe_u32 s71, s58, 0x10002
    s_lshl_b32 s71, s71, 22
    s_or_b32 s68, s68, s71
    s_bfe_u32 s71, s57, 0x30000
    s_lshl_b32 s71, s71, 8
    s_bfe_u32 s72, s57, 0x10000
    s_lshl_b32 s72, s72, 21
    s_or_b32 s71, s71, s72
    s_add_u32 s68, s68, s71
    s_lshl_b32 s71, s75, 11
    s_add_u32 s68, s68, s71
    s_xor_b32 s69, s68, 0x200000
    s_lshl_b32 s70, s58, 14
    s_add_u32 m0, s70, 0
    s_nop 0
    buffer_load_dwordx4 v84, s[28:31], s68 offen lds
    s_add_u32 s68, s68, 0x8000
    s_add_u32 m0, s70, 1024
    s_nop 0
    buffer_load_dwordx4 v84, s[28:31], s68 offen lds
    s_add_u32 s68, s68, 0x8000
    s_add_u32 m0, s70, 2048
    s_nop 0
    buffer_load_dwordx4 v85, s[28:31], s68 offen lds
    s_add_u32 s68, s68, 0x8000
    s_add_u32 m0, s70, 3072
    s_nop 0
    buffer_load_dwordx4 v85, s[28:31], s68 offen lds
    s_add_u32 s68, s68, 0x8000
    s_add_u32 m0, s70, 4096
    s_nop 0
    buffer_load_dwordx4 v84, s[28:31], s68 offen lds
    s_add_u32 s68, s68, 0x8000
    s_add_u32 m0, s70, 5120
    s_nop 0
    buffer_load_dwordx4 v84, s[28:31], s68 offen lds
    s_add_u32 s68, s68, 0x8000
    s_add_u32 m0, s70, 6144
    s_nop 0
    buffer_load_dwordx4 v85, s[28:31], s68 offen lds
    s_add_u32 s68, s68, 0x8000
    s_add_u32 m0, s70, 7168
    s_nop 0
    buffer_load_dwordx4 v85, s[28:31], s68 offen lds
    s_add_u32 s68, s68, 0x8000
    s_add_u32 m0, s70, 8192
    s_nop 0
    buffer_load_dwordx4 v84, s[28:31], s68 offen lds
    s_add_u32 s68, s68, 0x8000
    s_add_u32 m0, s70, 9216
    s_nop 0
    buffer_load_dwordx4 v84, s[28:31], s68 offen lds
    s_add_u32 s68, s68, 0x8000
    s_add_u32 m0, s70, 10240
    s_nop 0
    buffer_load_dwordx4 v85, s[28:31], s68 offen lds
    s_add_u32 s68, s68, 0x8000
    s_add_u32 m0, s70, 11264
    s_nop 0
    buffer_load_dwordx4 v85, s[28:31], s68 offen lds
    s_add_u32 s68, s68, 0x8000
    s_add_u32 m0, s70, 12288
    s_nop 0
    buffer_load_dwordx4 v84, s[28:31], s68 offen lds
    s_add_u32 s68, s68, 0x8000
    s_add_u32 m0, s70, 13312
    s_nop 0
    buffer_load_dwordx4 v84, s[28:31], s68 offen lds
    s_add_u32 s68, s68, 0x8000
    s_add_u32 m0, s70, 14336
    s_nop 0
    buffer_load_dwordx4 v85, s[28:31], s68 offen lds
    s_add_u32 s68, s68, 0x8000
    s_add_u32 m0, s70, 15360
    s_nop 0
    buffer_load_dwordx4 v85, s[28:31], s68 offen lds
    s_add_u32 s68, s68, 0x8000
    buffer_load_dwordx4 v[192:195], v84, s[28:31], s69 offen
    s_add_u32 s69, s69, 0x8000
    buffer_load_dwordx4 v[196:199], v84, s[28:31], s69 offen
    s_add_u32 s69, s69, 0x8000
    buffer_load_dwordx4 v[200:203], v85, s[28:31], s69 offen
    s_add_u32 s69, s69, 0x8000
    buffer_load_dwordx4 v[204:207], v85, s[28:31], s69 offen
    s_add_u32 s69, s69, 0x8000
    buffer_load_dwordx4 v[208:211], v84, s[28:31], s69 offen
    s_add_u32 s69, s69, 0x8000
    buffer_load_dwordx4 v[212:215], v84, s[28:31], s69 offen
    s_add_u32 s69, s69, 0x8000
    buffer_load_dwordx4 v[216:219], v85, s[28:31], s69 offen
    s_add_u32 s69, s69, 0x8000
    buffer_load_dwordx4 v[220:223], v85, s[28:31], s69 offen
    s_add_u32 s69, s69, 0x8000
    buffer_load_dwordx4 v[224:227], v84, s[28:31], s69 offen
    s_add_u32 s69, s69, 0x8000
    buffer_load_dwordx4 v[228:231], v84, s[28:31], s69 offen
    s_add_u32 s69, s69, 0x8000
    buffer_load_dwordx4 v[232:235], v85, s[28:31], s69 offen
    s_add_u32 s69, s69, 0x8000
    buffer_load_dwordx4 v[236:239], v85, s[28:31], s69 offen
    s_add_u32 s69, s69, 0x8000
    buffer_load_dwordx4 v[240:243], v84, s[28:31], s69 offen
    s_add_u32 s69, s69, 0x8000
    buffer_load_dwordx4 v[244:247], v84, s[28:31], s69 offen
    s_add_u32 s69, s69, 0x8000
    buffer_load_dwordx4 v[248:251], v85, s[28:31], s69 offen
    s_add_u32 s69, s69, 0x8000
    buffer_load_dwordx4 v[252:255], v85, s[28:31], s69 offen
    s_add_u32 s69, s69, 0x8000
    s_lshl_b32 s71, s57, 3
    s_add_u32 s71, s71, s58
    s_lshl_b32 s71, s71, 13
    s_cmp_lt_u32 s57, 3
    s_cselect_b32 s71, s71, 0x5ffffff0
    v_lshlrev_b32 v4, 7, v1
    buffer_load_dword v99, v4, s[36:39], s71 offen
    v_bfe_u32 v88, v1, 0, 2
    v_lshlrev_b32 v88, 3, v88
    v_bfe_u32 v5, v1, 4, 1
    v_lshl_or_b32 v88, v5, 5, v88
    v_bfe_u32 v5, v1, 2, 2
    v_lshl_or_b32 v88, v5, 6, v88
    v_bfe_u32 v5, v1, 2, 2
    v_lshl_or_b32 v88, v5, 8, v88
    v_bfe_u32 v5, v1, 4, 2
    v_lshl_or_b32 v88, v5, 11, v88
    s_bfe_u32 s71, s58, 0x20000
    s_lshl_b32 s71, s71, 6
    s_bfe_u32 s72, s58, 0x10002
    s_lshl_b32 s72, s72, 16
    s_or_b32 s71, s71, s72
    s_bfe_u32 s72, s58, 0x10002
    s_lshl_b32 s72, s72, 5
    s_or_b32 s71, s71, s72
    v_xor_b32 v88, s71, v88
    v_xor_b32 v89, 32, v88
    v_lshl_add_u32 v96, v1, 4, s70
    s_waitcnt vmcnt(17)
    s_barrier
    ds_read_b64_tr_b16 v[128:129], v88 offset:0
    ds_read_b64_tr_b16 v[130:131], v88 offset:1024
    ds_read_b64_tr_b16 v[132:133], v89 offset:0
    ds_read_b64_tr_b16 v[134:135], v89 offset:1024
    ds_read_b64_tr_b16 v[136:137], v88 offset:8192
    ds_read_b64_tr_b16 v[138:139], v88 offset:9216
    ds_read_b64_tr_b16 v[140:141], v89 offset:8192
    ds_read_b64_tr_b16 v[142:143], v89 offset:9216
    s_waitcnt lgkmcnt(4)
    ds_read_b64_tr_b16 v[144:145], v88 offset:16384
    ds_read_b64_tr_b16 v[146:147], v88 offset:17408
    ds_read_b64_tr_b16 v[148:149], v89 offset:16384
    ds_read_b64_tr_b16 v[150:151], v89 offset:17408
    ds_read_b64_tr_b16 v[152:153], v88 offset:24576
    ds_read_b64_tr_b16 v[154:155], v88 offset:25600
    ds_read_b64_tr_b16 v[156:157], v89 offset:24576
    ds_read_b64_tr_b16 v[158:159], v89 offset:25600
    s_waitcnt lgkmcnt(4)
    ds_read_b64_tr_b16 v[160:161], v88 offset:32768
    ds_read_b64_tr_b16 v[162:163], v88 offset:33792
    ds_read_b64_tr_b16 v[164:165], v89 offset:32768
    ds_read_b64_tr_b16 v[166:167], v89 offset:33792
    ds_read_b64_tr_b16 v[168:169], v88 offset:40960
    ds_read_b64_tr_b16 v[170:171], v88 offset:41984
    ds_read_b64_tr_b16 v[172:173], v89 offset:40960
    ds_read_b64_tr_b16 v[174:175], v89 offset:41984
    s_waitcnt lgkmcnt(4)
    ds_read_b64_tr_b16 v[176:177], v88 offset:49152
    ds_read_b64_tr_b16 v[178:179], v88 offset:50176
    ds_read_b64_tr_b16 v[180:181], v89 offset:49152
    ds_read_b64_tr_b16 v[182:183], v89 offset:50176
    ds_read_b64_tr_b16 v[184:185], v88 offset:57344
    ds_read_b64_tr_b16 v[186:187], v88 offset:58368
    ds_read_b64_tr_b16 v[188:189], v89 offset:57344
    ds_read_b64_tr_b16 v[190:191], v89 offset:58368
    s_waitcnt lgkmcnt(0)
    s_barrier
    s_waitcnt vmcnt(16)
    ds_write_b128 v96, v[192:195] offset:0
    s_waitcnt vmcnt(15)
    ds_write_b128 v96, v[196:199] offset:1024
    s_waitcnt vmcnt(14)
    ds_write_b128 v96, v[200:203] offset:2048
    s_waitcnt vmcnt(13)
    ds_write_b128 v96, v[204:207] offset:3072
    s_waitcnt vmcnt(12)
    ds_write_b128 v96, v[208:211] offset:4096
    s_waitcnt vmcnt(11)
    ds_write_b128 v96, v[212:215] offset:5120
    s_waitcnt vmcnt(10)
    ds_write_b128 v96, v[216:219] offset:6144
    s_waitcnt vmcnt(9)
    ds_write_b128 v96, v[220:223] offset:7168
    s_waitcnt vmcnt(8)
    ds_write_b128 v96, v[224:227] offset:8192
    s_waitcnt vmcnt(7)
    ds_write_b128 v96, v[228:231] offset:9216
    s_waitcnt vmcnt(6)
    ds_write_b128 v96, v[232:235] offset:10240
    s_waitcnt vmcnt(5)
    ds_write_b128 v96, v[236:239] offset:11264
    s_waitcnt vmcnt(4)
    ds_write_b128 v96, v[240:243] offset:12288
    s_waitcnt vmcnt(3)
    ds_write_b128 v96, v[244:247] offset:13312
    s_waitcnt vmcnt(2)
    ds_write_b128 v96, v[248:251] offset:14336
    s_waitcnt vmcnt(1)
    ds_write_b128 v96, v[252:255] offset:15360
    s_lshl_b32 s71, s75, 16
    s_add_u32 s81, s81, s71
    s_bfe_u32 s68, s57, 0x10000
    s_lshl_b32 s68, s68, 9
    s_mov_b32 s2, 2048
    s_mov_b32 s3, 65536
    s_mov_b32 s4, 262144
    s_mov_b32 s5, 1
    s_lshl_b32 s71, s58, 2
    s_bfe_u32 s72, s71, 0x30000
    s_bfe_u32 s73, s71, 0x10003
    s_lshl_b32 s73, s73, 4
    s_or_b32 s72, s72, s73
    s_bfe_u32 s73, s71, 0x10004
    s_lshl_b32 s73, s73, 3
    s_or_b32 s72, s72, s73
    s_mul_i32 s72, s72, s2
    v_mov_b32 v4, s72
    s_and_b32 s71, s71, 12
    v_xor_b32 v5, s71, v1
    v_bfe_u32 v84, v5, 0, 5
    v_lshlrev_b32 v84, 4, v84
    v_bfe_u32 v6, v5, 5, 1
    v_lshl_or_b32 v84, v6, 10, v84
    s_sub_u32 s72, s2, 1024
    v_add_u32 v84, v84, v4
    v_xor_b32 v85, 16, v84
    v_add_u32 v85, s72, v85
    v_xor_b32 v86, 48, v85
    v_add_u32 v86, s72, v86
    v_xor_b32 v87, 16, v86
    v_add_u32 v87, s72, v87
    s_xor_b32 s69, s68, 512
    s_lshl_b32 s70, s58, 12
    s_waitcnt lgkmcnt(0)
    s_barrier
    ds_read_b64_tr_b16 v[192:193], v88 offset:0
    ds_read_b64_tr_b16 v[194:195], v88 offset:1024
    ds_read_b64_tr_b16 v[196:197], v89 offset:0
    ds_read_b64_tr_b16 v[198:199], v89 offset:1024
    ds_read_b64_tr_b16 v[200:201], v88 offset:8192
    ds_read_b64_tr_b16 v[202:203], v88 offset:9216
    ds_read_b64_tr_b16 v[204:205], v89 offset:8192
    ds_read_b64_tr_b16 v[206:207], v89 offset:9216
    s_waitcnt lgkmcnt(4)
    ds_read_b64_tr_b16 v[208:209], v88 offset:16384
    ds_read_b64_tr_b16 v[210:211], v88 offset:17408
    ds_read_b64_tr_b16 v[212:213], v89 offset:16384
    ds_read_b64_tr_b16 v[214:215], v89 offset:17408
    ds_read_b64_tr_b16 v[216:217], v88 offset:24576
    ds_read_b64_tr_b16 v[218:219], v88 offset:25600
    ds_read_b64_tr_b16 v[220:221], v89 offset:24576
    ds_read_b64_tr_b16 v[222:223], v89 offset:25600
    s_waitcnt lgkmcnt(4)
    ds_read_b64_tr_b16 v[224:225], v88 offset:32768
    ds_read_b64_tr_b16 v[226:227], v88 offset:33792
    ds_read_b64_tr_b16 v[228:229], v89 offset:32768
    ds_read_b64_tr_b16 v[230:231], v89 offset:33792
    ds_read_b64_tr_b16 v[232:233], v88 offset:40960
    ds_read_b64_tr_b16 v[234:235], v88 offset:41984
    ds_read_b64_tr_b16 v[236:237], v89 offset:40960
    ds_read_b64_tr_b16 v[238:239], v89 offset:41984
    s_waitcnt lgkmcnt(4)
    ds_read_b64_tr_b16 v[240:241], v88 offset:49152
    ds_read_b64_tr_b16 v[242:243], v88 offset:50176
    ds_read_b64_tr_b16 v[244:245], v89 offset:49152
    ds_read_b64_tr_b16 v[246:247], v89 offset:50176
    ds_read_b64_tr_b16 v[248:249], v88 offset:57344
    ds_read_b64_tr_b16 v[250:251], v88 offset:58368
    ds_read_b64_tr_b16 v[252:253], v89 offset:57344
    ds_read_b64_tr_b16 v[254:255], v89 offset:58368
    s_waitcnt lgkmcnt(0)
    s_barrier
    buffer_load_dword v99, off, s[12:15], s70 offset:32 sc1
    s_branch sgo_72
gen_59:
    s_mov_b32 s2, 131072
    s_mov_b32 s3, 2048
    s_mov_b32 s4, 65536
    s_mov_b32 s5, 7
    s_lshl_b32 s71, s75, 20
    s_add_u32 s81, s81, s71
    s_bfe_u32 s68, s57, 0x10000
    s_lshl_b32 s68, s68, 9
    s_lshl_b32 s71, s75, 15
    s_add_u32 s68, s68, s71
    s_bfe_u32 s71, s57, 0x30000
    s_lshl_b32 s71, s71, 7
    s_bfe_u32 s72, s58, 0x20000
    s_lshl_b32 s72, s72, 5
    s_bfe_u32 s73, s58, 0x10002
    s_lshl_b32 s73, s73, 4
    s_or_b32 s72, s72, s73
    s_or_b32 s71, s71, s72
    v_and_or_b32 v4, v1, 15, s71
    v_mov_b32 v6, 1024
    v_cmp_eq_u32 vcc, 1, v4
    s_nop 1
    v_cndmask_b32 v5, v4, v6, vcc
    v_and_b32 v54, 1, v5
    v_lshrrev_b32 v5, 1, v5
    v_cvt_f32_u32 v54, v54
    v_cvt_f32_u32 v5, v5
    v_mul_f32 v54, 0x3e800000, v54
    v_mul_f32 v52, 0x3a800000, v5
    v_xor_b32 v4, 16, v4
    v_cmp_eq_u32 vcc, 1, v4
    s_nop 1
    v_cndmask_b32 v5, v4, v6, vcc
    v_and_b32 v55, 1, v5
    v_lshrrev_b32 v5, 1, v5
    v_cvt_f32_u32 v55, v55
    v_cvt_f32_u32 v5, v5
    v_mul_f32 v55, 0x3e800000, v55
    v_mul_f32 v53, 0x3a800000, v5
    v_xor_b32 v4, 16, v4
    v_bfe_u32 v4, v1, 4, 2
    v_lshlrev_b32 v4, 3, v4
    s_bfe_u32 s71, s58, 0x10002
    s_lshl_b32 s71, s71, 9
    s_bfe_u32 s72, s57, 0x10000
    s_lshl_b32 s72, s72, 8
    s_or_b32 s71, s71, s72
    v_or_b32 v4, s71, v4
    v_cvt_f32_u32 v56, v4
    v_xor_b32 v4, 0x100, v4
    v_fma_f32 v60, v52, v56, v54
    v_fract_f32 v60, v60
    v_add_f32 v61, v60, v52
    v_add_f32 v62, v61, v52
    v_add_f32 v63, v62, v52
    v_add_f32 v64, v63, v52
    v_add_f32 v65, v64, v52
    v_add_f32 v66, v65, v52
    v_add_f32 v67, v66, v52
    v_cos_f32 v60, v60
    v_cos_f32 v61, v61
    v_cos_f32 v62, v62
    v_cos_f32 v63, v63
    v_cos_f32 v64, v64
    v_cos_f32 v65, v65
    v_cos_f32 v66, v66
    v_cos_f32 v67, v67
    v_cvt_pk_bf16_f32 v128, v60, v61
    v_cvt_pk_bf16_f32 v129, v62, v63
    v_cvt_pk_bf16_f32 v130, v64, v65
    v_cvt_pk_bf16_f32 v131, v66, v67
    v_fma_f32 v68, v53, v56, v55
    v_fract_f32 v68, v68
    v_add_f32 v69, v68, v53
    v_add_f32 v70, v69, v53
    v_add_f32 v71, v70, v53
    v_add_f32 v72, v71, v53
    v_add_f32 v73, v72, v53
    v_add_f32 v74, v73, v53
    v_add_f32 v75, v74, v53
    v_cos_f32 v68, v68
    v_cos_f32 v69, v69
    v_cos_f32 v70, v70
    v_cos_f32 v71, v71
    v_cos_f32 v72, v72
    v_cos_f32 v73, v73
    v_cos_f32 v74, v74
    v_cos_f32 v75, v75
    v_cvt_pk_bf16_f32 v132, v68, v69
    v_cvt_pk_bf16_f32 v133, v70, v71
    v_cvt_pk_bf16_f32 v134, v72, v73
    v_cvt_pk_bf16_f32 v135, v74, v75
    v_add_f32 v56, 0x42000000, v56
    v_fma_f32 v60, v52, v56, v54
    v_fract_f32 v60, v60
    v_add_f32 v61, v60, v52
    v_add_f32 v62, v61, v52
    v_add_f32 v63, v62, v52
    v_add_f32 v64, v63, v52
    v_add_f32 v65, v64, v52
    v_add_f32 v66, v65, v52
    v_add_f32 v67, v66, v52
    v_cos_f32 v60, v60
    v_cos_f32 v61, v61
    v_cos_f32 v62, v62
    v_cos_f32 v63, v63
    v_cos_f32 v64, v64
    v_cos_f32 v65, v65
    v_cos_f32 v66, v66
    v_cos_f32 v67, v67
    v_cvt_pk_bf16_f32 v136, v60, v61
    v_cvt_pk_bf16_f32 v137, v62, v63
    v_cvt_pk_bf16_f32 v138, v64, v65
    v_cvt_pk_bf16_f32 v139, v66, v67
    v_fma_f32 v68, v53, v56, v55
    v_fract_f32 v68, v68
    v_add_f32 v69, v68, v53
    v_add_f32 v70, v69, v53
    v_add_f32 v71, v70, v53
    v_add_f32 v72, v71, v53
    v_add_f32 v73, v72, v53
    v_add_f32 v74, v73, v53
    v_add_f32 v75, v74, v53
    v_cos_f32 v68, v68
    v_cos_f32 v69, v69
    v_cos_f32 v70, v70
    v_cos_f32 v71, v71
    v_cos_f32 v72, v72
    v_cos_f32 v73, v73
    v_cos_f32 v74, v74
    v_cos_f32 v75, v75
    v_cvt_pk_bf16_f32 v140, v68, v69
    v_cvt_pk_bf16_f32 v141, v70, v71
    v_cvt_pk_bf16_f32 v142, v72, v73
    v_cvt_pk_bf16_f32 v143, v74, v75
    v_add_f32 v56, 0x42000000, v56
    v_fma_f32 v60, v52, v56, v54
    v_fract_f32 v60, v60
    v_add_f32 v61, v60, v52
    v_add_f32 v62, v61, v52
    v_add_f32 v63, v62, v52
    v_add_f32 v64, v63, v52
    v_add_f32 v65, v64, v52
    v_add_f32 v66, v65, v52
    v_add_f32 v67, v66, v52
    v_cos_f32 v60, v60
    v_cos_f32 v61, v61
    v_cos_f32 v62, v62
    v_cos_f32 v63, v63
    v_cos_f32 v64, v64
    v_cos_f32 v65, v65
    v_cos_f32 v66, v66
    v_cos_f32 v67, v67
    v_cvt_pk_bf16_f32 v144, v60, v61
    v_cvt_pk_bf16_f32 v145, v62, v63
    v_cvt_pk_bf16_f32 v146, v64, v65
    v_cvt_pk_bf16_f32 v147, v66, v67
    v_fma_f32 v68, v53, v56, v55
    v_fract_f32 v68, v68
    v_add_f32 v69, v68, v53
    v_add_f32 v70, v69, v53
    v_add_f32 v71, v70, v53
    v_add_f32 v72, v71, v53
    v_add_f32 v73, v72, v53
    v_add_f32 v74, v73, v53
    v_add_f32 v75, v74, v53
    v_cos_f32 v68, v68
    v_cos_f32 v69, v69
    v_cos_f32 v70, v70
    v_cos_f32 v71, v71
    v_cos_f32 v72, v72
    v_cos_f32 v73, v73
    v_cos_f32 v74, v74
    v_cos_f32 v75, v75
    v_cvt_pk_bf16_f32 v148, v68, v69
    v_cvt_pk_bf16_f32 v149, v70, v71
    v_cvt_pk_bf16_f32 v150, v72, v73
    v_cvt_pk_bf16_f32 v151, v74, v75
    v_add_f32 v56, 0x42000000, v56
    v_fma_f32 v60, v52, v56, v54
    v_fract_f32 v60, v60
    v_add_f32 v61, v60, v52
    v_add_f32 v62, v61, v52
    v_add_f32 v63, v62, v52
    v_add_f32 v64, v63, v52
    v_add_f32 v65, v64, v52
    v_add_f32 v66, v65, v52
    v_add_f32 v67, v66, v52
    v_cos_f32 v60, v60
    v_cos_f32 v61, v61
    v_cos_f32 v62, v62
    v_cos_f32 v63, v63
    v_cos_f32 v64, v64
    v_cos_f32 v65, v65
    v_cos_f32 v66, v66
    v_cos_f32 v67, v67
    v_cvt_pk_bf16_f32 v152, v60, v61
    v_cvt_pk_bf16_f32 v153, v62, v63
    v_cvt_pk_bf16_f32 v154, v64, v65
    v_cvt_pk_bf16_f32 v155, v66, v67
    v_fma_f32 v68, v53, v56, v55
    v_fract_f32 v68, v68
    v_add_f32 v69, v68, v53
    v_add_f32 v70, v69, v53
    v_add_f32 v71, v70, v53
    v_add_f32 v72, v71, v53
    v_add_f32 v73, v72, v53
    v_add_f32 v74, v73, v53
    v_add_f32 v75, v74, v53
    v_cos_f32 v68, v68
    v_cos_f32 v69, v69
    v_cos_f32 v70, v70
    v_cos_f32 v71, v71
    v_cos_f32 v72, v72
    v_cos_f32 v73, v73
    v_cos_f32 v74, v74
    v_cos_f32 v75, v75
    v_cvt_pk_bf16_f32 v156, v68, v69
    v_cvt_pk_bf16_f32 v157, v70, v71
    v_cvt_pk_bf16_f32 v158, v72, v73
    v_cvt_pk_bf16_f32 v159, v74, v75
    v_add_f32 v56, 0x42000000, v56
    v_fma_f32 v60, v52, v56, v54
    v_fract_f32 v60, v60
    v_add_f32 v61, v60, v52
    v_add_f32 v62, v61, v52
    v_add_f32 v63, v62, v52
    v_add_f32 v64, v63, v52
    v_add_f32 v65, v64, v52
    v_add_f32 v66, v65, v52
    v_add_f32 v67, v66, v52
    v_cos_f32 v60, v60
    v_cos_f32 v61, v61
    v_cos_f32 v62, v62
    v_cos_f32 v63, v63
    v_cos_f32 v64, v64
    v_cos_f32 v65, v65
    v_cos_f32 v66, v66
    v_cos_f32 v67, v67
    v_cvt_pk_bf16_f32 v160, v60, v61
    v_cvt_pk_bf16_f32 v161, v62, v63
    v_cvt_pk_bf16_f32 v162, v64, v65
    v_cvt_pk_bf16_f32 v163, v66, v67
    v_fma_f32 v68, v53, v56, v55
    v_fract_f32 v68, v68
    v_add_f32 v69, v68, v53
    v_add_f32 v70, v69, v53
    v_add_f32 v71, v70, v53
    v_add_f32 v72, v71, v53
    v_add_f32 v73, v72, v53
    v_add_f32 v74, v73, v53
    v_add_f32 v75, v74, v53
    v_cos_f32 v68, v68
    v_cos_f32 v69, v69
    v_cos_f32 v70, v70
    v_cos_f32 v71, v71
    v_cos_f32 v72, v72
    v_cos_f32 v73, v73
    v_cos_f32 v74, v74
    v_cos_f32 v75, v75
    v_cvt_pk_bf16_f32 v164, v68, v69
    v_cvt_pk_bf16_f32 v165, v70, v71
    v_cvt_pk_bf16_f32 v166, v72, v73
    v_cvt_pk_bf16_f32 v167, v74, v75
    v_add_f32 v56, 0x42000000, v56
    v_fma_f32 v60, v52, v56, v54
    v_fract_f32 v60, v60
    v_add_f32 v61, v60, v52
    v_add_f32 v62, v61, v52
    v_add_f32 v63, v62, v52
    v_add_f32 v64, v63, v52
    v_add_f32 v65, v64, v52
    v_add_f32 v66, v65, v52
    v_add_f32 v67, v66, v52
    v_cos_f32 v60, v60
    v_cos_f32 v61, v61
    v_cos_f32 v62, v62
    v_cos_f32 v63, v63
    v_cos_f32 v64, v64
    v_cos_f32 v65, v65
    v_cos_f32 v66, v66
    v_cos_f32 v67, v67
    v_cvt_pk_bf16_f32 v168, v60, v61
    v_cvt_pk_bf16_f32 v169, v62, v63
    v_cvt_pk_bf16_f32 v170, v64, v65
    v_cvt_pk_bf16_f32 v171, v66, v67
    v_fma_f32 v68, v53, v56, v55
    v_fract_f32 v68, v68
    v_add_f32 v69, v68, v53
    v_add_f32 v70, v69, v53
    v_add_f32 v71, v70, v53
    v_add_f32 v72, v71, v53
    v_add_f32 v73, v72, v53
    v_add_f32 v74, v73, v53
    v_add_f32 v75, v74, v53
    v_cos_f32 v68, v68
    v_cos_f32 v69, v69
    v_cos_f32 v70, v70
    v_cos_f32 v71, v71
    v_cos_f32 v72, v72
    v_cos_f32 v73, v73
    v_cos_f32 v74, v74
    v_cos_f32 v75, v75
    v_cvt_pk_bf16_f32 v172, v68, v69
    v_cvt_pk_bf16_f32 v173, v70, v71
    v_cvt_pk_bf16_f32 v174, v72, v73
    v_cvt_pk_bf16_f32 v175, v74, v75
    v_add_f32 v56, 0x42000000, v56
    v_fma_f32 v60, v52, v56, v54
    v_fract_f32 v60, v60
    v_add_f32 v61, v60, v52
    v_add_f32 v62, v61, v52
    v_add_f32 v63, v62, v52
    v_add_f32 v64, v63, v52
    v_add_f32 v65, v64, v52
    v_add_f32 v66, v65, v52
    v_add_f32 v67, v66, v52
    v_cos_f32 v60, v60
    v_cos_f32 v61, v61
    v_cos_f32 v62, v62
    v_cos_f32 v63, v63
    v_cos_f32 v64, v64
    v_cos_f32 v65, v65
    v_cos_f32 v66, v66
    v_cos_f32 v67, v67
    v_cvt_pk_bf16_f32 v176, v60, v61
    v_cvt_pk_bf16_f32 v177, v62, v63
    v_cvt_pk_bf16_f32 v178, v64, v65
    v_cvt_pk_bf16_f32 v179, v66, v67
    v_fma_f32 v68, v53, v56, v55
    v_fract_f32 v68, v68
    v_add_f32 v69, v68, v53
    v_add_f32 v70, v69, v53
    v_add_f32 v71, v70, v53
    v_add_f32 v72, v71, v53
    v_add_f32 v73, v72, v53
    v_add_f32 v74, v73, v53
    v_add_f32 v75, v74, v53
    v_cos_f32 v68, v68
    v_cos_f32 v69, v69
    v_cos_f32 v70, v70
    v_cos_f32 v71, v71
    v_cos_f32 v72, v72
    v_cos_f32 v73, v73
    v_cos_f32 v74, v74
    v_cos_f32 v75, v75
    v_cvt_pk_bf16_f32 v180, v68, v69
    v_cvt_pk_bf16_f32 v181, v70, v71
    v_cvt_pk_bf16_f32 v182, v72, v73
    v_cvt_pk_bf16_f32 v183, v74, v75
    v_add_f32 v56, 0x42000000, v56
    v_fma_f32 v60, v52, v56, v54
    v_fract_f32 v60, v60
    v_add_f32 v61, v60, v52
    v_add_f32 v62, v61, v52
    v_add_f32 v63, v62, v52
    v_add_f32 v64, v63, v52
    v_add_f32 v65, v64, v52
    v_add_f32 v66, v65, v52
    v_add_f32 v67, v66, v52
    v_cos_f32 v60, v60
    v_cos_f32 v61, v61
    v_cos_f32 v62, v62
    v_cos_f32 v63, v63
    v_cos_f32 v64, v64
    v_cos_f32 v65, v65
    v_cos_f32 v66, v66
    v_cos_f32 v67, v67
    v_cvt_pk_bf16_f32 v184, v60, v61
    v_cvt_pk_bf16_f32 v185, v62, v63
    v_cvt_pk_bf16_f32 v186, v64, v65
    v_cvt_pk_bf16_f32 v187, v66, v67
    v_fma_f32 v68, v53, v56, v55
    v_fract_f32 v68, v68
    v_add_f32 v69, v68, v53
    v_add_f32 v70, v69, v53
    v_add_f32 v71, v70, v53
    v_add_f32 v72, v71, v53
    v_add_f32 v73, v72, v53
    v_add_f32 v74, v73, v53
    v_add_f32 v75, v74, v53
    v_cos_f32 v68, v68
    v_cos_f32 v69, v69
    v_cos_f32 v70, v70
    v_cos_f32 v71, v71
    v_cos_f32 v72, v72
    v_cos_f32 v73, v73
    v_cos_f32 v74, v74
    v_cos_f32 v75, v75
    v_cvt_pk_bf16_f32 v188, v68, v69
    v_cvt_pk_bf16_f32 v189, v70, v71
    v_cvt_pk_bf16_f32 v190, v72, v73
    v_cvt_pk_bf16_f32 v191, v74, v75
    v_cvt_f32_u32 v56, v4
    v_xor_b32 v4, 0x100, v4
    v_fma_f32 v60, v52, v56, v54
    v_fract_f32 v60, v60
    v_add_f32 v61, v60, v52
    v_add_f32 v62, v61, v52
    v_add_f32 v63, v62, v52
    v_add_f32 v64, v63, v52
    v_add_f32 v65, v64, v52
    v_add_f32 v66, v65, v52
    v_add_f32 v67, v66, v52
    v_cos_f32 v60, v60
    v_cos_f32 v61, v61
    v_cos_f32 v62, v62
    v_cos_f32 v63, v63
    v_cos_f32 v64, v64
    v_cos_f32 v65, v65
    v_cos_f32 v66, v66
    v_cos_f32 v67, v67
    v_cvt_pk_bf16_f32 v192, v60, v61
    v_cvt_pk_bf16_f32 v193, v62, v63
    v_cvt_pk_bf16_f32 v194, v64, v65
    v_cvt_pk_bf16_f32 v195, v66, v67
    v_fma_f32 v68, v53, v56, v55
    v_fract_f32 v68, v68
    v_add_f32 v69, v68, v53
    v_add_f32 v70, v69, v53
    v_add_f32 v71, v70, v53
    v_add_f32 v72, v71, v53
    v_add_f32 v73, v72, v53
    v_add_f32 v74, v73, v53
    v_add_f32 v75, v74, v53
    v_cos_f32 v68, v68
    v_cos_f32 v69, v69
    v_cos_f32 v70, v70
    v_cos_f32 v71, v71
    v_cos_f32 v72, v72
    v_cos_f32 v73, v73
    v_cos_f32 v74, v74
    v_cos_f32 v75, v75
    v_cvt_pk_bf16_f32 v196, v68, v69
    v_cvt_pk_bf16_f32 v197, v70, v71
    v_cvt_pk_bf16_f32 v198, v72, v73
    v_cvt_pk_bf16_f32 v199, v74, v75
    v_add_f32 v56, 0x42000000, v56
    v_fma_f32 v60, v52, v56, v54
    v_fract_f32 v60, v60
    v_add_f32 v61, v60, v52
    v_add_f32 v62, v61, v52
    v_add_f32 v63, v62, v52
    v_add_f32 v64, v63, v52
    v_add_f32 v65, v64, v52
    v_add_f32 v66, v65, v52
    v_add_f32 v67, v66, v52
    v_cos_f32 v60, v60
    v_cos_f32 v61, v61
    v_cos_f32 v62, v62
    v_cos_f32 v63, v63
    v_cos_f32 v64, v64
    v_cos_f32 v65, v65
    v_cos_f32 v66, v66
    v_cos_f32 v67, v67
    v_cvt_pk_bf16_f32 v200, v60, v61
    v_cvt_pk_bf16_f32 v201, v62, v63
    v_cvt_pk_bf16_f32 v202, v64, v65
    v_cvt_pk_bf16_f32 v203, v66, v67
    v_fma_f32 v68, v53, v56, v55
    v_fract_f32 v68, v68
    v_add_f32 v69, v68, v53
    v_add_f32 v70, v69, v53
    v_add_f32 v71, v70, v53
    v_add_f32 v72, v71, v53
    v_add_f32 v73, v72, v53
    v_add_f32 v74, v73, v53
    v_add_f32 v75, v74, v53
    v_cos_f32 v68, v68
    v_cos_f32 v69, v69
    v_cos_f32 v70, v70
    v_cos_f32 v71, v71
    v_cos_f32 v72, v72
    v_cos_f32 v73, v73
    v_cos_f32 v74, v74
    v_cos_f32 v75, v75
    v_cvt_pk_bf16_f32 v204, v68, v69
    v_cvt_pk_bf16_f32 v205, v70, v71
    v_cvt_pk_bf16_f32 v206, v72, v73
    v_cvt_pk_bf16_f32 v207, v74, v75
    v_add_f32 v56, 0x42000000, v56
    v_fma_f32 v60, v52, v56, v54
    v_fract_f32 v60, v60
    v_add_f32 v61, v60, v52
    v_add_f32 v62, v61, v52
    v_add_f32 v63, v62, v52
    v_add_f32 v64, v63, v52
    v_add_f32 v65, v64, v52
    v_add_f32 v66, v65, v52
    v_add_f32 v67, v66, v52
    v_cos_f32 v60, v60
    v_cos_f32 v61, v61
    v_cos_f32 v62, v62
    v_cos_f32 v63, v63
    v_cos_f32 v64, v64
    v_cos_f32 v65, v65
    v_cos_f32 v66, v66
    v_cos_f32 v67, v67
    v_cvt_pk_bf16_f32 v208, v60, v61
    v_cvt_pk_bf16_f32 v209, v62, v63
    v_cvt_pk_bf16_f32 v210, v64, v65
    v_cvt_pk_bf16_f32 v211, v66, v67
    v_fma_f32 v68, v53, v56, v55
    v_fract_f32 v68, v68
    v_add_f32 v69, v68, v53
    v_add_f32 v70, v69, v53
    v_add_f32 v71, v70, v53
    v_add_f32 v72, v71, v53
    v_add_f32 v73, v72, v53
    v_add_f32 v74, v73, v53
    v_add_f32 v75, v74, v53
    v_cos_f32 v68, v68
    v_cos_f32 v69, v69
    v_cos_f32 v70, v70
    v_cos_f32 v71, v71
    v_cos_f32 v72, v72
    v_cos_f32 v73, v73
    v_cos_f32 v74, v74
    v_cos_f32 v75, v75
    v_cvt_pk_bf16_f32 v212, v68, v69
    v_cvt_pk_bf16_f32 v213, v70, v71
    v_cvt_pk_bf16_f32 v214, v72, v73
    v_cvt_pk_bf16_f32 v215, v74, v75
    v_add_f32 v56, 0x42000000, v56
    v_fma_f32 v60, v52, v56, v54
    v_fract_f32 v60, v60
    v_add_f32 v61, v60, v52
    v_add_f32 v62, v61, v52
    v_add_f32 v63, v62, v52
    v_add_f32 v64, v63, v52
    v_add_f32 v65, v64, v52
    v_add_f32 v66, v65, v52
    v_add_f32 v67, v66, v52
    v_cos_f32 v60, v60
    v_cos_f32 v61, v61
    v_cos_f32 v62, v62
    v_cos_f32 v63, v63
    v_cos_f32 v64, v64
    v_cos_f32 v65, v65
    v_cos_f32 v66, v66
    v_cos_f32 v67, v67
    v_cvt_pk_bf16_f32 v216, v60, v61
    v_cvt_pk_bf16_f32 v217, v62, v63
    v_cvt_pk_bf16_f32 v218, v64, v65
    v_cvt_pk_bf16_f32 v219, v66, v67
    v_fma_f32 v68, v53, v56, v55
    v_fract_f32 v68, v68
    v_add_f32 v69, v68, v53
    v_add_f32 v70, v69, v53
    v_add_f32 v71, v70, v53
    v_add_f32 v72, v71, v53
    v_add_f32 v73, v72, v53
    v_add_f32 v74, v73, v53
    v_add_f32 v75, v74, v53
    v_cos_f32 v68, v68
    v_cos_f32 v69, v69
    v_cos_f32 v70, v70
    v_cos_f32 v71, v71
    v_cos_f32 v72, v72
    v_cos_f32 v73, v73
    v_cos_f32 v74, v74
    v_cos_f32 v75, v75
    v_cvt_pk_bf16_f32 v220, v68, v69
    v_cvt_pk_bf16_f32 v221, v70, v71
    v_cvt_pk_bf16_f32 v222, v72, v73
    v_cvt_pk_bf16_f32 v223, v74, v75
    v_add_f32 v56, 0x42000000, v56
    v_fma_f32 v60, v52, v56, v54
    v_fract_f32 v60, v60
    v_add_f32 v61, v60, v52
    v_add_f32 v62, v61, v52
    v_add_f32 v63, v62, v52
    v_add_f32 v64, v63, v52
    v_add_f32 v65, v64, v52
    v_add_f32 v66, v65, v52
    v_add_f32 v67, v66, v52
    v_cos_f32 v60, v60
    v_cos_f32 v61, v61
    v_cos_f32 v62, v62
    v_cos_f32 v63, v63
    v_cos_f32 v64, v64
    v_cos_f32 v65, v65
    v_cos_f32 v66, v66
    v_cos_f32 v67, v67
    v_cvt_pk_bf16_f32 v224, v60, v61
    v_cvt_pk_bf16_f32 v225, v62, v63
    v_cvt_pk_bf16_f32 v226, v64, v65
    v_cvt_pk_bf16_f32 v227, v66, v67
    v_fma_f32 v68, v53, v56, v55
    v_fract_f32 v68, v68
    v_add_f32 v69, v68, v53
    v_add_f32 v70, v69, v53
    v_add_f32 v71, v70, v53
    v_add_f32 v72, v71, v53
    v_add_f32 v73, v72, v53
    v_add_f32 v74, v73, v53
    v_add_f32 v75, v74, v53
    v_cos_f32 v68, v68
    v_cos_f32 v69, v69
    v_cos_f32 v70, v70
    v_cos_f32 v71, v71
    v_cos_f32 v72, v72
    v_cos_f32 v73, v73
    v_cos_f32 v74, v74
    v_cos_f32 v75, v75
    v_cvt_pk_bf16_f32 v228, v68, v69
    v_cvt_pk_bf16_f32 v229, v70, v71
    v_cvt_pk_bf16_f32 v230, v72, v73
    v_cvt_pk_bf16_f32 v231, v74, v75
    v_add_f32 v56, 0x42000000, v56
    v_fma_f32 v60, v52, v56, v54
    v_fract_f32 v60, v60
    v_add_f32 v61, v60, v52
    v_add_f32 v62, v61, v52
    v_add_f32 v63, v62, v52
    v_add_f32 v64, v63, v52
    v_add_f32 v65, v64, v52
    v_add_f32 v66, v65, v52
    v_add_f32 v67, v66, v52
    v_cos_f32 v60, v60
    v_cos_f32 v61, v61
    v_cos_f32 v62, v62
    v_cos_f32 v63, v63
    v_cos_f32 v64, v64
    v_cos_f32 v65, v65
    v_cos_f32 v66, v66
    v_cos_f32 v67, v67
    v_cvt_pk_bf16_f32 v232, v60, v61
    v_cvt_pk_bf16_f32 v233, v62, v63
    v_cvt_pk_bf16_f32 v234, v64, v65
    v_cvt_pk_bf16_f32 v235, v66, v67
    v_fma_f32 v68, v53, v56, v55
    v_fract_f32 v68, v68
    v_add_f32 v69, v68, v53
    v_add_f32 v70, v69, v53
    v_add_f32 v71, v70, v53
    v_add_f32 v72, v71, v53
    v_add_f32 v73, v72, v53
    v_add_f32 v74, v73, v53
    v_add_f32 v75, v74, v53
    v_cos_f32 v68, v68
    v_cos_f32 v69, v69
    v_cos_f32 v70, v70
    v_cos_f32 v71, v71
    v_cos_f32 v72, v72
    v_cos_f32 v73, v73
    v_cos_f32 v74, v74
    v_cos_f32 v75, v75
    v_cvt_pk_bf16_f32 v236, v68, v69
    v_cvt_pk_bf16_f32 v237, v70, v71
    v_cvt_pk_bf16_f32 v238, v72, v73
    v_cvt_pk_bf16_f32 v239, v74, v75
    v_add_f32 v56, 0x42000000, v56
    v_fma_f32 v60, v52, v56, v54
    v_fract_f32 v60, v60
    v_add_f32 v61, v60, v52
    v_add_f32 v62, v61, v52
    v_add_f32 v63, v62, v52
    v_add_f32 v64, v63, v52
    v_add_f32 v65, v64, v52
    v_add_f32 v66, v65, v52
    v_add_f32 v67, v66, v52
    v_cos_f32 v60, v60
    v_cos_f32 v61, v61
    v_cos_f32 v62, v62
    v_cos_f32 v63, v63
    v_cos_f32 v64, v64
    v_cos_f32 v65, v65
    v_cos_f32 v66, v66
    v_cos_f32 v67, v67
    v_cvt_pk_bf16_f32 v240, v60, v61
    v_cvt_pk_bf16_f32 v241, v62, v63
    v_cvt_pk_bf16_f32 v242, v64, v65
    v_cvt_pk_bf16_f32 v243, v66, v67
    v_fma_f32 v68, v53, v56, v55
    v_fract_f32 v68, v68
    v_add_f32 v69, v68, v53
    v_add_f32 v70, v69, v53
    v_add_f32 v71, v70, v53
    v_add_f32 v72, v71, v53
    v_add_f32 v73, v72, v53
    v_add_f32 v74, v73, v53
    v_add_f32 v75, v74, v53
    v_cos_f32 v68, v68
    v_cos_f32 v69, v69
    v_cos_f32 v70, v70
    v_cos_f32 v71, v71
    v_cos_f32 v72, v72
    v_cos_f32 v73, v73
    v_cos_f32 v74, v74
    v_cos_f32 v75, v75
    v_cvt_pk_bf16_f32 v244, v68, v69
    v_cvt_pk_bf16_f32 v245, v70, v71
    v_cvt_pk_bf16_f32 v246, v72, v73
    v_cvt_pk_bf16_f32 v247, v74, v75
    v_add_f32 v56, 0x42000000, v56
    v_fma_f32 v60, v52, v56, v54
    v_fract_f32 v60, v60
    v_add_f32 v61, v60, v52
    v_add_f32 v62, v61, v52
    v_add_f32 v63, v62, v52
    v_add_f32 v64, v63, v52
    v_add_f32 v65, v64, v52
    v_add_f32 v66, v65, v52
    v_add_f32 v67, v66, v52
    v_cos_f32 v60, v60
    v_cos_f32 v61, v61
    v_cos_f32 v62, v62
    v_cos_f32 v63, v63
    v_cos_f32 v64, v64
    v_cos_f32 v65, v65
    v_cos_f32 v66, v66
    v_cos_f32 v67, v67
    v_cvt_pk_bf16_f32 v248, v60, v61
    v_cvt_pk_bf16_f32 v249, v62, v63
    v_cvt_pk_bf16_f32 v250, v64, v65
    v_cvt_pk_bf16_f32 v251, v66, v67
    v_fma_f32 v68, v53, v56, v55
    v_fract_f32 v68, v68
    v_add_f32 v69, v68, v53
    v_add_f32 v70, v69, v53
    v_add_f32 v71, v70, v53
    v_add_f32 v72, v71, v53
    v_add_f32 v73, v72, v53
    v_add_f32 v74, v73, v53
    v_add_f32 v75, v74, v53
    v_cos_f32 v68, v68
    v_cos_f32 v69, v69
    v_cos_f32 v70, v70
    v_cos_f32 v71, v71
    v_cos_f32 v72, v72
    v_cos_f32 v73, v73
    v_cos_f32 v74, v74
    v_cos_f32 v75, v75
    v_cvt_pk_bf16_f32 v252, v68, v69
    v_cvt_pk_bf16_f32 v253, v70, v71
    v_cvt_pk_bf16_f32 v254, v72, v73
    v_cvt_pk_bf16_f32 v255, v74, v75
    s_lshl_b32 s71, s58, 2
    s_bfe_u32 s72, s71, 0x30000
    s_bfe_u32 s73, s71, 0x10003
    s_lshl_b32 s73, s73, 4
    s_or_b32 s72, s72, s73
    s_bfe_u32 s73, s71, 0x10004
    s_lshl_b32 s73, s73, 3
    s_or_b32 s72, s72, s73
    s_mul_i32 s72, s72, s2
    v_mov_b32 v4, s72
    s_and_b32 s71, s71, 12
    v_xor_b32 v5, s71, v1
    v_bfe_u32 v84, v5, 0, 5
    v_lshlrev_b32 v84, 4, v84
    v_bfe_u32 v6, v5, 5, 1
    v_lshl_or_b32 v84, v6, 10, v84
    s_sub_u32 s72, s2, 1024
    v_add_u32 v84, v84, v4
    v_xor_b32 v85, 16, v84
    v_add_u32 v85, s72, v85
    v_xor_b32 v86, 48, v85
    v_add_u32 v86, s72, v86
    v_xor_b32 v87, 16, v86
    v_add_u32 v87, s72, v87
    s_xor_b32 s69, s68, 512
    s_lshl_b32 s70, s58, 12
sgo_72:
    s_add_u32 m0, s70, 0
    s_nop 0
    buffer_load_dwordx4 v84, s[60:63], s68 offen offset:0 lds
    buffer_load_dwordx4 v85, s[60:63], s68 offen offset:1024 lds
    buffer_load_dwordx4 v86, s[60:63], s68 offen offset:2048 lds
    buffer_load_dwordx4 v87, s[60:63], s68 offen offset:3072 lds
    s_add_u32 s68, s68, s3
    s_add_u32 m0, s70, 32768
    s_nop 0
    buffer_load_dwordx4 v84, s[60:63], s69 offen offset:0 lds
    buffer_load_dwordx4 v85, s[60:63], s69 offen offset:1024 lds
    buffer_load_dwordx4 v86, s[60:63], s69 offen offset:2048 lds
    buffer_load_dwordx4 v87, s[60:63], s69 offen offset:3072 lds
    s_add_u32 s69, s69, s3
    s_add_u32 m0, s70, 65536
    s_nop 0
    buffer_load_dwordx4 v84, s[60:63], s68 offen offset:0 lds
    buffer_load_dwordx4 v85, s[60:63], s68 offen offset:1024 lds
    buffer_load_dwordx4 v86, s[60:63], s68 offen offset:2048 lds
    buffer_load_dwordx4 v87, s[60:63], s68 offen offset:3072 lds
    s_add_u32 s68, s68, s3
    v_lshrrev_b32 v4, 4, v1
    v_xor_b32 v4, v4, v1
    v_bfe_u32 v5, v4, 0, 4
    v_lshlrev_b32 v5, 4, v5
    v_bfe_u32 v4, v1, 0, 4
    v_lshlrev_b32 v4, 10, v4
    s_bfe_u32 s71, s58, 0x10002
    s_lshl_b32 s71, s71, 9
    v_or3_b32 v88, v4, v5, s71
    v_xor_b32 v89, 0x40, v88
    v_xor_b32 v90, 0x80, v88
    v_xor_b32 v91, 0xc0, v88
    v_xor_b32 v92, 0x10000, v88
    v_xor_b32 v93, 0x10040, v88
    v_xor_b32 v94, 0x10080, v88
    v_xor_b32 v95, 0x100c0, v88
    s_lshl_b32 s71, s58, 11
    s_or_b32 s71, s71, 131072
    v_lshl_add_u32 v96, v1, 4, s71
    v_xor_b32 v97, 0x2000, v96
    v_bfe_u32 v98, v1, 0, 4
    v_lshlrev_b32 v98, 4, v98
    v_bfe_u32 v4, v1, 4, 2
    v_lshl_or_b32 v98, v4, 9, v98
    s_bfe_u32 s71, s57, 0x30000
    s_lshl_b32 s71, s71, 13
    s_add_u32 s81, s81, s71
    s_bfe_u32 s71, s58, 0x20000
    s_lshl_b32 s71, s71, 11
    s_bfe_u32 s72, s58, 0x10002
    s_lshl_b32 s72, s72, 8
    s_or_b32 s71, s71, s72
    s_add_u32 s81, s81, s71
    s_mov_b32 s73, 0x5ffffff0
    s_mov_b32 s82, 0
    s_waitcnt vmcnt(8)
    s_barrier
    ds_read_b128 v[52:55], v88 offset:0
    ds_read_b128 v[56:59], v88 offset:16384
    ds_read_b128 v[60:63], v89 offset:0
    ds_read_b128 v[64:67], v89 offset:16384
stream_73:
    s_waitcnt lgkmcnt(2)
    v_mfma_f32_16x16x32_bf16 v[20:23], v[52:55], v[128:131], 0
    ds_read_b128 v[68:71], v90 offset:0
    v_mfma_f32_16x16x32_bf16 v[24:27], v[52:55], v[132:135], 0
    ds_read_b128 v[72:75], v90 offset:16384
    v_mfma_f32_16x16x32_bf16 v[28:31], v[56:59], v[128:131], 0
    s_add_u32 m0, s70, 98304
    s_nop 0
    buffer_load_dwordx4 v84, s[60:63], s69 offen offset:0 lds
    v_mfma_f32_16x16x32_bf16 v[32:35], v[56:59], v[132:135], 0
    s_waitcnt lgkmcnt(2)
    v_mfma_f32_16x16x32_bf16 v[20:23], v[60:63], v[136:139], v[20:23]
    ds_read_b128 v[76:79], v91 offset:0
    v_mfma_f32_16x16x32_bf16 v[24:27], v[60:63], v[140:143], v[24:27]
    ds_read_b128 v[80:83], v91 offset:16384
    v_mfma_f32_16x16x32_bf16 v[28:31], v[64:67], v[136:139], v[28:31]
    buffer_load_dwordx4 v85, s[60:63], s69 offen offset:1024 lds
    v_mfma_f32_16x16x32_bf16 v[32:35], v[64:67], v[140:143], v[32:35]
    ds_write_b128 v96, v[40:43] offset:0
    s_waitcnt lgkmcnt(3)
    v_mfma_f32_16x16x32_bf16 v[20:23], v[68:71], v[144:147], v[20:23]
    ds_read_b128 v[52:55], v88 offset:256
    v_mfma_f32_16x16x32_bf16 v[24:27], v[68:71], v[148:151], v[24:27]
    ds_read_b128 v[56:59], v88 offset:16640
    v_mfma_f32_16x16x32_bf16 v[28:31], v[72:75], v[144:147], v[28:31]
    buffer_load_dwordx4 v86, s[60:63], s69 offen offset:2048 lds
    v_mfma_f32_16x16x32_bf16 v[32:35], v[72:75], v[148:151], v[32:35]
    ds_write_b128 v96, v[48:51] offset:1024
    s_waitcnt lgkmcnt(4)
    v_mfma_f32_16x16x32_bf16 v[20:23], v[76:79], v[152:155], v[20:23]
    ds_read_b128 v[60:63], v89 offset:256
    v_mfma_f32_16x16x32_bf16 v[24:27], v[76:79], v[156:159], v[24:27]
    ds_read_b128 v[64:67], v89 offset:16640
    v_mfma_f32_16x16x32_bf16 v[28:31], v[80:83], v[152:155], v[28:31]
    buffer_load_dwordx4 v87, s[60:63], s69 offen offset:3072 lds
    s_add_u32 s69, s69, s3
    v_mfma_f32_16x16x32_bf16 v[32:35], v[80:83], v[156:159], v[32:35]
    s_waitcnt lgkmcnt(3)
    v_mfma_f32_16x16x32_bf16 v[20:23], v[52:55], v[160:163], v[20:23]
    ds_read_b128 v[68:71], v90 offset:256
    v_mfma_f32_16x16x32_bf16 v[24:27], v[52:55], v[164:167], v[24:27]
    ds_read_b128 v[72:75], v90 offset:16640
    v_mfma_f32_16x16x32_bf16 v[28:31], v[56:59], v[160:163], v[28:31]
    v_mfma_f32_16x16x32_bf16 v[32:35], v[56:59], v[164:167], v[32:35]
    s_waitcnt lgkmcnt(2)
    v_mfma_f32_16x16x32_bf16 v[20:23], v[60:63], v[168:171], v[20:23]
    ds_read_b128 v[76:79], v91 offset:256
    v_mfma_f32_16x16x32_bf16 v[24:27], v[60:63], v[172:175], v[24:27]
    ds_read_b128 v[80:83], v91 offset:16640
    v_mfma_f32_16x16x32_bf16 v[28:31], v[64:67], v[168:171], v[28:31]
    v_mfma_f32_16x16x32_bf16 v[32:35], v[64:67], v[172:175], v[32:35]
    s_waitcnt vmcnt(8) lgkmcnt(0)
    s_barrier
    v_mfma_f32_16x16x32_bf16 v[20:23], v[68:71], v[176:179], v[20:23]
    ds_read_b128 v[4:7], v97 offset:0
    ds_read_b128 v[8:11], v97 offset:1024
    ds_read_b128 v[52:55], v88 offset:32768
    v_mfma_f32_16x16x32_bf16 v[24:27], v[68:71], v[180:183], v[24:27]
    ds_read_b128 v[56:59], v88 offset:49152
    v_mfma_f32_16x16x32_bf16 v[28:31], v[72:75], v[176:179], v[28:31]
    v_mfma_f32_16x16x32_bf16 v[32:35], v[72:75], v[180:183], v[32:35]
    s_waitcnt lgkmcnt(2)
    v_mfma_f32_16x16x32_bf16 v[20:23], v[76:79], v[184:187], v[20:23]
    v_add_f32 v4, v4, v36
    v_add_f32 v5, v5, v37
    v_add_f32 v6, v6, v38
    v_add_f32 v7, v7, v39
    ds_read_b128 v[60:63], v89 offset:32768
    v_mfma_f32_16x16x32_bf16 v[24:27], v[76:79], v[188:191], v[24:27]
    v_cvt_pk_bf16_f32 v12, v4, v5
    v_cvt_pk_bf16_f32 v13, v6, v7
    ds_read_b128 v[64:67], v89 offset:49152
    v_mfma_f32_16x16x32_bf16 v[28:31], v[80:83], v[184:187], v[28:31]
    v_add_f32 v8, v8, v44
    v_add_f32 v9, v9, v45
    v_add_f32 v10, v10, v46
    v_add_f32 v11, v11, v47
    v_mfma_f32_16x16x32_bf16 v[32:35], v[80:83], v[188:191], v[32:35]
    v_cvt_pk_bf16_f32 v14, v8, v9
    v_cvt_pk_bf16_f32 v15, v10, v11
    buffer_store_dwordx4 v[12:15], v98, s[8:11], s73 offen sc1
    s_mov_b32 s73, s81
    s_add_u32 s81, s81, s4
    s_waitcnt lgkmcnt(2)
    v_mfma_f32_16x16x32_bf16 v[20:23], v[52:55], v[192:195], v[20:23]
    ds_read_b128 v[68:71], v90 offset:32768
    v_mfma_f32_16x16x32_bf16 v[24:27], v[52:55], v[196:199], v[24:27]
    ds_read_b128 v[72:75], v90 offset:49152
    v_mfma_f32_16x16x32_bf16 v[28:31], v[56:59], v[192:195], v[28:31]
    s_add_u32 m0, s70, 0
    s_nop 0
    buffer_load_dwordx4 v84, s[60:63], s68 offen offset:0 lds
    v_mfma_f32_16x16x32_bf16 v[32:35], v[56:59], v[196:199], v[32:35]
    s_waitcnt lgkmcnt(2)
    v_mfma_f32_16x16x32_bf16 v[20:23], v[60:63], v[200:203], v[20:23]
    ds_read_b128 v[76:79], v91 offset:32768
    v_mfma_f32_16x16x32_bf16 v[24:27], v[60:63], v[204:207], v[24:27]
    ds_read_b128 v[80:83], v91 offset:49152
    v_mfma_f32_16x16x32_bf16 v[28:31], v[64:67], v[200:203], v[28:31]
    buffer_load_dwordx4 v85, s[60:63], s68 offen offset:1024 lds
    v_mfma_f32_16x16x32_bf16 v[32:35], v[64:67], v[204:207], v[32:35]
    s_waitcnt lgkmcnt(2)
    v_mfma_f32_16x16x32_bf16 v[20:23], v[68:71], v[208:211], v[20:23]
    ds_read_b128 v[52:55], v88 offset:33024
    v_mfma_f32_16x16x32_bf16 v[24:27], v[68:71], v[212:215], v[24:27]
    ds_read_b128 v[56:59], v88 offset:49408
    v_mfma_f32_16x16x32_bf16 v[28:31], v[72:75], v[208:211], v[28:31]
    buffer_load_dwordx4 v86, s[60:63], s68 offen offset:2048 lds
    v_mfma_f32_16x16x32_bf16 v[32:35], v[72:75], v[212:215], v[32:35]
    s_waitcnt lgkmcnt(2)
    v_mfma_f32_16x16x32_bf16 v[20:23], v[76:79], v[216:219], v[20:23]
    ds_read_b128 v[60:63], v89 offset:33024
    v_mfma_f32_16x16x32_bf16 v[24:27], v[76:79], v[220:223], v[24:27]
    ds_read_b128 v[64:67], v89 offset:49408
    v_mfma_f32_16x16x32_bf16 v[28:31], v[80:83], v[216:219], v[28:31]
    buffer_load_dwordx4 v87, s[60:63], s68 offen offset:3072 lds
    s_add_u32 s68, s68, s3
    v_mfma_f32_16x16x32_bf16 v[32:35], v[80:83], v[220:223], v[32:35]
    s_waitcnt lgkmcnt(2)
    v_mfma_f32_16x16x32_bf16 v[20:23], v[52:55], v[224:227], v[20:23]
    ds_read_b128 v[68:71], v90 offset:33024
    v_mfma_f32_16x16x32_bf16 v[24:27], v[52:55], v[228:231], v[24:27]
    ds_read_b128 v[72:75], v90 offset:49408
    v_mfma_f32_16x16x32_bf16 v[28:31], v[56:59], v[224:227], v[28:31]
    v_mfma_f32_16x16x32_bf16 v[32:35], v[56:59], v[228:231], v[32:35]
    s_waitcnt lgkmcnt(2)
    v_mfma_f32_16x16x32_bf16 v[20:23], v[60:63], v[232:235], v[20:23]
    ds_read_b128 v[76:79], v91 offset:33024
    v_mfma_f32_16x16x32_bf16 v[24:27], v[60:63], v[236:239], v[24:27]
    ds_read_b128 v[80:83], v91 offset:49408
    v_mfma_f32_16x16x32_bf16 v[28:31], v[64:67], v[232:235], v[28:31]
    v_mfma_f32_16x16x32_bf16 v[32:35], v[64:67], v[236:239], v[32:35]
    s_bitcmp1_b64 s[6:7], s82
    s_cbranch_scc1 ssig_54
    s_waitcnt vmcnt(8) lgkmcnt(0)
    s_barrier
srett_56:
    s_add_u32 s82, s82, 1
    v_mfma_f32_16x16x32_bf16 v[20:23], v[68:71], v[240:243], v[20:23]
    ds_read_b128 v[52:55], v92 offset:0
    v_mfma_f32_16x16x32_bf16 v[24:27], v[68:71], v[244:247], v[24:27]
    ds_read_b128 v[56:59], v92 offset:16384
    v_mfma_f32_16x16x32_bf16 v[28:31], v[72:75], v[240:243], v[28:31]
    v_mfma_f32_16x16x32_bf16 v[32:35], v[72:75], v[244:247], v[32:35]
    v_mfma_f32_16x16x32_bf16 v[20:23], v[76:79], v[248:251], v[20:23]
    ds_read_b128 v[60:63], v93 offset:0
    v_mfma_f32_16x16x32_bf16 v[24:27], v[76:79], v[252:255], v[24:27]
    ds_read_b128 v[64:67], v93 offset:16384
    v_mfma_f32_16x16x32_bf16 v[28:31], v[80:83], v[248:251], v[28:31]
    v_mfma_f32_16x16x32_bf16 v[32:35], v[80:83], v[252:255], v[32:35]
    s_waitcnt lgkmcnt(2)
    v_mfma_f32_16x16x32_bf16 v[36:39], v[52:55], v[128:131], 0
    ds_read_b128 v[68:71], v94 offset:0
    v_mfma_f32_16x16x32_bf16 v[40:43], v[52:55], v[132:135], 0
    ds_read_b128 v[72:75], v94 offset:16384
    v_mfma_f32_16x16x32_bf16 v[44:47], v[56:59], v[128:131], 0
    s_add_u32 m0, s70, 32768
    s_nop 0
    buffer_load_dwordx4 v84, s[60:63], s69 offen offset:0 lds
    v_mfma_f32_16x16x32_bf16 v[48:51], v[56:59], v[132:135], 0
    s_waitcnt lgkmcnt(2)
    v_mfma_f32_16x16x32_bf16 v[36:39], v[60:63], v[136:139], v[36:39]
    ds_read_b128 v[76:79], v95 offset:0
    v_mfma_f32_16x16x32_bf16 v[40:43], v[60:63], v[140:143], v[40:43]
    ds_read_b128 v[80:83], v95 offset:16384
    v_mfma_f32_16x16x32_bf16 v[44:47], v[64:67], v[136:139], v[44:47]
    buffer_load_dwordx4 v85, s[60:63], s69 offen offset:1024 lds
    v_mfma_f32_16x16x32_bf16 v[48:51], v[64:67], v[140:143], v[48:51]
    ds_write_b128 v96, v[24:27] offset:0
    s_waitcnt lgkmcnt(3)
    v_mfma_f32_16x16x32_bf16 v[36:39], v[68:71], v[144:147], v[36:39]
    ds_read_b128 v[52:55], v92 offset:256
    v_mfma_f32_16x16x32_bf16 v[40:43], v[68:71], v[148:151], v[40:43]
    ds_read_b128 v[56:59], v92 offset:16640
    v_mfma_f32_16x16x32_bf16 v[44:47], v[72:75], v[144:147], v[44:47]
    buffer_load_dwordx4 v86, s[60:63], s69 offen offset:2048 lds
    v_mfma_f32_16x16x32_bf16 v[48:51], v[72:75], v[148:151], v[48:51]
    ds_write_b128 v96, v[32:35] offset:1024
    s_waitcnt lgkmcnt(4)
    v_mfma_f32_16x16x32_bf16 v[36:39], v[76:79], v[152:155], v[36:39]
    ds_read_b128 v[60:63], v93 offset:256
    v_mfma_f32_16x16x32_bf16 v[40:43], v[76:79], v[156:159], v[40:43]
    ds_read_b128 v[64:67], v93 offset:16640
    v_mfma_f32_16x16x32_bf16 v[44:47], v[80:83], v[152:155], v[44:47]
    buffer_load_dwordx4 v87, s[60:63], s69 offen offset:3072 lds
    s_add_u32 s69, s69, s3
    v_mfma_f32_16x16x32_bf16 v[48:51], v[80:83], v[156:159], v[48:51]
    s_waitcnt lgkmcnt(3)
    v_mfma_f32_16x16x32_bf16 v[36:39], v[52:55], v[160:163], v[36:39]
    ds_read_b128 v[68:71], v94 offset:256
    v_mfma_f32_16x16x32_bf16 v[40:43], v[52:55], v[164:167], v[40:43]
    ds_read_b128 v[72:75], v94 offset:16640
    v_mfma_f32_16x16x32_bf16 v[44:47], v[56:59], v[160:163], v[44:47]
    v_mfma_f32_16x16x32_bf16 v[48:51], v[56:59], v[164:167], v[48:51]
    s_waitcnt lgkmcnt(2)
    v_mfma_f32_16x16x32_bf16 v[36:39], v[60:63], v[168:171], v[36:39]
    ds_read_b128 v[76:79], v95 offset:256
    v_mfma_f32_16x16x32_bf16 v[40:43], v[60:63], v[172:175], v[40:43]
    ds_read_b128 v[80:83], v95 offset:16640
    v_mfma_f32_16x16x32_bf16 v[44:47], v[64:67], v[168:171], v[44:47]
    v_mfma_f32_16x16x32_bf16 v[48:51], v[64:67], v[172:175], v[48:51]
    s_waitcnt vmcnt(8) lgkmcnt(0)
    s_barrier
    v_mfma_f32_16x16x32_bf16 v[36:39], v[68:71], v[176:179], v[36:39]
    ds_read_b128 v[4:7], v97 offset:0
    ds_read_b128 v[8:11], v97 offset:1024
    ds_read_b128 v[52:55], v92 offset:32768
    v_mfma_f32_16x16x32_bf16 v[40:43], v[68:71], v[180:183], v[40:43]
    ds_read_b128 v[56:59], v92 offset:49152
    v_mfma_f32_16x16x32_bf16 v[44:47], v[72:75], v[176:179], v[44:47]
    v_mfma_f32_16x16x32_bf16 v[48:51], v[72:75], v[180:183], v[48:51]
    s_waitcnt lgkmcnt(2)
    v_mfma_f32_16x16x32_bf16 v[36:39], v[76:79], v[184:187], v[36:39]
    v_add_f32 v4, v4, v20
    v_add_f32 v5, v5, v21
    v_add_f32 v6, v6, v22
    v_add_f32 v7, v7, v23
    ds_read_b128 v[60:63], v93 offset:32768
    v_mfma_f32_16x16x32_bf16 v[40:43], v[76:79], v[188:191], v[40:43]
    v_cvt_pk_bf16_f32 v12, v4, v5
    v_cvt_pk_bf16_f32 v13, v6, v7
    ds_read_b128 v[64:67], v93 offset:49152
    v_mfma_f32_16x16x32_bf16 v[44:47], v[80:83], v[184:187], v[44:47]
    v_add_f32 v8, v8, v28
    v_add_f32 v9, v9, v29
    v_add_f32 v10, v10, v30
    v_add_f32 v11, v11, v31
    v_mfma_f32_16x16x32_bf16 v[48:51], v[80:83], v[188:191], v[48:51]
    v_cvt_pk_bf16_f32 v14, v8, v9
    v_cvt_pk_bf16_f32 v15, v10, v11
    buffer_store_dwordx4 v[12:15], v98, s[8:11], s73 offen sc1
    s_mov_b32 s73, s81
    s_add_u32 s81, s81, s4
    s_waitcnt lgkmcnt(2)
    v_mfma_f32_16x16x32_bf16 v[36:39], v[52:55], v[192:195], v[36:39]
    ds_read_b128 v[68:71], v94 offset:32768
    v_mfma_f32_16x16x32_bf16 v[40:43], v[52:55], v[196:199], v[40:43]
    ds_read_b128 v[72:75], v94 offset:49152
    v_mfma_f32_16x16x32_bf16 v[44:47], v[56:59], v[192:195], v[44:47]
    s_add_u32 m0, s70, 65536
    s_nop 0
    buffer_load_dwordx4 v84, s[60:63], s68 offen offset:0 lds
    v_mfma_f32_16x16x32_bf16 v[48:51], v[56:59], v[196:199], v[48:51]
    s_waitcnt lgkmcnt(2)
    v_mfma_f32_16x16x32_bf16 v[36:39], v[60:63], v[200:203], v[36:39]
    ds_read_b128 v[76:79], v95 offset:32768
    v_mfma_f32_16x16x32_bf16 v[40:43], v[60:63], v[204:207], v[40:43]
    ds_read_b128 v[80:83], v95 offset:49152
    v_mfma_f32_16x16x32_bf16 v[44:47], v[64:67], v[200:203], v[44:47]
    buffer_load_dwordx4 v85, s[60:63], s68 offen offset:1024 lds
    v_mfma_f32_16x16x32_bf16 v[48:51], v[64:67], v[204:207], v[48:51]
    s_waitcnt lgkmcnt(2)
    v_mfma_f32_16x16x32_bf16 v[36:39], v[68:71], v[208:211], v[36:39]
    ds_read_b128 v[52:55], v92 offset:33024
    v_mfma_f32_16x16x32_bf16 v[40:43], v[68:71], v[212:215], v[40:43]
    ds_read_b128 v[56:59], v92 offset:49408
    v_mfma_f32_16x16x32_bf16 v[44:47], v[72:75], v[208:211], v[44:47]
    buffer_load_dwordx4 v86, s[60:63], s68 offen offset:2048 lds
    v_mfma_f32_16x16x32_bf16 v[48:51], v[72:75], v[212:215], v[48:51]
    s_waitcnt lgkmcnt(2)
    v_mfma_f32_16x16x32_bf16 v[36:39], v[76:79], v[216:219], v[36:39]
    ds_read_b128 v[60:63], v93 offset:33024
    v_mfma_f32_16x16x32_bf16 v[40:43], v[76:79], v[220:223], v[40:43]
    ds_read_b128 v[64:67], v93 offset:49408
    v_mfma_f32_16x16x32_bf16 v[44:47], v[80:83], v[216:219], v[44:47]
    buffer_load_dwordx4 v87, s[60:63], s68 offen offset:3072 lds
    s_add_u32 s68, s68, s3
    v_mfma_f32_16x16x32_bf16 v[48:51], v[80:83], v[220:223], v[48:51]
    s_waitcnt lgkmcnt(2)
    v_mfma_f32_16x16x32_bf16 v[36:39], v[52:55], v[224:227], v[36:39]
    ds_read_b128 v[68:71], v94 offset:33024
    v_mfma_f32_16x16x32_bf16 v[40:43], v[52:55], v[228:231], v[40:43]
    ds_read_b128 v[72:75], v94 offset:49408
    v_mfma_f32_16x16x32_bf16 v[44:47], v[56:59], v[224:227], v[44:47]
    v_mfma_f32_16x16x32_bf16 v[48:51], v[56:59], v[228:231], v[48:51]
    s_waitcnt lgkmcnt(2)
    v_mfma_f32_16x16x32_bf16 v[36:39], v[60:63], v[232:235], v[36:39]
    ds_read_b128 v[76:79], v95 offset:33024
    v_mfma_f32_16x16x32_bf16 v[40:43], v[60:63], v[236:239], v[40:43]
    ds_read_b128 v[80:83], v95 offset:49408
    v_mfma_f32_16x16x32_bf16 v[44:47], v[64:67], v[232:235], v[44:47]
    v_mfma_f32_16x16x32_bf16 v[48:51], v[64:67], v[236:239], v[48:51]
    s_bitcmp1_b64 s[6:7], s82
    s_cbranch_scc1 ssig_54
    s_waitcnt vmcnt(8) lgkmcnt(0)
    s_barrier
srett_62:
    s_add_u32 s82, s82, s5
    v_mfma_f32_16x16x32_bf16 v[36:39], v[68:71], v[240:243], v[36:39]
    ds_read_b128 v[52:55], v88 offset:0
    v_mfma_f32_16x16x32_bf16 v[40:43], v[68:71], v[244:247], v[40:43]
    ds_read_b128 v[56:59], v88 offset:16384
    v_mfma_f32_16x16x32_bf16 v[44:47], v[72:75], v[240:243], v[44:47]
    v_mfma_f32_16x16x32_bf16 v[48:51], v[72:75], v[244:247], v[48:51]
    v_mfma_f32_16x16x32_bf16 v[36:39], v[76:79], v[248:251], v[36:39]
    ds_read_b128 v[60:63], v89 offset:0
    v_mfma_f32_16x16x32_bf16 v[40:43], v[76:79], v[252:255], v[40:43]
    ds_read_b128 v[64:67], v89 offset:16384
    v_mfma_f32_16x16x32_bf16 v[44:47], v[80:83], v[248:251], v[44:47]
    v_mfma_f32_16x16x32_bf16 v[48:51], v[80:83], v[252:255], v[48:51]
    s_cmp_lt_u32 s82, 64
    s_cbranch_scc1 stream_73
    s_nop 2
    ds_write_b128 v96, v[40:43] offset:0
    s_nop 1
    ds_write_b128 v96, v[48:51] offset:1024
    s_waitcnt lgkmcnt(0)
    s_barrier
    ds_read_b128 v[4:7], v97 offset:0
    ds_read_b128 v[8:11], v97 offset:1024
    s_waitcnt lgkmcnt(0)
    v_add_f32 v4, v4, v36
    v_add_f32 v5, v5, v37
    v_add_f32 v6, v6, v38
    v_add_f32 v7, v7, v39
    v_cvt_pk_bf16_f32 v12, v4, v5
    v_cvt_pk_bf16_f32 v13, v6, v7
    v_add_f32 v8, v8, v44
    v_add_f32 v9, v9, v45
    v_add_f32 v10, v10, v46
    v_add_f32 v11, v11, v47
    v_cvt_pk_bf16_f32 v14, v8, v9
    v_cvt_pk_bf16_f32 v15, v10, v11
    buffer_store_dwordx4 v[12:15], v98, s[8:11], s73 offen sc1
    s_mov_b32 s73, s81
    s_add_u32 s81, s81, s4
    s_cmp_ge_u32 s57, 24
    s_cbranch_scc1 col_58
send_57:
    s_waitcnt vmcnt(0) lgkmcnt(0)
    s_barrier
    s_cmp_lg_u32 s58, 0
    s_cbranch_scc1 sig_75
    s_cmp_ge_u32 s57, 16
    s_cbranch_scc1 sig_74
    s_bfe_u32 s85, s76, 0x10003
    s_lshl_b32 s85, s85, 2
    s_bfe_u32 s79, s76, 0x30000
    s_lshl_b32 s79, s79, 7
    s_or_b32 s85, s85, s79
    s_bfe_u32 s79, s76, 0x20005
    s_lshl_b32 s79, s79, 10
    s_or_b32 s85, s85, s79
    s_add_u32 s85, s85, 0x5110000
    v_mov_b32 v4, s82
    buffer_store_dword v4, off, s[8:11], s85 sc1
sig_74:
    v_mov_b32 v5, s84
    s_mov_b64 exec, 1
    buffer_atomic_add v5, off, s[12:15], s83 sc1
    s_mov_b64 exec, -1
    s_add_u32 s83, s83, 4
sig_75:
    v_bfe_u32 v2, v1, 4, 2
    v_lshlrev_b32 v2, 2, v2
    v_xor_b32 v2, v2, v1
    v_bfe_u32 v111, v2, 0, 4
    v_lshlrev_b32 v111, 4, v111
    v_bfe_u32 v3, v2, 4, 2
    v_lshl_or_b32 v111, v3, 11, v111
    s_lshl_b32 s63, s75, 3
    s_add_u32 s63, s63, s58
    s_lshl_b32 s5, s63, 13
    s_lshl_b32 s64, s63, 18
    s_bfe_u32 s7, s57, 0x30000
    s_lshl_b32 s7, s7, 8
    s_add_u32 s64, s64, s7
    s_lshl_b32 s66, s58, 14
    s_add_u32 m0, s66, 0
    s_nop 0
    buffer_load_dwordx4 v111, s[32:35], s64 offen lds
    s_add_u32 s64, s64, 0x2000
    s_add_u32 m0, s66, 1024
    s_nop 0
    buffer_load_dwordx4 v111, s[32:35], s64 offen lds
    s_add_u32 s64, s64, 0x2000
    s_add_u32 m0, s66, 2048
    s_nop 0
    buffer_load_dwordx4 v111, s[32:35], s64 offen lds
    s_add_u32 s64, s64, 0x2000
    s_add_u32 m0, s66, 3072
    s_nop 0
    buffer_load_dwordx4 v111, s[32:35], s64 offen lds
    s_add_u32 s64, s64, 0x2000
    s_add_u32 m0, s66, 4096
    s_nop 0
    buffer_load_dwordx4 v111, s[32:35], s64 offen lds
    s_add_u32 s64, s64, 0x2000
    s_add_u32 m0, s66, 5120
    s_nop 0
    buffer_load_dwordx4 v111, s[32:35], s64 offen lds
    s_add_u32 s64, s64, 0x2000
    s_add_u32 m0, s66, 6144
    s_nop 0
    buffer_load_dwordx4 v111, s[32:35], s64 offen lds
    s_add_u32 s64, s64, 0x2000
    s_add_u32 m0, s66, 7168
    s_nop 0
    buffer_load_dwordx4 v111, s[32:35], s64 offen lds
    s_add_u32 s64, s64, 0x2000
    s_add_u32 m0, s66, 8192
    s_nop 0
    buffer_load_dwordx4 v111, s[32:35], s64 offen lds
    s_add_u32 s64, s64, 0x2000
    s_add_u32 m0, s66, 9216
    s_nop 0
    buffer_load_dwordx4 v111, s[32:35], s64 offen lds
    s_add_u32 s64, s64, 0x2000
    s_add_u32 m0, s66, 10240
    s_nop 0
    buffer_load_dwordx4 v111, s[32:35], s64 offen lds
    s_add_u32 s64, s64, 0x2000
    s_add_u32 m0, s66, 11264
    s_nop 0
    buffer_load_dwordx4 v111, s[32:35], s64 offen lds
    s_add_u32 s64, s64, 0x2000
    s_add_u32 m0, s66, 12288
    s_nop 0
    buffer_load_dwordx4 v111, s[32:35], s64 offen lds
    s_add_u32 s64, s64, 0x2000
    s_add_u32 m0, s66, 13312
    s_nop 0
    buffer_load_dwordx4 v111, s[32:35], s64 offen lds
    s_add_u32 s64, s64, 0x2000
    s_add_u32 m0, s66, 14336
    s_nop 0
    buffer_load_dwordx4 v111, s[32:35], s64 offen lds
    s_add_u32 s64, s64, 0x2000
    s_add_u32 m0, s66, 15360
    s_nop 0
    buffer_load_dwordx4 v111, s[32:35], s64 offen lds
    s_add_u32 s64, s64, 0x2000
    buffer_load_dwordx4 v[192:195], v111, s[32:35], s64 offen
    s_add_u32 s64, s64, 0x2000
    buffer_load_dwordx4 v[196:199], v111, s[32:35], s64 offen
    s_add_u32 s64, s64, 0x2000
    buffer_load_dwordx4 v[200:203], v111, s[32:35], s64 offen
    s_add_u32 s64, s64, 0x2000
    buffer_load_dwordx4 v[204:207], v111, s[32:35], s64 offen
    s_add_u32 s64, s64, 0x2000
    buffer_load_dwordx4 v[208:211], v111, s[32:35], s64 offen
    s_add_u32 s64, s64, 0x2000
    buffer_load_dwordx4 v[212:215], v111, s[32:35], s64 offen
    s_add_u32 s64, s64, 0x2000
    buffer_load_dwordx4 v[216:219], v111, s[32:35], s64 offen
    s_add_u32 s64, s64, 0x2000
    buffer_load_dwordx4 v[220:223], v111, s[32:35], s64 offen
    s_add_u32 s64, s64, 0x2000
    buffer_load_dwordx4 v[224:227], v111, s[32:35], s64 offen
    s_add_u32 s64, s64, 0x2000
    buffer_load_dwordx4 v[228:231], v111, s[32:35], s64 offen
    s_add_u32 s64, s64, 0x2000
    buffer_load_dwordx4 v[232:235], v111, s[32:35], s64 offen
    s_add_u32 s64, s64, 0x2000
    buffer_load_dwordx4 v[236:239], v111, s[32:35], s64 offen
    s_add_u32 s64, s64, 0x2000
    buffer_load_dwordx4 v[240:243], v111, s[32:35], s64 offen
    s_add_u32 s64, s64, 0x2000
    buffer_load_dwordx4 v[244:247], v111, s[32:35], s64 offen
    s_add_u32 s64, s64, 0x2000
    buffer_load_dwordx4 v[248:251], v111, s[32:35], s64 offen
    s_add_u32 s64, s64, 0x2000
    buffer_load_dwordx4 v[252:255], v111, s[32:35], s64 offen
    s_add_u32 s64, s64, 0x2000
    v_bfe_u32 v113, v1, 0, 2
    v_lshlrev_b32 v113, 4, v113
    v_bfe_u32 v3, v1, 2, 2
    v_lshl_or_b32 v113, v3, 6, v113
    v_bfe_u32 v3, v1, 2, 2
    v_lshl_or_b32 v113, v3, 8, v113
    v_bfe_u32 v3, v1, 4, 1
    v_lshl_or_b32 v113, v3, 10, v113
    v_bfe_u32 v3, v1, 5, 1
    v_lshl_or_b32 v113, v3, 12, v113
    s_bfe_u32 s63, s58, 0x20000
    s_lshl_b32 s63, s63, 6
    s_bfe_u32 s70, s58, 0x10002
    s_lshl_b32 s70, s70, 16
    s_or_b32 s63, s63, s70
    v_xor_b32 v113, s63, v113
    v_lshl_add_u32 v112, v1, 4, s66
    s_waitcnt vmcnt(16)
    s_barrier
    ds_read_b64_tr_b16 v[128:129], v113 offset:0
    ds_read_b64_tr_b16 v[130:131], v113 offset:2048
    ds_read_b64_tr_b16 v[132:133], v113 offset:8
    ds_read_b64_tr_b16 v[134:135], v113 offset:2056
    ds_read_b64_tr_b16 v[136:137], v113 offset:8192
    ds_read_b64_tr_b16 v[138:139], v113 offset:10240
    ds_read_b64_tr_b16 v[140:141], v113 offset:8200
    ds_read_b64_tr_b16 v[142:143], v113 offset:10248
    s_waitcnt lgkmcnt(4)
    ds_read_b64_tr_b16 v[144:145], v113 offset:16384
    ds_read_b64_tr_b16 v[146:147], v113 offset:18432
    ds_read_b64_tr_b16 v[148:149], v113 offset:16392
    ds_read_b64_tr_b16 v[150:151], v113 offset:18440
    ds_read_b64_tr_b16 v[152:153], v113 offset:24576
    ds_read_b64_tr_b16 v[154:155], v113 offset:26624
    ds_read_b64_tr_b16 v[156:157], v113 offset:24584
    ds_read_b64_tr_b16 v[158:159], v113 offset:26632
    s_waitcnt lgkmcnt(4)
    ds_read_b64_tr_b16 v[160:161], v113 offset:32768
    ds_read_b64_tr_b16 v[162:163], v113 offset:34816
    ds_read_b64_tr_b16 v[164:165], v113 offset:32776
    ds_read_b64_tr_b16 v[166:167], v113 offset:34824
    ds_read_b64_tr_b16 v[168:169], v113 offset:40960
    ds_read_b64_tr_b16 v[170:171], v113 offset:43008
    ds_read_b64_tr_b16 v[172:173], v113 offset:40968
    ds_read_b64_tr_b16 v[174:175], v113 offset:43016
    s_waitcnt lgkmcnt(4)
    ds_read_b64_tr_b16 v[176:177], v113 offset:49152
    ds_read_b64_tr_b16 v[178:179], v113 offset:51200
    ds_read_b64_tr_b16 v[180:181], v113 offset:49160
    ds_read_b64_tr_b16 v[182:183], v113 offset:51208
    ds_read_b64_tr_b16 v[184:185], v113 offset:57344
    ds_read_b64_tr_b16 v[186:187], v113 offset:59392
    ds_read_b64_tr_b16 v[188:189], v113 offset:57352
    ds_read_b64_tr_b16 v[190:191], v113 offset:59400
    s_waitcnt lgkmcnt(0)
    s_barrier
    s_waitcnt vmcnt(15)
    ds_write_b128 v112, v[192:195] offset:0
    s_waitcnt vmcnt(14)
    ds_write_b128 v112, v[196:199] offset:1024
    s_waitcnt vmcnt(13)
    ds_write_b128 v112, v[200:203] offset:2048
    s_waitcnt vmcnt(12)
    ds_write_b128 v112, v[204:207] offset:3072
    s_waitcnt vmcnt(11)
    ds_write_b128 v112, v[208:211] offset:4096
    s_waitcnt vmcnt(10)
    ds_write_b128 v112, v[212:215] offset:5120
    s_waitcnt vmcnt(9)
    ds_write_b128 v112, v[216:219] offset:6144
    s_waitcnt vmcnt(8)
    ds_write_b128 v112, v[220:223] offset:7168
    s_waitcnt vmcnt(7)
    ds_write_b128 v112, v[224:227] offset:8192
    s_waitcnt vmcnt(6)
    ds_write_b128 v112, v[228:231] offset:9216
    s_waitcnt vmcnt(5)
    ds_write_b128 v112, v[232:235] offset:10240
    s_waitcnt vmcnt(4)
    ds_write_b128 v112, v[236:239] offset:11264
    s_waitcnt vmcnt(3)
    ds_write_b128 v112, v[240:243] offset:12288
    s_waitcnt vmcnt(2)
    ds_write_b128 v112, v[244:247] offset:13312
    s_waitcnt vmcnt(1)
    ds_write_b128 v112, v[248:251] offset:14336
    s_waitcnt vmcnt(0)
    ds_write_b128 v112, v[252:255] offset:15360
    s_cmp_lg_u32 s58, 0
    s_cbranch_scc1 wall_76
    v_mov_b32 v3, 136
wctr_77:
    buffer_load_dword v2, v3, s[12:15], 0 offen sc1
    s_waitcnt vmcnt(0)
    v_cmp_ne_u32 vcc, 2097216, v2
    s_cbranch_vccz wctr_ok_78
    s_sub_u32 s77, s77, 1
    s_cbranch_scc0 wctr_77
    s_mov_b32 s77, 0
wctr_ok_78:
wall_76:
    s_waitcnt lgkmcnt(0)
    s_barrier
    ds_read_b64_tr_b16 v[192:193], v113 offset:0
    ds_read_b64_tr_b16 v[194:195], v113 offset:2048
    ds_read_b64_tr_b16 v[196:197], v113 offset:8
    ds_read_b64_tr_b16 v[198:199], v113 offset:2056
    ds_read_b64_tr_b16 v[200:201], v113 offset:8192
    ds_read_b64_tr_b16 v[202:203], v113 offset:10240
    ds_read_b64_tr_b16 v[204:205], v113 offset:8200
    ds_read_b64_tr_b16 v[206:207], v113 offset:10248
    s_waitcnt lgkmcnt(4)
    ds_read_b64_tr_b16 v[208:209], v113 offset:16384
    ds_read_b64_tr_b16 v[210:211], v113 offset:18432
    ds_read_b64_tr_b16 v[212:213], v113 offset:16392
    ds_read_b64_tr_b16 v[214:215], v113 offset:18440
    ds_read_b64_tr_b16 v[216:217], v113 offset:24576
    ds_read_b64_tr_b16 v[218:219], v113 offset:26624
    ds_read_b64_tr_b16 v[220:221], v113 offset:24584
    ds_read_b64_tr_b16 v[222:223], v113 offset:26632
    s_waitcnt lgkmcnt(4)
    ds_read_b64_tr_b16 v[224:225], v113 offset:32768
    ds_read_b64_tr_b16 v[226:227], v113 offset:34816
    ds_read_b64_tr_b16 v[228:229], v113 offset:32776
    ds_read_b64_tr_b16 v[230:231], v113 offset:34824
    ds_read_b64_tr_b16 v[232:233], v113 offset:40960
    ds_read_b64_tr_b16 v[234:235], v113 offset:43008
    ds_read_b64_tr_b16 v[236:237], v113 offset:40968
    ds_read_b64_tr_b16 v[238:239], v113 offset:43016
    s_waitcnt lgkmcnt(4)
    ds_read_b64_tr_b16 v[240:241], v113 offset:49152
    ds_read_b64_tr_b16 v[242:243], v113 offset:51200
    ds_read_b64_tr_b16 v[244:245], v113 offset:49160
    ds_read_b64_tr_b16 v[246:247], v113 offset:51208
    ds_read_b64_tr_b16 v[248:249], v113 offset:57344
    ds_read_b64_tr_b16 v[250:251], v113 offset:59392
    ds_read_b64_tr_b16 v[252:253], v113 offset:57352
    ds_read_b64_tr_b16 v[254:255], v113 offset:59400
    s_waitcnt lgkmcnt(0)
    s_barrier
    s_add_u32 s5, s5, 0x3000000
    s_lshl_b32 s6, s75, 7
    s_add_u32 s6, s6, 0x5100000
    s_lshl_b32 s66, s58, 12
    v_lshlrev_b32 v115, 4, v1
    s_bfe_u32 s63, s58, 0x10002
    s_lshl_b32 s63, s63, 8
    v_xor_b32 v111, s63, v115
    v_bfe_u32 v108, v1, 0, 4
    v_lshlrev_b32 v108, 4, v108
    v_bfe_u32 v2, v1, 4, 2
    v_lshl_or_b32 v108, v2, 9, v108
    v_lshl_or_b32 v108, s63, 6, v108
    v_xor_b32 v109, 0x10000, v108
    s_lshl_b32 s63, s58, 11
    s_or_b32 s63, s63, 131072
    v_add_u32 v112, s63, v115
    v_xor_b32 v113, 0x2000, v112
    v_bfe_u32 v114, v1, 4, 2
    v_lshlrev_b32 v114, 4, v114
    v_bfe_u32 v2, v1, 0, 4
    v_lshl_or_b32 v114, v2, 12, v114
    s_bfe_u32 s63, s58, 0x20000
    s_lshl_b32 s63, s63, 6
    s_bfe_u32 s70, s58, 0x10002
    s_lshl_b32 s70, s70, 16
    s_or_b32 s63, s63, s70
    s_add_u32 s7, s7, s63
    s_bfe_u32 s69, s57, 0x30000
    s_lshl_b32 s69, s69, 16
    s_bfe_u32 s63, s57, 0x20003
    s_lshl_b32 s63, s63, 21
    s_or_b32 s69, s69, s63
    s_lshl_b32 s63, s58, 13
    s_add_u32 s69, s69, s63
    s_add_u32 s69, s69, 0x6000000
    s_lshl_b32 s63, s75, 11
    s_add_u32 s69, s69, s63
    s_xor_b32 s2, s69, 2048
    s_xor_b32 s3, s69, 4096
    s_xor_b32 s4, s69, 6144
    s_lshr_b32 s63, s58, 1
    s_xor_b32 s74, s63, s75
    s_mov_b32 s60, 0x49249249
    s_mov_b32 s61, 0x92492492
    s_lshr_b32 s63, s57, 3
    s_lshl_b64 s[60:61], s[60:61], s63
    v_bfe_u32 v117, v1, 0, 3
    v_lshlrev_b32 v117, 2, v117
    v_mov_b32 v119, 163744
    s_mov_b32 s70, 0
    v_mov_b32 v116, v115
    s_ff1_i32_b64 s62, s[60:61]
    s_bitset0_b64 s[60:61], s62
    s_lshl_b32 s65, s62, 9
    s_add_u32 s65, s65, s6
wo_slow_79:
    s_lshl_b32 s63, s58, 2
    s_add_u32 s65, s65, s63
pollfl_84:
    buffer_load_dword v110, off, s[8:11], s65 sc1
    s_waitcnt vmcnt(0)
    v_cmp_eq_u32 vcc, 0, v110
    s_cbranch_vccz pollfl_ok_85
    s_sub_u32 s77, s77, 1
    s_cbranch_scc0 pollfl_84
    s_mov_b32 s77, 0
pollfl_ok_85:
    s_mov_b32 s72, s62
    s_lshl_b32 s64, s62, 18
    s_add_u32 s64, s64, s5
    s_ff1_i32_b64 s62, s[60:61]
    s_bitset0_b64 s[60:61], s62
    s_lshl_b32 s65, s62, 9
    s_add_u32 s65, s65, s6
    s_add_u32 m0, s66, 0
    s_nop 0
    buffer_load_dwordx4 v111, s[8:11], s64 offen offset:0 sc1 lds
    buffer_load_dwordx4 v111, s[8:11], s64 offen offset:1024 sc1 lds
    buffer_load_dwordx4 v111, s[8:11], s64 offen offset:2048 sc1 lds
    buffer_load_dwordx4 v111, s[8:11], s64 offen offset:3072 sc1 lds
    s_add_u32 s64, s64, 4096
    buffer_load_dword v110, v117, s[8:11], s65 offen sc1
    s_add_u32 m0, s66, 32768
    s_nop 0
    buffer_load_dwordx4 v111, s[8:11], s64 offen offset:0 sc1 lds
    buffer_load_dwordx4 v111, s[8:11], s64 offen offset:1024 sc1 lds
    buffer_load_dwordx4 v111, s[8:11], s64 offen offset:2048 sc1 lds
    buffer_load_dwordx4 v111, s[8:11], s64 offen offset:3072 sc1 lds
    s_add_u32 s64, s64, 4096
    s_mov_b32 s59, -1
    s_mov_b32 s67, -1
    s_waitcnt vmcnt(4)
    s_cmp_lg_u32 s58, 0
    s_cbranch_scc1 wo_v_86
    v_cmp_eq_u32 vcc, 0, v110
    s_nop 1
    v_mov_b32 v118, vcc_lo
    ds_write_b32 v119, v118
wo_v_86:
    s_waitcnt lgkmcnt(0)
    s_barrier
    ds_read_b32 v118, v119
    ds_read_b128 v[44:47], v108 offset:0
    ds_read_b128 v[48:51], v108 offset:256
    ds_read_b128 v[52:55], v108 offset:2048
    ds_read_b128 v[56:59], v108 offset:2304
wo_loop_80:
    s_waitcnt lgkmcnt(2)
    v_mfma_f32_16x16x32_bf16 v[12:15], v[128:131], v[44:47], 0
    ds_read_b128 v[60:63], v108 offset:4096
    v_mfma_f32_16x16x32_bf16 v[16:19], v[132:135], v[44:47], 0
    ds_read_b128 v[64:67], v108 offset:4352
    v_readfirstlane_b32 s68, v118
    s_mov_b32 s73, s59
    s_mov_b32 s59, s72
    s_mov_b32 s64, 0x5ffffff0
    s_lshr_b32 s63, s62, 31
    s_or_b32 s68, s68, s63
    s_cbranch_scc1 wo_np_87
    s_mov_b32 s72, s62
    s_lshl_b32 s64, s62, 18
    s_add_u32 s64, s64, s5
    s_ff1_i32_b64 s62, s[60:61]
    s_bitset0_b64 s[60:61], s62
    s_lshl_b32 s65, s62, 9
    s_add_u32 s65, s65, s6
wo_np_87:
    v_mfma_f32_16x16x32_bf16 v[20:23], v[128:131], v[48:51], 0
    s_add_u32 m0, s66, 65536
    s_nop 0
    buffer_load_dwordx4 v111, s[8:11], s64 offen offset:0 sc1 lds
    v_mfma_f32_16x16x32_bf16 v[24:27], v[132:135], v[48:51], 0
    s_waitcnt lgkmcnt(2)
    v_mfma_f32_16x16x32_bf16 v[12:15], v[136:139], v[52:55], v[12:15]
    ds_read_b128 v[68:71], v108 offset:6144
    v_mfma_f32_16x16x32_bf16 v[16:19], v[140:143], v[52:55], v[16:19]
    ds_read_b128 v[72:75], v108 offset:6400
    v_mfma_f32_16x16x32_bf16 v[20:23], v[136:139], v[56:59], v[20:23]
    buffer_load_dwordx4 v111, s[8:11], s64 offen offset:1024 sc1 lds
    v_mfma_f32_16x16x32_bf16 v[24:27], v[140:143], v[56:59], v[24:27]
    ds_write_b128 v112, v[36:39] offset:0
    s_waitcnt lgkmcnt(3)
    v_mfma_f32_16x16x32_bf16 v[12:15], v[144:147], v[60:63], v[12:15]
    ds_read_b128 v[44:47], v108 offset:8192
    v_mfma_f32_16x16x32_bf16 v[16:19], v[148:151], v[60:63], v[16:19]
    ds_read_b128 v[48:51], v108 offset:8448
    v_mfma_f32_16x16x32_bf16 v[20:23], v[144:147], v[64:67], v[20:23]
    buffer_load_dwordx4 v111, s[8:11], s64 offen offset:2048 sc1 lds
    v_mfma_f32_16x16x32_bf16 v[24:27], v[148:151], v[64:67], v[24:27]
    ds_write_b128 v112, v[40:43] offset:1024
    s_waitcnt lgkmcnt(4)
    v_mfma_f32_16x16x32_bf16 v[12:15], v[152:155], v[68:71], v[12:15]
    ds_read_b128 v[52:55], v108 offset:10240
    v_mfma_f32_16x16x32_bf16 v[16:19], v[156:159], v[68:71], v[16:19]
    ds_read_b128 v[56:59], v108 offset:10496
    v_mfma_f32_16x16x32_bf16 v[20:23], v[152:155], v[72:75], v[20:23]
    buffer_load_dwordx4 v111, s[8:11], s64 offen offset:3072 sc1 lds
    s_add_u32 s64, s64, 4096
    v_mfma_f32_16x16x32_bf16 v[24:27], v[156:159], v[72:75], v[24:27]
    s_waitcnt lgkmcnt(3)
    v_mfma_f32_16x16x32_bf16 v[12:15], v[160:163], v[44:47], v[12:15]
    ds_read_b128 v[60:63], v108 offset:12288
    v_mfma_f32_16x16x32_bf16 v[16:19], v[164:167], v[44:47], v[16:19]
    ds_read_b128 v[64:67], v108 offset:12544
    v_mfma_f32_16x16x32_bf16 v[20:23], v[160:163], v[48:51], v[20:23]
    v_mfma_f32_16x16x32_bf16 v[24:27], v[164:167], v[48:51], v[24:27]
    s_waitcnt lgkmcnt(2)
    v_mfma_f32_16x16x32_bf16 v[12:15], v[168:171], v[52:55], v[12:15]
    ds_read_b128 v[68:71], v108 offset:14336
    v_mfma_f32_16x16x32_bf16 v[16:19], v[172:175], v[52:55], v[16:19]
    ds_read_b128 v[72:75], v108 offset:14592
    v_mfma_f32_16x16x32_bf16 v[20:23], v[168:171], v[56:59], v[20:23]
    v_mfma_f32_16x16x32_bf16 v[24:27], v[172:175], v[56:59], v[24:27]
    s_lshr_b32 s63, s67, 31
    s_or_b32 s63, s63, s74
    s_cbranch_scc0 wo_w_88
    s_waitcnt vmcnt(4)
wo_w_88:
    s_waitcnt vmcnt(10) lgkmcnt(0)
    s_barrier
    v_mfma_f32_16x16x32_bf16 v[12:15], v[176:179], v[60:63], v[12:15]
    ds_read_b128 v[4:7], v113 offset:0
    ds_read_b128 v[8:11], v113 offset:1024
    ds_read_b128 v[44:47], v108 offset:32768
    v_mfma_f32_16x16x32_bf16 v[16:19], v[180:183], v[60:63], v[16:19]
    ds_read_b128 v[48:51], v108 offset:33024
    v_mfma_f32_16x16x32_bf16 v[20:23], v[176:179], v[64:67], v[20:23]
    v_mfma_f32_16x16x32_bf16 v[24:27], v[180:183], v[64:67], v[24:27]
    s_waitcnt lgkmcnt(2)
    v_mfma_f32_16x16x32_bf16 v[12:15], v[184:187], v[68:71], v[12:15]
    ds_read_b128 v[52:55], v108 offset:34816
    v_mfma_f32_16x16x32_bf16 v[16:19], v[188:191], v[68:71], v[16:19]
    ds_read_b128 v[56:59], v108 offset:35072
    v_mfma_f32_16x16x32_bf16 v[20:23], v[184:187], v[72:75], v[20:23]
    v_mfma_f32_16x16x32_bf16 v[24:27], v[188:191], v[72:75], v[24:27]
    s_cmp_lt_i32 s73, 0
    s_cbranch_scc1 wo_e_92
    s_cmp_lg_u32 s74, 0
    s_cbranch_scc1 wo_k_90
    s_cmp_lt_i32 s67, 0
    s_cbranch_scc1 wo_k_90
    s_waitcnt vmcnt(4)
    v_bitop3_b32 v2, v84, v88, s71 bitop3:0x7e
    v_bitop3_b32 v3, v92, v96, s71 bitop3:0x7e
    v_or_b32 v2, v2, v3
    v_bitop3_b32 v3, v100, v104, s71 bitop3:0x7e
    v_bitop3_b32 v2, v2, v3, 1 bitop3:0xa8
    v_cmp_ne_u32 vcc, 0, v2
    s_cbranch_vccz pollpart_ok_94
pollpart_93:
    buffer_load_dwordx4 v[84:87], v116, s[8:11], s2 offen offset:0 sc1
    buffer_load_dwordx4 v[88:91], v116, s[8:11], s2 offen offset:1024 sc1
    buffer_load_dwordx4 v[92:95], v116, s[8:11], s3 offen offset:0 sc1
    buffer_load_dwordx4 v[96:99], v116, s[8:11], s3 offen offset:1024 sc1
    buffer_load_dwordx4 v[100:103], v116, s[8:11], s4 offen offset:0 sc1
    buffer_load_dwordx4 v[104:107], v116, s[8:11], s4 offen offset:1024 sc1
    s_waitcnt vmcnt(0)
    v_bitop3_b32 v2, v84, v88, s71 bitop3:0x7e
    v_bitop3_b32 v3, v92, v96, s71 bitop3:0x7e
    v_or_b32 v2, v2, v3
    v_bitop3_b32 v3, v100, v104, s71 bitop3:0x7e
    v_bitop3_b32 v2, v2, v3, 1 bitop3:0xa8
    v_cmp_ne_u32 vcc, 0, v2
    s_cbranch_vccz pollpart_ok_94
    s_sub_u32 s77, s77, 1
    s_cbranch_scc0 pollpart_93
    s_mov_b32 s77, 0
pollpart_ok_94:
    v_pk_add_f32 v[76:77], v[76:77], v[84:85]
    v_pk_add_f32 v[92:93], v[92:93], v[100:101]
    v_pk_add_f32 v[76:77], v[76:77], v[92:93]
    v_cvt_pk_bf16_f32 v84, v76, v77
    v_pk_add_f32 v[78:79], v[78:79], v[86:87]
    v_pk_add_f32 v[94:95], v[94:95], v[102:103]
    v_pk_add_f32 v[78:79], v[78:79], v[94:95]
    v_cvt_pk_bf16_f32 v85, v78, v79
    v_pk_add_f32 v[80:81], v[80:81], v[88:89]
    v_pk_add_f32 v[96:97], v[96:97], v[104:105]
    v_pk_add_f32 v[80:81], v[80:81], v[96:97]
    v_cvt_pk_bf16_f32 v86, v80, v81
    v_pk_add_f32 v[82:83], v[82:83], v[90:91]
    v_pk_add_f32 v[98:99], v[98:99], v[106:107]
    v_pk_add_f32 v[82:83], v[82:83], v[98:99]
    v_cvt_pk_bf16_f32 v87, v82, v83
    buffer_store_dwordx4 v[84:87], v114, s[16:19], s67 offen offset:2048
wo_k_90:
    s_bfe_u32 s71, s70, 0x10002
    s_add_u32 s70, s70, 1
    v_pk_add_f32 v[76:77], v[4:5], v[28:29]
    v_pk_add_f32 v[78:79], v[6:7], v[30:31]
    v_pk_add_f32 v[80:81], v[8:9], v[32:33]
    v_pk_add_f32 v[82:83], v[10:11], v[34:35]
    v_mov_b32 v116, v115
    s_lshl_b32 s67, s73, 17
    s_add_u32 s67, s67, s7
    s_cmp_eq_u32 s74, 0
    s_cbranch_scc1 wo_j_91
    v_bfi_b32 v76, 1, s71, v76
    buffer_store_dwordx4 v[76:79], v116, s[8:11], s69 offen offset:0 sc1
    v_bfi_b32 v80, 1, s71, v80
    buffer_store_dwordx4 v[80:83], v116, s[8:11], s69 offen offset:1024 sc1
wo_j_91:
    v_add_u32 v115, 0x80000, v115
    v_and_b32 v115, 0x1fffff, v115
wo_e_92:
    buffer_load_dword v110, v117, s[8:11], s65 offen sc1
    s_waitcnt lgkmcnt(2)
    v_mfma_f32_16x16x32_bf16 v[12:15], v[192:195], v[44:47], v[12:15]
    ds_read_b128 v[60:63], v108 offset:36864
    v_mfma_f32_16x16x32_bf16 v[16:19], v[196:199], v[44:47], v[16:19]
    ds_read_b128 v[64:67], v108 offset:37120
    v_mfma_f32_16x16x32_bf16 v[20:23], v[192:195], v[48:51], v[20:23]
    s_add_u32 m0, s66, 98304
    s_nop 0
    buffer_load_dwordx4 v111, s[8:11], s64 offen offset:0 sc1 lds
    v_mfma_f32_16x16x32_bf16 v[24:27], v[196:199], v[48:51], v[24:27]
    s_waitcnt lgkmcnt(2)
    v_mfma_f32_16x16x32_bf16 v[12:15], v[200:203], v[52:55], v[12:15]
    ds_read_b128 v[68:71], v108 offset:38912
    v_mfma_f32_16x16x32_bf16 v[16:19], v[204:207], v[52:55], v[16:19]
    ds_read_b128 v[72:75], v108 offset:39168
    v_mfma_f32_16x16x32_bf16 v[20:23], v[200:203], v[56:59], v[20:23]
    buffer_load_dwordx4 v111, s[8:11], s64 offen offset:1024 sc1 lds
    v_mfma_f32_16x16x32_bf16 v[24:27], v[204:207], v[56:59], v[24:27]
    s_waitcnt lgkmcnt(2)
    v_mfma_f32_16x16x32_bf16 v[12:15], v[208:211], v[60:63], v[12:15]
    ds_read_b128 v[44:47], v108 offset:40960
    v_mfma_f32_16x16x32_bf16 v[16:19], v[212:215], v[60:63], v[16:19]
    ds_read_b128 v[48:51], v108 offset:41216
    v_mfma_f32_16x16x32_bf16 v[20:23], v[208:211], v[64:67], v[20:23]
    buffer_load_dwordx4 v111, s[8:11], s64 offen offset:2048 sc1 lds
    v_mfma_f32_16x16x32_bf16 v[24:27], v[212:215], v[64:67], v[24:27]
    s_waitcnt lgkmcnt(2)
    v_mfma_f32_16x16x32_bf16 v[12:15], v[216:219], v[68:71], v[12:15]
    ds_read_b128 v[52:55], v108 offset:43008
    v_mfma_f32_16x16x32_bf16 v[16:19], v[220:223], v[68:71], v[16:19]
    ds_read_b128 v[56:59], v108 offset:43264
    v_mfma_f32_16x16x32_bf16 v[20:23], v[216:219], v[72:75], v[20:23]
    buffer_load_dwordx4 v111, s[8:11], s64 offen offset:3072 sc1 lds
    s_add_u32 s64, s64, 4096
    v_mfma_f32_16x16x32_bf16 v[24:27], v[220:223], v[72:75], v[24:27]
    s_waitcnt lgkmcnt(2)
    v_mfma_f32_16x16x32_bf16 v[12:15], v[224:227], v[44:47], v[12:15]
    ds_read_b128 v[60:63], v108 offset:45056
    v_mfma_f32_16x16x32_bf16 v[16:19], v[228:231], v[44:47], v[16:19]
    ds_read_b128 v[64:67], v108 offset:45312
    v_mfma_f32_16x16x32_bf16 v[20:23], v[224:227], v[48:51], v[20:23]
    v_mfma_f32_16x16x32_bf16 v[24:27], v[228:231], v[48:51], v[24:27]
    s_waitcnt lgkmcnt(2)
    v_mfma_f32_16x16x32_bf16 v[12:15], v[232:235], v[52:55], v[12:15]
    ds_read_b128 v[68:71], v108 offset:47104
    v_mfma_f32_16x16x32_bf16 v[16:19], v[236:239], v[52:55], v[16:19]
    ds_read_b128 v[72:75], v108 offset:47360
    v_mfma_f32_16x16x32_bf16 v[20:23], v[232:235], v[56:59], v[20:23]
    v_mfma_f32_16x16x32_bf16 v[24:27], v[236:239], v[56:59], v[24:27]
    s_waitcnt vmcnt(4)
    s_cmp_lg_u32 s58, 0
    s_cbranch_scc1 wo_v_95
    v_cmp_eq_u32 vcc, 0, v110
    s_nop 1
    v_mov_b32 v118, vcc_lo
    ds_write_b32 v119, v118
wo_v_95:
    s_waitcnt lgkmcnt(0)
    s_barrier
    v_mfma_f32_16x16x32_bf16 v[12:15], v[240:243], v[60:63], v[12:15]
    ds_read_b32 v118, v119
    ds_read_b128 v[44:47], v109 offset:0
    v_mfma_f32_16x16x32_bf16 v[16:19], v[244:247], v[60:63], v[16:19]
    ds_read_b128 v[48:51], v109 offset:256
    v_mfma_f32_16x16x32_bf16 v[20:23], v[240:243], v[64:67], v[20:23]
    v_mfma_f32_16x16x32_bf16 v[24:27], v[244:247], v[64:67], v[24:27]
    s_lshr_b32 s63, s67, 31
    s_or_b32 s63, s63, s74
    s_cbranch_scc1 wo_g_96
    buffer_load_dwordx4 v[84:87], v116, s[8:11], s2 offen offset:0 sc1
    buffer_load_dwordx4 v[88:91], v116, s[8:11], s2 offen offset:1024 sc1
    buffer_load_dwordx4 v[92:95], v116, s[8:11], s3 offen offset:0 sc1
    buffer_load_dwordx4 v[96:99], v116, s[8:11], s3 offen offset:1024 sc1
    buffer_load_dwordx4 v[100:103], v116, s[8:11], s4 offen offset:0 sc1
    buffer_load_dwordx4 v[104:107], v116, s[8:11], s4 offen offset:1024 sc1
wo_g_96:
    v_mfma_f32_16x16x32_bf16 v[12:15], v[248:251], v[68:71], v[12:15]
    ds_read_b128 v[52:55], v109 offset:2048
    v_mfma_f32_16x16x32_bf16 v[16:19], v[252:255], v[68:71], v[16:19]
    ds_read_b128 v[56:59], v109 offset:2304
    v_mfma_f32_16x16x32_bf16 v[20:23], v[248:251], v[72:75], v[20:23]
    v_mfma_f32_16x16x32_bf16 v[24:27], v[252:255], v[72:75], v[24:27]
    s_cmp_eq_u32 s68, 0
    s_cbranch_scc0 wo_f0_82
    s_waitcnt lgkmcnt(2)
    v_mfma_f32_16x16x32_bf16 v[28:31], v[128:131], v[44:47], 0
    ds_read_b128 v[60:63], v109 offset:4096
    v_mfma_f32_16x16x32_bf16 v[32:35], v[132:135], v[44:47], 0
    ds_read_b128 v[64:67], v109 offset:4352
    v_readfirstlane_b32 s68, v118
    s_mov_b32 s73, s59
    s_mov_b32 s59, s72
    s_mov_b32 s64, 0x5ffffff0
    s_lshr_b32 s63, s62, 31
    s_or_b32 s68, s68, s63
    s_cbranch_scc1 wo_np_97
    s_mov_b32 s72, s62
    s_lshl_b32 s64, s62, 18
    s_add_u32 s64, s64, s5
    s_ff1_i32_b64 s62, s[60:61]
    s_bitset0_b64 s[60:61], s62
    s_lshl_b32 s65, s62, 9
    s_add_u32 s65, s65, s6
wo_np_97:
    v_mfma_f32_16x16x32_bf16 v[36:39], v[128:131], v[48:51], 0
    s_add_u32 m0, s66, 0
    s_nop 0
    buffer_load_dwordx4 v111, s[8:11], s64 offen offset:0 sc1 lds
    v_mfma_f32_16x16x32_bf16 v[40:43], v[132:135], v[48:51], 0
    s_waitcnt lgkmcnt(2)
    v_mfma_f32_16x16x32_bf16 v[28:31], v[136:139], v[52:55], v[28:31]
    ds_read_b128 v[68:71], v109 offset:6144
    v_mfma_f32_16x16x32_bf16 v[32:35], v[140:143], v[52:55], v[32:35]
    ds_read_b128 v[72:75], v109 offset:6400
    v_mfma_f32_16x16x32_bf16 v[36:39], v[136:139], v[56:59], v[36:39]
    buffer_load_dwordx4 v111, s[8:11], s64 offen offset:1024 sc1 lds
    v_mfma_f32_16x16x32_bf16 v[40:43], v[140:143], v[56:59], v[40:43]
    ds_write_b128 v112, v[20:23] offset:0
    s_waitcnt lgkmcnt(3)
    v_mfma_f32_16x16x32_bf16 v[28:31], v[144:147], v[60:63], v[28:31]
    ds_read_b128 v[44:47], v109 offset:8192
    v_mfma_f32_16x16x32_bf16 v[32:35], v[148:151], v[60:63], v[32:35]
    ds_read_b128 v[48:51], v109 offset:8448
    v_mfma_f32_16x16x32_bf16 v[36:39], v[144:147], v[64:67], v[36:39]
    buffer_load_dwordx4 v111, s[8:11], s64 offen offset:2048 sc1 lds
    v_mfma_f32_16x16x32_bf16 v[40:43], v[148:151], v[64:67], v[40:43]
    ds_write_b128 v112, v[24:27] offset:1024
    s_waitcnt lgkmcnt(4)
    v_mfma_f32_16x16x32_bf16 v[28:31], v[152:155], v[68:71], v[28:31]
    ds_read_b128 v[52:55], v109 offset:10240
    v_mfma_f32_16x16x32_bf16 v[32:35], v[156:159], v[68:71], v[32:35]
    ds_read_b128 v[56:59], v109 offset:10496
    v_mfma_f32_16x16x32_bf16 v[36:39], v[152:155], v[72:75], v[36:39]
    buffer_load_dwordx4 v111, s[8:11], s64 offen offset:3072 sc1 lds
    s_add_u32 s64, s64, 4096
    v_mfma_f32_16x16x32_bf16 v[40:43], v[156:159], v[72:75], v[40:43]
    s_waitcnt lgkmcnt(3)
    v_mfma_f32_16x16x32_bf16 v[28:31], v[160:163], v[44:47], v[28:31]
    ds_read_b128 v[60:63], v109 offset:12288
    v_mfma_f32_16x16x32_bf16 v[32:35], v[164:167], v[44:47], v[32:35]
    ds_read_b128 v[64:67], v109 offset:12544
    v_mfma_f32_16x16x32_bf16 v[36:39], v[160:163], v[48:51], v[36:39]
    v_mfma_f32_16x16x32_bf16 v[40:43], v[164:167], v[48:51], v[40:43]
    s_waitcnt lgkmcnt(2)
    v_mfma_f32_16x16x32_bf16 v[28:31], v[168:171], v[52:55], v[28:31]
    ds_read_b128 v[68:71], v109 offset:14336
    v_mfma_f32_16x16x32_bf16 v[32:35], v[172:175], v[52:55], v[32:35]
    ds_read_b128 v[72:75], v109 offset:14592
    v_mfma_f32_16x16x32_bf16 v[36:39], v[168:171], v[56:59], v[36:39]
    v_mfma_f32_16x16x32_bf16 v[40:43], v[172:175], v[56:59], v[40:43]
    s_lshr_b32 s63, s67, 31
    s_or_b32 s63, s63, s74
    s_cbranch_scc0 wo_w_98
    s_waitcnt vmcnt(4)
wo_w_98:
    s_waitcnt vmcnt(10) lgkmcnt(0)
    s_barrier
    v_mfma_f32_16x16x32_bf16 v[28:31], v[176:179], v[60:63], v[28:31]
    ds_read_b128 v[4:7], v113 offset:0
    ds_read_b128 v[8:11], v113 offset:1024
    ds_read_b128 v[44:47], v109 offset:32768
    v_mfma_f32_16x16x32_bf16 v[32:35], v[180:183], v[60:63], v[32:35]
    ds_read_b128 v[48:51], v109 offset:33024
    v_mfma_f32_16x16x32_bf16 v[36:39], v[176:179], v[64:67], v[36:39]
    v_mfma_f32_16x16x32_bf16 v[40:43], v[180:183], v[64:67], v[40:43]
    s_waitcnt lgkmcnt(2)
    v_mfma_f32_16x16x32_bf16 v[28:31], v[184:187], v[68:71], v[28:31]
    ds_read_b128 v[52:55], v109 offset:34816
    v_mfma_f32_16x16x32_bf16 v[32:35], v[188:191], v[68:71], v[32:35]
    ds_read_b128 v[56:59], v109 offset:35072
    v_mfma_f32_16x16x32_bf16 v[36:39], v[184:187], v[72:75], v[36:39]
    v_mfma_f32_16x16x32_bf16 v[40:43], v[188:191], v[72:75], v[40:43]
    s_cmp_lt_i32 s73, 0
    s_cbranch_scc1 wo_e_102
    s_cmp_lg_u32 s74, 0
    s_cbranch_scc1 wo_k_100
    s_cmp_lt_i32 s67, 0
    s_cbranch_scc1 wo_k_100
    s_waitcnt vmcnt(4)
    v_bitop3_b32 v2, v84, v88, s71 bitop3:0x7e
    v_bitop3_b32 v3, v92, v96, s71 bitop3:0x7e
    v_or_b32 v2, v2, v3
    v_bitop3_b32 v3, v100, v104, s71 bitop3:0x7e
    v_bitop3_b32 v2, v2, v3, 1 bitop3:0xa8
    v_cmp_ne_u32 vcc, 0, v2
    s_cbranch_vccz pollpart_ok_104
pollpart_103:
    buffer_load_dwordx4 v[84:87], v116, s[8:11], s2 offen offset:0 sc1
    buffer_load_dwordx4 v[88:91], v116, s[8:11], s2 offen offset:1024 sc1
    buffer_load_dwordx4 v[92:95], v116, s[8:11], s3 offen offset:0 sc1
    buffer_load_dwordx4 v[96:99], v116, s[8:11], s3 offen offset:1024 sc1
    buffer_load_dwordx4 v[100:103], v116, s[8:11], s4 offen offset:0 sc1
    buffer_load_dwordx4 v[104:107], v116, s[8:11], s4 offen offset:1024 sc1
    s_waitcnt vmcnt(0)
    v_bitop3_b32 v2, v84, v88, s71 bitop3:0x7e
    v_bitop3_b32 v3, v92, v96, s71 bitop3:0x7e
    v_or_b32 v2, v2, v3
    v_bitop3_b32 v3, v100, v104, s71 bitop3:0x7e
    v_bitop3_b32 v2, v2, v3, 1 bitop3:0xa8
    v_cmp_ne_u32 vcc, 0, v2
    s_cbranch_vccz pollpart_ok_104
    s_sub_u32 s77, s77, 1
    s_cbranch_scc0 pollpart_103
    s_mov_b32 s77, 0
pollpart_ok_104:
    v_pk_add_f32 v[76:77], v[76:77], v[84:85]
    v_pk_add_f32 v[92:93], v[92:93], v[100:101]
    v_pk_add_f32 v[76:77], v[76:77], v[92:93]
    v_cvt_pk_bf16_f32 v84, v76, v77
    v_pk_add_f32 v[78:79], v[78:79], v[86:87]
    v_pk_add_f32 v[94:95], v[94:95], v[102:103]
    v_pk_add_f32 v[78:79], v[78:79], v[94:95]
    v_cvt_pk_bf16_f32 v85, v78, v79
    v_pk_add_f32 v[80:81], v[80:81], v[88:89]
    v_pk_add_f32 v[96:97], v[96:97], v[104:105]
    v_pk_add_f32 v[80:81], v[80:81], v[96:97]
    v_cvt_pk_bf16_f32 v86, v80, v81
    v_pk_add_f32 v[82:83], v[82:83], v[90:91]
    v_pk_add_f32 v[98:99], v[98:99], v[106:107]
    v_pk_add_f32 v[82:83], v[82:83], v[98:99]
    v_cvt_pk_bf16_f32 v87, v82, v83
    buffer_store_dwordx4 v[84:87], v114, s[16:19], s67 offen offset:2048
wo_k_100:
    s_bfe_u32 s71, s70, 0x10002
    s_add_u32 s70, s70, 1
    v_pk_add_f32 v[76:77], v[4:5], v[12:13]
    v_pk_add_f32 v[78:79], v[6:7], v[14:15]
    v_pk_add_f32 v[80:81], v[8:9], v[16:17]
    v_pk_add_f32 v[82:83], v[10:11], v[18:19]
    v_mov_b32 v116, v115
    s_lshl_b32 s67, s73, 17
    s_add_u32 s67, s67, s7
    s_cmp_eq_u32 s74, 0
    s_cbranch_scc1 wo_j_101
    v_bfi_b32 v76, 1, s71, v76
    buffer_store_dwordx4 v[76:79], v116, s[8:11], s69 offen offset:0 sc1
    v_bfi_b32 v80, 1, s71, v80
    buffer_store_dwordx4 v[80:83], v116, s[8:11], s69 offen offset:1024 sc1
wo_j_101:
    v_add_u32 v115, 0x80000, v115
    v_and_b32 v115, 0x1fffff, v115
wo_e_102:
    buffer_load_dword v110, v117, s[8:11], s65 offen sc1
    s_waitcnt lgkmcnt(2)
    v_mfma_f32_16x16x32_bf16 v[28:31], v[192:195], v[44:47], v[28:31]
    ds_read_b128 v[60:63], v109 offset:36864
    v_mfma_f32_16x16x32_bf16 v[32:35], v[196:199], v[44:47], v[32:35]
    ds_read_b128 v[64:67], v109 offset:37120
    v_mfma_f32_16x16x32_bf16 v[36:39], v[192:195], v[48:51], v[36:39]
    s_add_u32 m0, s66, 32768
    s_nop 0
    buffer_load_dwordx4 v111, s[8:11], s64 offen offset:0 sc1 lds
    v_mfma_f32_16x16x32_bf16 v[40:43], v[196:199], v[48:51], v[40:43]
    s_waitcnt lgkmcnt(2)
    v_mfma_f32_16x16x32_bf16 v[28:31], v[200:203], v[52:55], v[28:31]
    ds_read_b128 v[68:71], v109 offset:38912
    v_mfma_f32_16x16x32_bf16 v[32:35], v[204:207], v[52:55], v[32:35]
    ds_read_b128 v[72:75], v109 offset:39168
    v_mfma_f32_16x16x32_bf16 v[36:39], v[200:203], v[56:59], v[36:39]
    buffer_load_dwordx4 v111, s[8:11], s64 offen offset:1024 sc1 lds
    v_mfma_f32_16x16x32_bf16 v[40:43], v[204:207], v[56:59], v[40:43]
    s_waitcnt lgkmcnt(2)
    v_mfma_f32_16x16x32_bf16 v[28:31], v[208:211], v[60:63], v[28:31]
    ds_read_b128 v[44:47], v109 offset:40960
    v_mfma_f32_16x16x32_bf16 v[32:35], v[212:215], v[60:63], v[32:35]
    ds_read_b128 v[48:51], v109 offset:41216
    v_mfma_f32_16x16x32_bf16 v[36:39], v[208:211], v[64:67], v[36:39]
    buffer_load_dwordx4 v111, s[8:11], s64 offen offset:2048 sc1 lds
    v_mfma_f32_16x16x32_bf16 v[40:43], v[212:215], v[64:67], v[40:43]
    s_waitcnt lgkmcnt(2)
    v_mfma_f32_16x16x32_bf16 v[28:31], v[216:219], v[68:71], v[28:31]
    ds_read_b128 v[52:55], v109 offset:43008
    v_mfma_f32_16x16x32_bf16 v[32:35], v[220:223], v[68:71], v[32:35]
    ds_read_b128 v[56:59], v109 offset:43264
    v_mfma_f32_16x16x32_bf16 v[36:39], v[216:219], v[72:75], v[36:39]
    buffer_load_dwordx4 v111, s[8:11], s64 offen offset:3072 sc1 lds
    s_add_u32 s64, s64, 4096
    v_mfma_f32_16x16x32_bf16 v[40:43], v[220:223], v[72:75], v[40:43]
    s_waitcnt lgkmcnt(2)
    v_mfma_f32_16x16x32_bf16 v[28:31], v[224:227], v[44:47], v[28:31]
    ds_read_b128 v[60:63], v109 offset:45056
    v_mfma_f32_16x16x32_bf16 v[32:35], v[228:231], v[44:47], v[32:35]
    ds_read_b128 v[64:67], v109 offset:45312
    v_mfma_f32_16x16x32_bf16 v[36:39], v[224:227], v[48:51], v[36:39]
    v_mfma_f32_16x16x32_bf16 v[40:43], v[228:231], v[48:51], v[40:43]
    s_waitcnt lgkmcnt(2)
    v_mfma_f32_16x16x32_bf16 v[28:31], v[232:235], v[52:55], v[28:31]
    ds_read_b128 v[68:71], v109 offset:47104
    v_mfma_f32_16x16x32_bf16 v[32:35], v[236:239], v[52:55], v[32:35]
    ds_read_b128 v[72:75], v109 offset:47360
    v_mfma_f32_16x16x32_bf16 v[36:39], v[232:235], v[56:59], v[36:39]
    v_mfma_f32_16x16x32_bf16 v[40:43], v[236:239], v[56:59], v[40:43]
    s_waitcnt vmcnt(4)
    s_cmp_lg_u32 s58, 0
    s_cbranch_scc1 wo_v_105
    v_cmp_eq_u32 vcc, 0, v110
    s_nop 1
    v_mov_b32 v118, vcc_lo
    ds_write_b32 v119, v118
wo_v_105:
    s_waitcnt lgkmcnt(0)
    s_barrier
    v_mfma_f32_16x16x32_bf16 v[28:31], v[240:243], v[60:63], v[28:31]
    ds_read_b32 v118, v119
    ds_read_b128 v[44:47], v108 offset:0
    v_mfma_f32_16x16x32_bf16 v[32:35], v[244:247], v[60:63], v[32:35]
    ds_read_b128 v[48:51], v108 offset:256
    v_mfma_f32_16x16x32_bf16 v[36:39], v[240:243], v[64:67], v[36:39]
    v_mfma_f32_16x16x32_bf16 v[40:43], v[244:247], v[64:67], v[40:43]
    s_lshr_b32 s63, s67, 31
    s_or_b32 s63, s63, s74
    s_cbranch_scc1 wo_g_106
    buffer_load_dwordx4 v[84:87], v116, s[8:11], s2 offen offset:0 sc1
    buffer_load_dwordx4 v[88:91], v116, s[8:11], s2 offen offset:1024 sc1
    buffer_load_dwordx4 v[92:95], v116, s[8:11], s3 offen offset:0 sc1
    buffer_load_dwordx4 v[96:99], v116, s[8:11], s3 offen offset:1024 sc1
    buffer_load_dwordx4 v[100:103], v116, s[8:11], s4 offen offset:0 sc1
    buffer_load_dwordx4 v[104:107], v116, s[8:11], s4 offen offset:1024 sc1
wo_g_106:
    v_mfma_f32_16x16x32_bf16 v[28:31], v[248:251], v[68:71], v[28:31]
    ds_read_b128 v[52:55], v108 offset:2048
    v_mfma_f32_16x16x32_bf16 v[32:35], v[252:255], v[68:71], v[32:35]
    ds_read_b128 v[56:59], v108 offset:2304
    v_mfma_f32_16x16x32_bf16 v[36:39], v[248:251], v[72:75], v[36:39]
    v_mfma_f32_16x16x32_bf16 v[40:43], v[252:255], v[72:75], v[40:43]
    s_cmp_eq_u32 s68, 0
    s_cbranch_scc1 wo_loop_80
    s_nop 0
    v_mov_b32 v12, v28
    v_mov_b32 v13, v29
    v_mov_b32 v14, v30
    v_mov_b32 v15, v31
    v_mov_b32 v16, v32
    v_mov_b32 v17, v33
    v_mov_b32 v18, v34
    v_mov_b32 v19, v35
    v_mov_b32 v20, v36
    v_mov_b32 v21, v37
    v_mov_b32 v22, v38
    v_mov_b32 v23, v39
    v_mov_b32 v24, v40
    v_mov_b32 v25, v41
    v_mov_b32 v26, v42
    v_mov_b32 v27, v43
wo_f0_82:
    s_nop 4
    ds_write_b128 v112, v[20:23] offset:0
    ds_write_b128 v112, v[24:27] offset:1024
    s_mov_b32 s73, s59
    s_waitcnt lgkmcnt(0)
    s_barrier
    ds_read_b128 v[4:7], v113 offset:0
    ds_read_b128 v[8:11], v113 offset:1024
    s_waitcnt lgkmcnt(0)
    s_cmp_lt_i32 s73, 0
    s_cbranch_scc1 wo_e_110
    s_cmp_lg_u32 s74, 0
    s_cbranch_scc1 wo_k_108
    s_cmp_lt_i32 s67, 0
    s_cbranch_scc1 wo_k_108
    s_waitcnt vmcnt(0)
    v_bitop3_b32 v2, v84, v88, s71 bitop3:0x7e
    v_bitop3_b32 v3, v92, v96, s71 bitop3:0x7e
    v_or_b32 v2, v2, v3
    v_bitop3_b32 v3, v100, v104, s71 bitop3:0x7e
    v_bitop3_b32 v2, v2, v3, 1 bitop3:0xa8
    v_cmp_ne_u32 vcc, 0, v2
    s_cbranch_vccz pollpart_ok_112
pollpart_111:
    buffer_load_dwordx4 v[84:87], v116, s[8:11], s2 offen offset:0 sc1
    buffer_load_dwordx4 v[88:91], v116, s[8:11], s2 offen offset:1024 sc1
    buffer_load_dwordx4 v[92:95], v116, s[8:11], s3 offen offset:0 sc1
    buffer_load_dwordx4 v[96:99], v116, s[8:11], s3 offen offset:1024 sc1
    buffer_load_dwordx4 v[100:103], v116, s[8:11], s4 offen offset:0 sc1
    buffer_load_dwordx4 v[104:107], v116, s[8:11], s4 offen offset:1024 sc1
    s_waitcnt vmcnt(0)
    v_bitop3_b32 v2, v84, v88, s71 bitop3:0x7e
    v_bitop3_b32 v3, v92, v96, s71 bitop3:0x7e
    v_or_b32 v2, v2, v3
    v_bitop3_b32 v3, v100, v104, s71 bitop3:0x7e
    v_bitop3_b32 v2, v2, v3, 1 bitop3:0xa8
    v_cmp_ne_u32 vcc, 0, v2
    s_cbranch_vccz pollpart_ok_112
    s_sub_u32 s77, s77, 1
    s_cbranch_scc0 pollpart_111
    s_mov_b32 s77, 0
pollpart_ok_112:
    v_pk_add_f32 v[76:77], v[76:77], v[84:85]
    v_pk_add_f32 v[92:93], v[92:93], v[100:101]
    v_pk_add_f32 v[76:77], v[76:77], v[92:93]
    v_cvt_pk_bf16_f32 v84, v76, v77
    v_pk_add_f32 v[78:79], v[78:79], v[86:87]
    v_pk_add_f32 v[94:95], v[94:95], v[102:103]
    v_pk_add_f32 v[78:79], v[78:79], v[94:95]
    v_cvt_pk_bf16_f32 v85, v78, v79
    v_pk_add_f32 v[80:81], v[80:81], v[88:89]
    v_pk_add_f32 v[96:97], v[96:97], v[104:105]
    v_pk_add_f32 v[80:81], v[80:81], v[96:97]
    v_cvt_pk_bf16_f32 v86, v80, v81
    v_pk_add_f32 v[82:83], v[82:83], v[90:91]
    v_pk_add_f32 v[98:99], v[98:99], v[106:107]
    v_pk_add_f32 v[82:83], v[82:83], v[98:99]
    v_cvt_pk_bf16_f32 v87, v82, v83
    buffer_store_dwordx4 v[84:87], v114, s[16:19], s67 offen offset:2048
wo_k_108:
    s_bfe_u32 s71, s70, 0x10002
    s_add_u32 s70, s70, 1
    v_pk_add_f32 v[76:77], v[4:5], v[12:13]
    v_pk_add_f32 v[78:79], v[6:7], v[14:15]
    v_pk_add_f32 v[80:81], v[8:9], v[16:17]
    v_pk_add_f32 v[82:83], v[10:11], v[18:19]
    v_mov_b32 v116, v115
    s_lshl_b32 s67, s73, 17
    s_add_u32 s67, s67, s7
    s_cmp_eq_u32 s74, 0
    s_cbranch_scc1 wo_j_109
    v_bfi_b32 v76, 1, s71, v76
    buffer_store_dwordx4 v[76:79], v116, s[8:11], s69 offen offset:0 sc1
    v_bfi_b32 v80, 1, s71, v80
    buffer_store_dwordx4 v[80:83], v116, s[8:11], s69 offen offset:1024 sc1
wo_j_109:
    v_add_u32 v115, 0x80000, v115
    v_and_b32 v115, 0x1fffff, v115
wo_e_110:
    s_cmp_lg_u32 s74, 0
    s_cbranch_scc1 wo_out_83
pollpart_113:
    buffer_load_dwordx4 v[84:87], v116, s[8:11], s2 offen offset:0 sc1
    buffer_load_dwordx4 v[88:91], v116, s[8:11], s2 offen offset:1024 sc1
    buffer_load_dwordx4 v[92:95], v116, s[8:11], s3 offen offset:0 sc1
    buffer_load_dwordx4 v[96:99], v116, s[8:11], s3 offen offset:1024 sc1
    buffer_load_dwordx4 v[100:103], v116, s[8:11], s4 offen offset:0 sc1
    buffer_load_dwordx4 v[104:107], v116, s[8:11], s4 offen offset:1024 sc1
    s_waitcnt vmcnt(0)
    v_bitop3_b32 v2, v84, v88, s71 bitop3:0x7e
    v_bitop3_b32 v3, v92, v96, s71 bitop3:0x7e
    v_or_b32 v2, v2, v3
    v_bitop3_b32 v3, v100, v104, s71 bitop3:0x7e
    v_bitop3_b32 v2, v2, v3, 1 bitop3:0xa8
    v_cmp_ne_u32 vcc, 0, v2
    s_cbranch_vccz pollpart_ok_114
    s_sub_u32 s77, s77, 1
    s_cbranch_scc0 pollpart_113
    s_mov_b32 s77, 0
pollpart_ok_114:
    v_pk_add_f32 v[76:77], v[76:77], v[84:85]
    v_pk_add_f32 v[92:93], v[92:93], v[100:101]
    v_pk_add_f32 v[76:77], v[76:77], v[92:93]
    v_cvt_pk_bf16_f32 v84, v76, v77
    v_pk_add_f32 v[78:79], v[78:79], v[86:87]
    v_pk_add_f32 v[94:95], v[94:95], v[102:103]
    v_pk_add_f32 v[78:79], v[78:79], v[94:95]
    v_cvt_pk_bf16_f32 v85, v78, v79
    v_pk_add_f32 v[80:81], v[80:81], v[88:89]
    v_pk_add_f32 v[96:97], v[96:97], v[104:105]
    v_pk_add_f32 v[80:81], v[80:81], v[96:97]
    v_cvt_pk_bf16_f32 v86, v80, v81
    v_pk_add_f32 v[82:83], v[82:83], v[90:91]
    v_pk_add_f32 v[98:99], v[98:99], v[106:107]
    v_pk_add_f32 v[82:83], v[82:83], v[98:99]
    v_cvt_pk_bf16_f32 v87, v82, v83
    buffer_store_dwordx4 v[84:87], v114, s[16:19], s67 offen offset:2048
wo_out_83:
    s_cmp_ge_i32 s62, 0
    s_cbranch_scc1 wo_slow_79
    s_branch end_60
fft_51:
    s_mov_b64 s[60:61], s[44:45]
    s_mov_b32 s62, 0x400000
    s_mov_b32 s63, 0x20000
    s_mov_b32 s81, 0x5400000
    s_mov_b32 s83, 48
    s_mov_b32 s6, 0x10000
    s_mov_b32 s7, 0
    s_branch gen_59
col_58:
    s_waitcnt vmcnt(0) lgkmcnt(0)
    s_barrier
    s_cmp_lg_u32 s58, 0
    s_cbranch_scc1 sig_115
    v_mov_b32 v75, 0x5ffffff0
    v_mov_b32 v76, 40
    v_cmp_eq_u32 vcc, 0, v1
    s_nop 1
    v_cndmask_b32 v76, v75, v76, vcc
    v_mov_b32 v75, 1
    buffer_atomic_add v75, v76, s[12:15], 0 offen sc1
sig_115:
    s_bfe_u32 s79, s76, 0x30000
    s_bfe_u32 s85, s76, 0x20005
    s_lshl_b32 s85, s85, 3
    s_or_b32 s79, s79, s85
    v_bfe_u32 v231, v1, 0, 5
    v_bfe_u32 v235, v1, 5, 1
    v_lshl_or_b32 v231, v235, 7, v231
    v_mul_u32_u24 v231, 1026, v231
    v_and_b32 v231, -4, v231
    s_mul_i32 s5, s58, 262656
    s_lshl_b32 s2, s79, 5
    s_add_u32 s5, s5, s2
    buffer_load_dwordx4 v[84:87], v231, s[48:51], s5 offen
    buffer_load_dwordx4 v[88:91], v231, s[48:51], s5 offen offset:16
    buffer_load_dword v92, v231, s[48:51], s5 offen offset:32
    buffer_load_dwordx4 v[94:97], v231, s[52:55], s5 offen
    buffer_load_dwordx4 v[98:101], v231, s[52:55], s5 offen offset:16
    buffer_load_dword v102, v231, s[52:55], s5 offen offset:32
    s_add_u32 s5, s5, 32832
    buffer_load_dwordx4 v[104:107], v231, s[48:51], s5 offen
    buffer_load_dwordx4 v[108:111], v231, s[48:51], s5 offen offset:16
    buffer_load_dword v112, v231, s[48:51], s5 offen offset:32
    buffer_load_dwordx4 v[114:117], v231, s[52:55], s5 offen
    buffer_load_dwordx4 v[118:121], v231, s[52:55], s5 offen offset:16
    buffer_load_dword v122, v231, s[52:55], s5 offen offset:32
    s_add_u32 s5, s5, 32832
    buffer_load_dwordx4 v[124:127], v231, s[48:51], s5 offen
    buffer_load_dwordx4 v[128:131], v231, s[48:51], s5 offen offset:16
    buffer_load_dword v132, v231, s[48:51], s5 offen offset:32
    buffer_load_dwordx4 v[134:137], v231, s[52:55], s5 offen
    buffer_load_dwordx4 v[138:141], v231, s[52:55], s5 offen offset:16
    buffer_load_dword v142, v231, s[52:55], s5 offen offset:32
    s_add_u32 s5, s5, 32832
    buffer_load_dwordx4 v[144:147], v231, s[48:51], s5 offen
    buffer_load_dwordx4 v[148:151], v231, s[48:51], s5 offen offset:16
    buffer_load_dword v152, v231, s[48:51], s5 offen offset:32
    buffer_load_dwordx4 v[154:157], v231, s[52:55], s5 offen
    buffer_load_dwordx4 v[158:161], v231, s[52:55], s5 offen offset:16
    buffer_load_dword v162, v231, s[52:55], s5 offen offset:32
    s_add_u32 s5, s5, 32832
    v_and_b32 v235, 31, v1
    v_cvt_f32_u32 v228, v235
    v_and_b32 v235, 32, v1
    v_cvt_f32_u32 v235, v235
    v_mul_f32 v229, v228, v235
    v_mul_f32 v229, 0x3b000000, v229
    v_mul_f32 v234, 0x3d000000, v229
    v_fmamk_f32 v230, v235, 0x3b000000, v234
    v_and_b32 v233, 1, v1
    v_lshlrev_b32 v232, 4, v233
    v_mul_u32_u24 v233, 0x8000, v233
    v_lshl_or_b32 v233, v233, 16, v233
    v_fmamk_f32 v243, v228, 0x0, v229
    v_add_f32 v244, v243, v243
    v_cos_f32 v235, v243
    v_sin_f32 v237, v243
    v_cos_f32 v239, v244
    v_sin_f32 v241, v244
    v_fmamk_f32 v243, v228, 0x3c800000, v229
    v_add_f32 v244, v243, v243
    v_cos_f32 v236, v243
    v_sin_f32 v238, v243
    v_cos_f32 v240, v244
    v_sin_f32 v242, v244
    v_cvt_pk_bf16_f32 v4, v235, v236
    v_cvt_pk_bf16_f32 v36, v237, v238
    v_cvt_pk_bf16_f32 v68, v239, v240
    v_cvt_pk_bf16_f32 v76, v241, v242
    v_fmamk_f32 v243, v228, 0x3d000000, v229
    v_add_f32 v244, v243, v243
    v_cos_f32 v235, v243
    v_sin_f32 v237, v243
    v_cos_f32 v239, v244
    v_sin_f32 v241, v244
    v_fmamk_f32 v243, v228, 0x3d400000, v229
    v_add_f32 v244, v243, v243
    v_cos_f32 v236, v243
    v_sin_f32 v238, v243
    v_cos_f32 v240, v244
    v_sin_f32 v242, v244
    v_cvt_pk_bf16_f32 v5, v235, v236
    v_cvt_pk_bf16_f32 v37, v237, v238
    v_cvt_pk_bf16_f32 v69, v239, v240
    v_cvt_pk_bf16_f32 v77, v241, v242
    v_fmamk_f32 v243, v228, 0x3e000000, v229
    v_add_f32 v244, v243, v243
    v_cos_f32 v235, v243
    v_sin_f32 v237, v243
    v_cos_f32 v239, v244
    v_sin_f32 v241, v244
    v_fmamk_f32 v243, v228, 0x3e100000, v229
    v_add_f32 v244, v243, v243
    v_cos_f32 v236, v243
    v_sin_f32 v238, v243
    v_cos_f32 v240, v244
    v_sin_f32 v242, v244
    v_cvt_pk_bf16_f32 v6, v235, v236
    v_cvt_pk_bf16_f32 v38, v237, v238
    v_cvt_pk_bf16_f32 v70, v239, v240
    v_cvt_pk_bf16_f32 v78, v241, v242
    v_fmamk_f32 v243, v228, 0x3e200000, v229
    v_add_f32 v244, v243, v243
    v_cos_f32 v235, v243
    v_sin_f32 v237, v243
    v_cos_f32 v239, v244
    v_sin_f32 v241, v244
    v_fmamk_f32 v243, v228, 0x3e300000, v229
    v_add_f32 v244, v243, v243
    v_cos_f32 v236, v243
    v_sin_f32 v238, v243
    v_cos_f32 v240, v244
    v_sin_f32 v242, v244
    v_cvt_pk_bf16_f32 v7, v235, v236
    v_cvt_pk_bf16_f32 v39, v237, v238
    v_cvt_pk_bf16_f32 v71, v239, v240
    v_cvt_pk_bf16_f32 v79, v241, v242
    v_fmamk_f32 v243, v228, 0x3e800000, v229
    v_add_f32 v244, v243, v243
    v_cos_f32 v235, v243
    v_sin_f32 v237, v243
    v_cos_f32 v239, v244
    v_sin_f32 v241, v244
    v_fmamk_f32 v243, v228, 0x3e880000, v229
    v_add_f32 v244, v243, v243
    v_cos_f32 v236, v243
    v_sin_f32 v238, v243
    v_cos_f32 v240, v244
    v_sin_f32 v242, v244
    v_cvt_pk_bf16_f32 v8, v235, v236
    v_cvt_pk_bf16_f32 v40, v237, v238
    v_cvt_pk_bf16_f32 v72, v239, v240
    v_cvt_pk_bf16_f32 v80, v241, v242
    v_fmamk_f32 v243, v228, 0x3e900000, v229
    v_add_f32 v244, v243, v243
    v_cos_f32 v235, v243
    v_sin_f32 v237, v243
    v_cos_f32 v239, v244
    v_sin_f32 v241, v244
    v_fmamk_f32 v243, v228, 0x3e980000, v229
    v_add_f32 v244, v243, v243
    v_cos_f32 v236, v243
    v_sin_f32 v238, v243
    v_cos_f32 v240, v244
    v_sin_f32 v242, v244
    v_cvt_pk_bf16_f32 v9, v235, v236
    v_cvt_pk_bf16_f32 v41, v237, v238
    v_cvt_pk_bf16_f32 v73, v239, v240
    v_cvt_pk_bf16_f32 v81, v241, v242
    v_fmamk_f32 v243, v228, 0x3ec00000, v229
    v_add_f32 v244, v243, v243
    v_cos_f32 v235, v243
    v_sin_f32 v237, v243
    v_cos_f32 v239, v244
    v_sin_f32 v241, v244
    v_fmamk_f32 v243, v228, 0x3ec80000, v229
    v_add_f32 v244, v243, v243
    v_cos_f32 v236, v243
    v_sin_f32 v238, v243
    v_cos_f32 v240, v244
    v_sin_f32 v242, v244
    v_cvt_pk_bf16_f32 v10, v235, v236
    v_cvt_pk_bf16_f32 v42, v237, v238
    v_cvt_pk_bf16_f32 v74, v239, v240
    v_cvt_pk_bf16_f32 v82, v241, v242
    v_fmamk_f32 v243, v228, 0x3ed00000, v229
    v_add_f32 v244, v243, v243
    v_cos_f32 v235, v243
    v_sin_f32 v237, v243
    v_cos_f32 v239, v244
    v_sin_f32 v241, v244
    v_fmamk_f32 v243, v228, 0x3ed80000, v229
    v_add_f32 v244, v243, v243
    v_cos_f32 v236, v243
    v_sin_f32 v238, v243
    v_cos_f32 v240, v244
    v_sin_f32 v242, v244
    v_cvt_pk_bf16_f32 v11, v235, v236
    v_cvt_pk_bf16_f32 v43, v237, v238
    v_cvt_pk_bf16_f32 v75, v239, v240
    v_cvt_pk_bf16_f32 v83, v241, v242
    v_xor_b32 v12, v233, v4
    v_xor_b32 v13, v233, v5
    v_xor_b32 v14, v233, v6
    v_xor_b32 v15, v233, v7
    v_xor_b32 v16, v233, v8
    v_xor_b32 v17, v233, v9
    v_xor_b32 v18, v233, v10
    v_xor_b32 v19, v233, v11
    v_xor_b32 v20, 0x80000000, v4
    v_xor_b32 v21, 0x80000000, v5
    v_xor_b32 v22, 0x80000000, v6
    v_xor_b32 v23, 0x80000000, v7
    v_xor_b32 v24, 0x80000000, v8
    v_xor_b32 v25, 0x80000000, v9
    v_xor_b32 v26, 0x80000000, v10
    v_xor_b32 v27, 0x80000000, v11
    v_xor_b32 v28, 0x80000000, v12
    v_xor_b32 v29, 0x80000000, v13
    v_xor_b32 v30, 0x80000000, v14
    v_xor_b32 v31, 0x80000000, v15
    v_xor_b32 v32, 0x80000000, v16
    v_xor_b32 v33, 0x80000000, v17
    v_xor_b32 v34, 0x80000000, v18
    v_xor_b32 v35, 0x80000000, v19
    v_xor_b32 v44, v233, v36
    v_xor_b32 v45, v233, v37
    v_xor_b32 v46, v233, v38
    v_xor_b32 v47, v233, v39
    v_xor_b32 v48, v233, v40
    v_xor_b32 v49, v233, v41
    v_xor_b32 v50, v233, v42
    v_xor_b32 v51, v233, v43
    v_xor_b32 v52, 0x80000000, v36
    v_xor_b32 v53, 0x80000000, v37
    v_xor_b32 v54, 0x80000000, v38
    v_xor_b32 v55, 0x80000000, v39
    v_xor_b32 v56, 0x80000000, v40
    v_xor_b32 v57, 0x80000000, v41
    v_xor_b32 v58, 0x80000000, v42
    v_xor_b32 v59, 0x80000000, v43
    v_xor_b32 v60, 0x80000000, v44
    v_xor_b32 v61, 0x80000000, v45
    v_xor_b32 v62, 0x80000000, v46
    v_xor_b32 v63, 0x80000000, v47
    v_xor_b32 v64, 0x80000000, v48
    v_xor_b32 v65, 0x80000000, v49
    v_xor_b32 v66, 0x80000000, v50
    v_xor_b32 v67, 0x80000000, v51
    s_mov_b32 s2, 0x05040100
    s_mov_b32 s3, 0x07060302
    s_lshl_b32 s5, s58, 10
    v_lshl_add_u32 v231, v1, 4, s5
    v_add_u32 v233, 0x10000, v231
    v_add_u32 v235, 0x20000, v231
    s_waitcnt vmcnt(0)
    v_alignbit_b32 v84, v85, v84, v232
    v_alignbit_b32 v94, v95, v94, v232
    v_alignbit_b32 v104, v105, v104, v232
    v_alignbit_b32 v114, v115, v114, v232
    v_alignbit_b32 v124, v125, v124, v232
    v_alignbit_b32 v134, v135, v134, v232
    v_alignbit_b32 v144, v145, v144, v232
    v_alignbit_b32 v154, v155, v154, v232
    v_perm_b32 v196, v94, v84, s2
    v_perm_b32 v197, v114, v104, s2
    v_perm_b32 v198, v134, v124, s2
    v_perm_b32 v199, v154, v144, s2
    ds_write_b128 v231, v[196:199] offset:0
    v_perm_b32 v200, v94, v84, s3
    v_perm_b32 v201, v114, v104, s3
    v_perm_b32 v202, v134, v124, s3
    v_perm_b32 v203, v154, v144, s3
    ds_write_b128 v231, v[200:203] offset:8192
    v_alignbit_b32 v85, v86, v85, v232
    v_alignbit_b32 v95, v96, v95, v232
    v_alignbit_b32 v105, v106, v105, v232
    v_alignbit_b32 v115, v116, v115, v232
    v_alignbit_b32 v125, v126, v125, v232
    v_alignbit_b32 v135, v136, v135, v232
    v_alignbit_b32 v145, v146, v145, v232
    v_alignbit_b32 v155, v156, v155, v232
    v_perm_b32 v204, v95, v85, s2
    v_perm_b32 v205, v115, v105, s2
    v_perm_b32 v206, v135, v125, s2
    v_perm_b32 v207, v155, v145, s2
    ds_write_b128 v231, v[204:207] offset:16384
    v_perm_b32 v208, v95, v85, s3
    v_perm_b32 v209, v115, v105, s3
    v_perm_b32 v210, v135, v125, s3
    v_perm_b32 v211, v155, v145, s3
    ds_write_b128 v231, v[208:211] offset:24576
    v_alignbit_b32 v86, v87, v86, v232
    v_alignbit_b32 v96, v97, v96, v232
    v_alignbit_b32 v106, v107, v106, v232
    v_alignbit_b32 v116, v117, v116, v232
    v_alignbit_b32 v126, v127, v126, v232
    v_alignbit_b32 v136, v137, v136, v232
    v_alignbit_b32 v146, v147, v146, v232
    v_alignbit_b32 v156, v157, v156, v232
    v_perm_b32 v212, v96, v86, s2
    v_perm_b32 v213, v116, v106, s2
    v_perm_b32 v214, v136, v126, s2
    v_perm_b32 v215, v156, v146, s2
    ds_write_b128 v231, v[212:215] offset:32768
    v_perm_b32 v216, v96, v86, s3
    v_perm_b32 v217, v116, v106, s3
    v_perm_b32 v218, v136, v126, s3
    v_perm_b32 v219, v156, v146, s3
    ds_write_b128 v231, v[216:219] offset:40960
    v_alignbit_b32 v87, v88, v87, v232
    v_alignbit_b32 v97, v98, v97, v232
    v_alignbit_b32 v107, v108, v107, v232
    v_alignbit_b32 v117, v118, v117, v232
    v_alignbit_b32 v127, v128, v127, v232
    v_alignbit_b32 v137, v138, v137, v232
    v_alignbit_b32 v147, v148, v147, v232
    v_alignbit_b32 v157, v158, v157, v232
    v_perm_b32 v220, v97, v87, s2
    v_perm_b32 v221, v117, v107, s2
    v_perm_b32 v222, v137, v127, s2
    v_perm_b32 v223, v157, v147, s2
    ds_write_b128 v231, v[220:223] offset:49152
    v_perm_b32 v224, v97, v87, s3
    v_perm_b32 v225, v117, v107, s3
    v_perm_b32 v226, v137, v127, s3
    v_perm_b32 v227, v157, v147, s3
    ds_write_b128 v231, v[224:227] offset:57344
    v_alignbit_b32 v88, v89, v88, v232
    v_alignbit_b32 v98, v99, v98, v232
    v_alignbit_b32 v108, v109, v108, v232
    v_alignbit_b32 v118, v119, v118, v232
    v_alignbit_b32 v128, v129, v128, v232
    v_alignbit_b32 v138, v139, v138, v232
    v_alignbit_b32 v148, v149, v148, v232
    v_alignbit_b32 v158, v159, v158, v232
    v_perm_b32 v196, v98, v88, s2
    v_perm_b32 v197, v118, v108, s2
    v_perm_b32 v198, v138, v128, s2
    v_perm_b32 v199, v158, v148, s2
    ds_write_b128 v233, v[196:199] offset:0
    v_perm_b32 v200, v98, v88, s3
    v_perm_b32 v201, v118, v108, s3
    v_perm_b32 v202, v138, v128, s3
    v_perm_b32 v203, v158, v148, s3
    ds_write_b128 v233, v[200:203] offset:8192
    v_alignbit_b32 v89, v90, v89, v232
    v_alignbit_b32 v99, v100, v99, v232
    v_alignbit_b32 v109, v110, v109, v232
    v_alignbit_b32 v119, v120, v119, v232
    v_alignbit_b32 v129, v130, v129, v232
    v_alignbit_b32 v139, v140, v139, v232
    v_alignbit_b32 v149, v150, v149, v232
    v_alignbit_b32 v159, v160, v159, v232
    v_perm_b32 v204, v99, v89, s2
    v_perm_b32 v205, v119, v109, s2
    v_perm_b32 v206, v139, v129, s2
    v_perm_b32 v207, v159, v149, s2
    ds_write_b128 v233, v[204:207] offset:16384
    v_perm_b32 v208, v99, v89, s3
    v_perm_b32 v209, v119, v109, s3
    v_perm_b32 v210, v139, v129, s3
    v_perm_b32 v211, v159, v149, s3
    ds_write_b128 v233, v[208:211] offset:24576
    v_alignbit_b32 v90, v91, v90, v232
    v_alignbit_b32 v100, v101, v100, v232
    v_alignbit_b32 v110, v111, v110, v232
    v_alignbit_b32 v120, v121, v120, v232
    v_alignbit_b32 v130, v131, v130, v232
    v_alignbit_b32 v140, v141, v140, v232
    v_alignbit_b32 v150, v151, v150, v232
    v_alignbit_b32 v160, v161, v160, v232
    v_perm_b32 v212, v100, v90, s2
    v_perm_b32 v213, v120, v110, s2
    v_perm_b32 v214, v140, v130, s2
    v_perm_b32 v215, v160, v150, s2
    ds_write_b128 v233, v[212:215] offset:32768
    v_perm_b32 v216, v100, v90, s3
    v_perm_b32 v217, v120, v110, s3
    v_perm_b32 v218, v140, v130, s3
    v_perm_b32 v219, v160, v150, s3
    ds_write_b128 v233, v[216:219] offset:40960
    v_alignbit_b32 v91, v92, v91, v232
    v_alignbit_b32 v101, v102, v101, v232
    v_alignbit_b32 v111, v112, v111, v232
    v_alignbit_b32 v121, v122, v121, v232
    v_alignbit_b32 v131, v132, v131, v232
    v_alignbit_b32 v141, v142, v141, v232
    v_alignbit_b32 v151, v152, v151, v232
    v_alignbit_b32 v161, v162, v161, v232
    v_perm_b32 v220, v101, v91, s2
    v_perm_b32 v221, v121, v111, s2
    v_perm_b32 v222, v141, v131, s2
    v_perm_b32 v223, v161, v151, s2
    ds_write_b128 v233, v[220:223] offset:49152
    v_perm_b32 v224, v101, v91, s3
    v_perm_b32 v225, v121, v111, s3
    v_perm_b32 v226, v141, v131, s3
    v_perm_b32 v227, v161, v151, s3
    ds_write_b128 v233, v[224:227] offset:57344
    v_alignbit_b32 v92, v92, v92, v232
    v_alignbit_b32 v102, v102, v102, v232
    v_alignbit_b32 v112, v112, v112, v232
    v_alignbit_b32 v122, v122, v122, v232
    v_alignbit_b32 v132, v132, v132, v232
    v_alignbit_b32 v142, v142, v142, v232
    v_alignbit_b32 v152, v152, v152, v232
    v_alignbit_b32 v162, v162, v162, v232
    v_perm_b32 v196, v102, v92, s2
    v_perm_b32 v197, v122, v112, s2
    v_perm_b32 v198, v142, v132, s2
    v_perm_b32 v199, v162, v152, s2
    ds_write_b128 v235, v[196:199] offset:0
    s_waitcnt lgkmcnt(0)
    s_cmp_lg_u32 s58, 0
    s_cbranch_scc1 wall_116
    v_mov_b32 v236, 40
wctr_117:
    buffer_load_dword v235, v236, s[12:15], 0 offen sc1
    s_waitcnt vmcnt(0)
    v_cmp_gt_u16 vcc, 32, v235
    s_cbranch_vccz wctr_ok_118
    s_sub_u32 s77, s77, 1
    s_cbranch_scc0 wctr_117
    s_mov_b32 s77, 0
wctr_ok_118:
wall_116:
    s_barrier
    s_mov_b32 s7, s58
colloop_119:
    s_lshl_b32 s3, s79, 4
    s_add_u32 s3, s3, s7
    s_lshl_b32 s3, s3, 1
    s_cmp_eq_u32 s3, 1024
    s_cselect_b32 s3, 1, s3
    s_cmp_lt_u32 s3, 2
    s_cselect_b32 s6, 0x5ffffff0, 0
    s_mov_b32 s4, 0x35800000
    s_cselect_b32 s4, 0x35000000, s4
    v_bfe_u32 v231, v1, 0, 5
    v_lshlrev_b32 v231, 16, v231
    v_bfe_u32 v235, v1, 5, 1
    v_lshl_or_b32 v231, v235, 9, v231
    v_add_u32 v232, s6, v231
    s_bfe_u32 s5, s3, 0x50000
    s_lshl_b32 s5, s5, 4
    s_bfe_u32 s2, s3, 0x50005
    s_lshl_b32 s2, s2, 11
    s_or_b32 s5, s5, s2
    s_add_u32 s5, s5, 0x5400000
    buffer_load_dwordx4 v[84:87], v231, s[8:11], s5 offen offset:0
    buffer_load_dwordx4 v[100:103], v232, s[8:11], s5 offen offset:16
    buffer_load_dwordx4 v[88:91], v231, s[8:11], s5 offen offset:1024
    buffer_load_dwordx4 v[104:107], v232, s[8:11], s5 offen offset:1040
    s_add_u32 s5, s5, 2097152
    buffer_load_dwordx4 v[92:95], v231, s[8:11], s5 offen offset:0
    buffer_load_dwordx4 v[108:111], v232, s[8:11], s5 offen offset:16
    buffer_load_dwordx4 v[96:99], v231, s[8:11], s5 offen offset:1024
    buffer_load_dwordx4 v[112:115], v232, s[8:11], s5 offen offset:1040
    s_add_u32 s5, s5, 2097152
    s_lshl_b32 s5, s7, 13
    v_lshl_add_u32 v235, v1, 4, s5
    ds_read_b128 v[196:199], v235 offset:0
    ds_read_b128 v[200:203], v235 offset:1024
    ds_read_b128 v[204:207], v235 offset:2048
    ds_read_b128 v[208:211], v235 offset:3072
    ds_read_b128 v[212:215], v235 offset:4096
    ds_read_b128 v[216:219], v235 offset:5120
    ds_read_b128 v[220:223], v235 offset:6144
    ds_read_b128 v[224:227], v235 offset:7168
    v_and_b32 v236, 31, v1
    v_cvt_f32_u32 v228, v236
    v_mov_b32 v229, v234
    s_waitcnt vmcnt(0) lgkmcnt(0)
    v_xor_b32 v116, 0x80008000, v84
    v_xor_b32 v117, 0x80008000, v85
    v_xor_b32 v118, 0x80008000, v86
    v_xor_b32 v119, 0x80008000, v87
    v_xor_b32 v120, 0x80008000, v88
    v_xor_b32 v121, 0x80008000, v89
    v_xor_b32 v122, 0x80008000, v90
    v_xor_b32 v123, 0x80008000, v91
    v_xor_b32 v124, 0x80008000, v92
    v_xor_b32 v125, 0x80008000, v93
    v_xor_b32 v126, 0x80008000, v94
    v_xor_b32 v127, 0x80008000, v95
    v_xor_b32 v128, 0x80008000, v96
    v_xor_b32 v129, 0x80008000, v97
    v_xor_b32 v130, 0x80008000, v98
    v_xor_b32 v131, 0x80008000, v99
    v_mfma_f32_32x32x16_bf16 v[132:147], v[84:87], v[68:71], 0
    v_mfma_f32_32x32x16_bf16 v[164:179], v[100:103], v[68:71], 0
    v_mfma_f32_32x32x16_bf16 v[132:147], v[100:103], v[76:79], v[132:147]
    v_mfma_f32_32x32x16_bf16 v[164:179], v[116:119], v[76:79], v[164:179]
    v_mfma_f32_32x32x16_bf16 v[132:147], v[88:91], v[72:75], v[132:147]
    v_mfma_f32_32x32x16_bf16 v[164:179], v[104:107], v[72:75], v[164:179]
    v_mfma_f32_32x32x16_bf16 v[132:147], v[104:107], v[80:83], v[132:147]
    v_mfma_f32_32x32x16_bf16 v[164:179], v[120:123], v[80:83], v[164:179]
    v_mfma_f32_32x32x16_bf16 v[148:163], v[92:95], v[68:71], 0
    v_mfma_f32_32x32x16_bf16 v[180:195], v[108:111], v[68:71], 0
    v_mfma_f32_32x32x16_bf16 v[148:163], v[108:111], v[76:79], v[148:163]
    v_mfma_f32_32x32x16_bf16 v[180:195], v[124:127], v[76:79], v[180:195]
    v_mfma_f32_32x32x16_bf16 v[148:163], v[96:99], v[72:75], v[148:163]
    v_mfma_f32_32x32x16_bf16 v[180:195], v[112:115], v[72:75], v[180:195]
    v_mfma_f32_32x32x16_bf16 v[148:163], v[112:115], v[80:83], v[148:163]
    v_mfma_f32_32x32x16_bf16 v[180:195], v[128:131], v[80:83], v[180:195]
    v_fmamk_f32 v243, v228, 0x0, v229
    v_cos_f32 v239, v243
    v_sin_f32 v240, v243
    v_mul_f32 v239, s4, v239
    v_mul_f32 v240, s4, v240
    v_mul_f32 v235, v132, v239
    v_mul_f32 v237, v164, v239
    v_fma_f32 v235, v164, v240, v235
    v_fma_f32 v237, -v132, v240, v237
    v_fmamk_f32 v243, v228, 0x3a000000, v229
    v_cos_f32 v241, v243
    v_sin_f32 v242, v243
    v_mul_f32 v241, s4, v241
    v_mul_f32 v242, s4, v242
    v_mul_f32 v236, v133, v241
    v_mul_f32 v238, v165, v241
    v_fma_f32 v236, v165, v242, v236
    v_fma_f32 v238, -v133, v242, v238
    v_cvt_pk_bf16_f32 v84, v235, v236
    v_cvt_pk_bf16_f32 v100, v237, v238
    v_cvt_pk_bf16_f32 v116, -v235, -v236
    v_fmamk_f32 v243, v228, 0x3a800000, v229
    v_cos_f32 v239, v243
    v_sin_f32 v240, v243
    v_mul_f32 v239, s4, v239
    v_mul_f32 v240, s4, v240
    v_mul_f32 v235, v134, v239
    v_mul_f32 v237, v166, v239
    v_fma_f32 v235, v166, v240, v235
    v_fma_f32 v237, -v134, v240, v237
    v_fmamk_f32 v243, v228, 0x3ac00000, v229
    v_cos_f32 v241, v243
    v_sin_f32 v242, v243
    v_mul_f32 v241, s4, v241
    v_mul_f32 v242, s4, v242
    v_mul_f32 v236, v135, v241
    v_mul_f32 v238, v167, v241
    v_fma_f32 v236, v167, v242, v236
    v_fma_f32 v238, -v135, v242, v238
    v_cvt_pk_bf16_f32 v85, v235, v236
    v_cvt_pk_bf16_f32 v101, v237, v238
    v_cvt_pk_bf16_f32 v117, -v235, -v236
    v_fmamk_f32 v243, v228, 0x3b800000, v229
    v_cos_f32 v239, v243
    v_sin_f32 v240, v243
    v_mul_f32 v239, s4, v239
    v_mul_f32 v240, s4, v240
    v_mul_f32 v235, v136, v239
    v_mul_f32 v237, v168, v239
    v_fma_f32 v235, v168, v240, v235
    v_fma_f32 v237, -v136, v240, v237
    v_fmamk_f32 v243, v228, 0x3b900000, v229
    v_cos_f32 v241, v243
    v_sin_f32 v242, v243
    v_mul_f32 v241, s4, v241
    v_mul_f32 v242, s4, v242
    v_mul_f32 v236, v137, v241
    v_mul_f32 v238, v169, v241
    v_fma_f32 v236, v169, v242, v236
    v_fma_f32 v238, -v137, v242, v238
    v_cvt_pk_bf16_f32 v86, v235, v236
    v_cvt_pk_bf16_f32 v102, v237, v238
    v_cvt_pk_bf16_f32 v118, -v235, -v236
    v_fmamk_f32 v243, v228, 0x3ba00000, v229
    v_cos_f32 v239, v243
    v_sin_f32 v240, v243
    v_mul_f32 v239, s4, v239
    v_mul_f32 v240, s4, v240
    v_mul_f32 v235, v138, v239
    v_mul_f32 v237, v170, v239
    v_fma_f32 v235, v170, v240, v235
    v_fma_f32 v237, -v138, v240, v237
    v_fmamk_f32 v243, v228, 0x3bb00000, v229
    v_cos_f32 v241, v243
    v_sin_f32 v242, v243
    v_mul_f32 v241, s4, v241
    v_mul_f32 v242, s4, v242
    v_mul_f32 v236, v139, v241
    v_mul_f32 v238, v171, v241
    v_fma_f32 v236, v171, v242, v236
    v_fma_f32 v238, -v139, v242, v238
    v_cvt_pk_bf16_f32 v87, v235, v236
    v_cvt_pk_bf16_f32 v103, v237, v238
    v_cvt_pk_bf16_f32 v119, -v235, -v236
    v_fmamk_f32 v243, v228, 0x3c000000, v229
    v_cos_f32 v239, v243
    v_sin_f32 v240, v243
    v_mul_f32 v239, s4, v239
    v_mul_f32 v240, s4, v240
    v_mul_f32 v235, v140, v239
    v_mul_f32 v237, v172, v239
    v_fma_f32 v235, v172, v240, v235
    v_fma_f32 v237, -v140, v240, v237
    v_fmamk_f32 v243, v228, 0x3c080000, v229
    v_cos_f32 v241, v243
    v_sin_f32 v242, v243
    v_mul_f32 v241, s4, v241
    v_mul_f32 v242, s4, v242
    v_mul_f32 v236, v141, v241
    v_mul_f32 v238, v173, v241
    v_fma_f32 v236, v173, v242, v236
    v_fma_f32 v238, -v141, v242, v238
    v_cvt_pk_bf16_f32 v88, v235, v236
    v_cvt_pk_bf16_f32 v104, v237, v238
    v_cvt_pk_bf16_f32 v120, -v235, -v236
    v_fmamk_f32 v243, v228, 0x3c100000, v229
    v_cos_f32 v239, v243
    v_sin_f32 v240, v243
    v_mul_f32 v239, s4, v239
    v_mul_f32 v240, s4, v240
    v_mul_f32 v235, v142, v239
    v_mul_f32 v237, v174, v239
    v_fma_f32 v235, v174, v240, v235
    v_fma_f32 v237, -v142, v240, v237
    v_fmamk_f32 v243, v228, 0x3c180000, v229
    v_cos_f32 v241, v243
    v_sin_f32 v242, v243
    v_mul_f32 v241, s4, v241
    v_mul_f32 v242, s4, v242
    v_mul_f32 v236, v143, v241
    v_mul_f32 v238, v175, v241
    v_fma_f32 v236, v175, v242, v236
    v_fma_f32 v238, -v143, v242, v238
    v_cvt_pk_bf16_f32 v89, v235, v236
    v_cvt_pk_bf16_f32 v105, v237, v238
    v_cvt_pk_bf16_f32 v121, -v235, -v236
    v_fmamk_f32 v243, v228, 0x3c400000, v229
    v_cos_f32 v239, v243
    v_sin_f32 v240, v243
    v_mul_f32 v239, s4, v239
    v_mul_f32 v240, s4, v240
    v_mul_f32 v235, v144, v239
    v_mul_f32 v237, v176, v239
    v_fma_f32 v235, v176, v240, v235
    v_fma_f32 v237, -v144, v240, v237
    v_fmamk_f32 v243, v228, 0x3c480000, v229
    v_cos_f32 v241, v243
    v_sin_f32 v242, v243
    v_mul_f32 v241, s4, v241
    v_mul_f32 v242, s4, v242
    v_mul_f32 v236, v145, v241
    v_mul_f32 v238, v177, v241
    v_fma_f32 v236, v177, v242, v236
    v_fma_f32 v238, -v145, v242, v238
    v_cvt_pk_bf16_f32 v90, v235, v236
    v_cvt_pk_bf16_f32 v106, v237, v238
    v_cvt_pk_bf16_f32 v122, -v235, -v236
    v_fmamk_f32 v243, v228, 0x3c500000, v229
    v_cos_f32 v239, v243
    v_sin_f32 v240, v243
    v_mul_f32 v239, s4, v239
    v_mul_f32 v240, s4, v240
    v_mul_f32 v235, v146, v239
    v_mul_f32 v237, v178, v239
    v_fma_f32 v235, v178, v240, v235
    v_fma_f32 v237, -v146, v240, v237
    v_fmamk_f32 v243, v228, 0x3c580000, v229
    v_cos_f32 v241, v243
    v_sin_f32 v242, v243
    v_mul_f32 v241, s4, v241
    v_mul_f32 v242, s4, v242
    v_mul_f32 v236, v147, v241
    v_mul_f32 v238, v179, v241
    v_fma_f32 v236, v179, v242, v236
    v_fma_f32 v238, -v147, v242, v238
    v_cvt_pk_bf16_f32 v91, v235, v236
    v_cvt_pk_bf16_f32 v107, v237, v238
    v_cvt_pk_bf16_f32 v123, -v235, -v236
    v_fmamk_f32 v243, v228, 0x3c800000, v229
    v_cos_f32 v239, v243
    v_sin_f32 v240, v243
    v_mul_f32 v239, s4, v239
    v_mul_f32 v240, s4, v240
    v_mul_f32 v235, v148, v239
    v_mul_f32 v237, v180, v239
    v_fma_f32 v235, v180, v240, v235
    v_fma_f32 v237, -v148, v240, v237
    v_fmamk_f32 v243, v228, 0x3c840000, v229
    v_cos_f32 v241, v243
    v_sin_f32 v242, v243
    v_mul_f32 v241, s4, v241
    v_mul_f32 v242, s4, v242
    v_mul_f32 v236, v149, v241
    v_mul_f32 v238, v181, v241
    v_fma_f32 v236, v181, v242, v236
    v_fma_f32 v238, -v149, v242, v238
    v_cvt_pk_bf16_f32 v92, v235, v236
    v_cvt_pk_bf16_f32 v108, v237, v238
    v_cvt_pk_bf16_f32 v124, -v235, -v236
    v_fmamk_f32 v243, v228, 0x3c880000, v229
    v_cos_f32 v239, v243
    v_sin_f32 v240, v243
    v_mul_f32 v239, s4, v239
    v_mul_f32 v240, s4, v240
    v_mul_f32 v235, v150, v239
    v_mul_f32 v237, v182, v239
    v_fma_f32 v235, v182, v240, v235
    v_fma_f32 v237, -v150, v240, v237
    v_fmamk_f32 v243, v228, 0x3c8c0000, v229
    v_cos_f32 v241, v243
    v_sin_f32 v242, v243
    v_mul_f32 v241, s4, v241
    v_mul_f32 v242, s4, v242
    v_mul_f32 v236, v151, v241
    v_mul_f32 v238, v183, v241
    v_fma_f32 v236, v183, v242, v236
    v_fma_f32 v238, -v151, v242, v238
    v_cvt_pk_bf16_f32 v93, v235, v236
    v_cvt_pk_bf16_f32 v109, v237, v238
    v_cvt_pk_bf16_f32 v125, -v235, -v236
    v_fmamk_f32 v243, v228, 0x3ca00000, v229
    v_cos_f32 v239, v243
    v_sin_f32 v240, v243
    v_mul_f32 v239, s4, v239
    v_mul_f32 v240, s4, v240
    v_mul_f32 v235, v152, v239
    v_mul_f32 v237, v184, v239
    v_fma_f32 v235, v184, v240, v235
    v_fma_f32 v237, -v152, v240, v237
    v_fmamk_f32 v243, v228, 0x3ca40000, v229
    v_cos_f32 v241, v243
    v_sin_f32 v242, v243
    v_mul_f32 v241, s4, v241
    v_mul_f32 v242, s4, v242
    v_mul_f32 v236, v153, v241
    v_mul_f32 v238, v185, v241
    v_fma_f32 v236, v185, v242, v236
    v_fma_f32 v238, -v153, v242, v238
    v_cvt_pk_bf16_f32 v94, v235, v236
    v_cvt_pk_bf16_f32 v110, v237, v238
    v_cvt_pk_bf16_f32 v126, -v235, -v236
    v_fmamk_f32 v243, v228, 0x3ca80000, v229
    v_cos_f32 v239, v243
    v_sin_f32 v240, v243
    v_mul_f32 v239, s4, v239
    v_mul_f32 v240, s4, v240
    v_mul_f32 v235, v154, v239
    v_mul_f32 v237, v186, v239
    v_fma_f32 v235, v186, v240, v235
    v_fma_f32 v237, -v154, v240, v237
    v_fmamk_f32 v243, v228, 0x3cac0000, v229
    v_cos_f32 v241, v243
    v_sin_f32 v242, v243
    v_mul_f32 v241, s4, v241
    v_mul_f32 v242, s4, v242
    v_mul_f32 v236, v155, v241
    v_mul_f32 v238, v187, v241
    v_fma_f32 v236, v187, v242, v236
    v_fma_f32 v238, -v155, v242, v238
    v_cvt_pk_bf16_f32 v95, v235, v236
    v_cvt_pk_bf16_f32 v111, v237, v238
    v_cvt_pk_bf16_f32 v127, -v235, -v236
    v_fmamk_f32 v243, v228, 0x3cc00000, v229
    v_cos_f32 v239, v243
    v_sin_f32 v240, v243
    v_mul_f32 v239, s4, v239
    v_mul_f32 v240, s4, v240
    v_mul_f32 v235, v156, v239
    v_mul_f32 v237, v188, v239
    v_fma_f32 v235, v188, v240, v235
    v_fma_f32 v237, -v156, v240, v237
    v_fmamk_f32 v243, v228, 0x3cc40000, v229
    v_cos_f32 v241, v243
    v_sin_f32 v242, v243
    v_mul_f32 v241, s4, v241
    v_mul_f32 v242, s4, v242
    v_mul_f32 v236, v157, v241
    v_mul_f32 v238, v189, v241
    v_fma_f32 v236, v189, v242, v236
    v_fma_f32 v238, -v157, v242, v238
    v_cvt_pk_bf16_f32 v96, v235, v236
    v_cvt_pk_bf16_f32 v112, v237, v238
    v_cvt_pk_bf16_f32 v128, -v235, -v236
    v_fmamk_f32 v243, v228, 0x3cc80000, v229
    v_cos_f32 v239, v243
    v_sin_f32 v240, v243
    v_mul_f32 v239, s4, v239
    v_mul_f32 v240, s4, v240
    v_mul_f32 v235, v158, v239
    v_mul_f32 v237, v190, v239
    v_fma_f32 v235, v190, v240, v235
    v_fma_f32 v237, -v158, v240, v237
    v_fmamk_f32 v243, v228, 0x3ccc0000, v229
    v_cos_f32 v241, v243
    v_sin_f32 v242, v243
    v_mul_f32 v241, s4, v241
    v_mul_f32 v242, s4, v242
    v_mul_f32 v236, v159, v241
    v_mul_f32 v238, v191, v241
    v_fma_f32 v236, v191, v242, v236
    v_fma_f32 v238, -v159, v242, v238
    v_cvt_pk_bf16_f32 v97, v235, v236
    v_cvt_pk_bf16_f32 v113, v237, v238
    v_cvt_pk_bf16_f32 v129, -v235, -v236
    v_fmamk_f32 v243, v228, 0x3ce00000, v229
    v_cos_f32 v239, v243
    v_sin_f32 v240, v243
    v_mul_f32 v239, s4, v239
    v_mul_f32 v240, s4, v240
    v_mul_f32 v235, v160, v239
    v_mul_f32 v237, v192, v239
    v_fma_f32 v235, v192, v240, v235
    v_fma_f32 v237, -v160, v240, v237
    v_fmamk_f32 v243, v228, 0x3ce40000, v229
    v_cos_f32 v241, v243
    v_sin_f32 v242, v243
    v_mul_f32 v241, s4, v241
    v_mul_f32 v242, s4, v242
    v_mul_f32 v236, v161, v241
    v_mul_f32 v238, v193, v241
    v_fma_f32 v236, v193, v242, v236
    v_fma_f32 v238, -v161, v242, v238
    v_cvt_pk_bf16_f32 v98, v235, v236
    v_cvt_pk_bf16_f32 v114, v237, v238
    v_cvt_pk_bf16_f32 v130, -v235, -v236
    v_fmamk_f32 v243, v228, 0x3ce80000, v229
    v_cos_f32 v239, v243
    v_sin_f32 v240, v243
    v_mul_f32 v239, s4, v239
    v_mul_f32 v240, s4, v240
    v_mul_f32 v235, v162, v239
    v_mul_f32 v237, v194, v239
    v_fma_f32 v235, v194, v240, v235
    v_fma_f32 v237, -v162, v240, v237
    v_fmamk_f32 v243, v228, 0x3cec0000, v229
    v_cos_f32 v241, v243
    v_sin_f32 v242, v243
    v_mul_f32 v241, s4, v241
    v_mul_f32 v242, s4, v242
    v_mul_f32 v236, v163, v241
    v_mul_f32 v238, v195, v241
    v_fma_f32 v236, v195, v242, v236
    v_fma_f32 v238, -v163, v242, v238
    v_cvt_pk_bf16_f32 v99, v235, v236
    v_cvt_pk_bf16_f32 v115, v237, v238
    v_cvt_pk_bf16_f32 v131, -v235, -v236
    v_mfma_f32_32x32x16_bf16 v[132:147], v[4:7], v[84:87], 0
    v_mfma_f32_32x32x16_bf16 v[164:179], v[4:7], v[100:103], 0
    v_mfma_f32_32x32x16_bf16 v[132:147], v[36:39], v[100:103], v[132:147]
    v_mfma_f32_32x32x16_bf16 v[164:179], v[36:39], v[116:119], v[164:179]
    v_mfma_f32_32x32x16_bf16 v[132:147], v[8:11], v[88:91], v[132:147]
    v_mfma_f32_32x32x16_bf16 v[164:179], v[8:11], v[104:107], v[164:179]
    v_mfma_f32_32x32x16_bf16 v[132:147], v[40:43], v[104:107], v[132:147]
    v_mfma_f32_32x32x16_bf16 v[164:179], v[40:43], v[120:123], v[164:179]
    v_mfma_f32_32x32x16_bf16 v[132:147], v[12:15], v[92:95], v[132:147]
    v_mfma_f32_32x32x16_bf16 v[164:179], v[12:15], v[108:111], v[164:179]
    v_mfma_f32_32x32x16_bf16 v[132:147], v[44:47], v[108:111], v[132:147]
    v_mfma_f32_32x32x16_bf16 v[164:179], v[44:47], v[124:127], v[164:179]
    v_mfma_f32_32x32x16_bf16 v[132:147], v[16:19], v[96:99], v[132:147]
    v_mfma_f32_32x32x16_bf16 v[164:179], v[16:19], v[112:115], v[164:179]
    v_mfma_f32_32x32x16_bf16 v[132:147], v[48:51], v[112:115], v[132:147]
    v_mfma_f32_32x32x16_bf16 v[164:179], v[48:51], v[128:131], v[164:179]
    v_mfma_f32_32x32x16_bf16 v[148:163], v[20:23], v[84:87], 0
    v_mfma_f32_32x32x16_bf16 v[180:195], v[20:23], v[100:103], 0
    v_mfma_f32_32x32x16_bf16 v[148:163], v[52:55], v[100:103], v[148:163]
    v_mfma_f32_32x32x16_bf16 v[180:195], v[52:55], v[116:119], v[180:195]
    v_mfma_f32_32x32x16_bf16 v[148:163], v[24:27], v[88:91], v[148:163]
    v_mfma_f32_32x32x16_bf16 v[180:195], v[24:27], v[104:107], v[180:195]
    v_mfma_f32_32x32x16_bf16 v[148:163], v[56:59], v[104:107], v[148:163]
    v_mfma_f32_32x32x16_bf16 v[180:195], v[56:59], v[120:123], v[180:195]
    v_mfma_f32_32x32x16_bf16 v[148:163], v[28:31], v[92:95], v[148:163]
    v_mfma_f32_32x32x16_bf16 v[180:195], v[28:31], v[108:111], v[180:195]
    v_mfma_f32_32x32x16_bf16 v[148:163], v[60:63], v[108:111], v[148:163]
    v_mfma_f32_32x32x16_bf16 v[180:195], v[60:63], v[124:127], v[180:195]
    v_mfma_f32_32x32x16_bf16 v[148:163], v[32:35], v[96:99], v[148:163]
    v_mfma_f32_32x32x16_bf16 v[180:195], v[32:35], v[112:115], v[180:195]
    v_mfma_f32_32x32x16_bf16 v[148:163], v[64:67], v[112:115], v[148:163]
    v_mfma_f32_32x32x16_bf16 v[180:195], v[64:67], v[128:131], v[180:195]
    v_lshlrev_b32 v239, 16, v196
    v_and_b32 v240, 0xffff0000, v196
    v_mul_f32 v235, v132, v239
    v_mul_f32 v237, v164, v239
    v_fma_f32 v235, -v164, v240, v235
    v_fma_f32 v237, v132, v240, v237
    v_lshlrev_b32 v241, 16, v197
    v_and_b32 v242, 0xffff0000, v197
    v_mul_f32 v236, v133, v241
    v_mul_f32 v238, v165, v241
    v_fma_f32 v236, -v165, v242, v236
    v_fma_f32 v238, v133, v242, v238
    v_cvt_pk_bf16_f32 v84, v235, v236
    v_cvt_pk_bf16_f32 v100, v237, v238
    v_cvt_pk_bf16_f32 v116, -v237, -v238
    v_lshlrev_b32 v239, 16, v198
    v_and_b32 v240, 0xffff0000, v198
    v_mul_f32 v235, v134, v239
    v_mul_f32 v237, v166, v239
    v_fma_f32 v235, -v166, v240, v235
    v_fma_f32 v237, v134, v240, v237
    v_lshlrev_b32 v241, 16, v199
    v_and_b32 v242, 0xffff0000, v199
    v_mul_f32 v236, v135, v241
    v_mul_f32 v238, v167, v241
    v_fma_f32 v236, -v167, v242, v236
    v_fma_f32 v238, v135, v242, v238
    v_cvt_pk_bf16_f32 v85, v235, v236
    v_cvt_pk_bf16_f32 v101, v237, v238
    v_cvt_pk_bf16_f32 v117, -v237, -v238
    v_lshlrev_b32 v239, 16, v200
    v_and_b32 v240, 0xffff0000, v200
    v_mul_f32 v235, v136, v239
    v_mul_f32 v237, v168, v239
    v_fma_f32 v235, -v168, v240, v235
    v_fma_f32 v237, v136, v240, v237
    v_lshlrev_b32 v241, 16, v201
    v_and_b32 v242, 0xffff0000, v201
    v_mul_f32 v236, v137, v241
    v_mul_f32 v238, v169, v241
    v_fma_f32 v236, -v169, v242, v236
    v_fma_f32 v238, v137, v242, v238
    v_cvt_pk_bf16_f32 v86, v235, v236
    v_cvt_pk_bf16_f32 v102, v237, v238
    v_cvt_pk_bf16_f32 v118, -v237, -v238
    v_lshlrev_b32 v239, 16, v202
    v_and_b32 v240, 0xffff0000, v202
    v_mul_f32 v235, v138, v239
    v_mul_f32 v237, v170, v239
    v_fma_f32 v235, -v170, v240, v235
    v_fma_f32 v237, v138, v240, v237
    v_lshlrev_b32 v241, 16, v203
    v_and_b32 v242, 0xffff0000, v203
    v_mul_f32 v236, v139, v241
    v_mul_f32 v238, v171, v241
    v_fma_f32 v236, -v171, v242, v236
    v_fma_f32 v238, v139, v242, v238
    v_cvt_pk_bf16_f32 v87, v235, v236
    v_cvt_pk_bf16_f32 v103, v237, v238
    v_cvt_pk_bf16_f32 v119, -v237, -v238
    v_lshlrev_b32 v239, 16, v204
    v_and_b32 v240, 0xffff0000, v204
    v_mul_f32 v235, v140, v239
    v_mul_f32 v237, v172, v239
    v_fma_f32 v235, -v172, v240, v235
    v_fma_f32 v237, v140, v240, v237
    v_lshlrev_b32 v241, 16, v205
    v_and_b32 v242, 0xffff0000, v205
    v_mul_f32 v236, v141, v241
    v_mul_f32 v238, v173, v241
    v_fma_f32 v236, -v173, v242, v236
    v_fma_f32 v238, v141, v242, v238
    v_cvt_pk_bf16_f32 v88, v235, v236
    v_cvt_pk_bf16_f32 v104, v237, v238
    v_cvt_pk_bf16_f32 v120, -v237, -v238
    v_lshlrev_b32 v239, 16, v206
    v_and_b32 v240, 0xffff0000, v206
    v_mul_f32 v235, v142, v239
    v_mul_f32 v237, v174, v239
    v_fma_f32 v235, -v174, v240, v235
    v_fma_f32 v237, v142, v240, v237
    v_lshlrev_b32 v241, 16, v207
    v_and_b32 v242, 0xffff0000, v207
    v_mul_f32 v236, v143, v241
    v_mul_f32 v238, v175, v241
    v_fma_f32 v236, -v175, v242, v236
    v_fma_f32 v238, v143, v242, v238
    v_cvt_pk_bf16_f32 v89, v235, v236
    v_cvt_pk_bf16_f32 v105, v237, v238
    v_cvt_pk_bf16_f32 v121, -v237, -v238
    v_lshlrev_b32 v239, 16, v208
    v_and_b32 v240, 0xffff0000, v208
    v_mul_f32 v235, v144, v239
    v_mul_f32 v237, v176, v239
    v_fma_f32 v235, -v176, v240, v235
    v_fma_f32 v237, v144, v240, v237
    v_lshlrev_b32 v241, 16, v209
    v_and_b32 v242, 0xffff0000, v209
    v_mul_f32 v236, v145, v241
    v_mul_f32 v238, v177, v241
    v_fma_f32 v236, -v177, v242, v236
    v_fma_f32 v238, v145, v242, v238
    v_cvt_pk_bf16_f32 v90, v235, v236
    v_cvt_pk_bf16_f32 v106, v237, v238
    v_cvt_pk_bf16_f32 v122, -v237, -v238
    v_lshlrev_b32 v239, 16, v210
    v_and_b32 v240, 0xffff0000, v210
    v_mul_f32 v235, v146, v239
    v_mul_f32 v237, v178, v239
    v_fma_f32 v235, -v178, v240, v235
    v_fma_f32 v237, v146, v240, v237
    v_lshlrev_b32 v241, 16, v211
    v_and_b32 v242, 0xffff0000, v211
    v_mul_f32 v236, v147, v241
    v_mul_f32 v238, v179, v241
    v_fma_f32 v236, -v179, v242, v236
    v_fma_f32 v238, v147, v242, v238
    v_cvt_pk_bf16_f32 v91, v235, v236
    v_cvt_pk_bf16_f32 v107, v237, v238
    v_cvt_pk_bf16_f32 v123, -v237, -v238
    v_lshlrev_b32 v239, 16, v212
    v_and_b32 v240, 0xffff0000, v212
    v_mul_f32 v235, v148, v239
    v_mul_f32 v237, v180, v239
    v_fma_f32 v235, -v180, v240, v235
    v_fma_f32 v237, v148, v240, v237
    v_lshlrev_b32 v241, 16, v213
    v_and_b32 v242, 0xffff0000, v213
    v_mul_f32 v236, v149, v241
    v_mul_f32 v238, v181, v241
    v_fma_f32 v236, -v181, v242, v236
    v_fma_f32 v238, v149, v242, v238
    v_cvt_pk_bf16_f32 v92, v235, v236
    v_cvt_pk_bf16_f32 v108, v237, v238
    v_cvt_pk_bf16_f32 v124, -v237, -v238
    v_lshlrev_b32 v239, 16, v214
    v_and_b32 v240, 0xffff0000, v214
    v_mul_f32 v235, v150, v239
    v_mul_f32 v237, v182, v239
    v_fma_f32 v235, -v182, v240, v235
    v_fma_f32 v237, v150, v240, v237
    v_lshlrev_b32 v241, 16, v215
    v_and_b32 v242, 0xffff0000, v215
    v_mul_f32 v236, v151, v241
    v_mul_f32 v238, v183, v241
    v_fma_f32 v236, -v183, v242, v236
    v_fma_f32 v238, v151, v242, v238
    v_cvt_pk_bf16_f32 v93, v235, v236
    v_cvt_pk_bf16_f32 v109, v237, v238
    v_cvt_pk_bf16_f32 v125, -v237, -v238
    v_lshlrev_b32 v239, 16, v216
    v_and_b32 v240, 0xffff0000, v216
    v_mul_f32 v235, v152, v239
    v_mul_f32 v237, v184, v239
    v_fma_f32 v235, -v184, v240, v235
    v_fma_f32 v237, v152, v240, v237
    v_lshlrev_b32 v241, 16, v217
    v_and_b32 v242, 0xffff0000, v217
    v_mul_f32 v236, v153, v241
    v_mul_f32 v238, v185, v241
    v_fma_f32 v236, -v185, v242, v236
    v_fma_f32 v238, v153, v242, v238
    v_cvt_pk_bf16_f32 v94, v235, v236
    v_cvt_pk_bf16_f32 v110, v237, v238
    v_cvt_pk_bf16_f32 v126, -v237, -v238
    v_lshlrev_b32 v239, 16, v218
    v_and_b32 v240, 0xffff0000, v218
    v_mul_f32 v235, v154, v239
    v_mul_f32 v237, v186, v239
    v_fma_f32 v235, -v186, v240, v235
    v_fma_f32 v237, v154, v240, v237
    v_lshlrev_b32 v241, 16, v219
    v_and_b32 v242, 0xffff0000, v219
    v_mul_f32 v236, v155, v241
    v_mul_f32 v238, v187, v241
    v_fma_f32 v236, -v187, v242, v236
    v_fma_f32 v238, v155, v242, v238
    v_cvt_pk_bf16_f32 v95, v235, v236
    v_cvt_pk_bf16_f32 v111, v237, v238
    v_cvt_pk_bf16_f32 v127, -v237, -v238
    v_lshlrev_b32 v239, 16, v220
    v_and_b32 v240, 0xffff0000, v220
    v_mul_f32 v235, v156, v239
    v_mul_f32 v237, v188, v239
    v_fma_f32 v235, -v188, v240, v235
    v_fma_f32 v237, v156, v240, v237
    v_lshlrev_b32 v241, 16, v221
    v_and_b32 v242, 0xffff0000, v221
    v_mul_f32 v236, v157, v241
    v_mul_f32 v238, v189, v241
    v_fma_f32 v236, -v189, v242, v236
    v_fma_f32 v238, v157, v242, v238
    v_cvt_pk_bf16_f32 v96, v235, v236
    v_cvt_pk_bf16_f32 v112, v237, v238
    v_cvt_pk_bf16_f32 v128, -v237, -v238
    v_lshlrev_b32 v239, 16, v222
    v_and_b32 v240, 0xffff0000, v222
    v_mul_f32 v235, v158, v239
    v_mul_f32 v237, v190, v239
    v_fma_f32 v235, -v190, v240, v235
    v_fma_f32 v237, v158, v240, v237
    v_lshlrev_b32 v241, 16, v223
    v_and_b32 v242, 0xffff0000, v223
    v_mul_f32 v236, v159, v241
    v_mul_f32 v238, v191, v241
    v_fma_f32 v236, -v191, v242, v236
    v_fma_f32 v238, v159, v242, v238
    v_cvt_pk_bf16_f32 v97, v235, v236
    v_cvt_pk_bf16_f32 v113, v237, v238
    v_cvt_pk_bf16_f32 v129, -v237, -v238
    v_lshlrev_b32 v239, 16, v224
    v_and_b32 v240, 0xffff0000, v224
    v_mul_f32 v235, v160, v239
    v_mul_f32 v237, v192, v239
    v_fma_f32 v235, -v192, v240, v235
    v_fma_f32 v237, v160, v240, v237
    v_lshlrev_b32 v241, 16, v225
    v_and_b32 v242, 0xffff0000, v225
    v_mul_f32 v236, v161, v241
    v_mul_f32 v238, v193, v241
    v_fma_f32 v236, -v193, v242, v236
    v_fma_f32 v238, v161, v242, v238
    v_cvt_pk_bf16_f32 v98, v235, v236
    v_cvt_pk_bf16_f32 v114, v237, v238
    v_cvt_pk_bf16_f32 v130, -v237, -v238
    v_lshlrev_b32 v239, 16, v226
    v_and_b32 v240, 0xffff0000, v226
    v_mul_f32 v235, v162, v239
    v_mul_f32 v237, v194, v239
    v_fma_f32 v235, -v194, v240, v235
    v_fma_f32 v237, v162, v240, v237
    v_lshlrev_b32 v241, 16, v227
    v_and_b32 v242, 0xffff0000, v227
    v_mul_f32 v236, v163, v241
    v_mul_f32 v238, v195, v241
    v_fma_f32 v236, -v195, v242, v236
    v_fma_f32 v238, v163, v242, v238
    v_cvt_pk_bf16_f32 v99, v235, v236
    v_cvt_pk_bf16_f32 v115, v237, v238
    v_cvt_pk_bf16_f32 v131, -v237, -v238
    v_mfma_f32_32x32x16_bf16 v[132:147], v[84:87], v[4:7], 0
    v_mfma_f32_32x32x16_bf16 v[164:179], v[100:103], v[4:7], 0
    v_mfma_f32_32x32x16_bf16 v[132:147], v[116:119], v[36:39], v[132:147]
    v_mfma_f32_32x32x16_bf16 v[164:179], v[84:87], v[36:39], v[164:179]
    v_mfma_f32_32x32x16_bf16 v[132:147], v[88:91], v[8:11], v[132:147]
    v_mfma_f32_32x32x16_bf16 v[164:179], v[104:107], v[8:11], v[164:179]
    v_mfma_f32_32x32x16_bf16 v[132:147], v[120:123], v[40:43], v[132:147]
    v_mfma_f32_32x32x16_bf16 v[164:179], v[88:91], v[40:43], v[164:179]
    v_mfma_f32_32x32x16_bf16 v[132:147], v[92:95], v[12:15], v[132:147]
    v_mfma_f32_32x32x16_bf16 v[164:179], v[108:111], v[12:15], v[164:179]
    v_mfma_f32_32x32x16_bf16 v[132:147], v[124:127], v[44:47], v[132:147]
    v_mfma_f32_32x32x16_bf16 v[164:179], v[92:95], v[44:47], v[164:179]
    v_mfma_f32_32x32x16_bf16 v[132:147], v[96:99], v[16:19], v[132:147]
    v_mfma_f32_32x32x16_bf16 v[164:179], v[112:115], v[16:19], v[164:179]
    v_mfma_f32_32x32x16_bf16 v[132:147], v[128:131], v[48:51], v[132:147]
    v_mfma_f32_32x32x16_bf16 v[164:179], v[96:99], v[48:51], v[164:179]
    v_mfma_f32_32x32x16_bf16 v[148:163], v[84:87], v[20:23], 0
    v_mfma_f32_32x32x16_bf16 v[180:195], v[100:103], v[20:23], 0
    v_mfma_f32_32x32x16_bf16 v[148:163], v[116:119], v[52:55], v[148:163]
    v_mfma_f32_32x32x16_bf16 v[180:195], v[84:87], v[52:55], v[180:195]
    v_mfma_f32_32x32x16_bf16 v[148:163], v[88:91], v[24:27], v[148:163]
    v_mfma_f32_32x32x16_bf16 v[180:195], v[104:107], v[24:27], v[180:195]
    v_mfma_f32_32x32x16_bf16 v[148:163], v[120:123], v[56:59], v[148:163]
    v_mfma_f32_32x32x16_bf16 v[180:195], v[88:91], v[56:59], v[180:195]
    v_mfma_f32_32x32x16_bf16 v[148:163], v[92:95], v[28:31], v[148:163]
    v_mfma_f32_32x32x16_bf16 v[180:195], v[108:111], v[28:31], v[180:195]
    v_mfma_f32_32x32x16_bf16 v[148:163], v[124:127], v[60:63], v[148:163]
    v_mfma_f32_32x32x16_bf16 v[180:195], v[92:95], v[60:63], v[180:195]
    v_mfma_f32_32x32x16_bf16 v[148:163], v[96:99], v[32:35], v[148:163]
    v_mfma_f32_32x32x16_bf16 v[180:195], v[112:115], v[32:35], v[180:195]
    v_mfma_f32_32x32x16_bf16 v[148:163], v[128:131], v[64:67], v[148:163]
    v_mfma_f32_32x32x16_bf16 v[180:195], v[96:99], v[64:67], v[180:195]
    v_fmamk_f32 v243, v228, 0x0, v229
    v_cos_f32 v239, v243
    v_sin_f32 v240, v243
    v_mul_f32 v235, v132, v239
    v_mul_f32 v237, v164, v239
    v_fma_f32 v235, -v164, v240, v235
    v_fma_f32 v237, v132, v240, v237
    v_fmamk_f32 v243, v228, 0x3a000000, v229
    v_cos_f32 v241, v243
    v_sin_f32 v242, v243
    v_mul_f32 v236, v133, v241
    v_mul_f32 v238, v165, v241
    v_fma_f32 v236, -v165, v242, v236
    v_fma_f32 v238, v133, v242, v238
    v_cvt_pk_bf16_f32 v84, v235, v236
    v_cvt_pk_bf16_f32 v100, v237, v238
    v_cvt_pk_bf16_f32 v116, -v237, -v238
    v_fmamk_f32 v243, v228, 0x3a800000, v229
    v_cos_f32 v239, v243
    v_sin_f32 v240, v243
    v_mul_f32 v235, v134, v239
    v_mul_f32 v237, v166, v239
    v_fma_f32 v235, -v166, v240, v235
    v_fma_f32 v237, v134, v240, v237
    v_fmamk_f32 v243, v228, 0x3ac00000, v229
    v_cos_f32 v241, v243
    v_sin_f32 v242, v243
    v_mul_f32 v236, v135, v241
    v_mul_f32 v238, v167, v241
    v_fma_f32 v236, -v167, v242, v236
    v_fma_f32 v238, v135, v242, v238
    v_cvt_pk_bf16_f32 v85, v235, v236
    v_cvt_pk_bf16_f32 v101, v237, v238
    v_cvt_pk_bf16_f32 v117, -v237, -v238
    v_fmamk_f32 v243, v228, 0x3b800000, v229
    v_cos_f32 v239, v243
    v_sin_f32 v240, v243
    v_mul_f32 v235, v136, v239
    v_mul_f32 v237, v168, v239
    v_fma_f32 v235, -v168, v240, v235
    v_fma_f32 v237, v136, v240, v237
    v_fmamk_f32 v243, v228, 0x3b900000, v229
    v_cos_f32 v241, v243
    v_sin_f32 v242, v243
    v_mul_f32 v236, v137, v241
    v_mul_f32 v238, v169, v241
    v_fma_f32 v236, -v169, v242, v236
    v_fma_f32 v238, v137, v242, v238
    v_cvt_pk_bf16_f32 v86, v235, v236
    v_cvt_pk_bf16_f32 v102, v237, v238
    v_cvt_pk_bf16_f32 v118, -v237, -v238
    v_fmamk_f32 v243, v228, 0x3ba00000, v229
    v_cos_f32 v239, v243
    v_sin_f32 v240, v243
    v_mul_f32 v235, v138, v239
    v_mul_f32 v237, v170, v239
    v_fma_f32 v235, -v170, v240, v235
    v_fma_f32 v237, v138, v240, v237
    v_fmamk_f32 v243, v228, 0x3bb00000, v229
    v_cos_f32 v241, v243
    v_sin_f32 v242, v243
    v_mul_f32 v236, v139, v241
    v_mul_f32 v238, v171, v241
    v_fma_f32 v236, -v171, v242, v236
    v_fma_f32 v238, v139, v242, v238
    v_cvt_pk_bf16_f32 v87, v235, v236
    v_cvt_pk_bf16_f32 v103, v237, v238
    v_cvt_pk_bf16_f32 v119, -v237, -v238
    v_fmamk_f32 v243, v228, 0x3c000000, v229
    v_cos_f32 v239, v243
    v_sin_f32 v240, v243
    v_mul_f32 v235, v140, v239
    v_mul_f32 v237, v172, v239
    v_fma_f32 v235, -v172, v240, v235
    v_fma_f32 v237, v140, v240, v237
    v_fmamk_f32 v243, v228, 0x3c080000, v229
    v_cos_f32 v241, v243
    v_sin_f32 v242, v243
    v_mul_f32 v236, v141, v241
    v_mul_f32 v238, v173, v241
    v_fma_f32 v236, -v173, v242, v236
    v_fma_f32 v238, v141, v242, v238
    v_cvt_pk_bf16_f32 v88, v235, v236
    v_cvt_pk_bf16_f32 v104, v237, v238
    v_cvt_pk_bf16_f32 v120, -v237, -v238
    v_fmamk_f32 v243, v228, 0x3c100000, v229
    v_cos_f32 v239, v243
    v_sin_f32 v240, v243
    v_mul_f32 v235, v142, v239
    v_mul_f32 v237, v174, v239
    v_fma_f32 v235, -v174, v240, v235
    v_fma_f32 v237, v142, v240, v237
    v_fmamk_f32 v243, v228, 0x3c180000, v229
    v_cos_f32 v241, v243
    v_sin_f32 v242, v243
    v_mul_f32 v236, v143, v241
    v_mul_f32 v238, v175, v241
    v_fma_f32 v236, -v175, v242, v236
    v_fma_f32 v238, v143, v242, v238
    v_cvt_pk_bf16_f32 v89, v235, v236
    v_cvt_pk_bf16_f32 v105, v237, v238
    v_cvt_pk_bf16_f32 v121, -v237, -v238
    v_fmamk_f32 v243, v228, 0x3c400000, v229
    v_cos_f32 v239, v243
    v_sin_f32 v240, v243
    v_mul_f32 v235, v144, v239
    v_mul_f32 v237, v176, v239
    v_fma_f32 v235, -v176, v240, v235
    v_fma_f32 v237, v144, v240, v237
    v_fmamk_f32 v243, v228, 0x3c480000, v229
    v_cos_f32 v241, v243
    v_sin_f32 v242, v243
    v_mul_f32 v236, v145, v241
    v_mul_f32 v238, v177, v241
    v_fma_f32 v236, -v177, v242, v236
    v_fma_f32 v238, v145, v242, v238
    v_cvt_pk_bf16_f32 v90, v235, v236
    v_cvt_pk_bf16_f32 v106, v237, v238
    v_cvt_pk_bf16_f32 v122, -v237, -v238
    v_fmamk_f32 v243, v228, 0x3c500000, v229
    v_cos_f32 v239, v243
    v_sin_f32 v240, v243
    v_mul_f32 v235, v146, v239
    v_mul_f32 v237, v178, v239
    v_fma_f32 v235, -v178, v240, v235
    v_fma_f32 v237, v146, v240, v237
    v_fmamk_f32 v243, v228, 0x3c580000, v229
    v_cos_f32 v241, v243
    v_sin_f32 v242, v243
    v_mul_f32 v236, v147, v241
    v_mul_f32 v238, v179, v241
    v_fma_f32 v236, -v179, v242, v236
    v_fma_f32 v238, v147, v242, v238
    v_cvt_pk_bf16_f32 v91, v235, v236
    v_cvt_pk_bf16_f32 v107, v237, v238
    v_cvt_pk_bf16_f32 v123, -v237, -v238
    v_add_f32 v228, 0x42000000, v228
    v_mov_b32 v229, v230
    v_fmamk_f32 v243, v228, 0x0, v229
    v_cos_f32 v239, v243
    v_sin_f32 v240, v243
    v_mul_f32 v235, v148, v239
    v_mul_f32 v237, v180, v239
    v_fma_f32 v235, -v180, v240, v235
    v_fma_f32 v237, v148, v240, v237
    v_fmamk_f32 v243, v228, 0x3a000000, v229
    v_cos_f32 v241, v243
    v_sin_f32 v242, v243
    v_mul_f32 v236, v149, v241
    v_mul_f32 v238, v181, v241
    v_fma_f32 v236, -v181, v242, v236
    v_fma_f32 v238, v149, v242, v238
    v_cvt_pk_bf16_f32 v92, v235, v236
    v_cvt_pk_bf16_f32 v108, v237, v238
    v_cvt_pk_bf16_f32 v124, -v237, -v238
    v_fmamk_f32 v243, v228, 0x3a800000, v229
    v_cos_f32 v239, v243
    v_sin_f32 v240, v243
    v_mul_f32 v235, v150, v239
    v_mul_f32 v237, v182, v239
    v_fma_f32 v235, -v182, v240, v235
    v_fma_f32 v237, v150, v240, v237
    v_fmamk_f32 v243, v228, 0x3ac00000, v229
    v_cos_f32 v241, v243
    v_sin_f32 v242, v243
    v_mul_f32 v236, v151, v241
    v_mul_f32 v238, v183, v241
    v_fma_f32 v236, -v183, v242, v236
    v_fma_f32 v238, v151, v242, v238
    v_cvt_pk_bf16_f32 v93, v235, v236
    v_cvt_pk_bf16_f32 v109, v237, v238
    v_cvt_pk_bf16_f32 v125, -v237, -v238
    v_fmamk_f32 v243, v228, 0x3b800000, v229
    v_cos_f32 v239, v243
    v_sin_f32 v240, v243
    v_mul_f32 v235, v152, v239
    v_mul_f32 v237, v184, v239
    v_fma_f32 v235, -v184, v240, v235
    v_fma_f32 v237, v152, v240, v237
    v_fmamk_f32 v243, v228, 0x3b900000, v229
    v_cos_f32 v241, v243
    v_sin_f32 v242, v243
    v_mul_f32 v236, v153, v241
    v_mul_f32 v238, v185, v241
    v_fma_f32 v236, -v185, v242, v236
    v_fma_f32 v238, v153, v242, v238
    v_cvt_pk_bf16_f32 v94, v235, v236
    v_cvt_pk_bf16_f32 v110, v237, v238
    v_cvt_pk_bf16_f32 v126, -v237, -v238
    v_fmamk_f32 v243, v228, 0x3ba00000, v229
    v_cos_f32 v239, v243
    v_sin_f32 v240, v243
    v_mul_f32 v235, v154, v239
    v_mul_f32 v237, v186, v239
    v_fma_f32 v235, -v186, v240, v235
    v_fma_f32 v237, v154, v240, v237
    v_fmamk_f32 v243, v228, 0x3bb00000, v229
    v_cos_f32 v241, v243
    v_sin_f32 v242, v243
    v_mul_f32 v236, v155, v241
    v_mul_f32 v238, v187, v241
    v_fma_f32 v236, -v187, v242, v236
    v_fma_f32 v238, v155, v242, v238
    v_cvt_pk_bf16_f32 v95, v235, v236
    v_cvt_pk_bf16_f32 v111, v237, v238
    v_cvt_pk_bf16_f32 v127, -v237, -v238
    v_fmamk_f32 v243, v228, 0x3c000000, v229
    v_cos_f32 v239, v243
    v_sin_f32 v240, v243
    v_mul_f32 v235, v156, v239
    v_mul_f32 v237, v188, v239
    v_fma_f32 v235, -v188, v240, v235
    v_fma_f32 v237, v156, v240, v237
    v_fmamk_f32 v243, v228, 0x3c080000, v229
    v_cos_f32 v241, v243
    v_sin_f32 v242, v243
    v_mul_f32 v236, v157, v241
    v_mul_f32 v238, v189, v241
    v_fma_f32 v236, -v189, v242, v236
    v_fma_f32 v238, v157, v242, v238
    v_cvt_pk_bf16_f32 v96, v235, v236
    v_cvt_pk_bf16_f32 v112, v237, v238
    v_cvt_pk_bf16_f32 v128, -v237, -v238
    v_fmamk_f32 v243, v228, 0x3c100000, v229
    v_cos_f32 v239, v243
    v_sin_f32 v240, v243
    v_mul_f32 v235, v158, v239
    v_mul_f32 v237, v190, v239
    v_fma_f32 v235, -v190, v240, v235
    v_fma_f32 v237, v158, v240, v237
    v_fmamk_f32 v243, v228, 0x3c180000, v229
    v_cos_f32 v241, v243
    v_sin_f32 v242, v243
    v_mul_f32 v236, v159, v241
    v_mul_f32 v238, v191, v241
    v_fma_f32 v236, -v191, v242, v236
    v_fma_f32 v238, v159, v242, v238
    v_cvt_pk_bf16_f32 v97, v235, v236
    v_cvt_pk_bf16_f32 v113, v237, v238
    v_cvt_pk_bf16_f32 v129, -v237, -v238
    v_fmamk_f32 v243, v228, 0x3c400000, v229
    v_cos_f32 v239, v243
    v_sin_f32 v240, v243
    v_mul_f32 v235, v160, v239
    v_mul_f32 v237, v192, v239
    v_fma_f32 v235, -v192, v240, v235
    v_fma_f32 v237, v160, v240, v237
    v_fmamk_f32 v243, v228, 0x3c480000, v229
    v_cos_f32 v241, v243
    v_sin_f32 v242, v243
    v_mul_f32 v236, v161, v241
    v_mul_f32 v238, v193, v241
    v_fma_f32 v236, -v193, v242, v236
    v_fma_f32 v238, v161, v242, v238
    v_cvt_pk_bf16_f32 v98, v235, v236
    v_cvt_pk_bf16_f32 v114, v237, v238
    v_cvt_pk_bf16_f32 v130, -v237, -v238
    v_fmamk_f32 v243, v228, 0x3c500000, v229
    v_cos_f32 v239, v243
    v_sin_f32 v240, v243
    v_mul_f32 v235, v162, v239
    v_mul_f32 v237, v194, v239
    v_fma_f32 v235, -v194, v240, v235
    v_fma_f32 v237, v162, v240, v237
    v_fmamk_f32 v243, v228, 0x3c580000, v229
    v_cos_f32 v241, v243
    v_sin_f32 v242, v243
    v_mul_f32 v236, v163, v241
    v_mul_f32 v238, v195, v241
    v_fma_f32 v236, -v195, v242, v236
    v_fma_f32 v238, v163, v242, v238
    v_cvt_pk_bf16_f32 v99, v235, v236
    v_cvt_pk_bf16_f32 v115, v237, v238
    v_cvt_pk_bf16_f32 v131, -v237, -v238
    v_mfma_f32_32x32x16_bf16 v[132:147], v[68:71], v[84:87], 0
    v_mfma_f32_32x32x16_bf16 v[164:179], v[68:71], v[100:103], 0
    v_mfma_f32_32x32x16_bf16 v[132:147], v[76:79], v[116:119], v[132:147]
    v_mfma_f32_32x32x16_bf16 v[164:179], v[76:79], v[84:87], v[164:179]
    v_mfma_f32_32x32x16_bf16 v[132:147], v[72:75], v[88:91], v[132:147]
    v_mfma_f32_32x32x16_bf16 v[164:179], v[72:75], v[104:107], v[164:179]
    v_mfma_f32_32x32x16_bf16 v[132:147], v[80:83], v[120:123], v[132:147]
    v_mfma_f32_32x32x16_bf16 v[164:179], v[80:83], v[88:91], v[164:179]
    v_mfma_f32_32x32x16_bf16 v[148:163], v[68:71], v[92:95], 0
    v_mfma_f32_32x32x16_bf16 v[180:195], v[68:71], v[108:111], 0
    v_mfma_f32_32x32x16_bf16 v[148:163], v[76:79], v[124:127], v[148:163]
    v_mfma_f32_32x32x16_bf16 v[180:195], v[76:79], v[92:95], v[180:195]
    v_mfma_f32_32x32x16_bf16 v[148:163], v[72:75], v[96:99], v[148:163]
    v_mfma_f32_32x32x16_bf16 v[180:195], v[72:75], v[112:115], v[180:195]
    v_mfma_f32_32x32x16_bf16 v[148:163], v[80:83], v[128:131], v[148:163]
    v_mfma_f32_32x32x16_bf16 v[180:195], v[80:83], v[96:99], v[180:195]
    v_lshlrev_b32 v231, 4, v1
    v_add_u32 v232, s6, v231
    s_lshl_b32 s5, s3, 12
    s_add_u32 s5, s5, 0x5800000
    s_add_u32 s2, s5, 4096
    v_cvt_pk_bf16_f32 v84, v132, v133
    v_cvt_pk_bf16_f32 v85, v134, v135
    v_cvt_pk_bf16_f32 v86, v136, v137
    v_cvt_pk_bf16_f32 v87, v138, v139
    buffer_store_dwordx4 v[84:87], v231, s[8:11], s5 offen offset:0 sc1
    v_cvt_pk_bf16_f32 v88, v140, v141
    v_cvt_pk_bf16_f32 v89, v142, v143
    v_cvt_pk_bf16_f32 v90, v144, v145
    v_cvt_pk_bf16_f32 v91, v146, v147
    buffer_store_dwordx4 v[88:91], v231, s[8:11], s5 offen offset:1024 sc1
    v_cvt_pk_bf16_f32 v92, v148, v149
    v_cvt_pk_bf16_f32 v93, v150, v151
    v_cvt_pk_bf16_f32 v94, v152, v153
    v_cvt_pk_bf16_f32 v95, v154, v155
    buffer_store_dwordx4 v[92:95], v231, s[8:11], s5 offen offset:2048 sc1
    v_cvt_pk_bf16_f32 v96, v156, v157
    v_cvt_pk_bf16_f32 v97, v158, v159
    v_cvt_pk_bf16_f32 v98, v160, v161
    v_cvt_pk_bf16_f32 v99, v162, v163
    buffer_store_dwordx4 v[96:99], v231, s[8:11], s5 offen offset:3072 sc1
    v_cvt_pk_bf16_f32 v100, v164, v165
    v_cvt_pk_bf16_f32 v101, v166, v167
    v_cvt_pk_bf16_f32 v102, v168, v169
    v_cvt_pk_bf16_f32 v103, v170, v171
    buffer_store_dwordx4 v[100:103], v232, s[8:11], s2 offen offset:0 sc1
    v_cvt_pk_bf16_f32 v104, v172, v173
    v_cvt_pk_bf16_f32 v105, v174, v175
    v_cvt_pk_bf16_f32 v106, v176, v177
    v_cvt_pk_bf16_f32 v107, v178, v179
    buffer_store_dwordx4 v[104:107], v232, s[8:11], s2 offen offset:1024 sc1
    v_cvt_pk_bf16_f32 v108, v180, v181
    v_cvt_pk_bf16_f32 v109, v182, v183
    v_cvt_pk_bf16_f32 v110, v184, v185
    v_cvt_pk_bf16_f32 v111, v186, v187
    buffer_store_dwordx4 v[108:111], v232, s[8:11], s2 offen offset:2048 sc1
    v_cvt_pk_bf16_f32 v112, v188, v189
    v_cvt_pk_bf16_f32 v113, v190, v191
    v_cvt_pk_bf16_f32 v114, v192, v193
    v_cvt_pk_bf16_f32 v115, v194, v195
    buffer_store_dwordx4 v[112:115], v232, s[8:11], s2 offen offset:3072 sc1
    s_add_u32 s7, s7, 8
    s_cmp_lt_u32 s7, 16
    s_cbranch_scc1 colloop_119
    s_cmp_eq_u32 s3, 1008
    s_cbranch_scc1 colloop_119
    s_waitcnt vmcnt(0) lgkmcnt(0)
    s_barrier
    s_cmp_lg_u32 s58, 0
    s_cbranch_scc1 sig_121
    v_mov_b32 v75, 0x5ffffff0
    v_mov_b32 v76, 44
    v_cmp_eq_u32 vcc, 0, v1
    s_nop 1
    v_cndmask_b32 v76, v75, v76, vcc
    v_mov_b32 v75, 1
    buffer_atomic_add v75, v76, s[12:15], 0 offen sc1
sig_121:
    v_bfe_u32 v76, v1, 2, 2
    v_sub_u32 v76, 0, v76
    v_lshrrev_b32 v75, 4, v1
    v_xor_b32 v76, v76, v75
    v_and_b32 v76, 3, v76
    v_bfe_u32 v72, v1, 0, 4
    v_lshlrev_b32 v72, 6, v72
    v_lshl_or_b32 v72, v76, 4, v72
    s_lshr_b32 s74, s58, 2
    s_mul_i32 s74, s74, 8192
    v_add_u32 v72, s74, v72
    v_bfe_u32 v73, v1, 0, 2
    v_lshlrev_b32 v73, 3, v73
    v_bfe_u32 v75, v1, 4, 1
    v_lshl_or_b32 v73, v75, 5, v73
    v_bfe_u32 v75, v1, 2, 2
    v_lshl_or_b32 v73, v75, 6, v73
    v_bfe_u32 v75, v1, 2, 2
    v_lshl_or_b32 v73, v75, 9, v73
    v_bfe_u32 v75, v1, 4, 2
    v_lshl_or_b32 v73, v75, 12, v73
    s_and_b32 s74, s58, 3
    s_mul_i32 s74, s74, 128
    s_or_b32 s74, s74, 16384
    v_xor_b32 v73, s74, v73
    s_mov_b64 s[60:61], s[8:9]
    s_mov_b32 s62, 0x10000000
    s_mov_b32 s63, 0x20000
    s_mov_b64 s[64:65], s[8:9]
    s_mov_b32 s66, 0x10000000
    s_mov_b32 s67, 0x20000
    v_lshrrev_b32 v76, 4, v1
    v_sub_u32 v76, 0, v76
    v_xor_b32 v76, v76, v1
    v_and_b32 v76, 3, v76
    s_mul_i32 s74, s58, 32
    v_lshrrev_b32 v77, 2, v1
    v_add3_u32 v77, v77, s74, 0
    v_bfe_u32 v68, v77, 0, 2
    v_lshlrev_b32 v68, 11, v68
    v_bfe_u32 v75, v77, 4, 1
    v_lshl_or_b32 v68, v75, 13, v68
    v_bfe_u32 v75, v77, 2, 2
    v_lshl_or_b32 v68, v75, 14, v68
    v_bfe_u32 v75, v77, 5, 3
    v_lshl_or_b32 v68, v75, 16, v68
    v_lshl_add_u32 v68, v76, 4, v68
    v_lshrrev_b32 v77, 2, v1
    v_add3_u32 v77, v77, s74, 16
    v_bfe_u32 v69, v77, 0, 2
    v_lshlrev_b32 v69, 11, v69
    v_bfe_u32 v75, v77, 4, 1
    v_lshl_or_b32 v69, v75, 13, v69
    v_bfe_u32 v75, v77, 2, 2
    v_lshl_or_b32 v69, v75, 14, v69
    v_bfe_u32 v75, v77, 5, 3
    v_lshl_or_b32 v69, v75, 16, v69
    v_lshl_add_u32 v69, v76, 4, v69
    s_and_b32 s74, s58, 2
    v_bfe_u32 v76, v1, 0, 5
    v_bfe_u32 v77, v1, 5, 1
    v_lshlrev_b32 v77, 2, v77
    v_xor_b32 v76, v76, v77
    v_xor_b32 v76, s74, v76
    v_lshlrev_b32 v77, 4, v76
    v_lshrrev_b32 v76, 5, v1
    v_lshl_add_u32 v70, v76, 12, v77
    v_bfe_u32 v76, v1, 0, 5
    v_bfe_u32 v77, v1, 5, 1
    v_lshlrev_b32 v77, 2, v77
    v_xor_b32 v76, v76, v77
    v_xor_b32 v76, s74, v76
    v_xor_b32 v76, 8, v76
    v_lshlrev_b32 v77, 4, v76
    v_lshrrev_b32 v76, 5, v1
    v_lshl_add_u32 v71, v76, 12, v77
    v_add_u32 v71, 8192, v71
    s_lshl_b32 s74, s58, 14
    v_add_u32 v70, s74, v70
    v_add_u32 v71, s74, v71
    s_mov_b32 s70, 131072
    s_and_b32 s79, s57, 3
    s_bfe_u32 s80, s76, 0x10002
    s_bfe_u32 s85, s76, 0x20005
    s_lshl_b32 s85, s85, 1
    s_or_b32 s80, s80, s85
    s_lshl_b32 s68, s79, 19
    s_add_u32 s68, s68, 0x5200000
    s_lshl_b32 s69, s80, 9
    s_add_u32 s69, s69, 0x5800000
    s_cmp_lg_u32 s58, 0
    s_cbranch_scc1 wall_122
    v_mov_b32 v76, 136
wctr_123:
    buffer_load_dword v75, v76, s[12:15], 0 offen sc1
    s_waitcnt vmcnt(0)
    v_cmp_ne_u32 vcc, 2097216, v75
    s_cbranch_vccz wctr_ok_124
    s_sub_u32 s77, s77, 1
    s_cbranch_scc0 wctr_123
    s_mov_b32 s77, 0
wctr_ok_124:
wall_122:
    s_cmp_lg_u32 s58, 0
    s_cbranch_scc1 wall_125
    v_mov_b32 v76, 44
wctr_126:
    buffer_load_dword v75, v76, s[12:15], 0 offen sc1
    s_waitcnt vmcnt(0)
    v_cmp_gt_u16 vcc, 32, v75
    s_cbranch_vccz wctr_ok_127
    s_sub_u32 s77, s77, 1
    s_cbranch_scc0 wctr_126
    s_mov_b32 s77, 0
wctr_ok_127:
wall_125:
    s_barrier
    s_mul_i32 s71, s58, 2048
    s_mov_b32 m0, s71
    s_nop 0
    buffer_load_dwordx4 v68, s[60:63], s68 offen lds
    s_add_u32 m0, s71, 1024
    s_nop 0
    buffer_load_dwordx4 v69, s[60:63], s68 offen lds
    s_add_u32 m0, s71, 16384
    s_nop 0
    buffer_load_dwordx4 v70, s[64:67], s69 offen lds
    s_add_u32 m0, s71, 17408
    s_nop 0
    buffer_load_dwordx4 v71, s[64:67], s69 offen lds
    s_add_u32 s68, s68, 64
    s_add_u32 s69, s69, s70
    s_add_u32 s71, s71, 32768
    s_and_b32 s71, s71, 0x1ffff
    s_mov_b32 m0, s71
    s_nop 0
    buffer_load_dwordx4 v68, s[60:63], s68 offen lds
    s_add_u32 m0, s71, 1024
    s_nop 0
    buffer_load_dwordx4 v69, s[60:63], s68 offen lds
    s_add_u32 m0, s71, 16384
    s_nop 0
    buffer_load_dwordx4 v70, s[64:67], s69 offen lds
    s_add_u32 m0, s71, 17408
    s_nop 0
    buffer_load_dwordx4 v71, s[64:67], s69 offen lds
    s_add_u32 s68, s68, 64
    s_add_u32 s69, s69, s70
    s_add_u32 s71, s71, 32768
    s_and_b32 s71, s71, 0x1ffff
    s_mov_b32 m0, s71
    s_nop 0
    buffer_load_dwordx4 v68, s[60:63], s68 offen lds
    s_add_u32 m0, s71, 1024
    s_nop 0
    buffer_load_dwordx4 v69, s[60:63], s68 offen lds
    s_add_u32 m0, s71, 16384
    s_nop 0
    buffer_load_dwordx4 v70, s[64:67], s69 offen lds
    s_add_u32 m0, s71, 17408
    s_nop 0
    buffer_load_dwordx4 v71, s[64:67], s69 offen lds
    s_add_u32 s68, s68, 64
    s_add_u32 s69, s69, s70
    s_add_u32 s71, s71, 32768
    s_and_b32 s71, s71, 0x1ffff
    s_mov_b32 m0, s71
    s_nop 0
    buffer_load_dwordx4 v68, s[60:63], s68 offen lds
    s_add_u32 m0, s71, 1024
    s_nop 0
    buffer_load_dwordx4 v69, s[60:63], s68 offen lds
    s_add_u32 m0, s71, 16384
    s_nop 0
    buffer_load_dwordx4 v70, s[64:67], s69 offen lds
    s_add_u32 m0, s71, 17408
    s_nop 0
    buffer_load_dwordx4 v71, s[64:67], s69 offen lds
    s_add_u32 s68, s68, 64
    s_add_u32 s69, s69, s70
    s_add_u32 s71, s71, 32768
    s_and_b32 s71, s71, 0x1ffff
    s_mov_b32 s72, 0
    s_waitcnt vmcnt(12)
    s_barrier
    v_add_u32 v74, s72, v72
    v_add_u32 v75, s72, v73
    v_xor_b32 v76, 32, v75
    v_xor_b32 v77, 64, v75
    v_xor_b32 v78, 96, v75
    s_add_u32 s72, s72, 32768
    s_and_b32 s72, s72, 0x1ffff
    ds_read_b128 v[4:7], v74 offset:0
    ds_read_b128 v[8:11], v74 offset:1024
    ds_read_b128 v[12:15], v74 offset:2048
    ds_read_b128 v[16:19], v74 offset:3072
    ds_read_b64_tr_b16 v[36:37], v75 offset:0
    ds_read_b64_tr_b16 v[38:39], v75 offset:2048
    ds_read_b64_tr_b16 v[40:41], v76 offset:0
    ds_read_b64_tr_b16 v[42:43], v76 offset:2048
    ds_read_b64_tr_b16 v[44:45], v77 offset:0
    ds_read_b64_tr_b16 v[46:47], v77 offset:2048
    ds_read_b64_tr_b16 v[48:49], v78 offset:0
    ds_read_b64_tr_b16 v[50:51], v78 offset:2048
    s_waitcnt lgkmcnt(0)
    v_mfma_f32_16x16x32_bf16 v[80:83], v[4:7], v[36:39], 0
    ds_read_b128 v[20:23], v74 offset:4096
    v_mfma_f32_16x16x32_bf16 v[84:87], v[4:7], v[40:43], 0
    v_mfma_f32_16x16x32_bf16 v[88:91], v[4:7], v[44:47], 0
    ds_read_b128 v[24:27], v74 offset:5120
    v_mfma_f32_16x16x32_bf16 v[92:95], v[4:7], v[48:51], 0
    v_mfma_f32_16x16x32_bf16 v[96:99], v[8:11], v[36:39], 0
    ds_read_b128 v[28:31], v74 offset:6144
    v_mfma_f32_16x16x32_bf16 v[100:103], v[8:11], v[40:43], 0
    v_mfma_f32_16x16x32_bf16 v[104:107], v[8:11], v[44:47], 0
    ds_read_b128 v[32:35], v74 offset:7168
    v_mfma_f32_16x16x32_bf16 v[108:111], v[8:11], v[48:51], 0
    v_mfma_f32_16x16x32_bf16 v[112:115], v[12:15], v[36:39], 0
    v_mfma_f32_16x16x32_bf16 v[116:119], v[12:15], v[40:43], 0
    v_mfma_f32_16x16x32_bf16 v[120:123], v[12:15], v[44:47], 0
    v_mfma_f32_16x16x32_bf16 v[124:127], v[12:15], v[48:51], 0
    v_mfma_f32_16x16x32_bf16 v[128:131], v[16:19], v[36:39], 0
    v_mfma_f32_16x16x32_bf16 v[132:135], v[16:19], v[40:43], 0
    v_mfma_f32_16x16x32_bf16 v[136:139], v[16:19], v[44:47], 0
    v_mfma_f32_16x16x32_bf16 v[140:143], v[16:19], v[48:51], 0
    s_waitcnt vmcnt(8) lgkmcnt(0)
    s_barrier
    v_mfma_f32_16x16x32_bf16 v[144:147], v[20:23], v[36:39], 0
    v_add_u32 v74, s72, v72
    v_add_u32 v75, s72, v73
    v_xor_b32 v76, 32, v75
    v_xor_b32 v77, 64, v75
    v_xor_b32 v78, 96, v75
    v_mfma_f32_16x16x32_bf16 v[148:151], v[20:23], v[40:43], 0
    s_add_u32 s72, s72, 32768
    s_and_b32 s72, s72, 0x1ffff
    ds_read_b128 v[4:7], v74 offset:0
    v_mfma_f32_16x16x32_bf16 v[152:155], v[20:23], v[44:47], 0
    ds_read_b64_tr_b16 v[52:53], v75 offset:0
    v_mfma_f32_16x16x32_bf16 v[156:159], v[20:23], v[48:51], 0
    ds_read_b64_tr_b16 v[54:55], v75 offset:2048
    ds_read_b64_tr_b16 v[56:57], v76 offset:0
    v_mfma_f32_16x16x32_bf16 v[160:163], v[24:27], v[36:39], 0
    ds_read_b64_tr_b16 v[58:59], v76 offset:2048
    v_mfma_f32_16x16x32_bf16 v[164:167], v[24:27], v[40:43], 0
    ds_read_b64_tr_b16 v[60:61], v77 offset:0
    ds_read_b64_tr_b16 v[62:63], v77 offset:2048
    v_mfma_f32_16x16x32_bf16 v[168:171], v[24:27], v[44:47], 0
    ds_read_b64_tr_b16 v[64:65], v78 offset:0
    v_mfma_f32_16x16x32_bf16 v[172:175], v[24:27], v[48:51], 0
    ds_read_b64_tr_b16 v[66:67], v78 offset:2048
    ds_read_b128 v[8:11], v74 offset:1024
    v_mfma_f32_16x16x32_bf16 v[176:179], v[28:31], v[36:39], 0
    ds_read_b128 v[12:15], v74 offset:2048
    ds_read_b128 v[16:19], v74 offset:3072
    v_mfma_f32_16x16x32_bf16 v[180:183], v[28:31], v[40:43], 0
    s_mov_b32 m0, s71
    v_mfma_f32_16x16x32_bf16 v[184:187], v[28:31], v[44:47], 0
    buffer_load_dwordx4 v68, s[60:63], s68 offen lds
    s_add_u32 m0, s71, 1024
    v_mfma_f32_16x16x32_bf16 v[188:191], v[28:31], v[48:51], 0
    buffer_load_dwordx4 v69, s[60:63], s68 offen lds
    v_mfma_f32_16x16x32_bf16 v[192:195], v[32:35], v[36:39], 0
    s_add_u32 m0, s71, 16384
    s_nop 0
    buffer_load_dwordx4 v70, s[64:67], s69 offen lds
    v_mfma_f32_16x16x32_bf16 v[196:199], v[32:35], v[40:43], 0
    s_add_u32 m0, s71, 17408
    v_mfma_f32_16x16x32_bf16 v[200:203], v[32:35], v[44:47], 0
    buffer_load_dwordx4 v71, s[64:67], s69 offen lds
    s_add_u32 s68, s68, 64
    s_add_u32 s69, s69, s70
    v_mfma_f32_16x16x32_bf16 v[204:207], v[32:35], v[48:51], 0
    s_add_u32 s71, s71, 32768
    s_and_b32 s71, s71, 0x1ffff
    s_waitcnt lgkmcnt(0)
    v_mfma_f32_16x16x32_bf16 v[80:83], v[4:7], v[52:55], v[80:83]
    ds_read_b128 v[20:23], v74 offset:4096
    v_mfma_f32_16x16x32_bf16 v[84:87], v[4:7], v[56:59], v[84:87]
    v_mfma_f32_16x16x32_bf16 v[88:91], v[4:7], v[60:63], v[88:91]
    ds_read_b128 v[24:27], v74 offset:5120
    v_mfma_f32_16x16x32_bf16 v[92:95], v[4:7], v[64:67], v[92:95]
    v_mfma_f32_16x16x32_bf16 v[96:99], v[8:11], v[52:55], v[96:99]
    ds_read_b128 v[28:31], v74 offset:6144
    v_mfma_f32_16x16x32_bf16 v[100:103], v[8:11], v[56:59], v[100:103]
    v_mfma_f32_16x16x32_bf16 v[104:107], v[8:11], v[60:63], v[104:107]
    ds_read_b128 v[32:35], v74 offset:7168
    v_mfma_f32_16x16x32_bf16 v[108:111], v[8:11], v[64:67], v[108:111]
    v_mfma_f32_16x16x32_bf16 v[112:115], v[12:15], v[52:55], v[112:115]
    v_mfma_f32_16x16x32_bf16 v[116:119], v[12:15], v[56:59], v[116:119]
    v_mfma_f32_16x16x32_bf16 v[120:123], v[12:15], v[60:63], v[120:123]
    v_mfma_f32_16x16x32_bf16 v[124:127], v[12:15], v[64:67], v[124:127]
    v_mfma_f32_16x16x32_bf16 v[128:131], v[16:19], v[52:55], v[128:131]
    v_mfma_f32_16x16x32_bf16 v[132:135], v[16:19], v[56:59], v[132:135]
    v_mfma_f32_16x16x32_bf16 v[136:139], v[16:19], v[60:63], v[136:139]
    v_mfma_f32_16x16x32_bf16 v[140:143], v[16:19], v[64:67], v[140:143]
    s_waitcnt vmcnt(8) lgkmcnt(0)
    s_barrier
    v_mfma_f32_16x16x32_bf16 v[144:147], v[20:23], v[52:55], v[144:147]
    v_add_u32 v74, s72, v72
    v_add_u32 v75, s72, v73
    v_xor_b32 v76, 32, v75
    v_xor_b32 v77, 64, v75
    v_xor_b32 v78, 96, v75
    v_mfma_f32_16x16x32_bf16 v[148:151], v[20:23], v[56:59], v[148:151]
    s_add_u32 s72, s72, 32768
    s_and_b32 s72, s72, 0x1ffff
    ds_read_b128 v[4:7], v74 offset:0
    v_mfma_f32_16x16x32_bf16 v[152:155], v[20:23], v[60:63], v[152:155]
    ds_read_b64_tr_b16 v[36:37], v75 offset:0
    v_mfma_f32_16x16x32_bf16 v[156:159], v[20:23], v[64:67], v[156:159]
    ds_read_b64_tr_b16 v[38:39], v75 offset:2048
    ds_read_b64_tr_b16 v[40:41], v76 offset:0
    v_mfma_f32_16x16x32_bf16 v[160:163], v[24:27], v[52:55], v[160:163]
    ds_read_b64_tr_b16 v[42:43], v76 offset:2048
    v_mfma_f32_16x16x32_bf16 v[164:167], v[24:27], v[56:59], v[164:167]
    ds_read_b64_tr_b16 v[44:45], v77 offset:0
    ds_read_b64_tr_b16 v[46:47], v77 offset:2048
    v_mfma_f32_16x16x32_bf16 v[168:171], v[24:27], v[60:63], v[168:171]
    ds_read_b64_tr_b16 v[48:49], v78 offset:0
    v_mfma_f32_16x16x32_bf16 v[172:175], v[24:27], v[64:67], v[172:175]
    ds_read_b64_tr_b16 v[50:51], v78 offset:2048
    ds_read_b128 v[8:11], v74 offset:1024
    v_mfma_f32_16x16x32_bf16 v[176:179], v[28:31], v[52:55], v[176:179]
    ds_read_b128 v[12:15], v74 offset:2048
    ds_read_b128 v[16:19], v74 offset:3072
    v_mfma_f32_16x16x32_bf16 v[180:183], v[28:31], v[56:59], v[180:183]
    s_mov_b32 m0, s71
    v_mfma_f32_16x16x32_bf16 v[184:187], v[28:31], v[60:63], v[184:187]
    buffer_load_dwordx4 v68, s[60:63], s68 offen lds
    s_add_u32 m0, s71, 1024
    v_mfma_f32_16x16x32_bf16 v[188:191], v[28:31], v[64:67], v[188:191]
    buffer_load_dwordx4 v69, s[60:63], s68 offen lds
    v_mfma_f32_16x16x32_bf16 v[192:195], v[32:35], v[52:55], v[192:195]
    s_add_u32 m0, s71, 16384
    s_nop 0
    buffer_load_dwordx4 v70, s[64:67], s69 offen lds
    v_mfma_f32_16x16x32_bf16 v[196:199], v[32:35], v[56:59], v[196:199]
    s_add_u32 m0, s71, 17408
    v_mfma_f32_16x16x32_bf16 v[200:203], v[32:35], v[60:63], v[200:203]
    buffer_load_dwordx4 v71, s[64:67], s69 offen lds
    s_add_u32 s68, s68, 64
    s_add_u32 s69, s69, s70
    v_mfma_f32_16x16x32_bf16 v[204:207], v[32:35], v[64:67], v[204:207]
    s_add_u32 s71, s71, 32768
    s_and_b32 s71, s71, 0x1ffff
    s_mov_b32 s73, 13
gl_128:
    s_waitcnt lgkmcnt(0)
    v_mfma_f32_16x16x32_bf16 v[80:83], v[4:7], v[36:39], v[80:83]
    ds_read_b128 v[20:23], v74 offset:4096
    v_mfma_f32_16x16x32_bf16 v[84:87], v[4:7], v[40:43], v[84:87]
    v_mfma_f32_16x16x32_bf16 v[88:91], v[4:7], v[44:47], v[88:91]
    ds_read_b128 v[24:27], v74 offset:5120
    v_mfma_f32_16x16x32_bf16 v[92:95], v[4:7], v[48:51], v[92:95]
    v_mfma_f32_16x16x32_bf16 v[96:99], v[8:11], v[36:39], v[96:99]
    ds_read_b128 v[28:31], v74 offset:6144
    v_mfma_f32_16x16x32_bf16 v[100:103], v[8:11], v[40:43], v[100:103]
    v_mfma_f32_16x16x32_bf16 v[104:107], v[8:11], v[44:47], v[104:107]
    ds_read_b128 v[32:35], v74 offset:7168
    v_mfma_f32_16x16x32_bf16 v[108:111], v[8:11], v[48:51], v[108:111]
    v_mfma_f32_16x16x32_bf16 v[112:115], v[12:15], v[36:39], v[112:115]
    v_mfma_f32_16x16x32_bf16 v[116:119], v[12:15], v[40:43], v[116:119]
    v_mfma_f32_16x16x32_bf16 v[120:123], v[12:15], v[44:47], v[120:123]
    v_mfma_f32_16x16x32_bf16 v[124:127], v[12:15], v[48:51], v[124:127]
    v_mfma_f32_16x16x32_bf16 v[128:131], v[16:19], v[36:39], v[128:131]
    v_mfma_f32_16x16x32_bf16 v[132:135], v[16:19], v[40:43], v[132:135]
    v_mfma_f32_16x16x32_bf16 v[136:139], v[16:19], v[44:47], v[136:139]
    v_mfma_f32_16x16x32_bf16 v[140:143], v[16:19], v[48:51], v[140:143]
    s_waitcnt vmcnt(8) lgkmcnt(0)
    s_barrier
    v_mfma_f32_16x16x32_bf16 v[144:147], v[20:23], v[36:39], v[144:147]
    v_add_u32 v74, s72, v72
    v_add_u32 v75, s72, v73
    v_xor_b32 v76, 32, v75
    v_xor_b32 v77, 64, v75
    v_xor_b32 v78, 96, v75
    v_mfma_f32_16x16x32_bf16 v[148:151], v[20:23], v[40:43], v[148:151]
    s_add_u32 s72, s72, 32768
    s_and_b32 s72, s72, 0x1ffff
    ds_read_b128 v[4:7], v74 offset:0
    v_mfma_f32_16x16x32_bf16 v[152:155], v[20:23], v[44:47], v[152:155]
    ds_read_b64_tr_b16 v[52:53], v75 offset:0
    v_mfma_f32_16x16x32_bf16 v[156:159], v[20:23], v[48:51], v[156:159]
    ds_read_b64_tr_b16 v[54:55], v75 offset:2048
    ds_read_b64_tr_b16 v[56:57], v76 offset:0
    v_mfma_f32_16x16x32_bf16 v[160:163], v[24:27], v[36:39], v[160:163]
    ds_read_b64_tr_b16 v[58:59], v76 offset:2048
    v_mfma_f32_16x16x32_bf16 v[164:167], v[24:27], v[40:43], v[164:167]
    ds_read_b64_tr_b16 v[60:61], v77 offset:0
    ds_read_b64_tr_b16 v[62:63], v77 offset:2048
    v_mfma_f32_16x16x32_bf16 v[168:171], v[24:27], v[44:47], v[168:171]
    ds_read_b64_tr_b16 v[64:65], v78 offset:0
    v_mfma_f32_16x16x32_bf16 v[172:175], v[24:27], v[48:51], v[172:175]
    ds_read_b64_tr_b16 v[66:67], v78 offset:2048
    ds_read_b128 v[8:11], v74 offset:1024
    v_mfma_f32_16x16x32_bf16 v[176:179], v[28:31], v[36:39], v[176:179]
    ds_read_b128 v[12:15], v74 offset:2048
    ds_read_b128 v[16:19], v74 offset:3072
    v_mfma_f32_16x16x32_bf16 v[180:183], v[28:31], v[40:43], v[180:183]
    s_mov_b32 m0, s71
    v_mfma_f32_16x16x32_bf16 v[184:187], v[28:31], v[44:47], v[184:187]
    buffer_load_dwordx4 v68, s[60:63], s68 offen lds
    s_add_u32 m0, s71, 1024
    v_mfma_f32_16x16x32_bf16 v[188:191], v[28:31], v[48:51], v[188:191]
    buffer_load_dwordx4 v69, s[60:63], s68 offen lds
    v_mfma_f32_16x16x32_bf16 v[192:195], v[32:35], v[36:39], v[192:195]
    s_add_u32 m0, s71, 16384
    s_nop 0
    buffer_load_dwordx4 v70, s[64:67], s69 offen lds
    v_mfma_f32_16x16x32_bf16 v[196:199], v[32:35], v[40:43], v[196:199]
    s_add_u32 m0, s71, 17408
    v_mfma_f32_16x16x32_bf16 v[200:203], v[32:35], v[44:47], v[200:203]
    buffer_load_dwordx4 v71, s[64:67], s69 offen lds
    s_add_u32 s68, s68, 64
    s_add_u32 s69, s69, s70
    v_mfma_f32_16x16x32_bf16 v[204:207], v[32:35], v[48:51], v[204:207]
    s_add_u32 s71, s71, 32768
    s_and_b32 s71, s71, 0x1ffff
    s_waitcnt lgkmcnt(0)
    v_mfma_f32_16x16x32_bf16 v[80:83], v[4:7], v[52:55], v[80:83]
    ds_read_b128 v[20:23], v74 offset:4096
    v_mfma_f32_16x16x32_bf16 v[84:87], v[4:7], v[56:59], v[84:87]
    v_mfma_f32_16x16x32_bf16 v[88:91], v[4:7], v[60:63], v[88:91]
    ds_read_b128 v[24:27], v74 offset:5120
    v_mfma_f32_16x16x32_bf16 v[92:95], v[4:7], v[64:67], v[92:95]
    v_mfma_f32_16x16x32_bf16 v[96:99], v[8:11], v[52:55], v[96:99]
    ds_read_b128 v[28:31], v74 offset:6144
    v_mfma_f32_16x16x32_bf16 v[100:103], v[8:11], v[56:59], v[100:103]
    v_mfma_f32_16x16x32_bf16 v[104:107], v[8:11], v[60:63], v[104:107]
    ds_read_b128 v[32:35], v74 offset:7168
    v_mfma_f32_16x16x32_bf16 v[108:111], v[8:11], v[64:67], v[108:111]
    v_mfma_f32_16x16x32_bf16 v[112:115], v[12:15], v[52:55], v[112:115]
    v_mfma_f32_16x16x32_bf16 v[116:119], v[12:15], v[56:59], v[116:119]
    v_mfma_f32_16x16x32_bf16 v[120:123], v[12:15], v[60:63], v[120:123]
    v_mfma_f32_16x16x32_bf16 v[124:127], v[12:15], v[64:67], v[124:127]
    v_mfma_f32_16x16x32_bf16 v[128:131], v[16:19], v[52:55], v[128:131]
    v_mfma_f32_16x16x32_bf16 v[132:135], v[16:19], v[56:59], v[132:135]
    v_mfma_f32_16x16x32_bf16 v[136:139], v[16:19], v[60:63], v[136:139]
    v_mfma_f32_16x16x32_bf16 v[140:143], v[16:19], v[64:67], v[140:143]
    s_waitcnt vmcnt(8) lgkmcnt(0)
    s_barrier
    v_mfma_f32_16x16x32_bf16 v[144:147], v[20:23], v[52:55], v[144:147]
    v_add_u32 v74, s72, v72
    v_add_u32 v75, s72, v73
    v_xor_b32 v76, 32, v75
    v_xor_b32 v77, 64, v75
    v_xor_b32 v78, 96, v75
    v_mfma_f32_16x16x32_bf16 v[148:151], v[20:23], v[56:59], v[148:151]
    s_add_u32 s72, s72, 32768
    s_and_b32 s72, s72, 0x1ffff
    ds_read_b128 v[4:7], v74 offset:0
    v_mfma_f32_16x16x32_bf16 v[152:155], v[20:23], v[60:63], v[152:155]
    ds_read_b64_tr_b16 v[36:37], v75 offset:0
    v_mfma_f32_16x16x32_bf16 v[156:159], v[20:23], v[64:67], v[156:159]
    ds_read_b64_tr_b16 v[38:39], v75 offset:2048
    ds_read_b64_tr_b16 v[40:41], v76 offset:0
    v_mfma_f32_16x16x32_bf16 v[160:163], v[24:27], v[52:55], v[160:163]
    ds_read_b64_tr_b16 v[42:43], v76 offset:2048
    v_mfma_f32_16x16x32_bf16 v[164:167], v[24:27], v[56:59], v[164:167]
    ds_read_b64_tr_b16 v[44:45], v77 offset:0
    ds_read_b64_tr_b16 v[46:47], v77 offset:2048
    v_mfma_f32_16x16x32_bf16 v[168:171], v[24:27], v[60:63], v[168:171]
    ds_read_b64_tr_b16 v[48:49], v78 offset:0
    v_mfma_f32_16x16x32_bf16 v[172:175], v[24:27], v[64:67], v[172:175]
    ds_read_b64_tr_b16 v[50:51], v78 offset:2048
    ds_read_b128 v[8:11], v74 offset:1024
    v_mfma_f32_16x16x32_bf16 v[176:179], v[28:31], v[52:55], v[176:179]
    ds_read_b128 v[12:15], v74 offset:2048
    ds_read_b128 v[16:19], v74 offset:3072
    v_mfma_f32_16x16x32_bf16 v[180:183], v[28:31], v[56:59], v[180:183]
    s_mov_b32 m0, s71
    v_mfma_f32_16x16x32_bf16 v[184:187], v[28:31], v[60:63], v[184:187]
    buffer_load_dwordx4 v68, s[60:63], s68 offen lds
    s_add_u32 m0, s71, 1024
    v_mfma_f32_16x16x32_bf16 v[188:191], v[28:31], v[64:67], v[188:191]
    buffer_load_dwordx4 v69, s[60:63], s68 offen lds
    v_mfma_f32_16x16x32_bf16 v[192:195], v[32:35], v[52:55], v[192:195]
    s_add_u32 m0, s71, 16384
    s_nop 0
    buffer_load_dwordx4 v70, s[64:67], s69 offen lds
    v_mfma_f32_16x16x32_bf16 v[196:199], v[32:35], v[56:59], v[196:199]
    s_add_u32 m0, s71, 17408
    v_mfma_f32_16x16x32_bf16 v[200:203], v[32:35], v[60:63], v[200:203]
    buffer_load_dwordx4 v71, s[64:67], s69 offen lds
    s_add_u32 s68, s68, 64
    s_add_u32 s69, s69, s70
    v_mfma_f32_16x16x32_bf16 v[204:207], v[32:35], v[64:67], v[204:207]
    s_add_u32 s71, s71, 32768
    s_and_b32 s71, s71, 0x1ffff
    s_sub_u32 s73, s73, 1
    s_cmp_lg_u32 s73, 0
    s_cbranch_scc1 gl_128
    s_waitcnt lgkmcnt(0)
    v_mfma_f32_16x16x32_bf16 v[80:83], v[4:7], v[36:39], v[80:83]
    ds_read_b128 v[20:23], v74 offset:4096
    v_mfma_f32_16x16x32_bf16 v[84:87], v[4:7], v[40:43], v[84:87]
    v_mfma_f32_16x16x32_bf16 v[88:91], v[4:7], v[44:47], v[88:91]
    ds_read_b128 v[24:27], v74 offset:5120
    v_mfma_f32_16x16x32_bf16 v[92:95], v[4:7], v[48:51], v[92:95]
    v_mfma_f32_16x16x32_bf16 v[96:99], v[8:11], v[36:39], v[96:99]
    ds_read_b128 v[28:31], v74 offset:6144
    v_mfma_f32_16x16x32_bf16 v[100:103], v[8:11], v[40:43], v[100:103]
    v_mfma_f32_16x16x32_bf16 v[104:107], v[8:11], v[44:47], v[104:107]
    ds_read_b128 v[32:35], v74 offset:7168
    v_mfma_f32_16x16x32_bf16 v[108:111], v[8:11], v[48:51], v[108:111]
    v_mfma_f32_16x16x32_bf16 v[112:115], v[12:15], v[36:39], v[112:115]
    v_mfma_f32_16x16x32_bf16 v[116:119], v[12:15], v[40:43], v[116:119]
    v_mfma_f32_16x16x32_bf16 v[120:123], v[12:15], v[44:47], v[120:123]
    v_mfma_f32_16x16x32_bf16 v[124:127], v[12:15], v[48:51], v[124:127]
    v_mfma_f32_16x16x32_bf16 v[128:131], v[16:19], v[36:39], v[128:131]
    v_mfma_f32_16x16x32_bf16 v[132:135], v[16:19], v[40:43], v[132:135]
    v_mfma_f32_16x16x32_bf16 v[136:139], v[16:19], v[44:47], v[136:139]
    v_mfma_f32_16x16x32_bf16 v[140:143], v[16:19], v[48:51], v[140:143]
    s_waitcnt vmcnt(8) lgkmcnt(0)
    s_barrier
    v_mfma_f32_16x16x32_bf16 v[144:147], v[20:23], v[36:39], v[144:147]
    v_add_u32 v74, s72, v72
    v_add_u32 v75, s72, v73
    v_mfma_f32_16x16x32_bf16 v[148:151], v[20:23], v[40:43], v[148:151]
    v_xor_b32 v76, 32, v75
    v_xor_b32 v77, 64, v75
    v_xor_b32 v78, 96, v75
    v_mfma_f32_16x16x32_bf16 v[152:155], v[20:23], v[44:47], v[152:155]
    s_add_u32 s72, s72, 32768
    s_and_b32 s72, s72, 0x1ffff
    v_mfma_f32_16x16x32_bf16 v[156:159], v[20:23], v[48:51], v[156:159]
    ds_read_b128 v[4:7], v74 offset:0
    v_mfma_f32_16x16x32_bf16 v[160:163], v[24:27], v[36:39], v[160:163]
    ds_read_b64_tr_b16 v[52:53], v75 offset:0
    v_mfma_f32_16x16x32_bf16 v[164:167], v[24:27], v[40:43], v[164:167]
    ds_read_b64_tr_b16 v[54:55], v75 offset:2048
    v_mfma_f32_16x16x32_bf16 v[168:171], v[24:27], v[44:47], v[168:171]
    ds_read_b64_tr_b16 v[56:57], v76 offset:0
    v_mfma_f32_16x16x32_bf16 v[172:175], v[24:27], v[48:51], v[172:175]
    ds_read_b64_tr_b16 v[58:59], v76 offset:2048
    v_mfma_f32_16x16x32_bf16 v[176:179], v[28:31], v[36:39], v[176:179]
    ds_read_b64_tr_b16 v[60:61], v77 offset:0
    v_mfma_f32_16x16x32_bf16 v[180:183], v[28:31], v[40:43], v[180:183]
    ds_read_b64_tr_b16 v[62:63], v77 offset:2048
    v_mfma_f32_16x16x32_bf16 v[184:187], v[28:31], v[44:47], v[184:187]
    ds_read_b64_tr_b16 v[64:65], v78 offset:0
    v_mfma_f32_16x16x32_bf16 v[188:191], v[28:31], v[48:51], v[188:191]
    ds_read_b64_tr_b16 v[66:67], v78 offset:2048
    v_mfma_f32_16x16x32_bf16 v[192:195], v[32:35], v[36:39], v[192:195]
    ds_read_b128 v[8:11], v74 offset:1024
    v_mfma_f32_16x16x32_bf16 v[196:199], v[32:35], v[40:43], v[196:199]
    ds_read_b128 v[12:15], v74 offset:2048
    v_mfma_f32_16x16x32_bf16 v[200:203], v[32:35], v[44:47], v[200:203]
    ds_read_b128 v[16:19], v74 offset:3072
    v_mfma_f32_16x16x32_bf16 v[204:207], v[32:35], v[48:51], v[204:207]
    s_waitcnt lgkmcnt(0)
    v_mfma_f32_16x16x32_bf16 v[80:83], v[4:7], v[52:55], v[80:83]
    ds_read_b128 v[20:23], v74 offset:4096
    v_mfma_f32_16x16x32_bf16 v[84:87], v[4:7], v[56:59], v[84:87]
    v_mfma_f32_16x16x32_bf16 v[88:91], v[4:7], v[60:63], v[88:91]
    ds_read_b128 v[24:27], v74 offset:5120
    v_mfma_f32_16x16x32_bf16 v[92:95], v[4:7], v[64:67], v[92:95]
    v_mfma_f32_16x16x32_bf16 v[96:99], v[8:11], v[52:55], v[96:99]
    ds_read_b128 v[28:31], v74 offset:6144
    v_mfma_f32_16x16x32_bf16 v[100:103], v[8:11], v[56:59], v[100:103]
    v_mfma_f32_16x16x32_bf16 v[104:107], v[8:11], v[60:63], v[104:107]
    ds_read_b128 v[32:35], v74 offset:7168
    v_mfma_f32_16x16x32_bf16 v[108:111], v[8:11], v[64:67], v[108:111]
    v_mfma_f32_16x16x32_bf16 v[112:115], v[12:15], v[52:55], v[112:115]
    v_mfma_f32_16x16x32_bf16 v[116:119], v[12:15], v[56:59], v[116:119]
    v_mfma_f32_16x16x32_bf16 v[120:123], v[12:15], v[60:63], v[120:123]
    v_mfma_f32_16x16x32_bf16 v[124:127], v[12:15], v[64:67], v[124:127]
    v_mfma_f32_16x16x32_bf16 v[128:131], v[16:19], v[52:55], v[128:131]
    v_mfma_f32_16x16x32_bf16 v[132:135], v[16:19], v[56:59], v[132:135]
    v_mfma_f32_16x16x32_bf16 v[136:139], v[16:19], v[60:63], v[136:139]
    v_mfma_f32_16x16x32_bf16 v[140:143], v[16:19], v[64:67], v[140:143]
    s_waitcnt vmcnt(4) lgkmcnt(0)
    s_barrier
    v_mfma_f32_16x16x32_bf16 v[144:147], v[20:23], v[52:55], v[144:147]
    v_add_u32 v74, s72, v72
    v_add_u32 v75, s72, v73
    v_mfma_f32_16x16x32_bf16 v[148:151], v[20:23], v[56:59], v[148:151]
    v_xor_b32 v76, 32, v75
    v_xor_b32 v77, 64, v75
    v_xor_b32 v78, 96, v75
    v_mfma_f32_16x16x32_bf16 v[152:155], v[20:23], v[60:63], v[152:155]
    s_add_u32 s72, s72, 32768
    s_and_b32 s72, s72, 0x1ffff
    v_mfma_f32_16x16x32_bf16 v[156:159], v[20:23], v[64:67], v[156:159]
    ds_read_b128 v[4:7], v74 offset:0
    v_mfma_f32_16x16x32_bf16 v[160:163], v[24:27], v[52:55], v[160:163]
    ds_read_b64_tr_b16 v[36:37], v75 offset:0
    v_mfma_f32_16x16x32_bf16 v[164:167], v[24:27], v[56:59], v[164:167]
    ds_read_b64_tr_b16 v[38:39], v75 offset:2048
    v_mfma_f32_16x16x32_bf16 v[168:171], v[24:27], v[60:63], v[168:171]
    ds_read_b64_tr_b16 v[40:41], v76 offset:0
    v_mfma_f32_16x16x32_bf16 v[172:175], v[24:27], v[64:67], v[172:175]
    ds_read_b64_tr_b16 v[42:43], v76 offset:2048
    v_mfma_f32_16x16x32_bf16 v[176:179], v[28:31], v[52:55], v[176:179]
    ds_read_b64_tr_b16 v[44:45], v77 offset:0
    v_mfma_f32_16x16x32_bf16 v[180:183], v[28:31], v[56:59], v[180:183]
    ds_read_b64_tr_b16 v[46:47], v77 offset:2048
    v_mfma_f32_16x16x32_bf16 v[184:187], v[28:31], v[60:63], v[184:187]
    ds_read_b64_tr_b16 v[48:49], v78 offset:0
    v_mfma_f32_16x16x32_bf16 v[188:191], v[28:31], v[64:67], v[188:191]
    ds_read_b64_tr_b16 v[50:51], v78 offset:2048
    v_mfma_f32_16x16x32_bf16 v[192:195], v[32:35], v[52:55], v[192:195]
    ds_read_b128 v[8:11], v74 offset:1024
    v_mfma_f32_16x16x32_bf16 v[196:199], v[32:35], v[56:59], v[196:199]
    ds_read_b128 v[12:15], v74 offset:2048
    v_mfma_f32_16x16x32_bf16 v[200:203], v[32:35], v[60:63], v[200:203]
    ds_read_b128 v[16:19], v74 offset:3072
    v_mfma_f32_16x16x32_bf16 v[204:207], v[32:35], v[64:67], v[204:207]
    s_waitcnt lgkmcnt(0)
    v_mfma_f32_16x16x32_bf16 v[80:83], v[4:7], v[36:39], v[80:83]
    ds_read_b128 v[20:23], v74 offset:4096
    v_mfma_f32_16x16x32_bf16 v[84:87], v[4:7], v[40:43], v[84:87]
    v_mfma_f32_16x16x32_bf16 v[88:91], v[4:7], v[44:47], v[88:91]
    ds_read_b128 v[24:27], v74 offset:5120
    v_mfma_f32_16x16x32_bf16 v[92:95], v[4:7], v[48:51], v[92:95]
    v_mfma_f32_16x16x32_bf16 v[96:99], v[8:11], v[36:39], v[96:99]
    ds_read_b128 v[28:31], v74 offset:6144
    v_mfma_f32_16x16x32_bf16 v[100:103], v[8:11], v[40:43], v[100:103]
    v_mfma_f32_16x16x32_bf16 v[104:107], v[8:11], v[44:47], v[104:107]
    ds_read_b128 v[32:35], v74 offset:7168
    v_mfma_f32_16x16x32_bf16 v[108:111], v[8:11], v[48:51], v[108:111]
    v_mfma_f32_16x16x32_bf16 v[112:115], v[12:15], v[36:39], v[112:115]
    v_mfma_f32_16x16x32_bf16 v[116:119], v[12:15], v[40:43], v[116:119]
    v_mfma_f32_16x16x32_bf16 v[120:123], v[12:15], v[44:47], v[120:123]
    v_mfma_f32_16x16x32_bf16 v[124:127], v[12:15], v[48:51], v[124:127]
    v_mfma_f32_16x16x32_bf16 v[128:131], v[16:19], v[36:39], v[128:131]
    v_mfma_f32_16x16x32_bf16 v[132:135], v[16:19], v[40:43], v[132:135]
    v_mfma_f32_16x16x32_bf16 v[136:139], v[16:19], v[44:47], v[136:139]
    v_mfma_f32_16x16x32_bf16 v[140:143], v[16:19], v[48:51], v[140:143]
    s_waitcnt vmcnt(0) lgkmcnt(0)
    s_barrier
    v_mfma_f32_16x16x32_bf16 v[144:147], v[20:23], v[36:39], v[144:147]
    v_add_u32 v74, s72, v72
    v_add_u32 v75, s72, v73
    v_mfma_f32_16x16x32_bf16 v[148:151], v[20:23], v[40:43], v[148:151]
    v_xor_b32 v76, 32, v75
    v_xor_b32 v77, 64, v75
    v_xor_b32 v78, 96, v75
    v_mfma_f32_16x16x32_bf16 v[152:155], v[20:23], v[44:47], v[152:155]
    s_add_u32 s72, s72, 32768
    s_and_b32 s72, s72, 0x1ffff
    v_mfma_f32_16x16x32_bf16 v[156:159], v[20:23], v[48:51], v[156:159]
    ds_read_b128 v[4:7], v74 offset:0
    v_mfma_f32_16x16x32_bf16 v[160:163], v[24:27], v[36:39], v[160:163]
    ds_read_b64_tr_b16 v[52:53], v75 offset:0
    v_mfma_f32_16x16x32_bf16 v[164:167], v[24:27], v[40:43], v[164:167]
    ds_read_b64_tr_b16 v[54:55], v75 offset:2048
    v_mfma_f32_16x16x32_bf16 v[168:171], v[24:27], v[44:47], v[168:171]
    ds_read_b64_tr_b16 v[56:57], v76 offset:0
    v_mfma_f32_16x16x32_bf16 v[172:175], v[24:27], v[48:51], v[172:175]
    ds_read_b64_tr_b16 v[58:59], v76 offset:2048
    v_mfma_f32_16x16x32_bf16 v[176:179], v[28:31], v[36:39], v[176:179]
    ds_read_b64_tr_b16 v[60:61], v77 offset:0
    v_mfma_f32_16x16x32_bf16 v[180:183], v[28:31], v[40:43], v[180:183]
    ds_read_b64_tr_b16 v[62:63], v77 offset:2048
    v_mfma_f32_16x16x32_bf16 v[184:187], v[28:31], v[44:47], v[184:187]
    ds_read_b64_tr_b16 v[64:65], v78 offset:0
    v_mfma_f32_16x16x32_bf16 v[188:191], v[28:31], v[48:51], v[188:191]
    ds_read_b64_tr_b16 v[66:67], v78 offset:2048
    v_mfma_f32_16x16x32_bf16 v[192:195], v[32:35], v[36:39], v[192:195]
    ds_read_b128 v[8:11], v74 offset:1024
    v_mfma_f32_16x16x32_bf16 v[196:199], v[32:35], v[40:43], v[196:199]
    ds_read_b128 v[12:15], v74 offset:2048
    v_mfma_f32_16x16x32_bf16 v[200:203], v[32:35], v[44:47], v[200:203]
    ds_read_b128 v[16:19], v74 offset:3072
    v_mfma_f32_16x16x32_bf16 v[204:207], v[32:35], v[48:51], v[204:207]
    s_waitcnt lgkmcnt(0)
    v_mfma_f32_16x16x32_bf16 v[80:83], v[4:7], v[52:55], v[80:83]
    ds_read_b128 v[20:23], v74 offset:4096
    v_mfma_f32_16x16x32_bf16 v[84:87], v[4:7], v[56:59], v[84:87]
    v_mfma_f32_16x16x32_bf16 v[88:91], v[4:7], v[60:63], v[88:91]
    ds_read_b128 v[24:27], v74 offset:5120
    v_mfma_f32_16x16x32_bf16 v[92:95], v[4:7], v[64:67], v[92:95]
    v_mfma_f32_16x16x32_bf16 v[96:99], v[8:11], v[52:55], v[96:99]
    ds_read_b128 v[28:31], v74 offset:6144
    v_mfma_f32_16x16x32_bf16 v[100:103], v[8:11], v[56:59], v[100:103]
    v_mfma_f32_16x16x32_bf16 v[104:107], v[8:11], v[60:63], v[104:107]
    ds_read_b128 v[32:35], v74 offset:7168
    v_mfma_f32_16x16x32_bf16 v[108:111], v[8:11], v[64:67], v[108:111]
    v_mfma_f32_16x16x32_bf16 v[112:115], v[12:15], v[52:55], v[112:115]
    v_mfma_f32_16x16x32_bf16 v[116:119], v[12:15], v[56:59], v[116:119]
    v_mfma_f32_16x16x32_bf16 v[120:123], v[12:15], v[60:63], v[120:123]
    v_mfma_f32_16x16x32_bf16 v[124:127], v[12:15], v[64:67], v[124:127]
    v_mfma_f32_16x16x32_bf16 v[128:131], v[16:19], v[52:55], v[128:131]
    v_mfma_f32_16x16x32_bf16 v[132:135], v[16:19], v[56:59], v[132:135]
    v_mfma_f32_16x16x32_bf16 v[136:139], v[16:19], v[60:63], v[136:139]
    v_mfma_f32_16x16x32_bf16 v[140:143], v[16:19], v[64:67], v[140:143]
    s_waitcnt lgkmcnt(0)
    v_mfma_f32_16x16x32_bf16 v[144:147], v[20:23], v[52:55], v[144:147]
    v_mfma_f32_16x16x32_bf16 v[148:151], v[20:23], v[56:59], v[148:151]
    v_mfma_f32_16x16x32_bf16 v[152:155], v[20:23], v[60:63], v[152:155]
    v_mfma_f32_16x16x32_bf16 v[156:159], v[20:23], v[64:67], v[156:159]
    v_mfma_f32_16x16x32_bf16 v[160:163], v[24:27], v[52:55], v[160:163]
    v_mfma_f32_16x16x32_bf16 v[164:167], v[24:27], v[56:59], v[164:167]
    v_mfma_f32_16x16x32_bf16 v[168:171], v[24:27], v[60:63], v[168:171]
    v_mfma_f32_16x16x32_bf16 v[172:175], v[24:27], v[64:67], v[172:175]
    v_mfma_f32_16x16x32_bf16 v[176:179], v[28:31], v[52:55], v[176:179]
    v_mfma_f32_16x16x32_bf16 v[180:183], v[28:31], v[56:59], v[180:183]
    v_mfma_f32_16x16x32_bf16 v[184:187], v[28:31], v[60:63], v[184:187]
    v_mfma_f32_16x16x32_bf16 v[188:191], v[28:31], v[64:67], v[188:191]
    v_mfma_f32_16x16x32_bf16 v[192:195], v[32:35], v[52:55], v[192:195]
    v_mfma_f32_16x16x32_bf16 v[196:199], v[32:35], v[56:59], v[196:199]
    v_mfma_f32_16x16x32_bf16 v[200:203], v[32:35], v[60:63], v[200:203]
    v_mfma_f32_16x16x32_bf16 v[204:207], v[32:35], v[64:67], v[204:207]
    s_lshl_b32 s85, s80, 2
    s_and_b32 s81, s58, 3
    s_add_u32 s85, s85, s81
    s_lshl_b32 s85, s85, 6
    v_and_b32 v77, 15, v1
    v_add_u32 v77, s85, v77
    v_bfe_u32 v76, v77, 3, 5
    v_lshlrev_b32 v76, 12, v76
    v_bfe_u32 v75, v77, 10, 1
    v_lshl_or_b32 v76, v75, 17, v76
    v_bfe_u32 v75, v77, 0, 2
    v_lshl_or_b32 v76, v75, 18, v76
    v_bfe_u32 v75, v77, 8, 1
    v_lshl_or_b32 v76, v75, 20, v76
    v_bfe_u32 v75, v77, 2, 1
    v_lshl_or_b32 v76, v75, 21, v76
    v_bfe_u32 v75, v77, 9, 1
    v_lshl_or_b32 v76, v75, 22, v76
    v_bfe_u32 v77, v1, 4, 2
    v_lshlrev_b32 v77, 4, v77
    v_add_u32 v76, v76, v77
    s_lshl_b32 s81, s79, 9
    s_lshr_b32 s85, s58, 2
    s_lshl_b32 s85, s85, 8
    s_add_u32 s81, s81, s85
    v_cvt_pk_bf16_f32 v4, v80, v81
    v_cvt_pk_bf16_f32 v5, v82, v83
    v_cvt_pk_bf16_f32 v6, v96, v97
    v_cvt_pk_bf16_f32 v7, v98, v99
    buffer_store_dwordx4 v[4:7], v76, s[16:19], s81 offen offset:0
    v_cvt_pk_bf16_f32 v8, v112, v113
    v_cvt_pk_bf16_f32 v9, v114, v115
    v_cvt_pk_bf16_f32 v10, v128, v129
    v_cvt_pk_bf16_f32 v11, v130, v131
    buffer_store_dwordx4 v[8:11], v76, s[16:19], s81 offen offset:64
    v_cvt_pk_bf16_f32 v12, v144, v145
    v_cvt_pk_bf16_f32 v13, v146, v147
    v_cvt_pk_bf16_f32 v14, v160, v161
    v_cvt_pk_bf16_f32 v15, v162, v163
    buffer_store_dwordx4 v[12:15], v76, s[16:19], s81 offen offset:128
    v_cvt_pk_bf16_f32 v16, v176, v177
    v_cvt_pk_bf16_f32 v17, v178, v179
    v_cvt_pk_bf16_f32 v18, v192, v193
    v_cvt_pk_bf16_f32 v19, v194, v195
    buffer_store_dwordx4 v[16:19], v76, s[16:19], s81 offen offset:192
    s_add_u32 s81, s81, 8192
    v_cvt_pk_bf16_f32 v20, v84, v85
    v_cvt_pk_bf16_f32 v21, v86, v87
    v_cvt_pk_bf16_f32 v22, v100, v101
    v_cvt_pk_bf16_f32 v23, v102, v103
    buffer_store_dwordx4 v[20:23], v76, s[16:19], s81 offen offset:0
    v_cvt_pk_bf16_f32 v24, v116, v117
    v_cvt_pk_bf16_f32 v25, v118, v119
    v_cvt_pk_bf16_f32 v26, v132, v133
    v_cvt_pk_bf16_f32 v27, v134, v135
    buffer_store_dwordx4 v[24:27], v76, s[16:19], s81 offen offset:64
    v_cvt_pk_bf16_f32 v28, v148, v149
    v_cvt_pk_bf16_f32 v29, v150, v151
    v_cvt_pk_bf16_f32 v30, v164, v165
    v_cvt_pk_bf16_f32 v31, v166, v167
    buffer_store_dwordx4 v[28:31], v76, s[16:19], s81 offen offset:128
    v_cvt_pk_bf16_f32 v32, v180, v181
    v_cvt_pk_bf16_f32 v33, v182, v183
    v_cvt_pk_bf16_f32 v34, v196, v197
    v_cvt_pk_bf16_f32 v35, v198, v199
    buffer_store_dwordx4 v[32:35], v76, s[16:19], s81 offen offset:192
    s_add_u32 s81, s81, 8192
    v_cvt_pk_bf16_f32 v36, v88, v89
    v_cvt_pk_bf16_f32 v37, v90, v91
    v_cvt_pk_bf16_f32 v38, v104, v105
    v_cvt_pk_bf16_f32 v39, v106, v107
    buffer_store_dwordx4 v[36:39], v76, s[16:19], s81 offen offset:0
    v_cvt_pk_bf16_f32 v40, v120, v121
    v_cvt_pk_bf16_f32 v41, v122, v123
    v_cvt_pk_bf16_f32 v42, v136, v137
    v_cvt_pk_bf16_f32 v43, v138, v139
    buffer_store_dwordx4 v[40:43], v76, s[16:19], s81 offen offset:64
    v_cvt_pk_bf16_f32 v44, v152, v153
    v_cvt_pk_bf16_f32 v45, v154, v155
    v_cvt_pk_bf16_f32 v46, v168, v169
    v_cvt_pk_bf16_f32 v47, v170, v171
    buffer_store_dwordx4 v[44:47], v76, s[16:19], s81 offen offset:128
    v_cvt_pk_bf16_f32 v48, v184, v185
    v_cvt_pk_bf16_f32 v49, v186, v187
    v_cvt_pk_bf16_f32 v50, v200, v201
    v_cvt_pk_bf16_f32 v51, v202, v203
    buffer_store_dwordx4 v[48:51], v76, s[16:19], s81 offen offset:192
    s_add_u32 s81, s81, 8192
    v_cvt_pk_bf16_f32 v52, v92, v93
    v_cvt_pk_bf16_f32 v53, v94, v95
    v_cvt_pk_bf16_f32 v54, v108, v109
    v_cvt_pk_bf16_f32 v55, v110, v111
    buffer_store_dwordx4 v[52:55], v76, s[16:19], s81 offen offset:0
    v_cvt_pk_bf16_f32 v56, v124, v125
    v_cvt_pk_bf16_f32 v57, v126, v127
    v_cvt_pk_bf16_f32 v58, v140, v141
    v_cvt_pk_bf16_f32 v59, v142, v143
    buffer_store_dwordx4 v[56:59], v76, s[16:19], s81 offen offset:64
    v_cvt_pk_bf16_f32 v60, v156, v157
    v_cvt_pk_bf16_f32 v61, v158, v159
    v_cvt_pk_bf16_f32 v62, v172, v173
    v_cvt_pk_bf16_f32 v63, v174, v175
    buffer_store_dwordx4 v[60:63], v76, s[16:19], s81 offen offset:128
    v_cvt_pk_bf16_f32 v64, v188, v189
    v_cvt_pk_bf16_f32 v65, v190, v191
    v_cvt_pk_bf16_f32 v66, v204, v205
    v_cvt_pk_bf16_f32 v67, v206, v207
    buffer_store_dwordx4 v[64:67], v76, s[16:19], s81 offen offset:192
    s_add_u32 s81, s81, 8192
    v_mov_b32 v75, 163760
    v_mov_b32 v76, 0
    s_barrier
    ds_write_b32 v75, v76
    s_waitcnt lgkmcnt(0)
    s_barrier
    v_lshlrev_b32 v5, 4, v1
    v_bfe_u32 v6, v1, 0, 3
    v_lshlrev_b32 v6, 4, v6
    v_bfe_u32 v3, v1, 5, 1
    v_lshl_or_b32 v6, v3, 7, v6
    v_lshlrev_b32 v7, 3, v1
    v_bfe_u32 v2, v1, 5, 1
    v_lshlrev_b32 v2, 2, v2
    v_and_b32 v8, 31, v1
    v_sub_u32 v8, v8, v2
    s_mov_b32 s89, 0x3e0293ee
    s_and_b32 s86, s57, 7
    s_mov_b32 s92, 0
    s_mov_b32 s91, 0
    s_mov_b32 s93, 0
    v_mov_b32 v9, 163760
    s_add_u32 s93, s93, 1
    s_cmp_lg_u32 s58, 0
    s_cbranch_scc1 at_f_132
    s_cmp_eq_u32 s92, 2097216
    s_cbranch_scc1 at_rb_134
    s_max_u32 s88, s86, 2
    s_sub_u32 s88, s88, 2
    s_and_b32 s88, s88, -4
pollrb_135:
    buffer_load_dword v2, off, s[12:15], s88 offset:128 sc1
    buffer_load_dword v3, off, s[12:15], 0 offset:188 sc1
    s_waitcnt vmcnt(0)
    v_cmp_ne_u32 vcc, 2097216, v2
    s_cbranch_vccz pollrb_ok_136
    s_sub_u32 s77, s77, 1
    s_cbranch_scc0 pollrb_135
    s_mov_b32 s77, 0
pollrb_ok_136:
    v_readfirstlane_b32 s92, v3
at_rb_134:
    v_mov_b32 v2, s93
    ds_write_b32 v9, v2
at_f_132:
    ds_read_b32 v2, v9
    s_waitcnt lgkmcnt(0)
    v_cmp_gt_u32 vcc, s93, v2
    s_cbranch_vccz at_d_133
    s_sub_u32 s77, s77, 1
    s_cbranch_scc0 at_f_132
    s_mov_b32 s77, 0
at_d_133:
    s_lshl_b32 s94, s86, 2
    s_add_u32 s94, s94, s75
    s_lshl_b32 s94, s94, 3
    s_add_u32 s94, s94, s58
    s_lshl_b32 s94, s94, 13
    s_add_u32 s88, s94, 0x0
    buffer_load_dwordx4 v[12:15], v5, s[8:11], s88 offen offset:0 sc1
    buffer_load_dwordx4 v[16:19], v5, s[8:11], s88 offen offset:1024 sc1
    buffer_load_dwordx4 v[20:23], v5, s[8:11], s88 offen offset:2048 sc1
    buffer_load_dwordx4 v[24:27], v5, s[8:11], s88 offen offset:3072 sc1
    s_add_u32 s88, s88, 4096
    buffer_load_dwordx4 v[28:31], v5, s[8:11], s88 offen offset:0 sc1
    buffer_load_dwordx4 v[32:35], v5, s[8:11], s88 offen offset:1024 sc1
    buffer_load_dwordx4 v[36:39], v5, s[8:11], s88 offen offset:2048 sc1
    buffer_load_dwordx4 v[40:43], v5, s[8:11], s88 offen offset:3072 sc1
    s_add_u32 s88, s94, 0x1000000
    buffer_load_dwordx4 v[44:47], v5, s[8:11], s88 offen offset:0 sc1
    buffer_load_dwordx4 v[48:51], v5, s[8:11], s88 offen offset:1024 sc1
    buffer_load_dwordx4 v[52:55], v5, s[8:11], s88 offen offset:2048 sc1
    buffer_load_dwordx4 v[56:59], v5, s[8:11], s88 offen offset:3072 sc1
    s_add_u32 s88, s88, 4096
    buffer_load_dwordx4 v[60:63], v5, s[8:11], s88 offen offset:0 sc1
    buffer_load_dwordx4 v[64:67], v5, s[8:11], s88 offen offset:1024 sc1
    buffer_load_dwordx4 v[68:71], v5, s[8:11], s88 offen offset:2048 sc1
    buffer_load_dwordx4 v[72:75], v5, s[8:11], s88 offen offset:3072 sc1
    s_add_u32 s88, s94, 0x2000000
    buffer_load_dwordx4 v[76:79], v5, s[8:11], s88 offen offset:0 sc1
    buffer_load_dwordx4 v[80:83], v5, s[8:11], s88 offen offset:1024 sc1
    buffer_load_dwordx4 v[84:87], v5, s[8:11], s88 offen offset:2048 sc1
    buffer_load_dwordx4 v[88:91], v5, s[8:11], s88 offen offset:3072 sc1
    s_add_u32 s88, s88, 4096
    buffer_load_dwordx4 v[92:95], v5, s[8:11], s88 offen offset:0 sc1
    buffer_load_dwordx4 v[96:99], v5, s[8:11], s88 offen offset:1024 sc1
    buffer_load_dwordx4 v[100:103], v5, s[8:11], s88 offen offset:2048 sc1
    buffer_load_dwordx4 v[104:107], v5, s[8:11], s88 offen offset:3072 sc1
at_loop_129:
    s_mov_b32 s90, s94
    s_add_u32 s93, s93, 1
    s_cmp_lg_u32 s58, 0
    s_cbranch_scc1 at_f_137
    s_cmp_ge_u32 s86, 48
    s_cselect_b32 s88, 1, 2
    s_add_u32 s88, s88, s86
    s_min_u32 s88, s88, 62
    s_cmp_ge_u32 s91, s88
    s_cbranch_scc1 at_go_131
pollprog_139:
    buffer_load_dword v4, off, s[12:15], 0 offset:64 sc1
    s_waitcnt vmcnt(0)
    v_cmp_gt_u32 vcc, s88, v4
    s_cbranch_vccz pollprog_ok_140
    s_sub_u32 s77, s77, 1
    s_cbranch_scc0 pollprog_139
    s_mov_b32 s77, 0
pollprog_ok_140:
    v_readfirstlane_b32 s91, v4
at_go_131:
    v_mov_b32 v2, s93
    ds_write_b32 v9, v2
at_f_137:
    ds_read_b32 v2, v9
    s_waitcnt lgkmcnt(0)
    v_cmp_gt_u32 vcc, s93, v2
    s_cbranch_vccz at_d_138
    s_sub_u32 s77, s77, 1
    s_cbranch_scc0 at_f_137
    s_mov_b32 s77, 0
at_d_138:
    s_lshr_b32 s88, s90, 2
    s_add_u32 s87, s88, 0x4400000
    s_add_u32 s88, s88, 0x4000000
    buffer_load_dwordx4 v[108:111], v6, s[8:11], s88 offen offset:0 sc1
    buffer_load_dwordx4 v[112:115], v6, s[8:11], s88 offen offset:256 sc1
    buffer_load_dwordx4 v[116:119], v6, s[8:11], s88 offen offset:512 sc1
    buffer_load_dwordx4 v[120:123], v6, s[8:11], s88 offen offset:768 sc1
    buffer_load_dwordx4 v[124:127], v6, s[8:11], s88 offen offset:1024 sc1
    buffer_load_dwordx4 v[128:131], v6, s[8:11], s88 offen offset:1280 sc1
    buffer_load_dwordx4 v[132:135], v6, s[8:11], s88 offen offset:1536 sc1
    buffer_load_dwordx4 v[136:139], v6, s[8:11], s88 offen offset:1792 sc1
    buffer_load_dwordx2 v[236:237], v7, s[8:11], s87 offen offset:0 sc1
    buffer_load_dwordx2 v[238:239], v7, s[8:11], s87 offen offset:512 sc1
    buffer_load_dwordx2 v[240:241], v7, s[8:11], s87 offen offset:1024 sc1
    buffer_load_dwordx2 v[242:243], v7, s[8:11], s87 offen offset:1536 sc1
    s_waitcnt vmcnt(27)
    v_mfma_f32_32x32x16_bf16 v[140:155], v[44:47], v[12:15], 0
    s_waitcnt vmcnt(26)
    v_mfma_f32_32x32x16_bf16 v[140:155], v[48:51], v[16:19], v[140:155]
    s_waitcnt vmcnt(25)
    v_mfma_f32_32x32x16_bf16 v[140:155], v[52:55], v[20:23], v[140:155]
    s_waitcnt vmcnt(24)
    v_mfma_f32_32x32x16_bf16 v[140:155], v[56:59], v[24:27], v[140:155]
    s_waitcnt vmcnt(23)
    v_mfma_f32_32x32x16_bf16 v[140:155], v[60:63], v[28:31], v[140:155]
    s_waitcnt vmcnt(22)
    v_mfma_f32_32x32x16_bf16 v[140:155], v[64:67], v[32:35], v[140:155]
    s_waitcnt vmcnt(21)
    v_mfma_f32_32x32x16_bf16 v[140:155], v[68:71], v[36:39], v[140:155]
    s_waitcnt vmcnt(20)
    v_mfma_f32_32x32x16_bf16 v[140:155], v[72:75], v[40:43], v[140:155]
    v_mov_b32 v3, 0xff800000
    v_cmp_le_i32 vcc, 0, v8
    s_nop 9
    v_cndmask_b32 v140, v3, v140, vcc
    v_cmp_le_i32 vcc, 1, v8
    s_nop 1
    v_cndmask_b32 v141, v3, v141, vcc
    v_cmp_le_i32 vcc, 2, v8
    s_nop 1
    v_cndmask_b32 v142, v3, v142, vcc
    v_cmp_le_i32 vcc, 3, v8
    s_nop 1
    v_cndmask_b32 v143, v3, v143, vcc
    v_cmp_le_i32 vcc, 8, v8
    s_nop 1
    v_cndmask_b32 v144, v3, v144, vcc
    v_cmp_le_i32 vcc, 9, v8
    s_nop 1
    v_cndmask_b32 v145, v3, v145, vcc
    v_cmp_le_i32 vcc, 10, v8
    s_nop 1
    v_cndmask_b32 v146, v3, v146, vcc
    v_cmp_le_i32 vcc, 11, v8
    s_nop 1
    v_cndmask_b32 v147, v3, v147, vcc
    v_cmp_le_i32 vcc, 16, v8
    s_nop 1
    v_cndmask_b32 v148, v3, v148, vcc
    v_cmp_le_i32 vcc, 17, v8
    s_nop 1
    v_cndmask_b32 v149, v3, v149, vcc
    v_cmp_le_i32 vcc, 18, v8
    s_nop 1
    v_cndmask_b32 v150, v3, v150, vcc
    v_cmp_le_i32 vcc, 19, v8
    s_nop 1
    v_cndmask_b32 v151, v3, v151, vcc
    v_cmp_le_i32 vcc, 24, v8
    s_nop 1
    v_cndmask_b32 v152, v3, v152, vcc
    v_cmp_le_i32 vcc, 25, v8
    s_nop 1
    v_cndmask_b32 v153, v3, v153, vcc
    v_cmp_le_i32 vcc, 26, v8
    s_nop 1
    v_cndmask_b32 v154, v3, v154, vcc
    v_cmp_le_i32 vcc, 27, v8
    s_nop 1
    v_cndmask_b32 v155, v3, v155, vcc
    v_max3_f32 v244, v140, v141, v142
    v_max3_f32 v244, v244, v143, v144
    v_max3_f32 v244, v244, v145, v146
    v_max3_f32 v244, v244, v147, v148
    v_max3_f32 v244, v244, v149, v150
    v_max3_f32 v244, v244, v151, v152
    v_max3_f32 v244, v244, v153, v154
    s_waitcnt vmcnt(0)
    v_max3_u32 v2, v108, v112, v116
    v_max3_u32 v2, v2, v120, v124
    v_max3_u32 v2, v2, v128, v132
    v_max_u32 v2, v2, v136
    v_cmp_eq_u32 vcc, -1, v2
    s_cbranch_vccz pollkm_ok_142
pollkm_141:
    buffer_load_dwordx4 v[108:111], v6, s[8:11], s88 offen offset:0 sc1
    buffer_load_dwordx4 v[112:115], v6, s[8:11], s88 offen offset:256 sc1
    buffer_load_dwordx4 v[116:119], v6, s[8:11], s88 offen offset:512 sc1
    buffer_load_dwordx4 v[120:123], v6, s[8:11], s88 offen offset:768 sc1
    buffer_load_dwordx4 v[124:127], v6, s[8:11], s88 offen offset:1024 sc1
    buffer_load_dwordx4 v[128:131], v6, s[8:11], s88 offen offset:1280 sc1
    buffer_load_dwordx4 v[132:135], v6, s[8:11], s88 offen offset:1536 sc1
    buffer_load_dwordx4 v[136:139], v6, s[8:11], s88 offen offset:1792 sc1
    buffer_load_dwordx2 v[236:237], v7, s[8:11], s87 offen offset:0 sc1
    buffer_load_dwordx2 v[238:239], v7, s[8:11], s87 offen offset:512 sc1
    buffer_load_dwordx2 v[240:241], v7, s[8:11], s87 offen offset:1024 sc1
    buffer_load_dwordx2 v[242:243], v7, s[8:11], s87 offen offset:1536 sc1
    s_waitcnt vmcnt(0)
    v_max3_u32 v2, v108, v112, v116
    v_max3_u32 v2, v2, v120, v124
    v_max3_u32 v2, v2, v128, v132
    v_max_u32 v2, v2, v136
    v_cmp_eq_u32 vcc, -1, v2
    s_cbranch_vccz pollkm_ok_142
    s_sub_u32 s77, s77, 1
    s_cbranch_scc0 pollkm_141
    s_mov_b32 s77, 0
pollkm_ok_142:
    v_mfma_f32_32x32x16_bf16 v[172:187], v[108:111], v[12:15], 0
    v_mfma_f32_32x32x16_bf16 v[156:171], v[112:115], v[16:19], 0
    v_mfma_f32_32x32x16_bf16 v[172:187], v[116:119], v[20:23], v[172:187]
    v_mfma_f32_32x32x16_bf16 v[156:171], v[120:123], v[24:27], v[156:171]
    v_mfma_f32_32x32x16_bf16 v[172:187], v[124:127], v[28:31], v[172:187]
    v_mfma_f32_32x32x16_bf16 v[156:171], v[128:131], v[32:35], v[156:171]
    v_mfma_f32_32x32x16_bf16 v[172:187], v[132:135], v[36:39], v[172:187]
    v_mfma_f32_32x32x16_bf16 v[156:171], v[136:139], v[40:43], v[156:171]
    v_max3_u32 v3, v236, v238, v240
    v_max_u32 v3, v3, v242
    v_cmp_eq_u32 vcc, -1, v3
    s_cbranch_vccz at_v_143
    buffer_load_dwordx2 v[236:237], v7, s[8:11], s87 offen offset:0 sc1
    buffer_load_dwordx2 v[238:239], v7, s[8:11], s87 offen offset:512 sc1
    buffer_load_dwordx2 v[240:241], v7, s[8:11], s87 offen offset:1024 sc1
    buffer_load_dwordx2 v[242:243], v7, s[8:11], s87 offen offset:1536 sc1
at_v_143:
    s_mov_b64 s[2:3], vcc
    s_add_u32 s86, s86, 8
    s_mov_b32 s94, 0x5ffffff0
    s_cmp_ge_u32 s86, 64
    s_cbranch_scc1 at_nf_144
    s_add_u32 s93, s93, 1
    s_cmp_lg_u32 s58, 0
    s_cbranch_scc1 at_f_145
    s_cmp_eq_u32 s92, 2097216
    s_cbranch_scc1 at_rb_147
    s_max_u32 s88, s86, 2
    s_sub_u32 s88, s88, 2
    s_and_b32 s88, s88, -4
pollrb_148:
    buffer_load_dword v2, off, s[12:15], s88 offset:128 sc1
    buffer_load_dword v3, off, s[12:15], 0 offset:188 sc1
    s_waitcnt vmcnt(0)
    v_cmp_ne_u32 vcc, 2097216, v2
    s_cbranch_vccz pollrb_ok_149
    s_sub_u32 s77, s77, 1
    s_cbranch_scc0 pollrb_148
    s_mov_b32 s77, 0
pollrb_ok_149:
    v_readfirstlane_b32 s92, v3
at_rb_147:
    v_mov_b32 v2, s93
    ds_write_b32 v9, v2
at_f_145:
    ds_read_b32 v2, v9
    s_waitcnt lgkmcnt(0)
    v_cmp_gt_u32 vcc, s93, v2
    s_cbranch_vccz at_d_146
    s_sub_u32 s77, s77, 1
    s_cbranch_scc0 at_f_145
    s_mov_b32 s77, 0
at_d_146:
    s_lshl_b32 s94, s86, 2
    s_add_u32 s94, s94, s75
    s_lshl_b32 s94, s94, 3
    s_add_u32 s94, s94, s58
    s_lshl_b32 s94, s94, 13
    s_add_u32 s88, s94, 0x0
    buffer_load_dwordx4 v[12:15], v5, s[8:11], s88 offen offset:0 sc1
    buffer_load_dwordx4 v[16:19], v5, s[8:11], s88 offen offset:1024 sc1
    buffer_load_dwordx4 v[20:23], v5, s[8:11], s88 offen offset:2048 sc1
    buffer_load_dwordx4 v[24:27], v5, s[8:11], s88 offen offset:3072 sc1
    s_add_u32 s88, s88, 4096
    buffer_load_dwordx4 v[28:31], v5, s[8:11], s88 offen offset:0 sc1
    buffer_load_dwordx4 v[32:35], v5, s[8:11], s88 offen offset:1024 sc1
    buffer_load_dwordx4 v[36:39], v5, s[8:11], s88 offen offset:2048 sc1
    buffer_load_dwordx4 v[40:43], v5, s[8:11], s88 offen offset:3072 sc1
    s_add_u32 s88, s94, 0x1000000
    buffer_load_dwordx4 v[44:47], v5, s[8:11], s88 offen offset:0 sc1
    buffer_load_dwordx4 v[48:51], v5, s[8:11], s88 offen offset:1024 sc1
    buffer_load_dwordx4 v[52:55], v5, s[8:11], s88 offen offset:2048 sc1
    buffer_load_dwordx4 v[56:59], v5, s[8:11], s88 offen offset:3072 sc1
    s_add_u32 s88, s88, 4096
    buffer_load_dwordx4 v[60:63], v5, s[8:11], s88 offen offset:0 sc1
    buffer_load_dwordx4 v[64:67], v5, s[8:11], s88 offen offset:1024 sc1
    buffer_load_dwordx4 v[68:71], v5, s[8:11], s88 offen offset:2048 sc1
    buffer_load_dwordx4 v[72:75], v5, s[8:11], s88 offen offset:3072 sc1
at_nf_144:
    s_nop 2
    v_pk_add_f32 v[156:157], v[156:157], v[172:173]
    v_pk_add_f32 v[158:159], v[158:159], v[174:175]
    v_max3_f32 v2, v244, v155, v156
    v_max3_f32 v2, v2, v157, v158
    v_max_f32 v2, v2, v159
    v_mov_b32 v3, v2
    s_nop 1
    v_permlane32_swap_b32 v2, v3
    v_max_f32 v2, v2, v3
    v_mul_f32 v2, s89, v2
    v_fma_f32 v140, v140, s89, -v2
    v_fma_f32 v141, v141, s89, -v2
    v_exp_f32 v140, v140
    v_exp_f32 v141, v141
    v_fma_f32 v142, v142, s89, -v2
    v_fma_f32 v143, v143, s89, -v2
    v_exp_f32 v142, v142
    v_exp_f32 v143, v143
    v_cvt_pk_bf16_f32 v244, v140, v141
    v_fma_f32 v144, v144, s89, -v2
    v_fma_f32 v145, v145, s89, -v2
    v_exp_f32 v144, v144
    v_exp_f32 v145, v145
    v_cvt_pk_bf16_f32 v245, v142, v143
    v_fma_f32 v146, v146, s89, -v2
    v_fma_f32 v147, v147, s89, -v2
    v_exp_f32 v146, v146
    v_exp_f32 v147, v147
    v_cvt_pk_bf16_f32 v246, v144, v145
    v_fma_f32 v148, v148, s89, -v2
    v_fma_f32 v149, v149, s89, -v2
    v_exp_f32 v148, v148
    v_exp_f32 v149, v149
    v_cvt_pk_bf16_f32 v247, v146, v147
    v_fma_f32 v150, v150, s89, -v2
    v_fma_f32 v151, v151, s89, -v2
    v_exp_f32 v150, v150
    v_exp_f32 v151, v151
    v_cvt_pk_bf16_f32 v248, v148, v149
    v_mfma_f32_32x32x16_bf16 v[172:187], v[76:79], v[244:247], 0
    v_fma_f32 v152, v152, s89, -v2
    v_fma_f32 v153, v153, s89, -v2
    v_exp_f32 v152, v152
    v_exp_f32 v153, v153
    v_cvt_pk_bf16_f32 v249, v150, v151
    v_mfma_f32_32x32x16_bf16 v[188:203], v[84:87], v[244:247], 0
    v_fma_f32 v154, v154, s89, -v2
    v_fma_f32 v155, v155, s89, -v2
    v_exp_f32 v154, v154
    v_exp_f32 v155, v155
    v_cvt_pk_bf16_f32 v250, v152, v153
    v_mfma_f32_32x32x16_bf16 v[204:219], v[92:95], v[244:247], 0
    v_fma_f32 v156, v156, s89, -v2
    v_fma_f32 v157, v157, s89, -v2
    v_exp_f32 v156, v156
    v_exp_f32 v157, v157
    v_cvt_pk_bf16_f32 v251, v154, v155
    v_mfma_f32_32x32x16_bf16 v[220:235], v[100:103], v[244:247], 0
    v_fma_f32 v158, v158, s89, -v2
    v_fma_f32 v159, v159, s89, -v2
    v_exp_f32 v158, v158
    v_exp_f32 v159, v159
    v_cvt_pk_bf16_f32 v252, v156, v157
    v_add_f32 v2, v140, v141
    v_cvt_pk_bf16_f32 v253, v158, v159
    v_mfma_f32_32x32x16_bf16 v[172:187], v[80:83], v[248:251], v[172:187]
    v_add_f32 v2, v2, v142
    v_add_f32 v2, v2, v143
    v_add_f32 v2, v2, v144
    v_add_f32 v2, v2, v145
    v_add_f32 v2, v2, v146
    v_mfma_f32_32x32x16_bf16 v[188:203], v[88:91], v[248:251], v[188:203]
    v_add_f32 v2, v2, v147
    v_add_f32 v2, v2, v148
    v_add_f32 v2, v2, v149
    v_add_f32 v2, v2, v150
    v_add_f32 v2, v2, v151
    v_mfma_f32_32x32x16_bf16 v[204:219], v[96:99], v[248:251], v[204:219]
    v_add_f32 v2, v2, v152
    v_add_f32 v2, v2, v153
    v_add_f32 v2, v2, v154
    v_add_f32 v2, v2, v155
    v_add_f32 v2, v2, v156
    v_mfma_f32_32x32x16_bf16 v[220:235], v[104:107], v[248:251], v[220:235]
    v_add_f32 v2, v2, v157
    v_add_f32 v2, v2, v158
    v_add_f32 v2, v2, v159
    s_cmp_eq_u64 s[2:3], 0
    s_cbranch_scc1 at_vok_150
    s_waitcnt vmcnt(0)
    v_max3_u32 v3, v236, v238, v240
    v_max_u32 v3, v3, v242
    v_cmp_eq_u32 vcc, -1, v3
    s_cbranch_vccz pollvm_ok_152
pollvm_151:
    buffer_load_dwordx2 v[236:237], v7, s[8:11], s87 offen offset:0 sc1
    buffer_load_dwordx2 v[238:239], v7, s[8:11], s87 offen offset:512 sc1
    buffer_load_dwordx2 v[240:241], v7, s[8:11], s87 offen offset:1024 sc1
    buffer_load_dwordx2 v[242:243], v7, s[8:11], s87 offen offset:1536 sc1
    s_waitcnt vmcnt(0)
    v_max3_u32 v3, v236, v238, v240
    v_max_u32 v3, v3, v242
    v_cmp_eq_u32 vcc, -1, v3
    s_cbranch_vccz pollvm_ok_152
    s_sub_u32 s77, s77, 1
    s_cbranch_scc0 pollvm_151
    s_mov_b32 s77, 0
pollvm_ok_152:
at_vok_150:
    v_mfma_f32_32x32x8_bf16 v[172:187], v[236:237], v[252:253], v[172:187]
    v_mov_b32 v3, v2
    s_add_u32 s87, s90, 0x3000000
    v_mfma_f32_32x32x8_bf16 v[188:203], v[238:239], v[252:253], v[188:203]
    v_permlane32_swap_b32 v2, v3
    v_add_f32 v2, v2, v3
    v_rcp_f32 v2, v2
    v_mfma_f32_32x32x8_bf16 v[204:219], v[240:241], v[252:253], v[204:219]
    v_mfma_f32_32x32x8_bf16 v[220:235], v[242:243], v[252:253], v[220:235]
    s_nop 3
    v_pk_mul_f32 v[172:173], v[172:173], v[2:3] op_sel_hi:[1,0]
    v_pk_mul_f32 v[174:175], v[174:175], v[2:3] op_sel_hi:[1,0]
    v_pk_mul_f32 v[176:177], v[176:177], v[2:3] op_sel_hi:[1,0]
    v_pk_mul_f32 v[178:179], v[178:179], v[2:3] op_sel_hi:[1,0]
    v_cvt_pk_bf16_f32 v108, v172, v173
    v_cvt_pk_bf16_f32 v109, v174, v175
    v_cvt_pk_bf16_f32 v110, v176, v177
    v_cvt_pk_bf16_f32 v111, v178, v179
    buffer_store_dwordx4 v[108:111], v5, s[8:11], s87 offen offset:0
    v_pk_mul_f32 v[180:181], v[180:181], v[2:3] op_sel_hi:[1,0]
    v_pk_mul_f32 v[182:183], v[182:183], v[2:3] op_sel_hi:[1,0]
    v_pk_mul_f32 v[184:185], v[184:185], v[2:3] op_sel_hi:[1,0]
    v_pk_mul_f32 v[186:187], v[186:187], v[2:3] op_sel_hi:[1,0]
    v_cvt_pk_bf16_f32 v112, v180, v181
    v_cvt_pk_bf16_f32 v113, v182, v183
    v_cvt_pk_bf16_f32 v114, v184, v185
    v_cvt_pk_bf16_f32 v115, v186, v187
    buffer_store_dwordx4 v[112:115], v5, s[8:11], s87 offen offset:1024
    v_pk_mul_f32 v[188:189], v[188:189], v[2:3] op_sel_hi:[1,0]
    v_pk_mul_f32 v[190:191], v[190:191], v[2:3] op_sel_hi:[1,0]
    v_pk_mul_f32 v[192:193], v[192:193], v[2:3] op_sel_hi:[1,0]
    v_pk_mul_f32 v[194:195], v[194:195], v[2:3] op_sel_hi:[1,0]
    v_cvt_pk_bf16_f32 v116, v188, v189
    v_cvt_pk_bf16_f32 v117, v190, v191
    v_cvt_pk_bf16_f32 v118, v192, v193
    v_cvt_pk_bf16_f32 v119, v194, v195
    buffer_store_dwordx4 v[116:119], v5, s[8:11], s87 offen offset:2048
    v_pk_mul_f32 v[196:197], v[196:197], v[2:3] op_sel_hi:[1,0]
    v_pk_mul_f32 v[198:199], v[198:199], v[2:3] op_sel_hi:[1,0]
    v_pk_mul_f32 v[200:201], v[200:201], v[2:3] op_sel_hi:[1,0]
    v_pk_mul_f32 v[202:203], v[202:203], v[2:3] op_sel_hi:[1,0]
    v_cvt_pk_bf16_f32 v120, v196, v197
    v_cvt_pk_bf16_f32 v121, v198, v199
    v_cvt_pk_bf16_f32 v122, v200, v201
    v_cvt_pk_bf16_f32 v123, v202, v203
    buffer_store_dwordx4 v[120:123], v5, s[8:11], s87 offen offset:3072
    v_pk_mul_f32 v[204:205], v[204:205], v[2:3] op_sel_hi:[1,0]
    v_pk_mul_f32 v[206:207], v[206:207], v[2:3] op_sel_hi:[1,0]
    v_pk_mul_f32 v[208:209], v[208:209], v[2:3] op_sel_hi:[1,0]
    v_pk_mul_f32 v[210:211], v[210:211], v[2:3] op_sel_hi:[1,0]
    v_cvt_pk_bf16_f32 v124, v204, v205
    v_cvt_pk_bf16_f32 v125, v206, v207
    v_cvt_pk_bf16_f32 v126, v208, v209
    v_cvt_pk_bf16_f32 v127, v210, v211
    s_add_u32 s87, s87, 4096
    buffer_store_dwordx4 v[124:127], v5, s[8:11], s87 offen offset:0
    v_pk_mul_f32 v[212:213], v[212:213], v[2:3] op_sel_hi:[1,0]
    v_pk_mul_f32 v[214:215], v[214:215], v[2:3] op_sel_hi:[1,0]
    v_pk_mul_f32 v[216:217], v[216:217], v[2:3] op_sel_hi:[1,0]
    v_pk_mul_f32 v[218:219], v[218:219], v[2:3] op_sel_hi:[1,0]
    v_cvt_pk_bf16_f32 v128, v212, v213
    v_cvt_pk_bf16_f32 v129, v214, v215
    v_cvt_pk_bf16_f32 v130, v216, v217
    v_cvt_pk_bf16_f32 v131, v218, v219
    buffer_store_dwordx4 v[128:131], v5, s[8:11], s87 offen offset:1024
    v_pk_mul_f32 v[220:221], v[220:221], v[2:3] op_sel_hi:[1,0]
    v_pk_mul_f32 v[222:223], v[222:223], v[2:3] op_sel_hi:[1,0]
    v_pk_mul_f32 v[224:225], v[224:225], v[2:3] op_sel_hi:[1,0]
    v_pk_mul_f32 v[226:227], v[226:227], v[2:3] op_sel_hi:[1,0]
    v_cvt_pk_bf16_f32 v132, v220, v221
    v_cvt_pk_bf16_f32 v133, v222, v223
    v_cvt_pk_bf16_f32 v134, v224, v225
    v_cvt_pk_bf16_f32 v135, v226, v227
    buffer_store_dwordx4 v[132:135], v5, s[8:11], s87 offen offset:2048
    v_pk_mul_f32 v[228:229], v[228:229], v[2:3] op_sel_hi:[1,0]
    v_pk_mul_f32 v[230:231], v[230:231], v[2:3] op_sel_hi:[1,0]
    v_pk_mul_f32 v[232:233], v[232:233], v[2:3] op_sel_hi:[1,0]
    v_pk_mul_f32 v[234:235], v[234:235], v[2:3] op_sel_hi:[1,0]
    v_cvt_pk_bf16_f32 v136, v228, v229
    v_cvt_pk_bf16_f32 v137, v230, v231
    v_cvt_pk_bf16_f32 v138, v232, v233
    v_cvt_pk_bf16_f32 v139, v234, v235
    buffer_store_dwordx4 v[136:139], v5, s[8:11], s87 offen offset:3072
    s_add_u32 s88, s94, 0x2000000
    buffer_load_dwordx4 v[76:79], v5, s[8:11], s88 offen offset:0 sc1
    buffer_load_dwordx4 v[80:83], v5, s[8:11], s88 offen offset:1024 sc1
    buffer_load_dwordx4 v[84:87], v5, s[8:11], s88 offen offset:2048 sc1
    buffer_load_dwordx4 v[88:91], v5, s[8:11], s88 offen offset:3072 sc1
    s_add_u32 s88, s88, 4096
    buffer_load_dwordx4 v[92:95], v5, s[8:11], s88 offen offset:0 sc1
    buffer_load_dwordx4 v[96:99], v5, s[8:11], s88 offen offset:1024 sc1
    buffer_load_dwordx4 v[100:103], v5, s[8:11], s88 offen offset:2048 sc1
    buffer_load_dwordx4 v[104:107], v5, s[8:11], s88 offen offset:3072 sc1
    s_bfe_u32 s87, s90, 0x3000d
    s_lshl_b32 s87, s87, 2
    s_bfe_u32 s88, s90, 0x80010
    s_lshl_b32 s88, s88, 7
    s_or_b32 s87, s87, s88
    s_add_u32 s87, s87, 0x5100000
    v_mov_b32 v2, 1
    s_waitcnt vmcnt(8)
    buffer_store_dword v2, off, s[8:11], s87
    s_cmp_lt_u32 s86, 64
    s_cbranch_scc1 at_loop_129
end_60:
    s_waitcnt vmcnt(0)
    s_endpgm
.section .rodata,"a"
.p2align 6
.amdhsa_kernel concat_heads__spectral_gfnet__memory_aug_recurrent_mem_tr__prompt_kernel
  .amdhsa_next_free_vgpr 256
  .amdhsa_next_free_sgpr 102
  .amdhsa_accum_offset 256
  .amdhsa_group_segment_fixed_size 0
  .amdhsa_kernarg_size 104
  .amdhsa_user_sgpr_count 2
  .amdhsa_user_sgpr_kernarg_segment_ptr 1
  .amdhsa_system_sgpr_workgroup_id_x 1
  .amdhsa_float_denorm_mode_32 3
  .amdhsa_float_denorm_mode_16_64 3
.end_amdhsa_kernel
```

```asm
; @launch grid=(256,1,1) block=(512,1,1) lds=163840
.amdgcn_target "amdgcn-amd-amdhsa--gfx950"
.text
.globl concat_heads__spectral_gfnet__memory_aug_recurrent_mem_tr__prompt_kernel
.p2align 8
.type concat_heads__spectral_gfnet__memory_aug_recurrent_mem_tr__prompt_kernel,@function
concat_heads__spectral_gfnet__memory_aug_recurrent_mem_tr__prompt_kernel:
    s_load_dwordx2 s[8:9], s[0:1], 96
    s_load_dwordx2 s[12:13], s[0:1], 88
    s_load_dwordx2 s[16:17], s[0:1], 80
    s_load_dwordx2 s[20:21], s[0:1], 40
    s_load_dwordx2 s[24:25], s[0:1], 48
    s_load_dwordx2 s[28:29], s[0:1], 56
    s_load_dwordx2 s[32:33], s[0:1], 64
    s_load_dwordx2 s[36:37], s[0:1], 24
    s_load_dwordx2 s[40:41], s[0:1], 32
    s_load_dwordx2 s[44:45], s[0:1], 0
    s_load_dwordx2 s[48:49], s[0:1], 8
    s_load_dwordx2 s[52:53], s[0:1], 16
    s_mov_b32 s10, 0x10000000
    s_mov_b32 s11, 0x20000
    s_mov_b32 s14, 0x100
    s_mov_b32 s15, 0x20000
    s_mov_b32 s18, 0x800000
    s_mov_b32 s19, 0x20000
    s_mov_b32 s22, 0x800000
    s_mov_b32 s23, 0x20000
    s_mov_b32 s26, 0x800000
    s_mov_b32 s27, 0x20000
    s_mov_b32 s30, 0x800000
    s_mov_b32 s31, 0x20000
    s_mov_b32 s34, 0x800000
    s_mov_b32 s35, 0x20000
    s_mov_b32 s38, 0x400000
    s_mov_b32 s39, 0x20000
    s_mov_b32 s42, 0x4000
    s_mov_b32 s43, 0x20000
    s_mov_b32 s46, 0x400000
    s_mov_b32 s47, 0x20000
    s_mov_b32 s50, 0x201000
    s_mov_b32 s51, 0x20000
    s_mov_b32 s54, 0x201000
    s_mov_b32 s55, 0x20000
    s_waitcnt lgkmcnt(0)
    s_getreg_b32 s56, hwreg(HW_REG_XCC_ID, 0, 3)
    v_lshrrev_b32 v2, 6, v0
    v_and_b32 v1, 63, v0
    v_readfirstlane_b32 s58, v2
    s_nop 0
    s_cmp_lg_u32 s58, 0
    s_cbranch_scc1 notw0_1
    s_and_b32 s57, s56, 3
    s_mul_i32 s57, s57, 76
    s_and_b32 s3, s56, 4
    s_add_u32 s57, s57, s3
    v_mov_b32 v2, s57
    v_mov_b32 v3, 0x5ffffff0
    v_cmp_eq_u32 vcc, 0, v1
    s_nop 1
    v_cndmask_b32 v2, v3, v2, vcc
    v_mov_b32 v3, 1
    buffer_atomic_add v3, v2, s[12:15], 0 offen sc0 sc1
    v_mov_b32 v4, 0x27ff0
    s_waitcnt vmcnt(0)
    v_readfirstlane_b32 s3, v3
    s_nop 1
    v_mov_b32 v3, s3
    ds_write_b32 v4, v3
    s_waitcnt lgkmcnt(0)
notw0_1:
    s_barrier
    v_mov_b32 v4, 0x27ff0
    ds_read_b32 v3, v4
    s_waitcnt lgkmcnt(0)
    v_readfirstlane_b32 s57, v3
    s_nop 0
    s_cmp_lt_u32 s57, 32
    s_cbranch_scc1 go_3
    s_endpgm
go_3:
    s_cmp_ge_u32 s56, 4
    s_cbranch_scc1 bulk_2
    s_and_b32 s64, s57, 3
    s_lshr_b32 s65, s57, 2
    s_lshl_b32 s66, s56, 3
    s_add_u32 s66, s66, s65
    s_and_b32 s67, s58, 3
    s_mov_b32 s69, 0x40000
    v_and_b32 v6, 15, v1
    v_lshlrev_b32 v8, 4, v1
    v_mov_b32 v14, -1
    v_mov_b32 v15, -1
    v_mov_b32 v16, -1
    v_mov_b32 v17, -1
    s_mov_b32 s86, 0
    s_mov_b32 s87, 0
    s_mov_b32 s88, 0
    s_mov_b32 s89, 0
    s_mov_b32 s90, 0
    s_mov_b32 s91, 0
    s_mov_b32 s92, 0
    s_mov_b32 s93, 0
    s_mov_b32 s94, 0
    s_mov_b32 s95, 0
    s_mov_b32 s96, 0
    s_mov_b32 s97, 0
    s_mov_b32 s98, 0
    v_mov_b32 v2, 0x4444
    v_mov_b32 v3, 0xeeee
    v_and_b32 v4, 2, v1
    v_cmp_eq_u32 vcc, 0, v4
    s_nop 1
    v_cndmask_b32 v7, v3, v2, vcc
    v_bfe_u32 v36, v1, 0, 2
    v_lshlrev_b32 v36, 4, v36
    v_bfe_u32 v2, v1, 5, 1
    v_lshl_or_b32 v36, v2, 6, v36
    v_bfe_u32 v2, v1, 2, 2
    v_lshl_or_b32 v36, v2, 10, v36
    v_bfe_u32 v2, v1, 4, 1
    v_lshl_or_b32 v36, v2, 12, v36
    s_lshl_b32 s70, s56, 2
    s_add_u32 s70, s70, s64
    s_lshl_b32 s70, s70, 15
    s_add_u32 s70, s70, 0x4a00000
    s_lshl_b32 s71, s65, 2
    s_add_u32 s71, s71, s67
    s_lshl_b32 s72, s71, 10
    s_add_u32 s78, s70, s72
    s_lshl_b32 s72, s67, 13
    s_add_u32 s79, s70, s72
    s_lshl_b32 s72, s65, 7
    s_add_u32 s79, s79, s72
    s_bfe_u32 s77, s71, 0x20001
    s_lshl_b32 s77, s77, 7
    s_bfe_u32 s72, s71, 0x10000
    s_lshl_b32 s72, s72, 11
    s_or_b32 s77, s77, s72
    s_bfe_u32 s72, s71, 0x10003
    s_lshl_b32 s72, s72, 12
    s_or_b32 s77, s77, s72
    s_bfe_u32 s72, s71, 0x10004
    s_lshl_b32 s72, s72, 14
    s_or_b32 s77, s77, s72
    s_lshl_b32 s72, s56, 9
    s_add_u32 s77, s77, s72
    s_bfe_u32 s76, s58, 0x10000
    s_lshl_b32 s76, s76, 12
    s_bfe_u32 s72, s58, 0x10001
    s_lshl_b32 s72, s72, 14
    s_or_b32 s76, s76, s72
    s_lshl_b32 s72, s64, 15
    s_add_u32 s76, s76, s72
    s_add_u32 s72, s72, 0x20000
    s_add_u32 s77, s77, s72
    s_sub_u32 s7, 0, s8
    s_and_b32 s7, s7, 0x1fffff
    s_add_u32 s7, s7, 0x6c00000
    v_bfe_u32 v37, v1, 0, 2
    v_lshlrev_b32 v37, 4, v37
    v_bfe_u32 v2, v1, 4, 1
    v_lshl_or_b32 v37, v2, 6, v37
    v_bfe_u32 v2, v1, 2, 2
    v_lshl_or_b32 v37, v2, 7, v37
    v_bfe_u32 v2, v1, 5, 1
    v_lshl_or_b32 v37, v2, 9, v37
    v_add_u32 v37, s7, v37
    v_mov_b32 v5, 0x5ffffff0
    v_add_u32 v3, s7, v8
    v_cmp_gt_u32 vcc, 8, v1
    s_nop 1
    v_cndmask_b32 v35, v5, v3, vcc
    s_lshl_b32 s70, s66, 2
    s_add_u32 s70, s70, s67
    s_lshl_b32 s74, s70, 11
    s_add_u32 s74, s74, 0x4900000
    s_cmp_ge_u32 s58, 4
    s_cbranch_scc1 vo_arm_4
    s_lshl_b32 s73, s70, 12
    s_add_u32 s73, s73, 0x4800000
    s_lshl_b32 s71, s64, 10
    v_add_u32 v34, s71, v8
    s_add_u32 s71, s73, 0x80000
    buffer_store_dwordx4 v[14:17], v34, s[8:11], s73 offen
    buffer_store_dwordx4 v[14:17], v34, s[8:11], s71 offen
    v_bfe_u32 v2, v1, 0, 3
    v_lshlrev_b32 v2, 4, v2
    v_bfe_u32 v3, v1, 3, 1
    v_lshl_or_b32 v2, v3, 13, v2
    v_bfe_u32 v3, v1, 4, 2
    v_lshl_or_b32 v2, v3, 17, v2
    v_add_u32 v2, s7, v2
    buffer_store_dwordx4 v[14:17], v2, s[8:11], s77 offen sc1
    s_add_u32 s77, s77, 0x60000
    s_branch arm_done_5
vo_arm_4:
    s_mov_b32 s73, s74
    v_bfe_u32 v34, v1, 0, 4
    v_lshlrev_b32 v34, 4, v34
    v_bfe_u32 v2, v1, 5, 1
    v_lshl_or_b32 v34, v2, 8, v34
    v_bfe_u32 v2, v1, 4, 1
    v_lshl_or_b32 v34, v2, 10, v34
    s_bfe_u32 s71, s64, 0x10000
    s_lshl_b32 s71, s71, 3
    s_bfe_u32 s72, s64, 0x10001
    s_lshl_b32 s72, s72, 9
    s_or_b32 s71, s71, s72
    v_add_u32 v34, s71, v34
    s_add_u32 s71, s73, 0x40000
    buffer_store_dwordx2 v[14:15], v34, s[8:11], s73 offen
    buffer_store_dwordx2 v[14:15], v34, s[8:11], s71 offen
    s_add_u32 s71, s79, 0x80000
    buffer_store_dwordx4 v[14:17], v36, s[8:11], s79 offen
    buffer_store_dwordx4 v[14:17], v36, s[8:11], s71 offen
    s_add_u32 s2, s77, s7
    s_add_u32 s2, s2, 0x1c0000
    v_bfe_u32 v2, v1, 0, 2
    v_lshlrev_b32 v2, 21, v2
    v_bfe_u32 v3, v1, 2, 1
    v_lshl_or_b32 v2, v3, 13, v2
    s_cmp_lg_u32 s58, 4
    s_cbranch_scc1 arm_done_5
    buffer_store_dword v14, v2, s[8:11], s2 offen sc1
    s_lshl_b32 s71, s66, 7
    s_add_u32 s71, s71, 0x5110000
    buffer_store_dwordx2 v[14:15], off, s[8:11], s71 sc1
arm_done_5:
    v_bfe_u32 v2, v1, 0, 1
    v_lshlrev_b32 v2, 11, v2
    v_bfe_u32 v3, v1, 2, 2
    v_lshl_or_b32 v2, v3, 12, v2
    v_bfe_u32 v3, v1, 1, 1
    v_lshl_or_b32 v2, v3, 8, v2
    v_bfe_u32 v3, v1, 4, 2
    v_lshl_or_b32 v2, v3, 4, v2
    s_lshl_b32 s70, s64, 9
    s_lshl_b32 s71, s67, 6
    s_add_u32 s70, s70, s71
    buffer_load_dwordx4 v[10:13], v2, s[40:43], s70 offen
    v_bfe_u32 v2, v1, 4, 1
    v_lshlrev_b32 v2, 4, v2
    v_bfe_u32 v3, v1, 5, 1
    v_lshl_or_b32 v2, v3, 6, v2
    v_bfe_u32 v3, v1, 4, 2
    v_lshl_or_b32 v2, v3, 13, v2
    v_lshlrev_b32 v3, 4, v6
    v_xor_b32 v38, v2, v3
    v_xor_b32 v39, 0x80, v38
    v_bfe_u32 v2, v1, 5, 1
    v_lshlrev_b32 v2, 5, v2
    v_bfe_u32 v3, v1, 5, 1
    v_lshl_or_b32 v2, v3, 11, v2
    v_bfe_u32 v3, v1, 0, 5
    v_lshlrev_b32 v3, 4, v3
    v_xor_b32 v40, v2, v3
    s_lshl_b32 s71, s67, 6
    v_bfe_u32 v4, v1, 0, 1
    v_lshlrev_b32 v4, 3, v4
    v_bfe_u32 v2, v1, 2, 1
    v_lshl_or_b32 v4, v2, 4, v4
    v_bfe_u32 v2, v1, 1, 1
    v_lshl_or_b32 v4, v2, 5, v4
    v_bfe_u32 v2, v1, 5, 1
    v_lshl_or_b32 v4, v2, 7, v4
    v_bfe_u32 v2, v1, 2, 1
    v_lshl_or_b32 v4, v2, 8, v4
    v_bfe_u32 v2, v1, 4, 2
    v_lshl_or_b32 v4, v2, 10, v4
    v_bfe_u32 v2, v1, 3, 1
    v_lshl_or_b32 v4, v2, 15, v4
    s_lshl_b32 s70, s58, 13
    s_cmp_ge_u32 s58, 4
    s_cselect_b32 s70, 0, s70
    s_or_b32 s70, s70, s71
    v_xor_b32 v41, s70, v4
    v_bfe_u32 v4, v1, 0, 1
    v_lshlrev_b32 v4, 3, v4
    v_bfe_u32 v2, v1, 1, 1
    v_lshl_or_b32 v4, v2, 4, v4
    v_bfe_u32 v2, v1, 2, 1
    v_lshl_or_b32 v4, v2, 5, v4
    v_bfe_u32 v2, v1, 5, 1
    v_lshl_or_b32 v4, v2, 7, v4
    v_bfe_u32 v2, v1, 2, 1
    v_lshl_or_b32 v4, v2, 9, v4
    v_bfe_u32 v2, v1, 5, 1
    v_lshl_or_b32 v4, v2, 11, v4
    v_bfe_u32 v2, v1, 4, 1
    v_lshl_or_b32 v4, v2, 12, v4
    v_bfe_u32 v2, v1, 3, 1
    v_lshl_or_b32 v4, v2, 14, v4
    s_or_b32 s71, s71, 0x10000
    v_xor_b32 v42, s71, v4
    s_lshl_b32 s70, s64, 21
    s_lshl_b32 s71, s58, 18
    s_add_u32 s70, s70, s71
    s_lshl_b32 s71, s66, 8
    s_add_u32 s70, s70, s71
    s_lshl_b32 s71, s58, 13
    s_add_u32 s71, s71, 0
    s_mov_b32 m0, s71
    s_nop 0
    buffer_load_dwordx4 v38, s[24:27], s70 offen lds
    s_add_u32 s71, s71, 0x400
    s_add_u32 s70, s70, 0x8000
    s_mov_b32 m0, s71
    s_nop 0
    buffer_load_dwordx4 v38, s[24:27], s70 offen lds
    s_add_u32 s71, s71, 0x400
    s_add_u32 s70, s70, 0x8000
    s_mov_b32 m0, s71
    s_nop 0
    buffer_load_dwordx4 v39, s[24:27], s70 offen lds
    s_add_u32 s71, s71, 0x400
    s_add_u32 s70, s70, 0x8000
    s_mov_b32 m0, s71
    s_nop 0
    buffer_load_dwordx4 v39, s[24:27], s70 offen lds
    s_add_u32 s71, s71, 0x400
    s_add_u32 s70, s70, 0x8000
    s_mov_b32 m0, s71
    s_nop 0
    buffer_load_dwordx4 v38, s[24:27], s70 offen lds
    s_add_u32 s71, s71, 0x400
    s_add_u32 s70, s70, 0x8000
    s_mov_b32 m0, s71
    s_nop 0
    buffer_load_dwordx4 v38, s[24:27], s70 offen lds
    s_add_u32 s71, s71, 0x400
    s_add_u32 s70, s70, 0x8000
    s_mov_b32 m0, s71
    s_nop 0
    buffer_load_dwordx4 v39, s[24:27], s70 offen lds
    s_add_u32 s71, s71, 0x400
    s_add_u32 s70, s70, 0x8000
    s_mov_b32 m0, s71
    s_nop 0
    buffer_load_dwordx4 v39, s[24:27], s70 offen lds
    s_add_u32 s71, s71, 0x400
    s_add_u32 s70, s70, 0x8000
    s_lshl_b32 s70, s64, 21
    s_lshl_b32 s71, s58, 18
    s_add_u32 s70, s70, s71
    s_lshl_b32 s71, s66, 8
    s_add_u32 s70, s70, s71
    s_lshl_b32 s71, s58, 13
    s_add_u32 s71, s71, 65536
    s_mov_b32 m0, s71
    s_nop 0
    buffer_load_dwordx4 v38, s[28:31], s70 offen lds
    s_add_u32 s71, s71, 0x400
    s_add_u32 s70, s70, 0x8000
    s_mov_b32 m0, s71
    s_nop 0
    buffer_load_dwordx4 v38, s[28:31], s70 offen lds
    s_add_u32 s71, s71, 0x400
    s_add_u32 s70, s70, 0x8000
    s_mov_b32 m0, s71
    s_nop 0
    buffer_load_dwordx4 v39, s[28:31], s70 offen lds
    s_add_u32 s71, s71, 0x400
    s_add_u32 s70, s70, 0x8000
    s_mov_b32 m0, s71
    s_nop 0
    buffer_load_dwordx4 v39, s[28:31], s70 offen lds
    s_add_u32 s71, s71, 0x400
    s_add_u32 s70, s70, 0x8000
    s_mov_b32 m0, s71
    s_nop 0
    buffer_load_dwordx4 v38, s[28:31], s70 offen lds
    s_add_u32 s71, s71, 0x400
    s_add_u32 s70, s70, 0x8000
    s_mov_b32 m0, s71
    s_nop 0
    buffer_load_dwordx4 v38, s[28:31], s70 offen lds
    s_add_u32 s71, s71, 0x400
    s_add_u32 s70, s70, 0x8000
    s_mov_b32 m0, s71
    s_nop 0
    buffer_load_dwordx4 v39, s[28:31], s70 offen lds
    s_add_u32 s71, s71, 0x400
    s_add_u32 s70, s70, 0x8000
    s_mov_b32 m0, s71
    s_nop 0
    buffer_load_dwordx4 v39, s[28:31], s70 offen lds
    s_add_u32 s71, s71, 0x400
    s_add_u32 s70, s70, 0x8000
    s_cmp_lg_u32 s58, 4
    s_cbranch_scc1 novote_6
    s_waitcnt vmcnt(16)
    s_mov_b32 s3, 1
    s_mov_b32 s59, 0
    s_bitcmp1_b32 s57, 0
    s_cselect_b32 s60, -1, 1
    s_cselect_b32 s70, 0x2000, 0
    s_cselect_b32 s71, 0, 0x2000
    s_add_u32 s70, s70, s2
    s_add_u32 s71, s71, s2
    s_mov_b64 s[4:5], 0
    s_buffer_load_dword s4, s[8:11], s70
    s_buffer_load_dword s5, s[8:11], s71
    s_waitcnt lgkmcnt(1)
    s_sub_u32 s72, s4, s5
    s_waitcnt lgkmcnt(0)
    s_mul_i32 s72, s72, s60
    s_add_u32 s72, s72, 1
    s_min_u32 s72, s72, 2
    s_lshl_b32 s72, s72, 10
    s_add_u32 s3, s3, s72
    s_add_u32 s70, s70, 0x200000
    s_add_u32 s71, s71, 0x200000
    s_mov_b64 s[4:5], 0
    s_buffer_load_dword s4, s[8:11], s70
    s_buffer_load_dword s5, s[8:11], s71
    s_waitcnt lgkmcnt(1)
    s_sub_u32 s72, s4, s5
    s_waitcnt lgkmcnt(0)
    s_mul_i32 s72, s72, s60
    s_add_u32 s72, s72, 1
    s_min_u32 s72, s72, 2
    s_lshl_b32 s72, s72, 20
    s_add_u32 s3, s3, s72
    s_add_u32 s70, s70, 0x200000
    s_add_u32 s71, s71, 0x200000
    s_mov_b64 s[4:5], 0
    s_buffer_load_dword s4, s[8:11], s70
    s_buffer_load_dword s5, s[8:11], s71
    s_waitcnt lgkmcnt(1)
    s_sub_u32 s72, s4, s5
    s_waitcnt lgkmcnt(0)
    s_mul_i32 s72, s72, s60
    s_add_u32 s72, s72, 1
    s_min_u32 s72, s72, 2
    s_lshl_b32 s72, s72, 10
    s_add_u32 s59, s59, s72
    s_add_u32 s70, s70, 0x200000
    s_add_u32 s71, s71, 0x200000
    s_mov_b64 s[4:5], 0
    s_buffer_load_dword s4, s[8:11], s70
    s_buffer_load_dword s5, s[8:11], s71
    s_waitcnt lgkmcnt(1)
    s_sub_u32 s72, s4, s5
    s_waitcnt lgkmcnt(0)
    s_mul_i32 s72, s72, s60
    s_add_u32 s72, s72, 1
    s_min_u32 s72, s72, 2
    s_lshl_b32 s72, s72, 20
    s_add_u32 s59, s59, s72
    s_add_u32 s70, s70, 0x200000
    s_add_u32 s71, s71, 0x200000
novote_6:
    s_waitcnt vmcnt(0)
    s_barrier
    s_cmp_lg_u32 s58, 4
    s_cbranch_scc1 nosig_7
    v_mov_b32 v2, s3
    v_mov_b32 v3, s59
    v_cmp_eq_u32 vcc, 0, v1
    v_mov_b32 v5, 32
    v_mov_b32 v4, 0x5ffffff0
    v_cndmask_b32 v4, v4, v5, vcc
    buffer_atomic_add_x2 v[2:3], v4, s[12:15], 0 offen sc1
nosig_7:
    s_cmp_ge_u32 s58, 4
    s_cbranch_scc1 skip_8
    v_xor_b32 v2, 0x0, v41
    v_xor_b32 v3, 0x40, v41
    ds_read_b64_tr_b16 v[192:193], v2 offset:0
    ds_read_b64_tr_b16 v[194:195], v3 offset:512
    ds_read_b64_tr_b16 v[196:197], v2 offset:4096
    ds_read_b64_tr_b16 v[198:199], v3 offset:4608
    v_xor_b32 v2, 0x2000, v41
    v_xor_b32 v3, 0x2040, v41
    ds_read_b64_tr_b16 v[200:201], v2 offset:0
    ds_read_b64_tr_b16 v[202:203], v3 offset:512
    ds_read_b64_tr_b16 v[204:205], v2 offset:4096
    ds_read_b64_tr_b16 v[206:207], v3 offset:4608
    v_xor_b32 v2, 0x4000, v41
    v_xor_b32 v3, 0x4040, v41
    ds_read_b64_tr_b16 v[208:209], v2 offset:0
    ds_read_b64_tr_b16 v[210:211], v3 offset:512
    ds_read_b64_tr_b16 v[212:213], v2 offset:4096
    ds_read_b64_tr_b16 v[214:215], v3 offset:4608
    v_xor_b32 v2, 0x6000, v41
    v_xor_b32 v3, 0x6040, v41
    ds_read_b64_tr_b16 v[216:217], v2 offset:0
    ds_read_b64_tr_b16 v[218:219], v3 offset:512
    ds_read_b64_tr_b16 v[220:221], v2 offset:4096
    ds_read_b64_tr_b16 v[222:223], v3 offset:4608
    s_waitcnt lgkmcnt(0)
    v_xor_b32 v2, 0x10, v41
    v_xor_b32 v3, 0x50, v41
    ds_read_b64_tr_b16 v[224:225], v2 offset:0
    ds_read_b64_tr_b16 v[226:227], v3 offset:512
    ds_read_b64_tr_b16 v[228:229], v2 offset:4096
    ds_read_b64_tr_b16 v[230:231], v3 offset:4608
    v_xor_b32 v2, 0x2010, v41
    v_xor_b32 v3, 0x2050, v41
    ds_read_b64_tr_b16 v[232:233], v2 offset:0
    ds_read_b64_tr_b16 v[234:235], v3 offset:512
    ds_read_b64_tr_b16 v[236:237], v2 offset:4096
    ds_read_b64_tr_b16 v[238:239], v3 offset:4608
    v_xor_b32 v2, 0x4010, v41
    v_xor_b32 v3, 0x4050, v41
    ds_read_b64_tr_b16 v[240:241], v2 offset:0
    ds_read_b64_tr_b16 v[242:243], v3 offset:512
    ds_read_b64_tr_b16 v[244:245], v2 offset:4096
    ds_read_b64_tr_b16 v[246:247], v3 offset:4608
    v_xor_b32 v2, 0x6010, v41
    v_xor_b32 v3, 0x6050, v41
    ds_read_b64_tr_b16 v[248:249], v2 offset:0
    ds_read_b64_tr_b16 v[250:251], v3 offset:512
    ds_read_b64_tr_b16 v[252:253], v2 offset:4096
    ds_read_b64_tr_b16 v[254:255], v3 offset:4608
    s_waitcnt lgkmcnt(0)
skip_8:
    s_cmp_ge_u32 s58, 4
    s_cbranch_scc0 skip_9
    v_xor_b32 v2, 0x10000, v41
    v_xor_b32 v3, 0x10040, v41
    ds_read_b64_tr_b16 v[128:129], v2 offset:0
    ds_read_b64_tr_b16 v[130:131], v3 offset:512
    ds_read_b64_tr_b16 v[132:133], v2 offset:4096
    ds_read_b64_tr_b16 v[134:135], v3 offset:4608
    v_xor_b32 v2, 0x12000, v41
    v_xor_b32 v3, 0x12040, v41
    ds_read_b64_tr_b16 v[136:137], v2 offset:0
    ds_read_b64_tr_b16 v[138:139], v3 offset:512
    ds_read_b64_tr_b16 v[140:141], v2 offset:4096
    ds_read_b64_tr_b16 v[142:143], v3 offset:4608
    v_xor_b32 v2, 0x14000, v41
    v_xor_b32 v3, 0x14040, v41
    ds_read_b64_tr_b16 v[144:145], v2 offset:0
    ds_read_b64_tr_b16 v[146:147], v3 offset:512
    ds_read_b64_tr_b16 v[148:149], v2 offset:4096
    ds_read_b64_tr_b16 v[150:151], v3 offset:4608
    v_xor_b32 v2, 0x16000, v41
    v_xor_b32 v3, 0x16040, v41
    ds_read_b64_tr_b16 v[152:153], v2 offset:0
    ds_read_b64_tr_b16 v[154:155], v3 offset:512
    ds_read_b64_tr_b16 v[156:157], v2 offset:4096
    ds_read_b64_tr_b16 v[158:159], v3 offset:4608
    s_waitcnt lgkmcnt(0)
    v_xor_b32 v2, 0x10010, v41
    v_xor_b32 v3, 0x10050, v41
    ds_read_b64_tr_b16 v[160:161], v2 offset:0
    ds_read_b64_tr_b16 v[162:163], v3 offset:512
    ds_read_b64_tr_b16 v[164:165], v2 offset:4096
    ds_read_b64_tr_b16 v[166:167], v3 offset:4608
    v_xor_b32 v2, 0x12010, v41
    v_xor_b32 v3, 0x12050, v41
    ds_read_b64_tr_b16 v[168:169], v2 offset:0
    ds_read_b64_tr_b16 v[170:171], v3 offset:512
    ds_read_b64_tr_b16 v[172:173], v2 offset:4096
    ds_read_b64_tr_b16 v[174:175], v3 offset:4608
    v_xor_b32 v2, 0x14010, v41
    v_xor_b32 v3, 0x14050, v41
    ds_read_b64_tr_b16 v[176:177], v2 offset:0
    ds_read_b64_tr_b16 v[178:179], v3 offset:512
    ds_read_b64_tr_b16 v[180:181], v2 offset:4096
    ds_read_b64_tr_b16 v[182:183], v3 offset:4608
    v_xor_b32 v2, 0x16010, v41
    v_xor_b32 v3, 0x16050, v41
    ds_read_b64_tr_b16 v[184:185], v2 offset:0
    ds_read_b64_tr_b16 v[186:187], v3 offset:512
    ds_read_b64_tr_b16 v[188:189], v2 offset:4096
    ds_read_b64_tr_b16 v[190:191], v3 offset:4608
    s_waitcnt lgkmcnt(0)
skip_9:
    s_barrier
    s_lshl_b32 s70, s64, 21
    s_lshl_b32 s71, s58, 18
    s_add_u32 s70, s70, s71
    s_lshl_b32 s71, s66, 8
    s_add_u32 s70, s70, s71
    s_lshl_b32 s71, s58, 13
    s_add_u32 s71, s71, 0
    s_mov_b32 m0, s71
    s_nop 0
    buffer_load_dwordx4 v38, s[20:23], s70 offen lds
    s_add_u32 s71, s71, 0x400
    s_add_u32 s70, s70, 0x8000
    s_mov_b32 m0, s71
    s_nop 0
    buffer_load_dwordx4 v38, s[20:23], s70 offen lds
    s_add_u32 s71, s71, 0x400
    s_add_u32 s70, s70, 0x8000
    s_mov_b32 m0, s71
    s_nop 0
    buffer_load_dwordx4 v39, s[20:23], s70 offen lds
    s_add_u32 s71, s71, 0x400
    s_add_u32 s70, s70, 0x8000
    s_mov_b32 m0, s71
    s_nop 0
    buffer_load_dwordx4 v39, s[20:23], s70 offen lds
    s_add_u32 s71, s71, 0x400
    s_add_u32 s70, s70, 0x8000
    s_mov_b32 m0, s71
    s_nop 0
    buffer_load_dwordx4 v38, s[20:23], s70 offen lds
    s_add_u32 s71, s71, 0x400
    s_add_u32 s70, s70, 0x8000
    s_mov_b32 m0, s71
    s_nop 0
    buffer_load_dwordx4 v38, s[20:23], s70 offen lds
    s_add_u32 s71, s71, 0x400
    s_add_u32 s70, s70, 0x8000
    s_mov_b32 m0, s71
    s_nop 0
    buffer_load_dwordx4 v39, s[20:23], s70 offen lds
    s_add_u32 s71, s71, 0x400
    s_add_u32 s70, s70, 0x8000
    s_mov_b32 m0, s71
    s_nop 0
    buffer_load_dwordx4 v39, s[20:23], s70 offen lds
    s_add_u32 s71, s71, 0x400
    s_add_u32 s70, s70, 0x8000
    s_lshl_b32 s70, s66, 18
    s_lshl_b32 s71, s58, 15
    s_add_u32 s70, s70, s71
    s_lshl_b32 s71, s64, 9
    s_add_u32 s70, s70, s71
    s_lshl_b32 s71, s58, 13
    s_add_u32 s71, s71, 65536
    v_xor_b32 v2, 0, v40
    s_mov_b32 m0, s71
    s_nop 0
    buffer_load_dwordx4 v2, s[32:35], s70 offen lds
    s_add_u32 s71, s71, 0x400
    s_add_u32 s70, s70, 0x1000
    v_xor_b32 v2, 64, v40
    s_mov_b32 m0, s71
    s_nop 0
    buffer_load_dwordx4 v2, s[32:35], s70 offen lds
    s_add_u32 s71, s71, 0x400
    s_add_u32 s70, s70, 0x1000
    v_xor_b32 v2, 128, v40
    s_mov_b32 m0, s71
    s_nop 0
    buffer_load_dwordx4 v2, s[32:35], s70 offen lds
    s_add_u32 s71, s71, 0x400
    s_add_u32 s70, s70, 0x1000
    v_xor_b32 v2, 192, v40
    s_mov_b32 m0, s71
    s_nop 0
    buffer_load_dwordx4 v2, s[32:35], s70 offen lds
    s_add_u32 s71, s71, 0x400
    s_add_u32 s70, s70, 0x1000
    v_xor_b32 v2, 0, v40
    s_mov_b32 m0, s71
    s_nop 0
    buffer_load_dwordx4 v2, s[32:35], s70 offen lds
    s_add_u32 s71, s71, 0x400
    s_add_u32 s70, s70, 0x1000
    v_xor_b32 v2, 64, v40
    s_mov_b32 m0, s71
    s_nop 0
    buffer_load_dwordx4 v2, s[32:35], s70 offen lds
    s_add_u32 s71, s71, 0x400
    s_add_u32 s70, s70, 0x1000
    v_xor_b32 v2, 128, v40
    s_mov_b32 m0, s71
    s_nop 0
    buffer_load_dwordx4 v2, s[32:35], s70 offen lds
    s_add_u32 s71, s71, 0x400
    s_add_u32 s70, s70, 0x1000
    v_xor_b32 v2, 192, v40
    s_mov_b32 m0, s71
    s_nop 0
    buffer_load_dwordx4 v2, s[32:35], s70 offen lds
    s_add_u32 s71, s71, 0x400
    s_add_u32 s70, s70, 0x1000
    s_waitcnt vmcnt(0)
    s_barrier
    s_lshl_b32 s4, s66, 7
    s_add_u32 s4, s4, 0x5110000
    s_cmp_lg_u32 s58, 4
    s_cbranch_scc1 armi_10
    buffer_load_dwordx2 v[120:121], off, s[12:15], 0 offset:32 sc1
    buffer_load_dwordx2 v[122:123], off, s[8:11], s4 sc1
armi_10:
    s_cmp_ge_u32 s58, 4
    s_cbranch_scc1 skip_11
    v_xor_b32 v2, 0x0, v41
    v_xor_b32 v3, 0x40, v41
    ds_read_b64_tr_b16 v[128:129], v2 offset:0
    ds_read_b64_tr_b16 v[130:131], v3 offset:512
    ds_read_b64_tr_b16 v[132:133], v2 offset:4096
    ds_read_b64_tr_b16 v[134:135], v3 offset:4608
    v_xor_b32 v2, 0x2000, v41
    v_xor_b32 v3, 0x2040, v41
    ds_read_b64_tr_b16 v[136:137], v2 offset:0
    ds_read_b64_tr_b16 v[138:139], v3 offset:512
    ds_read_b64_tr_b16 v[140:141], v2 offset:4096
    ds_read_b64_tr_b16 v[142:143], v3 offset:4608
    v_xor_b32 v2, 0x4000, v41
    v_xor_b32 v3, 0x4040, v41
    ds_read_b64_tr_b16 v[144:145], v2 offset:0
    ds_read_b64_tr_b16 v[146:147], v3 offset:512
    ds_read_b64_tr_b16 v[148:149], v2 offset:4096
    ds_read_b64_tr_b16 v[150:151], v3 offset:4608
    v_xor_b32 v2, 0x6000, v41
    v_xor_b32 v3, 0x6040, v41
    ds_read_b64_tr_b16 v[152:153], v2 offset:0
    ds_read_b64_tr_b16 v[154:155], v3 offset:512
    ds_read_b64_tr_b16 v[156:157], v2 offset:4096
    ds_read_b64_tr_b16 v[158:159], v3 offset:4608
    s_waitcnt lgkmcnt(0)
    v_xor_b32 v2, 0x10, v41
    v_xor_b32 v3, 0x50, v41
    ds_read_b64_tr_b16 v[160:161], v2 offset:0
    ds_read_b64_tr_b16 v[162:163], v3 offset:512
    ds_read_b64_tr_b16 v[164:165], v2 offset:4096
    ds_read_b64_tr_b16 v[166:167], v3 offset:4608
    v_xor_b32 v2, 0x2010, v41
    v_xor_b32 v3, 0x2050, v41
    ds_read_b64_tr_b16 v[168:169], v2 offset:0
    ds_read_b64_tr_b16 v[170:171], v3 offset:512
    ds_read_b64_tr_b16 v[172:173], v2 offset:4096
    ds_read_b64_tr_b16 v[174:175], v3 offset:4608
    v_xor_b32 v2, 0x4010, v41
    v_xor_b32 v3, 0x4050, v41
    ds_read_b64_tr_b16 v[176:177], v2 offset:0
    ds_read_b64_tr_b16 v[178:179], v3 offset:512
    ds_read_b64_tr_b16 v[180:181], v2 offset:4096
    ds_read_b64_tr_b16 v[182:183], v3 offset:4608
    v_xor_b32 v2, 0x6010, v41
    v_xor_b32 v3, 0x6050, v41
    ds_read_b64_tr_b16 v[184:185], v2 offset:0
    ds_read_b64_tr_b16 v[186:187], v3 offset:512
    ds_read_b64_tr_b16 v[188:189], v2 offset:4096
    ds_read_b64_tr_b16 v[190:191], v3 offset:4608
    s_waitcnt lgkmcnt(0)
skip_11:
    s_cmp_ge_u32 s58, 4
    s_cbranch_scc0 skip_12
    v_xor_b32 v2, 0, v42
    v_xor_b32 v3, 64, v42
    ds_read_b64_tr_b16 v[192:193], v2 offset:0
    ds_read_b64_tr_b16 v[194:195], v3 offset:1024
    ds_read_b64_tr_b16 v[196:197], v2 offset:8192
    ds_read_b64_tr_b16 v[198:199], v3 offset:9216
    ds_read_b64_tr_b16 v[200:201], v2 offset:32768
    ds_read_b64_tr_b16 v[202:203], v3 offset:33792
    ds_read_b64_tr_b16 v[204:205], v2 offset:40960
    ds_read_b64_tr_b16 v[206:207], v3 offset:41984
    ds_read_b64_tr_b16 v[224:225], v2 offset:256
    ds_read_b64_tr_b16 v[226:227], v3 offset:1280
    ds_read_b64_tr_b16 v[228:229], v2 offset:8448
    ds_read_b64_tr_b16 v[230:231], v3 offset:9472
    ds_read_b64_tr_b16 v[232:233], v2 offset:33024
    ds_read_b64_tr_b16 v[234:235], v3 offset:34048
    ds_read_b64_tr_b16 v[236:237], v2 offset:41216
    ds_read_b64_tr_b16 v[238:239], v3 offset:42240
    s_waitcnt lgkmcnt(0)
    v_xor_b32 v2, 32, v42
    v_xor_b32 v3, 96, v42
    ds_read_b64_tr_b16 v[208:209], v2 offset:0
    ds_read_b64_tr_b16 v[210:211], v3 offset:1024
    ds_read_b64_tr_b16 v[212:213], v2 offset:8192
    ds_read_b64_tr_b16 v[214:215], v3 offset:9216
    ds_read_b64_tr_b16 v[216:217], v2 offset:32768
    ds_read_b64_tr_b16 v[218:219], v3 offset:33792
    ds_read_b64_tr_b16 v[220:221], v2 offset:40960
    ds_read_b64_tr_b16 v[222:223], v3 offset:41984
    ds_read_b64_tr_b16 v[240:241], v2 offset:256
    ds_read_b64_tr_b16 v[242:243], v3 offset:1280
    ds_read_b64_tr_b16 v[244:245], v2 offset:8448
    ds_read_b64_tr_b16 v[246:247], v3 offset:9472
    ds_read_b64_tr_b16 v[248:249], v2 offset:33024
    ds_read_b64_tr_b16 v[250:251], v3 offset:34048
    ds_read_b64_tr_b16 v[252:253], v2 offset:41216
    ds_read_b64_tr_b16 v[254:255], v3 offset:42240
    s_waitcnt lgkmcnt(0)
skip_12:
    v_mov_b32 v4, 0x27ff0
    s_cmp_lg_u32 s58, 4
    s_cbranch_scc1 armw_13
    s_waitcnt vmcnt(0)
    v_and_b32 v5, 0x3ff, v120
    v_cmp_gt_u32 vcc, 128, v5
    s_cbranch_vccz armwait_ok_15
armwait_14:
    buffer_load_dwordx2 v[120:121], off, s[12:15], 0 offset:32 sc1
    buffer_load_dwordx2 v[122:123], off, s[8:11], s4 sc1
    s_waitcnt vmcnt(0)
    v_and_b32 v5, 0x3ff, v120
    v_cmp_gt_u32 vcc, 128, v5
    s_cbranch_vccz armwait_ok_15
    s_sub_u32 s69, s69, 1
    s_cbranch_scc0 armwait_14
    s_mov_b32 s69, 0
armwait_ok_15:
    ds_write_b64 v4, v[120:121]
    s_waitcnt lgkmcnt(0)
armw_13:
    s_barrier
    ds_read_b64 v[2:3], v4
    s_mov_b32 s59, 0
    s_waitcnt lgkmcnt(0)
    v_readfirstlane_b32 s70, v2
    v_readfirstlane_b32 s71, v3
    s_bfe_u32 s72, s70, 0xa000a
    s_cmp_gt_u32 s72, 128
    s_cselect_b32 s72, 1, 0
    s_or_b32 s59, s59, s72
    s_bfe_u32 s72, s70, 0xa0014
    s_cmp_gt_u32 s72, 128
    s_cselect_b32 s72, 2, 0
    s_or_b32 s59, s59, s72
    s_bfe_u32 s72, s71, 0xa000a
    s_cmp_gt_u32 s72, 128
    s_cselect_b32 s72, 4, 0
    s_or_b32 s59, s59, s72
    s_bfe_u32 s72, s71, 0xa0014
    s_cmp_gt_u32 s72, 128
    s_cselect_b32 s72, 8, 0
    s_or_b32 s59, s59, s72
    s_and_b32 s70, s59, 1
    s_lshl_b32 s70, s70, 13
    s_add_u32 s77, s77, s70
    s_add_u32 s76, s76, s70
    s_mov_b32 s68, 0
    s_mov_b32 s82, 0
    s_lshl_b32 s80, s66, 11
    s_lshl_b32 s70, s67, 9
    s_add_u32 s80, s80, s70
    v_bfe_u32 v38, v1, 0, 3
    v_lshlrev_b32 v38, 4, v38
    v_bfe_u32 v2, v1, 3, 1
    v_lshl_or_b32 v38, v2, 8, v38
    v_bfe_u32 v2, v1, 4, 2
    v_lshl_or_b32 v38, v2, 9, v38
    s_lshl_b32 s75, s80, 2
    s_add_u32 s75, s75, 0x1000000
    s_cmp_ge_u32 s58, 4
    s_cbranch_scc1 vo_main_16
    s_setprio 3
    s_lshl_b32 s70, s66, 4
    s_lshl_b32 s71, s64, 2
    s_add_u32 s71, s71, s67
    s_add_u32 s3, s70, s71
    s_add_u32 s80, s80, 0x3ff0000
    s_lshl_b32 s70, s67, 10
    v_add_u32 v102, s70, v8
    v_lshrrev_b32 v103, 2, v102
    v_bfe_u32 v2, v1, 0, 3
    v_lshlrev_b32 v2, 4, v2
    v_bfe_u32 v3, v1, 4, 2
    v_lshl_or_b32 v2, v3, 7, v2
    v_mov_b32 v3, 0x5ffffff0
    v_cmp_le_u32 vcc, 8, v6
    s_nop 1
    v_cndmask_b32 v104, v3, v2, vcc
    v_xor_b32 v100, 1024, v102
    v_xor_b32 v101, 2048, v102
    v_xor_b32 v36, 3072, v102
    v_xor_b32 v106, 0x400, v34
    v_bfe_u32 v105, v1, 0, 4
    v_lshlrev_b32 v105, 4, v105
    v_bfe_u32 v2, v1, 4, 2
    v_lshl_or_b32 v105, v2, 9, v105
    s_lshl_b32 s70, s64, 10
    s_xor_b32 s70, s70, 0x800
    v_xor_b32 v105, s70, v105
    v_and_b32 v2, 1, v1
    v_lshlrev_b32 v2, 4, v2
    v_mov_b32 v3, 0x3f80
    v_lshlrev_b32 v2, v2, v3
    v_bfe_u32 v3, v1, 1, 1
    v_bfe_u32 v4, v1, 3, 1
    v_lshl_or_b32 v3, v4, 1, v3
    v_bfe_u32 v4, v1, 2, 1
    v_lshl_or_b32 v3, v4, 2, v3
    v_bfe_u32 v4, v1, 4, 1
    v_lshlrev_b32 v4, 2, v4
    v_xor_b32 v3, v3, v4
    v_cmp_eq_u32 vcc, 0, v3
    s_nop 1
    v_cndmask_b32 v26, 0, v2, vcc
    v_cmp_eq_u32 vcc, 1, v3
    s_nop 1
    v_cndmask_b32 v27, 0, v2, vcc
    v_cmp_eq_u32 vcc, 2, v3
    s_nop 1
    v_cndmask_b32 v28, 0, v2, vcc
    v_cmp_eq_u32 vcc, 3, v3
    s_nop 1
    v_cndmask_b32 v29, 0, v2, vcc
    v_bfe_u32 v3, v1, 1, 1
    v_bfe_u32 v4, v1, 3, 1
    v_lshl_or_b32 v3, v4, 1, v3
    v_bfe_u32 v4, v1, 4, 1
    v_lshl_or_b32 v3, v4, 2, v3
    v_bfe_u32 v4, v1, 2, 1
    v_lshl_or_b32 v3, v4, 3, v3
    v_bfe_u32 v4, v1, 5, 1
    v_lshlrev_b32 v4, 3, v4
    v_xor_b32 v3, v3, v4
    v_cmp_eq_u32 vcc, 0, v3
    s_nop 1
    v_cndmask_b32 v92, 0, v2, vcc
    v_cmp_eq_u32 vcc, 1, v3
    s_nop 1
    v_cndmask_b32 v93, 0, v2, vcc
    v_cmp_eq_u32 vcc, 2, v3
    s_nop 1
    v_cndmask_b32 v94, 0, v2, vcc
    v_cmp_eq_u32 vcc, 3, v3
    s_nop 1
    v_cndmask_b32 v95, 0, v2, vcc
    v_cmp_eq_u32 vcc, 4, v3
    s_nop 1
    v_cndmask_b32 v96, 0, v2, vcc
    v_cmp_eq_u32 vcc, 5, v3
    s_nop 1
    v_cndmask_b32 v97, 0, v2, vcc
    v_cmp_eq_u32 vcc, 6, v3
    s_nop 1
    v_cndmask_b32 v98, 0, v2, vcc
    v_cmp_eq_u32 vcc, 7, v3
    s_nop 1
    v_cndmask_b32 v99, 0, v2, vcc
    v_bfe_u32 v3, v1, 2, 1
    v_bfe_u32 v4, v1, 1, 1
    v_lshl_or_b32 v3, v4, 1, v3
    v_bfe_u32 v4, v1, 3, 1
    v_lshl_or_b32 v3, v4, 2, v3
    v_bfe_u32 v4, v1, 4, 1
    v_lshlrev_b32 v4, 2, v4
    v_xor_b32 v3, v3, v4
    v_cmp_eq_u32 vcc, 0, v3
    s_nop 1
    v_cndmask_b32 v30, 0, v2, vcc
    v_cmp_eq_u32 vcc, 1, v3
    s_nop 1
    v_cndmask_b32 v31, 0, v2, vcc
    v_cmp_eq_u32 vcc, 2, v3
    s_nop 1
    v_cndmask_b32 v32, 0, v2, vcc
    v_cmp_eq_u32 vcc, 3, v3
    s_nop 1
    v_cndmask_b32 v33, 0, v2, vcc
    v_mov_b32 v40, 0
    v_mov_b32 v41, 0
    v_mov_b32 v42, 0
    v_mov_b32 v43, 0
    v_mov_b32 v44, 0
    v_mov_b32 v45, 0
    v_mov_b32 v46, 0
    v_mov_b32 v47, 0
    v_mov_b32 v48, 0
    v_mov_b32 v49, 0
    v_mov_b32 v50, 0
    v_mov_b32 v51, 0
    v_mov_b32 v52, 0
    v_mov_b32 v53, 0
    v_mov_b32 v54, 0
    v_mov_b32 v55, 0
    s_branch qk_loop_18
.p2align 6
qk_c_19:
    s_barrier
    buffer_load_dwordx4 v[56:59], v37, s[8:11], s76 offen offset:0 sc1
    buffer_load_dwordx4 v[60:63], v37, s[8:11], s76 offen offset:1024 sc1
    buffer_load_dwordx4 v[64:67], v37, s[8:11], s76 offen offset:2048 sc1
    buffer_load_dwordx4 v[68:71], v37, s[8:11], s76 offen offset:3072 sc1
c_w_21:
    s_waitcnt vmcnt(3)
    v_mfma_f32_16x16x32_bf16 v[72:75], v[56:59], v[30:33], 0
    s_waitcnt vmcnt(2)
    v_mfma_f32_16x16x32_bf16 v[72:75], v[60:63], v[30:33], v[72:75]
    s_waitcnt vmcnt(1)
    v_mfma_f32_16x16x32_bf16 v[76:79], v[64:67], v[30:33], 0
    v_max3_u32 v2, v56, v60, v64
    s_waitcnt vmcnt(0)
    v_mfma_f32_16x16x32_bf16 v[76:79], v[68:71], v[30:33], v[76:79]
    v_max_u32 v2, v2, v68
    v_cmp_eq_u32 vcc, -1, v2
    s_cbranch_vccnz c_s_20
c_j_22:
    v_cvt_pk_bf16_f32 v10, v72, v73
    v_cvt_pk_bf16_f32 v11, v74, v75
    s_nop 2
    v_cvt_pk_bf16_f32 v12, v76, v77
    v_cvt_pk_bf16_f32 v13, v78, v79
qk_loop_18:
    ds_write_b128 v102, v[10:13] offset:0
    s_waitcnt lgkmcnt(0)
    s_barrier
    ds_read_b128 v[14:17], v100 offset:0
    ds_read_b128 v[18:21], v101 offset:0
    ds_read_b128 v[22:25], v36 offset:0
    v_smfmac_f32_16x16x64_bf16 v[40:43], v[10:13], v[128:135], v7
    v_smfmac_f32_16x16x64_bf16 v[44:47], v[10:13], v[160:167], v7
    v_smfmac_f32_16x16x64_bf16 v[48:51], v[10:13], v[192:199], v7
    v_smfmac_f32_16x16x64_bf16 v[52:55], v[10:13], v[224:231], v7
    s_waitcnt lgkmcnt(2)
    v_smfmac_f32_16x16x64_bf16 v[40:43], v[14:17], v[136:143], v7
    v_smfmac_f32_16x16x64_bf16 v[44:47], v[14:17], v[168:175], v7
    s_waitcnt lgkmcnt(1)
    v_smfmac_f32_16x16x64_bf16 v[40:43], v[18:21], v[144:151], v7
    v_smfmac_f32_16x16x64_bf16 v[44:47], v[18:21], v[176:183], v7
    s_waitcnt lgkmcnt(0)
    v_smfmac_f32_16x16x64_bf16 v[40:43], v[22:25], v[152:159], v7
    v_smfmac_f32_16x16x64_bf16 v[44:47], v[22:25], v[184:191], v7
    v_smfmac_f32_16x16x64_bf16 v[48:51], v[14:17], v[200:207], v7
    v_smfmac_f32_16x16x64_bf16 v[48:51], v[18:21], v[208:215], v7
    v_smfmac_f32_16x16x64_bf16 v[48:51], v[22:25], v[216:223], v7
    v_smfmac_f32_16x16x64_bf16 v[52:55], v[14:17], v[232:239], v7
    s_nop 1
    v_smfmac_f32_16x16x64_bf16 v[52:55], v[18:21], v[240:247], v7
    v_pk_add_f32 v[40:41], v[40:41], v[42:43]
    v_cvt_pk_bf16_f32 v80, v40, v41
    v_smfmac_f32_16x16x64_bf16 v[52:55], v[22:25], v[248:255], v7
    v_pk_add_f32 v[44:45], v[44:45], v[46:47]
    v_cvt_pk_bf16_f32 v81, v44, v45
    v_pk_add_f32 v[48:49], v[48:49], v[50:51]
    v_cvt_pk_bf16_f32 v82, v48, v49
    v_permlane16_swap_b32 v80, v81
    v_bfi_b32 v80, 1, s82, v80
    s_nop 1
    v_pk_add_f32 v[52:53], v[52:53], v[54:55]
    v_cvt_pk_bf16_f32 v83, v52, v53
    s_nop 1
    v_permlane16_swap_b32 v82, v83
    buffer_store_dwordx4 v[80:83], v34, s[8:11], s73 offen
    s_barrier
    s_cmp_le_u32 s68, 1
    s_cbranch_scc1 kv0_23
kv0j_24:
    v_mfma_f32_16x16x32_bf16 v[72:75], v[80:83], v[92:95], 0
    v_mfma_f32_16x16x32_bf16 v[76:79], v[80:83], v[96:99], 0
    v_mov_b32 v40, 0
    v_mov_b32 v41, 0
    v_mov_b32 v42, 0
    v_mov_b32 v43, 0
    v_mov_b32 v44, 0
    v_mov_b32 v45, 0
    v_mov_b32 v46, 0
    v_mov_b32 v47, 0
    v_mov_b32 v48, 0
    v_mov_b32 v49, 0
    v_mov_b32 v50, 0
    v_mov_b32 v51, 0
    v_mov_b32 v52, 0
    v_mov_b32 v53, 0
    v_mov_b32 v54, 0
    v_mov_b32 v55, 0
    buffer_load_dwordx4 v[56:59], v106, s[8:11], s73 offen sc1
    buffer_load_dwordx4 v[60:63], v105, s[8:11], s73 offen sc1
    buffer_load_dwordx4 v[64:67], v105, s[8:11], s73 offen offset:256 sc1
x_w_26:
    s_waitcnt vmcnt(2)
    v_mfma_f32_16x16x32_bf16 v[18:21], v[56:59], v[92:95], v[72:75]
    v_mfma_f32_16x16x32_bf16 v[22:25], v[56:59], v[96:99], v[76:79]
    s_waitcnt vmcnt(1)
    v_mfma_f32_16x16x32_bf16 v[18:21], v[60:63], v[26:29], v[18:21]
    v_bitop3_b32 v2, v56, v60, s82 bitop3:0x7e
    s_waitcnt vmcnt(0)
    v_mfma_f32_16x16x32_bf16 v[22:25], v[64:67], v[26:29], v[22:25]
    v_xor_b32 v3, s82, v64
    v_bitop3_b32 v2, v2, v3, 1 bitop3:0xa8
    v_cmp_ne_u32 vcc, 0, v2
    s_cbranch_vccnz x_s_25
x_j_27:
    s_nop 0
    v_cvt_pk_bf16_f32 v80, v18, v19
    v_cvt_pk_bf16_f32 v81, v20, v21
    s_nop 0
    v_cvt_pk_bf16_f32 v82, v22, v23
    v_cvt_pk_bf16_f32 v83, v24, v25
    s_nop 1
    v_mfma_f32_16x16x32_bf16 v[18:21], v[80:83], v[80:83], 0
    s_nop 1
    v_mfma_f32_16x16x32_bf16 v[14:17], v[88:91], v[80:83], 0
    s_nop 1
    v_mfma_f32_16x16x32_bf16 v[10:13], v[84:87], v[80:83], 0
    s_nop 1
    v_mov_b32_dpp v18, v20 row_shr:8 row_mask:0xf bank_mask:0xc
    v_mov_b32_dpp v19, v21 row_shr:8 row_mask:0xf bank_mask:0xc
    s_nop 1
    v_permlane32_swap_b32 v18, v19
    ds_write_b32 v103, v19 offset:8192
    v_mov_b32_dpp v10, v14 row_shr:8 row_mask:0xf bank_mask:0xc
    v_mov_b32_dpp v11, v15 row_shr:8 row_mask:0xf bank_mask:0xc
    v_mov_b32_dpp v12, v16 row_shr:8 row_mask:0xf bank_mask:0xc
    v_mov_b32_dpp v13, v17 row_shr:8 row_mask:0xf bank_mask:0xc
    ds_write_b128 v102, v[10:13] offset:4096
    s_waitcnt lgkmcnt(0)
    s_barrier
    s_setprio 0
    s_add_u32 s77, s77, 0x20000
    s_lshr_b32 s60, s77, 21
    s_bitcmp1_b32 s59, s60
    s_cselect_b32 s60, 0x2000, 0
    s_bitset0_b32 s77, 13
    s_or_b32 s77, s77, s60
    s_add_u32 s76, s76, 0x20000
    s_lshr_b32 s60, s76, 21
    s_bitcmp1_b32 s59, s60
    s_cselect_b32 s60, 0x2000, 0
    s_bitset0_b32 s76, 13
    s_or_b32 s76, s76, s60
    s_add_u32 s80, s80, 0x10000
    s_and_b32 s72, s68, 3
    s_cmp_lg_u32 s72, s64
    s_cbranch_scc1 nokm_28
    v_min_u32 v80, -2, v80
    buffer_store_dwordx4 v[80:83], v104, s[8:11], s80 offen sc1
nokm_28:
    s_cmp_eq_u32 s68, 63
    s_cbranch_scc1 chain_end_17
    buffer_load_dwordx4 v[84:87], v38, s[8:11], s75 offen offset:0
    buffer_load_dwordx4 v[88:91], v38, s[8:11], s75 offen offset:128
    s_add_u32 s75, s75, 0x40000
    v_mov_b32 v10, -1
    v_mov_b32 v11, -1
    v_mov_b32 v12, -1
    v_mov_b32 v13, -1
    buffer_store_dwordx4 v[10:13], v35, s[8:11], s77 offen sc1
    s_cmp_lg_u32 s3, 1
    s_cbranch_scc1 noprog_29
    v_mov_b32 v2, s68
    buffer_store_dword v2, off, s[12:15], 0 offset:64 sc1
noprog_29:
    s_barrier
    s_add_u32 s68, s68, 1
    s_bfe_u32 s82, s68, 0x10001
    s_xor_b32 s73, s73, 0x80000
    s_setprio 3
    s_branch qk_c_19
c_s_20:
    buffer_load_dwordx4 v[56:59], v37, s[8:11], s76 offen offset:0 sc1
    buffer_load_dwordx4 v[60:63], v37, s[8:11], s76 offen offset:1024 sc1
    buffer_load_dwordx4 v[64:67], v37, s[8:11], s76 offen offset:2048 sc1
    buffer_load_dwordx4 v[68:71], v37, s[8:11], s76 offen offset:3072 sc1
    s_sub_u32 s69, s69, 1
    s_cbranch_scc0 c_w_21
    s_mov_b32 s69, 0
    s_branch c_j_22
kv0_23:
    s_bitset0_b32 s75, 30
    buffer_load_dwordx4 v[84:87], v38, s[8:11], s75 offen offset:0
    buffer_load_dwordx4 v[88:91], v38, s[8:11], s75 offen offset:128
    s_add_u32 s75, s75, 0x40000
    s_cmp_lt_u32 s68, 1
    s_cbranch_scc0 kv0j_24
    s_add_u32 s75, s75, 0x3ffc0000
    s_branch kv0j_24
x_s_25:
    buffer_load_dwordx4 v[56:59], v106, s[8:11], s73 offen sc1
    buffer_load_dwordx4 v[60:63], v105, s[8:11], s73 offen sc1
    buffer_load_dwordx4 v[64:67], v105, s[8:11], s73 offen offset:256 sc1
    s_sub_u32 s69, s69, 1
    s_cbranch_scc0 x_w_26
    s_mov_b32 s69, 0
    s_branch x_j_27
vo_main_16:
    s_setprio 1
    v_mov_b32 v88, 0x3f803f80
    v_mov_b32 v92, 0x3e803e80
    v_mov_b32 v89, 0x3f803f80
    v_mov_b32 v93, 0x3e803e80
    v_mov_b32 v90, 0x3f803f80
    v_mov_b32 v94, 0x3e803e80
    v_mov_b32 v91, 0x3f803f80
    v_mov_b32 v95, 0x3e803e80
    v_and_b32 v2, 1, v1
    v_lshlrev_b32 v2, 4, v2
    v_mov_b32 v3, 0x3f80
    v_lshlrev_b32 v2, v2, v3
    v_lshrrev_b32 v3, 1, v6
    v_cmp_eq_u32 vcc, 0, v3
    s_nop 1
    v_cndmask_b32 v26, 0, v2, vcc
    v_cmp_eq_u32 vcc, 1, v3
    s_nop 1
    v_cndmask_b32 v27, 0, v2, vcc
    v_cmp_eq_u32 vcc, 2, v3
    s_nop 1
    v_cndmask_b32 v28, 0, v2, vcc
    v_cmp_eq_u32 vcc, 3, v3
    s_nop 1
    v_cndmask_b32 v29, 0, v2, vcc
    v_bfe_u32 v119, v1, 0, 3
    v_lshlrev_b32 v119, 3, v119
    v_bfe_u32 v3, v1, 3, 1
    v_lshl_or_b32 v119, v3, 7, v119
    v_bfe_u32 v3, v1, 5, 1
    v_lshl_or_b32 v119, v3, 6, v119
    v_bfe_u32 v3, v1, 4, 1
    v_lshl_or_b32 v119, v3, 8, v119
    v_bfe_u32 v3, v1, 1, 3
    v_bfe_u32 v4, v1, 4, 1
    v_lshlrev_b32 v4, 1, v4
    v_xor_b32 v3, v3, v4
    v_cmp_eq_u32 vcc, 0, v3
    s_nop 1
    v_cndmask_b32 v100, 0, v2, vcc
    v_cndmask_b32 v102, 0, v2, vcc
    v_cmp_eq_u32 vcc, 1, v3
    s_nop 1
    v_cndmask_b32 v101, 0, v2, vcc
    v_cndmask_b32 v103, 0, v2, vcc
    v_cmp_eq_u32 vcc, 4, v3
    s_nop 1
    v_cndmask_b32 v104, 0, v2, vcc
    v_cndmask_b32 v106, 0, v2, vcc
    v_cmp_eq_u32 vcc, 5, v3
    s_nop 1
    v_cndmask_b32 v105, 0, v2, vcc
    v_cndmask_b32 v107, 0, v2, vcc
    s_add_u32 s80, s80, 0x4400000
    s_mov_b32 s81, 0x3e0293ee
    v_lshlrev_b32 v116, 2, v1
    v_bfe_u32 v118, v1, 0, 1
    v_lshlrev_b32 v118, 4, v118
    v_bfe_u32 v2, v1, 2, 2
    v_lshl_or_b32 v118, v2, 5, v118
    v_bfe_u32 v2, v1, 1, 1
    v_lshl_or_b32 v118, v2, 7, v118
    v_bfe_u32 v2, v1, 4, 2
    v_lshl_or_b32 v118, v2, 8, v118
    v_bfe_u32 v2, v1, 1, 1
    v_lshl_or_b32 v118, v2, 10, v118
    v_bfe_u32 v120, v1, 4, 2
    v_lshlrev_b32 v120, 3, v120
    s_add_u32 s75, s75, 0x1000000
    s_bfe_u32 s70, s67, 0x10000
    s_lshl_b32 s70, s70, 7
    s_bfe_u32 s71, s67, 0x20000
    s_lshl_b32 s71, s71, 10
    s_or_b32 s70, s70, s71
    v_xor_b32 v117, s70, v8
    s_cmp_eq_u32 s58, 4
    s_cselect_b32 s2, 0, 99
    s_mov_b32 s3, 0
    v_mov_b32 v40, 0
    v_mov_b32 v41, 0
    v_mov_b32 v42, 0
    v_mov_b32 v43, 0
    v_mov_b32 v44, 0
    v_mov_b32 v45, 0
    v_mov_b32 v46, 0
    v_mov_b32 v47, 0
    v_mov_b32 v48, 0
    v_mov_b32 v49, 0
    v_mov_b32 v50, 0
    v_mov_b32 v51, 0
    v_mov_b32 v52, 0
    v_mov_b32 v53, 0
    v_mov_b32 v54, 0
    v_mov_b32 v55, 0
    v_mov_b32 v56, 0
    v_mov_b32 v57, 0
    v_mov_b32 v58, 0
    v_mov_b32 v59, 0
    v_mov_b32 v60, 0
    v_mov_b32 v61, 0
    v_mov_b32 v62, 0
    v_mov_b32 v63, 0
    s_branch vo_loop_30
.p2align 6
vo_loop_30:
    s_barrier
    ds_read_b128 v[10:13], v8 offset:0
    ds_read_b128 v[14:17], v8 offset:1024
    ds_read_b128 v[18:21], v8 offset:2048
    ds_read_b128 v[22:25], v8 offset:3072
    s_cmp_ge_i32 s3, s2
    s_cbranch_scc1 kvg_32
kvj_34:
    s_add_u32 s3, s3, 1
    s_barrier
    s_cmp_le_u32 s68, 1
    s_cbranch_scc1 kv0_35
kv0j_36:
    s_waitcnt lgkmcnt(3)
    v_smfmac_f32_16x16x64_bf16 v[40:43], v[10:13], v[128:135], v7
    v_smfmac_f32_16x16x64_bf16 v[44:47], v[10:13], v[160:167], v7
    s_waitcnt lgkmcnt(2)
    v_smfmac_f32_16x16x64_bf16 v[40:43], v[14:17], v[136:143], v7
    v_smfmac_f32_16x16x64_bf16 v[44:47], v[14:17], v[168:175], v7
    s_waitcnt lgkmcnt(1)
    v_smfmac_f32_16x16x64_bf16 v[40:43], v[18:21], v[144:151], v7
    v_smfmac_f32_16x16x64_bf16 v[44:47], v[18:21], v[176:183], v7
    s_waitcnt lgkmcnt(0)
    v_smfmac_f32_16x16x64_bf16 v[40:43], v[22:25], v[152:159], v7
    v_smfmac_f32_16x16x64_bf16 v[44:47], v[22:25], v[184:191], v7
    s_nop 6
    v_pk_add_f32 v[40:41], v[40:41], v[42:43]
    v_cvt_pk_bf16_f32 v80, v40, v41
    v_pk_add_f32 v[44:45], v[44:45], v[46:47]
    v_cvt_pk_bf16_f32 v81, v44, v45
    s_nop 1
    v_permlane16_swap_b32 v80, v81
    v_bfi_b32 v80, 1, s82, v80
    buffer_store_dwordx2 v[80:81], v34, s[8:11], s73 offen
    s_and_b32 s70, s68, 1
    s_lshl_b32 s70, s70, 19
    s_add_u32 s71, s70, s79
    s_add_u32 s70, s70, s78
    s_cmp_eq_u32 s68, 63
    s_cbranch_scc1 vo_last_31
    s_waitcnt vmcnt(1)
    s_cmp_ge_i32 s3, s2
    s_cbranch_scc1 kvg_37
kvj_39:
    s_barrier
    ds_read_b128 v[10:13], v8 offset:4096
    ds_read_b128 v[14:17], v8 offset:5120
    ds_read2st64_b32 v[30:31], v116 offset0:32 offset1:33
    ds_read_b128 v[18:21], v8 offset:6144
    ds_read_b128 v[22:25], v8 offset:7168
    ds_read2st64_b32 v[32:33], v116 offset0:34 offset1:35
    buffer_load_dwordx4 v[64:67], v8, s[8:11], s73 offen offset:0 sc1
    buffer_load_dwordx4 v[68:71], v8, s[8:11], s73 offen offset:1024 sc1
    s_waitcnt lgkmcnt(4)
    v_pk_add_f32 v[10:11], v[10:11], v[14:15]
    v_pk_add_f32 v[12:13], v[12:13], v[16:17]
    s_waitcnt lgkmcnt(2)
    v_pk_add_f32 v[10:11], v[10:11], v[18:19]
    v_pk_add_f32 v[12:13], v[12:13], v[20:21]
    s_waitcnt lgkmcnt(0)
    v_pk_add_f32 v[30:31], v[30:31], v[32:33]
    v_pk_add_f32 v[10:11], v[10:11], v[22:23]
    v_pk_add_f32 v[12:13], v[12:13], v[24:25]
    v_add_f32 v14, v30, v31
    v_max3_f32 v2, v10, v11, v12
    v_max3_f32 v3, v2, v13, v14
    v_max3_f32 v2, v2, v13, v14
    s_nop 1
    v_permlane32_swap_b32 v2, v3
    v_max_f32 v4, v2, v3
    v_max_f32 v3, v2, v3
    s_nop 1
    v_permlane16_swap_b32 v4, v3
    v_max_f32 v2, v4, v3
    v_mul_f32 v2, s81, v2
    s_nop 1
    v_max_f32_dpp v2, v2, v2 row_ror:8 row_mask:0xf bank_mask:0xf
    v_fma_f32 v10, v10, s81, -v2
    v_fma_f32 v11, v11, s81, -v2
    v_fma_f32 v12, v12, s81, -v2
    v_fma_f32 v13, v13, s81, -v2
    v_fma_f32 v14, v14, s81, -v2
    v_exp_f32 v10, v10
    v_exp_f32 v11, v11
    v_exp_f32 v12, v12
    v_exp_f32 v13, v13
    v_exp_f32 v15, v14
    v_cvt_pk_bf16_f32 v80, v10, v11
    v_cvt_pk_bf16_f32 v81, v12, v13
    v_mov_b32 v14, v15
    v_mov_b32_dpp v82, v80 row_ror:8 row_mask:0xf bank_mask:0xf
    v_mov_b32_dpp v83, v81 row_ror:8 row_mask:0xf bank_mask:0xf
    v_permlane32_swap_b32 v14, v15
    v_cvt_pk_bf16_f32 v84, v14, v15
    v_mfma_f32_16x16x32_bf16 v[108:111], v[72:75], v[80:83], 0
    v_mov_b32 v86, v84
    v_mov_b32_dpp v85, v84 row_ror:8 row_mask:0xf bank_mask:0xf
    v_mov_b32_dpp v87, v84 row_ror:8 row_mask:0xf bank_mask:0xf
    v_mfma_f32_16x16x32_bf16 v[112:115], v[76:79], v[80:83], 0
xv_w_41:
    s_waitcnt vmcnt(0)
    v_mfma_f32_16x16x32_bf16 v[18:21], v[64:67], v[84:87], v[108:111]
    v_bitop3_b32 v2, v64, v66, s82 bitop3:0x7e
    v_bitop3_b32 v3, v68, v70, s82 bitop3:0x7e
    v_mfma_f32_16x16x32_bf16 v[22:25], v[68:71], v[84:87], v[112:115]
    v_bitop3_b32 v2, v2, v3, 1 bitop3:0xa8
    v_cmp_ne_u32 vcc, 0, v2
    s_cbranch_vccnz xv_s_40
xv_j_42:
    v_mfma_f32_16x16x32_bf16 v[96:99], v[88:91], v[80:83], 0
    s_nop 0
    v_cvt_pk_bf16_f32 v108, v18, v19
    v_cvt_pk_bf16_f32 v109, v20, v21
    s_nop 0
    v_cvt_pk_bf16_f32 v110, v22, v23
    v_cvt_pk_bf16_f32 v111, v24, v25
    ds_write_b128 v117, v[108:111] offset:9216
    v_mfma_f32_16x16x32_bf16 v[96:99], v[92:95], v[84:87], v[96:99]
    s_nop 3
    s_waitcnt lgkmcnt(0)
    s_barrier
    ds_read_b128 v[10:13], v118 offset:9216
    ds_read_b128 v[14:17], v118 offset:11264
    v_rcp_f32 v98, v96
    s_nop 0
    ds_bpermute_b32 v96, v120, v98 offset:0
    ds_bpermute_b32 v97, v120, v98 offset:4
    s_waitcnt lgkmcnt(3)
    v_smfmac_f32_16x16x64_bf16 v[48:51], v[10:13], v[192:199], v7
    v_smfmac_f32_16x16x64_bf16 v[52:55], v[10:13], v[208:215], v7
    s_waitcnt lgkmcnt(2)
    v_smfmac_f32_16x16x64_bf16 v[48:51], v[14:17], v[200:207], v7
    s_nop 1
    v_smfmac_f32_16x16x64_bf16 v[52:55], v[14:17], v[216:223], v7
    s_nop 1
    v_smfmac_f32_16x16x64_bf16 v[56:59], v[10:13], v[224:231], v7
    s_waitcnt lgkmcnt(0)
    v_smfmac_f32_16x16x64_bf16 v[56:59], v[14:17], v[232:239], v7
    v_pk_add_f32 v[48:49], v[48:49], v[50:51]
    v_smfmac_f32_16x16x64_bf16 v[60:63], v[10:13], v[240:247], v7
    v_pk_mul_f32 v[48:49], v[48:49], v[96:97]
    v_cvt_pk_bf16_f32 v80, v48, v49
    v_smfmac_f32_16x16x64_bf16 v[60:63], v[14:17], v[248:255], v7
    v_pk_add_f32 v[52:53], v[52:53], v[54:55]
    v_pk_mul_f32 v[52:53], v[52:53], v[96:97]
    v_cvt_pk_bf16_f32 v81, v52, v53
    v_pk_add_f32 v[56:57], v[56:57], v[58:59]
    v_pk_mul_f32 v[56:57], v[56:57], v[96:97]
    v_cvt_pk_bf16_f32 v82, v56, v57
    v_permlane16_swap_b32 v80, v81
    v_bfi_b32 v80, 1, s82, v80
    v_pk_add_f32 v[60:61], v[60:61], v[62:63]
    v_pk_mul_f32 v[60:61], v[60:61], v[96:97]
    v_cvt_pk_bf16_f32 v83, v60, v61
    s_nop 1
    v_permlane16_swap_b32 v82, v83
    buffer_store_dwordx4 v[80:83], v36, s[8:11], s71 offen
    s_waitcnt vmcnt(0)
    buffer_load_dwordx4 v[10:13], v8, s[8:11], s70 offen sc1
b_w_44:
    s_waitcnt vmcnt(0)
    v_mfma_f32_16x16x32_bf16 v[30:33], v[26:29], v[10:13], 0
    v_bitop3_b32 v2, v10, s82, 1 bitop3:0x28
    v_cmp_ne_u32 vcc, 0, v2
    s_cbranch_vccnz b_s_43
b_j_45:
    s_nop 4
    v_add_f32_dpp v30, v30, v30 row_ror:8 row_mask:0xf bank_mask:0xf
    v_add_f32_dpp v31, v31, v31 row_ror:8 row_mask:0xf bank_mask:0xf
    v_add_f32_dpp v32, v32, v32 row_ror:8 row_mask:0xf bank_mask:0xf
    v_add_f32_dpp v33, v33, v33 row_ror:8 row_mask:0xf bank_mask:0xf
    v_cvt_pk_bf16_f32 v30, v30, v31
    v_cvt_pk_bf16_f32 v31, v32, v33
    v_min_u32 v30, -2, v30
    s_nop 0
    v_permlane16_swap_b32 v31, v33
    v_permlane16_swap_b32 v30, v32
    buffer_store_dwordx4 v[30:33], v35, s[8:11], s77 offen sc1
    s_add_u32 s68, s68, 1
    s_bfe_u32 s82, s68, 0x10001
    s_xor_b32 s73, s73, 0x40000
    s_add_u32 s77, s77, 0x20000
    s_lshr_b32 s60, s77, 21
    s_bitcmp1_b32 s59, s60
    s_cselect_b32 s60, 0x2000, 0
    s_bitset0_b32 s77, 13
    s_or_b32 s77, s77, s60
    v_mov_b32 v40, 0
    v_mov_b32 v41, 0
    v_mov_b32 v42, 0
    v_mov_b32 v43, 0
    v_mov_b32 v44, 0
    v_mov_b32 v45, 0
    v_mov_b32 v46, 0
    v_mov_b32 v47, 0
    v_mov_b32 v48, 0
    v_mov_b32 v49, 0
    v_mov_b32 v50, 0
    v_mov_b32 v51, 0
    v_mov_b32 v52, 0
    v_mov_b32 v53, 0
    v_mov_b32 v54, 0
    v_mov_b32 v55, 0
    v_mov_b32 v56, 0
    v_mov_b32 v57, 0
    v_mov_b32 v58, 0
    v_mov_b32 v59, 0
    v_mov_b32 v60, 0
    v_mov_b32 v61, 0
    v_mov_b32 v62, 0
    v_mov_b32 v63, 0
    buffer_load_dwordx4 v[72:75], v38, s[8:11], s75 offen offset:0
    buffer_load_dwordx4 v[76:79], v38, s[8:11], s75 offen offset:128
    s_add_u32 s75, s75, 0x40000
    s_waitcnt vmcnt(2)
    s_barrier
    s_and_b32 s72, s68, 3
    s_cmp_lg_u32 s72, s64
    s_cbranch_scc1 novm_46
    v_mfma_f32_16x16x32_bf16 v[108:111], v[100:103], v[64:67], 0
    v_mfma_f32_16x16x32_bf16 v[108:111], v[104:107], v[68:71], v[108:111]
    s_nop 7
    v_cvt_pk_bf16_f32 v108, v108, v109
    v_cvt_pk_bf16_f32 v109, v110, v111
    v_min_u32 v108, -2, v108
    buffer_store_dwordx2 v[108:109], v119, s[8:11], s80 offen sc1
novm_46:
    s_add_u32 s80, s80, 0x10000
    s_add_u32 s72, s3, 1
    s_cmp_lt_i32 s72, s2
    s_cbranch_scc1 vo_loop_30
    buffer_load_dwordx2 v[122:123], off, s[8:11], s4 sc1
    s_branch vo_loop_30
kvp_33:
    buffer_load_dwordx2 v[122:123], off, s[8:11], s4 sc1
    s_waitcnt vmcnt(0)
kvg_32:
    v_min_i32 v122, v122, v123
    s_nop 0
    v_readfirstlane_b32 s2, v122
    s_nop 0
    s_cmp_lt_i32 s3, s2
    s_cbranch_scc1 kvj_34
    s_sub_u32 s69, s69, 1
    s_cbranch_scc0 kvp_33
    s_mov_b32 s69, 0
    s_branch kvj_34
kv0_35:
    s_bitset0_b32 s75, 30
    buffer_load_dwordx4 v[72:75], v38, s[8:11], s75 offen offset:0
    buffer_load_dwordx4 v[76:79], v38, s[8:11], s75 offen offset:128
    s_add_u32 s75, s75, 0x40000
    s_cmp_lt_u32 s68, 1
    s_cbranch_scc0 kv0j_36
    s_add_u32 s75, s75, 0x3ffc0000
    s_branch kv0j_36
kvp_38:
    buffer_load_dwordx2 v[122:123], off, s[8:11], s4 sc1
    s_waitcnt vmcnt(0)
kvg_37:
    s_cmp_lt_u32 s68, 1
    s_cbranch_scc1 kvj_39
    v_min_i32 v122, v122, v123
    s_nop 0
    v_readfirstlane_b32 s2, v122
    s_nop 0
    s_cmp_lt_i32 s3, s2
    s_cbranch_scc1 kvj_39
    s_sub_u32 s69, s69, 1
    s_cbranch_scc0 kvp_38
    s_mov_b32 s69, 0
    s_branch kvj_39
xv_s_40:
    buffer_load_dwordx4 v[64:67], v8, s[8:11], s73 offen offset:0 sc1
    buffer_load_dwordx4 v[68:71], v8, s[8:11], s73 offen offset:1024 sc1
    s_sub_u32 s69, s69, 1
    s_cbranch_scc0 xv_w_41
    s_mov_b32 s69, 0
    s_branch xv_j_42
b_s_43:
    buffer_load_dwordx4 v[10:13], v8, s[8:11], s70 offen sc1
    s_sub_u32 s69, s69, 1
    s_cbranch_scc0 b_w_44
    s_mov_b32 s69, 0
    s_branch b_j_45
vo_last_31:
    s_cmp_lg_u32 s64, 0
    s_cbranch_scc1 chain_end_17
pollvm_47:
    buffer_load_dwordx4 v[64:67], v8, s[8:11], s73 offen offset:0 sc1
    buffer_load_dwordx4 v[68:71], v8, s[8:11], s73 offen offset:1024 sc1
    s_waitcnt vmcnt(0)
    v_bitop3_b32 v2, v64, v66, s82 bitop3:0x7e
    v_bitop3_b32 v3, v68, v70, s82 bitop3:0x7e
    v_bitop3_b32 v2, v2, v3, 1 bitop3:0xa8
    v_cmp_ne_u32 vcc, 0, v2
    s_cbranch_vccz pollvm_ok_48
    s_sub_u32 s69, s69, 1
    s_cbranch_scc0 pollvm_47
    s_mov_b32 s69, 0
pollvm_ok_48:
    v_mfma_f32_16x16x32_bf16 v[108:111], v[100:103], v[64:67], 0
    v_mfma_f32_16x16x32_bf16 v[108:111], v[104:107], v[68:71], v[108:111]
    s_nop 7
    v_cvt_pk_bf16_f32 v108, v108, v109
    v_cvt_pk_bf16_f32 v109, v110, v111
    v_min_u32 v108, -2, v108
    buffer_store_dwordx2 v[108:109], v119, s[8:11], s80 offen sc1
chain_end_17:
    s_waitcnt vmcnt(0)
    s_endpgm
bulk_2:
    s_and_b32 s75, s56, 3
    s_lshl_b32 s76, s75, 5
    s_add_u32 s76, s76, s57
    s_mov_b32 s77, 0x40000
    s_mov_b32 s84, 1
    s_cmp_ge_u32 s57, 24
    s_cbranch_scc1 fft_52
    s_mov_b32 s83, 160
    s_mov_b32 s6, 0x4444557e
    s_mov_b32 s7, 0x44444444
    s_mov_b64 s[60:61], s[36:37]
    s_mov_b32 s62, 0x400000
    s_mov_b32 s63, 0x20000
    s_bitcmp1_b32 s57, 3
    s_cbranch_scc1 sv_53
    s_mov_b64 s[64:65], s[24:25]
    s_mov_b32 s66, 0x800000
    s_mov_b32 s67, 0x20000
    s_mov_b32 s81, 0x1000000
    s_cmp_lt_u32 s57, 8
    s_cbranch_scc1 sf_54
    s_mov_b64 s[64:65], s[20:21]
    s_mov_b32 s66, 0x800000
    s_mov_b32 s67, 0x20000
    s_mov_b32 s81, 0x0
    s_mov_b32 s84, 0x10000
    v_bfe_u32 v120, v1, 0, 1
    v_lshlrev_b32 v120, 7, v120
    v_bfe_u32 v121, v1, 1, 5
    v_lshl_or_b32 v120, v121, 13, v120
    s_bfe_u32 s79, s58, 0x20000
    s_lshl_b32 s79, s79, 19
    s_bfe_u32 s85, s58, 0x10002
    s_lshl_b32 s85, s85, 22
    s_or_b32 s79, s79, s85
    s_bfe_u32 s80, s76, 0x30000
    s_lshl_b32 s80, s80, 8
    s_bfe_u32 s85, s76, 0x20005
    s_lshl_b32 s85, s85, 11
    s_or_b32 s80, s80, s85
    s_bfe_u32 s85, s76, 0x10000
    s_lshl_b32 s85, s85, 21
    s_or_b32 s80, s80, s85
    s_add_u32 s79, s79, s80
    s_xor_b32 s85, s79, 0x200000
    buffer_load_dword v122, v120, s[24:27], s85 offen
    s_xor_b32 s85, s79, 0x200000
    buffer_load_dword v123, v120, s[28:31], s85 offen
    s_add_u32 s79, s76, 8
    s_lshl_b32 s85, s79, 3
    s_add_u32 s85, s85, s58
    v_lshlrev_b32 v4, 2, v1
    v_mul_u32_u24 v4, s85, v4
    v_mov_b32 v8, 253
    v_and_b32 v5, 0x3ff, v4
    v_cvt_f32_u32 v5, v5
    v_mul_f32 v5, 0x3a800000, v5
    v_cos_f32 v6, v5
    v_sin_f32 v7, -v5
    v_add_u32 v4, s85, v4
    v_cvt_pk_bf16_f32 v10, v6, v7
    v_and_b32 v5, 0x3ff, v4
    v_cvt_f32_u32 v5, v5
    v_mul_f32 v5, 0x3a800000, v5
    v_cos_f32 v6, v5
    v_sin_f32 v7, -v5
    v_add_u32 v4, s85, v4
    v_cvt_pk_bf16_f32 v11, v6, v7
    v_and_b32 v5, 0x3ff, v4
    v_cvt_f32_u32 v5, v5
    v_mul_f32 v5, 0x3a800000, v5
    v_cos_f32 v6, v5
    v_sin_f32 v7, -v5
    v_add_u32 v4, s85, v4
    v_cvt_pk_bf16_f32 v12, v6, v7
    v_and_b32 v5, 0x3ff, v4
    v_cvt_f32_u32 v5, v5
    v_mul_f32 v5, 0x3a800000, v5
    v_cos_f32 v6, v5
    v_sin_f32 v7, -v5
    v_mad_u32_u24 v4, s85, v8, v4
    v_cvt_pk_bf16_f32 v13, v6, v7
    v_and_b32 v5, 0x3ff, v4
    v_cvt_f32_u32 v5, v5
    v_mul_f32 v5, 0x3a800000, v5
    v_cos_f32 v6, v5
    v_sin_f32 v7, -v5
    v_add_u32 v4, s85, v4
    v_cvt_pk_bf16_f32 v14, v6, v7
    v_and_b32 v5, 0x3ff, v4
    v_cvt_f32_u32 v5, v5
    v_mul_f32 v5, 0x3a800000, v5
    v_cos_f32 v6, v5
    v_sin_f32 v7, -v5
    v_add_u32 v4, s85, v4
    v_cvt_pk_bf16_f32 v15, v6, v7
    v_and_b32 v5, 0x3ff, v4
    v_cvt_f32_u32 v5, v5
    v_mul_f32 v5, 0x3a800000, v5
    v_cos_f32 v6, v5
    v_sin_f32 v7, -v5
    v_add_u32 v4, s85, v4
    v_cvt_pk_bf16_f32 v16, v6, v7
    v_and_b32 v5, 0x3ff, v4
    v_cvt_f32_u32 v5, v5
    v_mul_f32 v5, 0x3a800000, v5
    v_cos_f32 v6, v5
    v_sin_f32 v7, -v5
    v_add_u32 v4, s85, v4
    v_cvt_pk_bf16_f32 v17, v6, v7
    v_mov_b32 v5, s85
    v_lshlrev_b32 v5, 31, v5
    v_or_b32 v5, 0x3f803f80, v5
    v_cmp_eq_u32 vcc, 0, v1
    s_nop 1
    v_cndmask_b32 v10, v10, v5, vcc
    v_lshlrev_b32 v8, 4, v1
    s_lshl_b32 s85, s85, 11
    s_add_u32 s85, s85, 0x5200000
    buffer_store_dwordx4 v[10:13], v8, s[8:11], s85 offen sc1
    buffer_store_dwordx4 v[14:17], v8, s[8:11], s85 offen offset:1024 sc1
    s_sub_u32 s79, s79, 8
    s_lshl_b32 s85, s79, 3
    s_add_u32 s85, s85, s58
    v_lshlrev_b32 v20, 2, v1
    v_mul_u32_u24 v20, s85, v20
    v_mov_b32 v24, 253
    v_and_b32 v21, 0x3ff, v20
    v_cvt_f32_u32 v21, v21
    v_mul_f32 v21, 0x3a800000, v21
    v_cos_f32 v22, v21
    v_sin_f32 v23, -v21
    v_add_u32 v20, s85, v20
    v_cvt_pk_bf16_f32 v26, v22, v23
    v_and_b32 v21, 0x3ff, v20
    v_cvt_f32_u32 v21, v21
    v_mul_f32 v21, 0x3a800000, v21
    v_cos_f32 v22, v21
    v_sin_f32 v23, -v21
    v_add_u32 v20, s85, v20
    v_cvt_pk_bf16_f32 v27, v22, v23
    v_and_b32 v21, 0x3ff, v20
    v_cvt_f32_u32 v21, v21
    v_mul_f32 v21, 0x3a800000, v21
    v_cos_f32 v22, v21
    v_sin_f32 v23, -v21
    v_add_u32 v20, s85, v20
    v_cvt_pk_bf16_f32 v28, v22, v23
    v_and_b32 v21, 0x3ff, v20
    v_cvt_f32_u32 v21, v21
    v_mul_f32 v21, 0x3a800000, v21
    v_cos_f32 v22, v21
    v_sin_f32 v23, -v21
    v_mad_u32_u24 v20, s85, v24, v20
    v_cvt_pk_bf16_f32 v29, v22, v23
    v_and_b32 v21, 0x3ff, v20
    v_cvt_f32_u32 v21, v21
    v_mul_f32 v21, 0x3a800000, v21
    v_cos_f32 v22, v21
    v_sin_f32 v23, -v21
    v_add_u32 v20, s85, v20
    v_cvt_pk_bf16_f32 v30, v22, v23
    v_and_b32 v21, 0x3ff, v20
    v_cvt_f32_u32 v21, v21
    v_mul_f32 v21, 0x3a800000, v21
    v_cos_f32 v22, v21
    v_sin_f32 v23, -v21
    v_add_u32 v20, s85, v20
    v_cvt_pk_bf16_f32 v31, v22, v23
    v_and_b32 v21, 0x3ff, v20
    v_cvt_f32_u32 v21, v21
    v_mul_f32 v21, 0x3a800000, v21
    v_cos_f32 v22, v21
    v_sin_f32 v23, -v21
    v_add_u32 v20, s85, v20
    v_cvt_pk_bf16_f32 v32, v22, v23
    v_and_b32 v21, 0x3ff, v20
    v_cvt_f32_u32 v21, v21
    v_mul_f32 v21, 0x3a800000, v21
    v_cos_f32 v22, v21
    v_sin_f32 v23, -v21
    v_add_u32 v20, s85, v20
    v_cvt_pk_bf16_f32 v33, v22, v23
    v_mov_b32 v21, s85
    v_lshlrev_b32 v21, 31, v21
    v_or_b32 v21, 0x3f803f80, v21
    v_cmp_eq_u32 vcc, 0, v1
    s_nop 1
    v_cndmask_b32 v26, v26, v21, vcc
    v_lshlrev_b32 v24, 4, v1
    s_lshl_b32 s85, s85, 11
    s_add_u32 s85, s85, 0x5200000
    buffer_store_dwordx4 v[26:29], v24, s[8:11], s85 offen sc1
    buffer_store_dwordx4 v[30:33], v24, s[8:11], s85 offen offset:1024 sc1
    s_sub_u32 s79, s79, 8
    s_lshl_b32 s85, s79, 3
    s_add_u32 s85, s85, s58
    v_lshlrev_b32 v36, 2, v1
    v_mul_u32_u24 v36, s85, v36
    v_mov_b32 v40, 253
    v_and_b32 v37, 0x3ff, v36
    v_cvt_f32_u32 v37, v37
    v_mul_f32 v37, 0x3a800000, v37
    v_cos_f32 v38, v37
    v_sin_f32 v39, -v37
    v_add_u32 v36, s85, v36
    v_cvt_pk_bf16_f32 v42, v38, v39
    v_and_b32 v37, 0x3ff, v36
    v_cvt_f32_u32 v37, v37
    v_mul_f32 v37, 0x3a800000, v37
    v_cos_f32 v38, v37
    v_sin_f32 v39, -v37
    v_add_u32 v36, s85, v36
    v_cvt_pk_bf16_f32 v43, v38, v39
    v_and_b32 v37, 0x3ff, v36
    v_cvt_f32_u32 v37, v37
    v_mul_f32 v37, 0x3a800000, v37
    v_cos_f32 v38, v37
    v_sin_f32 v39, -v37
    v_add_u32 v36, s85, v36
    v_cvt_pk_bf16_f32 v44, v38, v39
    v_and_b32 v37, 0x3ff, v36
    v_cvt_f32_u32 v37, v37
    v_mul_f32 v37, 0x3a800000, v37
    v_cos_f32 v38, v37
    v_sin_f32 v39, -v37
    v_mad_u32_u24 v36, s85, v40, v36
    v_cvt_pk_bf16_f32 v45, v38, v39
    v_and_b32 v37, 0x3ff, v36
    v_cvt_f32_u32 v37, v37
    v_mul_f32 v37, 0x3a800000, v37
    v_cos_f32 v38, v37
    v_sin_f32 v39, -v37
    v_add_u32 v36, s85, v36
    v_cvt_pk_bf16_f32 v46, v38, v39
    v_and_b32 v37, 0x3ff, v36
    v_cvt_f32_u32 v37, v37
    v_mul_f32 v37, 0x3a800000, v37
    v_cos_f32 v38, v37
    v_sin_f32 v39, -v37
    v_add_u32 v36, s85, v36
    v_cvt_pk_bf16_f32 v47, v38, v39
    v_and_b32 v37, 0x3ff, v36
    v_cvt_f32_u32 v37, v37
    v_mul_f32 v37, 0x3a800000, v37
    v_cos_f32 v38, v37
    v_sin_f32 v39, -v37
    v_add_u32 v36, s85, v36
    v_cvt_pk_bf16_f32 v48, v38, v39
    v_and_b32 v37, 0x3ff, v36
    v_cvt_f32_u32 v37, v37
    v_mul_f32 v37, 0x3a800000, v37
    v_cos_f32 v38, v37
    v_sin_f32 v39, -v37
    v_add_u32 v36, s85, v36
    v_cvt_pk_bf16_f32 v49, v38, v39
    v_mov_b32 v37, s85
    v_lshlrev_b32 v37, 31, v37
    v_or_b32 v37, 0x3f803f80, v37
    v_cmp_eq_u32 vcc, 0, v1
    s_nop 1
    v_cndmask_b32 v42, v42, v37, vcc
    v_lshlrev_b32 v40, 4, v1
    s_lshl_b32 s85, s85, 11
    s_add_u32 s85, s85, 0x5200000
    buffer_store_dwordx4 v[42:45], v40, s[8:11], s85 offen sc1
    buffer_store_dwordx4 v[46:49], v40, s[8:11], s85 offen offset:1024 sc1
    s_sub_u32 s79, s79, 8
    s_lshl_b32 s85, s79, 3
    s_add_u32 s85, s85, s58
    v_lshlrev_b32 v52, 2, v1
    v_mul_u32_u24 v52, s85, v52
    v_mov_b32 v56, 253
    v_and_b32 v53, 0x3ff, v52
    v_cvt_f32_u32 v53, v53
    v_mul_f32 v53, 0x3a800000, v53
    v_cos_f32 v54, v53
    v_sin_f32 v55, -v53
    v_add_u32 v52, s85, v52
    v_cvt_pk_bf16_f32 v58, v54, v55
    v_and_b32 v53, 0x3ff, v52
    v_cvt_f32_u32 v53, v53
    v_mul_f32 v53, 0x3a800000, v53
    v_cos_f32 v54, v53
    v_sin_f32 v55, -v53
    v_add_u32 v52, s85, v52
    v_cvt_pk_bf16_f32 v59, v54, v55
    v_and_b32 v53, 0x3ff, v52
    v_cvt_f32_u32 v53, v53
    v_mul_f32 v53, 0x3a800000, v53
    v_cos_f32 v54, v53
    v_sin_f32 v55, -v53
    v_add_u32 v52, s85, v52
    v_cvt_pk_bf16_f32 v60, v54, v55
    v_and_b32 v53, 0x3ff, v52
    v_cvt_f32_u32 v53, v53
    v_mul_f32 v53, 0x3a800000, v53
    v_cos_f32 v54, v53
    v_sin_f32 v55, -v53
    v_mad_u32_u24 v52, s85, v56, v52
    v_cvt_pk_bf16_f32 v61, v54, v55
    v_and_b32 v53, 0x3ff, v52
    v_cvt_f32_u32 v53, v53
    v_mul_f32 v53, 0x3a800000, v53
    v_cos_f32 v54, v53
    v_sin_f32 v55, -v53
    v_add_u32 v52, s85, v52
    v_cvt_pk_bf16_f32 v62, v54, v55
    v_and_b32 v53, 0x3ff, v52
    v_cvt_f32_u32 v53, v53
    v_mul_f32 v53, 0x3a800000, v53
    v_cos_f32 v54, v53
    v_sin_f32 v55, -v53
    v_add_u32 v52, s85, v52
    v_cvt_pk_bf16_f32 v63, v54, v55
    v_and_b32 v53, 0x3ff, v52
    v_cvt_f32_u32 v53, v53
    v_mul_f32 v53, 0x3a800000, v53
    v_cos_f32 v54, v53
    v_sin_f32 v55, -v53
    v_add_u32 v52, s85, v52
    v_cvt_pk_bf16_f32 v64, v54, v55
    v_and_b32 v53, 0x3ff, v52
    v_cvt_f32_u32 v53, v53
    v_mul_f32 v53, 0x3a800000, v53
    v_cos_f32 v54, v53
    v_sin_f32 v55, -v53
    v_add_u32 v52, s85, v52
    v_cvt_pk_bf16_f32 v65, v54, v55
    v_mov_b32 v53, s85
    v_lshlrev_b32 v53, 31, v53
    v_or_b32 v53, 0x3f803f80, v53
    v_cmp_eq_u32 vcc, 0, v1
    s_nop 1
    v_cndmask_b32 v58, v58, v53, vcc
    v_lshlrev_b32 v56, 4, v1
    s_lshl_b32 s85, s85, 11
    s_add_u32 s85, s85, 0x5200000
    buffer_store_dwordx4 v[58:61], v56, s[8:11], s85 offen sc1
    buffer_store_dwordx4 v[62:65], v56, s[8:11], s85 offen offset:1024 sc1
    s_sub_u32 s79, s79, 8
    s_waitcnt vmcnt(0)
sf_54:
    v_bfe_u32 v4, v1, 4, 2
    v_lshlrev_b32 v4, 2, v4
    v_xor_b32 v4, v4, v1
    v_bfe_u32 v84, v4, 0, 1
    v_lshlrev_b32 v84, 5, v84
    v_bfe_u32 v5, v4, 1, 1
    v_lshl_or_b32 v84, v5, 4, v84
    v_bfe_u32 v5, v4, 2, 2
    v_lshl_or_b32 v84, v5, 6, v84
    v_bfe_u32 v5, v4, 4, 2
    v_lshl_or_b32 v84, v5, 13, v84
    v_xor_b32 v85, 16, v84
    s_bfe_u32 s68, s58, 0x20000
    s_lshl_b32 s68, s68, 19
    s_bfe_u32 s71, s58, 0x10002
    s_lshl_b32 s71, s71, 22
    s_or_b32 s68, s68, s71
    s_bfe_u32 s71, s57, 0x30000
    s_lshl_b32 s71, s71, 8
    s_bfe_u32 s72, s57, 0x10000
    s_lshl_b32 s72, s72, 21
    s_or_b32 s71, s71, s72
    s_add_u32 s68, s68, s71
    s_lshl_b32 s71, s75, 11
    s_add_u32 s68, s68, s71
    s_xor_b32 s69, s68, 0x200000
    s_lshl_b32 s70, s58, 14
    s_add_u32 m0, s70, 0
    s_nop 0
    buffer_load_dwordx4 v84, s[64:67], s68 offen lds
    s_add_u32 s68, s68, 0x8000
    s_add_u32 m0, s70, 1024
    s_nop 0
    buffer_load_dwordx4 v84, s[64:67], s68 offen lds
    s_add_u32 s68, s68, 0x8000
    s_add_u32 m0, s70, 2048
    s_nop 0
    buffer_load_dwordx4 v85, s[64:67], s68 offen lds
    s_add_u32 s68, s68, 0x8000
    s_add_u32 m0, s70, 3072
    s_nop 0
    buffer_load_dwordx4 v85, s[64:67], s68 offen lds
    s_add_u32 s68, s68, 0x8000
    s_add_u32 m0, s70, 4096
    s_nop 0
    buffer_load_dwordx4 v84, s[64:67], s68 offen lds
    s_add_u32 s68, s68, 0x8000
    s_add_u32 m0, s70, 5120
    s_nop 0
    buffer_load_dwordx4 v84, s[64:67], s68 offen lds
    s_add_u32 s68, s68, 0x8000
    s_add_u32 m0, s70, 6144
    s_nop 0
    buffer_load_dwordx4 v85, s[64:67], s68 offen lds
    s_add_u32 s68, s68, 0x8000
    s_add_u32 m0, s70, 7168
    s_nop 0
    buffer_load_dwordx4 v85, s[64:67], s68 offen lds
    s_add_u32 s68, s68, 0x8000
    s_add_u32 m0, s70, 8192
    s_nop 0
    buffer_load_dwordx4 v84, s[64:67], s68 offen lds
    s_add_u32 s68, s68, 0x8000
    s_add_u32 m0, s70, 9216
    s_nop 0
    buffer_load_dwordx4 v84, s[64:67], s68 offen lds
    s_add_u32 s68, s68, 0x8000
    s_add_u32 m0, s70, 10240
    s_nop 0
    buffer_load_dwordx4 v85, s[64:67], s68 offen lds
    s_add_u32 s68, s68, 0x8000
    s_add_u32 m0, s70, 11264
    s_nop 0
    buffer_load_dwordx4 v85, s[64:67], s68 offen lds
    s_add_u32 s68, s68, 0x8000
    s_add_u32 m0, s70, 12288
    s_nop 0
    buffer_load_dwordx4 v84, s[64:67], s68 offen lds
    s_add_u32 s68, s68, 0x8000
    s_add_u32 m0, s70, 13312
    s_nop 0
    buffer_load_dwordx4 v84, s[64:67], s68 offen lds
    s_add_u32 s68, s68, 0x8000
    s_add_u32 m0, s70, 14336
    s_nop 0
    buffer_load_dwordx4 v85, s[64:67], s68 offen lds
    s_add_u32 s68, s68, 0x8000
    s_add_u32 m0, s70, 15360
    s_nop 0
    buffer_load_dwordx4 v85, s[64:67], s68 offen lds
    s_add_u32 s68, s68, 0x8000
    s_cmp_lt_u32 s57, 16
    s_cbranch_scc1 sq_64
    s_waitcnt vmcnt(0)
sq_64:
    buffer_load_dwordx4 v[192:195], v84, s[64:67], s69 offen
    s_add_u32 s69, s69, 0x8000
    buffer_load_dwordx4 v[196:199], v84, s[64:67], s69 offen
    s_add_u32 s69, s69, 0x8000
    buffer_load_dwordx4 v[200:203], v85, s[64:67], s69 offen
    s_add_u32 s69, s69, 0x8000
    buffer_load_dwordx4 v[204:207], v85, s[64:67], s69 offen
    s_add_u32 s69, s69, 0x8000
    buffer_load_dwordx4 v[208:211], v84, s[64:67], s69 offen
    s_add_u32 s69, s69, 0x8000
    buffer_load_dwordx4 v[212:215], v84, s[64:67], s69 offen
    s_add_u32 s69, s69, 0x8000
    buffer_load_dwordx4 v[216:219], v85, s[64:67], s69 offen
    s_add_u32 s69, s69, 0x8000
    buffer_load_dwordx4 v[220:223], v85, s[64:67], s69 offen
    s_add_u32 s69, s69, 0x8000
    buffer_load_dwordx4 v[224:227], v84, s[64:67], s69 offen
    s_add_u32 s69, s69, 0x8000
    buffer_load_dwordx4 v[228:231], v84, s[64:67], s69 offen
    s_add_u32 s69, s69, 0x8000
    buffer_load_dwordx4 v[232:235], v85, s[64:67], s69 offen
    s_add_u32 s69, s69, 0x8000
    buffer_load_dwordx4 v[236:239], v85, s[64:67], s69 offen
    s_add_u32 s69, s69, 0x8000
    buffer_load_dwordx4 v[240:243], v84, s[64:67], s69 offen
    s_add_u32 s69, s69, 0x8000
    buffer_load_dwordx4 v[244:247], v84, s[64:67], s69 offen
    s_add_u32 s69, s69, 0x8000
    buffer_load_dwordx4 v[248:251], v85, s[64:67], s69 offen
    s_add_u32 s69, s69, 0x8000
    buffer_load_dwordx4 v[252:255], v85, s[64:67], s69 offen
    s_add_u32 s69, s69, 0x8000
    s_lshl_b32 s71, s57, 3
    s_add_u32 s71, s71, s58
    s_lshl_b32 s71, s71, 13
    s_cmp_lt_u32 s57, 3
    s_cselect_b32 s71, s71, 0x5ffffff0
    v_lshlrev_b32 v4, 7, v1
    buffer_load_dword v99, v4, s[36:39], s71 offen
    v_bfe_u32 v88, v1, 0, 2
    v_lshlrev_b32 v88, 3, v88
    v_bfe_u32 v5, v1, 4, 1
    v_lshl_or_b32 v88, v5, 5, v88
    v_bfe_u32 v5, v1, 2, 2
    v_lshl_or_b32 v88, v5, 6, v88
    v_bfe_u32 v5, v1, 2, 2
    v_lshl_or_b32 v88, v5, 8, v88
    v_bfe_u32 v5, v1, 4, 2
    v_lshl_or_b32 v88, v5, 11, v88
    s_bfe_u32 s71, s58, 0x20000
    s_lshl_b32 s71, s71, 6
    s_bfe_u32 s72, s58, 0x10002
    s_lshl_b32 s72, s72, 16
    s_or_b32 s71, s71, s72
    v_xor_b32 v88, s71, v88
    v_xor_b32 v89, 32, v88
    v_lshl_add_u32 v96, v1, 4, s70
    s_lshl_b32 s71, s75, 16
    s_add_u32 s81, s81, s71
    s_bfe_u32 s68, s57, 0x10000
    s_lshl_b32 s68, s68, 9
    s_lshl_b32 s71, s58, 2
    v_bfe_u32 v4, v1, 5, 1
    v_lshlrev_b32 v4, 4, v4
    v_xor_b32 v4, s71, v4
    v_lshlrev_b32 v4, 11, v4
    s_and_b32 s71, s71, 12
    v_xor_b32 v5, s71, v1
    v_bfe_u32 v84, v5, 0, 5
    v_lshlrev_b32 v84, 4, v84
    v_bfe_u32 v6, v5, 5, 1
    v_lshl_or_b32 v84, v6, 10, v84
    s_mov_b32 s72, 1024
    v_add_u32 v84, v84, v4
    v_xor_b32 v85, 16, v84
    v_add_u32 v85, s72, v85
    v_xor_b32 v86, 48, v85
    v_add_u32 v86, s72, v86
    v_xor_b32 v87, 16, v86
    v_add_u32 v87, s72, v87
    s_xor_b32 s69, s68, 512
    s_lshl_b32 s70, s58, 12
    s_waitcnt vmcnt(17)
    s_barrier
    ds_read_b64_tr_b16 v[128:129], v88 offset:0
    ds_read_b64_tr_b16 v[130:131], v88 offset:1024
    ds_read_b64_tr_b16 v[132:133], v89 offset:0
    ds_read_b64_tr_b16 v[134:135], v89 offset:1024
    ds_read_b64_tr_b16 v[136:137], v88 offset:8192
    ds_read_b64_tr_b16 v[138:139], v88 offset:9216
    ds_read_b64_tr_b16 v[140:141], v89 offset:8192
    ds_read_b64_tr_b16 v[142:143], v89 offset:9216
    s_waitcnt lgkmcnt(4)
    ds_read_b64_tr_b16 v[144:145], v88 offset:16384
    ds_read_b64_tr_b16 v[146:147], v88 offset:17408
    ds_read_b64_tr_b16 v[148:149], v89 offset:16384
    ds_read_b64_tr_b16 v[150:151], v89 offset:17408
    ds_read_b64_tr_b16 v[152:153], v88 offset:24576
    ds_read_b64_tr_b16 v[154:155], v88 offset:25600
    ds_read_b64_tr_b16 v[156:157], v89 offset:24576
    ds_read_b64_tr_b16 v[158:159], v89 offset:25600
    s_waitcnt lgkmcnt(4)
    ds_read_b64_tr_b16 v[160:161], v88 offset:32768
    ds_read_b64_tr_b16 v[162:163], v88 offset:33792
    ds_read_b64_tr_b16 v[164:165], v89 offset:32768
    ds_read_b64_tr_b16 v[166:167], v89 offset:33792
    ds_read_b64_tr_b16 v[168:169], v88 offset:40960
    ds_read_b64_tr_b16 v[170:171], v88 offset:41984
    ds_read_b64_tr_b16 v[172:173], v89 offset:40960
    ds_read_b64_tr_b16 v[174:175], v89 offset:41984
    s_waitcnt lgkmcnt(4)
    ds_read_b64_tr_b16 v[176:177], v88 offset:49152
    ds_read_b64_tr_b16 v[178:179], v88 offset:50176
    ds_read_b64_tr_b16 v[180:181], v89 offset:49152
    ds_read_b64_tr_b16 v[182:183], v89 offset:50176
    ds_read_b64_tr_b16 v[184:185], v88 offset:57344
    ds_read_b64_tr_b16 v[186:187], v88 offset:58368
    ds_read_b64_tr_b16 v[188:189], v89 offset:57344
    ds_read_b64_tr_b16 v[190:191], v89 offset:58368
    s_waitcnt lgkmcnt(0)
    s_barrier
    buffer_load_dwordx4 v[20:23], v84, s[36:39], s68 offen offset:0
    buffer_load_dwordx4 v[24:27], v85, s[36:39], s68 offen offset:1024
    buffer_load_dwordx4 v[28:31], v86, s[36:39], s68 offen offset:2048
    buffer_load_dwordx4 v[32:35], v87, s[36:39], s68 offen offset:3072
    s_add_u32 s68, s68, 0x10000
    buffer_load_dwordx4 v[36:39], v84, s[36:39], s69 offen offset:0
    buffer_load_dwordx4 v[40:43], v85, s[36:39], s69 offen offset:1024
    buffer_load_dwordx4 v[44:47], v86, s[36:39], s69 offen offset:2048
    buffer_load_dwordx4 v[48:51], v87, s[36:39], s69 offen offset:3072
    s_add_u32 s69, s69, 0x10000
    buffer_load_dwordx4 v[52:55], v84, s[36:39], s68 offen offset:0
    buffer_load_dwordx4 v[56:59], v85, s[36:39], s68 offen offset:1024
    buffer_load_dwordx4 v[60:63], v86, s[36:39], s68 offen offset:2048
    buffer_load_dwordx4 v[64:67], v87, s[36:39], s68 offen offset:3072
    s_add_u32 s68, s68, 0x10000
    s_waitcnt vmcnt(28)
    ds_write_b128 v96, v[192:195] offset:0
    s_waitcnt vmcnt(27)
    ds_write_b128 v96, v[196:199] offset:1024
    s_waitcnt vmcnt(26)
    ds_write_b128 v96, v[200:203] offset:2048
    s_waitcnt vmcnt(25)
    ds_write_b128 v96, v[204:207] offset:3072
    s_waitcnt vmcnt(24)
    ds_write_b128 v96, v[208:211] offset:4096
    s_waitcnt vmcnt(23)
    ds_write_b128 v96, v[212:215] offset:5120
    s_waitcnt vmcnt(22)
    ds_write_b128 v96, v[216:219] offset:6144
    s_waitcnt vmcnt(21)
    ds_write_b128 v96, v[220:223] offset:7168
    s_waitcnt vmcnt(20)
    ds_write_b128 v96, v[224:227] offset:8192
    s_waitcnt vmcnt(19)
    ds_write_b128 v96, v[228:231] offset:9216
    s_waitcnt vmcnt(18)
    ds_write_b128 v96, v[232:235] offset:10240
    s_waitcnt vmcnt(17)
    ds_write_b128 v96, v[236:239] offset:11264
    s_waitcnt vmcnt(16)
    ds_write_b128 v96, v[240:243] offset:12288
    s_waitcnt vmcnt(15)
    ds_write_b128 v96, v[244:247] offset:13312
    s_waitcnt vmcnt(14)
    ds_write_b128 v96, v[248:251] offset:14336
    s_waitcnt vmcnt(13)
    ds_write_b128 v96, v[252:255] offset:15360
    s_waitcnt lgkmcnt(0)
    s_barrier
    ds_read_b64_tr_b16 v[192:193], v88 offset:0
    ds_read_b64_tr_b16 v[194:195], v88 offset:1024
    ds_read_b64_tr_b16 v[196:197], v89 offset:0
    ds_read_b64_tr_b16 v[198:199], v89 offset:1024
    ds_read_b64_tr_b16 v[200:201], v88 offset:8192
    ds_read_b64_tr_b16 v[202:203], v88 offset:9216
    ds_read_b64_tr_b16 v[204:205], v89 offset:8192
    ds_read_b64_tr_b16 v[206:207], v89 offset:9216
    s_waitcnt lgkmcnt(4)
    ds_read_b64_tr_b16 v[208:209], v88 offset:16384
    ds_read_b64_tr_b16 v[210:211], v88 offset:17408
    ds_read_b64_tr_b16 v[212:213], v89 offset:16384
    ds_read_b64_tr_b16 v[214:215], v89 offset:17408
    ds_read_b64_tr_b16 v[216:217], v88 offset:24576
    ds_read_b64_tr_b16 v[218:219], v88 offset:25600
    ds_read_b64_tr_b16 v[220:221], v89 offset:24576
    ds_read_b64_tr_b16 v[222:223], v89 offset:25600
    s_waitcnt lgkmcnt(4)
    ds_read_b64_tr_b16 v[224:225], v88 offset:32768
    ds_read_b64_tr_b16 v[226:227], v88 offset:33792
    ds_read_b64_tr_b16 v[228:229], v89 offset:32768
    ds_read_b64_tr_b16 v[230:231], v89 offset:33792
    ds_read_b64_tr_b16 v[232:233], v88 offset:40960
    ds_read_b64_tr_b16 v[234:235], v88 offset:41984
    ds_read_b64_tr_b16 v[236:237], v89 offset:40960
    ds_read_b64_tr_b16 v[238:239], v89 offset:41984
    s_waitcnt lgkmcnt(4)
    ds_read_b64_tr_b16 v[240:241], v88 offset:49152
    ds_read_b64_tr_b16 v[242:243], v88 offset:50176
    ds_read_b64_tr_b16 v[244:245], v89 offset:49152
    ds_read_b64_tr_b16 v[246:247], v89 offset:50176
    ds_read_b64_tr_b16 v[248:249], v88 offset:57344
    ds_read_b64_tr_b16 v[250:251], v88 offset:58368
    ds_read_b64_tr_b16 v[252:253], v89 offset:57344
    ds_read_b64_tr_b16 v[254:255], v89 offset:58368
    s_waitcnt lgkmcnt(0)
    s_barrier
    v_lshl_add_u32 v96, v1, 4, s70
    v_add_u32 v97, 0x10000, v96
    s_waitcnt vmcnt(11)
    ds_write_b128 v96, v[20:23] offset:0
    s_waitcnt vmcnt(10)
    ds_write_b128 v96, v[24:27] offset:1024
    s_waitcnt vmcnt(9)
    ds_write_b128 v96, v[28:31] offset:2048
    s_waitcnt vmcnt(8)
    ds_write_b128 v96, v[32:35] offset:3072
    s_waitcnt vmcnt(7)
    ds_write_b128 v96, v[36:39] offset:32768
    s_waitcnt vmcnt(6)
    ds_write_b128 v96, v[40:43] offset:33792
    s_waitcnt vmcnt(5)
    ds_write_b128 v96, v[44:47] offset:34816
    s_waitcnt vmcnt(4)
    ds_write_b128 v96, v[48:51] offset:35840
    s_waitcnt vmcnt(3)
    ds_write_b128 v97, v[52:55] offset:0
    s_waitcnt vmcnt(2)
    ds_write_b128 v97, v[56:59] offset:1024
    s_waitcnt vmcnt(1)
    ds_write_b128 v97, v[60:63] offset:2048
    s_waitcnt vmcnt(0)
    ds_write_b128 v97, v[64:67] offset:3072
    buffer_load_dword v99, off, s[12:15], s70 offset:32 sc1
    v_lshrrev_b32 v4, 4, v1
    v_xor_b32 v4, v4, v1
    v_bfe_u32 v5, v4, 0, 4
    v_lshlrev_b32 v5, 4, v5
    v_bfe_u32 v4, v1, 0, 4
    v_lshlrev_b32 v4, 10, v4
    s_bfe_u32 s71, s58, 0x10002
    s_lshl_b32 s71, s71, 9
    v_or3_b32 v88, v4, v5, s71
    v_xor_b32 v89, 0x40, v88
    v_xor_b32 v90, 0x80, v88
    v_xor_b32 v91, 0xc0, v88
    v_xor_b32 v92, 0x10000, v88
    v_xor_b32 v93, 0x10040, v88
    v_xor_b32 v94, 0x10080, v88
    v_xor_b32 v95, 0x100c0, v88
    s_lshl_b32 s71, s58, 11
    s_or_b32 s71, s71, 131072
    v_lshl_add_u32 v96, v1, 4, s71
    v_xor_b32 v97, 0x2000, v96
    v_bfe_u32 v98, v1, 0, 4
    v_lshlrev_b32 v98, 4, v98
    v_bfe_u32 v4, v1, 4, 2
    v_lshl_or_b32 v98, v4, 9, v98
    s_bfe_u32 s71, s57, 0x30000
    s_lshl_b32 s71, s71, 13
    s_add_u32 s81, s81, s71
    s_bfe_u32 s71, s58, 0x20000
    s_lshl_b32 s71, s71, 11
    s_bfe_u32 s72, s58, 0x10002
    s_lshl_b32 s72, s72, 8
    s_or_b32 s71, s71, s72
    s_add_u32 s81, s81, s71
    s_mov_b32 s73, 0x5ffffff0
    s_mov_b32 s82, 0
    s_waitcnt vmcnt(8) lgkmcnt(0)
    s_barrier
    ds_read_b128 v[52:55], v88 offset:0
    ds_read_b128 v[56:59], v88 offset:16384
    ds_read_b128 v[60:63], v89 offset:0
    ds_read_b128 v[64:67], v89 offset:16384
    v_mov_b32 v100, 3
    v_cmp_gt_u32 vcc, s58, v100
stream_65:
    s_waitcnt lgkmcnt(2)
    v_mfma_f32_16x16x32_bf16 v[20:23], v[128:131], v[52:55], 0
    ds_read_b128 v[68:71], v90 offset:0
    v_mfma_f32_16x16x32_bf16 v[24:27], v[132:135], v[52:55], 0
    ds_read_b128 v[72:75], v90 offset:16384
    v_mfma_f32_16x16x32_bf16 v[28:31], v[128:131], v[56:59], 0
    s_add_u32 m0, s70, 98304
    s_nop 0
    buffer_load_dwordx4 v84, s[36:39], s69 offen offset:0 lds
    v_mfma_f32_16x16x32_bf16 v[32:35], v[132:135], v[56:59], 0
    s_waitcnt lgkmcnt(2)
    v_mfma_f32_16x16x32_bf16 v[20:23], v[136:139], v[60:63], v[20:23]
    ds_read_b128 v[76:79], v91 offset:0
    v_mfma_f32_16x16x32_bf16 v[24:27], v[140:143], v[60:63], v[24:27]
    ds_read_b128 v[80:83], v91 offset:16384
    v_mfma_f32_16x16x32_bf16 v[28:31], v[136:139], v[64:67], v[28:31]
    buffer_load_dwordx4 v85, s[36:39], s69 offen offset:1024 lds
    v_mfma_f32_16x16x32_bf16 v[32:35], v[140:143], v[64:67], v[32:35]
    ds_write_b128 v96, v[44:47] offset:0
    s_waitcnt lgkmcnt(3)
    v_mfma_f32_16x16x32_bf16 v[20:23], v[144:147], v[68:71], v[20:23]
    ds_read_b128 v[52:55], v88 offset:256
    v_mfma_f32_16x16x32_bf16 v[24:27], v[148:151], v[68:71], v[24:27]
    ds_read_b128 v[56:59], v88 offset:16640
    v_mfma_f32_16x16x32_bf16 v[28:31], v[144:147], v[72:75], v[28:31]
    buffer_load_dwordx4 v86, s[36:39], s69 offen offset:2048 lds
    v_mfma_f32_16x16x32_bf16 v[32:35], v[148:151], v[72:75], v[32:35]
    ds_write_b128 v96, v[48:51] offset:1024
    s_waitcnt lgkmcnt(4)
    v_mfma_f32_16x16x32_bf16 v[20:23], v[152:155], v[76:79], v[20:23]
    ds_read_b128 v[60:63], v89 offset:256
    v_mfma_f32_16x16x32_bf16 v[24:27], v[156:159], v[76:79], v[24:27]
    ds_read_b128 v[64:67], v89 offset:16640
    v_mfma_f32_16x16x32_bf16 v[28:31], v[152:155], v[80:83], v[28:31]
    buffer_load_dwordx4 v87, s[36:39], s69 offen offset:3072 lds
    s_add_u32 s69, s69, 0x10000
    v_mfma_f32_16x16x32_bf16 v[32:35], v[156:159], v[80:83], v[32:35]
    s_waitcnt lgkmcnt(3)
    v_mfma_f32_16x16x32_bf16 v[20:23], v[160:163], v[52:55], v[20:23]
    ds_read_b128 v[68:71], v90 offset:256
    v_mfma_f32_16x16x32_bf16 v[24:27], v[164:167], v[52:55], v[24:27]
    ds_read_b128 v[72:75], v90 offset:16640
    v_mfma_f32_16x16x32_bf16 v[28:31], v[160:163], v[56:59], v[28:31]
    v_mfma_f32_16x16x32_bf16 v[32:35], v[164:167], v[56:59], v[32:35]
    s_waitcnt lgkmcnt(2)
    v_mfma_f32_16x16x32_bf16 v[20:23], v[168:171], v[60:63], v[20:23]
    ds_read_b128 v[76:79], v91 offset:256
    v_mfma_f32_16x16x32_bf16 v[24:27], v[172:175], v[60:63], v[24:27]
    ds_read_b128 v[80:83], v91 offset:16640
    v_mfma_f32_16x16x32_bf16 v[28:31], v[168:171], v[64:67], v[28:31]
    v_mfma_f32_16x16x32_bf16 v[32:35], v[172:175], v[64:67], v[32:35]
    s_waitcnt vmcnt(8) lgkmcnt(0)
    s_barrier
    v_mfma_f32_16x16x32_bf16 v[20:23], v[176:179], v[68:71], v[20:23]
    ds_read_b128 v[4:7], v97 offset:0
    ds_read_b128 v[8:11], v97 offset:1024
    ds_read_b128 v[52:55], v88 offset:32768
    v_mfma_f32_16x16x32_bf16 v[24:27], v[180:183], v[68:71], v[24:27]
    ds_read_b128 v[56:59], v88 offset:49152
    v_mfma_f32_16x16x32_bf16 v[28:31], v[176:179], v[72:75], v[28:31]
    v_mfma_f32_16x16x32_bf16 v[32:35], v[180:183], v[72:75], v[32:35]
    s_waitcnt lgkmcnt(2)
    v_mfma_f32_16x16x32_bf16 v[20:23], v[184:187], v[76:79], v[20:23]
    v_add_f32 v4, v4, v36
    v_add_f32 v5, v5, v37
    v_add_f32 v6, v6, v38
    v_add_f32 v7, v7, v39
    ds_read_b128 v[60:63], v89 offset:32768
    v_mfma_f32_16x16x32_bf16 v[24:27], v[188:191], v[76:79], v[24:27]
    v_cvt_pk_bf16_f32 v12, v4, v5
    v_cvt_pk_bf16_f32 v13, v6, v7
    ds_read_b128 v[64:67], v89 offset:49152
    v_mfma_f32_16x16x32_bf16 v[28:31], v[184:187], v[80:83], v[28:31]
    v_add_f32 v8, v8, v40
    v_add_f32 v9, v9, v41
    v_add_f32 v10, v10, v42
    v_add_f32 v11, v11, v43
    v_mfma_f32_16x16x32_bf16 v[32:35], v[188:191], v[80:83], v[32:35]
    v_cvt_pk_bf16_f32 v14, v8, v9
    v_cvt_pk_bf16_f32 v15, v10, v11
    buffer_store_dwordx4 v[12:15], v98, s[8:11], s73 offen sc1
    s_mov_b32 s73, s81
    s_add_u32 s81, s81, 0x40000
    s_waitcnt lgkmcnt(2)
    v_mfma_f32_16x16x32_bf16 v[20:23], v[192:195], v[52:55], v[20:23]
    ds_read_b128 v[68:71], v90 offset:32768
    v_mfma_f32_16x16x32_bf16 v[24:27], v[196:199], v[52:55], v[24:27]
    ds_read_b128 v[72:75], v90 offset:49152
    v_mfma_f32_16x16x32_bf16 v[28:31], v[192:195], v[56:59], v[28:31]
    s_add_u32 m0, s70, 0
    s_nop 0
    buffer_load_dwordx4 v84, s[36:39], s68 offen offset:0 lds
    v_mfma_f32_16x16x32_bf16 v[32:35], v[196:199], v[56:59], v[32:35]
    s_waitcnt lgkmcnt(2)
    v_mfma_f32_16x16x32_bf16 v[20:23], v[200:203], v[60:63], v[20:23]
    ds_read_b128 v[76:79], v91 offset:32768
    v_mfma_f32_16x16x32_bf16 v[24:27], v[204:207], v[60:63], v[24:27]
    ds_read_b128 v[80:83], v91 offset:49152
    v_mfma_f32_16x16x32_bf16 v[28:31], v[200:203], v[64:67], v[28:31]
    buffer_load_dwordx4 v85, s[36:39], s68 offen offset:1024 lds
    v_mfma_f32_16x16x32_bf16 v[32:35], v[204:207], v[64:67], v[32:35]
    s_waitcnt lgkmcnt(2)
    v_mfma_f32_16x16x32_bf16 v[20:23], v[208:211], v[68:71], v[20:23]
    ds_read_b128 v[52:55], v88 offset:33024
    v_mfma_f32_16x16x32_bf16 v[24:27], v[212:215], v[68:71], v[24:27]
    ds_read_b128 v[56:59], v88 offset:49408
    v_mfma_f32_16x16x32_bf16 v[28:31], v[208:211], v[72:75], v[28:31]
    buffer_load_dwordx4 v86, s[36:39], s68 offen offset:2048 lds
    v_mfma_f32_16x16x32_bf16 v[32:35], v[212:215], v[72:75], v[32:35]
    s_waitcnt lgkmcnt(2)
    v_mfma_f32_16x16x32_bf16 v[20:23], v[216:219], v[76:79], v[20:23]
    ds_read_b128 v[60:63], v89 offset:33024
    v_mfma_f32_16x16x32_bf16 v[24:27], v[220:223], v[76:79], v[24:27]
    ds_read_b128 v[64:67], v89 offset:49408
    v_mfma_f32_16x16x32_bf16 v[28:31], v[216:219], v[80:83], v[28:31]
    buffer_load_dwordx4 v87, s[36:39], s68 offen offset:3072 lds
    s_add_u32 s68, s68, 0x10000
    v_mfma_f32_16x16x32_bf16 v[32:35], v[220:223], v[80:83], v[32:35]
    s_waitcnt lgkmcnt(2)
    v_mfma_f32_16x16x32_bf16 v[20:23], v[224:227], v[52:55], v[20:23]
    ds_read_b128 v[68:71], v90 offset:33024
    v_mfma_f32_16x16x32_bf16 v[24:27], v[228:231], v[52:55], v[24:27]
    ds_read_b128 v[72:75], v90 offset:49408
    v_mfma_f32_16x16x32_bf16 v[28:31], v[224:227], v[56:59], v[28:31]
    v_mfma_f32_16x16x32_bf16 v[32:35], v[228:231], v[56:59], v[32:35]
    s_waitcnt lgkmcnt(2)
    v_mfma_f32_16x16x32_bf16 v[20:23], v[232:235], v[60:63], v[20:23]
    ds_read_b128 v[76:79], v91 offset:33024
    v_mfma_f32_16x16x32_bf16 v[24:27], v[236:239], v[60:63], v[24:27]
    ds_read_b128 v[80:83], v91 offset:49408
    v_mfma_f32_16x16x32_bf16 v[28:31], v[232:235], v[64:67], v[28:31]
    v_mfma_f32_16x16x32_bf16 v[32:35], v[236:239], v[64:67], v[32:35]
    s_bitcmp1_b64 s[6:7], s82
    s_cbranch_scc1 ssig_55
    s_waitcnt vmcnt(8) lgkmcnt(0)
    s_barrier
sretf_56:
    s_add_u32 s82, s82, 1
    v_mfma_f32_16x16x32_bf16 v[20:23], v[240:243], v[68:71], v[20:23]
    ds_read_b128 v[52:55], v92 offset:0
    v_mfma_f32_16x16x32_bf16 v[24:27], v[244:247], v[68:71], v[24:27]
    ds_read_b128 v[56:59], v92 offset:16384
    v_mfma_f32_16x16x32_bf16 v[28:31], v[240:243], v[72:75], v[28:31]
    v_mfma_f32_16x16x32_bf16 v[32:35], v[244:247], v[72:75], v[32:35]
    v_mfma_f32_16x16x32_bf16 v[20:23], v[248:251], v[76:79], v[20:23]
    ds_read_b128 v[60:63], v93 offset:0
    v_mfma_f32_16x16x32_bf16 v[24:27], v[252:255], v[76:79], v[24:27]
    ds_read_b128 v[64:67], v93 offset:16384
    v_mfma_f32_16x16x32_bf16 v[28:31], v[248:251], v[80:83], v[28:31]
    v_mfma_f32_16x16x32_bf16 v[32:35], v[252:255], v[80:83], v[32:35]
    s_waitcnt lgkmcnt(2)
    v_mfma_f32_16x16x32_bf16 v[36:39], v[128:131], v[52:55], 0
    ds_read_b128 v[68:71], v94 offset:0
    v_mfma_f32_16x16x32_bf16 v[40:43], v[132:135], v[52:55], 0
    ds_read_b128 v[72:75], v94 offset:16384
    v_mfma_f32_16x16x32_bf16 v[44:47], v[128:131], v[56:59], 0
    s_add_u32 m0, s70, 32768
    s_nop 0
    buffer_load_dwordx4 v84, s[36:39], s69 offen offset:0 lds
    v_mfma_f32_16x16x32_bf16 v[48:51], v[132:135], v[56:59], 0
    s_waitcnt lgkmcnt(2)
    v_mfma_f32_16x16x32_bf16 v[36:39], v[136:139], v[60:63], v[36:39]
    ds_read_b128 v[76:79], v95 offset:0
    v_mfma_f32_16x16x32_bf16 v[40:43], v[140:143], v[60:63], v[40:43]
    ds_read_b128 v[80:83], v95 offset:16384
    v_mfma_f32_16x16x32_bf16 v[44:47], v[136:139], v[64:67], v[44:47]
    buffer_load_dwordx4 v85, s[36:39], s69 offen offset:1024 lds
    v_mfma_f32_16x16x32_bf16 v[48:51], v[140:143], v[64:67], v[48:51]
    ds_write_b128 v96, v[28:31] offset:0
    s_waitcnt lgkmcnt(3)
    v_mfma_f32_16x16x32_bf16 v[36:39], v[144:147], v[68:71], v[36:39]
    ds_read_b128 v[52:55], v92 offset:256
    v_mfma_f32_16x16x32_bf16 v[40:43], v[148:151], v[68:71], v[40:43]
    ds_read_b128 v[56:59], v92 offset:16640
    v_mfma_f32_16x16x32_bf16 v[44:47], v[144:147], v[72:75], v[44:47]
    buffer_load_dwordx4 v86, s[36:39], s69 offen offset:2048 lds
    v_mfma_f32_16x16x32_bf16 v[48:51], v[148:151], v[72:75], v[48:51]
    ds_write_b128 v96, v[32:35] offset:1024
    s_waitcnt lgkmcnt(4)
    v_mfma_f32_16x16x32_bf16 v[36:39], v[152:155], v[76:79], v[36:39]
    ds_read_b128 v[60:63], v93 offset:256
    v_mfma_f32_16x16x32_bf16 v[40:43], v[156:159], v[76:79], v[40:43]
    ds_read_b128 v[64:67], v93 offset:16640
    v_mfma_f32_16x16x32_bf16 v[44:47], v[152:155], v[80:83], v[44:47]
    buffer_load_dwordx4 v87, s[36:39], s69 offen offset:3072 lds
    s_add_u32 s69, s69, 0x10000
    v_mfma_f32_16x16x32_bf16 v[48:51], v[156:159], v[80:83], v[48:51]
    s_waitcnt lgkmcnt(3)
    v_mfma_f32_16x16x32_bf16 v[36:39], v[160:163], v[52:55], v[36:39]
    ds_read_b128 v[68:71], v94 offset:256
    v_mfma_f32_16x16x32_bf16 v[40:43], v[164:167], v[52:55], v[40:43]
    ds_read_b128 v[72:75], v94 offset:16640
    v_mfma_f32_16x16x32_bf16 v[44:47], v[160:163], v[56:59], v[44:47]
    v_mfma_f32_16x16x32_bf16 v[48:51], v[164:167], v[56:59], v[48:51]
    s_waitcnt lgkmcnt(2)
    v_mfma_f32_16x16x32_bf16 v[36:39], v[168:171], v[60:63], v[36:39]
    ds_read_b128 v[76:79], v95 offset:256
    v_mfma_f32_16x16x32_bf16 v[40:43], v[172:175], v[60:63], v[40:43]
    ds_read_b128 v[80:83], v95 offset:16640
    v_mfma_f32_16x16x32_bf16 v[44:47], v[168:171], v[64:67], v[44:47]
    v_mfma_f32_16x16x32_bf16 v[48:51], v[172:175], v[64:67], v[48:51]
    s_waitcnt vmcnt(8) lgkmcnt(0)
    s_barrier
    v_mfma_f32_16x16x32_bf16 v[36:39], v[176:179], v[68:71], v[36:39]
    ds_read_b128 v[4:7], v97 offset:0
    ds_read_b128 v[8:11], v97 offset:1024
    ds_read_b128 v[52:55], v92 offset:32768
    v_mfma_f32_16x16x32_bf16 v[40:43], v[180:183], v[68:71], v[40:43]
    ds_read_b128 v[56:59], v92 offset:49152
    v_mfma_f32_16x16x32_bf16 v[44:47], v[176:179], v[72:75], v[44:47]
    v_mfma_f32_16x16x32_bf16 v[48:51], v[180:183], v[72:75], v[48:51]
    s_waitcnt lgkmcnt(2)
    v_mfma_f32_16x16x32_bf16 v[36:39], v[184:187], v[76:79], v[36:39]
    v_add_f32 v4, v4, v20
    v_add_f32 v5, v5, v21
    v_add_f32 v6, v6, v22
    v_add_f32 v7, v7, v23
    ds_read_b128 v[60:63], v93 offset:32768
    v_mfma_f32_16x16x32_bf16 v[40:43], v[188:191], v[76:79], v[40:43]
    v_cvt_pk_bf16_f32 v12, v4, v5
    v_cvt_pk_bf16_f32 v13, v6, v7
    ds_read_b128 v[64:67], v93 offset:49152
    v_mfma_f32_16x16x32_bf16 v[44:47], v[184:187], v[80:83], v[44:47]
    v_add_f32 v8, v8, v24
    v_add_f32 v9, v9, v25
    v_add_f32 v10, v10, v26
    v_add_f32 v11, v11, v27
    v_mfma_f32_16x16x32_bf16 v[48:51], v[188:191], v[80:83], v[48:51]
    v_cvt_pk_bf16_f32 v14, v8, v9
    v_cvt_pk_bf16_f32 v15, v10, v11
    buffer_store_dwordx4 v[12:15], v98, s[8:11], s73 offen sc1
    s_mov_b32 s73, s81
    s_add_u32 s81, s81, 0x40000
    s_waitcnt lgkmcnt(2)
    v_mfma_f32_16x16x32_bf16 v[36:39], v[192:195], v[52:55], v[36:39]
    ds_read_b128 v[68:71], v94 offset:32768
    v_mfma_f32_16x16x32_bf16 v[40:43], v[196:199], v[52:55], v[40:43]
    ds_read_b128 v[72:75], v94 offset:49152
    v_mfma_f32_16x16x32_bf16 v[44:47], v[192:195], v[56:59], v[44:47]
    s_add_u32 m0, s70, 65536
    s_nop 0
    buffer_load_dwordx4 v84, s[36:39], s68 offen offset:0 lds
    v_mfma_f32_16x16x32_bf16 v[48:51], v[196:199], v[56:59], v[48:51]
    s_waitcnt lgkmcnt(2)
    v_mfma_f32_16x16x32_bf16 v[36:39], v[200:203], v[60:63], v[36:39]
    ds_read_b128 v[76:79], v95 offset:32768
    v_mfma_f32_16x16x32_bf16 v[40:43], v[204:207], v[60:63], v[40:43]
    ds_read_b128 v[80:83], v95 offset:49152
    v_mfma_f32_16x16x32_bf16 v[44:47], v[200:203], v[64:67], v[44:47]
    buffer_load_dwordx4 v85, s[36:39], s68 offen offset:1024 lds
    v_mfma_f32_16x16x32_bf16 v[48:51], v[204:207], v[64:67], v[48:51]
    s_waitcnt lgkmcnt(2)
    v_mfma_f32_16x16x32_bf16 v[36:39], v[208:211], v[68:71], v[36:39]
    ds_read_b128 v[52:55], v92 offset:33024
    v_mfma_f32_16x16x32_bf16 v[40:43], v[212:215], v[68:71], v[40:43]
    ds_read_b128 v[56:59], v92 offset:49408
    v_mfma_f32_16x16x32_bf16 v[44:47], v[208:211], v[72:75], v[44:47]
    buffer_load_dwordx4 v86, s[36:39], s68 offen offset:2048 lds
    v_mfma_f32_16x16x32_bf16 v[48:51], v[212:215], v[72:75], v[48:51]
    s_waitcnt lgkmcnt(2)
    v_mfma_f32_16x16x32_bf16 v[36:39], v[216:219], v[76:79], v[36:39]
    ds_read_b128 v[60:63], v93 offset:33024
    v_mfma_f32_16x16x32_bf16 v[40:43], v[220:223], v[76:79], v[40:43]
    ds_read_b128 v[64:67], v93 offset:49408
    v_mfma_f32_16x16x32_bf16 v[44:47], v[216:219], v[80:83], v[44:47]
    buffer_load_dwordx4 v87, s[36:39], s68 offen offset:3072 lds
    s_add_u32 s68, s68, 0x10000
    v_mfma_f32_16x16x32_bf16 v[48:51], v[220:223], v[80:83], v[48:51]
    s_waitcnt lgkmcnt(2)
    v_mfma_f32_16x16x32_bf16 v[36:39], v[224:227], v[52:55], v[36:39]
    ds_read_b128 v[68:71], v94 offset:33024
    v_mfma_f32_16x16x32_bf16 v[40:43], v[228:231], v[52:55], v[40:43]
    ds_read_b128 v[72:75], v94 offset:49408
    v_mfma_f32_16x16x32_bf16 v[44:47], v[224:227], v[56:59], v[44:47]
    v_mfma_f32_16x16x32_bf16 v[48:51], v[228:231], v[56:59], v[48:51]
    s_waitcnt lgkmcnt(2)
    v_mfma_f32_16x16x32_bf16 v[36:39], v[232:235], v[60:63], v[36:39]
    ds_read_b128 v[76:79], v95 offset:33024
    v_mfma_f32_16x16x32_bf16 v[40:43], v[236:239], v[60:63], v[40:43]
    ds_read_b128 v[80:83], v95 offset:49408
    v_mfma_f32_16x16x32_bf16 v[44:47], v[232:235], v[64:67], v[44:47]
    v_mfma_f32_16x16x32_bf16 v[48:51], v[236:239], v[64:67], v[48:51]
    s_bitcmp1_b64 s[6:7], s82
    s_cbranch_scc1 ssig_55
    s_waitcnt vmcnt(8) lgkmcnt(0)
    s_barrier
sretf_62:
    s_add_u32 s82, s82, 1
    v_mfma_f32_16x16x32_bf16 v[36:39], v[240:243], v[68:71], v[36:39]
    ds_read_b128 v[52:55], v88 offset:0
    v_mfma_f32_16x16x32_bf16 v[40:43], v[244:247], v[68:71], v[40:43]
    ds_read_b128 v[56:59], v88 offset:16384
    v_mfma_f32_16x16x32_bf16 v[44:47], v[240:243], v[72:75], v[44:47]
    v_mfma_f32_16x16x32_bf16 v[48:51], v[244:247], v[72:75], v[48:51]
    v_mfma_f32_16x16x32_bf16 v[36:39], v[248:251], v[76:79], v[36:39]
    ds_read_b128 v[60:63], v89 offset:0
    v_mfma_f32_16x16x32_bf16 v[40:43], v[252:255], v[76:79], v[40:43]
    ds_read_b128 v[64:67], v89 offset:16384
    v_mfma_f32_16x16x32_bf16 v[44:47], v[248:251], v[80:83], v[44:47]
    v_mfma_f32_16x16x32_bf16 v[48:51], v[252:255], v[80:83], v[48:51]
    s_cmp_lt_u32 s82, 64
    s_cbranch_scc1 stream_65
    s_nop 4
    ds_write_b128 v96, v[44:47] offset:0
    ds_write_b128 v96, v[48:51] offset:1024
    s_waitcnt lgkmcnt(0)
    s_barrier
    ds_read_b128 v[4:7], v97 offset:0
    ds_read_b128 v[8:11], v97 offset:1024
    s_waitcnt lgkmcnt(0)
    v_add_f32 v4, v4, v36
    v_add_f32 v5, v5, v37
    v_add_f32 v6, v6, v38
    v_add_f32 v7, v7, v39
    v_cvt_pk_bf16_f32 v12, v4, v5
    v_cvt_pk_bf16_f32 v13, v6, v7
    v_add_f32 v8, v8, v40
    v_add_f32 v9, v9, v41
    v_add_f32 v10, v10, v42
    v_add_f32 v11, v11, v43
    v_cvt_pk_bf16_f32 v14, v8, v9
    v_cvt_pk_bf16_f32 v15, v10, v11
    buffer_store_dwordx4 v[12:15], v98, s[8:11], s73 offen sc1
    s_mov_b32 s73, s81
    s_add_u32 s81, s81, 0x40000
    s_branch send_58
ssig_55:
    s_waitcnt vmcnt(4) lgkmcnt(0)
    s_barrier
    s_cmp_lg_u32 s58, 0
    s_cbranch_scc1 sig_67
    s_cmp_ge_u32 s57, 16
    s_cbranch_scc1 sig_66
    s_waitcnt vmcnt(4)
    v_and_b32 v4, 0x3ff, v99
    v_cmp_gt_u32 vcc, 128, v4
    s_cbranch_vccz armd_ok_69
armd_68:
    buffer_load_dword v99, off, s[12:15], 0 offset:32 sc1
    s_waitcnt vmcnt(0)
    v_and_b32 v4, 0x3ff, v99
    v_cmp_gt_u32 vcc, 128, v4
    s_cbranch_vccz armd_ok_69
    s_sub_u32 s77, s77, 1
    s_cbranch_scc0 armd_68
    s_mov_b32 s77, 0
armd_ok_69:
    s_bfe_u32 s85, s76, 0x10003
    s_lshl_b32 s85, s85, 2
    s_bfe_u32 s79, s76, 0x30000
    s_lshl_b32 s79, s79, 7
    s_or_b32 s85, s85, s79
    s_bfe_u32 s79, s76, 0x20005
    s_lshl_b32 s79, s79, 10
    s_or_b32 s85, s85, s79
    s_add_u32 s85, s85, 0x5110000
    v_mov_b32 v4, s82
    buffer_store_dword v4, off, s[8:11], s85 sc1
sig_66:
    s_bitcmp0_b32 s82, 1
    s_cbranch_scc1 sig_67
    s_cmp_lt_u32 s82, 6
    s_cbranch_scc1 sig_67
    v_mov_b32 v5, s84
    s_mov_b64 exec, 1
    buffer_atomic_add v5, off, s[12:15], s83 sc1
    s_mov_b64 exec, -1
    s_add_u32 s83, s83, 4
sig_67:
    s_cmp_lt_u32 s57, 24
    s_cbranch_scc1 xtra_70
    s_bfe_u32 s79, s76, 0x30000
    s_lshl_b32 s79, s79, 16
    s_bfe_u32 s85, s76, 0x20005
    s_lshl_b32 s85, s85, 19
    s_or_b32 s79, s79, s85
    s_lshl_b32 s85, s58, 13
    s_add_u32 s85, s85, s79
    v_lshlrev_b32 v6, 7, v1
    buffer_load_dword v16, v6, s[36:39], s85 offen
    buffer_load_dword v17, v6, s[48:51], s85 offen
    buffer_load_dword v18, v6, s[52:55], s85 offen
    s_add_u32 s85, s85, 0x200000
    buffer_load_dword v19, v6, s[36:39], s85 offen
    s_branch xtra_71
xtra_70:
    v_lshlrev_b32 v6, 4, v1
    s_bfe_u32 s80, s76, 0x40000
    s_lshl_b32 s80, s80, 3
    s_bfe_u32 s85, s76, 0x20005
    s_lshl_b32 s85, s85, 7
    s_or_b32 s80, s80, s85
    s_add_u32 s80, s80, s58
    s_cmp_lg_u32 s82, 10
    s_cbranch_scc1 xtra_72
    v_mov_b32 v16, 0
    v_mov_b32 v17, 0
    v_mov_b32 v18, 0
    v_mov_b32 v19, 0
    s_lshl_b32 s85, s80, 6
    s_add_u32 s85, s85, 0x5100000
    v_and_b32 v7, 48, v6
    s_cmp_ge_u32 s57, 16
    s_cselect_b32 s85, 0x5ffffff0, s85
    buffer_store_dwordx4 v[16:19], v7, s[8:11], s85 offen sc1
xtra_72:
    s_bfe_u32 s85, s57, 0x30000
    s_lshl_b32 s85, s85, 2
    s_add_u32 s85, s85, 10
    s_cmp_lg_u32 s82, s85
    s_cbranch_scc1 xtra_71
    v_mov_b32 v8, -1
    v_mov_b32 v9, -1
    v_mov_b32 v10, -1
    v_mov_b32 v11, -1
    s_bfe_u32 s85, s76, 0x20005
    s_lshl_b32 s85, s85, 11
    s_bfe_u32 s79, s76, 0x30000
    s_lshl_b32 s79, s79, 16
    s_or_b32 s85, s85, s79
    s_bfe_u32 s79, s76, 0x20003
    s_lshl_b32 s79, s79, 21
    s_or_b32 s85, s85, s79
    s_lshl_b32 s79, s58, 13
    s_add_u32 s85, s85, s79
    s_add_u32 s85, s85, 0x6000000
    buffer_store_dwordx4 v[8:11], v6, s[8:11], s85 offen offset:0 sc1
    buffer_store_dwordx4 v[8:11], v6, s[8:11], s85 offen offset:1024 sc1
    s_add_u32 s85, s85, 0x80000
    buffer_store_dwordx4 v[8:11], v6, s[8:11], s85 offen offset:0 sc1
    buffer_store_dwordx4 v[8:11], v6, s[8:11], s85 offen offset:1024 sc1
    s_add_u32 s85, s85, 0x80000
    buffer_store_dwordx4 v[8:11], v6, s[8:11], s85 offen offset:0 sc1
    buffer_store_dwordx4 v[8:11], v6, s[8:11], s85 offen offset:1024 sc1
    s_add_u32 s85, s85, 0x80000
    buffer_store_dwordx4 v[8:11], v6, s[8:11], s85 offen offset:0 sc1
    buffer_store_dwordx4 v[8:11], v6, s[8:11], s85 offen offset:1024 sc1
    s_add_u32 s85, s85, 0x80000
    s_cmp_ge_u32 s57, 16
    s_cbranch_scc1 xtra_71
    s_bfe_u32 s85, s80, 0x30003
    s_lshl_b32 s85, s85, 11
    s_bfe_u32 s79, s80, 0x20007
    s_lshl_b32 s79, s79, 14
    s_or_b32 s85, s85, s79
    s_bfe_u32 s79, s80, 0x30000
    s_lshl_b32 s79, s79, 17
    s_or_b32 s85, s85, s79
    s_bfe_u32 s79, s80, 0x10006
    s_lshl_b32 s79, s79, 22
    s_or_b32 s85, s85, s79
    s_add_u32 s85, s85, 0x4300000
    buffer_store_dwordx4 v[8:11], v6, s[8:11], s85 offen offset:0 sc1
    buffer_store_dwordx4 v[8:11], v6, s[8:11], s85 offen offset:1024 sc1
    s_add_u32 s85, s85, 0x10000
    buffer_store_dwordx4 v[8:11], v6, s[8:11], s85 offen offset:0 sc1
    buffer_store_dwordx4 v[8:11], v6, s[8:11], s85 offen offset:1024 sc1
xtra_71:
    s_bitcmp1_b32 s82, 0
    s_cbranch_scc1 xtra_73
    s_bitcmp1_b32 s57, 3
    s_cbranch_scc1 srett_57
    s_branch sretf_56
xtra_73:
    s_bitcmp1_b32 s57, 3
    s_cbranch_scc1 srett_63
    s_branch sretf_62
sv_53:
    s_mov_b32 s81, 0x2000000
    v_bfe_u32 v4, v1, 4, 2
    v_lshlrev_b32 v4, 2, v4
    v_xor_b32 v4, v4, v1
    v_bfe_u32 v84, v4, 0, 2
    v_lshlrev_b32 v84, 4, v84
    v_bfe_u32 v5, v4, 2, 2
    v_lshl_or_b32 v84, v5, 6, v84
    v_bfe_u32 v5, v4, 4, 2
    v_lshl_or_b32 v84, v5, 13, v84
    v_xor_b32 v85, 32, v84
    s_bfe_u32 s68, s58, 0x20000
    s_lshl_b32 s68, s68, 19
    s_bfe_u32 s71, s58, 0x10002
    s_lshl_b32 s71, s71, 22
    s_or_b32 s68, s68, s71
    s_bfe_u32 s71, s57, 0x30000
    s_lshl_b32 s71, s71, 8
    s_bfe_u32 s72, s57, 0x10000
    s_lshl_b32 s72, s72, 21
    s_or_b32 s71, s71, s72
    s_add_u32 s68, s68, s71
    s_lshl_b32 s71, s75, 11
    s_add_u32 s68, s68, s71
    s_xor_b32 s69, s68, 0x200000
    s_lshl_b32 s70, s58, 14
    s_add_u32 m0, s70, 0
    s_nop 0
    buffer_load_dwordx4 v84, s[28:31], s68 offen lds
    s_add_u32 s68, s68, 0x8000
    s_add_u32 m0, s70, 1024
    s_nop 0
    buffer_load_dwordx4 v84, s[28:31], s68 offen lds
    s_add_u32 s68, s68, 0x8000
    s_add_u32 m0, s70, 2048
    s_nop 0
    buffer_load_dwordx4 v85, s[28:31], s68 offen lds
    s_add_u32 s68, s68, 0x8000
    s_add_u32 m0, s70, 3072
    s_nop 0
    buffer_load_dwordx4 v85, s[28:31], s68 offen lds
    s_add_u32 s68, s68, 0x8000
    s_add_u32 m0, s70, 4096
    s_nop 0
    buffer_load_dwordx4 v84, s[28:31], s68 offen lds
    s_add_u32 s68, s68, 0x8000
    s_add_u32 m0, s70, 5120
    s_nop 0
    buffer_load_dwordx4 v84, s[28:31], s68 offen lds
    s_add_u32 s68, s68, 0x8000
    s_add_u32 m0, s70, 6144
    s_nop 0
    buffer_load_dwordx4 v85, s[28:31], s68 offen lds
    s_add_u32 s68, s68, 0x8000
    s_add_u32 m0, s70, 7168
    s_nop 0
    buffer_load_dwordx4 v85, s[28:31], s68 offen lds
    s_add_u32 s68, s68, 0x8000
    s_add_u32 m0, s70, 8192
    s_nop 0
    buffer_load_dwordx4 v84, s[28:31], s68 offen lds
    s_add_u32 s68, s68, 0x8000
    s_add_u32 m0, s70, 9216
    s_nop 0
    buffer_load_dwordx4 v84, s[28:31], s68 offen lds
    s_add_u32 s68, s68, 0x8000
    s_add_u32 m0, s70, 10240
    s_nop 0
    buffer_load_dwordx4 v85, s[28:31], s68 offen lds
    s_add_u32 s68, s68, 0x8000
    s_add_u32 m0, s70, 11264
    s_nop 0
    buffer_load_dwordx4 v85, s[28:31], s68 offen lds
    s_add_u32 s68, s68, 0x8000
    s_add_u32 m0, s70, 12288
    s_nop 0
    buffer_load_dwordx4 v84, s[28:31], s68 offen lds
    s_add_u32 s68, s68, 0x8000
    s_add_u32 m0, s70, 13312
    s_nop 0
    buffer_load_dwordx4 v84, s[28:31], s68 offen lds
    s_add_u32 s68, s68, 0x8000
    s_add_u32 m0, s70, 14336
    s_nop 0
    buffer_load_dwordx4 v85, s[28:31], s68 offen lds
    s_add_u32 s68, s68, 0x8000
    s_add_u32 m0, s70, 15360
    s_nop 0
    buffer_load_dwordx4 v85, s[28:31], s68 offen lds
    s_add_u32 s68, s68, 0x8000
    buffer_load_dwordx4 v[192:195], v84, s[28:31], s69 offen
    s_add_u32 s69, s69, 0x8000
    buffer_load_dwordx4 v[196:199], v84, s[28:31], s69 offen
    s_add_u32 s69, s69, 0x8000
    buffer_load_dwordx4 v[200:203], v85, s[28:31], s69 offen
    s_add_u32 s69, s69, 0x8000
    buffer_load_dwordx4 v[204:207], v85, s[28:31], s69 offen
    s_add_u32 s69, s69, 0x8000
    buffer_load_dwordx4 v[208:211], v84, s[28:31], s69 offen
    s_add_u32 s69, s69, 0x8000
    buffer_load_dwordx4 v[212:215], v84, s[28:31], s69 offen
    s_add_u32 s69, s69, 0x8000
    buffer_load_dwordx4 v[216:219], v85, s[28:31], s69 offen
    s_add_u32 s69, s69, 0x8000
    buffer_load_dwordx4 v[220:223], v85, s[28:31], s69 offen
    s_add_u32 s69, s69, 0x8000
    buffer_load_dwordx4 v[224:227], v84, s[28:31], s69 offen
    s_add_u32 s69, s69, 0x8000
    buffer_load_dwordx4 v[228:231], v84, s[28:31], s69 offen
    s_add_u32 s69, s69, 0x8000
    buffer_load_dwordx4 v[232:235], v85, s[28:31], s69 offen
    s_add_u32 s69, s69, 0x8000
    buffer_load_dwordx4 v[236:239], v85, s[28:31], s69 offen
    s_add_u32 s69, s69, 0x8000
    buffer_load_dwordx4 v[240:243], v84, s[28:31], s69 offen
    s_add_u32 s69, s69, 0x8000
    buffer_load_dwordx4 v[244:247], v84, s[28:31], s69 offen
    s_add_u32 s69, s69, 0x8000
    buffer_load_dwordx4 v[248:251], v85, s[28:31], s69 offen
    s_add_u32 s69, s69, 0x8000
    buffer_load_dwordx4 v[252:255], v85, s[28:31], s69 offen
    s_add_u32 s69, s69, 0x8000
    s_lshl_b32 s71, s57, 3
    s_add_u32 s71, s71, s58
    s_lshl_b32 s71, s71, 13
    s_cmp_lt_u32 s57, 3
    s_cselect_b32 s71, s71, 0x5ffffff0
    v_lshlrev_b32 v4, 7, v1
    buffer_load_dword v99, v4, s[36:39], s71 offen
    v_bfe_u32 v88, v1, 0, 2
    v_lshlrev_b32 v88, 3, v88
    v_bfe_u32 v5, v1, 4, 1
    v_lshl_or_b32 v88, v5, 5, v88
    v_bfe_u32 v5, v1, 2, 2
    v_lshl_or_b32 v88, v5, 6, v88
    v_bfe_u32 v5, v1, 2, 2
    v_lshl_or_b32 v88, v5, 8, v88
    v_bfe_u32 v5, v1, 4, 2
    v_lshl_or_b32 v88, v5, 11, v88
    s_bfe_u32 s71, s58, 0x20000
    s_lshl_b32 s71, s71, 6
    s_bfe_u32 s72, s58, 0x10002
    s_lshl_b32 s72, s72, 16
    s_or_b32 s71, s71, s72
    s_bfe_u32 s72, s58, 0x10002
    s_lshl_b32 s72, s72, 5
    s_or_b32 s71, s71, s72
    v_xor_b32 v88, s71, v88
    v_xor_b32 v89, 32, v88
    v_lshl_add_u32 v96, v1, 4, s70
    s_lshl_b32 s71, s75, 16
    s_add_u32 s81, s81, s71
    s_bfe_u32 s68, s57, 0x10000
    s_lshl_b32 s68, s68, 9
    s_mov_b32 s2, 2048
    s_mov_b32 s3, 65536
    s_mov_b32 s4, 262144
    s_mov_b32 s5, 1
    s_lshl_b32 s71, s58, 2
    s_bfe_u32 s72, s71, 0x30000
    s_bfe_u32 s73, s71, 0x10003
    s_lshl_b32 s73, s73, 4
    s_or_b32 s72, s72, s73
    s_bfe_u32 s73, s71, 0x10004
    s_lshl_b32 s73, s73, 3
    s_or_b32 s72, s72, s73
    s_mul_i32 s72, s72, s2
    v_mov_b32 v4, s72
    s_and_b32 s71, s71, 12
    v_xor_b32 v5, s71, v1
    v_bfe_u32 v84, v5, 0, 5
    v_lshlrev_b32 v84, 4, v84
    v_bfe_u32 v6, v5, 5, 1
    v_lshl_or_b32 v84, v6, 10, v84
    s_sub_u32 s72, s2, 1024
    v_add_u32 v84, v84, v4
    v_xor_b32 v85, 16, v84
    v_add_u32 v85, s72, v85
    v_xor_b32 v86, 48, v85
    v_add_u32 v86, s72, v86
    v_xor_b32 v87, 16, v86
    v_add_u32 v87, s72, v87
    s_xor_b32 s69, s68, 512
    s_lshl_b32 s70, s58, 12
    s_waitcnt vmcnt(17)
    s_barrier
    ds_read_b64_tr_b16 v[128:129], v88 offset:0
    ds_read_b64_tr_b16 v[130:131], v88 offset:1024
    ds_read_b64_tr_b16 v[132:133], v89 offset:0
    ds_read_b64_tr_b16 v[134:135], v89 offset:1024
    ds_read_b64_tr_b16 v[136:137], v88 offset:8192
    ds_read_b64_tr_b16 v[138:139], v88 offset:9216
    ds_read_b64_tr_b16 v[140:141], v89 offset:8192
    ds_read_b64_tr_b16 v[142:143], v89 offset:9216
    s_waitcnt lgkmcnt(4)
    ds_read_b64_tr_b16 v[144:145], v88 offset:16384
    ds_read_b64_tr_b16 v[146:147], v88 offset:17408
    ds_read_b64_tr_b16 v[148:149], v89 offset:16384
    ds_read_b64_tr_b16 v[150:151], v89 offset:17408
    ds_read_b64_tr_b16 v[152:153], v88 offset:24576
    ds_read_b64_tr_b16 v[154:155], v88 offset:25600
    ds_read_b64_tr_b16 v[156:157], v89 offset:24576
    ds_read_b64_tr_b16 v[158:159], v89 offset:25600
    s_waitcnt lgkmcnt(4)
    ds_read_b64_tr_b16 v[160:161], v88 offset:32768
    ds_read_b64_tr_b16 v[162:163], v88 offset:33792
    ds_read_b64_tr_b16 v[164:165], v89 offset:32768
    ds_read_b64_tr_b16 v[166:167], v89 offset:33792
    ds_read_b64_tr_b16 v[168:169], v88 offset:40960
    ds_read_b64_tr_b16 v[170:171], v88 offset:41984
    ds_read_b64_tr_b16 v[172:173], v89 offset:40960
    ds_read_b64_tr_b16 v[174:175], v89 offset:41984
    s_waitcnt lgkmcnt(4)
    ds_read_b64_tr_b16 v[176:177], v88 offset:49152
    ds_read_b64_tr_b16 v[178:179], v88 offset:50176
    ds_read_b64_tr_b16 v[180:181], v89 offset:49152
    ds_read_b64_tr_b16 v[182:183], v89 offset:50176
    ds_read_b64_tr_b16 v[184:185], v88 offset:57344
    ds_read_b64_tr_b16 v[186:187], v88 offset:58368
    ds_read_b64_tr_b16 v[188:189], v89 offset:57344
    ds_read_b64_tr_b16 v[190:191], v89 offset:58368
    s_waitcnt lgkmcnt(0)
    s_barrier
    buffer_load_dwordx4 v[20:23], v84, s[60:63], s68 offen offset:0
    buffer_load_dwordx4 v[24:27], v85, s[60:63], s68 offen offset:1024
    buffer_load_dwordx4 v[28:31], v86, s[60:63], s68 offen offset:2048
    buffer_load_dwordx4 v[32:35], v87, s[60:63], s68 offen offset:3072
    s_add_u32 s68, s68, s3
    buffer_load_dwordx4 v[36:39], v84, s[60:63], s69 offen offset:0
    buffer_load_dwordx4 v[40:43], v85, s[60:63], s69 offen offset:1024
    buffer_load_dwordx4 v[44:47], v86, s[60:63], s69 offen offset:2048
    buffer_load_dwordx4 v[48:51], v87, s[60:63], s69 offen offset:3072
    s_add_u32 s69, s69, s3
    buffer_load_dwordx4 v[52:55], v84, s[60:63], s68 offen offset:0
    buffer_load_dwordx4 v[56:59], v85, s[60:63], s68 offen offset:1024
    buffer_load_dwordx4 v[60:63], v86, s[60:63], s68 offen offset:2048
    buffer_load_dwordx4 v[64:67], v87, s[60:63], s68 offen offset:3072
    s_add_u32 s68, s68, s3
    s_waitcnt vmcnt(28)
    ds_write_b128 v96, v[192:195] offset:0
    s_waitcnt vmcnt(27)
    ds_write_b128 v96, v[196:199] offset:1024
    s_waitcnt vmcnt(26)
    ds_write_b128 v96, v[200:203] offset:2048
    s_waitcnt vmcnt(25)
    ds_write_b128 v96, v[204:207] offset:3072
    s_waitcnt vmcnt(24)
    ds_write_b128 v96, v[208:211] offset:4096
    s_waitcnt vmcnt(23)
    ds_write_b128 v96, v[212:215] offset:5120
    s_waitcnt vmcnt(22)
    ds_write_b128 v96, v[216:219] offset:6144
    s_waitcnt vmcnt(21)
    ds_write_b128 v96, v[220:223] offset:7168
    s_waitcnt vmcnt(20)
    ds_write_b128 v96, v[224:227] offset:8192
    s_waitcnt vmcnt(19)
    ds_write_b128 v96, v[228:231] offset:9216
    s_waitcnt vmcnt(18)
    ds_write_b128 v96, v[232:235] offset:10240
    s_waitcnt vmcnt(17)
    ds_write_b128 v96, v[236:239] offset:11264
    s_waitcnt vmcnt(16)
    ds_write_b128 v96, v[240:243] offset:12288
    s_waitcnt vmcnt(15)
    ds_write_b128 v96, v[244:247] offset:13312
    s_waitcnt vmcnt(14)
    ds_write_b128 v96, v[248:251] offset:14336
    s_waitcnt vmcnt(13)
    ds_write_b128 v96, v[252:255] offset:15360
    s_waitcnt lgkmcnt(0)
    s_barrier
    ds_read_b64_tr_b16 v[192:193], v88 offset:0
    ds_read_b64_tr_b16 v[194:195], v88 offset:1024
    ds_read_b64_tr_b16 v[196:197], v89 offset:0
    ds_read_b64_tr_b16 v[198:199], v89 offset:1024
    ds_read_b64_tr_b16 v[200:201], v88 offset:8192
    ds_read_b64_tr_b16 v[202:203], v88 offset:9216
    ds_read_b64_tr_b16 v[204:205], v89 offset:8192
    ds_read_b64_tr_b16 v[206:207], v89 offset:9216
    s_waitcnt lgkmcnt(4)
    ds_read_b64_tr_b16 v[208:209], v88 offset:16384
    ds_read_b64_tr_b16 v[210:211], v88 offset:17408
    ds_read_b64_tr_b16 v[212:213], v89 offset:16384
    ds_read_b64_tr_b16 v[214:215], v89 offset:17408
    ds_read_b64_tr_b16 v[216:217], v88 offset:24576
    ds_read_b64_tr_b16 v[218:219], v88 offset:25600
    ds_read_b64_tr_b16 v[220:221], v89 offset:24576
    ds_read_b64_tr_b16 v[222:223], v89 offset:25600
    s_waitcnt lgkmcnt(4)
    ds_read_b64_tr_b16 v[224:225], v88 offset:32768
    ds_read_b64_tr_b16 v[226:227], v88 offset:33792
    ds_read_b64_tr_b16 v[228:229], v89 offset:32768
    ds_read_b64_tr_b16 v[230:231], v89 offset:33792
    ds_read_b64_tr_b16 v[232:233], v88 offset:40960
    ds_read_b64_tr_b16 v[234:235], v88 offset:41984
    ds_read_b64_tr_b16 v[236:237], v89 offset:40960
    ds_read_b64_tr_b16 v[238:239], v89 offset:41984
    s_waitcnt lgkmcnt(4)
    ds_read_b64_tr_b16 v[240:241], v88 offset:49152
    ds_read_b64_tr_b16 v[242:243], v88 offset:50176
    ds_read_b64_tr_b16 v[244:245], v89 offset:49152
    ds_read_b64_tr_b16 v[246:247], v89 offset:50176
    ds_read_b64_tr_b16 v[248:249], v88 offset:57344
    ds_read_b64_tr_b16 v[250:251], v88 offset:58368
    ds_read_b64_tr_b16 v[252:253], v89 offset:57344
    ds_read_b64_tr_b16 v[254:255], v89 offset:58368
    s_waitcnt lgkmcnt(0)
    s_barrier
    v_lshl_add_u32 v96, v1, 4, s70
    v_add_u32 v97, 0x10000, v96
    s_waitcnt vmcnt(11)
    ds_write_b128 v96, v[20:23] offset:0
    s_waitcnt vmcnt(10)
    ds_write_b128 v96, v[24:27] offset:1024
    s_waitcnt vmcnt(9)
    ds_write_b128 v96, v[28:31] offset:2048
    s_waitcnt vmcnt(8)
    ds_write_b128 v96, v[32:35] offset:3072
    s_waitcnt vmcnt(7)
    ds_write_b128 v96, v[36:39] offset:32768
    s_waitcnt vmcnt(6)
    ds_write_b128 v96, v[40:43] offset:33792
    s_waitcnt vmcnt(5)
    ds_write_b128 v96, v[44:47] offset:34816
    s_waitcnt vmcnt(4)
    ds_write_b128 v96, v[48:51] offset:35840
    s_waitcnt vmcnt(3)
    ds_write_b128 v97, v[52:55] offset:0
    s_waitcnt vmcnt(2)
    ds_write_b128 v97, v[56:59] offset:1024
    s_waitcnt vmcnt(1)
    ds_write_b128 v97, v[60:63] offset:2048
    s_waitcnt vmcnt(0)
    ds_write_b128 v97, v[64:67] offset:3072
    buffer_load_dword v99, off, s[12:15], s70 offset:32 sc1
    s_branch sgo_74
gen_60:
    s_mov_b32 s2, 131072
    s_mov_b32 s3, 2048
    s_mov_b32 s4, 65536
    s_mov_b32 s5, 7
    s_lshl_b32 s71, s75, 20
    s_add_u32 s81, s81, s71
    s_bfe_u32 s68, s57, 0x10000
    s_lshl_b32 s68, s68, 9
    s_lshl_b32 s71, s75, 15
    s_add_u32 s68, s68, s71
    s_bfe_u32 s71, s57, 0x30000
    s_lshl_b32 s71, s71, 7
    s_bfe_u32 s72, s58, 0x20000
    s_lshl_b32 s72, s72, 5
    s_bfe_u32 s73, s58, 0x10002
    s_lshl_b32 s73, s73, 4
    s_or_b32 s72, s72, s73
    s_or_b32 s71, s71, s72
    v_and_or_b32 v4, v1, 15, s71
    v_mov_b32 v6, 1024
    v_cmp_eq_u32 vcc, 1, v4
    s_nop 1
    v_cndmask_b32 v5, v4, v6, vcc
    v_and_b32 v54, 1, v5
    v_lshrrev_b32 v5, 1, v5
    v_cvt_f32_u32 v54, v54
    v_cvt_f32_u32 v5, v5
    v_mul_f32 v54, 0x3e800000, v54
    v_mul_f32 v52, 0x3a800000, v5
    v_xor_b32 v4, 16, v4
    v_cmp_eq_u32 vcc, 1, v4
    s_nop 1
    v_cndmask_b32 v5, v4, v6, vcc
    v_and_b32 v55, 1, v5
    v_lshrrev_b32 v5, 1, v5
    v_cvt_f32_u32 v55, v55
    v_cvt_f32_u32 v5, v5
    v_mul_f32 v55, 0x3e800000, v55
    v_mul_f32 v53, 0x3a800000, v5
    v_xor_b32 v4, 16, v4
    v_bfe_u32 v4, v1, 4, 2
    v_lshlrev_b32 v4, 3, v4
    s_bfe_u32 s71, s58, 0x10002
    s_lshl_b32 s71, s71, 9
    s_bfe_u32 s72, s57, 0x10000
    s_lshl_b32 s72, s72, 8
    s_or_b32 s71, s71, s72
    v_or_b32 v4, s71, v4
    v_cvt_f32_u32 v56, v4
    v_xor_b32 v4, 0x100, v4
    v_fma_f32 v60, v52, v56, v54
    v_fract_f32 v60, v60
    v_add_f32 v61, v60, v52
    v_add_f32 v62, v61, v52
    v_add_f32 v63, v62, v52
    v_add_f32 v64, v63, v52
    v_add_f32 v65, v64, v52
    v_add_f32 v66, v65, v52
    v_add_f32 v67, v66, v52
    v_cos_f32 v60, v60
    v_cos_f32 v61, v61
    v_cos_f32 v62, v62
    v_cos_f32 v63, v63
    v_cos_f32 v64, v64
    v_cos_f32 v65, v65
    v_cos_f32 v66, v66
    v_cos_f32 v67, v67
    v_cvt_pk_bf16_f32 v128, v60, v61
    v_cvt_pk_bf16_f32 v129, v62, v63
    v_cvt_pk_bf16_f32 v130, v64, v65
    v_cvt_pk_bf16_f32 v131, v66, v67
    v_fma_f32 v68, v53, v56, v55
    v_fract_f32 v68, v68
    v_add_f32 v69, v68, v53
    v_add_f32 v70, v69, v53
    v_add_f32 v71, v70, v53
    v_add_f32 v72, v71, v53
    v_add_f32 v73, v72, v53
    v_add_f32 v74, v73, v53
    v_add_f32 v75, v74, v53
    v_cos_f32 v68, v68
    v_cos_f32 v69, v69
    v_cos_f32 v70, v70
    v_cos_f32 v71, v71
    v_cos_f32 v72, v72
    v_cos_f32 v73, v73
    v_cos_f32 v74, v74
    v_cos_f32 v75, v75
    v_cvt_pk_bf16_f32 v132, v68, v69
    v_cvt_pk_bf16_f32 v133, v70, v71
    v_cvt_pk_bf16_f32 v134, v72, v73
    v_cvt_pk_bf16_f32 v135, v74, v75
    v_add_f32 v56, 0x42000000, v56
    v_fma_f32 v60, v52, v56, v54
    v_fract_f32 v60, v60
    v_add_f32 v61, v60, v52
    v_add_f32 v62, v61, v52
    v_add_f32 v63, v62, v52
    v_add_f32 v64, v63, v52
    v_add_f32 v65, v64, v52
    v_add_f32 v66, v65, v52
    v_add_f32 v67, v66, v52
    v_cos_f32 v60, v60
    v_cos_f32 v61, v61
    v_cos_f32 v62, v62
    v_cos_f32 v63, v63
    v_cos_f32 v64, v64
    v_cos_f32 v65, v65
    v_cos_f32 v66, v66
    v_cos_f32 v67, v67
    v_cvt_pk_bf16_f32 v136, v60, v61
    v_cvt_pk_bf16_f32 v137, v62, v63
    v_cvt_pk_bf16_f32 v138, v64, v65
    v_cvt_pk_bf16_f32 v139, v66, v67
    v_fma_f32 v68, v53, v56, v55
    v_fract_f32 v68, v68
    v_add_f32 v69, v68, v53
    v_add_f32 v70, v69, v53
    v_add_f32 v71, v70, v53
    v_add_f32 v72, v71, v53
    v_add_f32 v73, v72, v53
    v_add_f32 v74, v73, v53
    v_add_f32 v75, v74, v53
    v_cos_f32 v68, v68
    v_cos_f32 v69, v69
    v_cos_f32 v70, v70
    v_cos_f32 v71, v71
    v_cos_f32 v72, v72
    v_cos_f32 v73, v73
    v_cos_f32 v74, v74
    v_cos_f32 v75, v75
    v_cvt_pk_bf16_f32 v140, v68, v69
    v_cvt_pk_bf16_f32 v141, v70, v71
    v_cvt_pk_bf16_f32 v142, v72, v73
    v_cvt_pk_bf16_f32 v143, v74, v75
    v_add_f32 v56, 0x42000000, v56
    v_fma_f32 v60, v52, v56, v54
    v_fract_f32 v60, v60
    v_add_f32 v61, v60, v52
    v_add_f32 v62, v61, v52
    v_add_f32 v63, v62, v52
    v_add_f32 v64, v63, v52
    v_add_f32 v65, v64, v52
    v_add_f32 v66, v65, v52
    v_add_f32 v67, v66, v52
    v_cos_f32 v60, v60
    v_cos_f32 v61, v61
    v_cos_f32 v62, v62
    v_cos_f32 v63, v63
    v_cos_f32 v64, v64
    v_cos_f32 v65, v65
    v_cos_f32 v66, v66
    v_cos_f32 v67, v67
    v_cvt_pk_bf16_f32 v144, v60, v61
    v_cvt_pk_bf16_f32 v145, v62, v63
    v_cvt_pk_bf16_f32 v146, v64, v65
    v_cvt_pk_bf16_f32 v147, v66, v67
    v_fma_f32 v68, v53, v56, v55
    v_fract_f32 v68, v68
    v_add_f32 v69, v68, v53
    v_add_f32 v70, v69, v53
    v_add_f32 v71, v70, v53
    v_add_f32 v72, v71, v53
    v_add_f32 v73, v72, v53
    v_add_f32 v74, v73, v53
    v_add_f32 v75, v74, v53
    v_cos_f32 v68, v68
    v_cos_f32 v69, v69
    v_cos_f32 v70, v70
    v_cos_f32 v71, v71
    v_cos_f32 v72, v72
    v_cos_f32 v73, v73
    v_cos_f32 v74, v74
    v_cos_f32 v75, v75
    v_cvt_pk_bf16_f32 v148, v68, v69
    v_cvt_pk_bf16_f32 v149, v70, v71
    v_cvt_pk_bf16_f32 v150, v72, v73
    v_cvt_pk_bf16_f32 v151, v74, v75
    v_add_f32 v56, 0x42000000, v56
    v_fma_f32 v60, v52, v56, v54
    v_fract_f32 v60, v60
    v_add_f32 v61, v60, v52
    v_add_f32 v62, v61, v52
    v_add_f32 v63, v62, v52
    v_add_f32 v64, v63, v52
    v_add_f32 v65, v64, v52
    v_add_f32 v66, v65, v52
    v_add_f32 v67, v66, v52
    v_cos_f32 v60, v60
    v_cos_f32 v61, v61
    v_cos_f32 v62, v62
    v_cos_f32 v63, v63
    v_cos_f32 v64, v64
    v_cos_f32 v65, v65
    v_cos_f32 v66, v66
    v_cos_f32 v67, v67
    v_cvt_pk_bf16_f32 v152, v60, v61
    v_cvt_pk_bf16_f32 v153, v62, v63
    v_cvt_pk_bf16_f32 v154, v64, v65
    v_cvt_pk_bf16_f32 v155, v66, v67
    v_fma_f32 v68, v53, v56, v55
    v_fract_f32 v68, v68
    v_add_f32 v69, v68, v53
    v_add_f32 v70, v69, v53
    v_add_f32 v71, v70, v53
    v_add_f32 v72, v71, v53
    v_add_f32 v73, v72, v53
    v_add_f32 v74, v73, v53
    v_add_f32 v75, v74, v53
    v_cos_f32 v68, v68
    v_cos_f32 v69, v69
    v_cos_f32 v70, v70
    v_cos_f32 v71, v71
    v_cos_f32 v72, v72
    v_cos_f32 v73, v73
    v_cos_f32 v74, v74
    v_cos_f32 v75, v75
    v_cvt_pk_bf16_f32 v156, v68, v69
    v_cvt_pk_bf16_f32 v157, v70, v71
    v_cvt_pk_bf16_f32 v158, v72, v73
    v_cvt_pk_bf16_f32 v159, v74, v75
    v_add_f32 v56, 0x42000000, v56
    v_fma_f32 v60, v52, v56, v54
    v_fract_f32 v60, v60
    v_add_f32 v61, v60, v52
    v_add_f32 v62, v61, v52
    v_add_f32 v63, v62, v52
    v_add_f32 v64, v63, v52
    v_add_f32 v65, v64, v52
    v_add_f32 v66, v65, v52
    v_add_f32 v67, v66, v52
    v_cos_f32 v60, v60
    v_cos_f32 v61, v61
    v_cos_f32 v62, v62
    v_cos_f32 v63, v63
    v_cos_f32 v64, v64
    v_cos_f32 v65, v65
    v_cos_f32 v66, v66
    v_cos_f32 v67, v67
    v_cvt_pk_bf16_f32 v160, v60, v61
    v_cvt_pk_bf16_f32 v161, v62, v63
    v_cvt_pk_bf16_f32 v162, v64, v65
    v_cvt_pk_bf16_f32 v163, v66, v67
    v_fma_f32 v68, v53, v56, v55
    v_fract_f32 v68, v68
    v_add_f32 v69, v68, v53
    v_add_f32 v70, v69, v53
    v_add_f32 v71, v70, v53
    v_add_f32 v72, v71, v53
    v_add_f32 v73, v72, v53
    v_add_f32 v74, v73, v53
    v_add_f32 v75, v74, v53
    v_cos_f32 v68, v68
    v_cos_f32 v69, v69
    v_cos_f32 v70, v70
    v_cos_f32 v71, v71
    v_cos_f32 v72, v72
    v_cos_f32 v73, v73
    v_cos_f32 v74, v74
    v_cos_f32 v75, v75
    v_cvt_pk_bf16_f32 v164, v68, v69
    v_cvt_pk_bf16_f32 v165, v70, v71
    v_cvt_pk_bf16_f32 v166, v72, v73
    v_cvt_pk_bf16_f32 v167, v74, v75
    v_add_f32 v56, 0x42000000, v56
    v_fma_f32 v60, v52, v56, v54
    v_fract_f32 v60, v60
    v_add_f32 v61, v60, v52
    v_add_f32 v62, v61, v52
    v_add_f32 v63, v62, v52
    v_add_f32 v64, v63, v52
    v_add_f32 v65, v64, v52
    v_add_f32 v66, v65, v52
    v_add_f32 v67, v66, v52
    v_cos_f32 v60, v60
    v_cos_f32 v61, v61
    v_cos_f32 v62, v62
    v_cos_f32 v63, v63
    v_cos_f32 v64, v64
    v_cos_f32 v65, v65
    v_cos_f32 v66, v66
    v_cos_f32 v67, v67
    v_cvt_pk_bf16_f32 v168, v60, v61
    v_cvt_pk_bf16_f32 v169, v62, v63
    v_cvt_pk_bf16_f32 v170, v64, v65
    v_cvt_pk_bf16_f32 v171, v66, v67
    v_fma_f32 v68, v53, v56, v55
    v_fract_f32 v68, v68
    v_add_f32 v69, v68, v53
    v_add_f32 v70, v69, v53
    v_add_f32 v71, v70, v53
    v_add_f32 v72, v71, v53
    v_add_f32 v73, v72, v53
    v_add_f32 v74, v73, v53
    v_add_f32 v75, v74, v53
    v_cos_f32 v68, v68
    v_cos_f32 v69, v69
    v_cos_f32 v70, v70
    v_cos_f32 v71, v71
    v_cos_f32 v72, v72
    v_cos_f32 v73, v73
    v_cos_f32 v74, v74
    v_cos_f32 v75, v75
    v_cvt_pk_bf16_f32 v172, v68, v69
    v_cvt_pk_bf16_f32 v173, v70, v71
    v_cvt_pk_bf16_f32 v174, v72, v73
    v_cvt_pk_bf16_f32 v175, v74, v75
    v_add_f32 v56, 0x42000000, v56
    v_fma_f32 v60, v52, v56, v54
    v_fract_f32 v60, v60
    v_add_f32 v61, v60, v52
    v_add_f32 v62, v61, v52
    v_add_f32 v63, v62, v52
    v_add_f32 v64, v63, v52
    v_add_f32 v65, v64, v52
    v_add_f32 v66, v65, v52
    v_add_f32 v67, v66, v52
    v_cos_f32 v60, v60
    v_cos_f32 v61, v61
    v_cos_f32 v62, v62
    v_cos_f32 v63, v63
    v_cos_f32 v64, v64
    v_cos_f32 v65, v65
    v_cos_f32 v66, v66
    v_cos_f32 v67, v67
    v_cvt_pk_bf16_f32 v176, v60, v61
    v_cvt_pk_bf16_f32 v177, v62, v63
    v_cvt_pk_bf16_f32 v178, v64, v65
    v_cvt_pk_bf16_f32 v179, v66, v67
    v_fma_f32 v68, v53, v56, v55
    v_fract_f32 v68, v68
    v_add_f32 v69, v68, v53
    v_add_f32 v70, v69, v53
    v_add_f32 v71, v70, v53
    v_add_f32 v72, v71, v53
    v_add_f32 v73, v72, v53
    v_add_f32 v74, v73, v53
    v_add_f32 v75, v74, v53
    v_cos_f32 v68, v68
    v_cos_f32 v69, v69
    v_cos_f32 v70, v70
    v_cos_f32 v71, v71
    v_cos_f32 v72, v72
    v_cos_f32 v73, v73
    v_cos_f32 v74, v74
    v_cos_f32 v75, v75
    v_cvt_pk_bf16_f32 v180, v68, v69
    v_cvt_pk_bf16_f32 v181, v70, v71
    v_cvt_pk_bf16_f32 v182, v72, v73
    v_cvt_pk_bf16_f32 v183, v74, v75
    v_add_f32 v56, 0x42000000, v56
    v_fma_f32 v60, v52, v56, v54
    v_fract_f32 v60, v60
    v_add_f32 v61, v60, v52
    v_add_f32 v62, v61, v52
    v_add_f32 v63, v62, v52
    v_add_f32 v64, v63, v52
    v_add_f32 v65, v64, v52
    v_add_f32 v66, v65, v52
    v_add_f32 v67, v66, v52
    v_cos_f32 v60, v60
    v_cos_f32 v61, v61
    v_cos_f32 v62, v62
    v_cos_f32 v63, v63
    v_cos_f32 v64, v64
    v_cos_f32 v65, v65
    v_cos_f32 v66, v66
    v_cos_f32 v67, v67
    v_cvt_pk_bf16_f32 v184, v60, v61
    v_cvt_pk_bf16_f32 v185, v62, v63
    v_cvt_pk_bf16_f32 v186, v64, v65
    v_cvt_pk_bf16_f32 v187, v66, v67
    v_fma_f32 v68, v53, v56, v55
    v_fract_f32 v68, v68
    v_add_f32 v69, v68, v53
    v_add_f32 v70, v69, v53
    v_add_f32 v71, v70, v53
    v_add_f32 v72, v71, v53
    v_add_f32 v73, v72, v53
    v_add_f32 v74, v73, v53
    v_add_f32 v75, v74, v53
    v_cos_f32 v68, v68
    v_cos_f32 v69, v69
    v_cos_f32 v70, v70
    v_cos_f32 v71, v71
    v_cos_f32 v72, v72
    v_cos_f32 v73, v73
    v_cos_f32 v74, v74
    v_cos_f32 v75, v75
    v_cvt_pk_bf16_f32 v188, v68, v69
    v_cvt_pk_bf16_f32 v189, v70, v71
    v_cvt_pk_bf16_f32 v190, v72, v73
    v_cvt_pk_bf16_f32 v191, v74, v75
    v_cvt_f32_u32 v56, v4
    v_xor_b32 v4, 0x100, v4
    v_fma_f32 v60, v52, v56, v54
    v_fract_f32 v60, v60
    v_add_f32 v61, v60, v52
    v_add_f32 v62, v61, v52
    v_add_f32 v63, v62, v52
    v_add_f32 v64, v63, v52
    v_add_f32 v65, v64, v52
    v_add_f32 v66, v65, v52
    v_add_f32 v67, v66, v52
    v_cos_f32 v60, v60
    v_cos_f32 v61, v61
    v_cos_f32 v62, v62
    v_cos_f32 v63, v63
    v_cos_f32 v64, v64
    v_cos_f32 v65, v65
    v_cos_f32 v66, v66
    v_cos_f32 v67, v67
    v_cvt_pk_bf16_f32 v192, v60, v61
    v_cvt_pk_bf16_f32 v193, v62, v63
    v_cvt_pk_bf16_f32 v194, v64, v65
    v_cvt_pk_bf16_f32 v195, v66, v67
    v_fma_f32 v68, v53, v56, v55
    v_fract_f32 v68, v68
    v_add_f32 v69, v68, v53
    v_add_f32 v70, v69, v53
    v_add_f32 v71, v70, v53
    v_add_f32 v72, v71, v53
    v_add_f32 v73, v72, v53
    v_add_f32 v74, v73, v53
    v_add_f32 v75, v74, v53
    v_cos_f32 v68, v68
    v_cos_f32 v69, v69
    v_cos_f32 v70, v70
    v_cos_f32 v71, v71
    v_cos_f32 v72, v72
    v_cos_f32 v73, v73
    v_cos_f32 v74, v74
    v_cos_f32 v75, v75
    v_cvt_pk_bf16_f32 v196, v68, v69
    v_cvt_pk_bf16_f32 v197, v70, v71
    v_cvt_pk_bf16_f32 v198, v72, v73
    v_cvt_pk_bf16_f32 v199, v74, v75
    v_add_f32 v56, 0x42000000, v56
    v_fma_f32 v60, v52, v56, v54
    v_fract_f32 v60, v60
    v_add_f32 v61, v60, v52
    v_add_f32 v62, v61, v52
    v_add_f32 v63, v62, v52
    v_add_f32 v64, v63, v52
    v_add_f32 v65, v64, v52
    v_add_f32 v66, v65, v52
    v_add_f32 v67, v66, v52
    v_cos_f32 v60, v60
    v_cos_f32 v61, v61
    v_cos_f32 v62, v62
    v_cos_f32 v63, v63
    v_cos_f32 v64, v64
    v_cos_f32 v65, v65
    v_cos_f32 v66, v66
    v_cos_f32 v67, v67
    v_cvt_pk_bf16_f32 v200, v60, v61
    v_cvt_pk_bf16_f32 v201, v62, v63
    v_cvt_pk_bf16_f32 v202, v64, v65
    v_cvt_pk_bf16_f32 v203, v66, v67
    v_fma_f32 v68, v53, v56, v55
    v_fract_f32 v68, v68
    v_add_f32 v69, v68, v53
    v_add_f32 v70, v69, v53
    v_add_f32 v71, v70, v53
    v_add_f32 v72, v71, v53
    v_add_f32 v73, v72, v53
    v_add_f32 v74, v73, v53
    v_add_f32 v75, v74, v53
    v_cos_f32 v68, v68
    v_cos_f32 v69, v69
    v_cos_f32 v70, v70
    v_cos_f32 v71, v71
    v_cos_f32 v72, v72
    v_cos_f32 v73, v73
    v_cos_f32 v74, v74
    v_cos_f32 v75, v75
    v_cvt_pk_bf16_f32 v204, v68, v69
    v_cvt_pk_bf16_f32 v205, v70, v71
    v_cvt_pk_bf16_f32 v206, v72, v73
    v_cvt_pk_bf16_f32 v207, v74, v75
    v_add_f32 v56, 0x42000000, v56
    v_fma_f32 v60, v52, v56, v54
    v_fract_f32 v60, v60
    v_add_f32 v61, v60, v52
    v_add_f32 v62, v61, v52
    v_add_f32 v63, v62, v52
    v_add_f32 v64, v63, v52
    v_add_f32 v65, v64, v52
    v_add_f32 v66, v65, v52
    v_add_f32 v67, v66, v52
    v_cos_f32 v60, v60
    v_cos_f32 v61, v61
    v_cos_f32 v62, v62
    v_cos_f32 v63, v63
    v_cos_f32 v64, v64
    v_cos_f32 v65, v65
    v_cos_f32 v66, v66
    v_cos_f32 v67, v67
    v_cvt_pk_bf16_f32 v208, v60, v61
    v_cvt_pk_bf16_f32 v209, v62, v63
    v_cvt_pk_bf16_f32 v210, v64, v65
    v_cvt_pk_bf16_f32 v211, v66, v67
    v_fma_f32 v68, v53, v56, v55
    v_fract_f32 v68, v68
    v_add_f32 v69, v68, v53
    v_add_f32 v70, v69, v53
    v_add_f32 v71, v70, v53
    v_add_f32 v72, v71, v53
    v_add_f32 v73, v72, v53
    v_add_f32 v74, v73, v53
    v_add_f32 v75, v74, v53
    v_cos_f32 v68, v68
    v_cos_f32 v69, v69
    v_cos_f32 v70, v70
    v_cos_f32 v71, v71
    v_cos_f32 v72, v72
    v_cos_f32 v73, v73
    v_cos_f32 v74, v74
    v_cos_f32 v75, v75
    v_cvt_pk_bf16_f32 v212, v68, v69
    v_cvt_pk_bf16_f32 v213, v70, v71
    v_cvt_pk_bf16_f32 v214, v72, v73
    v_cvt_pk_bf16_f32 v215, v74, v75
    v_add_f32 v56, 0x42000000, v56
    v_fma_f32 v60, v52, v56, v54
    v_fract_f32 v60, v60
    v_add_f32 v61, v60, v52
    v_add_f32 v62, v61, v52
    v_add_f32 v63, v62, v52
    v_add_f32 v64, v63, v52
    v_add_f32 v65, v64, v52
    v_add_f32 v66, v65, v52
    v_add_f32 v67, v66, v52
    v_cos_f32 v60, v60
    v_cos_f32 v61, v61
    v_cos_f32 v62, v62
    v_cos_f32 v63, v63
    v_cos_f32 v64, v64
    v_cos_f32 v65, v65
    v_cos_f32 v66, v66
    v_cos_f32 v67, v67
    v_cvt_pk_bf16_f32 v216, v60, v61
    v_cvt_pk_bf16_f32 v217, v62, v63
    v_cvt_pk_bf16_f32 v218, v64, v65
    v_cvt_pk_bf16_f32 v219, v66, v67
    v_fma_f32 v68, v53, v56, v55
    v_fract_f32 v68, v68
    v_add_f32 v69, v68, v53
    v_add_f32 v70, v69, v53
    v_add_f32 v71, v70, v53
    v_add_f32 v72, v71, v53
    v_add_f32 v73, v72, v53
    v_add_f32 v74, v73, v53
    v_add_f32 v75, v74, v53
    v_cos_f32 v68, v68
    v_cos_f32 v69, v69
    v_cos_f32 v70, v70
    v_cos_f32 v71, v71
    v_cos_f32 v72, v72
    v_cos_f32 v73, v73
    v_cos_f32 v74, v74
    v_cos_f32 v75, v75
    v_cvt_pk_bf16_f32 v220, v68, v69
    v_cvt_pk_bf16_f32 v221, v70, v71
    v_cvt_pk_bf16_f32 v222, v72, v73
    v_cvt_pk_bf16_f32 v223, v74, v75
    v_add_f32 v56, 0x42000000, v56
    v_fma_f32 v60, v52, v56, v54
    v_fract_f32 v60, v60
    v_add_f32 v61, v60, v52
    v_add_f32 v62, v61, v52
    v_add_f32 v63, v62, v52
    v_add_f32 v64, v63, v52
    v_add_f32 v65, v64, v52
    v_add_f32 v66, v65, v52
    v_add_f32 v67, v66, v52
    v_cos_f32 v60, v60
    v_cos_f32 v61, v61
    v_cos_f32 v62, v62
    v_cos_f32 v63, v63
    v_cos_f32 v64, v64
    v_cos_f32 v65, v65
    v_cos_f32 v66, v66
    v_cos_f32 v67, v67
    v_cvt_pk_bf16_f32 v224, v60, v61
    v_cvt_pk_bf16_f32 v225, v62, v63
    v_cvt_pk_bf16_f32 v226, v64, v65
    v_cvt_pk_bf16_f32 v227, v66, v67
    v_fma_f32 v68, v53, v56, v55
    v_fract_f32 v68, v68
    v_add_f32 v69, v68, v53
    v_add_f32 v70, v69, v53
    v_add_f32 v71, v70, v53
    v_add_f32 v72, v71, v53
    v_add_f32 v73, v72, v53
    v_add_f32 v74, v73, v53
    v_add_f32 v75, v74, v53
    v_cos_f32 v68, v68
    v_cos_f32 v69, v69
    v_cos_f32 v70, v70
    v_cos_f32 v71, v71
    v_cos_f32 v72, v72
    v_cos_f32 v73, v73
    v_cos_f32 v74, v74
    v_cos_f32 v75, v75
    v_cvt_pk_bf16_f32 v228, v68, v69
    v_cvt_pk_bf16_f32 v229, v70, v71
    v_cvt_pk_bf16_f32 v230, v72, v73
    v_cvt_pk_bf16_f32 v231, v74, v75
    v_add_f32 v56, 0x42000000, v56
    v_fma_f32 v60, v52, v56, v54
    v_fract_f32 v60, v60
    v_add_f32 v61, v60, v52
    v_add_f32 v62, v61, v52
    v_add_f32 v63, v62, v52
    v_add_f32 v64, v63, v52
    v_add_f32 v65, v64, v52
    v_add_f32 v66, v65, v52
    v_add_f32 v67, v66, v52
    v_cos_f32 v60, v60
    v_cos_f32 v61, v61
    v_cos_f32 v62, v62
    v_cos_f32 v63, v63
    v_cos_f32 v64, v64
    v_cos_f32 v65, v65
    v_cos_f32 v66, v66
    v_cos_f32 v67, v67
    v_cvt_pk_bf16_f32 v232, v60, v61
    v_cvt_pk_bf16_f32 v233, v62, v63
    v_cvt_pk_bf16_f32 v234, v64, v65
    v_cvt_pk_bf16_f32 v235, v66, v67
    v_fma_f32 v68, v53, v56, v55
    v_fract_f32 v68, v68
    v_add_f32 v69, v68, v53
    v_add_f32 v70, v69, v53
    v_add_f32 v71, v70, v53
    v_add_f32 v72, v71, v53
    v_add_f32 v73, v72, v53
    v_add_f32 v74, v73, v53
    v_add_f32 v75, v74, v53
    v_cos_f32 v68, v68
    v_cos_f32 v69, v69
    v_cos_f32 v70, v70
    v_cos_f32 v71, v71
    v_cos_f32 v72, v72
    v_cos_f32 v73, v73
    v_cos_f32 v74, v74
    v_cos_f32 v75, v75
    v_cvt_pk_bf16_f32 v236, v68, v69
    v_cvt_pk_bf16_f32 v237, v70, v71
    v_cvt_pk_bf16_f32 v238, v72, v73
    v_cvt_pk_bf16_f32 v239, v74, v75
    v_add_f32 v56, 0x42000000, v56
    v_fma_f32 v60, v52, v56, v54
    v_fract_f32 v60, v60
    v_add_f32 v61, v60, v52
    v_add_f32 v62, v61, v52
    v_add_f32 v63, v62, v52
    v_add_f32 v64, v63, v52
    v_add_f32 v65, v64, v52
    v_add_f32 v66, v65, v52
    v_add_f32 v67, v66, v52
    v_cos_f32 v60, v60
    v_cos_f32 v61, v61
    v_cos_f32 v62, v62
    v_cos_f32 v63, v63
    v_cos_f32 v64, v64
    v_cos_f32 v65, v65
    v_cos_f32 v66, v66
    v_cos_f32 v67, v67
    v_cvt_pk_bf16_f32 v240, v60, v61
    v_cvt_pk_bf16_f32 v241, v62, v63
    v_cvt_pk_bf16_f32 v242, v64, v65
    v_cvt_pk_bf16_f32 v243, v66, v67
    v_fma_f32 v68, v53, v56, v55
    v_fract_f32 v68, v68
    v_add_f32 v69, v68, v53
    v_add_f32 v70, v69, v53
    v_add_f32 v71, v70, v53
    v_add_f32 v72, v71, v53
    v_add_f32 v73, v72, v53
    v_add_f32 v74, v73, v53
    v_add_f32 v75, v74, v53
    v_cos_f32 v68, v68
    v_cos_f32 v69, v69
    v_cos_f32 v70, v70
    v_cos_f32 v71, v71
    v_cos_f32 v72, v72
    v_cos_f32 v73, v73
    v_cos_f32 v74, v74
    v_cos_f32 v75, v75
    v_cvt_pk_bf16_f32 v244, v68, v69
    v_cvt_pk_bf16_f32 v245, v70, v71
    v_cvt_pk_bf16_f32 v246, v72, v73
    v_cvt_pk_bf16_f32 v247, v74, v75
    v_add_f32 v56, 0x42000000, v56
    v_fma_f32 v60, v52, v56, v54
    v_fract_f32 v60, v60
    v_add_f32 v61, v60, v52
    v_add_f32 v62, v61, v52
    v_add_f32 v63, v62, v52
    v_add_f32 v64, v63, v52
    v_add_f32 v65, v64, v52
    v_add_f32 v66, v65, v52
    v_add_f32 v67, v66, v52
    v_cos_f32 v60, v60
    v_cos_f32 v61, v61
    v_cos_f32 v62, v62
    v_cos_f32 v63, v63
    v_cos_f32 v64, v64
    v_cos_f32 v65, v65
    v_cos_f32 v66, v66
    v_cos_f32 v67, v67
    v_cvt_pk_bf16_f32 v248, v60, v61
    v_cvt_pk_bf16_f32 v249, v62, v63
    v_cvt_pk_bf16_f32 v250, v64, v65
    v_cvt_pk_bf16_f32 v251, v66, v67
    v_fma_f32 v68, v53, v56, v55
    v_fract_f32 v68, v68
    v_add_f32 v69, v68, v53
    v_add_f32 v70, v69, v53
    v_add_f32 v71, v70, v53
    v_add_f32 v72, v71, v53
    v_add_f32 v73, v72, v53
    v_add_f32 v74, v73, v53
    v_add_f32 v75, v74, v53
    v_cos_f32 v68, v68
    v_cos_f32 v69, v69
    v_cos_f32 v70, v70
    v_cos_f32 v71, v71
    v_cos_f32 v72, v72
    v_cos_f32 v73, v73
    v_cos_f32 v74, v74
    v_cos_f32 v75, v75
    v_cvt_pk_bf16_f32 v252, v68, v69
    v_cvt_pk_bf16_f32 v253, v70, v71
    v_cvt_pk_bf16_f32 v254, v72, v73
    v_cvt_pk_bf16_f32 v255, v74, v75
    s_lshl_b32 s71, s58, 2
    s_bfe_u32 s72, s71, 0x30000
    s_bfe_u32 s73, s71, 0x10003
    s_lshl_b32 s73, s73, 4
    s_or_b32 s72, s72, s73
    s_bfe_u32 s73, s71, 0x10004
    s_lshl_b32 s73, s73, 3
    s_or_b32 s72, s72, s73
    s_mul_i32 s72, s72, s2
    v_mov_b32 v4, s72
    s_and_b32 s71, s71, 12
    v_xor_b32 v5, s71, v1
    v_bfe_u32 v84, v5, 0, 5
    v_lshlrev_b32 v84, 4, v84
    v_bfe_u32 v6, v5, 5, 1
    v_lshl_or_b32 v84, v6, 10, v84
    s_sub_u32 s72, s2, 1024
    v_add_u32 v84, v84, v4
    v_xor_b32 v85, 16, v84
    v_add_u32 v85, s72, v85
    v_xor_b32 v86, 48, v85
    v_add_u32 v86, s72, v86
    v_xor_b32 v87, 16, v86
    v_add_u32 v87, s72, v87
    s_xor_b32 s69, s68, 512
    s_lshl_b32 s70, s58, 12
    s_add_u32 m0, s70, 0
    s_nop 0
    buffer_load_dwordx4 v84, s[60:63], s68 offen offset:0 lds
    buffer_load_dwordx4 v85, s[60:63], s68 offen offset:1024 lds
    buffer_load_dwordx4 v86, s[60:63], s68 offen offset:2048 lds
    buffer_load_dwordx4 v87, s[60:63], s68 offen offset:3072 lds
    s_add_u32 s68, s68, s3
    s_add_u32 m0, s70, 32768
    s_nop 0
    buffer_load_dwordx4 v84, s[60:63], s69 offen offset:0 lds
    buffer_load_dwordx4 v85, s[60:63], s69 offen offset:1024 lds
    buffer_load_dwordx4 v86, s[60:63], s69 offen offset:2048 lds
    buffer_load_dwordx4 v87, s[60:63], s69 offen offset:3072 lds
    s_add_u32 s69, s69, s3
    s_add_u32 m0, s70, 65536
    s_nop 0
    buffer_load_dwordx4 v84, s[60:63], s68 offen offset:0 lds
    buffer_load_dwordx4 v85, s[60:63], s68 offen offset:1024 lds
    buffer_load_dwordx4 v86, s[60:63], s68 offen offset:2048 lds
    buffer_load_dwordx4 v87, s[60:63], s68 offen offset:3072 lds
    s_add_u32 s68, s68, s3
sgo_74:
    v_lshrrev_b32 v4, 4, v1
    v_xor_b32 v4, v4, v1
    v_bfe_u32 v5, v4, 0, 4
    v_lshlrev_b32 v5, 4, v5
    v_bfe_u32 v4, v1, 0, 4
    v_lshlrev_b32 v4, 10, v4
    s_bfe_u32 s71, s58, 0x10002
    s_lshl_b32 s71, s71, 9
    v_or3_b32 v88, v4, v5, s71
    v_xor_b32 v89, 0x40, v88
    v_xor_b32 v90, 0x80, v88
    v_xor_b32 v91, 0xc0, v88
    v_xor_b32 v92, 0x10000, v88
    v_xor_b32 v93, 0x10040, v88
    v_xor_b32 v94, 0x10080, v88
    v_xor_b32 v95, 0x100c0, v88
    s_lshl_b32 s71, s58, 11
    s_or_b32 s71, s71, 131072
    v_lshl_add_u32 v96, v1, 4, s71
    v_xor_b32 v97, 0x2000, v96
    v_bfe_u32 v98, v1, 0, 4
    v_lshlrev_b32 v98, 4, v98
    v_bfe_u32 v4, v1, 4, 2
    v_lshl_or_b32 v98, v4, 9, v98
    s_bfe_u32 s71, s57, 0x30000
    s_lshl_b32 s71, s71, 13
    s_add_u32 s81, s81, s71
    s_bfe_u32 s71, s58, 0x20000
    s_lshl_b32 s71, s71, 11
    s_bfe_u32 s72, s58, 0x10002
    s_lshl_b32 s72, s72, 8
    s_or_b32 s71, s71, s72
    s_add_u32 s81, s81, s71
    s_mov_b32 s73, 0x5ffffff0
    s_mov_b32 s82, 0
    s_waitcnt vmcnt(8) lgkmcnt(0)
    s_barrier
    ds_read_b128 v[52:55], v88 offset:0
    ds_read_b128 v[56:59], v88 offset:16384
    ds_read_b128 v[60:63], v89 offset:0
    ds_read_b128 v[64:67], v89 offset:16384
    v_mov_b32 v100, 3
    v_cmp_gt_u32 vcc, s58, v100
stream_75:
    s_waitcnt lgkmcnt(2)
    v_mfma_f32_16x16x32_bf16 v[20:23], v[52:55], v[128:131], 0
    ds_read_b128 v[68:71], v90 offset:0
    v_mfma_f32_16x16x32_bf16 v[24:27], v[52:55], v[132:135], 0
    ds_read_b128 v[72:75], v90 offset:16384
    v_mfma_f32_16x16x32_bf16 v[28:31], v[56:59], v[128:131], 0
    s_add_u32 m0, s70, 98304
    s_nop 0
    buffer_load_dwordx4 v84, s[60:63], s69 offen offset:0 lds
    v_mfma_f32_16x16x32_bf16 v[32:35], v[56:59], v[132:135], 0
    s_waitcnt lgkmcnt(2)
    v_mfma_f32_16x16x32_bf16 v[20:23], v[60:63], v[136:139], v[20:23]
    ds_read_b128 v[76:79], v91 offset:0
    v_mfma_f32_16x16x32_bf16 v[24:27], v[60:63], v[140:143], v[24:27]
    ds_read_b128 v[80:83], v91 offset:16384
    v_mfma_f32_16x16x32_bf16 v[28:31], v[64:67], v[136:139], v[28:31]
    buffer_load_dwordx4 v85, s[60:63], s69 offen offset:1024 lds
    v_mfma_f32_16x16x32_bf16 v[32:35], v[64:67], v[140:143], v[32:35]
    ds_write_b128 v96, v[40:43] offset:0
    s_waitcnt lgkmcnt(3)
    v_mfma_f32_16x16x32_bf16 v[20:23], v[68:71], v[144:147], v[20:23]
    ds_read_b128 v[52:55], v88 offset:256
    v_mfma_f32_16x16x32_bf16 v[24:27], v[68:71], v[148:151], v[24:27]
    ds_read_b128 v[56:59], v88 offset:16640
    v_mfma_f32_16x16x32_bf16 v[28:31], v[72:75], v[144:147], v[28:31]
    buffer_load_dwordx4 v86, s[60:63], s69 offen offset:2048 lds
    v_mfma_f32_16x16x32_bf16 v[32:35], v[72:75], v[148:151], v[32:35]
    ds_write_b128 v96, v[48:51] offset:1024
    s_waitcnt lgkmcnt(4)
    v_mfma_f32_16x16x32_bf16 v[20:23], v[76:79], v[152:155], v[20:23]
    ds_read_b128 v[60:63], v89 offset:256
    v_mfma_f32_16x16x32_bf16 v[24:27], v[76:79], v[156:159], v[24:27]
    ds_read_b128 v[64:67], v89 offset:16640
    v_mfma_f32_16x16x32_bf16 v[28:31], v[80:83], v[152:155], v[28:31]
    buffer_load_dwordx4 v87, s[60:63], s69 offen offset:3072 lds
    s_add_u32 s69, s69, s3
    v_mfma_f32_16x16x32_bf16 v[32:35], v[80:83], v[156:159], v[32:35]
    s_waitcnt lgkmcnt(3)
    v_mfma_f32_16x16x32_bf16 v[20:23], v[52:55], v[160:163], v[20:23]
    ds_read_b128 v[68:71], v90 offset:256
    v_mfma_f32_16x16x32_bf16 v[24:27], v[52:55], v[164:167], v[24:27]
    ds_read_b128 v[72:75], v90 offset:16640
    v_mfma_f32_16x16x32_bf16 v[28:31], v[56:59], v[160:163], v[28:31]
    v_mfma_f32_16x16x32_bf16 v[32:35], v[56:59], v[164:167], v[32:35]
    s_waitcnt lgkmcnt(2)
    v_mfma_f32_16x16x32_bf16 v[20:23], v[60:63], v[168:171], v[20:23]
    ds_read_b128 v[76:79], v91 offset:256
    v_mfma_f32_16x16x32_bf16 v[24:27], v[60:63], v[172:175], v[24:27]
    ds_read_b128 v[80:83], v91 offset:16640
    v_mfma_f32_16x16x32_bf16 v[28:31], v[64:67], v[168:171], v[28:31]
    v_mfma_f32_16x16x32_bf16 v[32:35], v[64:67], v[172:175], v[32:35]
    s_waitcnt vmcnt(8) lgkmcnt(0)
    s_barrier
    v_mfma_f32_16x16x32_bf16 v[20:23], v[68:71], v[176:179], v[20:23]
    ds_read_b128 v[4:7], v97 offset:0
    ds_read_b128 v[8:11], v97 offset:1024
    ds_read_b128 v[52:55], v88 offset:32768
    v_mfma_f32_16x16x32_bf16 v[24:27], v[68:71], v[180:183], v[24:27]
    ds_read_b128 v[56:59], v88 offset:49152
    v_mfma_f32_16x16x32_bf16 v[28:31], v[72:75], v[176:179], v[28:31]
    v_mfma_f32_16x16x32_bf16 v[32:35], v[72:75], v[180:183], v[32:35]
    s_waitcnt lgkmcnt(2)
    v_mfma_f32_16x16x32_bf16 v[20:23], v[76:79], v[184:187], v[20:23]
    v_add_f32 v4, v4, v36
    v_add_f32 v5, v5, v37
    v_add_f32 v6, v6, v38
    v_add_f32 v7, v7, v39
    ds_read_b128 v[60:63], v89 offset:32768
    v_mfma_f32_16x16x32_bf16 v[24:27], v[76:79], v[188:191], v[24:27]
    v_cvt_pk_bf16_f32 v12, v4, v5
    v_cvt_pk_bf16_f32 v13, v6, v7
    ds_read_b128 v[64:67], v89 offset:49152
    v_mfma_f32_16x16x32_bf16 v[28:31], v[80:83], v[184:187], v[28:31]
    v_add_f32 v8, v8, v44
    v_add_f32 v9, v9, v45
    v_add_f32 v10, v10, v46
    v_add_f32 v11, v11, v47
    v_mfma_f32_16x16x32_bf16 v[32:35], v[80:83], v[188:191], v[32:35]
    v_cvt_pk_bf16_f32 v14, v8, v9
    v_cvt_pk_bf16_f32 v15, v10, v11
    buffer_store_dwordx4 v[12:15], v98, s[8:11], s73 offen sc1
    s_mov_b32 s73, s81
    s_add_u32 s81, s81, s4
    s_waitcnt lgkmcnt(2)
    v_mfma_f32_16x16x32_bf16 v[20:23], v[52:55], v[192:195], v[20:23]
    ds_read_b128 v[68:71], v90 offset:32768
    v_mfma_f32_16x16x32_bf16 v[24:27], v[52:55], v[196:199], v[24:27]
    ds_read_b128 v[72:75], v90 offset:49152
    v_mfma_f32_16x16x32_bf16 v[28:31], v[56:59], v[192:195], v[28:31]
    s_add_u32 m0, s70, 0
    s_nop 0
    buffer_load_dwordx4 v84, s[60:63], s68 offen offset:0 lds
    v_mfma_f32_16x16x32_bf16 v[32:35], v[56:59], v[196:199], v[32:35]
    s_waitcnt lgkmcnt(2)
    v_mfma_f32_16x16x32_bf16 v[20:23], v[60:63], v[200:203], v[20:23]
    ds_read_b128 v[76:79], v91 offset:32768
    v_mfma_f32_16x16x32_bf16 v[24:27], v[60:63], v[204:207], v[24:27]
    ds_read_b128 v[80:83], v91 offset:49152
    v_mfma_f32_16x16x32_bf16 v[28:31], v[64:67], v[200:203], v[28:31]
    buffer_load_dwordx4 v85, s[60:63], s68 offen offset:1024 lds
    v_mfma_f32_16x16x32_bf16 v[32:35], v[64:67], v[204:207], v[32:35]
    s_waitcnt lgkmcnt(2)
    v_mfma_f32_16x16x32_bf16 v[20:23], v[68:71], v[208:211], v[20:23]
    ds_read_b128 v[52:55], v88 offset:33024
    v_mfma_f32_16x16x32_bf16 v[24:27], v[68:71], v[212:215], v[24:27]
    ds_read_b128 v[56:59], v88 offset:49408
    v_mfma_f32_16x16x32_bf16 v[28:31], v[72:75], v[208:211], v[28:31]
    buffer_load_dwordx4 v86, s[60:63], s68 offen offset:2048 lds
    v_mfma_f32_16x16x32_bf16 v[32:35], v[72:75], v[212:215], v[32:35]
    s_waitcnt lgkmcnt(2)
    v_mfma_f32_16x16x32_bf16 v[20:23], v[76:79], v[216:219], v[20:23]
    ds_read_b128 v[60:63], v89 offset:33024
    v_mfma_f32_16x16x32_bf16 v[24:27], v[76:79], v[220:223], v[24:27]
    ds_read_b128 v[64:67], v89 offset:49408
    v_mfma_f32_16x16x32_bf16 v[28:31], v[80:83], v[216:219], v[28:31]
    buffer_load_dwordx4 v87, s[60:63], s68 offen offset:3072 lds
    s_add_u32 s68, s68, s3
    v_mfma_f32_16x16x32_bf16 v[32:35], v[80:83], v[220:223], v[32:35]
    s_waitcnt lgkmcnt(2)
    v_mfma_f32_16x16x32_bf16 v[20:23], v[52:55], v[224:227], v[20:23]
    ds_read_b128 v[68:71], v90 offset:33024
    v_mfma_f32_16x16x32_bf16 v[24:27], v[52:55], v[228:231], v[24:27]
    ds_read_b128 v[72:75], v90 offset:49408
    v_mfma_f32_16x16x32_bf16 v[28:31], v[56:59], v[224:227], v[28:31]
    v_mfma_f32_16x16x32_bf16 v[32:35], v[56:59], v[228:231], v[32:35]
    s_waitcnt lgkmcnt(2)
    v_mfma_f32_16x16x32_bf16 v[20:23], v[60:63], v[232:235], v[20:23]
    ds_read_b128 v[76:79], v91 offset:33024
    v_mfma_f32_16x16x32_bf16 v[24:27], v[60:63], v[236:239], v[24:27]
    ds_read_b128 v[80:83], v91 offset:49408
    v_mfma_f32_16x16x32_bf16 v[28:31], v[64:67], v[232:235], v[28:31]
    v_mfma_f32_16x16x32_bf16 v[32:35], v[64:67], v[236:239], v[32:35]
    s_bitcmp1_b64 s[6:7], s82
    s_cbranch_scc1 ssig_55
    s_waitcnt vmcnt(8) lgkmcnt(0)
    s_barrier
srett_57:
    s_add_u32 s82, s82, 1
    v_mfma_f32_16x16x32_bf16 v[20:23], v[68:71], v[240:243], v[20:23]
    ds_read_b128 v[52:55], v92 offset:0
    v_mfma_f32_16x16x32_bf16 v[24:27], v[68:71], v[244:247], v[24:27]
    ds_read_b128 v[56:59], v92 offset:16384
    v_mfma_f32_16x16x32_bf16 v[28:31], v[72:75], v[240:243], v[28:31]
    v_mfma_f32_16x16x32_bf16 v[32:35], v[72:75], v[244:247], v[32:35]
    v_mfma_f32_16x16x32_bf16 v[20:23], v[76:79], v[248:251], v[20:23]
    ds_read_b128 v[60:63], v93 offset:0
    v_mfma_f32_16x16x32_bf16 v[24:27], v[76:79], v[252:255], v[24:27]
    ds_read_b128 v[64:67], v93 offset:16384
    v_mfma_f32_16x16x32_bf16 v[28:31], v[80:83], v[248:251], v[28:31]
    v_mfma_f32_16x16x32_bf16 v[32:35], v[80:83], v[252:255], v[32:35]
    s_waitcnt lgkmcnt(2)
    v_mfma_f32_16x16x32_bf16 v[36:39], v[52:55], v[128:131], 0
    ds_read_b128 v[68:71], v94 offset:0
    v_mfma_f32_16x16x32_bf16 v[40:43], v[52:55], v[132:135], 0
    ds_read_b128 v[72:75], v94 offset:16384
    v_mfma_f32_16x16x32_bf16 v[44:47], v[56:59], v[128:131], 0
    s_add_u32 m0, s70, 32768
    s_nop 0
    buffer_load_dwordx4 v84, s[60:63], s69 offen offset:0 lds
    v_mfma_f32_16x16x32_bf16 v[48:51], v[56:59], v[132:135], 0
    s_waitcnt lgkmcnt(2)
    v_mfma_f32_16x16x32_bf16 v[36:39], v[60:63], v[136:139], v[36:39]
    ds_read_b128 v[76:79], v95 offset:0
    v_mfma_f32_16x16x32_bf16 v[40:43], v[60:63], v[140:143], v[40:43]
    ds_read_b128 v[80:83], v95 offset:16384
    v_mfma_f32_16x16x32_bf16 v[44:47], v[64:67], v[136:139], v[44:47]
    buffer_load_dwordx4 v85, s[60:63], s69 offen offset:1024 lds
    v_mfma_f32_16x16x32_bf16 v[48:51], v[64:67], v[140:143], v[48:51]
    ds_write_b128 v96, v[24:27] offset:0
    s_waitcnt lgkmcnt(3)
    v_mfma_f32_16x16x32_bf16 v[36:39], v[68:71], v[144:147], v[36:39]
    ds_read_b128 v[52:55], v92 offset:256
    v_mfma_f32_16x16x32_bf16 v[40:43], v[68:71], v[148:151], v[40:43]
    ds_read_b128 v[56:59], v92 offset:16640
    v_mfma_f32_16x16x32_bf16 v[44:47], v[72:75], v[144:147], v[44:47]
    buffer_load_dwordx4 v86, s[60:63], s69 offen offset:2048 lds
    v_mfma_f32_16x16x32_bf16 v[48:51], v[72:75], v[148:151], v[48:51]
    ds_write_b128 v96, v[32:35] offset:1024
    s_waitcnt lgkmcnt(4)
    v_mfma_f32_16x16x32_bf16 v[36:39], v[76:79], v[152:155], v[36:39]
    ds_read_b128 v[60:63], v93 offset:256
    v_mfma_f32_16x16x32_bf16 v[40:43], v[76:79], v[156:159], v[40:43]
    ds_read_b128 v[64:67], v93 offset:16640
    v_mfma_f32_16x16x32_bf16 v[44:47], v[80:83], v[152:155], v[44:47]
    buffer_load_dwordx4 v87, s[60:63], s69 offen offset:3072 lds
    s_add_u32 s69, s69, s3
    v_mfma_f32_16x16x32_bf16 v[48:51], v[80:83], v[156:159], v[48:51]
    s_waitcnt lgkmcnt(3)
    v_mfma_f32_16x16x32_bf16 v[36:39], v[52:55], v[160:163], v[36:39]
    ds_read_b128 v[68:71], v94 offset:256
    v_mfma_f32_16x16x32_bf16 v[40:43], v[52:55], v[164:167], v[40:43]
    ds_read_b128 v[72:75], v94 offset:16640
    v_mfma_f32_16x16x32_bf16 v[44:47], v[56:59], v[160:163], v[44:47]
    v_mfma_f32_16x16x32_bf16 v[48:51], v[56:59], v[164:167], v[48:51]
    s_waitcnt lgkmcnt(2)
    v_mfma_f32_16x16x32_bf16 v[36:39], v[60:63], v[168:171], v[36:39]
    ds_read_b128 v[76:79], v95 offset:256
    v_mfma_f32_16x16x32_bf16 v[40:43], v[60:63], v[172:175], v[40:43]
    ds_read_b128 v[80:83], v95 offset:16640
    v_mfma_f32_16x16x32_bf16 v[44:47], v[64:67], v[168:171], v[44:47]
    v_mfma_f32_16x16x32_bf16 v[48:51], v[64:67], v[172:175], v[48:51]
    s_waitcnt vmcnt(8) lgkmcnt(0)
    s_barrier
    v_mfma_f32_16x16x32_bf16 v[36:39], v[68:71], v[176:179], v[36:39]
    ds_read_b128 v[4:7], v97 offset:0
    ds_read_b128 v[8:11], v97 offset:1024
    ds_read_b128 v[52:55], v92 offset:32768
    v_mfma_f32_16x16x32_bf16 v[40:43], v[68:71], v[180:183], v[40:43]
    ds_read_b128 v[56:59], v92 offset:49152
    v_mfma_f32_16x16x32_bf16 v[44:47], v[72:75], v[176:179], v[44:47]
    v_mfma_f32_16x16x32_bf16 v[48:51], v[72:75], v[180:183], v[48:51]
    s_waitcnt lgkmcnt(2)
    v_mfma_f32_16x16x32_bf16 v[36:39], v[76:79], v[184:187], v[36:39]
    v_add_f32 v4, v4, v20
    v_add_f32 v5, v5, v21
    v_add_f32 v6, v6, v22
    v_add_f32 v7, v7, v23
    ds_read_b128 v[60:63], v93 offset:32768
    v_mfma_f32_16x16x32_bf16 v[40:43], v[76:79], v[188:191], v[40:43]
    v_cvt_pk_bf16_f32 v12, v4, v5
    v_cvt_pk_bf16_f32 v13, v6, v7
    ds_read_b128 v[64:67], v93 offset:49152
    v_mfma_f32_16x16x32_bf16 v[44:47], v[80:83], v[184:187], v[44:47]
    v_add_f32 v8, v8, v28
    v_add_f32 v9, v9, v29
    v_add_f32 v10, v10, v30
    v_add_f32 v11, v11, v31
    v_mfma_f32_16x16x32_bf16 v[48:51], v[80:83], v[188:191], v[48:51]
    v_cvt_pk_bf16_f32 v14, v8, v9
    v_cvt_pk_bf16_f32 v15, v10, v11
    buffer_store_dwordx4 v[12:15], v98, s[8:11], s73 offen sc1
    s_mov_b32 s73, s81
    s_add_u32 s81, s81, s4
    s_waitcnt lgkmcnt(2)
    v_mfma_f32_16x16x32_bf16 v[36:39], v[52:55], v[192:195], v[36:39]
    ds_read_b128 v[68:71], v94 offset:32768
    v_mfma_f32_16x16x32_bf16 v[40:43], v[52:55], v[196:199], v[40:43]
    ds_read_b128 v[72:75], v94 offset:49152
    v_mfma_f32_16x16x32_bf16 v[44:47], v[56:59], v[192:195], v[44:47]
    s_add_u32 m0, s70, 65536
    s_nop 0
    buffer_load_dwordx4 v84, s[60:63], s68 offen offset:0 lds
    v_mfma_f32_16x16x32_bf16 v[48:51], v[56:59], v[196:199], v[48:51]
    s_waitcnt lgkmcnt(2)
    v_mfma_f32_16x16x32_bf16 v[36:39], v[60:63], v[200:203], v[36:39]
    ds_read_b128 v[76:79], v95 offset:32768
    v_mfma_f32_16x16x32_bf16 v[40:43], v[60:63], v[204:207], v[40:43]
    ds_read_b128 v[80:83], v95 offset:49152
    v_mfma_f32_16x16x32_bf16 v[44:47], v[64:67], v[200:203], v[44:47]
    buffer_load_dwordx4 v85, s[60:63], s68 offen offset:1024 lds
    v_mfma_f32_16x16x32_bf16 v[48:51], v[64:67], v[204:207], v[48:51]
    s_waitcnt lgkmcnt(2)
    v_mfma_f32_16x16x32_bf16 v[36:39], v[68:71], v[208:211], v[36:39]
    ds_read_b128 v[52:55], v92 offset:33024
    v_mfma_f32_16x16x32_bf16 v[40:43], v[68:71], v[212:215], v[40:43]
    ds_read_b128 v[56:59], v92 offset:49408
    v_mfma_f32_16x16x32_bf16 v[44:47], v[72:75], v[208:211], v[44:47]
    buffer_load_dwordx4 v86, s[60:63], s68 offen offset:2048 lds
    v_mfma_f32_16x16x32_bf16 v[48:51], v[72:75], v[212:215], v[48:51]
    s_waitcnt lgkmcnt(2)
    v_mfma_f32_16x16x32_bf16 v[36:39], v[76:79], v[216:219], v[36:39]
    ds_read_b128 v[60:63], v93 offset:33024
    v_mfma_f32_16x16x32_bf16 v[40:43], v[76:79], v[220:223], v[40:43]
    ds_read_b128 v[64:67], v93 offset:49408
    v_mfma_f32_16x16x32_bf16 v[44:47], v[80:83], v[216:219], v[44:47]
    buffer_load_dwordx4 v87, s[60:63], s68 offen offset:3072 lds
    s_add_u32 s68, s68, s3
    v_mfma_f32_16x16x32_bf16 v[48:51], v[80:83], v[220:223], v[48:51]
    s_waitcnt lgkmcnt(2)
    v_mfma_f32_16x16x32_bf16 v[36:39], v[52:55], v[224:227], v[36:39]
    ds_read_b128 v[68:71], v94 offset:33024
    v_mfma_f32_16x16x32_bf16 v[40:43], v[52:55], v[228:231], v[40:43]
    ds_read_b128 v[72:75], v94 offset:49408
    v_mfma_f32_16x16x32_bf16 v[44:47], v[56:59], v[224:227], v[44:47]
    v_mfma_f32_16x16x32_bf16 v[48:51], v[56:59], v[228:231], v[48:51]
    s_waitcnt lgkmcnt(2)
    v_mfma_f32_16x16x32_bf16 v[36:39], v[60:63], v[232:235], v[36:39]
    ds_read_b128 v[76:79], v95 offset:33024
    v_mfma_f32_16x16x32_bf16 v[40:43], v[60:63], v[236:239], v[40:43]
    ds_read_b128 v[80:83], v95 offset:49408
    v_mfma_f32_16x16x32_bf16 v[44:47], v[64:67], v[232:235], v[44:47]
    v_mfma_f32_16x16x32_bf16 v[48:51], v[64:67], v[236:239], v[48:51]
    s_bitcmp1_b64 s[6:7], s82
    s_cbranch_scc1 ssig_55
    s_waitcnt vmcnt(8) lgkmcnt(0)
    s_barrier
srett_63:
    s_add_u32 s82, s82, s5
    v_mfma_f32_16x16x32_bf16 v[36:39], v[68:71], v[240:243], v[36:39]
    ds_read_b128 v[52:55], v88 offset:0
    v_mfma_f32_16x16x32_bf16 v[40:43], v[68:71], v[244:247], v[40:43]
    ds_read_b128 v[56:59], v88 offset:16384
    v_mfma_f32_16x16x32_bf16 v[44:47], v[72:75], v[240:243], v[44:47]
    v_mfma_f32_16x16x32_bf16 v[48:51], v[72:75], v[244:247], v[48:51]
    v_mfma_f32_16x16x32_bf16 v[36:39], v[76:79], v[248:251], v[36:39]
    ds_read_b128 v[60:63], v89 offset:0
    v_mfma_f32_16x16x32_bf16 v[40:43], v[76:79], v[252:255], v[40:43]
    ds_read_b128 v[64:67], v89 offset:16384
    v_mfma_f32_16x16x32_bf16 v[44:47], v[80:83], v[248:251], v[44:47]
    v_mfma_f32_16x16x32_bf16 v[48:51], v[80:83], v[252:255], v[48:51]
    s_cmp_lt_u32 s82, 64
    s_cbranch_scc1 stream_75
    s_nop 2
    ds_write_b128 v96, v[40:43] offset:0
    s_nop 1
    ds_write_b128 v96, v[48:51] offset:1024
    s_waitcnt lgkmcnt(0)
    s_barrier
    ds_read_b128 v[4:7], v97 offset:0
    ds_read_b128 v[8:11], v97 offset:1024
    s_waitcnt lgkmcnt(0)
    v_add_f32 v4, v4, v36
    v_add_f32 v5, v5, v37
    v_add_f32 v6, v6, v38
    v_add_f32 v7, v7, v39
    v_cvt_pk_bf16_f32 v12, v4, v5
    v_cvt_pk_bf16_f32 v13, v6, v7
    v_add_f32 v8, v8, v44
    v_add_f32 v9, v9, v45
    v_add_f32 v10, v10, v46
    v_add_f32 v11, v11, v47
    v_cvt_pk_bf16_f32 v14, v8, v9
    v_cvt_pk_bf16_f32 v15, v10, v11
    buffer_store_dwordx4 v[12:15], v98, s[8:11], s73 offen sc1
    s_mov_b32 s73, s81
    s_add_u32 s81, s81, s4
    s_cmp_ge_u32 s57, 24
    s_cbranch_scc1 col_59
send_58:
    s_waitcnt vmcnt(0) lgkmcnt(0)
    s_barrier
    s_cmp_lg_u32 s58, 0
    s_cbranch_scc1 sig_77
    s_cmp_ge_u32 s57, 16
    s_cbranch_scc1 sig_76
    s_bfe_u32 s85, s76, 0x10003
    s_lshl_b32 s85, s85, 2
    s_bfe_u32 s79, s76, 0x30000
    s_lshl_b32 s79, s79, 7
    s_or_b32 s85, s85, s79
    s_bfe_u32 s79, s76, 0x20005
    s_lshl_b32 s79, s79, 10
    s_or_b32 s85, s85, s79
    s_add_u32 s85, s85, 0x5110000
    v_mov_b32 v4, s82
    buffer_store_dword v4, off, s[8:11], s85 sc1
sig_76:
    v_mov_b32 v5, s84
    s_mov_b64 exec, 1
    buffer_atomic_add v5, off, s[12:15], s83 sc1
    s_mov_b64 exec, -1
    s_add_u32 s83, s83, 4
sig_77:
    v_bfe_u32 v2, v1, 4, 2
    v_lshlrev_b32 v2, 2, v2
    v_xor_b32 v2, v2, v1
    v_bfe_u32 v119, v2, 0, 4
    v_lshlrev_b32 v119, 4, v119
    v_bfe_u32 v3, v2, 4, 2
    v_lshl_or_b32 v119, v3, 11, v119
    s_lshl_b32 s63, s75, 3
    s_add_u32 s63, s63, s58
    s_lshl_b32 s5, s63, 13
    s_lshl_b32 s64, s63, 18
    s_bfe_u32 s7, s57, 0x30000
    s_lshl_b32 s7, s7, 8
    s_add_u32 s64, s64, s7
    s_lshl_b32 s66, s58, 14
    s_add_u32 m0, s66, 0
    s_nop 0
    buffer_load_dwordx4 v119, s[32:35], s64 offen lds
    s_add_u32 s64, s64, 0x2000
    s_add_u32 m0, s66, 1024
    s_nop 0
    buffer_load_dwordx4 v119, s[32:35], s64 offen lds
    s_add_u32 s64, s64, 0x2000
    s_add_u32 m0, s66, 2048
    s_nop 0
    buffer_load_dwordx4 v119, s[32:35], s64 offen lds
    s_add_u32 s64, s64, 0x2000
    s_add_u32 m0, s66, 3072
    s_nop 0
    buffer_load_dwordx4 v119, s[32:35], s64 offen lds
    s_add_u32 s64, s64, 0x2000
    s_add_u32 m0, s66, 4096
    s_nop 0
    buffer_load_dwordx4 v119, s[32:35], s64 offen lds
    s_add_u32 s64, s64, 0x2000
    s_add_u32 m0, s66, 5120
    s_nop 0
    buffer_load_dwordx4 v119, s[32:35], s64 offen lds
    s_add_u32 s64, s64, 0x2000
    s_add_u32 m0, s66, 6144
    s_nop 0
    buffer_load_dwordx4 v119, s[32:35], s64 offen lds
    s_add_u32 s64, s64, 0x2000
    s_add_u32 m0, s66, 7168
    s_nop 0
    buffer_load_dwordx4 v119, s[32:35], s64 offen lds
    s_add_u32 s64, s64, 0x2000
    s_add_u32 m0, s66, 8192
    s_nop 0
    buffer_load_dwordx4 v119, s[32:35], s64 offen lds
    s_add_u32 s64, s64, 0x2000
    s_add_u32 m0, s66, 9216
    s_nop 0
    buffer_load_dwordx4 v119, s[32:35], s64 offen lds
    s_add_u32 s64, s64, 0x2000
    s_add_u32 m0, s66, 10240
    s_nop 0
    buffer_load_dwordx4 v119, s[32:35], s64 offen lds
    s_add_u32 s64, s64, 0x2000
    s_add_u32 m0, s66, 11264
    s_nop 0
    buffer_load_dwordx4 v119, s[32:35], s64 offen lds
    s_add_u32 s64, s64, 0x2000
    s_add_u32 m0, s66, 12288
    s_nop 0
    buffer_load_dwordx4 v119, s[32:35], s64 offen lds
    s_add_u32 s64, s64, 0x2000
    s_add_u32 m0, s66, 13312
    s_nop 0
    buffer_load_dwordx4 v119, s[32:35], s64 offen lds
    s_add_u32 s64, s64, 0x2000
    s_add_u32 m0, s66, 14336
    s_nop 0
    buffer_load_dwordx4 v119, s[32:35], s64 offen lds
    s_add_u32 s64, s64, 0x2000
    s_add_u32 m0, s66, 15360
    s_nop 0
    buffer_load_dwordx4 v119, s[32:35], s64 offen lds
    s_add_u32 s64, s64, 0x2000
    buffer_load_dwordx4 v[192:195], v119, s[32:35], s64 offen
    s_add_u32 s64, s64, 0x2000
    buffer_load_dwordx4 v[196:199], v119, s[32:35], s64 offen
    s_add_u32 s64, s64, 0x2000
    buffer_load_dwordx4 v[200:203], v119, s[32:35], s64 offen
    s_add_u32 s64, s64, 0x2000
    buffer_load_dwordx4 v[204:207], v119, s[32:35], s64 offen
    s_add_u32 s64, s64, 0x2000
    buffer_load_dwordx4 v[208:211], v119, s[32:35], s64 offen
    s_add_u32 s64, s64, 0x2000
    buffer_load_dwordx4 v[212:215], v119, s[32:35], s64 offen
    s_add_u32 s64, s64, 0x2000
    buffer_load_dwordx4 v[216:219], v119, s[32:35], s64 offen
    s_add_u32 s64, s64, 0x2000
    buffer_load_dwordx4 v[220:223], v119, s[32:35], s64 offen
    s_add_u32 s64, s64, 0x2000
    buffer_load_dwordx4 v[224:227], v119, s[32:35], s64 offen
    s_add_u32 s64, s64, 0x2000
    buffer_load_dwordx4 v[228:231], v119, s[32:35], s64 offen
    s_add_u32 s64, s64, 0x2000
    buffer_load_dwordx4 v[232:235], v119, s[32:35], s64 offen
    s_add_u32 s64, s64, 0x2000
    buffer_load_dwordx4 v[236:239], v119, s[32:35], s64 offen
    s_add_u32 s64, s64, 0x2000
    buffer_load_dwordx4 v[240:243], v119, s[32:35], s64 offen
    s_add_u32 s64, s64, 0x2000
    buffer_load_dwordx4 v[244:247], v119, s[32:35], s64 offen
    s_add_u32 s64, s64, 0x2000
    buffer_load_dwordx4 v[248:251], v119, s[32:35], s64 offen
    s_add_u32 s64, s64, 0x2000
    buffer_load_dwordx4 v[252:255], v119, s[32:35], s64 offen
    s_add_u32 s64, s64, 0x2000
    v_bfe_u32 v121, v1, 0, 2
    v_lshlrev_b32 v121, 4, v121
    v_bfe_u32 v3, v1, 2, 2
    v_lshl_or_b32 v121, v3, 6, v121
    v_bfe_u32 v3, v1, 2, 2
    v_lshl_or_b32 v121, v3, 8, v121
    v_bfe_u32 v3, v1, 4, 1
    v_lshl_or_b32 v121, v3, 10, v121
    v_bfe_u32 v3, v1, 5, 1
    v_lshl_or_b32 v121, v3, 12, v121
    s_bfe_u32 s63, s58, 0x20000
    s_lshl_b32 s63, s63, 6
    s_bfe_u32 s70, s58, 0x10002
    s_lshl_b32 s70, s70, 16
    s_or_b32 s63, s63, s70
    v_xor_b32 v121, s63, v121
    v_lshl_add_u32 v120, v1, 4, s66
    s_waitcnt vmcnt(16)
    s_barrier
    ds_read_b64_tr_b16 v[128:129], v121 offset:0
    ds_read_b64_tr_b16 v[130:131], v121 offset:2048
    ds_read_b64_tr_b16 v[132:133], v121 offset:8
    ds_read_b64_tr_b16 v[134:135], v121 offset:2056
    ds_read_b64_tr_b16 v[136:137], v121 offset:8192
    ds_read_b64_tr_b16 v[138:139], v121 offset:10240
    ds_read_b64_tr_b16 v[140:141], v121 offset:8200
    ds_read_b64_tr_b16 v[142:143], v121 offset:10248
    s_waitcnt lgkmcnt(4)
    ds_read_b64_tr_b16 v[144:145], v121 offset:16384
    ds_read_b64_tr_b16 v[146:147], v121 offset:18432
    ds_read_b64_tr_b16 v[148:149], v121 offset:16392
    ds_read_b64_tr_b16 v[150:151], v121 offset:18440
    ds_read_b64_tr_b16 v[152:153], v121 offset:24576
    ds_read_b64_tr_b16 v[154:155], v121 offset:26624
    ds_read_b64_tr_b16 v[156:157], v121 offset:24584
    ds_read_b64_tr_b16 v[158:159], v121 offset:26632
    s_waitcnt lgkmcnt(4)
    ds_read_b64_tr_b16 v[160:161], v121 offset:32768
    ds_read_b64_tr_b16 v[162:163], v121 offset:34816
    ds_read_b64_tr_b16 v[164:165], v121 offset:32776
    ds_read_b64_tr_b16 v[166:167], v121 offset:34824
    ds_read_b64_tr_b16 v[168:169], v121 offset:40960
    ds_read_b64_tr_b16 v[170:171], v121 offset:43008
    ds_read_b64_tr_b16 v[172:173], v121 offset:40968
    ds_read_b64_tr_b16 v[174:175], v121 offset:43016
    s_waitcnt lgkmcnt(4)
    ds_read_b64_tr_b16 v[176:177], v121 offset:49152
    ds_read_b64_tr_b16 v[178:179], v121 offset:51200
    ds_read_b64_tr_b16 v[180:181], v121 offset:49160
    ds_read_b64_tr_b16 v[182:183], v121 offset:51208
    ds_read_b64_tr_b16 v[184:185], v121 offset:57344
    ds_read_b64_tr_b16 v[186:187], v121 offset:59392
    ds_read_b64_tr_b16 v[188:189], v121 offset:57352
    ds_read_b64_tr_b16 v[190:191], v121 offset:59400
    s_waitcnt lgkmcnt(0)
    s_barrier
    s_waitcnt vmcnt(15)
    ds_write_b128 v120, v[192:195] offset:0
    s_waitcnt vmcnt(14)
    ds_write_b128 v120, v[196:199] offset:1024
    s_waitcnt vmcnt(13)
    ds_write_b128 v120, v[200:203] offset:2048
    s_waitcnt vmcnt(12)
    ds_write_b128 v120, v[204:207] offset:3072
    s_waitcnt vmcnt(11)
    ds_write_b128 v120, v[208:211] offset:4096
    s_waitcnt vmcnt(10)
    ds_write_b128 v120, v[212:215] offset:5120
    s_waitcnt vmcnt(9)
    ds_write_b128 v120, v[216:219] offset:6144
    s_waitcnt vmcnt(8)
    ds_write_b128 v120, v[220:223] offset:7168
    s_waitcnt vmcnt(7)
    ds_write_b128 v120, v[224:227] offset:8192
    s_waitcnt vmcnt(6)
    ds_write_b128 v120, v[228:231] offset:9216
    s_waitcnt vmcnt(5)
    ds_write_b128 v120, v[232:235] offset:10240
    s_waitcnt vmcnt(4)
    ds_write_b128 v120, v[236:239] offset:11264
    s_waitcnt vmcnt(3)
    ds_write_b128 v120, v[240:243] offset:12288
    s_waitcnt vmcnt(2)
    ds_write_b128 v120, v[244:247] offset:13312
    s_waitcnt vmcnt(1)
    ds_write_b128 v120, v[248:251] offset:14336
    s_waitcnt vmcnt(0)
    ds_write_b128 v120, v[252:255] offset:15360
    s_cmp_lg_u32 s58, 0
    s_cbranch_scc1 wall_78
    v_mov_b32 v3, 196
wctr_79:
    buffer_load_dword v2, v3, s[12:15], 0 offen sc1
    s_waitcnt vmcnt(0)
    v_cmp_ne_u32 vcc, 2097216, v2
    s_cbranch_vccz wctr_ok_80
    s_sub_u32 s77, s77, 1
    s_cbranch_scc0 wctr_79
    s_mov_b32 s77, 0
wctr_ok_80:
wall_78:
    s_waitcnt lgkmcnt(0)
    s_barrier
    ds_read_b64_tr_b16 v[192:193], v121 offset:0
    ds_read_b64_tr_b16 v[194:195], v121 offset:2048
    ds_read_b64_tr_b16 v[196:197], v121 offset:8
    ds_read_b64_tr_b16 v[198:199], v121 offset:2056
    ds_read_b64_tr_b16 v[200:201], v121 offset:8192
    ds_read_b64_tr_b16 v[202:203], v121 offset:10240
    ds_read_b64_tr_b16 v[204:205], v121 offset:8200
    ds_read_b64_tr_b16 v[206:207], v121 offset:10248
    s_waitcnt lgkmcnt(4)
    ds_read_b64_tr_b16 v[208:209], v121 offset:16384
    ds_read_b64_tr_b16 v[210:211], v121 offset:18432
    ds_read_b64_tr_b16 v[212:213], v121 offset:16392
    ds_read_b64_tr_b16 v[214:215], v121 offset:18440
    ds_read_b64_tr_b16 v[216:217], v121 offset:24576
    ds_read_b64_tr_b16 v[218:219], v121 offset:26624
    ds_read_b64_tr_b16 v[220:221], v121 offset:24584
    ds_read_b64_tr_b16 v[222:223], v121 offset:26632
    s_waitcnt lgkmcnt(4)
    ds_read_b64_tr_b16 v[224:225], v121 offset:32768
    ds_read_b64_tr_b16 v[226:227], v121 offset:34816
    ds_read_b64_tr_b16 v[228:229], v121 offset:32776
    ds_read_b64_tr_b16 v[230:231], v121 offset:34824
    ds_read_b64_tr_b16 v[232:233], v121 offset:40960
    ds_read_b64_tr_b16 v[234:235], v121 offset:43008
    ds_read_b64_tr_b16 v[236:237], v121 offset:40968
    ds_read_b64_tr_b16 v[238:239], v121 offset:43016
    s_waitcnt lgkmcnt(4)
    ds_read_b64_tr_b16 v[240:241], v121 offset:49152
    ds_read_b64_tr_b16 v[242:243], v121 offset:51200
    ds_read_b64_tr_b16 v[244:245], v121 offset:49160
    ds_read_b64_tr_b16 v[246:247], v121 offset:51208
    ds_read_b64_tr_b16 v[248:249], v121 offset:57344
    ds_read_b64_tr_b16 v[250:251], v121 offset:59392
    ds_read_b64_tr_b16 v[252:253], v121 offset:57352
    ds_read_b64_tr_b16 v[254:255], v121 offset:59400
    s_waitcnt lgkmcnt(0)
    s_barrier
    s_add_u32 s5, s5, 0x3000000
    s_lshl_b32 s6, s75, 7
    s_add_u32 s6, s6, 0x5100000
    s_lshl_b32 s66, s58, 12
    v_lshlrev_b32 v123, 4, v1
    s_bfe_u32 s63, s58, 0x10002
    s_lshl_b32 s63, s63, 8
    v_xor_b32 v119, s63, v123
    v_bfe_u32 v116, v1, 0, 4
    v_lshlrev_b32 v116, 4, v116
    v_bfe_u32 v2, v1, 4, 2
    v_lshl_or_b32 v116, v2, 9, v116
    v_lshl_or_b32 v116, s63, 6, v116
    v_xor_b32 v117, 0x10000, v116
    s_lshl_b32 s63, s58, 11
    s_or_b32 s63, s63, 131072
    v_add_u32 v120, s63, v123
    v_xor_b32 v121, 0x2000, v120
    v_bfe_u32 v122, v1, 4, 2
    v_lshlrev_b32 v122, 4, v122
    v_bfe_u32 v2, v1, 0, 4
    v_lshl_or_b32 v122, v2, 12, v122
    s_bfe_u32 s63, s58, 0x20000
    s_lshl_b32 s63, s63, 6
    s_bfe_u32 s70, s58, 0x10002
    s_lshl_b32 s70, s70, 16
    s_or_b32 s63, s63, s70
    s_add_u32 s7, s7, s63
    s_bfe_u32 s69, s57, 0x30000
    s_lshl_b32 s69, s69, 16
    s_bfe_u32 s63, s57, 0x20003
    s_lshl_b32 s63, s63, 21
    s_or_b32 s69, s69, s63
    s_lshl_b32 s63, s58, 13
    s_add_u32 s69, s69, s63
    s_add_u32 s69, s69, 0x6000000
    s_lshl_b32 s63, s75, 11
    s_add_u32 s69, s69, s63
    s_xor_b32 s2, s69, 2048
    s_xor_b32 s3, s69, 4096
    s_xor_b32 s4, s69, 6144
    s_lshr_b32 s63, s58, 1
    s_xor_b32 s74, s63, s75
    s_mov_b32 s60, 0x92492490
    s_mov_b32 s61, 0x24924924
    s_cmp_lt_u32 s57, 16
    s_cselect_b32 s63, 5, 0
    s_or_b32 s60, s60, s63
    s_lshr_b32 s63, s57, 3
    s_lshl_b64 s[60:61], s[60:61], s63
    v_bfe_u32 v125, v1, 0, 3
    v_lshlrev_b32 v125, 2, v125
    v_lshl_or_b32 v125, s58, 28, v125
    v_mov_b32 v127, 163744
    s_mov_b32 s70, 0
    v_mov_b32 v124, v123
    s_ff1_i32_b64 s62, s[60:61]
    s_bitset0_b64 s[60:61], s62
    s_lshl_b32 s65, s62, 9
    s_add_u32 s65, s65, s6
    s_mov_b32 s59, -1
    s_mov_b32 s67, -1
wo_slow_81:
    s_lshl_b32 s63, s58, 2
    s_add_u32 s65, s65, s63
pollfl_86:
    buffer_load_dword v118, off, s[8:11], s65 sc1
    s_waitcnt vmcnt(0)
    v_cmp_eq_u32 vcc, 0, v118
    s_cbranch_vccz pollfl_ok_87
    s_sub_u32 s77, s77, 1
    s_cbranch_scc0 pollfl_86
    s_mov_b32 s77, 0
pollfl_ok_87:
    s_mov_b32 s72, s62
    s_lshl_b32 s64, s62, 18
    s_add_u32 s64, s64, s5
    s_ff1_i32_b64 s62, s[60:61]
    s_bitset0_b64 s[60:61], s62
    s_lshl_b32 s65, s62, 9
    s_add_u32 s65, s65, s6
    s_add_u32 m0, s66, 0
    s_nop 0
    buffer_load_dwordx4 v119, s[8:11], s64 offen offset:0 lds
    buffer_load_dwordx4 v119, s[8:11], s64 offen offset:1024 lds
    buffer_load_dwordx4 v119, s[8:11], s64 offen offset:2048 lds
    buffer_load_dwordx4 v119, s[8:11], s64 offen offset:3072 lds
    s_add_u32 s64, s64, 4096
    buffer_load_dword v118, v125, s[8:11], s65 offen sc1
    s_add_u32 m0, s66, 32768
    s_nop 0
    buffer_load_dwordx4 v119, s[8:11], s64 offen offset:0 lds
    buffer_load_dwordx4 v119, s[8:11], s64 offen offset:1024 lds
    buffer_load_dwordx4 v119, s[8:11], s64 offen offset:2048 lds
    buffer_load_dwordx4 v119, s[8:11], s64 offen offset:3072 lds
    s_add_u32 s64, s64, 4096
    s_waitcnt vmcnt(4)
    s_cmp_lg_u32 s58, 0
    s_cbranch_scc1 wo_v_88
    v_cmp_eq_u32 vcc, 0, v118
    s_nop 1
    v_mov_b32 v126, vcc_lo
    ds_write_b32 v127, v126
wo_v_88:
    s_waitcnt lgkmcnt(0)
    s_barrier
    ds_read_b32 v126, v127
    ds_read_b128 v[44:47], v116 offset:0
    ds_read_b128 v[48:51], v116 offset:256
    ds_read_b128 v[52:55], v116 offset:2048
    ds_read_b128 v[56:59], v116 offset:2304
wo_loop_82:
    s_waitcnt lgkmcnt(2)
    v_mfma_f32_16x16x32_bf16 v[12:15], v[128:131], v[44:47], 0
    ds_read_b128 v[60:63], v116 offset:4096
    v_mfma_f32_16x16x32_bf16 v[16:19], v[132:135], v[44:47], 0
    ds_read_b128 v[64:67], v116 offset:4352
    v_readfirstlane_b32 s68, v126
    s_mov_b32 s73, s59
    s_mov_b32 s59, s72
    s_mov_b32 s64, 0x5ffffff0
    s_lshr_b32 s63, s62, 31
    s_or_b32 s68, s68, s63
    s_cbranch_scc1 wo_np_89
    s_mov_b32 s72, s62
    s_lshl_b32 s64, s62, 18
    s_add_u32 s64, s64, s5
    s_ff1_i32_b64 s62, s[60:61]
    s_bitset0_b64 s[60:61], s62
    s_lshl_b32 s65, s62, 9
    s_add_u32 s65, s65, s6
wo_np_89:
    v_mfma_f32_16x16x32_bf16 v[20:23], v[128:131], v[48:51], 0
    v_mfma_f32_16x16x32_bf16 v[24:27], v[132:135], v[48:51], 0
    s_waitcnt lgkmcnt(2)
    v_mfma_f32_16x16x32_bf16 v[12:15], v[136:139], v[52:55], v[12:15]
    ds_read_b128 v[68:71], v116 offset:6144
    v_mfma_f32_16x16x32_bf16 v[16:19], v[140:143], v[52:55], v[16:19]
    ds_read_b128 v[72:75], v116 offset:6400
    v_mfma_f32_16x16x32_bf16 v[20:23], v[136:139], v[56:59], v[20:23]
    v_mfma_f32_16x16x32_bf16 v[24:27], v[140:143], v[56:59], v[24:27]
    ds_write_b128 v120, v[36:39] offset:0
    s_waitcnt lgkmcnt(3)
    v_mfma_f32_16x16x32_bf16 v[12:15], v[144:147], v[60:63], v[12:15]
    ds_read_b128 v[44:47], v116 offset:8192
    v_mfma_f32_16x16x32_bf16 v[16:19], v[148:151], v[60:63], v[16:19]
    ds_read_b128 v[48:51], v116 offset:8448
    v_mfma_f32_16x16x32_bf16 v[20:23], v[144:147], v[64:67], v[20:23]
    s_add_u32 m0, s66, 65536
    s_nop 0
    buffer_load_dwordx4 v119, s[8:11], s64 offen offset:0 lds
    v_mfma_f32_16x16x32_bf16 v[24:27], v[148:151], v[64:67], v[24:27]
    ds_write_b128 v120, v[40:43] offset:1024
    s_waitcnt lgkmcnt(4)
    v_mfma_f32_16x16x32_bf16 v[12:15], v[152:155], v[68:71], v[12:15]
    ds_read_b128 v[52:55], v116 offset:10240
    v_mfma_f32_16x16x32_bf16 v[16:19], v[156:159], v[68:71], v[16:19]
    ds_read_b128 v[56:59], v116 offset:10496
    v_mfma_f32_16x16x32_bf16 v[20:23], v[152:155], v[72:75], v[20:23]
    buffer_load_dwordx4 v119, s[8:11], s64 offen offset:1024 lds
    v_mfma_f32_16x16x32_bf16 v[24:27], v[156:159], v[72:75], v[24:27]
    s_waitcnt lgkmcnt(3)
    v_mfma_f32_16x16x32_bf16 v[12:15], v[160:163], v[44:47], v[12:15]
    ds_read_b128 v[60:63], v116 offset:12288
    v_mfma_f32_16x16x32_bf16 v[16:19], v[164:167], v[44:47], v[16:19]
    ds_read_b128 v[64:67], v116 offset:12544
    v_mfma_f32_16x16x32_bf16 v[20:23], v[160:163], v[48:51], v[20:23]
    buffer_load_dwordx4 v119, s[8:11], s64 offen offset:2048 lds
    v_mfma_f32_16x16x32_bf16 v[24:27], v[164:167], v[48:51], v[24:27]
    buffer_load_dword v118, v125, s[8:11], s65 offen sc1
    s_waitcnt lgkmcnt(2)
    v_mfma_f32_16x16x32_bf16 v[12:15], v[168:171], v[52:55], v[12:15]
    ds_read_b128 v[68:71], v116 offset:14336
    v_mfma_f32_16x16x32_bf16 v[16:19], v[172:175], v[52:55], v[16:19]
    ds_read_b128 v[72:75], v116 offset:14592
    v_mfma_f32_16x16x32_bf16 v[20:23], v[168:171], v[56:59], v[20:23]
    buffer_load_dwordx4 v119, s[8:11], s64 offen offset:3072 lds
    s_add_u32 s64, s64, 4096
    v_mfma_f32_16x16x32_bf16 v[24:27], v[172:175], v[56:59], v[24:27]
    s_cmp_eq_u32 s74, 0
    s_cbranch_scc0 wo_o_90
    buffer_load_dwordx4 v[92:95], v124, s[8:11], s2 offen offset:0 sc1
    buffer_load_dwordx4 v[96:99], v124, s[8:11], s2 offen offset:1024 sc1
    buffer_load_dwordx4 v[100:103], v124, s[8:11], s3 offen offset:0 sc1
    buffer_load_dwordx4 v[104:107], v124, s[8:11], s3 offen offset:1024 sc1
    buffer_load_dwordx4 v[108:111], v124, s[8:11], s4 offen offset:0 sc1
    buffer_load_dwordx4 v[112:115], v124, s[8:11], s4 offen offset:1024 sc1
wo_o_90:
    s_cmp_eq_u32 s74, 0
    s_cbranch_scc1 wo_w_91
    s_waitcnt vmcnt(5)
wo_w_91:
    s_waitcnt vmcnt(11)
    s_waitcnt lgkmcnt(0)
    s_barrier
    v_mfma_f32_16x16x32_bf16 v[12:15], v[176:179], v[60:63], v[12:15]
    ds_read_b128 v[4:7], v121 offset:0
    ds_read_b128 v[8:11], v121 offset:1024
    ds_read_b128 v[44:47], v116 offset:32768
    v_mfma_f32_16x16x32_bf16 v[16:19], v[180:183], v[60:63], v[16:19]
    ds_read_b128 v[48:51], v116 offset:33024
    v_mfma_f32_16x16x32_bf16 v[20:23], v[176:179], v[64:67], v[20:23]
    v_mfma_f32_16x16x32_bf16 v[24:27], v[180:183], v[64:67], v[24:27]
    s_waitcnt lgkmcnt(2)
    v_mfma_f32_16x16x32_bf16 v[12:15], v[184:187], v[68:71], v[12:15]
    ds_read_b128 v[52:55], v116 offset:34816
    v_mfma_f32_16x16x32_bf16 v[16:19], v[188:191], v[68:71], v[16:19]
    ds_read_b128 v[56:59], v116 offset:35072
    v_mfma_f32_16x16x32_bf16 v[20:23], v[184:187], v[72:75], v[20:23]
    v_mfma_f32_16x16x32_bf16 v[24:27], v[188:191], v[72:75], v[24:27]
    v_pk_add_f32 v[84:85], v[4:5], v[28:29]
    v_pk_add_f32 v[86:87], v[6:7], v[30:31]
    v_pk_add_f32 v[88:89], v[8:9], v[32:33]
    v_pk_add_f32 v[90:91], v[10:11], v[34:35]
    s_cmp_eq_u32 s74, 0
    s_cbranch_scc1 wo_e_92
    s_bfe_u32 s71, s70, 0x10002
    s_cmp_lt_i32 s73, 0
    s_cselect_b32 s63, 0x5ffffff0, s69
    v_bfi_b32 v84, 1, s71, v84
    buffer_store_dwordx4 v[84:87], v123, s[8:11], s63 offen offset:0 sc1
    v_bfi_b32 v88, 1, s71, v88
    buffer_store_dwordx4 v[88:91], v123, s[8:11], s63 offen offset:1024 sc1
wo_e_92:
    s_waitcnt lgkmcnt(2)
    v_mfma_f32_16x16x32_bf16 v[12:15], v[192:195], v[44:47], v[12:15]
    ds_read_b128 v[60:63], v116 offset:36864
    v_mfma_f32_16x16x32_bf16 v[16:19], v[196:199], v[44:47], v[16:19]
    ds_read_b128 v[64:67], v116 offset:37120
    v_mfma_f32_16x16x32_bf16 v[20:23], v[192:195], v[48:51], v[20:23]
    v_mfma_f32_16x16x32_bf16 v[24:27], v[196:199], v[48:51], v[24:27]
    s_waitcnt lgkmcnt(2)
    v_mfma_f32_16x16x32_bf16 v[12:15], v[200:203], v[52:55], v[12:15]
    ds_read_b128 v[68:71], v116 offset:38912
    v_mfma_f32_16x16x32_bf16 v[16:19], v[204:207], v[52:55], v[16:19]
    ds_read_b128 v[72:75], v116 offset:39168
    v_mfma_f32_16x16x32_bf16 v[20:23], v[200:203], v[56:59], v[20:23]
    v_mfma_f32_16x16x32_bf16 v[24:27], v[204:207], v[56:59], v[24:27]
    s_waitcnt lgkmcnt(2)
    v_mfma_f32_16x16x32_bf16 v[12:15], v[208:211], v[60:63], v[12:15]
    ds_read_b128 v[44:47], v116 offset:40960
    v_mfma_f32_16x16x32_bf16 v[16:19], v[212:215], v[60:63], v[16:19]
    ds_read_b128 v[48:51], v116 offset:41216
    v_mfma_f32_16x16x32_bf16 v[20:23], v[208:211], v[64:67], v[20:23]
    s_add_u32 m0, s66, 98304
    s_nop 0
    buffer_load_dwordx4 v119, s[8:11], s64 offen offset:0 lds
    v_mfma_f32_16x16x32_bf16 v[24:27], v[212:215], v[64:67], v[24:27]
    s_waitcnt lgkmcnt(2)
    v_mfma_f32_16x16x32_bf16 v[12:15], v[216:219], v[68:71], v[12:15]
    ds_read_b128 v[52:55], v116 offset:43008
    v_mfma_f32_16x16x32_bf16 v[16:19], v[220:223], v[68:71], v[16:19]
    ds_read_b128 v[56:59], v116 offset:43264
    v_mfma_f32_16x16x32_bf16 v[20:23], v[216:219], v[72:75], v[20:23]
    buffer_load_dwordx4 v119, s[8:11], s64 offen offset:1024 lds
    v_mfma_f32_16x16x32_bf16 v[24:27], v[220:223], v[72:75], v[24:27]
    s_waitcnt lgkmcnt(2)
    v_mfma_f32_16x16x32_bf16 v[12:15], v[224:227], v[44:47], v[12:15]
    ds_read_b128 v[60:63], v116 offset:45056
    v_mfma_f32_16x16x32_bf16 v[16:19], v[228:231], v[44:47], v[16:19]
    ds_read_b128 v[64:67], v116 offset:45312
    v_mfma_f32_16x16x32_bf16 v[20:23], v[224:227], v[48:51], v[20:23]
    buffer_load_dwordx4 v119, s[8:11], s64 offen offset:2048 lds
    v_mfma_f32_16x16x32_bf16 v[24:27], v[228:231], v[48:51], v[24:27]
    s_waitcnt lgkmcnt(2)
    v_mfma_f32_16x16x32_bf16 v[12:15], v[232:235], v[52:55], v[12:15]
    ds_read_b128 v[68:71], v116 offset:47104
    v_mfma_f32_16x16x32_bf16 v[16:19], v[236:239], v[52:55], v[16:19]
    ds_read_b128 v[72:75], v116 offset:47360
    v_mfma_f32_16x16x32_bf16 v[20:23], v[232:235], v[56:59], v[20:23]
    buffer_load_dwordx4 v119, s[8:11], s64 offen offset:3072 lds
    s_add_u32 s64, s64, 4096
    v_mfma_f32_16x16x32_bf16 v[24:27], v[236:239], v[56:59], v[24:27]
    s_cmp_eq_u32 s74, 0
    s_cbranch_scc1 wo_w_93
    s_waitcnt vmcnt(6)
wo_w_93:
    s_waitcnt vmcnt(10)
    s_cmp_lg_u32 s58, 0
    s_cbranch_scc1 wo_v_94
    v_cmp_eq_u32 vcc, 0, v118
    s_nop 1
    v_mov_b32 v126, vcc_lo
    ds_write_b32 v127, v126
wo_v_94:
    s_waitcnt lgkmcnt(0)
    s_barrier
    v_mfma_f32_16x16x32_bf16 v[12:15], v[240:243], v[60:63], v[12:15]
    ds_read_b32 v126, v127
    ds_read_b128 v[44:47], v117 offset:0
    v_mfma_f32_16x16x32_bf16 v[16:19], v[244:247], v[60:63], v[16:19]
    ds_read_b128 v[48:51], v117 offset:256
    v_mfma_f32_16x16x32_bf16 v[20:23], v[240:243], v[64:67], v[20:23]
    v_mfma_f32_16x16x32_bf16 v[24:27], v[244:247], v[64:67], v[24:27]
    v_mfma_f32_16x16x32_bf16 v[12:15], v[248:251], v[68:71], v[12:15]
    ds_read_b128 v[52:55], v117 offset:2048
    v_mfma_f32_16x16x32_bf16 v[16:19], v[252:255], v[68:71], v[16:19]
    ds_read_b128 v[56:59], v117 offset:2304
    v_mfma_f32_16x16x32_bf16 v[20:23], v[248:251], v[72:75], v[20:23]
    v_mfma_f32_16x16x32_bf16 v[24:27], v[252:255], v[72:75], v[24:27]
    s_lshr_b32 s63, s67, 31
    s_or_b32 s63, s63, s74
    s_cbranch_scc1 wo_k_95
    s_waitcnt vmcnt(4)
    v_bitop3_b32 v2, v92, v96, s71 bitop3:0x7e
    v_bitop3_b32 v3, v100, v104, s71 bitop3:0x7e
    v_or_b32 v2, v2, v3
    v_bitop3_b32 v3, v108, v112, s71 bitop3:0x7e
    v_bitop3_b32 v2, v2, v3, 1 bitop3:0xa8
    v_cmp_ne_u32 vcc, 0, v2
    s_cbranch_vccz pollpart_ok_98
pollpart_97:
    buffer_load_dwordx4 v[92:95], v124, s[8:11], s2 offen offset:0 sc1
    buffer_load_dwordx4 v[96:99], v124, s[8:11], s2 offen offset:1024 sc1
    buffer_load_dwordx4 v[100:103], v124, s[8:11], s3 offen offset:0 sc1
    buffer_load_dwordx4 v[104:107], v124, s[8:11], s3 offen offset:1024 sc1
    buffer_load_dwordx4 v[108:111], v124, s[8:11], s4 offen offset:0 sc1
    buffer_load_dwordx4 v[112:115], v124, s[8:11], s4 offen offset:1024 sc1
    s_waitcnt vmcnt(0)
    v_bitop3_b32 v2, v92, v96, s71 bitop3:0x7e
    v_bitop3_b32 v3, v100, v104, s71 bitop3:0x7e
    v_or_b32 v2, v2, v3
    v_bitop3_b32 v3, v108, v112, s71 bitop3:0x7e
    v_bitop3_b32 v2, v2, v3, 1 bitop3:0xa8
    v_cmp_ne_u32 vcc, 0, v2
    s_cbranch_vccz pollpart_ok_98
    s_sub_u32 s77, s77, 1
    s_cbranch_scc0 pollpart_97
    s_mov_b32 s77, 0
pollpart_ok_98:
    v_pk_add_f32 v[76:77], v[76:77], v[92:93]
    v_pk_add_f32 v[100:101], v[100:101], v[108:109]
    v_pk_add_f32 v[76:77], v[76:77], v[100:101]
    v_cvt_pk_bf16_f32 v92, v76, v77
    v_pk_add_f32 v[78:79], v[78:79], v[94:95]
    v_pk_add_f32 v[102:103], v[102:103], v[110:111]
    v_pk_add_f32 v[78:79], v[78:79], v[102:103]
    v_cvt_pk_bf16_f32 v93, v78, v79
    v_pk_add_f32 v[80:81], v[80:81], v[96:97]
    v_pk_add_f32 v[104:105], v[104:105], v[112:113]
    v_pk_add_f32 v[80:81], v[80:81], v[104:105]
    v_cvt_pk_bf16_f32 v94, v80, v81
    v_pk_add_f32 v[82:83], v[82:83], v[98:99]
    v_pk_add_f32 v[106:107], v[106:107], v[114:115]
    v_pk_add_f32 v[82:83], v[82:83], v[106:107]
    v_cvt_pk_bf16_f32 v95, v82, v83
    buffer_store_dwordx4 v[92:95], v122, s[16:19], s67 offen offset:2048
wo_k_95:
    s_cmp_lt_i32 s73, 0
    s_cbranch_scc1 wo_e_96
    s_bfe_u32 s71, s70, 0x10002
    s_add_u32 s70, s70, 1
    v_pk_mov_b32 v[76:77], v[84:85], v[84:85] op_sel:[0,1]
    v_pk_mov_b32 v[78:79], v[86:87], v[86:87] op_sel:[0,1]
    v_pk_mov_b32 v[80:81], v[88:89], v[88:89] op_sel:[0,1]
    v_pk_mov_b32 v[82:83], v[90:91], v[90:91] op_sel:[0,1]
    v_mov_b32 v124, v123
    s_lshl_b32 s67, s73, 17
    s_add_u32 s67, s67, s7
    v_add_u32 v123, 0x80000, v123
    v_and_b32 v123, 0x1fffff, v123
wo_e_96:
    s_cmp_eq_u32 s68, 0
    s_cbranch_scc0 wo_fl_83
wo_out_85:
    s_waitcnt lgkmcnt(2)
    v_mfma_f32_16x16x32_bf16 v[28:31], v[128:131], v[44:47], 0
    ds_read_b128 v[60:63], v117 offset:4096
    v_mfma_f32_16x16x32_bf16 v[32:35], v[132:135], v[44:47], 0
    ds_read_b128 v[64:67], v117 offset:4352
    v_readfirstlane_b32 s68, v126
    s_mov_b32 s73, s59
    s_mov_b32 s59, s72
    s_mov_b32 s64, 0x5ffffff0
    s_lshr_b32 s63, s62, 31
    s_or_b32 s68, s68, s63
    s_cbranch_scc1 wo_np_99
    s_mov_b32 s72, s62
    s_lshl_b32 s64, s62, 18
    s_add_u32 s64, s64, s5
    s_ff1_i32_b64 s62, s[60:61]
    s_bitset0_b64 s[60:61], s62
    s_lshl_b32 s65, s62, 9
    s_add_u32 s65, s65, s6
wo_np_99:
    v_mfma_f32_16x16x32_bf16 v[36:39], v[128:131], v[48:51], 0
    v_mfma_f32_16x16x32_bf16 v[40:43], v[132:135], v[48:51], 0
    s_waitcnt lgkmcnt(2)
    v_mfma_f32_16x16x32_bf16 v[28:31], v[136:139], v[52:55], v[28:31]
    ds_read_b128 v[68:71], v117 offset:6144
    v_mfma_f32_16x16x32_bf16 v[32:35], v[140:143], v[52:55], v[32:35]
    ds_read_b128 v[72:75], v117 offset:6400
    v_mfma_f32_16x16x32_bf16 v[36:39], v[136:139], v[56:59], v[36:39]
    v_mfma_f32_16x16x32_bf16 v[40:43], v[140:143], v[56:59], v[40:43]
    ds_write_b128 v120, v[20:23] offset:0
    s_waitcnt lgkmcnt(3)
    v_mfma_f32_16x16x32_bf16 v[28:31], v[144:147], v[60:63], v[28:31]
    ds_read_b128 v[44:47], v117 offset:8192
    v_mfma_f32_16x16x32_bf16 v[32:35], v[148:151], v[60:63], v[32:35]
    ds_read_b128 v[48:51], v117 offset:8448
    v_mfma_f32_16x16x32_bf16 v[36:39], v[144:147], v[64:67], v[36:39]
    s_add_u32 m0, s66, 0
    s_nop 0
    buffer_load_dwordx4 v119, s[8:11], s64 offen offset:0 lds
    v_mfma_f32_16x16x32_bf16 v[40:43], v[148:151], v[64:67], v[40:43]
    ds_write_b128 v120, v[24:27] offset:1024
    s_waitcnt lgkmcnt(4)
    v_mfma_f32_16x16x32_bf16 v[28:31], v[152:155], v[68:71], v[28:31]
    ds_read_b128 v[52:55], v117 offset:10240
    v_mfma_f32_16x16x32_bf16 v[32:35], v[156:159], v[68:71], v[32:35]
    ds_read_b128 v[56:59], v117 offset:10496
    v_mfma_f32_16x16x32_bf16 v[36:39], v[152:155], v[72:75], v[36:39]
    buffer_load_dwordx4 v119, s[8:11], s64 offen offset:1024 lds
    v_mfma_f32_16x16x32_bf16 v[40:43], v[156:159], v[72:75], v[40:43]
    s_waitcnt lgkmcnt(3)
    v_mfma_f32_16x16x32_bf16 v[28:31], v[160:163], v[44:47], v[28:31]
    ds_read_b128 v[60:63], v117 offset:12288
    v_mfma_f32_16x16x32_bf16 v[32:35], v[164:167], v[44:47], v[32:35]
    ds_read_b128 v[64:67], v117 offset:12544
    v_mfma_f32_16x16x32_bf16 v[36:39], v[160:163], v[48:51], v[36:39]
    buffer_load_dwordx4 v119, s[8:11], s64 offen offset:2048 lds
    v_mfma_f32_16x16x32_bf16 v[40:43], v[164:167], v[48:51], v[40:43]
    buffer_load_dword v118, v125, s[8:11], s65 offen sc1
    s_waitcnt lgkmcnt(2)
    v_mfma_f32_16x16x32_bf16 v[28:31], v[168:171], v[52:55], v[28:31]
    ds_read_b128 v[68:71], v117 offset:14336
    v_mfma_f32_16x16x32_bf16 v[32:35], v[172:175], v[52:55], v[32:35]
    ds_read_b128 v[72:75], v117 offset:14592
    v_mfma_f32_16x16x32_bf16 v[36:39], v[168:171], v[56:59], v[36:39]
    buffer_load_dwordx4 v119, s[8:11], s64 offen offset:3072 lds
    s_add_u32 s64, s64, 4096
    v_mfma_f32_16x16x32_bf16 v[40:43], v[172:175], v[56:59], v[40:43]
    s_cmp_eq_u32 s74, 0
    s_cbranch_scc0 wo_o_100
    buffer_load_dwordx4 v[92:95], v124, s[8:11], s2 offen offset:0 sc1
    buffer_load_dwordx4 v[96:99], v124, s[8:11], s2 offen offset:1024 sc1
    buffer_load_dwordx4 v[100:103], v124, s[8:11], s3 offen offset:0 sc1
    buffer_load_dwordx4 v[104:107], v124, s[8:11], s3 offen offset:1024 sc1
    buffer_load_dwordx4 v[108:111], v124, s[8:11], s4 offen offset:0 sc1
    buffer_load_dwordx4 v[112:115], v124, s[8:11], s4 offen offset:1024 sc1
wo_o_100:
    s_cmp_eq_u32 s74, 0
    s_cbranch_scc1 wo_w_101
    s_waitcnt vmcnt(5)
wo_w_101:
    s_waitcnt vmcnt(11)
    s_waitcnt lgkmcnt(0)
    s_barrier
    v_mfma_f32_16x16x32_bf16 v[28:31], v[176:179], v[60:63], v[28:31]
    ds_read_b128 v[4:7], v121 offset:0
    ds_read_b128 v[8:11], v121 offset:1024
    ds_read_b128 v[44:47], v117 offset:32768
    v_mfma_f32_16x16x32_bf16 v[32:35], v[180:183], v[60:63], v[32:35]
    ds_read_b128 v[48:51], v117 offset:33024
    v_mfma_f32_16x16x32_bf16 v[36:39], v[176:179], v[64:67], v[36:39]
    v_mfma_f32_16x16x32_bf16 v[40:43], v[180:183], v[64:67], v[40:43]
    s_waitcnt lgkmcnt(2)
    v_mfma_f32_16x16x32_bf16 v[28:31], v[184:187], v[68:71], v[28:31]
    ds_read_b128 v[52:55], v117 offset:34816
    v_mfma_f32_16x16x32_bf16 v[32:35], v[188:191], v[68:71], v[32:35]
    ds_read_b128 v[56:59], v117 offset:35072
    v_mfma_f32_16x16x32_bf16 v[36:39], v[184:187], v[72:75], v[36:39]
    v_mfma_f32_16x16x32_bf16 v[40:43], v[188:191], v[72:75], v[40:43]
    v_pk_add_f32 v[84:85], v[4:5], v[12:13]
    v_pk_add_f32 v[86:87], v[6:7], v[14:15]
    v_pk_add_f32 v[88:89], v[8:9], v[16:17]
    v_pk_add_f32 v[90:91], v[10:11], v[18:19]
    s_cmp_eq_u32 s74, 0
    s_cbranch_scc1 wo_e_102
    s_bfe_u32 s71, s70, 0x10002
    s_cmp_lt_i32 s73, 0
    s_cselect_b32 s63, 0x5ffffff0, s69
    v_bfi_b32 v84, 1, s71, v84
    buffer_store_dwordx4 v[84:87], v123, s[8:11], s63 offen offset:0 sc1
    v_bfi_b32 v88, 1, s71, v88
    buffer_store_dwordx4 v[88:91], v123, s[8:11], s63 offen offset:1024 sc1
wo_e_102:
    s_waitcnt lgkmcnt(2)
    v_mfma_f32_16x16x32_bf16 v[28:31], v[192:195], v[44:47], v[28:31]
    ds_read_b128 v[60:63], v117 offset:36864
    v_mfma_f32_16x16x32_bf16 v[32:35], v[196:199], v[44:47], v[32:35]
    ds_read_b128 v[64:67], v117 offset:37120
    v_mfma_f32_16x16x32_bf16 v[36:39], v[192:195], v[48:51], v[36:39]
    v_mfma_f32_16x16x32_bf16 v[40:43], v[196:199], v[48:51], v[40:43]
    s_waitcnt lgkmcnt(2)
    v_mfma_f32_16x16x32_bf16 v[28:31], v[200:203], v[52:55], v[28:31]
    ds_read_b128 v[68:71], v117 offset:38912
    v_mfma_f32_16x16x32_bf16 v[32:35], v[204:207], v[52:55], v[32:35]
    ds_read_b128 v[72:75], v117 offset:39168
    v_mfma_f32_16x16x32_bf16 v[36:39], v[200:203], v[56:59], v[36:39]
    v_mfma_f32_16x16x32_bf16 v[40:43], v[204:207], v[56:59], v[40:43]
    s_waitcnt lgkmcnt(2)
    v_mfma_f32_16x16x32_bf16 v[28:31], v[208:211], v[60:63], v[28:31]
    ds_read_b128 v[44:47], v117 offset:40960
    v_mfma_f32_16x16x32_bf16 v[32:35], v[212:215], v[60:63], v[32:35]
    ds_read_b128 v[48:51], v117 offset:41216
    v_mfma_f32_16x16x32_bf16 v[36:39], v[208:211], v[64:67], v[36:39]
    s_add_u32 m0, s66, 32768
    s_nop 0
    buffer_load_dwordx4 v119, s[8:11], s64 offen offset:0 lds
    v_mfma_f32_16x16x32_bf16 v[40:43], v[212:215], v[64:67], v[40:43]
    s_waitcnt lgkmcnt(2)
    v_mfma_f32_16x16x32_bf16 v[28:31], v[216:219], v[68:71], v[28:31]
    ds_read_b128 v[52:55], v117 offset:43008
    v_mfma_f32_16x16x32_bf16 v[32:35], v[220:223], v[68:71], v[32:35]
    ds_read_b128 v[56:59], v117 offset:43264
    v_mfma_f32_16x16x32_bf16 v[36:39], v[216:219], v[72:75], v[36:39]
    buffer_load_dwordx4 v119, s[8:11], s64 offen offset:1024 lds
    v_mfma_f32_16x16x32_bf16 v[40:43], v[220:223], v[72:75], v[40:43]
    s_waitcnt lgkmcnt(2)
    v_mfma_f32_16x16x32_bf16 v[28:31], v[224:227], v[44:47], v[28:31]
    ds_read_b128 v[60:63], v117 offset:45056
    v_mfma_f32_16x16x32_bf16 v[32:35], v[228:231], v[44:47], v[32:35]
    ds_read_b128 v[64:67], v117 offset:45312
    v_mfma_f32_16x16x32_bf16 v[36:39], v[224:227], v[48:51], v[36:39]
    buffer_load_dwordx4 v119, s[8:11], s64 offen offset:2048 lds
    v_mfma_f32_16x16x32_bf16 v[40:43], v[228:231], v[48:51], v[40:43]
    s_waitcnt lgkmcnt(2)
    v_mfma_f32_16x16x32_bf16 v[28:31], v[232:235], v[52:55], v[28:31]
    ds_read_b128 v[68:71], v117 offset:47104
    v_mfma_f32_16x16x32_bf16 v[32:35], v[236:239], v[52:55], v[32:35]
    ds_read_b128 v[72:75], v117 offset:47360
    v_mfma_f32_16x16x32_bf16 v[36:39], v[232:235], v[56:59], v[36:39]
    buffer_load_dwordx4 v119, s[8:11], s64 offen offset:3072 lds
    s_add_u32 s64, s64, 4096
    v_mfma_f32_16x16x32_bf16 v[40:43], v[236:239], v[56:59], v[40:43]
    s_cmp_eq_u32 s74, 0
    s_cbranch_scc1 wo_w_103
    s_waitcnt vmcnt(6)
wo_w_103:
    s_waitcnt vmcnt(10)
    s_cmp_lg_u32 s58, 0
    s_cbranch_scc1 wo_v_104
    v_cmp_eq_u32 vcc, 0, v118
    s_nop 1
    v_mov_b32 v126, vcc_lo
    ds_write_b32 v127, v126
wo_v_104:
    s_waitcnt lgkmcnt(0)
    s_barrier
    v_mfma_f32_16x16x32_bf16 v[28:31], v[240:243], v[60:63], v[28:31]
    ds_read_b32 v126, v127
    ds_read_b128 v[44:47], v116 offset:0
    v_mfma_f32_16x16x32_bf16 v[32:35], v[244:247], v[60:63], v[32:35]
    ds_read_b128 v[48:51], v116 offset:256
    v_mfma_f32_16x16x32_bf16 v[36:39], v[240:243], v[64:67], v[36:39]
    v_mfma_f32_16x16x32_bf16 v[40:43], v[244:247], v[64:67], v[40:43]
    v_mfma_f32_16x16x32_bf16 v[28:31], v[248:251], v[68:71], v[28:31]
    ds_read_b128 v[52:55], v116 offset:2048
    v_mfma_f32_16x16x32_bf16 v[32:35], v[252:255], v[68:71], v[32:35]
    ds_read_b128 v[56:59], v116 offset:2304
    v_mfma_f32_16x16x32_bf16 v[36:39], v[248:251], v[72:75], v[36:39]
    v_mfma_f32_16x16x32_bf16 v[40:43], v[252:255], v[72:75], v[40:43]
    s_lshr_b32 s63, s67, 31
    s_or_b32 s63, s63, s74
    s_cbranch_scc1 wo_k_105
    s_waitcnt vmcnt(4)
    v_bitop3_b32 v2, v92, v96, s71 bitop3:0x7e
    v_bitop3_b32 v3, v100, v104, s71 bitop3:0x7e
    v_or_b32 v2, v2, v3
    v_bitop3_b32 v3, v108, v112, s71 bitop3:0x7e
    v_bitop3_b32 v2, v2, v3, 1 bitop3:0xa8
    v_cmp_ne_u32 vcc, 0, v2
    s_cbranch_vccz pollpart_ok_108
pollpart_107:
    buffer_load_dwordx4 v[92:95], v124, s[8:11], s2 offen offset:0 sc1
    buffer_load_dwordx4 v[96:99], v124, s[8:11], s2 offen offset:1024 sc1
    buffer_load_dwordx4 v[100:103], v124, s[8:11], s3 offen offset:0 sc1
    buffer_load_dwordx4 v[104:107], v124, s[8:11], s3 offen offset:1024 sc1
    buffer_load_dwordx4 v[108:111], v124, s[8:11], s4 offen offset:0 sc1
    buffer_load_dwordx4 v[112:115], v124, s[8:11], s4 offen offset:1024 sc1
    s_waitcnt vmcnt(0)
    v_bitop3_b32 v2, v92, v96, s71 bitop3:0x7e
    v_bitop3_b32 v3, v100, v104, s71 bitop3:0x7e
    v_or_b32 v2, v2, v3
    v_bitop3_b32 v3, v108, v112, s71 bitop3:0x7e
    v_bitop3_b32 v2, v2, v3, 1 bitop3:0xa8
    v_cmp_ne_u32 vcc, 0, v2
    s_cbranch_vccz pollpart_ok_108
    s_sub_u32 s77, s77, 1
    s_cbranch_scc0 pollpart_107
    s_mov_b32 s77, 0
pollpart_ok_108:
    v_pk_add_f32 v[76:77], v[76:77], v[92:93]
    v_pk_add_f32 v[100:101], v[100:101], v[108:109]
    v_pk_add_f32 v[76:77], v[76:77], v[100:101]
    v_cvt_pk_bf16_f32 v92, v76, v77
    v_pk_add_f32 v[78:79], v[78:79], v[94:95]
    v_pk_add_f32 v[102:103], v[102:103], v[110:111]
    v_pk_add_f32 v[78:79], v[78:79], v[102:103]
    v_cvt_pk_bf16_f32 v93, v78, v79
    v_pk_add_f32 v[80:81], v[80:81], v[96:97]
    v_pk_add_f32 v[104:105], v[104:105], v[112:113]
    v_pk_add_f32 v[80:81], v[80:81], v[104:105]
    v_cvt_pk_bf16_f32 v94, v80, v81
    v_pk_add_f32 v[82:83], v[82:83], v[98:99]
    v_pk_add_f32 v[106:107], v[106:107], v[114:115]
    v_pk_add_f32 v[82:83], v[82:83], v[106:107]
    v_cvt_pk_bf16_f32 v95, v82, v83
    buffer_store_dwordx4 v[92:95], v122, s[16:19], s67 offen offset:2048
wo_k_105:
    s_cmp_lt_i32 s73, 0
    s_cbranch_scc1 wo_e_106
    s_bfe_u32 s71, s70, 0x10002
    s_add_u32 s70, s70, 1
    v_pk_mov_b32 v[76:77], v[84:85], v[84:85] op_sel:[0,1]
    v_pk_mov_b32 v[78:79], v[86:87], v[86:87] op_sel:[0,1]
    v_pk_mov_b32 v[80:81], v[88:89], v[88:89] op_sel:[0,1]
    v_pk_mov_b32 v[82:83], v[90:91], v[90:91] op_sel:[0,1]
    v_mov_b32 v124, v123
    s_lshl_b32 s67, s73, 17
    s_add_u32 s67, s67, s7
    v_add_u32 v123, 0x80000, v123
    v_and_b32 v123, 0x1fffff, v123
wo_e_106:
    s_cmp_eq_u32 s68, 0
    s_cbranch_scc1 wo_loop_82
    s_cmp_ge_i32 s62, 0
    s_cbranch_scc1 wo_slow_81
    v_mov_b32 v12, v28
    v_mov_b32 v13, v29
    v_mov_b32 v14, v30
    v_mov_b32 v15, v31
    v_mov_b32 v16, v32
    v_mov_b32 v17, v33
    v_mov_b32 v18, v34
    v_mov_b32 v19, v35
    v_mov_b32 v20, v36
    v_mov_b32 v21, v37
    v_mov_b32 v22, v38
    v_mov_b32 v23, v39
    v_mov_b32 v24, v40
    v_mov_b32 v25, v41
    v_mov_b32 v26, v42
    v_mov_b32 v27, v43
    s_branch wo_f0_84
wo_fl_83:
    s_cmp_lt_i32 s62, 0
    s_cbranch_scc1 wo_f0_84
    s_lshl_b32 s63, s58, 2
    s_add_u32 s65, s65, s63
pollfl_109:
    buffer_load_dword v118, off, s[8:11], s65 sc1
    s_waitcnt vmcnt(0)
    v_cmp_eq_u32 vcc, 0, v118
    s_cbranch_vccz pollfl_ok_110
    s_sub_u32 s77, s77, 1
    s_cbranch_scc0 pollfl_109
    s_mov_b32 s77, 0
pollfl_ok_110:
    s_mov_b32 s72, s62
    s_lshl_b32 s64, s62, 18
    s_add_u32 s64, s64, s5
    s_ff1_i32_b64 s62, s[60:61]
    s_bitset0_b64 s[60:61], s62
    s_lshl_b32 s65, s62, 9
    s_add_u32 s65, s65, s6
    s_add_u32 m0, s66, 65536
    s_nop 0
    buffer_load_dwordx4 v119, s[8:11], s64 offen offset:0 lds
    buffer_load_dwordx4 v119, s[8:11], s64 offen offset:1024 lds
    buffer_load_dwordx4 v119, s[8:11], s64 offen offset:2048 lds
    buffer_load_dwordx4 v119, s[8:11], s64 offen offset:3072 lds
    s_add_u32 s64, s64, 4096
    buffer_load_dword v118, v125, s[8:11], s65 offen sc1
    s_add_u32 m0, s66, 98304
    s_nop 0
    buffer_load_dwordx4 v119, s[8:11], s64 offen offset:0 lds
    buffer_load_dwordx4 v119, s[8:11], s64 offen offset:1024 lds
    buffer_load_dwordx4 v119, s[8:11], s64 offen offset:2048 lds
    buffer_load_dwordx4 v119, s[8:11], s64 offen offset:3072 lds
    s_add_u32 s64, s64, 4096
    s_waitcnt vmcnt(4)
    s_cmp_lg_u32 s58, 0
    s_cbranch_scc1 wo_v_111
    v_cmp_eq_u32 vcc, 0, v118
    s_nop 1
    v_mov_b32 v126, vcc_lo
    ds_write_b32 v127, v126
wo_v_111:
    s_waitcnt lgkmcnt(0)
    s_barrier
    ds_read_b32 v126, v127
    ds_read_b128 v[44:47], v117 offset:0
    ds_read_b128 v[48:51], v117 offset:256
    ds_read_b128 v[52:55], v117 offset:2048
    ds_read_b128 v[56:59], v117 offset:2304
    s_branch wo_out_85
wo_f0_84:
    ds_write_b128 v120, v[20:23] offset:0
    ds_write_b128 v120, v[24:27] offset:1024
    s_mov_b32 s73, s59
    s_cmp_eq_u32 s74, 0
    s_cbranch_scc0 wo_o_112
    buffer_load_dwordx4 v[92:95], v124, s[8:11], s2 offen offset:0 sc1
    buffer_load_dwordx4 v[96:99], v124, s[8:11], s2 offen offset:1024 sc1
    buffer_load_dwordx4 v[100:103], v124, s[8:11], s3 offen offset:0 sc1
    buffer_load_dwordx4 v[104:107], v124, s[8:11], s3 offen offset:1024 sc1
    buffer_load_dwordx4 v[108:111], v124, s[8:11], s4 offen offset:0 sc1
    buffer_load_dwordx4 v[112:115], v124, s[8:11], s4 offen offset:1024 sc1
wo_o_112:
    s_waitcnt lgkmcnt(0)
    s_barrier
    ds_read_b128 v[4:7], v121 offset:0
    ds_read_b128 v[8:11], v121 offset:1024
    s_waitcnt lgkmcnt(0)
    v_pk_add_f32 v[84:85], v[4:5], v[12:13]
    v_pk_add_f32 v[86:87], v[6:7], v[14:15]
    v_pk_add_f32 v[88:89], v[8:9], v[16:17]
    v_pk_add_f32 v[90:91], v[10:11], v[18:19]
    s_cmp_eq_u32 s74, 0
    s_cbranch_scc1 wo_e_113
    s_bfe_u32 s71, s70, 0x10002
    s_cmp_lt_i32 s73, 0
    s_cselect_b32 s63, 0x5ffffff0, s69
    v_bfi_b32 v84, 1, s71, v84
    buffer_store_dwordx4 v[84:87], v123, s[8:11], s63 offen offset:0 sc1
    v_bfi_b32 v88, 1, s71, v88
    buffer_store_dwordx4 v[88:91], v123, s[8:11], s63 offen offset:1024 sc1
wo_e_113:
    s_lshr_b32 s63, s67, 31
    s_or_b32 s63, s63, s74
    s_cbranch_scc1 wo_k_114
    s_waitcnt vmcnt(0)
    v_bitop3_b32 v2, v92, v96, s71 bitop3:0x7e
    v_bitop3_b32 v3, v100, v104, s71 bitop3:0x7e
    v_or_b32 v2, v2, v3
    v_bitop3_b32 v3, v108, v112, s71 bitop3:0x7e
    v_bitop3_b32 v2, v2, v3, 1 bitop3:0xa8
    v_cmp_ne_u32 vcc, 0, v2
    s_cbranch_vccz pollpart_ok_117
pollpart_116:
    buffer_load_dwordx4 v[92:95], v124, s[8:11], s2 offen offset:0 sc1
    buffer_load_dwordx4 v[96:99], v124, s[8:11], s2 offen offset:1024 sc1
    buffer_load_dwordx4 v[100:103], v124, s[8:11], s3 offen offset:0 sc1
    buffer_load_dwordx4 v[104:107], v124, s[8:11], s3 offen offset:1024 sc1
    buffer_load_dwordx4 v[108:111], v124, s[8:11], s4 offen offset:0 sc1
    buffer_load_dwordx4 v[112:115], v124, s[8:11], s4 offen offset:1024 sc1
    s_waitcnt vmcnt(0)
    v_bitop3_b32 v2, v92, v96, s71 bitop3:0x7e
    v_bitop3_b32 v3, v100, v104, s71 bitop3:0x7e
    v_or_b32 v2, v2, v3
    v_bitop3_b32 v3, v108, v112, s71 bitop3:0x7e
    v_bitop3_b32 v2, v2, v3, 1 bitop3:0xa8
    v_cmp_ne_u32 vcc, 0, v2
    s_cbranch_vccz pollpart_ok_117
    s_sub_u32 s77, s77, 1
    s_cbranch_scc0 pollpart_116
    s_mov_b32 s77, 0
pollpart_ok_117:
    v_pk_add_f32 v[76:77], v[76:77], v[92:93]
    v_pk_add_f32 v[100:101], v[100:101], v[108:109]
    v_pk_add_f32 v[76:77], v[76:77], v[100:101]
    v_cvt_pk_bf16_f32 v92, v76, v77
    v_pk_add_f32 v[78:79], v[78:79], v[94:95]
    v_pk_add_f32 v[102:103], v[102:103], v[110:111]
    v_pk_add_f32 v[78:79], v[78:79], v[102:103]
    v_cvt_pk_bf16_f32 v93, v78, v79
    v_pk_add_f32 v[80:81], v[80:81], v[96:97]
    v_pk_add_f32 v[104:105], v[104:105], v[112:113]
    v_pk_add_f32 v[80:81], v[80:81], v[104:105]
    v_cvt_pk_bf16_f32 v94, v80, v81
    v_pk_add_f32 v[82:83], v[82:83], v[98:99]
    v_pk_add_f32 v[106:107], v[106:107], v[114:115]
    v_pk_add_f32 v[82:83], v[82:83], v[106:107]
    v_cvt_pk_bf16_f32 v95, v82, v83
    buffer_store_dwordx4 v[92:95], v122, s[16:19], s67 offen offset:2048
wo_k_114:
    s_cmp_lt_i32 s73, 0
    s_cbranch_scc1 wo_e_115
    s_bfe_u32 s71, s70, 0x10002
    s_add_u32 s70, s70, 1
    v_pk_mov_b32 v[76:77], v[84:85], v[84:85] op_sel:[0,1]
    v_pk_mov_b32 v[78:79], v[86:87], v[86:87] op_sel:[0,1]
    v_pk_mov_b32 v[80:81], v[88:89], v[88:89] op_sel:[0,1]
    v_pk_mov_b32 v[82:83], v[90:91], v[90:91] op_sel:[0,1]
    v_mov_b32 v124, v123
    s_lshl_b32 s67, s73, 17
    s_add_u32 s67, s67, s7
    v_add_u32 v123, 0x80000, v123
    v_and_b32 v123, 0x1fffff, v123
wo_e_115:
    s_cmp_eq_u32 s74, 0
    s_cbranch_scc0 wo_o_118
pollpart_119:
    buffer_load_dwordx4 v[92:95], v124, s[8:11], s2 offen offset:0 sc1
    buffer_load_dwordx4 v[96:99], v124, s[8:11], s2 offen offset:1024 sc1
    buffer_load_dwordx4 v[100:103], v124, s[8:11], s3 offen offset:0 sc1
    buffer_load_dwordx4 v[104:107], v124, s[8:11], s3 offen offset:1024 sc1
    buffer_load_dwordx4 v[108:111], v124, s[8:11], s4 offen offset:0 sc1
    buffer_load_dwordx4 v[112:115], v124, s[8:11], s4 offen offset:1024 sc1
    s_waitcnt vmcnt(0)
    v_bitop3_b32 v2, v92, v96, s71 bitop3:0x7e
    v_bitop3_b32 v3, v100, v104, s71 bitop3:0x7e
    v_or_b32 v2, v2, v3
    v_bitop3_b32 v3, v108, v112, s71 bitop3:0x7e
    v_bitop3_b32 v2, v2, v3, 1 bitop3:0xa8
    v_cmp_ne_u32 vcc, 0, v2
    s_cbranch_vccz pollpart_ok_120
    s_sub_u32 s77, s77, 1
    s_cbranch_scc0 pollpart_119
    s_mov_b32 s77, 0
pollpart_ok_120:
    v_pk_add_f32 v[76:77], v[76:77], v[92:93]
    v_pk_add_f32 v[100:101], v[100:101], v[108:109]
    v_pk_add_f32 v[76:77], v[76:77], v[100:101]
    v_cvt_pk_bf16_f32 v92, v76, v77
    v_pk_add_f32 v[78:79], v[78:79], v[94:95]
    v_pk_add_f32 v[102:103], v[102:103], v[110:111]
    v_pk_add_f32 v[78:79], v[78:79], v[102:103]
    v_cvt_pk_bf16_f32 v93, v78, v79
    v_pk_add_f32 v[80:81], v[80:81], v[96:97]
    v_pk_add_f32 v[104:105], v[104:105], v[112:113]
    v_pk_add_f32 v[80:81], v[80:81], v[104:105]
    v_cvt_pk_bf16_f32 v94, v80, v81
    v_pk_add_f32 v[82:83], v[82:83], v[98:99]
    v_pk_add_f32 v[106:107], v[106:107], v[114:115]
    v_pk_add_f32 v[82:83], v[82:83], v[106:107]
    v_cvt_pk_bf16_f32 v95, v82, v83
    buffer_store_dwordx4 v[92:95], v122, s[16:19], s67 offen offset:2048
wo_o_118:
    s_branch end_61
fft_52:
    s_mov_b64 s[60:61], s[44:45]
    s_mov_b32 s62, 0x400000
    s_mov_b32 s63, 0x20000
    s_mov_b32 s81, 0x5400000
    s_mov_b32 s83, 48
    s_mov_b32 s6, 0x10000
    s_mov_b32 s7, 0
    s_branch gen_60
col_59:
    s_waitcnt vmcnt(0) lgkmcnt(0)
    s_barrier
    s_cmp_lg_u32 s58, 0
    s_cbranch_scc1 sig_121
    v_mov_b32 v75, 0x5ffffff0
    v_mov_b32 v76, 40
    v_cmp_eq_u32 vcc, 0, v1
    s_nop 1
    v_cndmask_b32 v76, v75, v76, vcc
    v_mov_b32 v75, 1
    buffer_atomic_add v75, v76, s[12:15], 0 offen sc1
sig_121:
    s_bfe_u32 s79, s76, 0x30000
    s_bfe_u32 s85, s76, 0x20005
    s_lshl_b32 s85, s85, 3
    s_or_b32 s79, s79, s85
    v_bfe_u32 v231, v1, 0, 5
    v_bfe_u32 v235, v1, 5, 1
    v_lshl_or_b32 v231, v235, 7, v231
    v_mul_u32_u24 v231, 1026, v231
    v_and_b32 v231, -4, v231
    s_mul_i32 s5, s58, 262656
    s_lshl_b32 s2, s79, 5
    s_add_u32 s5, s5, s2
    buffer_load_dwordx4 v[84:87], v231, s[48:51], s5 offen
    buffer_load_dwordx4 v[88:91], v231, s[48:51], s5 offen offset:16
    buffer_load_dword v92, v231, s[48:51], s5 offen offset:32
    buffer_load_dwordx4 v[94:97], v231, s[52:55], s5 offen
    buffer_load_dwordx4 v[98:101], v231, s[52:55], s5 offen offset:16
    buffer_load_dword v102, v231, s[52:55], s5 offen offset:32
    s_add_u32 s5, s5, 32832
    buffer_load_dwordx4 v[104:107], v231, s[48:51], s5 offen
    buffer_load_dwordx4 v[108:111], v231, s[48:51], s5 offen offset:16
    buffer_load_dword v112, v231, s[48:51], s5 offen offset:32
    buffer_load_dwordx4 v[114:117], v231, s[52:55], s5 offen
    buffer_load_dwordx4 v[118:121], v231, s[52:55], s5 offen offset:16
    buffer_load_dword v122, v231, s[52:55], s5 offen offset:32
    s_add_u32 s5, s5, 32832
    buffer_load_dwordx4 v[124:127], v231, s[48:51], s5 offen
    buffer_load_dwordx4 v[128:131], v231, s[48:51], s5 offen offset:16
    buffer_load_dword v132, v231, s[48:51], s5 offen offset:32
    buffer_load_dwordx4 v[134:137], v231, s[52:55], s5 offen
    buffer_load_dwordx4 v[138:141], v231, s[52:55], s5 offen offset:16
    buffer_load_dword v142, v231, s[52:55], s5 offen offset:32
    s_add_u32 s5, s5, 32832
    buffer_load_dwordx4 v[144:147], v231, s[48:51], s5 offen
    buffer_load_dwordx4 v[148:151], v231, s[48:51], s5 offen offset:16
    buffer_load_dword v152, v231, s[48:51], s5 offen offset:32
    buffer_load_dwordx4 v[154:157], v231, s[52:55], s5 offen
    buffer_load_dwordx4 v[158:161], v231, s[52:55], s5 offen offset:16
    buffer_load_dword v162, v231, s[52:55], s5 offen offset:32
    s_add_u32 s5, s5, 32832
    v_and_b32 v235, 31, v1
    v_cvt_f32_u32 v228, v235
    v_and_b32 v235, 32, v1
    v_cvt_f32_u32 v235, v235
    v_mul_f32 v229, v228, v235
    v_mul_f32 v229, 0x3b000000, v229
    v_mul_f32 v234, 0x3d000000, v229
    v_fmamk_f32 v230, v235, 0x3b000000, v234
    v_and_b32 v233, 1, v1
    v_lshlrev_b32 v232, 4, v233
    v_mul_u32_u24 v233, 0x8000, v233
    v_lshl_or_b32 v233, v233, 16, v233
    v_fmamk_f32 v243, v228, 0x0, v229
    v_add_f32 v244, v243, v243
    v_cos_f32 v235, v243
    v_sin_f32 v237, v243
    v_cos_f32 v239, v244
    v_sin_f32 v241, v244
    v_fmamk_f32 v243, v228, 0x3c800000, v229
    v_add_f32 v244, v243, v243
    v_cos_f32 v236, v243
    v_sin_f32 v238, v243
    v_cos_f32 v240, v244
    v_sin_f32 v242, v244
    v_cvt_pk_bf16_f32 v4, v235, v236
    v_cvt_pk_bf16_f32 v36, v237, v238
    v_cvt_pk_bf16_f32 v68, v239, v240
    v_cvt_pk_bf16_f32 v76, v241, v242
    v_fmamk_f32 v243, v228, 0x3d000000, v229
    v_add_f32 v244, v243, v243
    v_cos_f32 v235, v243
    v_sin_f32 v237, v243
    v_cos_f32 v239, v244
    v_sin_f32 v241, v244
    v_fmamk_f32 v243, v228, 0x3d400000, v229
    v_add_f32 v244, v243, v243
    v_cos_f32 v236, v243
    v_sin_f32 v238, v243
    v_cos_f32 v240, v244
    v_sin_f32 v242, v244
    v_cvt_pk_bf16_f32 v5, v235, v236
    v_cvt_pk_bf16_f32 v37, v237, v238
    v_cvt_pk_bf16_f32 v69, v239, v240
    v_cvt_pk_bf16_f32 v77, v241, v242
    v_fmamk_f32 v243, v228, 0x3e000000, v229
    v_add_f32 v244, v243, v243
    v_cos_f32 v235, v243
    v_sin_f32 v237, v243
    v_cos_f32 v239, v244
    v_sin_f32 v241, v244
    v_fmamk_f32 v243, v228, 0x3e100000, v229
    v_add_f32 v244, v243, v243
    v_cos_f32 v236, v243
    v_sin_f32 v238, v243
    v_cos_f32 v240, v244
    v_sin_f32 v242, v244
    v_cvt_pk_bf16_f32 v6, v235, v236
    v_cvt_pk_bf16_f32 v38, v237, v238
    v_cvt_pk_bf16_f32 v70, v239, v240
    v_cvt_pk_bf16_f32 v78, v241, v242
    v_fmamk_f32 v243, v228, 0x3e200000, v229
    v_add_f32 v244, v243, v243
    v_cos_f32 v235, v243
    v_sin_f32 v237, v243
    v_cos_f32 v239, v244
    v_sin_f32 v241, v244
    v_fmamk_f32 v243, v228, 0x3e300000, v229
    v_add_f32 v244, v243, v243
    v_cos_f32 v236, v243
    v_sin_f32 v238, v243
    v_cos_f32 v240, v244
    v_sin_f32 v242, v244
    v_cvt_pk_bf16_f32 v7, v235, v236
    v_cvt_pk_bf16_f32 v39, v237, v238
    v_cvt_pk_bf16_f32 v71, v239, v240
    v_cvt_pk_bf16_f32 v79, v241, v242
    v_fmamk_f32 v243, v228, 0x3e800000, v229
    v_add_f32 v244, v243, v243
    v_cos_f32 v235, v243
    v_sin_f32 v237, v243
    v_cos_f32 v239, v244
    v_sin_f32 v241, v244
    v_fmamk_f32 v243, v228, 0x3e880000, v229
    v_add_f32 v244, v243, v243
    v_cos_f32 v236, v243
    v_sin_f32 v238, v243
    v_cos_f32 v240, v244
    v_sin_f32 v242, v244
    v_cvt_pk_bf16_f32 v8, v235, v236
    v_cvt_pk_bf16_f32 v40, v237, v238
    v_cvt_pk_bf16_f32 v72, v239, v240
    v_cvt_pk_bf16_f32 v80, v241, v242
    v_fmamk_f32 v243, v228, 0x3e900000, v229
    v_add_f32 v244, v243, v243
    v_cos_f32 v235, v243
    v_sin_f32 v237, v243
    v_cos_f32 v239, v244
    v_sin_f32 v241, v244
    v_fmamk_f32 v243, v228, 0x3e980000, v229
    v_add_f32 v244, v243, v243
    v_cos_f32 v236, v243
    v_sin_f32 v238, v243
    v_cos_f32 v240, v244
    v_sin_f32 v242, v244
    v_cvt_pk_bf16_f32 v9, v235, v236
    v_cvt_pk_bf16_f32 v41, v237, v238
    v_cvt_pk_bf16_f32 v73, v239, v240
    v_cvt_pk_bf16_f32 v81, v241, v242
    v_fmamk_f32 v243, v228, 0x3ec00000, v229
    v_add_f32 v244, v243, v243
    v_cos_f32 v235, v243
    v_sin_f32 v237, v243
    v_cos_f32 v239, v244
    v_sin_f32 v241, v244
    v_fmamk_f32 v243, v228, 0x3ec80000, v229
    v_add_f32 v244, v243, v243
    v_cos_f32 v236, v243
    v_sin_f32 v238, v243
    v_cos_f32 v240, v244
    v_sin_f32 v242, v244
    v_cvt_pk_bf16_f32 v10, v235, v236
    v_cvt_pk_bf16_f32 v42, v237, v238
    v_cvt_pk_bf16_f32 v74, v239, v240
    v_cvt_pk_bf16_f32 v82, v241, v242
    v_fmamk_f32 v243, v228, 0x3ed00000, v229
    v_add_f32 v244, v243, v243
    v_cos_f32 v235, v243
    v_sin_f32 v237, v243
    v_cos_f32 v239, v244
    v_sin_f32 v241, v244
    v_fmamk_f32 v243, v228, 0x3ed80000, v229
    v_add_f32 v244, v243, v243
    v_cos_f32 v236, v243
    v_sin_f32 v238, v243
    v_cos_f32 v240, v244
    v_sin_f32 v242, v244
    v_cvt_pk_bf16_f32 v11, v235, v236
    v_cvt_pk_bf16_f32 v43, v237, v238
    v_cvt_pk_bf16_f32 v75, v239, v240
    v_cvt_pk_bf16_f32 v83, v241, v242
    v_xor_b32 v12, v233, v4
    v_xor_b32 v13, v233, v5
    v_xor_b32 v14, v233, v6
    v_xor_b32 v15, v233, v7
    v_xor_b32 v16, v233, v8
    v_xor_b32 v17, v233, v9
    v_xor_b32 v18, v233, v10
    v_xor_b32 v19, v233, v11
    v_xor_b32 v20, 0x80000000, v4
    v_xor_b32 v21, 0x80000000, v5
    v_xor_b32 v22, 0x80000000, v6
    v_xor_b32 v23, 0x80000000, v7
    v_xor_b32 v24, 0x80000000, v8
    v_xor_b32 v25, 0x80000000, v9
    v_xor_b32 v26, 0x80000000, v10
    v_xor_b32 v27, 0x80000000, v11
    v_xor_b32 v28, 0x80000000, v12
    v_xor_b32 v29, 0x80000000, v13
    v_xor_b32 v30, 0x80000000, v14
    v_xor_b32 v31, 0x80000000, v15
    v_xor_b32 v32, 0x80000000, v16
    v_xor_b32 v33, 0x80000000, v17
    v_xor_b32 v34, 0x80000000, v18
    v_xor_b32 v35, 0x80000000, v19
    v_xor_b32 v44, v233, v36
    v_xor_b32 v45, v233, v37
    v_xor_b32 v46, v233, v38
    v_xor_b32 v47, v233, v39
    v_xor_b32 v48, v233, v40
    v_xor_b32 v49, v233, v41
    v_xor_b32 v50, v233, v42
    v_xor_b32 v51, v233, v43
    v_xor_b32 v52, 0x80000000, v36
    v_xor_b32 v53, 0x80000000, v37
    v_xor_b32 v54, 0x80000000, v38
    v_xor_b32 v55, 0x80000000, v39
    v_xor_b32 v56, 0x80000000, v40
    v_xor_b32 v57, 0x80000000, v41
    v_xor_b32 v58, 0x80000000, v42
    v_xor_b32 v59, 0x80000000, v43
    v_xor_b32 v60, 0x80000000, v44
    v_xor_b32 v61, 0x80000000, v45
    v_xor_b32 v62, 0x80000000, v46
    v_xor_b32 v63, 0x80000000, v47
    v_xor_b32 v64, 0x80000000, v48
    v_xor_b32 v65, 0x80000000, v49
    v_xor_b32 v66, 0x80000000, v50
    v_xor_b32 v67, 0x80000000, v51
    s_mov_b32 s2, 0x05040100
    s_mov_b32 s3, 0x07060302
    s_lshl_b32 s5, s58, 10
    v_lshl_add_u32 v231, v1, 4, s5
    v_add_u32 v233, 0x10000, v231
    v_add_u32 v235, 0x20000, v231
    s_waitcnt vmcnt(0)
    v_alignbit_b32 v84, v85, v84, v232
    v_alignbit_b32 v94, v95, v94, v232
    v_alignbit_b32 v104, v105, v104, v232
    v_alignbit_b32 v114, v115, v114, v232
    v_alignbit_b32 v124, v125, v124, v232
    v_alignbit_b32 v134, v135, v134, v232
    v_alignbit_b32 v144, v145, v144, v232
    v_alignbit_b32 v154, v155, v154, v232
    v_perm_b32 v196, v94, v84, s2
    v_perm_b32 v197, v114, v104, s2
    v_perm_b32 v198, v134, v124, s2
    v_perm_b32 v199, v154, v144, s2
    ds_write_b128 v231, v[196:199] offset:0
    v_perm_b32 v200, v94, v84, s3
    v_perm_b32 v201, v114, v104, s3
    v_perm_b32 v202, v134, v124, s3
    v_perm_b32 v203, v154, v144, s3
    ds_write_b128 v231, v[200:203] offset:8192
    v_alignbit_b32 v85, v86, v85, v232
    v_alignbit_b32 v95, v96, v95, v232
    v_alignbit_b32 v105, v106, v105, v232
    v_alignbit_b32 v115, v116, v115, v232
    v_alignbit_b32 v125, v126, v125, v232
    v_alignbit_b32 v135, v136, v135, v232
    v_alignbit_b32 v145, v146, v145, v232
    v_alignbit_b32 v155, v156, v155, v232
    v_perm_b32 v204, v95, v85, s2
    v_perm_b32 v205, v115, v105, s2
    v_perm_b32 v206, v135, v125, s2
    v_perm_b32 v207, v155, v145, s2
    ds_write_b128 v231, v[204:207] offset:16384
    v_perm_b32 v208, v95, v85, s3
    v_perm_b32 v209, v115, v105, s3
    v_perm_b32 v210, v135, v125, s3
    v_perm_b32 v211, v155, v145, s3
    ds_write_b128 v231, v[208:211] offset:24576
    v_alignbit_b32 v86, v87, v86, v232
    v_alignbit_b32 v96, v97, v96, v232
    v_alignbit_b32 v106, v107, v106, v232
    v_alignbit_b32 v116, v117, v116, v232
    v_alignbit_b32 v126, v127, v126, v232
    v_alignbit_b32 v136, v137, v136, v232
    v_alignbit_b32 v146, v147, v146, v232
    v_alignbit_b32 v156, v157, v156, v232
    v_perm_b32 v212, v96, v86, s2
    v_perm_b32 v213, v116, v106, s2
    v_perm_b32 v214, v136, v126, s2
    v_perm_b32 v215, v156, v146, s2
    ds_write_b128 v231, v[212:215] offset:32768
    v_perm_b32 v216, v96, v86, s3
    v_perm_b32 v217, v116, v106, s3
    v_perm_b32 v218, v136, v126, s3
    v_perm_b32 v219, v156, v146, s3
    ds_write_b128 v231, v[216:219] offset:40960
    v_alignbit_b32 v87, v88, v87, v232
    v_alignbit_b32 v97, v98, v97, v232
    v_alignbit_b32 v107, v108, v107, v232
    v_alignbit_b32 v117, v118, v117, v232
    v_alignbit_b32 v127, v128, v127, v232
    v_alignbit_b32 v137, v138, v137, v232
    v_alignbit_b32 v147, v148, v147, v232
    v_alignbit_b32 v157, v158, v157, v232
    v_perm_b32 v220, v97, v87, s2
    v_perm_b32 v221, v117, v107, s2
    v_perm_b32 v222, v137, v127, s2
    v_perm_b32 v223, v157, v147, s2
    ds_write_b128 v231, v[220:223] offset:49152
    v_perm_b32 v224, v97, v87, s3
    v_perm_b32 v225, v117, v107, s3
    v_perm_b32 v226, v137, v127, s3
    v_perm_b32 v227, v157, v147, s3
    ds_write_b128 v231, v[224:227] offset:57344
    v_alignbit_b32 v88, v89, v88, v232
    v_alignbit_b32 v98, v99, v98, v232
    v_alignbit_b32 v108, v109, v108, v232
    v_alignbit_b32 v118, v119, v118, v232
    v_alignbit_b32 v128, v129, v128, v232
    v_alignbit_b32 v138, v139, v138, v232
    v_alignbit_b32 v148, v149, v148, v232
    v_alignbit_b32 v158, v159, v158, v232
    v_perm_b32 v196, v98, v88, s2
    v_perm_b32 v197, v118, v108, s2
    v_perm_b32 v198, v138, v128, s2
    v_perm_b32 v199, v158, v148, s2
    ds_write_b128 v233, v[196:199] offset:0
    v_perm_b32 v200, v98, v88, s3
    v_perm_b32 v201, v118, v108, s3
    v_perm_b32 v202, v138, v128, s3
    v_perm_b32 v203, v158, v148, s3
    ds_write_b128 v233, v[200:203] offset:8192
    v_alignbit_b32 v89, v90, v89, v232
    v_alignbit_b32 v99, v100, v99, v232
    v_alignbit_b32 v109, v110, v109, v232
    v_alignbit_b32 v119, v120, v119, v232
    v_alignbit_b32 v129, v130, v129, v232
    v_alignbit_b32 v139, v140, v139, v232
    v_alignbit_b32 v149, v150, v149, v232
    v_alignbit_b32 v159, v160, v159, v232
    v_perm_b32 v204, v99, v89, s2
    v_perm_b32 v205, v119, v109, s2
    v_perm_b32 v206, v139, v129, s2
    v_perm_b32 v207, v159, v149, s2
    ds_write_b128 v233, v[204:207] offset:16384
    v_perm_b32 v208, v99, v89, s3
    v_perm_b32 v209, v119, v109, s3
    v_perm_b32 v210, v139, v129, s3
    v_perm_b32 v211, v159, v149, s3
    ds_write_b128 v233, v[208:211] offset:24576
    v_alignbit_b32 v90, v91, v90, v232
    v_alignbit_b32 v100, v101, v100, v232
    v_alignbit_b32 v110, v111, v110, v232
    v_alignbit_b32 v120, v121, v120, v232
    v_alignbit_b32 v130, v131, v130, v232
    v_alignbit_b32 v140, v141, v140, v232
    v_alignbit_b32 v150, v151, v150, v232
    v_alignbit_b32 v160, v161, v160, v232
    v_perm_b32 v212, v100, v90, s2
    v_perm_b32 v213, v120, v110, s2
    v_perm_b32 v214, v140, v130, s2
    v_perm_b32 v215, v160, v150, s2
    ds_write_b128 v233, v[212:215] offset:32768
    v_perm_b32 v216, v100, v90, s3
    v_perm_b32 v217, v120, v110, s3
    v_perm_b32 v218, v140, v130, s3
    v_perm_b32 v219, v160, v150, s3
    ds_write_b128 v233, v[216:219] offset:40960
    v_alignbit_b32 v91, v92, v91, v232
    v_alignbit_b32 v101, v102, v101, v232
    v_alignbit_b32 v111, v112, v111, v232
    v_alignbit_b32 v121, v122, v121, v232
    v_alignbit_b32 v131, v132, v131, v232
    v_alignbit_b32 v141, v142, v141, v232
    v_alignbit_b32 v151, v152, v151, v232
    v_alignbit_b32 v161, v162, v161, v232
    v_perm_b32 v220, v101, v91, s2
    v_perm_b32 v221, v121, v111, s2
    v_perm_b32 v222, v141, v131, s2
    v_perm_b32 v223, v161, v151, s2
    ds_write_b128 v233, v[220:223] offset:49152
    v_perm_b32 v224, v101, v91, s3
    v_perm_b32 v225, v121, v111, s3
    v_perm_b32 v226, v141, v131, s3
    v_perm_b32 v227, v161, v151, s3
    ds_write_b128 v233, v[224:227] offset:57344
    v_alignbit_b32 v92, v92, v92, v232
    v_alignbit_b32 v102, v102, v102, v232
    v_alignbit_b32 v112, v112, v112, v232
    v_alignbit_b32 v122, v122, v122, v232
    v_alignbit_b32 v132, v132, v132, v232
    v_alignbit_b32 v142, v142, v142, v232
    v_alignbit_b32 v152, v152, v152, v232
    v_alignbit_b32 v162, v162, v162, v232
    v_perm_b32 v196, v102, v92, s2
    v_perm_b32 v197, v122, v112, s2
    v_perm_b32 v198, v142, v132, s2
    v_perm_b32 v199, v162, v152, s2
    ds_write_b128 v235, v[196:199] offset:0
    s_waitcnt lgkmcnt(0)
    s_cmp_lg_u32 s58, 0
    s_cbranch_scc1 wall_122
    v_mov_b32 v236, 40
wctr_123:
    buffer_load_dword v235, v236, s[12:15], 0 offen sc1
    s_waitcnt vmcnt(0)
    v_cmp_gt_u16 vcc, 32, v235
    s_cbranch_vccz wctr_ok_124
    s_sub_u32 s77, s77, 1
    s_cbranch_scc0 wctr_123
    s_mov_b32 s77, 0
wctr_ok_124:
wall_122:
    s_barrier
    s_mov_b32 s7, s58
colloop_125:
    s_lshl_b32 s3, s79, 4
    s_add_u32 s3, s3, s7
    s_lshl_b32 s3, s3, 1
    s_cmp_eq_u32 s3, 1024
    s_cselect_b32 s3, 1, s3
    s_cmp_lt_u32 s3, 2
    s_cselect_b32 s6, 0x5ffffff0, 0
    s_mov_b32 s4, 0x35800000
    s_cselect_b32 s4, 0x35000000, s4
    v_bfe_u32 v231, v1, 0, 5
    v_lshlrev_b32 v231, 16, v231
    v_bfe_u32 v235, v1, 5, 1
    v_lshl_or_b32 v231, v235, 9, v231
    v_add_u32 v232, s6, v231
    s_bfe_u32 s5, s3, 0x50000
    s_lshl_b32 s5, s5, 4
    s_bfe_u32 s2, s3, 0x50005
    s_lshl_b32 s2, s2, 11
    s_or_b32 s5, s5, s2
    s_add_u32 s5, s5, 0x5400000
    buffer_load_dwordx4 v[84:87], v231, s[8:11], s5 offen offset:0
    buffer_load_dwordx4 v[100:103], v232, s[8:11], s5 offen offset:16
    buffer_load_dwordx4 v[88:91], v231, s[8:11], s5 offen offset:1024
    buffer_load_dwordx4 v[104:107], v232, s[8:11], s5 offen offset:1040
    s_add_u32 s5, s5, 2097152
    buffer_load_dwordx4 v[92:95], v231, s[8:11], s5 offen offset:0
    buffer_load_dwordx4 v[108:111], v232, s[8:11], s5 offen offset:16
    buffer_load_dwordx4 v[96:99], v231, s[8:11], s5 offen offset:1024
    buffer_load_dwordx4 v[112:115], v232, s[8:11], s5 offen offset:1040
    s_add_u32 s5, s5, 2097152
    s_lshl_b32 s5, s7, 13
    v_lshl_add_u32 v235, v1, 4, s5
    ds_read_b128 v[196:199], v235 offset:0
    ds_read_b128 v[200:203], v235 offset:1024
    ds_read_b128 v[204:207], v235 offset:2048
    ds_read_b128 v[208:211], v235 offset:3072
    ds_read_b128 v[212:215], v235 offset:4096
    ds_read_b128 v[216:219], v235 offset:5120
    ds_read_b128 v[220:223], v235 offset:6144
    ds_read_b128 v[224:227], v235 offset:7168
    v_and_b32 v236, 31, v1
    v_cvt_f32_u32 v228, v236
    v_mov_b32 v229, v234
    s_waitcnt vmcnt(0) lgkmcnt(0)
    v_xor_b32 v116, 0x80008000, v84
    v_xor_b32 v117, 0x80008000, v85
    v_xor_b32 v118, 0x80008000, v86
    v_xor_b32 v119, 0x80008000, v87
    v_xor_b32 v120, 0x80008000, v88
    v_xor_b32 v121, 0x80008000, v89
    v_xor_b32 v122, 0x80008000, v90
    v_xor_b32 v123, 0x80008000, v91
    v_xor_b32 v124, 0x80008000, v92
    v_xor_b32 v125, 0x80008000, v93
    v_xor_b32 v126, 0x80008000, v94
    v_xor_b32 v127, 0x80008000, v95
    v_xor_b32 v128, 0x80008000, v96
    v_xor_b32 v129, 0x80008000, v97
    v_xor_b32 v130, 0x80008000, v98
    v_xor_b32 v131, 0x80008000, v99
    v_mfma_f32_32x32x16_bf16 v[132:147], v[84:87], v[68:71], 0
    v_mfma_f32_32x32x16_bf16 v[164:179], v[100:103], v[68:71], 0
    v_mfma_f32_32x32x16_bf16 v[132:147], v[100:103], v[76:79], v[132:147]
    v_mfma_f32_32x32x16_bf16 v[164:179], v[116:119], v[76:79], v[164:179]
    v_mfma_f32_32x32x16_bf16 v[132:147], v[88:91], v[72:75], v[132:147]
    v_mfma_f32_32x32x16_bf16 v[164:179], v[104:107], v[72:75], v[164:179]
    v_mfma_f32_32x32x16_bf16 v[132:147], v[104:107], v[80:83], v[132:147]
    v_mfma_f32_32x32x16_bf16 v[164:179], v[120:123], v[80:83], v[164:179]
    v_mfma_f32_32x32x16_bf16 v[148:163], v[92:95], v[68:71], 0
    v_mfma_f32_32x32x16_bf16 v[180:195], v[108:111], v[68:71], 0
    v_mfma_f32_32x32x16_bf16 v[148:163], v[108:111], v[76:79], v[148:163]
    v_mfma_f32_32x32x16_bf16 v[180:195], v[124:127], v[76:79], v[180:195]
    v_mfma_f32_32x32x16_bf16 v[148:163], v[96:99], v[72:75], v[148:163]
    v_mfma_f32_32x32x16_bf16 v[180:195], v[112:115], v[72:75], v[180:195]
    v_mfma_f32_32x32x16_bf16 v[148:163], v[112:115], v[80:83], v[148:163]
    v_mfma_f32_32x32x16_bf16 v[180:195], v[128:131], v[80:83], v[180:195]
    v_fmamk_f32 v243, v228, 0x0, v229
    v_cos_f32 v239, v243
    v_sin_f32 v240, v243
    v_mul_f32 v239, s4, v239
    v_mul_f32 v240, s4, v240
    v_mul_f32 v235, v132, v239
    v_mul_f32 v237, v164, v239
    v_fma_f32 v235, v164, v240, v235
    v_fma_f32 v237, -v132, v240, v237
    v_fmamk_f32 v243, v228, 0x3a000000, v229
    v_cos_f32 v241, v243
    v_sin_f32 v242, v243
    v_mul_f32 v241, s4, v241
    v_mul_f32 v242, s4, v242
    v_mul_f32 v236, v133, v241
    v_mul_f32 v238, v165, v241
    v_fma_f32 v236, v165, v242, v236
    v_fma_f32 v238, -v133, v242, v238
    v_cvt_pk_bf16_f32 v84, v235, v236
    v_cvt_pk_bf16_f32 v100, v237, v238
    v_cvt_pk_bf16_f32 v116, -v235, -v236
    v_fmamk_f32 v243, v228, 0x3a800000, v229
    v_cos_f32 v239, v243
    v_sin_f32 v240, v243
    v_mul_f32 v239, s4, v239
    v_mul_f32 v240, s4, v240
    v_mul_f32 v235, v134, v239
    v_mul_f32 v237, v166, v239
    v_fma_f32 v235, v166, v240, v235
    v_fma_f32 v237, -v134, v240, v237
    v_fmamk_f32 v243, v228, 0x3ac00000, v229
    v_cos_f32 v241, v243
    v_sin_f32 v242, v243
    v_mul_f32 v241, s4, v241
    v_mul_f32 v242, s4, v242
    v_mul_f32 v236, v135, v241
    v_mul_f32 v238, v167, v241
    v_fma_f32 v236, v167, v242, v236
    v_fma_f32 v238, -v135, v242, v238
    v_cvt_pk_bf16_f32 v85, v235, v236
    v_cvt_pk_bf16_f32 v101, v237, v238
    v_cvt_pk_bf16_f32 v117, -v235, -v236
    v_fmamk_f32 v243, v228, 0x3b800000, v229
    v_cos_f32 v239, v243
    v_sin_f32 v240, v243
    v_mul_f32 v239, s4, v239
    v_mul_f32 v240, s4, v240
    v_mul_f32 v235, v136, v239
    v_mul_f32 v237, v168, v239
    v_fma_f32 v235, v168, v240, v235
    v_fma_f32 v237, -v136, v240, v237
    v_fmamk_f32 v243, v228, 0x3b900000, v229
    v_cos_f32 v241, v243
    v_sin_f32 v242, v243
    v_mul_f32 v241, s4, v241
    v_mul_f32 v242, s4, v242
    v_mul_f32 v236, v137, v241
    v_mul_f32 v238, v169, v241
    v_fma_f32 v236, v169, v242, v236
    v_fma_f32 v238, -v137, v242, v238
    v_cvt_pk_bf16_f32 v86, v235, v236
    v_cvt_pk_bf16_f32 v102, v237, v238
    v_cvt_pk_bf16_f32 v118, -v235, -v236
    v_fmamk_f32 v243, v228, 0x3ba00000, v229
    v_cos_f32 v239, v243
    v_sin_f32 v240, v243
    v_mul_f32 v239, s4, v239
    v_mul_f32 v240, s4, v240
    v_mul_f32 v235, v138, v239
    v_mul_f32 v237, v170, v239
    v_fma_f32 v235, v170, v240, v235
    v_fma_f32 v237, -v138, v240, v237
    v_fmamk_f32 v243, v228, 0x3bb00000, v229
    v_cos_f32 v241, v243
    v_sin_f32 v242, v243
    v_mul_f32 v241, s4, v241
    v_mul_f32 v242, s4, v242
    v_mul_f32 v236, v139, v241
    v_mul_f32 v238, v171, v241
    v_fma_f32 v236, v171, v242, v236
    v_fma_f32 v238, -v139, v242, v238
    v_cvt_pk_bf16_f32 v87, v235, v236
    v_cvt_pk_bf16_f32 v103, v237, v238
    v_cvt_pk_bf16_f32 v119, -v235, -v236
    v_fmamk_f32 v243, v228, 0x3c000000, v229
    v_cos_f32 v239, v243
    v_sin_f32 v240, v243
    v_mul_f32 v239, s4, v239
    v_mul_f32 v240, s4, v240
    v_mul_f32 v235, v140, v239
    v_mul_f32 v237, v172, v239
    v_fma_f32 v235, v172, v240, v235
    v_fma_f32 v237, -v140, v240, v237
    v_fmamk_f32 v243, v228, 0x3c080000, v229
    v_cos_f32 v241, v243
    v_sin_f32 v242, v243
    v_mul_f32 v241, s4, v241
    v_mul_f32 v242, s4, v242
    v_mul_f32 v236, v141, v241
    v_mul_f32 v238, v173, v241
    v_fma_f32 v236, v173, v242, v236
    v_fma_f32 v238, -v141, v242, v238
    v_cvt_pk_bf16_f32 v88, v235, v236
    v_cvt_pk_bf16_f32 v104, v237, v238
    v_cvt_pk_bf16_f32 v120, -v235, -v236
    v_fmamk_f32 v243, v228, 0x3c100000, v229
    v_cos_f32 v239, v243
    v_sin_f32 v240, v243
    v_mul_f32 v239, s4, v239
    v_mul_f32 v240, s4, v240
    v_mul_f32 v235, v142, v239
    v_mul_f32 v237, v174, v239
    v_fma_f32 v235, v174, v240, v235
    v_fma_f32 v237, -v142, v240, v237
    v_fmamk_f32 v243, v228, 0x3c180000, v229
    v_cos_f32 v241, v243
    v_sin_f32 v242, v243
    v_mul_f32 v241, s4, v241
    v_mul_f32 v242, s4, v242
    v_mul_f32 v236, v143, v241
    v_mul_f32 v238, v175, v241
    v_fma_f32 v236, v175, v242, v236
    v_fma_f32 v238, -v143, v242, v238
    v_cvt_pk_bf16_f32 v89, v235, v236
    v_cvt_pk_bf16_f32 v105, v237, v238
    v_cvt_pk_bf16_f32 v121, -v235, -v236
    v_fmamk_f32 v243, v228, 0x3c400000, v229
    v_cos_f32 v239, v243
    v_sin_f32 v240, v243
    v_mul_f32 v239, s4, v239
    v_mul_f32 v240, s4, v240
    v_mul_f32 v235, v144, v239
    v_mul_f32 v237, v176, v239
    v_fma_f32 v235, v176, v240, v235
    v_fma_f32 v237, -v144, v240, v237
    v_fmamk_f32 v243, v228, 0x3c480000, v229
    v_cos_f32 v241, v243
    v_sin_f32 v242, v243
    v_mul_f32 v241, s4, v241
    v_mul_f32 v242, s4, v242
    v_mul_f32 v236, v145, v241
    v_mul_f32 v238, v177, v241
    v_fma_f32 v236, v177, v242, v236
    v_fma_f32 v238, -v145, v242, v238
    v_cvt_pk_bf16_f32 v90, v235, v236
    v_cvt_pk_bf16_f32 v106, v237, v238
    v_cvt_pk_bf16_f32 v122, -v235, -v236
    v_fmamk_f32 v243, v228, 0x3c500000, v229
    v_cos_f32 v239, v243
    v_sin_f32 v240, v243
    v_mul_f32 v239, s4, v239
    v_mul_f32 v240, s4, v240
    v_mul_f32 v235, v146, v239
    v_mul_f32 v237, v178, v239
    v_fma_f32 v235, v178, v240, v235
    v_fma_f32 v237, -v146, v240, v237
    v_fmamk_f32 v243, v228, 0x3c580000, v229
    v_cos_f32 v241, v243
    v_sin_f32 v242, v243
    v_mul_f32 v241, s4, v241
    v_mul_f32 v242, s4, v242
    v_mul_f32 v236, v147, v241
    v_mul_f32 v238, v179, v241
    v_fma_f32 v236, v179, v242, v236
    v_fma_f32 v238, -v147, v242, v238
    v_cvt_pk_bf16_f32 v91, v235, v236
    v_cvt_pk_bf16_f32 v107, v237, v238
    v_cvt_pk_bf16_f32 v123, -v235, -v236
    v_fmamk_f32 v243, v228, 0x3c800000, v229
    v_cos_f32 v239, v243
    v_sin_f32 v240, v243
    v_mul_f32 v239, s4, v239
    v_mul_f32 v240, s4, v240
    v_mul_f32 v235, v148, v239
    v_mul_f32 v237, v180, v239
    v_fma_f32 v235, v180, v240, v235
    v_fma_f32 v237, -v148, v240, v237
    v_fmamk_f32 v243, v228, 0x3c840000, v229
    v_cos_f32 v241, v243
    v_sin_f32 v242, v243
    v_mul_f32 v241, s4, v241
    v_mul_f32 v242, s4, v242
    v_mul_f32 v236, v149, v241
    v_mul_f32 v238, v181, v241
    v_fma_f32 v236, v181, v242, v236
    v_fma_f32 v238, -v149, v242, v238
    v_cvt_pk_bf16_f32 v92, v235, v236
    v_cvt_pk_bf16_f32 v108, v237, v238
    v_cvt_pk_bf16_f32 v124, -v235, -v236
    v_fmamk_f32 v243, v228, 0x3c880000, v229
    v_cos_f32 v239, v243
    v_sin_f32 v240, v243
    v_mul_f32 v239, s4, v239
    v_mul_f32 v240, s4, v240
    v_mul_f32 v235, v150, v239
    v_mul_f32 v237, v182, v239
    v_fma_f32 v235, v182, v240, v235
    v_fma_f32 v237, -v150, v240, v237
    v_fmamk_f32 v243, v228, 0x3c8c0000, v229
    v_cos_f32 v241, v243
    v_sin_f32 v242, v243
    v_mul_f32 v241, s4, v241
    v_mul_f32 v242, s4, v242
    v_mul_f32 v236, v151, v241
    v_mul_f32 v238, v183, v241
    v_fma_f32 v236, v183, v242, v236
    v_fma_f32 v238, -v151, v242, v238
    v_cvt_pk_bf16_f32 v93, v235, v236
    v_cvt_pk_bf16_f32 v109, v237, v238
    v_cvt_pk_bf16_f32 v125, -v235, -v236
    v_fmamk_f32 v243, v228, 0x3ca00000, v229
    v_cos_f32 v239, v243
    v_sin_f32 v240, v243
    v_mul_f32 v239, s4, v239
    v_mul_f32 v240, s4, v240
    v_mul_f32 v235, v152, v239
    v_mul_f32 v237, v184, v239
    v_fma_f32 v235, v184, v240, v235
    v_fma_f32 v237, -v152, v240, v237
    v_fmamk_f32 v243, v228, 0x3ca40000, v229
    v_cos_f32 v241, v243
    v_sin_f32 v242, v243
    v_mul_f32 v241, s4, v241
    v_mul_f32 v242, s4, v242
    v_mul_f32 v236, v153, v241
    v_mul_f32 v238, v185, v241
    v_fma_f32 v236, v185, v242, v236
    v_fma_f32 v238, -v153, v242, v238
    v_cvt_pk_bf16_f32 v94, v235, v236
    v_cvt_pk_bf16_f32 v110, v237, v238
    v_cvt_pk_bf16_f32 v126, -v235, -v236
    v_fmamk_f32 v243, v228, 0x3ca80000, v229
    v_cos_f32 v239, v243
    v_sin_f32 v240, v243
    v_mul_f32 v239, s4, v239
    v_mul_f32 v240, s4, v240
    v_mul_f32 v235, v154, v239
    v_mul_f32 v237, v186, v239
    v_fma_f32 v235, v186, v240, v235
    v_fma_f32 v237, -v154, v240, v237
    v_fmamk_f32 v243, v228, 0x3cac0000, v229
    v_cos_f32 v241, v243
    v_sin_f32 v242, v243
    v_mul_f32 v241, s4, v241
    v_mul_f32 v242, s4, v242
    v_mul_f32 v236, v155, v241
    v_mul_f32 v238, v187, v241
    v_fma_f32 v236, v187, v242, v236
    v_fma_f32 v238, -v155, v242, v238
    v_cvt_pk_bf16_f32 v95, v235, v236
    v_cvt_pk_bf16_f32 v111, v237, v238
    v_cvt_pk_bf16_f32 v127, -v235, -v236
    v_fmamk_f32 v243, v228, 0x3cc00000, v229
    v_cos_f32 v239, v243
    v_sin_f32 v240, v243
    v_mul_f32 v239, s4, v239
    v_mul_f32 v240, s4, v240
    v_mul_f32 v235, v156, v239
    v_mul_f32 v237, v188, v239
    v_fma_f32 v235, v188, v240, v235
    v_fma_f32 v237, -v156, v240, v237
    v_fmamk_f32 v243, v228, 0x3cc40000, v229
    v_cos_f32 v241, v243
    v_sin_f32 v242, v243
    v_mul_f32 v241, s4, v241
    v_mul_f32 v242, s4, v242
    v_mul_f32 v236, v157, v241
    v_mul_f32 v238, v189, v241
    v_fma_f32 v236, v189, v242, v236
    v_fma_f32 v238, -v157, v242, v238
    v_cvt_pk_bf16_f32 v96, v235, v236
    v_cvt_pk_bf16_f32 v112, v237, v238
    v_cvt_pk_bf16_f32 v128, -v235, -v236
    v_fmamk_f32 v243, v228, 0x3cc80000, v229
    v_cos_f32 v239, v243
    v_sin_f32 v240, v243
    v_mul_f32 v239, s4, v239
    v_mul_f32 v240, s4, v240
    v_mul_f32 v235, v158, v239
    v_mul_f32 v237, v190, v239
    v_fma_f32 v235, v190, v240, v235
    v_fma_f32 v237, -v158, v240, v237
    v_fmamk_f32 v243, v228, 0x3ccc0000, v229
    v_cos_f32 v241, v243
    v_sin_f32 v242, v243
    v_mul_f32 v241, s4, v241
    v_mul_f32 v242, s4, v242
    v_mul_f32 v236, v159, v241
    v_mul_f32 v238, v191, v241
    v_fma_f32 v236, v191, v242, v236
    v_fma_f32 v238, -v159, v242, v238
    v_cvt_pk_bf16_f32 v97, v235, v236
    v_cvt_pk_bf16_f32 v113, v237, v238
    v_cvt_pk_bf16_f32 v129, -v235, -v236
    v_fmamk_f32 v243, v228, 0x3ce00000, v229
    v_cos_f32 v239, v243
    v_sin_f32 v240, v243
    v_mul_f32 v239, s4, v239
    v_mul_f32 v240, s4, v240
    v_mul_f32 v235, v160, v239
    v_mul_f32 v237, v192, v239
    v_fma_f32 v235, v192, v240, v235
    v_fma_f32 v237, -v160, v240, v237
    v_fmamk_f32 v243, v228, 0x3ce40000, v229
    v_cos_f32 v241, v243
    v_sin_f32 v242, v243
    v_mul_f32 v241, s4, v241
    v_mul_f32 v242, s4, v242
    v_mul_f32 v236, v161, v241
    v_mul_f32 v238, v193, v241
    v_fma_f32 v236, v193, v242, v236
    v_fma_f32 v238, -v161, v242, v238
    v_cvt_pk_bf16_f32 v98, v235, v236
    v_cvt_pk_bf16_f32 v114, v237, v238
    v_cvt_pk_bf16_f32 v130, -v235, -v236
    v_fmamk_f32 v243, v228, 0x3ce80000, v229
    v_cos_f32 v239, v243
    v_sin_f32 v240, v243
    v_mul_f32 v239, s4, v239
    v_mul_f32 v240, s4, v240
    v_mul_f32 v235, v162, v239
    v_mul_f32 v237, v194, v239
    v_fma_f32 v235, v194, v240, v235
    v_fma_f32 v237, -v162, v240, v237
    v_fmamk_f32 v243, v228, 0x3cec0000, v229
    v_cos_f32 v241, v243
    v_sin_f32 v242, v243
    v_mul_f32 v241, s4, v241
    v_mul_f32 v242, s4, v242
    v_mul_f32 v236, v163, v241
    v_mul_f32 v238, v195, v241
    v_fma_f32 v236, v195, v242, v236
    v_fma_f32 v238, -v163, v242, v238
    v_cvt_pk_bf16_f32 v99, v235, v236
    v_cvt_pk_bf16_f32 v115, v237, v238
    v_cvt_pk_bf16_f32 v131, -v235, -v236
    v_mfma_f32_32x32x16_bf16 v[132:147], v[4:7], v[84:87], 0
    v_mfma_f32_32x32x16_bf16 v[164:179], v[4:7], v[100:103], 0
    v_mfma_f32_32x32x16_bf16 v[132:147], v[36:39], v[100:103], v[132:147]
    v_mfma_f32_32x32x16_bf16 v[164:179], v[36:39], v[116:119], v[164:179]
    v_mfma_f32_32x32x16_bf16 v[132:147], v[8:11], v[88:91], v[132:147]
    v_mfma_f32_32x32x16_bf16 v[164:179], v[8:11], v[104:107], v[164:179]
    v_mfma_f32_32x32x16_bf16 v[132:147], v[40:43], v[104:107], v[132:147]
    v_mfma_f32_32x32x16_bf16 v[164:179], v[40:43], v[120:123], v[164:179]
    v_mfma_f32_32x32x16_bf16 v[132:147], v[12:15], v[92:95], v[132:147]
    v_mfma_f32_32x32x16_bf16 v[164:179], v[12:15], v[108:111], v[164:179]
    v_mfma_f32_32x32x16_bf16 v[132:147], v[44:47], v[108:111], v[132:147]
    v_mfma_f32_32x32x16_bf16 v[164:179], v[44:47], v[124:127], v[164:179]
    v_mfma_f32_32x32x16_bf16 v[132:147], v[16:19], v[96:99], v[132:147]
    v_mfma_f32_32x32x16_bf16 v[164:179], v[16:19], v[112:115], v[164:179]
    v_mfma_f32_32x32x16_bf16 v[132:147], v[48:51], v[112:115], v[132:147]
    v_mfma_f32_32x32x16_bf16 v[164:179], v[48:51], v[128:131], v[164:179]
    v_mfma_f32_32x32x16_bf16 v[148:163], v[20:23], v[84:87], 0
    v_mfma_f32_32x32x16_bf16 v[180:195], v[20:23], v[100:103], 0
    v_mfma_f32_32x32x16_bf16 v[148:163], v[52:55], v[100:103], v[148:163]
    v_mfma_f32_32x32x16_bf16 v[180:195], v[52:55], v[116:119], v[180:195]
    v_mfma_f32_32x32x16_bf16 v[148:163], v[24:27], v[88:91], v[148:163]
    v_mfma_f32_32x32x16_bf16 v[180:195], v[24:27], v[104:107], v[180:195]
    v_mfma_f32_32x32x16_bf16 v[148:163], v[56:59], v[104:107], v[148:163]
    v_mfma_f32_32x32x16_bf16 v[180:195], v[56:59], v[120:123], v[180:195]
    v_mfma_f32_32x32x16_bf16 v[148:163], v[28:31], v[92:95], v[148:163]
    v_mfma_f32_32x32x16_bf16 v[180:195], v[28:31], v[108:111], v[180:195]
    v_mfma_f32_32x32x16_bf16 v[148:163], v[60:63], v[108:111], v[148:163]
    v_mfma_f32_32x32x16_bf16 v[180:195], v[60:63], v[124:127], v[180:195]
    v_mfma_f32_32x32x16_bf16 v[148:163], v[32:35], v[96:99], v[148:163]
    v_mfma_f32_32x32x16_bf16 v[180:195], v[32:35], v[112:115], v[180:195]
    v_mfma_f32_32x32x16_bf16 v[148:163], v[64:67], v[112:115], v[148:163]
    v_mfma_f32_32x32x16_bf16 v[180:195], v[64:67], v[128:131], v[180:195]
    v_lshlrev_b32 v239, 16, v196
    v_and_b32 v240, 0xffff0000, v196
    v_mul_f32 v235, v132, v239
    v_mul_f32 v237, v164, v239
    v_fma_f32 v235, -v164, v240, v235
    v_fma_f32 v237, v132, v240, v237
    v_lshlrev_b32 v241, 16, v197
    v_and_b32 v242, 0xffff0000, v197
    v_mul_f32 v236, v133, v241
    v_mul_f32 v238, v165, v241
    v_fma_f32 v236, -v165, v242, v236
    v_fma_f32 v238, v133, v242, v238
    v_cvt_pk_bf16_f32 v84, v235, v236
    v_cvt_pk_bf16_f32 v100, v237, v238
    v_cvt_pk_bf16_f32 v116, -v237, -v238
    v_lshlrev_b32 v239, 16, v198
    v_and_b32 v240, 0xffff0000, v198
    v_mul_f32 v235, v134, v239
    v_mul_f32 v237, v166, v239
    v_fma_f32 v235, -v166, v240, v235
    v_fma_f32 v237, v134, v240, v237
    v_lshlrev_b32 v241, 16, v199
    v_and_b32 v242, 0xffff0000, v199
    v_mul_f32 v236, v135, v241
    v_mul_f32 v238, v167, v241
    v_fma_f32 v236, -v167, v242, v236
    v_fma_f32 v238, v135, v242, v238
    v_cvt_pk_bf16_f32 v85, v235, v236
    v_cvt_pk_bf16_f32 v101, v237, v238
    v_cvt_pk_bf16_f32 v117, -v237, -v238
    v_lshlrev_b32 v239, 16, v200
    v_and_b32 v240, 0xffff0000, v200
    v_mul_f32 v235, v136, v239
    v_mul_f32 v237, v168, v239
    v_fma_f32 v235, -v168, v240, v235
    v_fma_f32 v237, v136, v240, v237
    v_lshlrev_b32 v241, 16, v201
    v_and_b32 v242, 0xffff0000, v201
    v_mul_f32 v236, v137, v241
    v_mul_f32 v238, v169, v241
    v_fma_f32 v236, -v169, v242, v236
    v_fma_f32 v238, v137, v242, v238
    v_cvt_pk_bf16_f32 v86, v235, v236
    v_cvt_pk_bf16_f32 v102, v237, v238
    v_cvt_pk_bf16_f32 v118, -v237, -v238
    v_lshlrev_b32 v239, 16, v202
    v_and_b32 v240, 0xffff0000, v202
    v_mul_f32 v235, v138, v239
    v_mul_f32 v237, v170, v239
    v_fma_f32 v235, -v170, v240, v235
    v_fma_f32 v237, v138, v240, v237
    v_lshlrev_b32 v241, 16, v203
    v_and_b32 v242, 0xffff0000, v203
    v_mul_f32 v236, v139, v241
    v_mul_f32 v238, v171, v241
    v_fma_f32 v236, -v171, v242, v236
    v_fma_f32 v238, v139, v242, v238
    v_cvt_pk_bf16_f32 v87, v235, v236
    v_cvt_pk_bf16_f32 v103, v237, v238
    v_cvt_pk_bf16_f32 v119, -v237, -v238
    v_lshlrev_b32 v239, 16, v204
    v_and_b32 v240, 0xffff0000, v204
    v_mul_f32 v235, v140, v239
    v_mul_f32 v237, v172, v239
    v_fma_f32 v235, -v172, v240, v235
    v_fma_f32 v237, v140, v240, v237
    v_lshlrev_b32 v241, 16, v205
    v_and_b32 v242, 0xffff0000, v205
    v_mul_f32 v236, v141, v241
    v_mul_f32 v238, v173, v241
    v_fma_f32 v236, -v173, v242, v236
    v_fma_f32 v238, v141, v242, v238
    v_cvt_pk_bf16_f32 v88, v235, v236
    v_cvt_pk_bf16_f32 v104, v237, v238
    v_cvt_pk_bf16_f32 v120, -v237, -v238
    v_lshlrev_b32 v239, 16, v206
    v_and_b32 v240, 0xffff0000, v206
    v_mul_f32 v235, v142, v239
    v_mul_f32 v237, v174, v239
    v_fma_f32 v235, -v174, v240, v235
    v_fma_f32 v237, v142, v240, v237
    v_lshlrev_b32 v241, 16, v207
    v_and_b32 v242, 0xffff0000, v207
    v_mul_f32 v236, v143, v241
    v_mul_f32 v238, v175, v241
    v_fma_f32 v236, -v175, v242, v236
    v_fma_f32 v238, v143, v242, v238
    v_cvt_pk_bf16_f32 v89, v235, v236
    v_cvt_pk_bf16_f32 v105, v237, v238
    v_cvt_pk_bf16_f32 v121, -v237, -v238
    v_lshlrev_b32 v239, 16, v208
    v_and_b32 v240, 0xffff0000, v208
    v_mul_f32 v235, v144, v239
    v_mul_f32 v237, v176, v239
    v_fma_f32 v235, -v176, v240, v235
    v_fma_f32 v237, v144, v240, v237
    v_lshlrev_b32 v241, 16, v209
    v_and_b32 v242, 0xffff0000, v209
    v_mul_f32 v236, v145, v241
    v_mul_f32 v238, v177, v241
    v_fma_f32 v236, -v177, v242, v236
    v_fma_f32 v238, v145, v242, v238
    v_cvt_pk_bf16_f32 v90, v235, v236
    v_cvt_pk_bf16_f32 v106, v237, v238
    v_cvt_pk_bf16_f32 v122, -v237, -v238
    v_lshlrev_b32 v239, 16, v210
    v_and_b32 v240, 0xffff0000, v210
    v_mul_f32 v235, v146, v239
    v_mul_f32 v237, v178, v239
    v_fma_f32 v235, -v178, v240, v235
    v_fma_f32 v237, v146, v240, v237
    v_lshlrev_b32 v241, 16, v211
    v_and_b32 v242, 0xffff0000, v211
    v_mul_f32 v236, v147, v241
    v_mul_f32 v238, v179, v241
    v_fma_f32 v236, -v179, v242, v236
    v_fma_f32 v238, v147, v242, v238
    v_cvt_pk_bf16_f32 v91, v235, v236
    v_cvt_pk_bf16_f32 v107, v237, v238
    v_cvt_pk_bf16_f32 v123, -v237, -v238
    v_lshlrev_b32 v239, 16, v212
    v_and_b32 v240, 0xffff0000, v212
    v_mul_f32 v235, v148, v239
    v_mul_f32 v237, v180, v239
    v_fma_f32 v235, -v180, v240, v235
    v_fma_f32 v237, v148, v240, v237
    v_lshlrev_b32 v241, 16, v213
    v_and_b32 v242, 0xffff0000, v213
    v_mul_f32 v236, v149, v241
    v_mul_f32 v238, v181, v241
    v_fma_f32 v236, -v181, v242, v236
    v_fma_f32 v238, v149, v242, v238
    v_cvt_pk_bf16_f32 v92, v235, v236
    v_cvt_pk_bf16_f32 v108, v237, v238
    v_cvt_pk_bf16_f32 v124, -v237, -v238
    v_lshlrev_b32 v239, 16, v214
    v_and_b32 v240, 0xffff0000, v214
    v_mul_f32 v235, v150, v239
    v_mul_f32 v237, v182, v239
    v_fma_f32 v235, -v182, v240, v235
    v_fma_f32 v237, v150, v240, v237
    v_lshlrev_b32 v241, 16, v215
    v_and_b32 v242, 0xffff0000, v215
    v_mul_f32 v236, v151, v241
    v_mul_f32 v238, v183, v241
    v_fma_f32 v236, -v183, v242, v236
    v_fma_f32 v238, v151, v242, v238
    v_cvt_pk_bf16_f32 v93, v235, v236
    v_cvt_pk_bf16_f32 v109, v237, v238
    v_cvt_pk_bf16_f32 v125, -v237, -v238
    v_lshlrev_b32 v239, 16, v216
    v_and_b32 v240, 0xffff0000, v216
    v_mul_f32 v235, v152, v239
    v_mul_f32 v237, v184, v239
    v_fma_f32 v235, -v184, v240, v235
    v_fma_f32 v237, v152, v240, v237
    v_lshlrev_b32 v241, 16, v217
    v_and_b32 v242, 0xffff0000, v217
    v_mul_f32 v236, v153, v241
    v_mul_f32 v238, v185, v241
    v_fma_f32 v236, -v185, v242, v236
    v_fma_f32 v238, v153, v242, v238
    v_cvt_pk_bf16_f32 v94, v235, v236
    v_cvt_pk_bf16_f32 v110, v237, v238
    v_cvt_pk_bf16_f32 v126, -v237, -v238
    v_lshlrev_b32 v239, 16, v218
    v_and_b32 v240, 0xffff0000, v218
    v_mul_f32 v235, v154, v239
    v_mul_f32 v237, v186, v239
    v_fma_f32 v235, -v186, v240, v235
    v_fma_f32 v237, v154, v240, v237
    v_lshlrev_b32 v241, 16, v219
    v_and_b32 v242, 0xffff0000, v219
    v_mul_f32 v236, v155, v241
    v_mul_f32 v238, v187, v241
    v_fma_f32 v236, -v187, v242, v236
    v_fma_f32 v238, v155, v242, v238
    v_cvt_pk_bf16_f32 v95, v235, v236
    v_cvt_pk_bf16_f32 v111, v237, v238
    v_cvt_pk_bf16_f32 v127, -v237, -v238
    v_lshlrev_b32 v239, 16, v220
    v_and_b32 v240, 0xffff0000, v220
    v_mul_f32 v235, v156, v239
    v_mul_f32 v237, v188, v239
    v_fma_f32 v235, -v188, v240, v235
    v_fma_f32 v237, v156, v240, v237
    v_lshlrev_b32 v241, 16, v221
    v_and_b32 v242, 0xffff0000, v221
    v_mul_f32 v236, v157, v241
    v_mul_f32 v238, v189, v241
    v_fma_f32 v236, -v189, v242, v236
    v_fma_f32 v238, v157, v242, v238
    v_cvt_pk_bf16_f32 v96, v235, v236
    v_cvt_pk_bf16_f32 v112, v237, v238
    v_cvt_pk_bf16_f32 v128, -v237, -v238
    v_lshlrev_b32 v239, 16, v222
    v_and_b32 v240, 0xffff0000, v222
    v_mul_f32 v235, v158, v239
    v_mul_f32 v237, v190, v239
    v_fma_f32 v235, -v190, v240, v235
    v_fma_f32 v237, v158, v240, v237
    v_lshlrev_b32 v241, 16, v223
    v_and_b32 v242, 0xffff0000, v223
    v_mul_f32 v236, v159, v241
    v_mul_f32 v238, v191, v241
    v_fma_f32 v236, -v191, v242, v236
    v_fma_f32 v238, v159, v242, v238
    v_cvt_pk_bf16_f32 v97, v235, v236
    v_cvt_pk_bf16_f32 v113, v237, v238
    v_cvt_pk_bf16_f32 v129, -v237, -v238
    v_lshlrev_b32 v239, 16, v224
    v_and_b32 v240, 0xffff0000, v224
    v_mul_f32 v235, v160, v239
    v_mul_f32 v237, v192, v239
    v_fma_f32 v235, -v192, v240, v235
    v_fma_f32 v237, v160, v240, v237
    v_lshlrev_b32 v241, 16, v225
    v_and_b32 v242, 0xffff0000, v225
    v_mul_f32 v236, v161, v241
    v_mul_f32 v238, v193, v241
    v_fma_f32 v236, -v193, v242, v236
    v_fma_f32 v238, v161, v242, v238
    v_cvt_pk_bf16_f32 v98, v235, v236
    v_cvt_pk_bf16_f32 v114, v237, v238
    v_cvt_pk_bf16_f32 v130, -v237, -v238
    v_lshlrev_b32 v239, 16, v226
    v_and_b32 v240, 0xffff0000, v226
    v_mul_f32 v235, v162, v239
    v_mul_f32 v237, v194, v239
    v_fma_f32 v235, -v194, v240, v235
    v_fma_f32 v237, v162, v240, v237
    v_lshlrev_b32 v241, 16, v227
    v_and_b32 v242, 0xffff0000, v227
    v_mul_f32 v236, v163, v241
    v_mul_f32 v238, v195, v241
    v_fma_f32 v236, -v195, v242, v236
    v_fma_f32 v238, v163, v242, v238
    v_cvt_pk_bf16_f32 v99, v235, v236
    v_cvt_pk_bf16_f32 v115, v237, v238
    v_cvt_pk_bf16_f32 v131, -v237, -v238
    v_mfma_f32_32x32x16_bf16 v[132:147], v[84:87], v[4:7], 0
    v_mfma_f32_32x32x16_bf16 v[164:179], v[100:103], v[4:7], 0
    v_mfma_f32_32x32x16_bf16 v[132:147], v[116:119], v[36:39], v[132:147]
    v_mfma_f32_32x32x16_bf16 v[164:179], v[84:87], v[36:39], v[164:179]
    v_mfma_f32_32x32x16_bf16 v[132:147], v[88:91], v[8:11], v[132:147]
    v_mfma_f32_32x32x16_bf16 v[164:179], v[104:107], v[8:11], v[164:179]
    v_mfma_f32_32x32x16_bf16 v[132:147], v[120:123], v[40:43], v[132:147]
    v_mfma_f32_32x32x16_bf16 v[164:179], v[88:91], v[40:43], v[164:179]
    v_mfma_f32_32x32x16_bf16 v[132:147], v[92:95], v[12:15], v[132:147]
    v_mfma_f32_32x32x16_bf16 v[164:179], v[108:111], v[12:15], v[164:179]
    v_mfma_f32_32x32x16_bf16 v[132:147], v[124:127], v[44:47], v[132:147]
    v_mfma_f32_32x32x16_bf16 v[164:179], v[92:95], v[44:47], v[164:179]
    v_mfma_f32_32x32x16_bf16 v[132:147], v[96:99], v[16:19], v[132:147]
    v_mfma_f32_32x32x16_bf16 v[164:179], v[112:115], v[16:19], v[164:179]
    v_mfma_f32_32x32x16_bf16 v[132:147], v[128:131], v[48:51], v[132:147]
    v_mfma_f32_32x32x16_bf16 v[164:179], v[96:99], v[48:51], v[164:179]
    v_mfma_f32_32x32x16_bf16 v[148:163], v[84:87], v[20:23], 0
    v_mfma_f32_32x32x16_bf16 v[180:195], v[100:103], v[20:23], 0
    v_mfma_f32_32x32x16_bf16 v[148:163], v[116:119], v[52:55], v[148:163]
    v_mfma_f32_32x32x16_bf16 v[180:195], v[84:87], v[52:55], v[180:195]
    v_mfma_f32_32x32x16_bf16 v[148:163], v[88:91], v[24:27], v[148:163]
    v_mfma_f32_32x32x16_bf16 v[180:195], v[104:107], v[24:27], v[180:195]
    v_mfma_f32_32x32x16_bf16 v[148:163], v[120:123], v[56:59], v[148:163]
    v_mfma_f32_32x32x16_bf16 v[180:195], v[88:91], v[56:59], v[180:195]
    v_mfma_f32_32x32x16_bf16 v[148:163], v[92:95], v[28:31], v[148:163]
    v_mfma_f32_32x32x16_bf16 v[180:195], v[108:111], v[28:31], v[180:195]
    v_mfma_f32_32x32x16_bf16 v[148:163], v[124:127], v[60:63], v[148:163]
    v_mfma_f32_32x32x16_bf16 v[180:195], v[92:95], v[60:63], v[180:195]
    v_mfma_f32_32x32x16_bf16 v[148:163], v[96:99], v[32:35], v[148:163]
    v_mfma_f32_32x32x16_bf16 v[180:195], v[112:115], v[32:35], v[180:195]
    v_mfma_f32_32x32x16_bf16 v[148:163], v[128:131], v[64:67], v[148:163]
    v_mfma_f32_32x32x16_bf16 v[180:195], v[96:99], v[64:67], v[180:195]
    v_fmamk_f32 v243, v228, 0x0, v229
    v_cos_f32 v239, v243
    v_sin_f32 v240, v243
    v_mul_f32 v235, v132, v239
    v_mul_f32 v237, v164, v239
    v_fma_f32 v235, -v164, v240, v235
    v_fma_f32 v237, v132, v240, v237
    v_fmamk_f32 v243, v228, 0x3a000000, v229
    v_cos_f32 v241, v243
    v_sin_f32 v242, v243
    v_mul_f32 v236, v133, v241
    v_mul_f32 v238, v165, v241
    v_fma_f32 v236, -v165, v242, v236
    v_fma_f32 v238, v133, v242, v238
    v_cvt_pk_bf16_f32 v84, v235, v236
    v_cvt_pk_bf16_f32 v100, v237, v238
    v_cvt_pk_bf16_f32 v116, -v237, -v238
    v_fmamk_f32 v243, v228, 0x3a800000, v229
    v_cos_f32 v239, v243
    v_sin_f32 v240, v243
    v_mul_f32 v235, v134, v239
    v_mul_f32 v237, v166, v239
    v_fma_f32 v235, -v166, v240, v235
    v_fma_f32 v237, v134, v240, v237
    v_fmamk_f32 v243, v228, 0x3ac00000, v229
    v_cos_f32 v241, v243
    v_sin_f32 v242, v243
    v_mul_f32 v236, v135, v241
    v_mul_f32 v238, v167, v241
    v_fma_f32 v236, -v167, v242, v236
    v_fma_f32 v238, v135, v242, v238
    v_cvt_pk_bf16_f32 v85, v235, v236
    v_cvt_pk_bf16_f32 v101, v237, v238
    v_cvt_pk_bf16_f32 v117, -v237, -v238
    v_fmamk_f32 v243, v228, 0x3b800000, v229
    v_cos_f32 v239, v243
    v_sin_f32 v240, v243
    v_mul_f32 v235, v136, v239
    v_mul_f32 v237, v168, v239
    v_fma_f32 v235, -v168, v240, v235
    v_fma_f32 v237, v136, v240, v237
    v_fmamk_f32 v243, v228, 0x3b900000, v229
    v_cos_f32 v241, v243
    v_sin_f32 v242, v243
    v_mul_f32 v236, v137, v241
    v_mul_f32 v238, v169, v241
    v_fma_f32 v236, -v169, v242, v236
    v_fma_f32 v238, v137, v242, v238
    v_cvt_pk_bf16_f32 v86, v235, v236
    v_cvt_pk_bf16_f32 v102, v237, v238
    v_cvt_pk_bf16_f32 v118, -v237, -v238
    v_fmamk_f32 v243, v228, 0x3ba00000, v229
    v_cos_f32 v239, v243
    v_sin_f32 v240, v243
    v_mul_f32 v235, v138, v239
    v_mul_f32 v237, v170, v239
    v_fma_f32 v235, -v170, v240, v235
    v_fma_f32 v237, v138, v240, v237
    v_fmamk_f32 v243, v228, 0x3bb00000, v229
    v_cos_f32 v241, v243
    v_sin_f32 v242, v243
    v_mul_f32 v236, v139, v241
    v_mul_f32 v238, v171, v241
    v_fma_f32 v236, -v171, v242, v236
    v_fma_f32 v238, v139, v242, v238
    v_cvt_pk_bf16_f32 v87, v235, v236
    v_cvt_pk_bf16_f32 v103, v237, v238
    v_cvt_pk_bf16_f32 v119, -v237, -v238
    v_fmamk_f32 v243, v228, 0x3c000000, v229
    v_cos_f32 v239, v243
    v_sin_f32 v240, v243
    v_mul_f32 v235, v140, v239
    v_mul_f32 v237, v172, v239
    v_fma_f32 v235, -v172, v240, v235
    v_fma_f32 v237, v140, v240, v237
    v_fmamk_f32 v243, v228, 0x3c080000, v229
    v_cos_f32 v241, v243
    v_sin_f32 v242, v243
    v_mul_f32 v236, v141, v241
    v_mul_f32 v238, v173, v241
    v_fma_f32 v236, -v173, v242, v236
    v_fma_f32 v238, v141, v242, v238
    v_cvt_pk_bf16_f32 v88, v235, v236
    v_cvt_pk_bf16_f32 v104, v237, v238
    v_cvt_pk_bf16_f32 v120, -v237, -v238
    v_fmamk_f32 v243, v228, 0x3c100000, v229
    v_cos_f32 v239, v243
    v_sin_f32 v240, v243
    v_mul_f32 v235, v142, v239
    v_mul_f32 v237, v174, v239
    v_fma_f32 v235, -v174, v240, v235
    v_fma_f32 v237, v142, v240, v237
    v_fmamk_f32 v243, v228, 0x3c180000, v229
    v_cos_f32 v241, v243
    v_sin_f32 v242, v243
    v_mul_f32 v236, v143, v241
    v_mul_f32 v238, v175, v241
    v_fma_f32 v236, -v175, v242, v236
    v_fma_f32 v238, v143, v242, v238
    v_cvt_pk_bf16_f32 v89, v235, v236
    v_cvt_pk_bf16_f32 v105, v237, v238
    v_cvt_pk_bf16_f32 v121, -v237, -v238
    v_fmamk_f32 v243, v228, 0x3c400000, v229
    v_cos_f32 v239, v243
    v_sin_f32 v240, v243
    v_mul_f32 v235, v144, v239
    v_mul_f32 v237, v176, v239
    v_fma_f32 v235, -v176, v240, v235
    v_fma_f32 v237, v144, v240, v237
    v_fmamk_f32 v243, v228, 0x3c480000, v229
    v_cos_f32 v241, v243
    v_sin_f32 v242, v243
    v_mul_f32 v236, v145, v241
    v_mul_f32 v238, v177, v241
    v_fma_f32 v236, -v177, v242, v236
    v_fma_f32 v238, v145, v242, v238
    v_cvt_pk_bf16_f32 v90, v235, v236
    v_cvt_pk_bf16_f32 v106, v237, v238
    v_cvt_pk_bf16_f32 v122, -v237, -v238
    v_fmamk_f32 v243, v228, 0x3c500000, v229
    v_cos_f32 v239, v243
    v_sin_f32 v240, v243
    v_mul_f32 v235, v146, v239
    v_mul_f32 v237, v178, v239
    v_fma_f32 v235, -v178, v240, v235
    v_fma_f32 v237, v146, v240, v237
    v_fmamk_f32 v243, v228, 0x3c580000, v229
    v_cos_f32 v241, v243
    v_sin_f32 v242, v243
    v_mul_f32 v236, v147, v241
    v_mul_f32 v238, v179, v241
    v_fma_f32 v236, -v179, v242, v236
    v_fma_f32 v238, v147, v242, v238
    v_cvt_pk_bf16_f32 v91, v235, v236
    v_cvt_pk_bf16_f32 v107, v237, v238
    v_cvt_pk_bf16_f32 v123, -v237, -v238
    v_add_f32 v228, 0x42000000, v228
    v_mov_b32 v229, v230
    v_fmamk_f32 v243, v228, 0x0, v229
    v_cos_f32 v239, v243
    v_sin_f32 v240, v243
    v_mul_f32 v235, v148, v239
    v_mul_f32 v237, v180, v239
    v_fma_f32 v235, -v180, v240, v235
    v_fma_f32 v237, v148, v240, v237
    v_fmamk_f32 v243, v228, 0x3a000000, v229
    v_cos_f32 v241, v243
    v_sin_f32 v242, v243
    v_mul_f32 v236, v149, v241
    v_mul_f32 v238, v181, v241
    v_fma_f32 v236, -v181, v242, v236
    v_fma_f32 v238, v149, v242, v238
    v_cvt_pk_bf16_f32 v92, v235, v236
    v_cvt_pk_bf16_f32 v108, v237, v238
    v_cvt_pk_bf16_f32 v124, -v237, -v238
    v_fmamk_f32 v243, v228, 0x3a800000, v229
    v_cos_f32 v239, v243
    v_sin_f32 v240, v243
    v_mul_f32 v235, v150, v239
    v_mul_f32 v237, v182, v239
    v_fma_f32 v235, -v182, v240, v235
    v_fma_f32 v237, v150, v240, v237
    v_fmamk_f32 v243, v228, 0x3ac00000, v229
    v_cos_f32 v241, v243
    v_sin_f32 v242, v243
    v_mul_f32 v236, v151, v241
    v_mul_f32 v238, v183, v241
    v_fma_f32 v236, -v183, v242, v236
    v_fma_f32 v238, v151, v242, v238
    v_cvt_pk_bf16_f32 v93, v235, v236
    v_cvt_pk_bf16_f32 v109, v237, v238
    v_cvt_pk_bf16_f32 v125, -v237, -v238
    v_fmamk_f32 v243, v228, 0x3b800000, v229
    v_cos_f32 v239, v243
    v_sin_f32 v240, v243
    v_mul_f32 v235, v152, v239
    v_mul_f32 v237, v184, v239
    v_fma_f32 v235, -v184, v240, v235
    v_fma_f32 v237, v152, v240, v237
    v_fmamk_f32 v243, v228, 0x3b900000, v229
    v_cos_f32 v241, v243
    v_sin_f32 v242, v243
    v_mul_f32 v236, v153, v241
    v_mul_f32 v238, v185, v241
    v_fma_f32 v236, -v185, v242, v236
    v_fma_f32 v238, v153, v242, v238
    v_cvt_pk_bf16_f32 v94, v235, v236
    v_cvt_pk_bf16_f32 v110, v237, v238
    v_cvt_pk_bf16_f32 v126, -v237, -v238
    v_fmamk_f32 v243, v228, 0x3ba00000, v229
    v_cos_f32 v239, v243
    v_sin_f32 v240, v243
    v_mul_f32 v235, v154, v239
    v_mul_f32 v237, v186, v239
    v_fma_f32 v235, -v186, v240, v235
    v_fma_f32 v237, v154, v240, v237
    v_fmamk_f32 v243, v228, 0x3bb00000, v229
    v_cos_f32 v241, v243
    v_sin_f32 v242, v243
    v_mul_f32 v236, v155, v241
    v_mul_f32 v238, v187, v241
    v_fma_f32 v236, -v187, v242, v236
    v_fma_f32 v238, v155, v242, v238
    v_cvt_pk_bf16_f32 v95, v235, v236
    v_cvt_pk_bf16_f32 v111, v237, v238
    v_cvt_pk_bf16_f32 v127, -v237, -v238
    v_fmamk_f32 v243, v228, 0x3c000000, v229
    v_cos_f32 v239, v243
    v_sin_f32 v240, v243
    v_mul_f32 v235, v156, v239
    v_mul_f32 v237, v188, v239
    v_fma_f32 v235, -v188, v240, v235
    v_fma_f32 v237, v156, v240, v237
    v_fmamk_f32 v243, v228, 0x3c080000, v229
    v_cos_f32 v241, v243
    v_sin_f32 v242, v243
    v_mul_f32 v236, v157, v241
    v_mul_f32 v238, v189, v241
    v_fma_f32 v236, -v189, v242, v236
    v_fma_f32 v238, v157, v242, v238
    v_cvt_pk_bf16_f32 v96, v235, v236
    v_cvt_pk_bf16_f32 v112, v237, v238
    v_cvt_pk_bf16_f32 v128, -v237, -v238
    v_fmamk_f32 v243, v228, 0x3c100000, v229
    v_cos_f32 v239, v243
    v_sin_f32 v240, v243
    v_mul_f32 v235, v158, v239
    v_mul_f32 v237, v190, v239
    v_fma_f32 v235, -v190, v240, v235
    v_fma_f32 v237, v158, v240, v237
    v_fmamk_f32 v243, v228, 0x3c180000, v229
    v_cos_f32 v241, v243
    v_sin_f32 v242, v243
    v_mul_f32 v236, v159, v241
    v_mul_f32 v238, v191, v241
    v_fma_f32 v236, -v191, v242, v236
    v_fma_f32 v238, v159, v242, v238
    v_cvt_pk_bf16_f32 v97, v235, v236
    v_cvt_pk_bf16_f32 v113, v237, v238
    v_cvt_pk_bf16_f32 v129, -v237, -v238
    v_fmamk_f32 v243, v228, 0x3c400000, v229
    v_cos_f32 v239, v243
    v_sin_f32 v240, v243
    v_mul_f32 v235, v160, v239
    v_mul_f32 v237, v192, v239
    v_fma_f32 v235, -v192, v240, v235
    v_fma_f32 v237, v160, v240, v237
    v_fmamk_f32 v243, v228, 0x3c480000, v229
    v_cos_f32 v241, v243
    v_sin_f32 v242, v243
    v_mul_f32 v236, v161, v241
    v_mul_f32 v238, v193, v241
    v_fma_f32 v236, -v193, v242, v236
    v_fma_f32 v238, v161, v242, v238
    v_cvt_pk_bf16_f32 v98, v235, v236
    v_cvt_pk_bf16_f32 v114, v237, v238
    v_cvt_pk_bf16_f32 v130, -v237, -v238
    v_fmamk_f32 v243, v228, 0x3c500000, v229
    v_cos_f32 v239, v243
    v_sin_f32 v240, v243
    v_mul_f32 v235, v162, v239
    v_mul_f32 v237, v194, v239
    v_fma_f32 v235, -v194, v240, v235
    v_fma_f32 v237, v162, v240, v237
    v_fmamk_f32 v243, v228, 0x3c580000, v229
    v_cos_f32 v241, v243
    v_sin_f32 v242, v243
    v_mul_f32 v236, v163, v241
    v_mul_f32 v238, v195, v241
    v_fma_f32 v236, -v195, v242, v236
    v_fma_f32 v238, v163, v242, v238
    v_cvt_pk_bf16_f32 v99, v235, v236
    v_cvt_pk_bf16_f32 v115, v237, v238
    v_cvt_pk_bf16_f32 v131, -v237, -v238
    v_mfma_f32_32x32x16_bf16 v[132:147], v[68:71], v[84:87], 0
    v_mfma_f32_32x32x16_bf16 v[164:179], v[68:71], v[100:103], 0
    v_mfma_f32_32x32x16_bf16 v[132:147], v[76:79], v[116:119], v[132:147]
    v_mfma_f32_32x32x16_bf16 v[164:179], v[76:79], v[84:87], v[164:179]
    v_mfma_f32_32x32x16_bf16 v[132:147], v[72:75], v[88:91], v[132:147]
    v_mfma_f32_32x32x16_bf16 v[164:179], v[72:75], v[104:107], v[164:179]
    v_mfma_f32_32x32x16_bf16 v[132:147], v[80:83], v[120:123], v[132:147]
    v_mfma_f32_32x32x16_bf16 v[164:179], v[80:83], v[88:91], v[164:179]
    v_mfma_f32_32x32x16_bf16 v[148:163], v[68:71], v[92:95], 0
    v_mfma_f32_32x32x16_bf16 v[180:195], v[68:71], v[108:111], 0
    v_mfma_f32_32x32x16_bf16 v[148:163], v[76:79], v[124:127], v[148:163]
    v_mfma_f32_32x32x16_bf16 v[180:195], v[76:79], v[92:95], v[180:195]
    v_mfma_f32_32x32x16_bf16 v[148:163], v[72:75], v[96:99], v[148:163]
    v_mfma_f32_32x32x16_bf16 v[180:195], v[72:75], v[112:115], v[180:195]
    v_mfma_f32_32x32x16_bf16 v[148:163], v[80:83], v[128:131], v[148:163]
    v_mfma_f32_32x32x16_bf16 v[180:195], v[80:83], v[96:99], v[180:195]
    v_lshlrev_b32 v231, 4, v1
    v_add_u32 v232, s6, v231
    s_lshl_b32 s5, s3, 12
    s_add_u32 s5, s5, 0x5800000
    s_add_u32 s2, s5, 4096
    v_cvt_pk_bf16_f32 v84, v132, v133
    v_cvt_pk_bf16_f32 v85, v134, v135
    v_cvt_pk_bf16_f32 v86, v136, v137
    v_cvt_pk_bf16_f32 v87, v138, v139
    buffer_store_dwordx4 v[84:87], v231, s[8:11], s5 offen offset:0 sc1
    v_cvt_pk_bf16_f32 v88, v140, v141
    v_cvt_pk_bf16_f32 v89, v142, v143
    v_cvt_pk_bf16_f32 v90, v144, v145
    v_cvt_pk_bf16_f32 v91, v146, v147
    buffer_store_dwordx4 v[88:91], v231, s[8:11], s5 offen offset:1024 sc1
    v_cvt_pk_bf16_f32 v92, v148, v149
    v_cvt_pk_bf16_f32 v93, v150, v151
    v_cvt_pk_bf16_f32 v94, v152, v153
    v_cvt_pk_bf16_f32 v95, v154, v155
    buffer_store_dwordx4 v[92:95], v231, s[8:11], s5 offen offset:2048 sc1
    v_cvt_pk_bf16_f32 v96, v156, v157
    v_cvt_pk_bf16_f32 v97, v158, v159
    v_cvt_pk_bf16_f32 v98, v160, v161
    v_cvt_pk_bf16_f32 v99, v162, v163
    buffer_store_dwordx4 v[96:99], v231, s[8:11], s5 offen offset:3072 sc1
    v_cvt_pk_bf16_f32 v100, v164, v165
    v_cvt_pk_bf16_f32 v101, v166, v167
    v_cvt_pk_bf16_f32 v102, v168, v169
    v_cvt_pk_bf16_f32 v103, v170, v171
    buffer_store_dwordx4 v[100:103], v232, s[8:11], s2 offen offset:0 sc1
    v_cvt_pk_bf16_f32 v104, v172, v173
    v_cvt_pk_bf16_f32 v105, v174, v175
    v_cvt_pk_bf16_f32 v106, v176, v177
    v_cvt_pk_bf16_f32 v107, v178, v179
    buffer_store_dwordx4 v[104:107], v232, s[8:11], s2 offen offset:1024 sc1
    v_cvt_pk_bf16_f32 v108, v180, v181
    v_cvt_pk_bf16_f32 v109, v182, v183
    v_cvt_pk_bf16_f32 v110, v184, v185
    v_cvt_pk_bf16_f32 v111, v186, v187
    buffer_store_dwordx4 v[108:111], v232, s[8:11], s2 offen offset:2048 sc1
    v_cvt_pk_bf16_f32 v112, v188, v189
    v_cvt_pk_bf16_f32 v113, v190, v191
    v_cvt_pk_bf16_f32 v114, v192, v193
    v_cvt_pk_bf16_f32 v115, v194, v195
    buffer_store_dwordx4 v[112:115], v232, s[8:11], s2 offen offset:3072 sc1
    s_add_u32 s7, s7, 8
    s_cmp_lt_u32 s7, 16
    s_cbranch_scc1 colloop_125
    s_cmp_eq_u32 s3, 1008
    s_cbranch_scc1 colloop_125
    s_waitcnt vmcnt(0) lgkmcnt(0)
    s_barrier
    s_cmp_lg_u32 s58, 0
    s_cbranch_scc1 sig_127
    v_mov_b32 v75, 0x5ffffff0
    v_mov_b32 v76, 44
    v_cmp_eq_u32 vcc, 0, v1
    s_nop 1
    v_cndmask_b32 v76, v75, v76, vcc
    v_mov_b32 v75, 1
    buffer_atomic_add v75, v76, s[12:15], 0 offen sc1
sig_127:
    v_bfe_u32 v76, v1, 2, 2
    v_sub_u32 v76, 0, v76
    v_lshrrev_b32 v75, 4, v1
    v_xor_b32 v76, v76, v75
    v_and_b32 v76, 3, v76
    v_bfe_u32 v72, v1, 0, 4
    v_lshlrev_b32 v72, 6, v72
    v_lshl_or_b32 v72, v76, 4, v72
    s_lshr_b32 s74, s58, 2
    s_mul_i32 s74, s74, 8192
    v_add_u32 v72, s74, v72
    v_bfe_u32 v73, v1, 0, 2
    v_lshlrev_b32 v73, 3, v73
    v_bfe_u32 v75, v1, 4, 1
    v_lshl_or_b32 v73, v75, 5, v73
    v_bfe_u32 v75, v1, 2, 2
    v_lshl_or_b32 v73, v75, 6, v73
    v_bfe_u32 v75, v1, 2, 2
    v_lshl_or_b32 v73, v75, 9, v73
    v_bfe_u32 v75, v1, 4, 2
    v_lshl_or_b32 v73, v75, 12, v73
    s_and_b32 s74, s58, 3
    s_mul_i32 s74, s74, 128
    s_or_b32 s74, s74, 16384
    v_xor_b32 v73, s74, v73
    s_mov_b64 s[60:61], s[8:9]
    s_mov_b32 s62, 0x10000000
    s_mov_b32 s63, 0x20000
    s_mov_b64 s[64:65], s[8:9]
    s_mov_b32 s66, 0x10000000
    s_mov_b32 s67, 0x20000
    v_lshrrev_b32 v76, 4, v1
    v_sub_u32 v76, 0, v76
    v_xor_b32 v76, v76, v1
    v_and_b32 v76, 3, v76
    s_mul_i32 s74, s58, 32
    v_lshrrev_b32 v77, 2, v1
    v_add3_u32 v77, v77, s74, 0
    v_bfe_u32 v68, v77, 0, 2
    v_lshlrev_b32 v68, 11, v68
    v_bfe_u32 v75, v77, 4, 1
    v_lshl_or_b32 v68, v75, 13, v68
    v_bfe_u32 v75, v77, 2, 2
    v_lshl_or_b32 v68, v75, 14, v68
    v_bfe_u32 v75, v77, 5, 3
    v_lshl_or_b32 v68, v75, 16, v68
    v_lshl_add_u32 v68, v76, 4, v68
    v_lshrrev_b32 v77, 2, v1
    v_add3_u32 v77, v77, s74, 16
    v_bfe_u32 v69, v77, 0, 2
    v_lshlrev_b32 v69, 11, v69
    v_bfe_u32 v75, v77, 4, 1
    v_lshl_or_b32 v69, v75, 13, v69
    v_bfe_u32 v75, v77, 2, 2
    v_lshl_or_b32 v69, v75, 14, v69
    v_bfe_u32 v75, v77, 5, 3
    v_lshl_or_b32 v69, v75, 16, v69
    v_lshl_add_u32 v69, v76, 4, v69
    s_and_b32 s74, s58, 2
    v_bfe_u32 v76, v1, 0, 5
    v_bfe_u32 v77, v1, 5, 1
    v_lshlrev_b32 v77, 2, v77
    v_xor_b32 v76, v76, v77
    v_xor_b32 v76, s74, v76
    v_lshlrev_b32 v77, 4, v76
    v_lshrrev_b32 v76, 5, v1
    v_lshl_add_u32 v70, v76, 12, v77
    v_bfe_u32 v76, v1, 0, 5
    v_bfe_u32 v77, v1, 5, 1
    v_lshlrev_b32 v77, 2, v77
    v_xor_b32 v76, v76, v77
    v_xor_b32 v76, s74, v76
    v_xor_b32 v76, 8, v76
    v_lshlrev_b32 v77, 4, v76
    v_lshrrev_b32 v76, 5, v1
    v_lshl_add_u32 v71, v76, 12, v77
    v_add_u32 v71, 8192, v71
    s_lshl_b32 s74, s58, 14
    v_add_u32 v70, s74, v70
    v_add_u32 v71, s74, v71
    s_mov_b32 s70, 131072
    s_and_b32 s79, s57, 3
    s_bfe_u32 s80, s76, 0x10002
    s_bfe_u32 s85, s76, 0x20005
    s_lshl_b32 s85, s85, 1
    s_or_b32 s80, s80, s85
    s_lshl_b32 s68, s79, 19
    s_add_u32 s68, s68, 0x5200000
    s_lshl_b32 s69, s80, 9
    s_add_u32 s69, s69, 0x5800000
    s_cmp_lg_u32 s58, 0
    s_cbranch_scc1 wall_128
    v_mov_b32 v76, 168
wctr_129:
    buffer_load_dword v75, v76, s[12:15], 0 offen sc1
    s_waitcnt vmcnt(0)
    v_cmp_ne_u32 vcc, 2097216, v75
    s_cbranch_vccz wctr_ok_130
    s_sub_u32 s77, s77, 1
    s_cbranch_scc0 wctr_129
    s_mov_b32 s77, 0
wctr_ok_130:
wall_128:
    s_cmp_lg_u32 s58, 0
    s_cbranch_scc1 wall_131
    v_mov_b32 v76, 44
wctr_132:
    buffer_load_dword v75, v76, s[12:15], 0 offen sc1
    s_waitcnt vmcnt(0)
    v_cmp_gt_u16 vcc, 32, v75
    s_cbranch_vccz wctr_ok_133
    s_sub_u32 s77, s77, 1
    s_cbranch_scc0 wctr_132
    s_mov_b32 s77, 0
wctr_ok_133:
wall_131:
    s_barrier
    s_mul_i32 s71, s58, 2048
    s_mov_b32 m0, s71
    s_nop 0
    buffer_load_dwordx4 v68, s[60:63], s68 offen lds
    s_add_u32 m0, s71, 1024
    s_nop 0
    buffer_load_dwordx4 v69, s[60:63], s68 offen lds
    s_add_u32 m0, s71, 16384
    s_nop 0
    buffer_load_dwordx4 v70, s[64:67], s69 offen lds
    s_add_u32 m0, s71, 17408
    s_nop 0
    buffer_load_dwordx4 v71, s[64:67], s69 offen lds
    s_add_u32 s68, s68, 64
    s_add_u32 s69, s69, s70
    s_add_u32 s71, s71, 32768
    s_and_b32 s71, s71, 0x1ffff
    s_mov_b32 m0, s71
    s_nop 0
    buffer_load_dwordx4 v68, s[60:63], s68 offen lds
    s_add_u32 m0, s71, 1024
    s_nop 0
    buffer_load_dwordx4 v69, s[60:63], s68 offen lds
    s_add_u32 m0, s71, 16384
    s_nop 0
    buffer_load_dwordx4 v70, s[64:67], s69 offen lds
    s_add_u32 m0, s71, 17408
    s_nop 0
    buffer_load_dwordx4 v71, s[64:67], s69 offen lds
    s_add_u32 s68, s68, 64
    s_add_u32 s69, s69, s70
    s_add_u32 s71, s71, 32768
    s_and_b32 s71, s71, 0x1ffff
    s_mov_b32 m0, s71
    s_nop 0
    buffer_load_dwordx4 v68, s[60:63], s68 offen lds
    s_add_u32 m0, s71, 1024
    s_nop 0
    buffer_load_dwordx4 v69, s[60:63], s68 offen lds
    s_add_u32 m0, s71, 16384
    s_nop 0
    buffer_load_dwordx4 v70, s[64:67], s69 offen lds
    s_add_u32 m0, s71, 17408
    s_nop 0
    buffer_load_dwordx4 v71, s[64:67], s69 offen lds
    s_add_u32 s68, s68, 64
    s_add_u32 s69, s69, s70
    s_add_u32 s71, s71, 32768
    s_and_b32 s71, s71, 0x1ffff
    s_mov_b32 m0, s71
    s_nop 0
    buffer_load_dwordx4 v68, s[60:63], s68 offen lds
    s_add_u32 m0, s71, 1024
    s_nop 0
    buffer_load_dwordx4 v69, s[60:63], s68 offen lds
    s_add_u32 m0, s71, 16384
    s_nop 0
    buffer_load_dwordx4 v70, s[64:67], s69 offen lds
    s_add_u32 m0, s71, 17408
    s_nop 0
    buffer_load_dwordx4 v71, s[64:67], s69 offen lds
    s_add_u32 s68, s68, 64
    s_add_u32 s69, s69, s70
    s_add_u32 s71, s71, 32768
    s_and_b32 s71, s71, 0x1ffff
    s_mov_b32 s72, 0
    s_waitcnt vmcnt(12)
    s_barrier
    v_add_u32 v74, s72, v72
    v_add_u32 v75, s72, v73
    v_xor_b32 v76, 32, v75
    v_xor_b32 v77, 64, v75
    v_xor_b32 v78, 96, v75
    s_add_u32 s72, s72, 32768
    s_and_b32 s72, s72, 0x1ffff
    ds_read_b128 v[4:7], v74 offset:0
    ds_read_b128 v[8:11], v74 offset:1024
    ds_read_b128 v[12:15], v74 offset:2048
    ds_read_b128 v[16:19], v74 offset:3072
    ds_read_b64_tr_b16 v[36:37], v75 offset:0
    ds_read_b64_tr_b16 v[38:39], v75 offset:2048
    ds_read_b64_tr_b16 v[40:41], v76 offset:0
    ds_read_b64_tr_b16 v[42:43], v76 offset:2048
    ds_read_b64_tr_b16 v[44:45], v77 offset:0
    ds_read_b64_tr_b16 v[46:47], v77 offset:2048
    ds_read_b64_tr_b16 v[48:49], v78 offset:0
    ds_read_b64_tr_b16 v[50:51], v78 offset:2048
    s_waitcnt lgkmcnt(0)
    v_mfma_f32_16x16x32_bf16 v[80:83], v[4:7], v[36:39], 0
    ds_read_b128 v[20:23], v74 offset:4096
    v_mfma_f32_16x16x32_bf16 v[84:87], v[4:7], v[40:43], 0
    v_mfma_f32_16x16x32_bf16 v[88:91], v[4:7], v[44:47], 0
    ds_read_b128 v[24:27], v74 offset:5120
    v_mfma_f32_16x16x32_bf16 v[92:95], v[4:7], v[48:51], 0
    v_mfma_f32_16x16x32_bf16 v[96:99], v[8:11], v[36:39], 0
    ds_read_b128 v[28:31], v74 offset:6144
    v_mfma_f32_16x16x32_bf16 v[100:103], v[8:11], v[40:43], 0
    v_mfma_f32_16x16x32_bf16 v[104:107], v[8:11], v[44:47], 0
    ds_read_b128 v[32:35], v74 offset:7168
    v_mfma_f32_16x16x32_bf16 v[108:111], v[8:11], v[48:51], 0
    v_mfma_f32_16x16x32_bf16 v[112:115], v[12:15], v[36:39], 0
    v_mfma_f32_16x16x32_bf16 v[116:119], v[12:15], v[40:43], 0
    v_mfma_f32_16x16x32_bf16 v[120:123], v[12:15], v[44:47], 0
    v_mfma_f32_16x16x32_bf16 v[124:127], v[12:15], v[48:51], 0
    v_mfma_f32_16x16x32_bf16 v[128:131], v[16:19], v[36:39], 0
    v_mfma_f32_16x16x32_bf16 v[132:135], v[16:19], v[40:43], 0
    v_mfma_f32_16x16x32_bf16 v[136:139], v[16:19], v[44:47], 0
    v_mfma_f32_16x16x32_bf16 v[140:143], v[16:19], v[48:51], 0
    s_waitcnt vmcnt(8) lgkmcnt(0)
    s_barrier
    v_mfma_f32_16x16x32_bf16 v[144:147], v[20:23], v[36:39], 0
    v_add_u32 v74, s72, v72
    v_add_u32 v75, s72, v73
    v_xor_b32 v76, 32, v75
    v_xor_b32 v77, 64, v75
    v_xor_b32 v78, 96, v75
    v_mfma_f32_16x16x32_bf16 v[148:151], v[20:23], v[40:43], 0
    s_add_u32 s72, s72, 32768
    s_and_b32 s72, s72, 0x1ffff
    ds_read_b128 v[4:7], v74 offset:0
    v_mfma_f32_16x16x32_bf16 v[152:155], v[20:23], v[44:47], 0
    ds_read_b64_tr_b16 v[52:53], v75 offset:0
    v_mfma_f32_16x16x32_bf16 v[156:159], v[20:23], v[48:51], 0
    ds_read_b64_tr_b16 v[54:55], v75 offset:2048
    ds_read_b64_tr_b16 v[56:57], v76 offset:0
    v_mfma_f32_16x16x32_bf16 v[160:163], v[24:27], v[36:39], 0
    ds_read_b64_tr_b16 v[58:59], v76 offset:2048
    v_mfma_f32_16x16x32_bf16 v[164:167], v[24:27], v[40:43], 0
    ds_read_b64_tr_b16 v[60:61], v77 offset:0
    ds_read_b64_tr_b16 v[62:63], v77 offset:2048
    v_mfma_f32_16x16x32_bf16 v[168:171], v[24:27], v[44:47], 0
    ds_read_b64_tr_b16 v[64:65], v78 offset:0
    v_mfma_f32_16x16x32_bf16 v[172:175], v[24:27], v[48:51], 0
    ds_read_b64_tr_b16 v[66:67], v78 offset:2048
    ds_read_b128 v[8:11], v74 offset:1024
    v_mfma_f32_16x16x32_bf16 v[176:179], v[28:31], v[36:39], 0
    ds_read_b128 v[12:15], v74 offset:2048
    ds_read_b128 v[16:19], v74 offset:3072
    v_mfma_f32_16x16x32_bf16 v[180:183], v[28:31], v[40:43], 0
    s_mov_b32 m0, s71
    v_mfma_f32_16x16x32_bf16 v[184:187], v[28:31], v[44:47], 0
    buffer_load_dwordx4 v68, s[60:63], s68 offen lds
    s_add_u32 m0, s71, 1024
    v_mfma_f32_16x16x32_bf16 v[188:191], v[28:31], v[48:51], 0
    buffer_load_dwordx4 v69, s[60:63], s68 offen lds
    v_mfma_f32_16x16x32_bf16 v[192:195], v[32:35], v[36:39], 0
    s_add_u32 m0, s71, 16384
    s_nop 0
    buffer_load_dwordx4 v70, s[64:67], s69 offen lds
    v_mfma_f32_16x16x32_bf16 v[196:199], v[32:35], v[40:43], 0
    s_add_u32 m0, s71, 17408
    v_mfma_f32_16x16x32_bf16 v[200:203], v[32:35], v[44:47], 0
    buffer_load_dwordx4 v71, s[64:67], s69 offen lds
    s_add_u32 s68, s68, 64
    s_add_u32 s69, s69, s70
    v_mfma_f32_16x16x32_bf16 v[204:207], v[32:35], v[48:51], 0
    s_add_u32 s71, s71, 32768
    s_and_b32 s71, s71, 0x1ffff
    s_waitcnt lgkmcnt(0)
    v_mfma_f32_16x16x32_bf16 v[80:83], v[4:7], v[52:55], v[80:83]
    ds_read_b128 v[20:23], v74 offset:4096
    v_mfma_f32_16x16x32_bf16 v[84:87], v[4:7], v[56:59], v[84:87]
    v_mfma_f32_16x16x32_bf16 v[88:91], v[4:7], v[60:63], v[88:91]
    ds_read_b128 v[24:27], v74 offset:5120
    v_mfma_f32_16x16x32_bf16 v[92:95], v[4:7], v[64:67], v[92:95]
    v_mfma_f32_16x16x32_bf16 v[96:99], v[8:11], v[52:55], v[96:99]
    ds_read_b128 v[28:31], v74 offset:6144
    v_mfma_f32_16x16x32_bf16 v[100:103], v[8:11], v[56:59], v[100:103]
    v_mfma_f32_16x16x32_bf16 v[104:107], v[8:11], v[60:63], v[104:107]
    ds_read_b128 v[32:35], v74 offset:7168
    v_mfma_f32_16x16x32_bf16 v[108:111], v[8:11], v[64:67], v[108:111]
    v_mfma_f32_16x16x32_bf16 v[112:115], v[12:15], v[52:55], v[112:115]
    v_mfma_f32_16x16x32_bf16 v[116:119], v[12:15], v[56:59], v[116:119]
    v_mfma_f32_16x16x32_bf16 v[120:123], v[12:15], v[60:63], v[120:123]
    v_mfma_f32_16x16x32_bf16 v[124:127], v[12:15], v[64:67], v[124:127]
    v_mfma_f32_16x16x32_bf16 v[128:131], v[16:19], v[52:55], v[128:131]
    v_mfma_f32_16x16x32_bf16 v[132:135], v[16:19], v[56:59], v[132:135]
    v_mfma_f32_16x16x32_bf16 v[136:139], v[16:19], v[60:63], v[136:139]
    v_mfma_f32_16x16x32_bf16 v[140:143], v[16:19], v[64:67], v[140:143]
    s_waitcnt vmcnt(8) lgkmcnt(0)
    s_barrier
    v_mfma_f32_16x16x32_bf16 v[144:147], v[20:23], v[52:55], v[144:147]
    v_add_u32 v74, s72, v72
    v_add_u32 v75, s72, v73
    v_xor_b32 v76, 32, v75
    v_xor_b32 v77, 64, v75
    v_xor_b32 v78, 96, v75
    v_mfma_f32_16x16x32_bf16 v[148:151], v[20:23], v[56:59], v[148:151]
    s_add_u32 s72, s72, 32768
    s_and_b32 s72, s72, 0x1ffff
    ds_read_b128 v[4:7], v74 offset:0
    v_mfma_f32_16x16x32_bf16 v[152:155], v[20:23], v[60:63], v[152:155]
    ds_read_b64_tr_b16 v[36:37], v75 offset:0
    v_mfma_f32_16x16x32_bf16 v[156:159], v[20:23], v[64:67], v[156:159]
    ds_read_b64_tr_b16 v[38:39], v75 offset:2048
    ds_read_b64_tr_b16 v[40:41], v76 offset:0
    v_mfma_f32_16x16x32_bf16 v[160:163], v[24:27], v[52:55], v[160:163]
    ds_read_b64_tr_b16 v[42:43], v76 offset:2048
    v_mfma_f32_16x16x32_bf16 v[164:167], v[24:27], v[56:59], v[164:167]
    ds_read_b64_tr_b16 v[44:45], v77 offset:0
    ds_read_b64_tr_b16 v[46:47], v77 offset:2048
    v_mfma_f32_16x16x32_bf16 v[168:171], v[24:27], v[60:63], v[168:171]
    ds_read_b64_tr_b16 v[48:49], v78 offset:0
    v_mfma_f32_16x16x32_bf16 v[172:175], v[24:27], v[64:67], v[172:175]
    ds_read_b64_tr_b16 v[50:51], v78 offset:2048
    ds_read_b128 v[8:11], v74 offset:1024
    v_mfma_f32_16x16x32_bf16 v[176:179], v[28:31], v[52:55], v[176:179]
    ds_read_b128 v[12:15], v74 offset:2048
    ds_read_b128 v[16:19], v74 offset:3072
    v_mfma_f32_16x16x32_bf16 v[180:183], v[28:31], v[56:59], v[180:183]
    s_mov_b32 m0, s71
    v_mfma_f32_16x16x32_bf16 v[184:187], v[28:31], v[60:63], v[184:187]
    buffer_load_dwordx4 v68, s[60:63], s68 offen lds
    s_add_u32 m0, s71, 1024
    v_mfma_f32_16x16x32_bf16 v[188:191], v[28:31], v[64:67], v[188:191]
    buffer_load_dwordx4 v69, s[60:63], s68 offen lds
    v_mfma_f32_16x16x32_bf16 v[192:195], v[32:35], v[52:55], v[192:195]
    s_add_u32 m0, s71, 16384
    s_nop 0
    buffer_load_dwordx4 v70, s[64:67], s69 offen lds
    v_mfma_f32_16x16x32_bf16 v[196:199], v[32:35], v[56:59], v[196:199]
    s_add_u32 m0, s71, 17408
    v_mfma_f32_16x16x32_bf16 v[200:203], v[32:35], v[60:63], v[200:203]
    buffer_load_dwordx4 v71, s[64:67], s69 offen lds
    s_add_u32 s68, s68, 64
    s_add_u32 s69, s69, s70
    v_mfma_f32_16x16x32_bf16 v[204:207], v[32:35], v[64:67], v[204:207]
    s_add_u32 s71, s71, 32768
    s_and_b32 s71, s71, 0x1ffff
    s_mov_b32 s73, 13
gl_134:
    s_waitcnt lgkmcnt(0)
    v_mfma_f32_16x16x32_bf16 v[80:83], v[4:7], v[36:39], v[80:83]
    ds_read_b128 v[20:23], v74 offset:4096
    v_mfma_f32_16x16x32_bf16 v[84:87], v[4:7], v[40:43], v[84:87]
    v_mfma_f32_16x16x32_bf16 v[88:91], v[4:7], v[44:47], v[88:91]
    ds_read_b128 v[24:27], v74 offset:5120
    v_mfma_f32_16x16x32_bf16 v[92:95], v[4:7], v[48:51], v[92:95]
    v_mfma_f32_16x16x32_bf16 v[96:99], v[8:11], v[36:39], v[96:99]
    ds_read_b128 v[28:31], v74 offset:6144
    v_mfma_f32_16x16x32_bf16 v[100:103], v[8:11], v[40:43], v[100:103]
    v_mfma_f32_16x16x32_bf16 v[104:107], v[8:11], v[44:47], v[104:107]
    ds_read_b128 v[32:35], v74 offset:7168
    v_mfma_f32_16x16x32_bf16 v[108:111], v[8:11], v[48:51], v[108:111]
    v_mfma_f32_16x16x32_bf16 v[112:115], v[12:15], v[36:39], v[112:115]
    v_mfma_f32_16x16x32_bf16 v[116:119], v[12:15], v[40:43], v[116:119]
    v_mfma_f32_16x16x32_bf16 v[120:123], v[12:15], v[44:47], v[120:123]
    v_mfma_f32_16x16x32_bf16 v[124:127], v[12:15], v[48:51], v[124:127]
    v_mfma_f32_16x16x32_bf16 v[128:131], v[16:19], v[36:39], v[128:131]
    v_mfma_f32_16x16x32_bf16 v[132:135], v[16:19], v[40:43], v[132:135]
    v_mfma_f32_16x16x32_bf16 v[136:139], v[16:19], v[44:47], v[136:139]
    v_mfma_f32_16x16x32_bf16 v[140:143], v[16:19], v[48:51], v[140:143]
    s_waitcnt vmcnt(8) lgkmcnt(0)
    s_barrier
    v_mfma_f32_16x16x32_bf16 v[144:147], v[20:23], v[36:39], v[144:147]
    v_add_u32 v74, s72, v72
    v_add_u32 v75, s72, v73
    v_xor_b32 v76, 32, v75
    v_xor_b32 v77, 64, v75
    v_xor_b32 v78, 96, v75
    v_mfma_f32_16x16x32_bf16 v[148:151], v[20:23], v[40:43], v[148:151]
    s_add_u32 s72, s72, 32768
    s_and_b32 s72, s72, 0x1ffff
    ds_read_b128 v[4:7], v74 offset:0
    v_mfma_f32_16x16x32_bf16 v[152:155], v[20:23], v[44:47], v[152:155]
    ds_read_b64_tr_b16 v[52:53], v75 offset:0
    v_mfma_f32_16x16x32_bf16 v[156:159], v[20:23], v[48:51], v[156:159]
    ds_read_b64_tr_b16 v[54:55], v75 offset:2048
    ds_read_b64_tr_b16 v[56:57], v76 offset:0
    v_mfma_f32_16x16x32_bf16 v[160:163], v[24:27], v[36:39], v[160:163]
    ds_read_b64_tr_b16 v[58:59], v76 offset:2048
    v_mfma_f32_16x16x32_bf16 v[164:167], v[24:27], v[40:43], v[164:167]
    ds_read_b64_tr_b16 v[60:61], v77 offset:0
    ds_read_b64_tr_b16 v[62:63], v77 offset:2048
    v_mfma_f32_16x16x32_bf16 v[168:171], v[24:27], v[44:47], v[168:171]
    ds_read_b64_tr_b16 v[64:65], v78 offset:0
    v_mfma_f32_16x16x32_bf16 v[172:175], v[24:27], v[48:51], v[172:175]
    ds_read_b64_tr_b16 v[66:67], v78 offset:2048
    ds_read_b128 v[8:11], v74 offset:1024
    v_mfma_f32_16x16x32_bf16 v[176:179], v[28:31], v[36:39], v[176:179]
    ds_read_b128 v[12:15], v74 offset:2048
    ds_read_b128 v[16:19], v74 offset:3072
    v_mfma_f32_16x16x32_bf16 v[180:183], v[28:31], v[40:43], v[180:183]
    s_mov_b32 m0, s71
    v_mfma_f32_16x16x32_bf16 v[184:187], v[28:31], v[44:47], v[184:187]
    buffer_load_dwordx4 v68, s[60:63], s68 offen lds
    s_add_u32 m0, s71, 1024
    v_mfma_f32_16x16x32_bf16 v[188:191], v[28:31], v[48:51], v[188:191]
    buffer_load_dwordx4 v69, s[60:63], s68 offen lds
    v_mfma_f32_16x16x32_bf16 v[192:195], v[32:35], v[36:39], v[192:195]
    s_add_u32 m0, s71, 16384
    s_nop 0
    buffer_load_dwordx4 v70, s[64:67], s69 offen lds
    v_mfma_f32_16x16x32_bf16 v[196:199], v[32:35], v[40:43], v[196:199]
    s_add_u32 m0, s71, 17408
    v_mfma_f32_16x16x32_bf16 v[200:203], v[32:35], v[44:47], v[200:203]
    buffer_load_dwordx4 v71, s[64:67], s69 offen lds
    s_add_u32 s68, s68, 64
    s_add_u32 s69, s69, s70
    v_mfma_f32_16x16x32_bf16 v[204:207], v[32:35], v[48:51], v[204:207]
    s_add_u32 s71, s71, 32768
    s_and_b32 s71, s71, 0x1ffff
    s_waitcnt lgkmcnt(0)
    v_mfma_f32_16x16x32_bf16 v[80:83], v[4:7], v[52:55], v[80:83]
    ds_read_b128 v[20:23], v74 offset:4096
    v_mfma_f32_16x16x32_bf16 v[84:87], v[4:7], v[56:59], v[84:87]
    v_mfma_f32_16x16x32_bf16 v[88:91], v[4:7], v[60:63], v[88:91]
    ds_read_b128 v[24:27], v74 offset:5120
    v_mfma_f32_16x16x32_bf16 v[92:95], v[4:7], v[64:67], v[92:95]
    v_mfma_f32_16x16x32_bf16 v[96:99], v[8:11], v[52:55], v[96:99]
    ds_read_b128 v[28:31], v74 offset:6144
    v_mfma_f32_16x16x32_bf16 v[100:103], v[8:11], v[56:59], v[100:103]
    v_mfma_f32_16x16x32_bf16 v[104:107], v[8:11], v[60:63], v[104:107]
    ds_read_b128 v[32:35], v74 offset:7168
    v_mfma_f32_16x16x32_bf16 v[108:111], v[8:11], v[64:67], v[108:111]
    v_mfma_f32_16x16x32_bf16 v[112:115], v[12:15], v[52:55], v[112:115]
    v_mfma_f32_16x16x32_bf16 v[116:119], v[12:15], v[56:59], v[116:119]
    v_mfma_f32_16x16x32_bf16 v[120:123], v[12:15], v[60:63], v[120:123]
    v_mfma_f32_16x16x32_bf16 v[124:127], v[12:15], v[64:67], v[124:127]
    v_mfma_f32_16x16x32_bf16 v[128:131], v[16:19], v[52:55], v[128:131]
    v_mfma_f32_16x16x32_bf16 v[132:135], v[16:19], v[56:59], v[132:135]
    v_mfma_f32_16x16x32_bf16 v[136:139], v[16:19], v[60:63], v[136:139]
    v_mfma_f32_16x16x32_bf16 v[140:143], v[16:19], v[64:67], v[140:143]
    s_waitcnt vmcnt(8) lgkmcnt(0)
    s_barrier
    v_mfma_f32_16x16x32_bf16 v[144:147], v[20:23], v[52:55], v[144:147]
    v_add_u32 v74, s72, v72
    v_add_u32 v75, s72, v73
    v_xor_b32 v76, 32, v75
    v_xor_b32 v77, 64, v75
    v_xor_b32 v78, 96, v75
    v_mfma_f32_16x16x32_bf16 v[148:151], v[20:23], v[56:59], v[148:151]
    s_add_u32 s72, s72, 32768
    s_and_b32 s72, s72, 0x1ffff
    ds_read_b128 v[4:7], v74 offset:0
    v_mfma_f32_16x16x32_bf16 v[152:155], v[20:23], v[60:63], v[152:155]
    ds_read_b64_tr_b16 v[36:37], v75 offset:0
    v_mfma_f32_16x16x32_bf16 v[156:159], v[20:23], v[64:67], v[156:159]
    ds_read_b64_tr_b16 v[38:39], v75 offset:2048
    ds_read_b64_tr_b16 v[40:41], v76 offset:0
    v_mfma_f32_16x16x32_bf16 v[160:163], v[24:27], v[52:55], v[160:163]
    ds_read_b64_tr_b16 v[42:43], v76 offset:2048
    v_mfma_f32_16x16x32_bf16 v[164:167], v[24:27], v[56:59], v[164:167]
    ds_read_b64_tr_b16 v[44:45], v77 offset:0
    ds_read_b64_tr_b16 v[46:47], v77 offset:2048
    v_mfma_f32_16x16x32_bf16 v[168:171], v[24:27], v[60:63], v[168:171]
    ds_read_b64_tr_b16 v[48:49], v78 offset:0
    v_mfma_f32_16x16x32_bf16 v[172:175], v[24:27], v[64:67], v[172:175]
    ds_read_b64_tr_b16 v[50:51], v78 offset:2048
    ds_read_b128 v[8:11], v74 offset:1024
    v_mfma_f32_16x16x32_bf16 v[176:179], v[28:31], v[52:55], v[176:179]
    ds_read_b128 v[12:15], v74 offset:2048
    ds_read_b128 v[16:19], v74 offset:3072
    v_mfma_f32_16x16x32_bf16 v[180:183], v[28:31], v[56:59], v[180:183]
    s_mov_b32 m0, s71
    v_mfma_f32_16x16x32_bf16 v[184:187], v[28:31], v[60:63], v[184:187]
    buffer_load_dwordx4 v68, s[60:63], s68 offen lds
    s_add_u32 m0, s71, 1024
    v_mfma_f32_16x16x32_bf16 v[188:191], v[28:31], v[64:67], v[188:191]
    buffer_load_dwordx4 v69, s[60:63], s68 offen lds
    v_mfma_f32_16x16x32_bf16 v[192:195], v[32:35], v[52:55], v[192:195]
    s_add_u32 m0, s71, 16384
    s_nop 0
    buffer_load_dwordx4 v70, s[64:67], s69 offen lds
    v_mfma_f32_16x16x32_bf16 v[196:199], v[32:35], v[56:59], v[196:199]
    s_add_u32 m0, s71, 17408
    v_mfma_f32_16x16x32_bf16 v[200:203], v[32:35], v[60:63], v[200:203]
    buffer_load_dwordx4 v71, s[64:67], s69 offen lds
    s_add_u32 s68, s68, 64
    s_add_u32 s69, s69, s70
    v_mfma_f32_16x16x32_bf16 v[204:207], v[32:35], v[64:67], v[204:207]
    s_add_u32 s71, s71, 32768
    s_and_b32 s71, s71, 0x1ffff
    s_sub_u32 s73, s73, 1
    s_cmp_lg_u32 s73, 0
    s_cbranch_scc1 gl_134
    s_waitcnt lgkmcnt(0)
    v_mfma_f32_16x16x32_bf16 v[80:83], v[4:7], v[36:39], v[80:83]
    ds_read_b128 v[20:23], v74 offset:4096
    v_mfma_f32_16x16x32_bf16 v[84:87], v[4:7], v[40:43], v[84:87]
    v_mfma_f32_16x16x32_bf16 v[88:91], v[4:7], v[44:47], v[88:91]
    ds_read_b128 v[24:27], v74 offset:5120
    v_mfma_f32_16x16x32_bf16 v[92:95], v[4:7], v[48:51], v[92:95]
    v_mfma_f32_16x16x32_bf16 v[96:99], v[8:11], v[36:39], v[96:99]
    ds_read_b128 v[28:31], v74 offset:6144
    v_mfma_f32_16x16x32_bf16 v[100:103], v[8:11], v[40:43], v[100:103]
    v_mfma_f32_16x16x32_bf16 v[104:107], v[8:11], v[44:47], v[104:107]
    ds_read_b128 v[32:35], v74 offset:7168
    v_mfma_f32_16x16x32_bf16 v[108:111], v[8:11], v[48:51], v[108:111]
    v_mfma_f32_16x16x32_bf16 v[112:115], v[12:15], v[36:39], v[112:115]
    v_mfma_f32_16x16x32_bf16 v[116:119], v[12:15], v[40:43], v[116:119]
    v_mfma_f32_16x16x32_bf16 v[120:123], v[12:15], v[44:47], v[120:123]
    v_mfma_f32_16x16x32_bf16 v[124:127], v[12:15], v[48:51], v[124:127]
    v_mfma_f32_16x16x32_bf16 v[128:131], v[16:19], v[36:39], v[128:131]
    v_mfma_f32_16x16x32_bf16 v[132:135], v[16:19], v[40:43], v[132:135]
    v_mfma_f32_16x16x32_bf16 v[136:139], v[16:19], v[44:47], v[136:139]
    v_mfma_f32_16x16x32_bf16 v[140:143], v[16:19], v[48:51], v[140:143]
    s_waitcnt vmcnt(8) lgkmcnt(0)
    s_barrier
    v_mfma_f32_16x16x32_bf16 v[144:147], v[20:23], v[36:39], v[144:147]
    v_add_u32 v74, s72, v72
    v_add_u32 v75, s72, v73
    v_mfma_f32_16x16x32_bf16 v[148:151], v[20:23], v[40:43], v[148:151]
    v_xor_b32 v76, 32, v75
    v_xor_b32 v77, 64, v75
    v_xor_b32 v78, 96, v75
    v_mfma_f32_16x16x32_bf16 v[152:155], v[20:23], v[44:47], v[152:155]
    s_add_u32 s72, s72, 32768
    s_and_b32 s72, s72, 0x1ffff
    v_mfma_f32_16x16x32_bf16 v[156:159], v[20:23], v[48:51], v[156:159]
    ds_read_b128 v[4:7], v74 offset:0
    v_mfma_f32_16x16x32_bf16 v[160:163], v[24:27], v[36:39], v[160:163]
    ds_read_b64_tr_b16 v[52:53], v75 offset:0
    v_mfma_f32_16x16x32_bf16 v[164:167], v[24:27], v[40:43], v[164:167]
    ds_read_b64_tr_b16 v[54:55], v75 offset:2048
    v_mfma_f32_16x16x32_bf16 v[168:171], v[24:27], v[44:47], v[168:171]
    ds_read_b64_tr_b16 v[56:57], v76 offset:0
    v_mfma_f32_16x16x32_bf16 v[172:175], v[24:27], v[48:51], v[172:175]
    ds_read_b64_tr_b16 v[58:59], v76 offset:2048
    v_mfma_f32_16x16x32_bf16 v[176:179], v[28:31], v[36:39], v[176:179]
    ds_read_b64_tr_b16 v[60:61], v77 offset:0
    v_mfma_f32_16x16x32_bf16 v[180:183], v[28:31], v[40:43], v[180:183]
    ds_read_b64_tr_b16 v[62:63], v77 offset:2048
    v_mfma_f32_16x16x32_bf16 v[184:187], v[28:31], v[44:47], v[184:187]
    ds_read_b64_tr_b16 v[64:65], v78 offset:0
    v_mfma_f32_16x16x32_bf16 v[188:191], v[28:31], v[48:51], v[188:191]
    ds_read_b64_tr_b16 v[66:67], v78 offset:2048
    v_mfma_f32_16x16x32_bf16 v[192:195], v[32:35], v[36:39], v[192:195]
    ds_read_b128 v[8:11], v74 offset:1024
    v_mfma_f32_16x16x32_bf16 v[196:199], v[32:35], v[40:43], v[196:199]
    ds_read_b128 v[12:15], v74 offset:2048
    v_mfma_f32_16x16x32_bf16 v[200:203], v[32:35], v[44:47], v[200:203]
    ds_read_b128 v[16:19], v74 offset:3072
    v_mfma_f32_16x16x32_bf16 v[204:207], v[32:35], v[48:51], v[204:207]
    s_waitcnt lgkmcnt(0)
    v_mfma_f32_16x16x32_bf16 v[80:83], v[4:7], v[52:55], v[80:83]
    ds_read_b128 v[20:23], v74 offset:4096
    v_mfma_f32_16x16x32_bf16 v[84:87], v[4:7], v[56:59], v[84:87]
    v_mfma_f32_16x16x32_bf16 v[88:91], v[4:7], v[60:63], v[88:91]
    ds_read_b128 v[24:27], v74 offset:5120
    v_mfma_f32_16x16x32_bf16 v[92:95], v[4:7], v[64:67], v[92:95]
    v_mfma_f32_16x16x32_bf16 v[96:99], v[8:11], v[52:55], v[96:99]
    ds_read_b128 v[28:31], v74 offset:6144
    v_mfma_f32_16x16x32_bf16 v[100:103], v[8:11], v[56:59], v[100:103]
    v_mfma_f32_16x16x32_bf16 v[104:107], v[8:11], v[60:63], v[104:107]
    ds_read_b128 v[32:35], v74 offset:7168
    v_mfma_f32_16x16x32_bf16 v[108:111], v[8:11], v[64:67], v[108:111]
    v_mfma_f32_16x16x32_bf16 v[112:115], v[12:15], v[52:55], v[112:115]
    v_mfma_f32_16x16x32_bf16 v[116:119], v[12:15], v[56:59], v[116:119]
    v_mfma_f32_16x16x32_bf16 v[120:123], v[12:15], v[60:63], v[120:123]
    v_mfma_f32_16x16x32_bf16 v[124:127], v[12:15], v[64:67], v[124:127]
    v_mfma_f32_16x16x32_bf16 v[128:131], v[16:19], v[52:55], v[128:131]
    v_mfma_f32_16x16x32_bf16 v[132:135], v[16:19], v[56:59], v[132:135]
    v_mfma_f32_16x16x32_bf16 v[136:139], v[16:19], v[60:63], v[136:139]
    v_mfma_f32_16x16x32_bf16 v[140:143], v[16:19], v[64:67], v[140:143]
    s_waitcnt vmcnt(4) lgkmcnt(0)
    s_barrier
    v_mfma_f32_16x16x32_bf16 v[144:147], v[20:23], v[52:55], v[144:147]
    v_add_u32 v74, s72, v72
    v_add_u32 v75, s72, v73
    v_mfma_f32_16x16x32_bf16 v[148:151], v[20:23], v[56:59], v[148:151]
    v_xor_b32 v76, 32, v75
    v_xor_b32 v77, 64, v75
    v_xor_b32 v78, 96, v75
    v_mfma_f32_16x16x32_bf16 v[152:155], v[20:23], v[60:63], v[152:155]
    s_add_u32 s72, s72, 32768
    s_and_b32 s72, s72, 0x1ffff
    v_mfma_f32_16x16x32_bf16 v[156:159], v[20:23], v[64:67], v[156:159]
    ds_read_b128 v[4:7], v74 offset:0
    v_mfma_f32_16x16x32_bf16 v[160:163], v[24:27], v[52:55], v[160:163]
    ds_read_b64_tr_b16 v[36:37], v75 offset:0
    v_mfma_f32_16x16x32_bf16 v[164:167], v[24:27], v[56:59], v[164:167]
    ds_read_b64_tr_b16 v[38:39], v75 offset:2048
    v_mfma_f32_16x16x32_bf16 v[168:171], v[24:27], v[60:63], v[168:171]
    ds_read_b64_tr_b16 v[40:41], v76 offset:0
    v_mfma_f32_16x16x32_bf16 v[172:175], v[24:27], v[64:67], v[172:175]
    ds_read_b64_tr_b16 v[42:43], v76 offset:2048
    v_mfma_f32_16x16x32_bf16 v[176:179], v[28:31], v[52:55], v[176:179]
    ds_read_b64_tr_b16 v[44:45], v77 offset:0
    v_mfma_f32_16x16x32_bf16 v[180:183], v[28:31], v[56:59], v[180:183]
    ds_read_b64_tr_b16 v[46:47], v77 offset:2048
    v_mfma_f32_16x16x32_bf16 v[184:187], v[28:31], v[60:63], v[184:187]
    ds_read_b64_tr_b16 v[48:49], v78 offset:0
    v_mfma_f32_16x16x32_bf16 v[188:191], v[28:31], v[64:67], v[188:191]
    ds_read_b64_tr_b16 v[50:51], v78 offset:2048
    v_mfma_f32_16x16x32_bf16 v[192:195], v[32:35], v[52:55], v[192:195]
    ds_read_b128 v[8:11], v74 offset:1024
    v_mfma_f32_16x16x32_bf16 v[196:199], v[32:35], v[56:59], v[196:199]
    ds_read_b128 v[12:15], v74 offset:2048
    v_mfma_f32_16x16x32_bf16 v[200:203], v[32:35], v[60:63], v[200:203]
    ds_read_b128 v[16:19], v74 offset:3072
    v_mfma_f32_16x16x32_bf16 v[204:207], v[32:35], v[64:67], v[204:207]
    s_waitcnt lgkmcnt(0)
    v_mfma_f32_16x16x32_bf16 v[80:83], v[4:7], v[36:39], v[80:83]
    ds_read_b128 v[20:23], v74 offset:4096
    v_mfma_f32_16x16x32_bf16 v[84:87], v[4:7], v[40:43], v[84:87]
    v_mfma_f32_16x16x32_bf16 v[88:91], v[4:7], v[44:47], v[88:91]
    ds_read_b128 v[24:27], v74 offset:5120
    v_mfma_f32_16x16x32_bf16 v[92:95], v[4:7], v[48:51], v[92:95]
    v_mfma_f32_16x16x32_bf16 v[96:99], v[8:11], v[36:39], v[96:99]
    ds_read_b128 v[28:31], v74 offset:6144
    v_mfma_f32_16x16x32_bf16 v[100:103], v[8:11], v[40:43], v[100:103]
    v_mfma_f32_16x16x32_bf16 v[104:107], v[8:11], v[44:47], v[104:107]
    ds_read_b128 v[32:35], v74 offset:7168
    v_mfma_f32_16x16x32_bf16 v[108:111], v[8:11], v[48:51], v[108:111]
    v_mfma_f32_16x16x32_bf16 v[112:115], v[12:15], v[36:39], v[112:115]
    v_mfma_f32_16x16x32_bf16 v[116:119], v[12:15], v[40:43], v[116:119]
    v_mfma_f32_16x16x32_bf16 v[120:123], v[12:15], v[44:47], v[120:123]
    v_mfma_f32_16x16x32_bf16 v[124:127], v[12:15], v[48:51], v[124:127]
    v_mfma_f32_16x16x32_bf16 v[128:131], v[16:19], v[36:39], v[128:131]
    v_mfma_f32_16x16x32_bf16 v[132:135], v[16:19], v[40:43], v[132:135]
    v_mfma_f32_16x16x32_bf16 v[136:139], v[16:19], v[44:47], v[136:139]
    v_mfma_f32_16x16x32_bf16 v[140:143], v[16:19], v[48:51], v[140:143]
    s_waitcnt vmcnt(0) lgkmcnt(0)
    s_barrier
    v_mfma_f32_16x16x32_bf16 v[144:147], v[20:23], v[36:39], v[144:147]
    v_add_u32 v74, s72, v72
    v_add_u32 v75, s72, v73
    v_mfma_f32_16x16x32_bf16 v[148:151], v[20:23], v[40:43], v[148:151]
    v_xor_b32 v76, 32, v75
    v_xor_b32 v77, 64, v75
    v_xor_b32 v78, 96, v75
    v_mfma_f32_16x16x32_bf16 v[152:155], v[20:23], v[44:47], v[152:155]
    s_add_u32 s72, s72, 32768
    s_and_b32 s72, s72, 0x1ffff
    v_mfma_f32_16x16x32_bf16 v[156:159], v[20:23], v[48:51], v[156:159]
    ds_read_b128 v[4:7], v74 offset:0
    v_mfma_f32_16x16x32_bf16 v[160:163], v[24:27], v[36:39], v[160:163]
    ds_read_b64_tr_b16 v[52:53], v75 offset:0
    v_mfma_f32_16x16x32_bf16 v[164:167], v[24:27], v[40:43], v[164:167]
    ds_read_b64_tr_b16 v[54:55], v75 offset:2048
    v_mfma_f32_16x16x32_bf16 v[168:171], v[24:27], v[44:47], v[168:171]
    ds_read_b64_tr_b16 v[56:57], v76 offset:0
    v_mfma_f32_16x16x32_bf16 v[172:175], v[24:27], v[48:51], v[172:175]
    ds_read_b64_tr_b16 v[58:59], v76 offset:2048
    v_mfma_f32_16x16x32_bf16 v[176:179], v[28:31], v[36:39], v[176:179]
    ds_read_b64_tr_b16 v[60:61], v77 offset:0
    v_mfma_f32_16x16x32_bf16 v[180:183], v[28:31], v[40:43], v[180:183]
    ds_read_b64_tr_b16 v[62:63], v77 offset:2048
    v_mfma_f32_16x16x32_bf16 v[184:187], v[28:31], v[44:47], v[184:187]
    ds_read_b64_tr_b16 v[64:65], v78 offset:0
    v_mfma_f32_16x16x32_bf16 v[188:191], v[28:31], v[48:51], v[188:191]
    ds_read_b64_tr_b16 v[66:67], v78 offset:2048
    v_mfma_f32_16x16x32_bf16 v[192:195], v[32:35], v[36:39], v[192:195]
    ds_read_b128 v[8:11], v74 offset:1024
    v_mfma_f32_16x16x32_bf16 v[196:199], v[32:35], v[40:43], v[196:199]
    ds_read_b128 v[12:15], v74 offset:2048
    v_mfma_f32_16x16x32_bf16 v[200:203], v[32:35], v[44:47], v[200:203]
    ds_read_b128 v[16:19], v74 offset:3072
    v_mfma_f32_16x16x32_bf16 v[204:207], v[32:35], v[48:51], v[204:207]
    s_waitcnt lgkmcnt(0)
    v_mfma_f32_16x16x32_bf16 v[80:83], v[4:7], v[52:55], v[80:83]
    ds_read_b128 v[20:23], v74 offset:4096
    v_mfma_f32_16x16x32_bf16 v[84:87], v[4:7], v[56:59], v[84:87]
    v_mfma_f32_16x16x32_bf16 v[88:91], v[4:7], v[60:63], v[88:91]
    ds_read_b128 v[24:27], v74 offset:5120
    v_mfma_f32_16x16x32_bf16 v[92:95], v[4:7], v[64:67], v[92:95]
    v_mfma_f32_16x16x32_bf16 v[96:99], v[8:11], v[52:55], v[96:99]
    ds_read_b128 v[28:31], v74 offset:6144
    v_mfma_f32_16x16x32_bf16 v[100:103], v[8:11], v[56:59], v[100:103]
    v_mfma_f32_16x16x32_bf16 v[104:107], v[8:11], v[60:63], v[104:107]
    ds_read_b128 v[32:35], v74 offset:7168
    v_mfma_f32_16x16x32_bf16 v[108:111], v[8:11], v[64:67], v[108:111]
    v_mfma_f32_16x16x32_bf16 v[112:115], v[12:15], v[52:55], v[112:115]
    v_mfma_f32_16x16x32_bf16 v[116:119], v[12:15], v[56:59], v[116:119]
    v_mfma_f32_16x16x32_bf16 v[120:123], v[12:15], v[60:63], v[120:123]
    v_mfma_f32_16x16x32_bf16 v[124:127], v[12:15], v[64:67], v[124:127]
    v_mfma_f32_16x16x32_bf16 v[128:131], v[16:19], v[52:55], v[128:131]
    v_mfma_f32_16x16x32_bf16 v[132:135], v[16:19], v[56:59], v[132:135]
    v_mfma_f32_16x16x32_bf16 v[136:139], v[16:19], v[60:63], v[136:139]
    v_mfma_f32_16x16x32_bf16 v[140:143], v[16:19], v[64:67], v[140:143]
    s_waitcnt lgkmcnt(0)
    v_mfma_f32_16x16x32_bf16 v[144:147], v[20:23], v[52:55], v[144:147]
    v_mfma_f32_16x16x32_bf16 v[148:151], v[20:23], v[56:59], v[148:151]
    v_mfma_f32_16x16x32_bf16 v[152:155], v[20:23], v[60:63], v[152:155]
    v_mfma_f32_16x16x32_bf16 v[156:159], v[20:23], v[64:67], v[156:159]
    v_mfma_f32_16x16x32_bf16 v[160:163], v[24:27], v[52:55], v[160:163]
    v_mfma_f32_16x16x32_bf16 v[164:167], v[24:27], v[56:59], v[164:167]
    v_mfma_f32_16x16x32_bf16 v[168:171], v[24:27], v[60:63], v[168:171]
    v_mfma_f32_16x16x32_bf16 v[172:175], v[24:27], v[64:67], v[172:175]
    v_mfma_f32_16x16x32_bf16 v[176:179], v[28:31], v[52:55], v[176:179]
    v_mfma_f32_16x16x32_bf16 v[180:183], v[28:31], v[56:59], v[180:183]
    v_mfma_f32_16x16x32_bf16 v[184:187], v[28:31], v[60:63], v[184:187]
    v_mfma_f32_16x16x32_bf16 v[188:191], v[28:31], v[64:67], v[188:191]
    v_mfma_f32_16x16x32_bf16 v[192:195], v[32:35], v[52:55], v[192:195]
    v_mfma_f32_16x16x32_bf16 v[196:199], v[32:35], v[56:59], v[196:199]
    v_mfma_f32_16x16x32_bf16 v[200:203], v[32:35], v[60:63], v[200:203]
    v_mfma_f32_16x16x32_bf16 v[204:207], v[32:35], v[64:67], v[204:207]
    s_lshl_b32 s85, s80, 2
    s_and_b32 s81, s58, 3
    s_add_u32 s85, s85, s81
    s_lshl_b32 s85, s85, 6
    v_and_b32 v77, 15, v1
    v_add_u32 v77, s85, v77
    v_bfe_u32 v76, v77, 3, 5
    v_lshlrev_b32 v76, 12, v76
    v_bfe_u32 v75, v77, 10, 1
    v_lshl_or_b32 v76, v75, 17, v76
    v_bfe_u32 v75, v77, 0, 2
    v_lshl_or_b32 v76, v75, 18, v76
    v_bfe_u32 v75, v77, 8, 1
    v_lshl_or_b32 v76, v75, 20, v76
    v_bfe_u32 v75, v77, 2, 1
    v_lshl_or_b32 v76, v75, 21, v76
    v_bfe_u32 v75, v77, 9, 1
    v_lshl_or_b32 v76, v75, 22, v76
    v_bfe_u32 v77, v1, 4, 2
    v_lshlrev_b32 v77, 4, v77
    v_add_u32 v76, v76, v77
    s_lshl_b32 s81, s79, 9
    s_lshr_b32 s85, s58, 2
    s_lshl_b32 s85, s85, 8
    s_add_u32 s81, s81, s85
    v_cvt_pk_bf16_f32 v4, v80, v81
    v_cvt_pk_bf16_f32 v5, v82, v83
    v_cvt_pk_bf16_f32 v6, v96, v97
    v_cvt_pk_bf16_f32 v7, v98, v99
    buffer_store_dwordx4 v[4:7], v76, s[16:19], s81 offen offset:0
    v_cvt_pk_bf16_f32 v8, v112, v113
    v_cvt_pk_bf16_f32 v9, v114, v115
    v_cvt_pk_bf16_f32 v10, v128, v129
    v_cvt_pk_bf16_f32 v11, v130, v131
    buffer_store_dwordx4 v[8:11], v76, s[16:19], s81 offen offset:64
    v_cvt_pk_bf16_f32 v12, v144, v145
    v_cvt_pk_bf16_f32 v13, v146, v147
    v_cvt_pk_bf16_f32 v14, v160, v161
    v_cvt_pk_bf16_f32 v15, v162, v163
    buffer_store_dwordx4 v[12:15], v76, s[16:19], s81 offen offset:128
    v_cvt_pk_bf16_f32 v16, v176, v177
    v_cvt_pk_bf16_f32 v17, v178, v179
    v_cvt_pk_bf16_f32 v18, v192, v193
    v_cvt_pk_bf16_f32 v19, v194, v195
    buffer_store_dwordx4 v[16:19], v76, s[16:19], s81 offen offset:192
    s_add_u32 s81, s81, 8192
    v_cvt_pk_bf16_f32 v20, v84, v85
    v_cvt_pk_bf16_f32 v21, v86, v87
    v_cvt_pk_bf16_f32 v22, v100, v101
    v_cvt_pk_bf16_f32 v23, v102, v103
    buffer_store_dwordx4 v[20:23], v76, s[16:19], s81 offen offset:0
    v_cvt_pk_bf16_f32 v24, v116, v117
    v_cvt_pk_bf16_f32 v25, v118, v119
    v_cvt_pk_bf16_f32 v26, v132, v133
    v_cvt_pk_bf16_f32 v27, v134, v135
    buffer_store_dwordx4 v[24:27], v76, s[16:19], s81 offen offset:64
    v_cvt_pk_bf16_f32 v28, v148, v149
    v_cvt_pk_bf16_f32 v29, v150, v151
    v_cvt_pk_bf16_f32 v30, v164, v165
    v_cvt_pk_bf16_f32 v31, v166, v167
    buffer_store_dwordx4 v[28:31], v76, s[16:19], s81 offen offset:128
    v_cvt_pk_bf16_f32 v32, v180, v181
    v_cvt_pk_bf16_f32 v33, v182, v183
    v_cvt_pk_bf16_f32 v34, v196, v197
    v_cvt_pk_bf16_f32 v35, v198, v199
    buffer_store_dwordx4 v[32:35], v76, s[16:19], s81 offen offset:192
    s_add_u32 s81, s81, 8192
    v_cvt_pk_bf16_f32 v36, v88, v89
    v_cvt_pk_bf16_f32 v37, v90, v91
    v_cvt_pk_bf16_f32 v38, v104, v105
    v_cvt_pk_bf16_f32 v39, v106, v107
    buffer_store_dwordx4 v[36:39], v76, s[16:19], s81 offen offset:0
    v_cvt_pk_bf16_f32 v40, v120, v121
    v_cvt_pk_bf16_f32 v41, v122, v123
    v_cvt_pk_bf16_f32 v42, v136, v137
    v_cvt_pk_bf16_f32 v43, v138, v139
    buffer_store_dwordx4 v[40:43], v76, s[16:19], s81 offen offset:64
    v_cvt_pk_bf16_f32 v44, v152, v153
    v_cvt_pk_bf16_f32 v45, v154, v155
    v_cvt_pk_bf16_f32 v46, v168, v169
    v_cvt_pk_bf16_f32 v47, v170, v171
    buffer_store_dwordx4 v[44:47], v76, s[16:19], s81 offen offset:128
    v_cvt_pk_bf16_f32 v48, v184, v185
    v_cvt_pk_bf16_f32 v49, v186, v187
    v_cvt_pk_bf16_f32 v50, v200, v201
    v_cvt_pk_bf16_f32 v51, v202, v203
    buffer_store_dwordx4 v[48:51], v76, s[16:19], s81 offen offset:192
    s_add_u32 s81, s81, 8192
    v_cvt_pk_bf16_f32 v52, v92, v93
    v_cvt_pk_bf16_f32 v53, v94, v95
    v_cvt_pk_bf16_f32 v54, v108, v109
    v_cvt_pk_bf16_f32 v55, v110, v111
    buffer_store_dwordx4 v[52:55], v76, s[16:19], s81 offen offset:0
    v_cvt_pk_bf16_f32 v56, v124, v125
    v_cvt_pk_bf16_f32 v57, v126, v127
    v_cvt_pk_bf16_f32 v58, v140, v141
    v_cvt_pk_bf16_f32 v59, v142, v143
    buffer_store_dwordx4 v[56:59], v76, s[16:19], s81 offen offset:64
    v_cvt_pk_bf16_f32 v60, v156, v157
    v_cvt_pk_bf16_f32 v61, v158, v159
    v_cvt_pk_bf16_f32 v62, v172, v173
    v_cvt_pk_bf16_f32 v63, v174, v175
    buffer_store_dwordx4 v[60:63], v76, s[16:19], s81 offen offset:128
    v_cvt_pk_bf16_f32 v64, v188, v189
    v_cvt_pk_bf16_f32 v65, v190, v191
    v_cvt_pk_bf16_f32 v66, v204, v205
    v_cvt_pk_bf16_f32 v67, v206, v207
    buffer_store_dwordx4 v[64:67], v76, s[16:19], s81 offen offset:192
    s_add_u32 s81, s81, 8192
    v_mov_b32 v75, 163760
    v_mov_b32 v76, 0
    s_barrier
    ds_write_b32 v75, v76
    s_waitcnt lgkmcnt(0)
    s_barrier
    v_lshlrev_b32 v5, 4, v1
    v_bfe_u32 v6, v1, 0, 3
    v_lshlrev_b32 v6, 4, v6
    v_bfe_u32 v3, v1, 5, 1
    v_lshl_or_b32 v6, v3, 7, v6
    v_lshlrev_b32 v7, 3, v1
    v_bfe_u32 v2, v1, 5, 1
    v_lshlrev_b32 v2, 2, v2
    v_and_b32 v8, 31, v1
    v_sub_u32 v8, v8, v2
    s_mov_b32 s89, 0x3e0293ee
    s_and_b32 s86, s57, 7
    s_mov_b32 s92, 0
    s_mov_b32 s91, 0
    s_mov_b32 s93, 0
    v_mov_b32 v9, 163760
    s_add_u32 s93, s93, 1
    s_cmp_lg_u32 s58, 0
    s_cbranch_scc1 at_f_138
    s_cmp_eq_u32 s92, 2097216
    s_cbranch_scc1 at_rb_140
    s_max_u32 s88, s86, 2
    s_sub_u32 s88, s88, 2
    s_and_b32 s88, s88, -4
pollrb_141:
    buffer_load_dword v2, off, s[12:15], s88 offset:160 sc1
    buffer_load_dword v3, off, s[12:15], 0 offset:220 sc1
    s_waitcnt vmcnt(0)
    v_cmp_ne_u32 vcc, 2097216, v2
    s_cbranch_vccz pollrb_ok_142
    s_sub_u32 s77, s77, 1
    s_cbranch_scc0 pollrb_141
    s_mov_b32 s77, 0
pollrb_ok_142:
    v_readfirstlane_b32 s92, v3
at_rb_140:
    v_mov_b32 v2, s93
    ds_write_b32 v9, v2
at_f_138:
    ds_read_b32 v2, v9
    s_waitcnt lgkmcnt(0)
    v_cmp_gt_u32 vcc, s93, v2
    s_cbranch_vccz at_d_139
    s_sub_u32 s77, s77, 1
    s_cbranch_scc0 at_f_138
    s_mov_b32 s77, 0
at_d_139:
    s_lshl_b32 s94, s86, 2
    s_add_u32 s94, s94, s75
    s_lshl_b32 s94, s94, 3
    s_add_u32 s94, s94, s58
    s_lshl_b32 s94, s94, 13
    s_add_u32 s88, s94, 0x0
    buffer_load_dwordx4 v[12:15], v5, s[8:11], s88 offen offset:0 sc1
    buffer_load_dwordx4 v[16:19], v5, s[8:11], s88 offen offset:1024 sc1
    buffer_load_dwordx4 v[20:23], v5, s[8:11], s88 offen offset:2048 sc1
    buffer_load_dwordx4 v[24:27], v5, s[8:11], s88 offen offset:3072 sc1
    s_add_u32 s88, s88, 4096
    buffer_load_dwordx4 v[28:31], v5, s[8:11], s88 offen offset:0 sc1
    buffer_load_dwordx4 v[32:35], v5, s[8:11], s88 offen offset:1024 sc1
    buffer_load_dwordx4 v[36:39], v5, s[8:11], s88 offen offset:2048 sc1
    buffer_load_dwordx4 v[40:43], v5, s[8:11], s88 offen offset:3072 sc1
    s_add_u32 s88, s94, 0x1000000
    buffer_load_dwordx4 v[44:47], v5, s[8:11], s88 offen offset:0 sc1
    buffer_load_dwordx4 v[48:51], v5, s[8:11], s88 offen offset:1024 sc1
    buffer_load_dwordx4 v[52:55], v5, s[8:11], s88 offen offset:2048 sc1
    buffer_load_dwordx4 v[56:59], v5, s[8:11], s88 offen offset:3072 sc1
    s_add_u32 s88, s88, 4096
    buffer_load_dwordx4 v[60:63], v5, s[8:11], s88 offen offset:0 sc1
    buffer_load_dwordx4 v[64:67], v5, s[8:11], s88 offen offset:1024 sc1
    buffer_load_dwordx4 v[68:71], v5, s[8:11], s88 offen offset:2048 sc1
    buffer_load_dwordx4 v[72:75], v5, s[8:11], s88 offen offset:3072 sc1
    s_add_u32 s88, s94, 0x2000000
    buffer_load_dwordx4 v[76:79], v5, s[8:11], s88 offen offset:0 sc1
    buffer_load_dwordx4 v[80:83], v5, s[8:11], s88 offen offset:1024 sc1
    buffer_load_dwordx4 v[84:87], v5, s[8:11], s88 offen offset:2048 sc1
    buffer_load_dwordx4 v[88:91], v5, s[8:11], s88 offen offset:3072 sc1
    s_add_u32 s88, s88, 4096
    buffer_load_dwordx4 v[92:95], v5, s[8:11], s88 offen offset:0 sc1
    buffer_load_dwordx4 v[96:99], v5, s[8:11], s88 offen offset:1024 sc1
    buffer_load_dwordx4 v[100:103], v5, s[8:11], s88 offen offset:2048 sc1
    buffer_load_dwordx4 v[104:107], v5, s[8:11], s88 offen offset:3072 sc1
at_loop_135:
    s_mov_b32 s90, s94
    s_add_u32 s93, s93, 1
    s_cmp_lg_u32 s58, 0
    s_cbranch_scc1 at_f_143
    s_cmp_ge_u32 s86, 48
    s_cselect_b32 s88, 1, 2
    s_add_u32 s88, s88, s86
    s_min_u32 s88, s88, 62
    s_cmp_ge_u32 s91, s88
    s_cbranch_scc1 at_go_137
pollprog_145:
    buffer_load_dword v4, off, s[12:15], 0 offset:64 sc1
    s_waitcnt vmcnt(0)
    v_cmp_gt_u32 vcc, s88, v4
    s_cbranch_vccz pollprog_ok_146
    s_sub_u32 s77, s77, 1
    s_cbranch_scc0 pollprog_145
    s_mov_b32 s77, 0
pollprog_ok_146:
    v_readfirstlane_b32 s91, v4
at_go_137:
    v_mov_b32 v2, s93
    ds_write_b32 v9, v2
at_f_143:
    ds_read_b32 v2, v9
    s_waitcnt lgkmcnt(0)
    v_cmp_gt_u32 vcc, s93, v2
    s_cbranch_vccz at_d_144
    s_sub_u32 s77, s77, 1
    s_cbranch_scc0 at_f_143
    s_mov_b32 s77, 0
at_d_144:
    s_lshr_b32 s88, s90, 2
    s_add_u32 s87, s88, 0x4400000
    s_add_u32 s88, s88, 0x4000000
    buffer_load_dwordx4 v[108:111], v6, s[8:11], s88 offen offset:0 sc1
    buffer_load_dwordx4 v[112:115], v6, s[8:11], s88 offen offset:256 sc1
    buffer_load_dwordx4 v[116:119], v6, s[8:11], s88 offen offset:512 sc1
    buffer_load_dwordx4 v[120:123], v6, s[8:11], s88 offen offset:768 sc1
    buffer_load_dwordx4 v[124:127], v6, s[8:11], s88 offen offset:1024 sc1
    buffer_load_dwordx4 v[128:131], v6, s[8:11], s88 offen offset:1280 sc1
    buffer_load_dwordx4 v[132:135], v6, s[8:11], s88 offen offset:1536 sc1
    buffer_load_dwordx4 v[136:139], v6, s[8:11], s88 offen offset:1792 sc1
    buffer_load_dwordx2 v[236:237], v7, s[8:11], s87 offen offset:0 sc1
    buffer_load_dwordx2 v[238:239], v7, s[8:11], s87 offen offset:512 sc1
    buffer_load_dwordx2 v[240:241], v7, s[8:11], s87 offen offset:1024 sc1
    buffer_load_dwordx2 v[242:243], v7, s[8:11], s87 offen offset:1536 sc1
    s_waitcnt vmcnt(27)
    v_mfma_f32_32x32x16_bf16 v[140:155], v[44:47], v[12:15], 0
    s_waitcnt vmcnt(26)
    v_mfma_f32_32x32x16_bf16 v[140:155], v[48:51], v[16:19], v[140:155]
    s_waitcnt vmcnt(25)
    v_mfma_f32_32x32x16_bf16 v[140:155], v[52:55], v[20:23], v[140:155]
    s_waitcnt vmcnt(24)
    v_mfma_f32_32x32x16_bf16 v[140:155], v[56:59], v[24:27], v[140:155]
    s_waitcnt vmcnt(23)
    v_mfma_f32_32x32x16_bf16 v[140:155], v[60:63], v[28:31], v[140:155]
    s_waitcnt vmcnt(22)
    v_mfma_f32_32x32x16_bf16 v[140:155], v[64:67], v[32:35], v[140:155]
    s_waitcnt vmcnt(21)
    v_mfma_f32_32x32x16_bf16 v[140:155], v[68:71], v[36:39], v[140:155]
    s_waitcnt vmcnt(20)
    v_mfma_f32_32x32x16_bf16 v[140:155], v[72:75], v[40:43], v[140:155]
    v_mov_b32 v3, 0xff800000
    v_cmp_le_i32 vcc, 0, v8
    s_nop 9
    v_cndmask_b32 v140, v3, v140, vcc
    v_cmp_le_i32 vcc, 1, v8
    s_nop 1
    v_cndmask_b32 v141, v3, v141, vcc
    v_cmp_le_i32 vcc, 2, v8
    s_nop 1
    v_cndmask_b32 v142, v3, v142, vcc
    v_cmp_le_i32 vcc, 3, v8
    s_nop 1
    v_cndmask_b32 v143, v3, v143, vcc
    v_cmp_le_i32 vcc, 8, v8
    s_nop 1
    v_cndmask_b32 v144, v3, v144, vcc
    v_cmp_le_i32 vcc, 9, v8
    s_nop 1
    v_cndmask_b32 v145, v3, v145, vcc
    v_cmp_le_i32 vcc, 10, v8
    s_nop 1
    v_cndmask_b32 v146, v3, v146, vcc
    v_cmp_le_i32 vcc, 11, v8
    s_nop 1
    v_cndmask_b32 v147, v3, v147, vcc
    v_cmp_le_i32 vcc, 16, v8
    s_nop 1
    v_cndmask_b32 v148, v3, v148, vcc
    v_cmp_le_i32 vcc, 17, v8
    s_nop 1
    v_cndmask_b32 v149, v3, v149, vcc
    v_cmp_le_i32 vcc, 18, v8
    s_nop 1
    v_cndmask_b32 v150, v3, v150, vcc
    v_cmp_le_i32 vcc, 19, v8
    s_nop 1
    v_cndmask_b32 v151, v3, v151, vcc
    v_cmp_le_i32 vcc, 24, v8
    s_nop 1
    v_cndmask_b32 v152, v3, v152, vcc
    v_cmp_le_i32 vcc, 25, v8
    s_nop 1
    v_cndmask_b32 v153, v3, v153, vcc
    v_cmp_le_i32 vcc, 26, v8
    s_nop 1
    v_cndmask_b32 v154, v3, v154, vcc
    v_cmp_le_i32 vcc, 27, v8
    s_nop 1
    v_cndmask_b32 v155, v3, v155, vcc
    v_max3_f32 v244, v140, v141, v142
    v_max3_f32 v244, v244, v143, v144
    v_max3_f32 v244, v244, v145, v146
    v_max3_f32 v244, v244, v147, v148
    v_max3_f32 v244, v244, v149, v150
    v_max3_f32 v244, v244, v151, v152
    v_max3_f32 v244, v244, v153, v154
    s_waitcnt vmcnt(0)
    v_max3_u32 v2, v108, v112, v116
    v_max3_u32 v2, v2, v120, v124
    v_max3_u32 v2, v2, v128, v132
    v_max_u32 v2, v2, v136
    v_cmp_eq_u32 vcc, -1, v2
    s_cbranch_vccz pollkm_ok_148
pollkm_147:
    buffer_load_dwordx4 v[108:111], v6, s[8:11], s88 offen offset:0 sc1
    buffer_load_dwordx4 v[112:115], v6, s[8:11], s88 offen offset:256 sc1
    buffer_load_dwordx4 v[116:119], v6, s[8:11], s88 offen offset:512 sc1
    buffer_load_dwordx4 v[120:123], v6, s[8:11], s88 offen offset:768 sc1
    buffer_load_dwordx4 v[124:127], v6, s[8:11], s88 offen offset:1024 sc1
    buffer_load_dwordx4 v[128:131], v6, s[8:11], s88 offen offset:1280 sc1
    buffer_load_dwordx4 v[132:135], v6, s[8:11], s88 offen offset:1536 sc1
    buffer_load_dwordx4 v[136:139], v6, s[8:11], s88 offen offset:1792 sc1
    buffer_load_dwordx2 v[236:237], v7, s[8:11], s87 offen offset:0 sc1
    buffer_load_dwordx2 v[238:239], v7, s[8:11], s87 offen offset:512 sc1
    buffer_load_dwordx2 v[240:241], v7, s[8:11], s87 offen offset:1024 sc1
    buffer_load_dwordx2 v[242:243], v7, s[8:11], s87 offen offset:1536 sc1
    s_waitcnt vmcnt(0)
    v_max3_u32 v2, v108, v112, v116
    v_max3_u32 v2, v2, v120, v124
    v_max3_u32 v2, v2, v128, v132
    v_max_u32 v2, v2, v136
    v_cmp_eq_u32 vcc, -1, v2
    s_cbranch_vccz pollkm_ok_148
    s_sub_u32 s77, s77, 1
    s_cbranch_scc0 pollkm_147
    s_mov_b32 s77, 0
pollkm_ok_148:
    v_mfma_f32_32x32x16_bf16 v[172:187], v[108:111], v[12:15], 0
    v_mfma_f32_32x32x16_bf16 v[156:171], v[112:115], v[16:19], 0
    v_mfma_f32_32x32x16_bf16 v[172:187], v[116:119], v[20:23], v[172:187]
    v_mfma_f32_32x32x16_bf16 v[156:171], v[120:123], v[24:27], v[156:171]
    v_mfma_f32_32x32x16_bf16 v[172:187], v[124:127], v[28:31], v[172:187]
    v_mfma_f32_32x32x16_bf16 v[156:171], v[128:131], v[32:35], v[156:171]
    v_mfma_f32_32x32x16_bf16 v[172:187], v[132:135], v[36:39], v[172:187]
    v_mfma_f32_32x32x16_bf16 v[156:171], v[136:139], v[40:43], v[156:171]
    v_max3_u32 v3, v236, v238, v240
    v_max_u32 v3, v3, v242
    v_cmp_eq_u32 vcc, -1, v3
    s_cbranch_vccz at_v_149
    buffer_load_dwordx2 v[236:237], v7, s[8:11], s87 offen offset:0 sc1
    buffer_load_dwordx2 v[238:239], v7, s[8:11], s87 offen offset:512 sc1
    buffer_load_dwordx2 v[240:241], v7, s[8:11], s87 offen offset:1024 sc1
    buffer_load_dwordx2 v[242:243], v7, s[8:11], s87 offen offset:1536 sc1
at_v_149:
    s_mov_b64 s[2:3], vcc
    s_add_u32 s86, s86, 8
    s_mov_b32 s94, 0x5ffffff0
    s_cmp_ge_u32 s86, 64
    s_cbranch_scc1 at_nf_150
    s_add_u32 s93, s93, 1
    s_cmp_lg_u32 s58, 0
    s_cbranch_scc1 at_f_151
    s_cmp_eq_u32 s92, 2097216
    s_cbranch_scc1 at_rb_153
    s_max_u32 s88, s86, 2
    s_sub_u32 s88, s88, 2
    s_and_b32 s88, s88, -4
pollrb_154:
    buffer_load_dword v2, off, s[12:15], s88 offset:160 sc1
    buffer_load_dword v3, off, s[12:15], 0 offset:220 sc1
    s_waitcnt vmcnt(0)
    v_cmp_ne_u32 vcc, 2097216, v2
    s_cbranch_vccz pollrb_ok_155
    s_sub_u32 s77, s77, 1
    s_cbranch_scc0 pollrb_154
    s_mov_b32 s77, 0
pollrb_ok_155:
    v_readfirstlane_b32 s92, v3
at_rb_153:
    v_mov_b32 v2, s93
    ds_write_b32 v9, v2
at_f_151:
    ds_read_b32 v2, v9
    s_waitcnt lgkmcnt(0)
    v_cmp_gt_u32 vcc, s93, v2
    s_cbranch_vccz at_d_152
    s_sub_u32 s77, s77, 1
    s_cbranch_scc0 at_f_151
    s_mov_b32 s77, 0
at_d_152:
    s_lshl_b32 s94, s86, 2
    s_add_u32 s94, s94, s75
    s_lshl_b32 s94, s94, 3
    s_add_u32 s94, s94, s58
    s_lshl_b32 s94, s94, 13
    s_add_u32 s88, s94, 0x0
    buffer_load_dwordx4 v[12:15], v5, s[8:11], s88 offen offset:0 sc1
    buffer_load_dwordx4 v[16:19], v5, s[8:11], s88 offen offset:1024 sc1
    buffer_load_dwordx4 v[20:23], v5, s[8:11], s88 offen offset:2048 sc1
    buffer_load_dwordx4 v[24:27], v5, s[8:11], s88 offen offset:3072 sc1
    s_add_u32 s88, s88, 4096
    buffer_load_dwordx4 v[28:31], v5, s[8:11], s88 offen offset:0 sc1
    buffer_load_dwordx4 v[32:35], v5, s[8:11], s88 offen offset:1024 sc1
    buffer_load_dwordx4 v[36:39], v5, s[8:11], s88 offen offset:2048 sc1
    buffer_load_dwordx4 v[40:43], v5, s[8:11], s88 offen offset:3072 sc1
    s_add_u32 s88, s94, 0x1000000
    buffer_load_dwordx4 v[44:47], v5, s[8:11], s88 offen offset:0 sc1
    buffer_load_dwordx4 v[48:51], v5, s[8:11], s88 offen offset:1024 sc1
    buffer_load_dwordx4 v[52:55], v5, s[8:11], s88 offen offset:2048 sc1
    buffer_load_dwordx4 v[56:59], v5, s[8:11], s88 offen offset:3072 sc1
    s_add_u32 s88, s88, 4096
    buffer_load_dwordx4 v[60:63], v5, s[8:11], s88 offen offset:0 sc1
    buffer_load_dwordx4 v[64:67], v5, s[8:11], s88 offen offset:1024 sc1
    buffer_load_dwordx4 v[68:71], v5, s[8:11], s88 offen offset:2048 sc1
    buffer_load_dwordx4 v[72:75], v5, s[8:11], s88 offen offset:3072 sc1
at_nf_150:
    s_nop 2
    v_pk_add_f32 v[156:157], v[156:157], v[172:173]
    v_pk_add_f32 v[158:159], v[158:159], v[174:175]
    v_max3_f32 v2, v244, v155, v156
    v_max3_f32 v2, v2, v157, v158
    v_max_f32 v2, v2, v159
    v_mov_b32 v3, v2
    s_nop 1
    v_permlane32_swap_b32 v2, v3
    v_max_f32 v2, v2, v3
    v_mul_f32 v2, s89, v2
    v_fma_f32 v140, v140, s89, -v2
    v_fma_f32 v141, v141, s89, -v2
    v_exp_f32 v140, v140
    v_exp_f32 v141, v141
    v_fma_f32 v142, v142, s89, -v2
    v_fma_f32 v143, v143, s89, -v2
    v_exp_f32 v142, v142
    v_exp_f32 v143, v143
    v_cvt_pk_bf16_f32 v244, v140, v141
    v_fma_f32 v144, v144, s89, -v2
    v_fma_f32 v145, v145, s89, -v2
    v_exp_f32 v144, v144
    v_exp_f32 v145, v145
    v_cvt_pk_bf16_f32 v245, v142, v143
    v_fma_f32 v146, v146, s89, -v2
    v_fma_f32 v147, v147, s89, -v2
    v_exp_f32 v146, v146
    v_exp_f32 v147, v147
    v_cvt_pk_bf16_f32 v246, v144, v145
    v_fma_f32 v148, v148, s89, -v2
    v_fma_f32 v149, v149, s89, -v2
    v_exp_f32 v148, v148
    v_exp_f32 v149, v149
    v_cvt_pk_bf16_f32 v247, v146, v147
    v_fma_f32 v150, v150, s89, -v2
    v_fma_f32 v151, v151, s89, -v2
    v_exp_f32 v150, v150
    v_exp_f32 v151, v151
    v_cvt_pk_bf16_f32 v248, v148, v149
    v_mfma_f32_32x32x16_bf16 v[172:187], v[76:79], v[244:247], 0
    v_fma_f32 v152, v152, s89, -v2
    v_fma_f32 v153, v153, s89, -v2
    v_exp_f32 v152, v152
    v_exp_f32 v153, v153
    v_cvt_pk_bf16_f32 v249, v150, v151
    v_mfma_f32_32x32x16_bf16 v[188:203], v[84:87], v[244:247], 0
    v_fma_f32 v154, v154, s89, -v2
    v_fma_f32 v155, v155, s89, -v2
    v_exp_f32 v154, v154
    v_exp_f32 v155, v155
    v_cvt_pk_bf16_f32 v250, v152, v153
    v_mfma_f32_32x32x16_bf16 v[204:219], v[92:95], v[244:247], 0
    v_fma_f32 v156, v156, s89, -v2
    v_fma_f32 v157, v157, s89, -v2
    v_exp_f32 v156, v156
    v_exp_f32 v157, v157
    v_cvt_pk_bf16_f32 v251, v154, v155
    v_mfma_f32_32x32x16_bf16 v[220:235], v[100:103], v[244:247], 0
    v_fma_f32 v158, v158, s89, -v2
    v_fma_f32 v159, v159, s89, -v2
    v_exp_f32 v158, v158
    v_exp_f32 v159, v159
    v_cvt_pk_bf16_f32 v252, v156, v157
    v_add_f32 v2, v140, v141
    v_cvt_pk_bf16_f32 v253, v158, v159
    v_mfma_f32_32x32x16_bf16 v[172:187], v[80:83], v[248:251], v[172:187]
    v_add_f32 v2, v2, v142
    v_add_f32 v2, v2, v143
    v_add_f32 v2, v2, v144
    v_add_f32 v2, v2, v145
    v_add_f32 v2, v2, v146
    v_mfma_f32_32x32x16_bf16 v[188:203], v[88:91], v[248:251], v[188:203]
    v_add_f32 v2, v2, v147
    v_add_f32 v2, v2, v148
    v_add_f32 v2, v2, v149
    v_add_f32 v2, v2, v150
    v_add_f32 v2, v2, v151
    v_mfma_f32_32x32x16_bf16 v[204:219], v[96:99], v[248:251], v[204:219]
    v_add_f32 v2, v2, v152
    v_add_f32 v2, v2, v153
    v_add_f32 v2, v2, v154
    v_add_f32 v2, v2, v155
    v_add_f32 v2, v2, v156
    v_mfma_f32_32x32x16_bf16 v[220:235], v[104:107], v[248:251], v[220:235]
    v_add_f32 v2, v2, v157
    v_add_f32 v2, v2, v158
    v_add_f32 v2, v2, v159
    s_cmp_eq_u64 s[2:3], 0
    s_cbranch_scc1 at_vok_156
    s_waitcnt vmcnt(0)
    v_max3_u32 v3, v236, v238, v240
    v_max_u32 v3, v3, v242
    v_cmp_eq_u32 vcc, -1, v3
    s_cbranch_vccz pollvm_ok_158
pollvm_157:
    buffer_load_dwordx2 v[236:237], v7, s[8:11], s87 offen offset:0 sc1
    buffer_load_dwordx2 v[238:239], v7, s[8:11], s87 offen offset:512 sc1
    buffer_load_dwordx2 v[240:241], v7, s[8:11], s87 offen offset:1024 sc1
    buffer_load_dwordx2 v[242:243], v7, s[8:11], s87 offen offset:1536 sc1
    s_waitcnt vmcnt(0)
    v_max3_u32 v3, v236, v238, v240
    v_max_u32 v3, v3, v242
    v_cmp_eq_u32 vcc, -1, v3
    s_cbranch_vccz pollvm_ok_158
    s_sub_u32 s77, s77, 1
    s_cbranch_scc0 pollvm_157
    s_mov_b32 s77, 0
pollvm_ok_158:
at_vok_156:
    v_mfma_f32_32x32x8_bf16 v[172:187], v[236:237], v[252:253], v[172:187]
    v_mov_b32 v3, v2
    s_add_u32 s87, s90, 0x3000000
    v_mfma_f32_32x32x8_bf16 v[188:203], v[238:239], v[252:253], v[188:203]
    v_permlane32_swap_b32 v2, v3
    v_add_f32 v2, v2, v3
    v_rcp_f32 v2, v2
    v_mfma_f32_32x32x8_bf16 v[204:219], v[240:241], v[252:253], v[204:219]
    v_mfma_f32_32x32x8_bf16 v[220:235], v[242:243], v[252:253], v[220:235]
    s_nop 3
    v_pk_mul_f32 v[172:173], v[172:173], v[2:3] op_sel_hi:[1,0]
    v_pk_mul_f32 v[174:175], v[174:175], v[2:3] op_sel_hi:[1,0]
    v_pk_mul_f32 v[176:177], v[176:177], v[2:3] op_sel_hi:[1,0]
    v_pk_mul_f32 v[178:179], v[178:179], v[2:3] op_sel_hi:[1,0]
    v_cvt_pk_bf16_f32 v108, v172, v173
    v_cvt_pk_bf16_f32 v109, v174, v175
    v_cvt_pk_bf16_f32 v110, v176, v177
    v_cvt_pk_bf16_f32 v111, v178, v179
    buffer_store_dwordx4 v[108:111], v5, s[8:11], s87 offen offset:0
    v_pk_mul_f32 v[180:181], v[180:181], v[2:3] op_sel_hi:[1,0]
    v_pk_mul_f32 v[182:183], v[182:183], v[2:3] op_sel_hi:[1,0]
    v_pk_mul_f32 v[184:185], v[184:185], v[2:3] op_sel_hi:[1,0]
    v_pk_mul_f32 v[186:187], v[186:187], v[2:3] op_sel_hi:[1,0]
    v_cvt_pk_bf16_f32 v112, v180, v181
    v_cvt_pk_bf16_f32 v113, v182, v183
    v_cvt_pk_bf16_f32 v114, v184, v185
    v_cvt_pk_bf16_f32 v115, v186, v187
    buffer_store_dwordx4 v[112:115], v5, s[8:11], s87 offen offset:1024
    v_pk_mul_f32 v[188:189], v[188:189], v[2:3] op_sel_hi:[1,0]
    v_pk_mul_f32 v[190:191], v[190:191], v[2:3] op_sel_hi:[1,0]
    v_pk_mul_f32 v[192:193], v[192:193], v[2:3] op_sel_hi:[1,0]
    v_pk_mul_f32 v[194:195], v[194:195], v[2:3] op_sel_hi:[1,0]
    v_cvt_pk_bf16_f32 v116, v188, v189
    v_cvt_pk_bf16_f32 v117, v190, v191
    v_cvt_pk_bf16_f32 v118, v192, v193
    v_cvt_pk_bf16_f32 v119, v194, v195
    buffer_store_dwordx4 v[116:119], v5, s[8:11], s87 offen offset:2048
    v_pk_mul_f32 v[196:197], v[196:197], v[2:3] op_sel_hi:[1,0]
    v_pk_mul_f32 v[198:199], v[198:199], v[2:3] op_sel_hi:[1,0]
    v_pk_mul_f32 v[200:201], v[200:201], v[2:3] op_sel_hi:[1,0]
    v_pk_mul_f32 v[202:203], v[202:203], v[2:3] op_sel_hi:[1,0]
    v_cvt_pk_bf16_f32 v120, v196, v197
    v_cvt_pk_bf16_f32 v121, v198, v199
    v_cvt_pk_bf16_f32 v122, v200, v201
    v_cvt_pk_bf16_f32 v123, v202, v203
    buffer_store_dwordx4 v[120:123], v5, s[8:11], s87 offen offset:3072
    v_pk_mul_f32 v[204:205], v[204:205], v[2:3] op_sel_hi:[1,0]
    v_pk_mul_f32 v[206:207], v[206:207], v[2:3] op_sel_hi:[1,0]
    v_pk_mul_f32 v[208:209], v[208:209], v[2:3] op_sel_hi:[1,0]
    v_pk_mul_f32 v[210:211], v[210:211], v[2:3] op_sel_hi:[1,0]
    v_cvt_pk_bf16_f32 v124, v204, v205
    v_cvt_pk_bf16_f32 v125, v206, v207
    v_cvt_pk_bf16_f32 v126, v208, v209
    v_cvt_pk_bf16_f32 v127, v210, v211
    s_add_u32 s87, s87, 4096
    buffer_store_dwordx4 v[124:127], v5, s[8:11], s87 offen offset:0
    v_pk_mul_f32 v[212:213], v[212:213], v[2:3] op_sel_hi:[1,0]
    v_pk_mul_f32 v[214:215], v[214:215], v[2:3] op_sel_hi:[1,0]
    v_pk_mul_f32 v[216:217], v[216:217], v[2:3] op_sel_hi:[1,0]
    v_pk_mul_f32 v[218:219], v[218:219], v[2:3] op_sel_hi:[1,0]
    v_cvt_pk_bf16_f32 v128, v212, v213
    v_cvt_pk_bf16_f32 v129, v214, v215
    v_cvt_pk_bf16_f32 v130, v216, v217
    v_cvt_pk_bf16_f32 v131, v218, v219
    buffer_store_dwordx4 v[128:131], v5, s[8:11], s87 offen offset:1024
    v_pk_mul_f32 v[220:221], v[220:221], v[2:3] op_sel_hi:[1,0]
    v_pk_mul_f32 v[222:223], v[222:223], v[2:3] op_sel_hi:[1,0]
    v_pk_mul_f32 v[224:225], v[224:225], v[2:3] op_sel_hi:[1,0]
    v_pk_mul_f32 v[226:227], v[226:227], v[2:3] op_sel_hi:[1,0]
    v_cvt_pk_bf16_f32 v132, v220, v221
    v_cvt_pk_bf16_f32 v133, v222, v223
    v_cvt_pk_bf16_f32 v134, v224, v225
    v_cvt_pk_bf16_f32 v135, v226, v227
    buffer_store_dwordx4 v[132:135], v5, s[8:11], s87 offen offset:2048
    v_pk_mul_f32 v[228:229], v[228:229], v[2:3] op_sel_hi:[1,0]
    v_pk_mul_f32 v[230:231], v[230:231], v[2:3] op_sel_hi:[1,0]
    v_pk_mul_f32 v[232:233], v[232:233], v[2:3] op_sel_hi:[1,0]
    v_pk_mul_f32 v[234:235], v[234:235], v[2:3] op_sel_hi:[1,0]
    v_cvt_pk_bf16_f32 v136, v228, v229
    v_cvt_pk_bf16_f32 v137, v230, v231
    v_cvt_pk_bf16_f32 v138, v232, v233
    v_cvt_pk_bf16_f32 v139, v234, v235
    buffer_store_dwordx4 v[136:139], v5, s[8:11], s87 offen offset:3072
    s_add_u32 s88, s94, 0x2000000
    buffer_load_dwordx4 v[76:79], v5, s[8:11], s88 offen offset:0 sc1
    buffer_load_dwordx4 v[80:83], v5, s[8:11], s88 offen offset:1024 sc1
    buffer_load_dwordx4 v[84:87], v5, s[8:11], s88 offen offset:2048 sc1
    buffer_load_dwordx4 v[88:91], v5, s[8:11], s88 offen offset:3072 sc1
    s_add_u32 s88, s88, 4096
    buffer_load_dwordx4 v[92:95], v5, s[8:11], s88 offen offset:0 sc1
    buffer_load_dwordx4 v[96:99], v5, s[8:11], s88 offen offset:1024 sc1
    buffer_load_dwordx4 v[100:103], v5, s[8:11], s88 offen offset:2048 sc1
    buffer_load_dwordx4 v[104:107], v5, s[8:11], s88 offen offset:3072 sc1
    s_bfe_u32 s87, s90, 0x3000d
    s_lshl_b32 s87, s87, 2
    s_bfe_u32 s88, s90, 0x80010
    s_lshl_b32 s88, s88, 7
    s_or_b32 s87, s87, s88
    s_add_u32 s87, s87, 0x5100000
    v_mov_b32 v2, 1
    s_waitcnt vmcnt(8)
    buffer_store_dword v2, off, s[8:11], s87
    s_cmp_lt_u32 s86, 64
    s_cbranch_scc1 at_loop_135
end_61:
    s_waitcnt vmcnt(0)
    s_endpgm
.section .rodata,"a"
.p2align 6
.amdhsa_kernel concat_heads__spectral_gfnet__memory_aug_recurrent_mem_tr__prompt_kernel
  .amdhsa_next_free_vgpr 256
  .amdhsa_next_free_sgpr 102
  .amdhsa_accum_offset 256
  .amdhsa_group_segment_fixed_size 0
  .amdhsa_kernarg_size 104
  .amdhsa_user_sgpr_count 2
  .amdhsa_user_sgpr_kernarg_segment_ptr 1
  .amdhsa_system_sgpr_workgroup_id_x 1
  .amdhsa_float_denorm_mode_32 3
  .amdhsa_float_denorm_mode_16_64 3
.end_amdhsa_kernel
```

```asm
; @launch grid=(256,1,1) block=(512,1,1) lds=163840
.amdgcn_target "amdgcn-amd-amdhsa--gfx950"
.text
.globl concat_heads__spectral_gfnet__memory_aug_recurrent_mem_tr__prompt_kernel
.p2align 8
.type concat_heads__spectral_gfnet__memory_aug_recurrent_mem_tr__prompt_kernel,@function
concat_heads__spectral_gfnet__memory_aug_recurrent_mem_tr__prompt_kernel:
    s_load_dwordx2 s[8:9], s[0:1], 96
    s_load_dwordx2 s[12:13], s[0:1], 88
    s_load_dwordx2 s[16:17], s[0:1], 80
    s_load_dwordx2 s[20:21], s[0:1], 40
    s_load_dwordx2 s[24:25], s[0:1], 48
    s_load_dwordx2 s[28:29], s[0:1], 56
    s_load_dwordx2 s[32:33], s[0:1], 64
    s_load_dwordx2 s[36:37], s[0:1], 24
    s_load_dwordx2 s[40:41], s[0:1], 32
    s_load_dwordx2 s[44:45], s[0:1], 0
    s_load_dwordx2 s[48:49], s[0:1], 8
    s_load_dwordx2 s[52:53], s[0:1], 16
    s_mov_b32 s10, 0x10000000
    s_mov_b32 s11, 0x20000
    s_mov_b32 s14, 0x100
    s_mov_b32 s15, 0x20000
    s_mov_b32 s18, 0x800000
    s_mov_b32 s19, 0x20000
    s_mov_b32 s22, 0x800000
    s_mov_b32 s23, 0x20000
    s_mov_b32 s26, 0x800000
    s_mov_b32 s27, 0x20000
    s_mov_b32 s30, 0x800000
    s_mov_b32 s31, 0x20000
    s_mov_b32 s34, 0x800000
    s_mov_b32 s35, 0x20000
    s_mov_b32 s38, 0x400000
    s_mov_b32 s39, 0x20000
    s_mov_b32 s42, 0x4000
    s_mov_b32 s43, 0x20000
    s_mov_b32 s46, 0x400000
    s_mov_b32 s47, 0x20000
    s_mov_b32 s50, 0x201000
    s_mov_b32 s51, 0x20000
    s_mov_b32 s54, 0x201000
    s_mov_b32 s55, 0x20000
    s_waitcnt lgkmcnt(0)
    s_getreg_b32 s56, hwreg(HW_REG_XCC_ID, 0, 3)
    v_lshrrev_b32 v2, 6, v0
    v_and_b32 v1, 63, v0
    v_readfirstlane_b32 s58, v2
    s_nop 0
    s_cmp_lg_u32 s58, 0
    s_cbranch_scc1 notw0_1
    s_and_b32 s57, s56, 3
    s_mul_i32 s57, s57, 76
    s_and_b32 s3, s56, 4
    s_add_u32 s57, s57, s3
    v_mov_b32 v2, s57
    v_mov_b32 v3, 0x5ffffff0
    v_cmp_eq_u32 vcc, 0, v1
    s_nop 1
    v_cndmask_b32 v2, v3, v2, vcc
    v_mov_b32 v3, 1
    buffer_atomic_add v3, v2, s[12:15], 0 offen sc0 sc1
    v_mov_b32 v4, 0x27ff0
    s_waitcnt vmcnt(0)
    v_readfirstlane_b32 s3, v3
    s_nop 1
    v_mov_b32 v3, s3
    ds_write_b32 v4, v3
    s_waitcnt lgkmcnt(0)
notw0_1:
    s_barrier
    v_mov_b32 v4, 0x27ff0
    ds_read_b32 v3, v4
    s_waitcnt lgkmcnt(0)
    v_readfirstlane_b32 s57, v3
    s_nop 0
    s_cmp_lt_u32 s57, 32
    s_cbranch_scc1 go_3
    s_endpgm
go_3:
    s_cmp_ge_u32 s56, 4
    s_cbranch_scc1 bulk_2
    s_and_b32 s64, s57, 3
    s_lshr_b32 s65, s57, 2
    s_lshl_b32 s66, s56, 3
    s_add_u32 s66, s66, s65
    s_and_b32 s67, s58, 3
    s_mov_b32 s69, 0x40000
    v_and_b32 v6, 15, v1
    v_lshlrev_b32 v8, 4, v1
    v_mov_b32 v14, -1
    v_mov_b32 v15, -1
    v_mov_b32 v16, -1
    v_mov_b32 v17, -1
    s_mov_b32 s86, 0
    s_mov_b32 s87, 0
    s_mov_b32 s88, 0
    s_mov_b32 s89, 0
    s_mov_b32 s90, 0
    s_mov_b32 s91, 0
    s_mov_b32 s92, 0
    s_mov_b32 s93, 0
    s_mov_b32 s94, 0
    s_mov_b32 s95, 0
    s_mov_b32 s96, 0
    s_mov_b32 s97, 0
    s_mov_b32 s98, 0
    v_mov_b32 v2, 0x4444
    v_mov_b32 v3, 0xeeee
    v_and_b32 v4, 2, v1
    v_cmp_eq_u32 vcc, 0, v4
    s_nop 1
    v_cndmask_b32 v7, v3, v2, vcc
    v_bfe_u32 v36, v1, 0, 2
    v_lshlrev_b32 v36, 4, v36
    v_bfe_u32 v2, v1, 5, 1
    v_lshl_or_b32 v36, v2, 6, v36
    v_bfe_u32 v2, v1, 2, 2
    v_lshl_or_b32 v36, v2, 10, v36
    v_bfe_u32 v2, v1, 4, 1
    v_lshl_or_b32 v36, v2, 12, v36
    s_lshl_b32 s70, s56, 2
    s_add_u32 s70, s70, s64
    s_lshl_b32 s70, s70, 15
    s_add_u32 s70, s70, 0x4a00000
    s_lshl_b32 s71, s65, 2
    s_add_u32 s71, s71, s67
    s_lshl_b32 s72, s71, 10
    s_add_u32 s78, s70, s72
    s_lshl_b32 s72, s67, 13
    s_add_u32 s79, s70, s72
    s_lshl_b32 s72, s65, 7
    s_add_u32 s79, s79, s72
    s_bfe_u32 s77, s71, 0x20001
    s_lshl_b32 s77, s77, 7
    s_bfe_u32 s72, s71, 0x10000
    s_lshl_b32 s72, s72, 11
    s_or_b32 s77, s77, s72
    s_bfe_u32 s72, s71, 0x10003
    s_lshl_b32 s72, s72, 12
    s_or_b32 s77, s77, s72
    s_bfe_u32 s72, s71, 0x10004
    s_lshl_b32 s72, s72, 14
    s_or_b32 s77, s77, s72
    s_lshl_b32 s72, s56, 9
    s_add_u32 s77, s77, s72
    s_bfe_u32 s76, s58, 0x10000
    s_lshl_b32 s76, s76, 12
    s_bfe_u32 s72, s58, 0x10001
    s_lshl_b32 s72, s72, 14
    s_or_b32 s76, s76, s72
    s_lshl_b32 s72, s64, 15
    s_add_u32 s76, s76, s72
    s_add_u32 s72, s72, 0x20000
    s_add_u32 s77, s77, s72
    s_sub_u32 s7, 0, s8
    s_and_b32 s7, s7, 0x1fffff
    s_add_u32 s7, s7, 0x6c00000
    v_bfe_u32 v37, v1, 0, 2
    v_lshlrev_b32 v37, 4, v37
    v_bfe_u32 v2, v1, 4, 1
    v_lshl_or_b32 v37, v2, 6, v37
    v_bfe_u32 v2, v1, 2, 2
    v_lshl_or_b32 v37, v2, 7, v37
    v_bfe_u32 v2, v1, 5, 1
    v_lshl_or_b32 v37, v2, 9, v37
    v_add_u32 v37, s7, v37
    v_mov_b32 v5, 0x5ffffff0
    v_add_u32 v3, s7, v8
    v_cmp_gt_u32 vcc, 8, v1
    s_nop 1
    v_cndmask_b32 v35, v5, v3, vcc
    s_lshl_b32 s70, s66, 2
    s_add_u32 s70, s70, s67
    s_lshl_b32 s74, s70, 11
    s_add_u32 s74, s74, 0x4900000
    s_cmp_ge_u32 s58, 4
    s_cbranch_scc1 vo_arm_4
    s_lshl_b32 s73, s70, 12
    s_add_u32 s73, s73, 0x4800000
    s_lshl_b32 s71, s64, 10
    v_add_u32 v34, s71, v8
    s_add_u32 s71, s73, 0x80000
    buffer_store_dwordx4 v[14:17], v34, s[8:11], s73 offen
    buffer_store_dwordx4 v[14:17], v34, s[8:11], s71 offen
    v_bfe_u32 v2, v1, 0, 3
    v_lshlrev_b32 v2, 4, v2
    v_bfe_u32 v3, v1, 3, 1
    v_lshl_or_b32 v2, v3, 13, v2
    v_bfe_u32 v3, v1, 4, 2
    v_lshl_or_b32 v2, v3, 17, v2
    v_add_u32 v2, s7, v2
    buffer_store_dwordx4 v[14:17], v2, s[8:11], s77 offen sc1
    s_add_u32 s77, s77, 0x60000
    s_branch arm_done_5
vo_arm_4:
    s_mov_b32 s73, s74
    v_bfe_u32 v34, v1, 0, 4
    v_lshlrev_b32 v34, 4, v34
    v_bfe_u32 v2, v1, 5, 1
    v_lshl_or_b32 v34, v2, 8, v34
    v_bfe_u32 v2, v1, 4, 1
    v_lshl_or_b32 v34, v2, 10, v34
    s_bfe_u32 s71, s64, 0x10000
    s_lshl_b32 s71, s71, 3
    s_bfe_u32 s72, s64, 0x10001
    s_lshl_b32 s72, s72, 9
    s_or_b32 s71, s71, s72
    v_add_u32 v34, s71, v34
    s_add_u32 s71, s73, 0x40000
    buffer_store_dwordx2 v[14:15], v34, s[8:11], s73 offen
    buffer_store_dwordx2 v[14:15], v34, s[8:11], s71 offen
    s_add_u32 s71, s79, 0x80000
    buffer_store_dwordx4 v[14:17], v36, s[8:11], s79 offen
    buffer_store_dwordx4 v[14:17], v36, s[8:11], s71 offen
    s_add_u32 s2, s77, s7
    s_add_u32 s2, s2, 0x1c0000
    v_bfe_u32 v2, v1, 0, 2
    v_lshlrev_b32 v2, 21, v2
    v_bfe_u32 v3, v1, 2, 1
    v_lshl_or_b32 v2, v3, 13, v2
    s_cmp_lg_u32 s58, 4
    s_cbranch_scc1 arm_done_5
    buffer_store_dword v14, v2, s[8:11], s2 offen sc1
    s_lshl_b32 s71, s66, 7
    s_add_u32 s71, s71, 0x5110000
    buffer_store_dwordx2 v[14:15], off, s[8:11], s71 sc1
arm_done_5:
    v_bfe_u32 v2, v1, 0, 1
    v_lshlrev_b32 v2, 11, v2
    v_bfe_u32 v3, v1, 2, 2
    v_lshl_or_b32 v2, v3, 12, v2
    v_bfe_u32 v3, v1, 1, 1
    v_lshl_or_b32 v2, v3, 8, v2
    v_bfe_u32 v3, v1, 4, 2
    v_lshl_or_b32 v2, v3, 4, v2
    s_lshl_b32 s70, s64, 9
    s_lshl_b32 s71, s67, 6
    s_add_u32 s70, s70, s71
    buffer_load_dwordx4 v[10:13], v2, s[40:43], s70 offen
    v_bfe_u32 v2, v1, 4, 1
    v_lshlrev_b32 v2, 4, v2
    v_bfe_u32 v3, v1, 5, 1
    v_lshl_or_b32 v2, v3, 6, v2
    v_bfe_u32 v3, v1, 4, 2
    v_lshl_or_b32 v2, v3, 13, v2
    v_lshlrev_b32 v3, 4, v6
    v_xor_b32 v38, v2, v3
    v_xor_b32 v39, 0x80, v38
    v_bfe_u32 v2, v1, 5, 1
    v_lshlrev_b32 v2, 5, v2
    v_bfe_u32 v3, v1, 5, 1
    v_lshl_or_b32 v2, v3, 11, v2
    v_bfe_u32 v3, v1, 0, 5
    v_lshlrev_b32 v3, 4, v3
    v_xor_b32 v40, v2, v3
    s_lshl_b32 s71, s67, 6
    v_bfe_u32 v4, v1, 0, 1
    v_lshlrev_b32 v4, 3, v4
    v_bfe_u32 v2, v1, 2, 1
    v_lshl_or_b32 v4, v2, 4, v4
    v_bfe_u32 v2, v1, 1, 1
    v_lshl_or_b32 v4, v2, 5, v4
    v_bfe_u32 v2, v1, 5, 1
    v_lshl_or_b32 v4, v2, 7, v4
    v_bfe_u32 v2, v1, 2, 1
    v_lshl_or_b32 v4, v2, 8, v4
    v_bfe_u32 v2, v1, 4, 2
    v_lshl_or_b32 v4, v2, 10, v4
    v_bfe_u32 v2, v1, 3, 1
    v_lshl_or_b32 v4, v2, 15, v4
    s_lshl_b32 s70, s58, 13
    s_cmp_ge_u32 s58, 4
    s_cselect_b32 s70, 0, s70
    s_or_b32 s70, s70, s71
    v_xor_b32 v41, s70, v4
    v_bfe_u32 v4, v1, 0, 1
    v_lshlrev_b32 v4, 3, v4
    v_bfe_u32 v2, v1, 1, 1
    v_lshl_or_b32 v4, v2, 4, v4
    v_bfe_u32 v2, v1, 2, 1
    v_lshl_or_b32 v4, v2, 5, v4
    v_bfe_u32 v2, v1, 5, 1
    v_lshl_or_b32 v4, v2, 7, v4
    v_bfe_u32 v2, v1, 2, 1
    v_lshl_or_b32 v4, v2, 9, v4
    v_bfe_u32 v2, v1, 5, 1
    v_lshl_or_b32 v4, v2, 11, v4
    v_bfe_u32 v2, v1, 4, 1
    v_lshl_or_b32 v4, v2, 12, v4
    v_bfe_u32 v2, v1, 3, 1
    v_lshl_or_b32 v4, v2, 14, v4
    s_or_b32 s71, s71, 0x10000
    v_xor_b32 v42, s71, v4
    s_lshl_b32 s70, s64, 21
    s_lshl_b32 s71, s58, 18
    s_add_u32 s70, s70, s71
    s_lshl_b32 s71, s66, 8
    s_add_u32 s70, s70, s71
    s_lshl_b32 s71, s58, 13
    s_add_u32 s71, s71, 0
    s_mov_b32 m0, s71
    s_nop 0
    buffer_load_dwordx4 v38, s[24:27], s70 offen lds
    s_add_u32 s71, s71, 0x400
    s_add_u32 s70, s70, 0x8000
    s_mov_b32 m0, s71
    s_nop 0
    buffer_load_dwordx4 v38, s[24:27], s70 offen lds
    s_add_u32 s71, s71, 0x400
    s_add_u32 s70, s70, 0x8000
    s_mov_b32 m0, s71
    s_nop 0
    buffer_load_dwordx4 v39, s[24:27], s70 offen lds
    s_add_u32 s71, s71, 0x400
    s_add_u32 s70, s70, 0x8000
    s_mov_b32 m0, s71
    s_nop 0
    buffer_load_dwordx4 v39, s[24:27], s70 offen lds
    s_add_u32 s71, s71, 0x400
    s_add_u32 s70, s70, 0x8000
    s_mov_b32 m0, s71
    s_nop 0
    buffer_load_dwordx4 v38, s[24:27], s70 offen lds
    s_add_u32 s71, s71, 0x400
    s_add_u32 s70, s70, 0x8000
    s_mov_b32 m0, s71
    s_nop 0
    buffer_load_dwordx4 v38, s[24:27], s70 offen lds
    s_add_u32 s71, s71, 0x400
    s_add_u32 s70, s70, 0x8000
    s_mov_b32 m0, s71
    s_nop 0
    buffer_load_dwordx4 v39, s[24:27], s70 offen lds
    s_add_u32 s71, s71, 0x400
    s_add_u32 s70, s70, 0x8000
    s_mov_b32 m0, s71
    s_nop 0
    buffer_load_dwordx4 v39, s[24:27], s70 offen lds
    s_add_u32 s71, s71, 0x400
    s_add_u32 s70, s70, 0x8000
    s_lshl_b32 s70, s64, 21
    s_lshl_b32 s71, s58, 18
    s_add_u32 s70, s70, s71
    s_lshl_b32 s71, s66, 8
    s_add_u32 s70, s70, s71
    s_lshl_b32 s71, s58, 13
    s_add_u32 s71, s71, 65536
    s_mov_b32 m0, s71
    s_nop 0
    buffer_load_dwordx4 v38, s[28:31], s70 offen lds
    s_add_u32 s71, s71, 0x400
    s_add_u32 s70, s70, 0x8000
    s_mov_b32 m0, s71
    s_nop 0
    buffer_load_dwordx4 v38, s[28:31], s70 offen lds
    s_add_u32 s71, s71, 0x400
    s_add_u32 s70, s70, 0x8000
    s_mov_b32 m0, s71
    s_nop 0
    buffer_load_dwordx4 v39, s[28:31], s70 offen lds
    s_add_u32 s71, s71, 0x400
    s_add_u32 s70, s70, 0x8000
    s_mov_b32 m0, s71
    s_nop 0
    buffer_load_dwordx4 v39, s[28:31], s70 offen lds
    s_add_u32 s71, s71, 0x400
    s_add_u32 s70, s70, 0x8000
    s_mov_b32 m0, s71
    s_nop 0
    buffer_load_dwordx4 v38, s[28:31], s70 offen lds
    s_add_u32 s71, s71, 0x400
    s_add_u32 s70, s70, 0x8000
    s_mov_b32 m0, s71
    s_nop 0
    buffer_load_dwordx4 v38, s[28:31], s70 offen lds
    s_add_u32 s71, s71, 0x400
    s_add_u32 s70, s70, 0x8000
    s_mov_b32 m0, s71
    s_nop 0
    buffer_load_dwordx4 v39, s[28:31], s70 offen lds
    s_add_u32 s71, s71, 0x400
    s_add_u32 s70, s70, 0x8000
    s_mov_b32 m0, s71
    s_nop 0
    buffer_load_dwordx4 v39, s[28:31], s70 offen lds
    s_add_u32 s71, s71, 0x400
    s_add_u32 s70, s70, 0x8000
    s_cmp_lg_u32 s58, 4
    s_cbranch_scc1 novote_6
    s_waitcnt vmcnt(16)
    s_mov_b32 s3, 1
    s_mov_b32 s59, 0
    s_bitcmp1_b32 s57, 0
    s_cselect_b32 s60, -1, 1
    s_cselect_b32 s70, 0x2000, 0
    s_cselect_b32 s71, 0, 0x2000
    s_add_u32 s70, s70, s2
    s_add_u32 s71, s71, s2
    s_mov_b64 s[4:5], 0
    s_buffer_load_dword s4, s[8:11], s70
    s_buffer_load_dword s5, s[8:11], s71
    s_waitcnt lgkmcnt(1)
    s_sub_u32 s72, s4, s5
    s_waitcnt lgkmcnt(0)
    s_mul_i32 s72, s72, s60
    s_add_u32 s72, s72, 1
    s_min_u32 s72, s72, 2
    s_lshl_b32 s72, s72, 10
    s_add_u32 s3, s3, s72
    s_add_u32 s70, s70, 0x200000
    s_add_u32 s71, s71, 0x200000
    s_mov_b64 s[4:5], 0
    s_buffer_load_dword s4, s[8:11], s70
    s_buffer_load_dword s5, s[8:11], s71
    s_waitcnt lgkmcnt(1)
    s_sub_u32 s72, s4, s5
    s_waitcnt lgkmcnt(0)
    s_mul_i32 s72, s72, s60
    s_add_u32 s72, s72, 1
    s_min_u32 s72, s72, 2
    s_lshl_b32 s72, s72, 20
    s_add_u32 s3, s3, s72
    s_add_u32 s70, s70, 0x200000
    s_add_u32 s71, s71, 0x200000
    s_mov_b64 s[4:5], 0
    s_buffer_load_dword s4, s[8:11], s70
    s_buffer_load_dword s5, s[8:11], s71
    s_waitcnt lgkmcnt(1)
    s_sub_u32 s72, s4, s5
    s_waitcnt lgkmcnt(0)
    s_mul_i32 s72, s72, s60
    s_add_u32 s72, s72, 1
    s_min_u32 s72, s72, 2
    s_lshl_b32 s72, s72, 10
    s_add_u32 s59, s59, s72
    s_add_u32 s70, s70, 0x200000
    s_add_u32 s71, s71, 0x200000
    s_mov_b64 s[4:5], 0
    s_buffer_load_dword s4, s[8:11], s70
    s_buffer_load_dword s5, s[8:11], s71
    s_waitcnt lgkmcnt(1)
    s_sub_u32 s72, s4, s5
    s_waitcnt lgkmcnt(0)
    s_mul_i32 s72, s72, s60
    s_add_u32 s72, s72, 1
    s_min_u32 s72, s72, 2
    s_lshl_b32 s72, s72, 20
    s_add_u32 s59, s59, s72
    s_add_u32 s70, s70, 0x200000
    s_add_u32 s71, s71, 0x200000
novote_6:
    s_waitcnt vmcnt(0)
    s_barrier
    s_cmp_lg_u32 s58, 4
    s_cbranch_scc1 nosig_7
    v_mov_b32 v2, s3
    v_mov_b32 v3, s59
    v_cmp_eq_u32 vcc, 0, v1
    v_mov_b32 v5, 32
    v_mov_b32 v4, 0x5ffffff0
    v_cndmask_b32 v4, v4, v5, vcc
    buffer_atomic_add_x2 v[2:3], v4, s[12:15], 0 offen sc1
nosig_7:
    s_cmp_ge_u32 s58, 4
    s_cbranch_scc1 skip_8
    v_xor_b32 v2, 0x0, v41
    v_xor_b32 v3, 0x40, v41
    ds_read_b64_tr_b16 v[192:193], v2 offset:0
    ds_read_b64_tr_b16 v[194:195], v3 offset:512
    ds_read_b64_tr_b16 v[196:197], v2 offset:4096
    ds_read_b64_tr_b16 v[198:199], v3 offset:4608
    v_xor_b32 v2, 0x2000, v41
    v_xor_b32 v3, 0x2040, v41
    ds_read_b64_tr_b16 v[200:201], v2 offset:0
    ds_read_b64_tr_b16 v[202:203], v3 offset:512
    ds_read_b64_tr_b16 v[204:205], v2 offset:4096
    ds_read_b64_tr_b16 v[206:207], v3 offset:4608
    v_xor_b32 v2, 0x4000, v41
    v_xor_b32 v3, 0x4040, v41
    ds_read_b64_tr_b16 v[208:209], v2 offset:0
    ds_read_b64_tr_b16 v[210:211], v3 offset:512
    ds_read_b64_tr_b16 v[212:213], v2 offset:4096
    ds_read_b64_tr_b16 v[214:215], v3 offset:4608
    v_xor_b32 v2, 0x6000, v41
    v_xor_b32 v3, 0x6040, v41
    ds_read_b64_tr_b16 v[216:217], v2 offset:0
    ds_read_b64_tr_b16 v[218:219], v3 offset:512
    ds_read_b64_tr_b16 v[220:221], v2 offset:4096
    ds_read_b64_tr_b16 v[222:223], v3 offset:4608
    s_waitcnt lgkmcnt(0)
    v_xor_b32 v2, 0x10, v41
    v_xor_b32 v3, 0x50, v41
    ds_read_b64_tr_b16 v[224:225], v2 offset:0
    ds_read_b64_tr_b16 v[226:227], v3 offset:512
    ds_read_b64_tr_b16 v[228:229], v2 offset:4096
    ds_read_b64_tr_b16 v[230:231], v3 offset:4608
    v_xor_b32 v2, 0x2010, v41
    v_xor_b32 v3, 0x2050, v41
    ds_read_b64_tr_b16 v[232:233], v2 offset:0
    ds_read_b64_tr_b16 v[234:235], v3 offset:512
    ds_read_b64_tr_b16 v[236:237], v2 offset:4096
    ds_read_b64_tr_b16 v[238:239], v3 offset:4608
    v_xor_b32 v2, 0x4010, v41
    v_xor_b32 v3, 0x4050, v41
    ds_read_b64_tr_b16 v[240:241], v2 offset:0
    ds_read_b64_tr_b16 v[242:243], v3 offset:512
    ds_read_b64_tr_b16 v[244:245], v2 offset:4096
    ds_read_b64_tr_b16 v[246:247], v3 offset:4608
    v_xor_b32 v2, 0x6010, v41
    v_xor_b32 v3, 0x6050, v41
    ds_read_b64_tr_b16 v[248:249], v2 offset:0
    ds_read_b64_tr_b16 v[250:251], v3 offset:512
    ds_read_b64_tr_b16 v[252:253], v2 offset:4096
    ds_read_b64_tr_b16 v[254:255], v3 offset:4608
    s_waitcnt lgkmcnt(0)
skip_8:
    s_cmp_ge_u32 s58, 4
    s_cbranch_scc0 skip_9
    v_xor_b32 v2, 0x10000, v41
    v_xor_b32 v3, 0x10040, v41
    ds_read_b64_tr_b16 v[128:129], v2 offset:0
    ds_read_b64_tr_b16 v[130:131], v3 offset:512
    ds_read_b64_tr_b16 v[132:133], v2 offset:4096
    ds_read_b64_tr_b16 v[134:135], v3 offset:4608
    v_xor_b32 v2, 0x12000, v41
    v_xor_b32 v3, 0x12040, v41
    ds_read_b64_tr_b16 v[136:137], v2 offset:0
    ds_read_b64_tr_b16 v[138:139], v3 offset:512
    ds_read_b64_tr_b16 v[140:141], v2 offset:4096
    ds_read_b64_tr_b16 v[142:143], v3 offset:4608
    v_xor_b32 v2, 0x14000, v41
    v_xor_b32 v3, 0x14040, v41
    ds_read_b64_tr_b16 v[144:145], v2 offset:0
    ds_read_b64_tr_b16 v[146:147], v3 offset:512
    ds_read_b64_tr_b16 v[148:149], v2 offset:4096
    ds_read_b64_tr_b16 v[150:151], v3 offset:4608
    v_xor_b32 v2, 0x16000, v41
    v_xor_b32 v3, 0x16040, v41
    ds_read_b64_tr_b16 v[152:153], v2 offset:0
    ds_read_b64_tr_b16 v[154:155], v3 offset:512
    ds_read_b64_tr_b16 v[156:157], v2 offset:4096
    ds_read_b64_tr_b16 v[158:159], v3 offset:4608
    s_waitcnt lgkmcnt(0)
    v_xor_b32 v2, 0x10010, v41
    v_xor_b32 v3, 0x10050, v41
    ds_read_b64_tr_b16 v[160:161], v2 offset:0
    ds_read_b64_tr_b16 v[162:163], v3 offset:512
    ds_read_b64_tr_b16 v[164:165], v2 offset:4096
    ds_read_b64_tr_b16 v[166:167], v3 offset:4608
    v_xor_b32 v2, 0x12010, v41
    v_xor_b32 v3, 0x12050, v41
    ds_read_b64_tr_b16 v[168:169], v2 offset:0
    ds_read_b64_tr_b16 v[170:171], v3 offset:512
    ds_read_b64_tr_b16 v[172:173], v2 offset:4096
    ds_read_b64_tr_b16 v[174:175], v3 offset:4608
    v_xor_b32 v2, 0x14010, v41
    v_xor_b32 v3, 0x14050, v41
    ds_read_b64_tr_b16 v[176:177], v2 offset:0
    ds_read_b64_tr_b16 v[178:179], v3 offset:512
    ds_read_b64_tr_b16 v[180:181], v2 offset:4096
    ds_read_b64_tr_b16 v[182:183], v3 offset:4608
    v_xor_b32 v2, 0x16010, v41
    v_xor_b32 v3, 0x16050, v41
    ds_read_b64_tr_b16 v[184:185], v2 offset:0
    ds_read_b64_tr_b16 v[186:187], v3 offset:512
    ds_read_b64_tr_b16 v[188:189], v2 offset:4096
    ds_read_b64_tr_b16 v[190:191], v3 offset:4608
    s_waitcnt lgkmcnt(0)
skip_9:
    s_barrier
    s_lshl_b32 s70, s64, 21
    s_lshl_b32 s71, s58, 18
    s_add_u32 s70, s70, s71
    s_lshl_b32 s71, s66, 8
    s_add_u32 s70, s70, s71
    s_lshl_b32 s71, s58, 13
    s_add_u32 s71, s71, 0
    s_mov_b32 m0, s71
    s_nop 0
    buffer_load_dwordx4 v38, s[20:23], s70 offen lds
    s_add_u32 s71, s71, 0x400
    s_add_u32 s70, s70, 0x8000
    s_mov_b32 m0, s71
    s_nop 0
    buffer_load_dwordx4 v38, s[20:23], s70 offen lds
    s_add_u32 s71, s71, 0x400
    s_add_u32 s70, s70, 0x8000
    s_mov_b32 m0, s71
    s_nop 0
    buffer_load_dwordx4 v39, s[20:23], s70 offen lds
    s_add_u32 s71, s71, 0x400
    s_add_u32 s70, s70, 0x8000
    s_mov_b32 m0, s71
    s_nop 0
    buffer_load_dwordx4 v39, s[20:23], s70 offen lds
    s_add_u32 s71, s71, 0x400
    s_add_u32 s70, s70, 0x8000
    s_mov_b32 m0, s71
    s_nop 0
    buffer_load_dwordx4 v38, s[20:23], s70 offen lds
    s_add_u32 s71, s71, 0x400
    s_add_u32 s70, s70, 0x8000
    s_mov_b32 m0, s71
    s_nop 0
    buffer_load_dwordx4 v38, s[20:23], s70 offen lds
    s_add_u32 s71, s71, 0x400
    s_add_u32 s70, s70, 0x8000
    s_mov_b32 m0, s71
    s_nop 0
    buffer_load_dwordx4 v39, s[20:23], s70 offen lds
    s_add_u32 s71, s71, 0x400
    s_add_u32 s70, s70, 0x8000
    s_mov_b32 m0, s71
    s_nop 0
    buffer_load_dwordx4 v39, s[20:23], s70 offen lds
    s_add_u32 s71, s71, 0x400
    s_add_u32 s70, s70, 0x8000
    s_lshl_b32 s70, s66, 18
    s_lshl_b32 s71, s58, 15
    s_add_u32 s70, s70, s71
    s_lshl_b32 s71, s64, 9
    s_add_u32 s70, s70, s71
    s_lshl_b32 s71, s58, 13
    s_add_u32 s71, s71, 65536
    v_xor_b32 v2, 0, v40
    s_mov_b32 m0, s71
    s_nop 0
    buffer_load_dwordx4 v2, s[32:35], s70 offen lds
    s_add_u32 s71, s71, 0x400
    s_add_u32 s70, s70, 0x1000
    v_xor_b32 v2, 64, v40
    s_mov_b32 m0, s71
    s_nop 0
    buffer_load_dwordx4 v2, s[32:35], s70 offen lds
    s_add_u32 s71, s71, 0x400
    s_add_u32 s70, s70, 0x1000
    v_xor_b32 v2, 128, v40
    s_mov_b32 m0, s71
    s_nop 0
    buffer_load_dwordx4 v2, s[32:35], s70 offen lds
    s_add_u32 s71, s71, 0x400
    s_add_u32 s70, s70, 0x1000
    v_xor_b32 v2, 192, v40
    s_mov_b32 m0, s71
    s_nop 0
    buffer_load_dwordx4 v2, s[32:35], s70 offen lds
    s_add_u32 s71, s71, 0x400
    s_add_u32 s70, s70, 0x1000
    v_xor_b32 v2, 0, v40
    s_mov_b32 m0, s71
    s_nop 0
    buffer_load_dwordx4 v2, s[32:35], s70 offen lds
    s_add_u32 s71, s71, 0x400
    s_add_u32 s70, s70, 0x1000
    v_xor_b32 v2, 64, v40
    s_mov_b32 m0, s71
    s_nop 0
    buffer_load_dwordx4 v2, s[32:35], s70 offen lds
    s_add_u32 s71, s71, 0x400
    s_add_u32 s70, s70, 0x1000
    v_xor_b32 v2, 128, v40
    s_mov_b32 m0, s71
    s_nop 0
    buffer_load_dwordx4 v2, s[32:35], s70 offen lds
    s_add_u32 s71, s71, 0x400
    s_add_u32 s70, s70, 0x1000
    v_xor_b32 v2, 192, v40
    s_mov_b32 m0, s71
    s_nop 0
    buffer_load_dwordx4 v2, s[32:35], s70 offen lds
    s_add_u32 s71, s71, 0x400
    s_add_u32 s70, s70, 0x1000
    s_waitcnt vmcnt(0)
    s_barrier
    s_lshl_b32 s4, s66, 7
    s_add_u32 s4, s4, 0x5110000
    s_cmp_lg_u32 s58, 4
    s_cbranch_scc1 armi_10
    buffer_load_dwordx2 v[120:121], off, s[12:15], 0 offset:32 sc1
    buffer_load_dwordx2 v[122:123], off, s[8:11], s4 sc1
armi_10:
    s_cmp_ge_u32 s58, 4
    s_cbranch_scc1 skip_11
    v_xor_b32 v2, 0x0, v41
    v_xor_b32 v3, 0x40, v41
    ds_read_b64_tr_b16 v[128:129], v2 offset:0
    ds_read_b64_tr_b16 v[130:131], v3 offset:512
    ds_read_b64_tr_b16 v[132:133], v2 offset:4096
    ds_read_b64_tr_b16 v[134:135], v3 offset:4608
    v_xor_b32 v2, 0x2000, v41
    v_xor_b32 v3, 0x2040, v41
    ds_read_b64_tr_b16 v[136:137], v2 offset:0
    ds_read_b64_tr_b16 v[138:139], v3 offset:512
    ds_read_b64_tr_b16 v[140:141], v2 offset:4096
    ds_read_b64_tr_b16 v[142:143], v3 offset:4608
    v_xor_b32 v2, 0x4000, v41
    v_xor_b32 v3, 0x4040, v41
    ds_read_b64_tr_b16 v[144:145], v2 offset:0
    ds_read_b64_tr_b16 v[146:147], v3 offset:512
    ds_read_b64_tr_b16 v[148:149], v2 offset:4096
    ds_read_b64_tr_b16 v[150:151], v3 offset:4608
    v_xor_b32 v2, 0x6000, v41
    v_xor_b32 v3, 0x6040, v41
    ds_read_b64_tr_b16 v[152:153], v2 offset:0
    ds_read_b64_tr_b16 v[154:155], v3 offset:512
    ds_read_b64_tr_b16 v[156:157], v2 offset:4096
    ds_read_b64_tr_b16 v[158:159], v3 offset:4608
    s_waitcnt lgkmcnt(0)
    v_xor_b32 v2, 0x10, v41
    v_xor_b32 v3, 0x50, v41
    ds_read_b64_tr_b16 v[160:161], v2 offset:0
    ds_read_b64_tr_b16 v[162:163], v3 offset:512
    ds_read_b64_tr_b16 v[164:165], v2 offset:4096
    ds_read_b64_tr_b16 v[166:167], v3 offset:4608
    v_xor_b32 v2, 0x2010, v41
    v_xor_b32 v3, 0x2050, v41
    ds_read_b64_tr_b16 v[168:169], v2 offset:0
    ds_read_b64_tr_b16 v[170:171], v3 offset:512
    ds_read_b64_tr_b16 v[172:173], v2 offset:4096
    ds_read_b64_tr_b16 v[174:175], v3 offset:4608
    v_xor_b32 v2, 0x4010, v41
    v_xor_b32 v3, 0x4050, v41
    ds_read_b64_tr_b16 v[176:177], v2 offset:0
    ds_read_b64_tr_b16 v[178:179], v3 offset:512
    ds_read_b64_tr_b16 v[180:181], v2 offset:4096
    ds_read_b64_tr_b16 v[182:183], v3 offset:4608
    v_xor_b32 v2, 0x6010, v41
    v_xor_b32 v3, 0x6050, v41
    ds_read_b64_tr_b16 v[184:185], v2 offset:0
    ds_read_b64_tr_b16 v[186:187], v3 offset:512
    ds_read_b64_tr_b16 v[188:189], v2 offset:4096
    ds_read_b64_tr_b16 v[190:191], v3 offset:4608
    s_waitcnt lgkmcnt(0)
skip_11:
    s_cmp_ge_u32 s58, 4
    s_cbranch_scc0 skip_12
    v_xor_b32 v2, 0, v42
    v_xor_b32 v3, 64, v42
    ds_read_b64_tr_b16 v[192:193], v2 offset:0
    ds_read_b64_tr_b16 v[194:195], v3 offset:1024
    ds_read_b64_tr_b16 v[196:197], v2 offset:8192
    ds_read_b64_tr_b16 v[198:199], v3 offset:9216
    ds_read_b64_tr_b16 v[200:201], v2 offset:32768
    ds_read_b64_tr_b16 v[202:203], v3 offset:33792
    ds_read_b64_tr_b16 v[204:205], v2 offset:40960
    ds_read_b64_tr_b16 v[206:207], v3 offset:41984
    ds_read_b64_tr_b16 v[224:225], v2 offset:256
    ds_read_b64_tr_b16 v[226:227], v3 offset:1280
    ds_read_b64_tr_b16 v[228:229], v2 offset:8448
    ds_read_b64_tr_b16 v[230:231], v3 offset:9472
    ds_read_b64_tr_b16 v[232:233], v2 offset:33024
    ds_read_b64_tr_b16 v[234:235], v3 offset:34048
    ds_read_b64_tr_b16 v[236:237], v2 offset:41216
    ds_read_b64_tr_b16 v[238:239], v3 offset:42240
    s_waitcnt lgkmcnt(0)
    v_xor_b32 v2, 32, v42
    v_xor_b32 v3, 96, v42
    ds_read_b64_tr_b16 v[208:209], v2 offset:0
    ds_read_b64_tr_b16 v[210:211], v3 offset:1024
    ds_read_b64_tr_b16 v[212:213], v2 offset:8192
    ds_read_b64_tr_b16 v[214:215], v3 offset:9216
    ds_read_b64_tr_b16 v[216:217], v2 offset:32768
    ds_read_b64_tr_b16 v[218:219], v3 offset:33792
    ds_read_b64_tr_b16 v[220:221], v2 offset:40960
    ds_read_b64_tr_b16 v[222:223], v3 offset:41984
    ds_read_b64_tr_b16 v[240:241], v2 offset:256
    ds_read_b64_tr_b16 v[242:243], v3 offset:1280
    ds_read_b64_tr_b16 v[244:245], v2 offset:8448
    ds_read_b64_tr_b16 v[246:247], v3 offset:9472
    ds_read_b64_tr_b16 v[248:249], v2 offset:33024
    ds_read_b64_tr_b16 v[250:251], v3 offset:34048
    ds_read_b64_tr_b16 v[252:253], v2 offset:41216
    ds_read_b64_tr_b16 v[254:255], v3 offset:42240
    s_waitcnt lgkmcnt(0)
skip_12:
    v_mov_b32 v4, 0x27ff0
    s_cmp_lg_u32 s58, 4
    s_cbranch_scc1 armw_13
    s_waitcnt vmcnt(0)
    v_and_b32 v5, 0x3ff, v120
    v_cmp_gt_u32 vcc, 128, v5
    s_cbranch_vccz armwait_ok_15
armwait_14:
    buffer_load_dwordx2 v[120:121], off, s[12:15], 0 offset:32 sc1
    buffer_load_dwordx2 v[122:123], off, s[8:11], s4 sc1
    s_waitcnt vmcnt(0)
    v_and_b32 v5, 0x3ff, v120
    v_cmp_gt_u32 vcc, 128, v5
    s_cbranch_vccz armwait_ok_15
    s_sub_u32 s69, s69, 1
    s_cbranch_scc0 armwait_14
    s_mov_b32 s69, 0
armwait_ok_15:
    ds_write_b64 v4, v[120:121]
    s_waitcnt lgkmcnt(0)
armw_13:
    s_barrier
    ds_read_b64 v[2:3], v4
    s_mov_b32 s59, 0
    s_waitcnt lgkmcnt(0)
    v_readfirstlane_b32 s70, v2
    v_readfirstlane_b32 s71, v3
    s_bfe_u32 s72, s70, 0xa000a
    s_cmp_gt_u32 s72, 128
    s_cselect_b32 s72, 1, 0
    s_or_b32 s59, s59, s72
    s_bfe_u32 s72, s70, 0xa0014
    s_cmp_gt_u32 s72, 128
    s_cselect_b32 s72, 2, 0
    s_or_b32 s59, s59, s72
    s_bfe_u32 s72, s71, 0xa000a
    s_cmp_gt_u32 s72, 128
    s_cselect_b32 s72, 4, 0
    s_or_b32 s59, s59, s72
    s_bfe_u32 s72, s71, 0xa0014
    s_cmp_gt_u32 s72, 128
    s_cselect_b32 s72, 8, 0
    s_or_b32 s59, s59, s72
    s_and_b32 s70, s59, 1
    s_lshl_b32 s70, s70, 13
    s_add_u32 s77, s77, s70
    s_add_u32 s76, s76, s70
    s_mov_b32 s68, 0
    s_mov_b32 s82, 0
    s_lshl_b32 s80, s66, 11
    s_lshl_b32 s70, s67, 9
    s_add_u32 s80, s80, s70
    v_bfe_u32 v38, v1, 0, 3
    v_lshlrev_b32 v38, 4, v38
    v_bfe_u32 v2, v1, 3, 1
    v_lshl_or_b32 v38, v2, 8, v38
    v_bfe_u32 v2, v1, 4, 2
    v_lshl_or_b32 v38, v2, 9, v38
    s_lshl_b32 s75, s80, 2
    s_add_u32 s75, s75, 0x1000000
    s_cmp_ge_u32 s58, 4
    s_cbranch_scc1 vo_main_16
    s_setprio 3
    s_lshl_b32 s70, s66, 4
    s_lshl_b32 s71, s64, 2
    s_add_u32 s71, s71, s67
    s_add_u32 s3, s70, s71
    s_add_u32 s80, s80, 0x3ff0000
    s_lshl_b32 s70, s67, 10
    v_add_u32 v102, s70, v8
    v_lshrrev_b32 v103, 2, v102
    v_bfe_u32 v2, v1, 0, 3
    v_lshlrev_b32 v2, 4, v2
    v_bfe_u32 v3, v1, 4, 2
    v_lshl_or_b32 v2, v3, 7, v2
    v_mov_b32 v3, 0x5ffffff0
    v_cmp_le_u32 vcc, 8, v6
    s_nop 1
    v_cndmask_b32 v104, v3, v2, vcc
    v_xor_b32 v100, 1024, v102
    v_xor_b32 v101, 2048, v102
    v_xor_b32 v36, 3072, v102
    v_xor_b32 v106, 0x400, v34
    v_bfe_u32 v105, v1, 0, 4
    v_lshlrev_b32 v105, 4, v105
    v_bfe_u32 v2, v1, 4, 2
    v_lshl_or_b32 v105, v2, 9, v105
    s_lshl_b32 s70, s64, 10
    s_xor_b32 s70, s70, 0x800
    v_xor_b32 v105, s70, v105
    v_and_b32 v2, 1, v1
    v_lshlrev_b32 v2, 4, v2
    v_mov_b32 v3, 0x3f80
    v_lshlrev_b32 v2, v2, v3
    v_bfe_u32 v3, v1, 1, 1
    v_bfe_u32 v4, v1, 3, 1
    v_lshl_or_b32 v3, v4, 1, v3
    v_bfe_u32 v4, v1, 2, 1
    v_lshl_or_b32 v3, v4, 2, v3
    v_bfe_u32 v4, v1, 4, 1
    v_lshlrev_b32 v4, 2, v4
    v_xor_b32 v3, v3, v4
    v_cmp_eq_u32 vcc, 0, v3
    s_nop 1
    v_cndmask_b32 v26, 0, v2, vcc
    v_cmp_eq_u32 vcc, 1, v3
    s_nop 1
    v_cndmask_b32 v27, 0, v2, vcc
    v_cmp_eq_u32 vcc, 2, v3
    s_nop 1
    v_cndmask_b32 v28, 0, v2, vcc
    v_cmp_eq_u32 vcc, 3, v3
    s_nop 1
    v_cndmask_b32 v29, 0, v2, vcc
    v_bfe_u32 v3, v1, 1, 1
    v_bfe_u32 v4, v1, 3, 1
    v_lshl_or_b32 v3, v4, 1, v3
    v_bfe_u32 v4, v1, 4, 1
    v_lshl_or_b32 v3, v4, 2, v3
    v_bfe_u32 v4, v1, 2, 1
    v_lshl_or_b32 v3, v4, 3, v3
    v_bfe_u32 v4, v1, 5, 1
    v_lshlrev_b32 v4, 3, v4
    v_xor_b32 v3, v3, v4
    v_cmp_eq_u32 vcc, 0, v3
    s_nop 1
    v_cndmask_b32 v92, 0, v2, vcc
    v_cmp_eq_u32 vcc, 1, v3
    s_nop 1
    v_cndmask_b32 v93, 0, v2, vcc
    v_cmp_eq_u32 vcc, 2, v3
    s_nop 1
    v_cndmask_b32 v94, 0, v2, vcc
    v_cmp_eq_u32 vcc, 3, v3
    s_nop 1
    v_cndmask_b32 v95, 0, v2, vcc
    v_cmp_eq_u32 vcc, 4, v3
    s_nop 1
    v_cndmask_b32 v96, 0, v2, vcc
    v_cmp_eq_u32 vcc, 5, v3
    s_nop 1
    v_cndmask_b32 v97, 0, v2, vcc
    v_cmp_eq_u32 vcc, 6, v3
    s_nop 1
    v_cndmask_b32 v98, 0, v2, vcc
    v_cmp_eq_u32 vcc, 7, v3
    s_nop 1
    v_cndmask_b32 v99, 0, v2, vcc
    v_bfe_u32 v3, v1, 2, 1
    v_bfe_u32 v4, v1, 1, 1
    v_lshl_or_b32 v3, v4, 1, v3
    v_bfe_u32 v4, v1, 3, 1
    v_lshl_or_b32 v3, v4, 2, v3
    v_bfe_u32 v4, v1, 4, 1
    v_lshlrev_b32 v4, 2, v4
    v_xor_b32 v3, v3, v4
    v_cmp_eq_u32 vcc, 0, v3
    s_nop 1
    v_cndmask_b32 v30, 0, v2, vcc
    v_cmp_eq_u32 vcc, 1, v3
    s_nop 1
    v_cndmask_b32 v31, 0, v2, vcc
    v_cmp_eq_u32 vcc, 2, v3
    s_nop 1
    v_cndmask_b32 v32, 0, v2, vcc
    v_cmp_eq_u32 vcc, 3, v3
    s_nop 1
    v_cndmask_b32 v33, 0, v2, vcc
    v_mov_b32 v40, 0
    v_mov_b32 v41, 0
    v_mov_b32 v42, 0
    v_mov_b32 v43, 0
    v_mov_b32 v44, 0
    v_mov_b32 v45, 0
    v_mov_b32 v46, 0
    v_mov_b32 v47, 0
    v_mov_b32 v48, 0
    v_mov_b32 v49, 0
    v_mov_b32 v50, 0
    v_mov_b32 v51, 0
    v_mov_b32 v52, 0
    v_mov_b32 v53, 0
    v_mov_b32 v54, 0
    v_mov_b32 v55, 0
    s_branch qk_loop_18
.p2align 6
qk_c_19:
    s_barrier
    buffer_load_dwordx4 v[56:59], v37, s[8:11], s76 offen offset:0 sc1
    buffer_load_dwordx4 v[60:63], v37, s[8:11], s76 offen offset:1024 sc1
    buffer_load_dwordx4 v[64:67], v37, s[8:11], s76 offen offset:2048 sc1
    buffer_load_dwordx4 v[68:71], v37, s[8:11], s76 offen offset:3072 sc1
c_w_21:
    s_waitcnt vmcnt(3)
    v_mfma_f32_16x16x32_bf16 v[72:75], v[56:59], v[30:33], 0
    s_waitcnt vmcnt(2)
    v_mfma_f32_16x16x32_bf16 v[72:75], v[60:63], v[30:33], v[72:75]
    s_waitcnt vmcnt(1)
    v_mfma_f32_16x16x32_bf16 v[76:79], v[64:67], v[30:33], 0
    v_max3_u32 v2, v56, v60, v64
    s_waitcnt vmcnt(0)
    v_mfma_f32_16x16x32_bf16 v[76:79], v[68:71], v[30:33], v[76:79]
    v_max_u32 v2, v2, v68
    v_cmp_eq_u32 vcc, -1, v2
    s_cbranch_vccnz c_s_20
c_j_22:
    v_cvt_pk_bf16_f32 v10, v72, v73
    v_cvt_pk_bf16_f32 v11, v74, v75
    s_nop 2
    v_cvt_pk_bf16_f32 v12, v76, v77
    v_cvt_pk_bf16_f32 v13, v78, v79
qk_loop_18:
    ds_write_b128 v102, v[10:13] offset:0
    s_waitcnt lgkmcnt(0)
    s_barrier
    ds_read_b128 v[14:17], v100 offset:0
    ds_read_b128 v[18:21], v101 offset:0
    ds_read_b128 v[22:25], v36 offset:0
    v_smfmac_f32_16x16x64_bf16 v[40:43], v[10:13], v[128:135], v7
    v_smfmac_f32_16x16x64_bf16 v[44:47], v[10:13], v[160:167], v7
    v_smfmac_f32_16x16x64_bf16 v[48:51], v[10:13], v[192:199], v7
    v_smfmac_f32_16x16x64_bf16 v[52:55], v[10:13], v[224:231], v7
    s_waitcnt lgkmcnt(2)
    v_smfmac_f32_16x16x64_bf16 v[40:43], v[14:17], v[136:143], v7
    v_smfmac_f32_16x16x64_bf16 v[44:47], v[14:17], v[168:175], v7
    s_waitcnt lgkmcnt(1)
    v_smfmac_f32_16x16x64_bf16 v[40:43], v[18:21], v[144:151], v7
    v_smfmac_f32_16x16x64_bf16 v[44:47], v[18:21], v[176:183], v7
    s_waitcnt lgkmcnt(0)
    v_smfmac_f32_16x16x64_bf16 v[40:43], v[22:25], v[152:159], v7
    v_smfmac_f32_16x16x64_bf16 v[44:47], v[22:25], v[184:191], v7
    v_smfmac_f32_16x16x64_bf16 v[48:51], v[14:17], v[200:207], v7
    v_smfmac_f32_16x16x64_bf16 v[48:51], v[18:21], v[208:215], v7
    v_smfmac_f32_16x16x64_bf16 v[48:51], v[22:25], v[216:223], v7
    v_smfmac_f32_16x16x64_bf16 v[52:55], v[14:17], v[232:239], v7
    s_nop 1
    v_smfmac_f32_16x16x64_bf16 v[52:55], v[18:21], v[240:247], v7
    v_pk_add_f32 v[40:41], v[40:41], v[42:43]
    v_cvt_pk_bf16_f32 v80, v40, v41
    v_smfmac_f32_16x16x64_bf16 v[52:55], v[22:25], v[248:255], v7
    v_pk_add_f32 v[44:45], v[44:45], v[46:47]
    v_cvt_pk_bf16_f32 v81, v44, v45
    v_pk_add_f32 v[48:49], v[48:49], v[50:51]
    v_cvt_pk_bf16_f32 v82, v48, v49
    v_permlane16_swap_b32 v80, v81
    v_bfi_b32 v80, 1, s82, v80
    s_nop 1
    v_pk_add_f32 v[52:53], v[52:53], v[54:55]
    v_cvt_pk_bf16_f32 v83, v52, v53
    s_nop 1
    v_permlane16_swap_b32 v82, v83
    buffer_store_dwordx4 v[80:83], v34, s[8:11], s73 offen
    s_barrier
    s_cmp_le_u32 s68, 1
    s_cbranch_scc1 kv0_23
kv0j_24:
    v_mfma_f32_16x16x32_bf16 v[72:75], v[80:83], v[92:95], 0
    v_mfma_f32_16x16x32_bf16 v[76:79], v[80:83], v[96:99], 0
    v_mov_b32 v40, 0
    v_mov_b32 v41, 0
    v_mov_b32 v42, 0
    v_mov_b32 v43, 0
    v_mov_b32 v44, 0
    v_mov_b32 v45, 0
    v_mov_b32 v46, 0
    v_mov_b32 v47, 0
    v_mov_b32 v48, 0
    v_mov_b32 v49, 0
    v_mov_b32 v50, 0
    v_mov_b32 v51, 0
    v_mov_b32 v52, 0
    v_mov_b32 v53, 0
    v_mov_b32 v54, 0
    v_mov_b32 v55, 0
    buffer_load_dwordx4 v[56:59], v106, s[8:11], s73 offen sc1
    buffer_load_dwordx4 v[60:63], v105, s[8:11], s73 offen sc1
    buffer_load_dwordx4 v[64:67], v105, s[8:11], s73 offen offset:256 sc1
x_w_26:
    s_waitcnt vmcnt(2)
    v_mfma_f32_16x16x32_bf16 v[18:21], v[56:59], v[92:95], v[72:75]
    v_mfma_f32_16x16x32_bf16 v[22:25], v[56:59], v[96:99], v[76:79]
    s_waitcnt vmcnt(1)
    v_mfma_f32_16x16x32_bf16 v[18:21], v[60:63], v[26:29], v[18:21]
    v_bitop3_b32 v2, v56, v60, s82 bitop3:0x7e
    s_waitcnt vmcnt(0)
    v_mfma_f32_16x16x32_bf16 v[22:25], v[64:67], v[26:29], v[22:25]
    v_xor_b32 v3, s82, v64
    v_bitop3_b32 v2, v2, v3, 1 bitop3:0xa8
    v_cmp_ne_u32 vcc, 0, v2
    s_cbranch_vccnz x_s_25
x_j_27:
    s_nop 0
    v_cvt_pk_bf16_f32 v80, v18, v19
    v_cvt_pk_bf16_f32 v81, v20, v21
    s_nop 0
    v_cvt_pk_bf16_f32 v82, v22, v23
    v_cvt_pk_bf16_f32 v83, v24, v25
    s_nop 1
    v_mfma_f32_16x16x32_bf16 v[18:21], v[80:83], v[80:83], 0
    s_nop 1
    v_mfma_f32_16x16x32_bf16 v[14:17], v[88:91], v[80:83], 0
    s_nop 1
    v_mfma_f32_16x16x32_bf16 v[10:13], v[84:87], v[80:83], 0
    s_nop 1
    v_mov_b32_dpp v18, v20 row_shr:8 row_mask:0xf bank_mask:0xc
    v_mov_b32_dpp v19, v21 row_shr:8 row_mask:0xf bank_mask:0xc
    s_nop 1
    v_permlane32_swap_b32 v18, v19
    ds_write_b32 v103, v19 offset:8192
    v_mov_b32_dpp v10, v14 row_shr:8 row_mask:0xf bank_mask:0xc
    v_mov_b32_dpp v11, v15 row_shr:8 row_mask:0xf bank_mask:0xc
    v_mov_b32_dpp v12, v16 row_shr:8 row_mask:0xf bank_mask:0xc
    v_mov_b32_dpp v13, v17 row_shr:8 row_mask:0xf bank_mask:0xc
    ds_write_b128 v102, v[10:13] offset:4096
    s_waitcnt lgkmcnt(0)
    s_barrier
    s_setprio 0
    s_add_u32 s77, s77, 0x20000
    s_lshr_b32 s60, s77, 21
    s_bitcmp1_b32 s59, s60
    s_cselect_b32 s60, 0x2000, 0
    s_bitset0_b32 s77, 13
    s_or_b32 s77, s77, s60
    s_add_u32 s76, s76, 0x20000
    s_lshr_b32 s60, s76, 21
    s_bitcmp1_b32 s59, s60
    s_cselect_b32 s60, 0x2000, 0
    s_bitset0_b32 s76, 13
    s_or_b32 s76, s76, s60
    s_add_u32 s80, s80, 0x10000
    s_and_b32 s72, s68, 3
    s_cmp_lg_u32 s72, s64
    s_cbranch_scc1 nokm_28
    v_min_u32 v80, -2, v80
    buffer_store_dwordx4 v[80:83], v104, s[8:11], s80 offen sc1
nokm_28:
    s_cmp_eq_u32 s68, 63
    s_cbranch_scc1 chain_end_17
    buffer_load_dwordx4 v[84:87], v38, s[8:11], s75 offen offset:0
    buffer_load_dwordx4 v[88:91], v38, s[8:11], s75 offen offset:128
    s_add_u32 s75, s75, 0x40000
    v_mov_b32 v10, -1
    v_mov_b32 v11, -1
    v_mov_b32 v12, -1
    v_mov_b32 v13, -1
    buffer_store_dwordx4 v[10:13], v35, s[8:11], s77 offen sc1
    s_cmp_lg_u32 s3, 1
    s_cbranch_scc1 noprog_29
    v_mov_b32 v2, s68
    buffer_store_dword v2, off, s[12:15], 0 offset:64 sc1
noprog_29:
    s_barrier
    s_add_u32 s68, s68, 1
    s_bfe_u32 s82, s68, 0x10001
    s_xor_b32 s73, s73, 0x80000
    s_setprio 3
    s_branch qk_c_19
c_s_20:
    buffer_load_dwordx4 v[56:59], v37, s[8:11], s76 offen offset:0 sc1
    buffer_load_dwordx4 v[60:63], v37, s[8:11], s76 offen offset:1024 sc1
    buffer_load_dwordx4 v[64:67], v37, s[8:11], s76 offen offset:2048 sc1
    buffer_load_dwordx4 v[68:71], v37, s[8:11], s76 offen offset:3072 sc1
    s_sub_u32 s69, s69, 1
    s_cbranch_scc0 c_w_21
    s_mov_b32 s69, 0
    s_branch c_j_22
kv0_23:
    s_bitset0_b32 s75, 30
    buffer_load_dwordx4 v[84:87], v38, s[8:11], s75 offen offset:0
    buffer_load_dwordx4 v[88:91], v38, s[8:11], s75 offen offset:128
    s_add_u32 s75, s75, 0x40000
    s_cmp_lt_u32 s68, 1
    s_cbranch_scc0 kv0j_24
    s_add_u32 s75, s75, 0x3ffc0000
    s_branch kv0j_24
x_s_25:
    buffer_load_dwordx4 v[56:59], v106, s[8:11], s73 offen sc1
    buffer_load_dwordx4 v[60:63], v105, s[8:11], s73 offen sc1
    buffer_load_dwordx4 v[64:67], v105, s[8:11], s73 offen offset:256 sc1
    s_sub_u32 s69, s69, 1
    s_cbranch_scc0 x_w_26
    s_mov_b32 s69, 0
    s_branch x_j_27
vo_main_16:
    s_setprio 1
    v_mov_b32 v88, 0x3f803f80
    v_mov_b32 v92, 0x3e803e80
    v_mov_b32 v89, 0x3f803f80
    v_mov_b32 v93, 0x3e803e80
    v_mov_b32 v90, 0x3f803f80
    v_mov_b32 v94, 0x3e803e80
    v_mov_b32 v91, 0x3f803f80
    v_mov_b32 v95, 0x3e803e80
    v_and_b32 v2, 1, v1
    v_lshlrev_b32 v2, 4, v2
    v_mov_b32 v3, 0x3f80
    v_lshlrev_b32 v2, v2, v3
    v_lshrrev_b32 v3, 1, v6
    v_cmp_eq_u32 vcc, 0, v3
    s_nop 1
    v_cndmask_b32 v26, 0, v2, vcc
    v_cmp_eq_u32 vcc, 1, v3
    s_nop 1
    v_cndmask_b32 v27, 0, v2, vcc
    v_cmp_eq_u32 vcc, 2, v3
    s_nop 1
    v_cndmask_b32 v28, 0, v2, vcc
    v_cmp_eq_u32 vcc, 3, v3
    s_nop 1
    v_cndmask_b32 v29, 0, v2, vcc
    v_bfe_u32 v119, v1, 0, 3
    v_lshlrev_b32 v119, 3, v119
    v_bfe_u32 v3, v1, 3, 1
    v_lshl_or_b32 v119, v3, 7, v119
    v_bfe_u32 v3, v1, 5, 1
    v_lshl_or_b32 v119, v3, 6, v119
    v_bfe_u32 v3, v1, 4, 1
    v_lshl_or_b32 v119, v3, 8, v119
    v_bfe_u32 v3, v1, 1, 3
    v_bfe_u32 v4, v1, 4, 1
    v_lshlrev_b32 v4, 1, v4
    v_xor_b32 v3, v3, v4
    v_cmp_eq_u32 vcc, 0, v3
    s_nop 1
    v_cndmask_b32 v100, 0, v2, vcc
    v_cndmask_b32 v102, 0, v2, vcc
    v_cmp_eq_u32 vcc, 1, v3
    s_nop 1
    v_cndmask_b32 v101, 0, v2, vcc
    v_cndmask_b32 v103, 0, v2, vcc
    v_cmp_eq_u32 vcc, 4, v3
    s_nop 1
    v_cndmask_b32 v104, 0, v2, vcc
    v_cndmask_b32 v106, 0, v2, vcc
    v_cmp_eq_u32 vcc, 5, v3
    s_nop 1
    v_cndmask_b32 v105, 0, v2, vcc
    v_cndmask_b32 v107, 0, v2, vcc
    s_add_u32 s80, s80, 0x4400000
    s_mov_b32 s81, 0x3e0293ee
    v_lshlrev_b32 v116, 2, v1
    v_bfe_u32 v118, v1, 0, 1
    v_lshlrev_b32 v118, 4, v118
    v_bfe_u32 v2, v1, 2, 2
    v_lshl_or_b32 v118, v2, 5, v118
    v_bfe_u32 v2, v1, 1, 1
    v_lshl_or_b32 v118, v2, 7, v118
    v_bfe_u32 v2, v1, 4, 2
    v_lshl_or_b32 v118, v2, 8, v118
    v_bfe_u32 v2, v1, 1, 1
    v_lshl_or_b32 v118, v2, 10, v118
    v_bfe_u32 v120, v1, 4, 2
    v_lshlrev_b32 v120, 3, v120
    s_add_u32 s75, s75, 0x1000000
    s_bfe_u32 s70, s67, 0x10000
    s_lshl_b32 s70, s70, 7
    s_bfe_u32 s71, s67, 0x20000
    s_lshl_b32 s71, s71, 10
    s_or_b32 s70, s70, s71
    v_xor_b32 v117, s70, v8
    s_cmp_eq_u32 s58, 4
    s_cselect_b32 s2, 0, 99
    s_mov_b32 s3, 0
    v_mov_b32 v40, 0
    v_mov_b32 v41, 0
    v_mov_b32 v42, 0
    v_mov_b32 v43, 0
    v_mov_b32 v44, 0
    v_mov_b32 v45, 0
    v_mov_b32 v46, 0
    v_mov_b32 v47, 0
    v_mov_b32 v48, 0
    v_mov_b32 v49, 0
    v_mov_b32 v50, 0
    v_mov_b32 v51, 0
    v_mov_b32 v52, 0
    v_mov_b32 v53, 0
    v_mov_b32 v54, 0
    v_mov_b32 v55, 0
    v_mov_b32 v56, 0
    v_mov_b32 v57, 0
    v_mov_b32 v58, 0
    v_mov_b32 v59, 0
    v_mov_b32 v60, 0
    v_mov_b32 v61, 0
    v_mov_b32 v62, 0
    v_mov_b32 v63, 0
    s_branch vo_loop_30
.p2align 6
vo_loop_30:
    s_barrier
    ds_read_b128 v[10:13], v8 offset:0
    ds_read_b128 v[14:17], v8 offset:1024
    ds_read_b128 v[18:21], v8 offset:2048
    ds_read_b128 v[22:25], v8 offset:3072
    s_cmp_ge_i32 s3, s2
    s_cbranch_scc1 kvg_32
kvj_34:
    s_add_u32 s3, s3, 1
    s_barrier
    s_cmp_le_u32 s68, 1
    s_cbranch_scc1 kv0_35
kv0j_36:
    s_waitcnt lgkmcnt(3)
    v_smfmac_f32_16x16x64_bf16 v[40:43], v[10:13], v[128:135], v7
    v_smfmac_f32_16x16x64_bf16 v[44:47], v[10:13], v[160:167], v7
    s_waitcnt lgkmcnt(2)
    v_smfmac_f32_16x16x64_bf16 v[40:43], v[14:17], v[136:143], v7
    v_smfmac_f32_16x16x64_bf16 v[44:47], v[14:17], v[168:175], v7
    s_waitcnt lgkmcnt(1)
    v_smfmac_f32_16x16x64_bf16 v[40:43], v[18:21], v[144:151], v7
    v_smfmac_f32_16x16x64_bf16 v[44:47], v[18:21], v[176:183], v7
    s_waitcnt lgkmcnt(0)
    v_smfmac_f32_16x16x64_bf16 v[40:43], v[22:25], v[152:159], v7
    v_smfmac_f32_16x16x64_bf16 v[44:47], v[22:25], v[184:191], v7
    s_nop 6
    v_pk_add_f32 v[40:41], v[40:41], v[42:43]
    v_cvt_pk_bf16_f32 v80, v40, v41
    v_pk_add_f32 v[44:45], v[44:45], v[46:47]
    v_cvt_pk_bf16_f32 v81, v44, v45
    s_nop 1
    v_permlane16_swap_b32 v80, v81
    v_bfi_b32 v80, 1, s82, v80
    buffer_store_dwordx2 v[80:81], v34, s[8:11], s73 offen
    s_and_b32 s70, s68, 1
    s_lshl_b32 s70, s70, 19
    s_add_u32 s71, s70, s79
    s_add_u32 s70, s70, s78
    s_cmp_eq_u32 s68, 63
    s_cbranch_scc1 vo_last_31
    s_waitcnt vmcnt(1)
    s_cmp_ge_i32 s3, s2
    s_cbranch_scc1 kvg_37
kvj_39:
    s_barrier
    ds_read_b128 v[10:13], v8 offset:4096
    ds_read_b128 v[14:17], v8 offset:5120
    ds_read2st64_b32 v[30:31], v116 offset0:32 offset1:33
    ds_read_b128 v[18:21], v8 offset:6144
    ds_read_b128 v[22:25], v8 offset:7168
    ds_read2st64_b32 v[32:33], v116 offset0:34 offset1:35
    buffer_load_dwordx4 v[64:67], v8, s[8:11], s73 offen offset:0 sc1
    buffer_load_dwordx4 v[68:71], v8, s[8:11], s73 offen offset:1024 sc1
    s_waitcnt lgkmcnt(4)
    v_pk_add_f32 v[10:11], v[10:11], v[14:15]
    v_pk_add_f32 v[12:13], v[12:13], v[16:17]
    s_waitcnt lgkmcnt(2)
    v_pk_add_f32 v[10:11], v[10:11], v[18:19]
    v_pk_add_f32 v[12:13], v[12:13], v[20:21]
    s_waitcnt lgkmcnt(0)
    v_pk_add_f32 v[30:31], v[30:31], v[32:33]
    v_pk_add_f32 v[10:11], v[10:11], v[22:23]
    v_pk_add_f32 v[12:13], v[12:13], v[24:25]
    v_add_f32 v14, v30, v31
    v_max3_f32 v2, v10, v11, v12
    v_max3_f32 v3, v2, v13, v14
    v_max3_f32 v2, v2, v13, v14
    s_nop 1
    v_permlane32_swap_b32 v2, v3
    v_max_f32 v4, v2, v3
    v_max_f32 v3, v2, v3
    s_nop 1
    v_permlane16_swap_b32 v4, v3
    v_max_f32 v2, v4, v3
    v_mul_f32 v2, s81, v2
    s_nop 1
    v_max_f32_dpp v2, v2, v2 row_ror:8 row_mask:0xf bank_mask:0xf
    v_fma_f32 v10, v10, s81, -v2
    v_fma_f32 v11, v11, s81, -v2
    v_fma_f32 v12, v12, s81, -v2
    v_fma_f32 v13, v13, s81, -v2
    v_fma_f32 v14, v14, s81, -v2
    v_exp_f32 v10, v10
    v_exp_f32 v11, v11
    v_exp_f32 v12, v12
    v_exp_f32 v13, v13
    v_exp_f32 v15, v14
    v_cvt_pk_bf16_f32 v80, v10, v11
    v_cvt_pk_bf16_f32 v81, v12, v13
    v_mov_b32 v14, v15
    v_mov_b32_dpp v82, v80 row_ror:8 row_mask:0xf bank_mask:0xf
    v_mov_b32_dpp v83, v81 row_ror:8 row_mask:0xf bank_mask:0xf
    v_permlane32_swap_b32 v14, v15
    v_cvt_pk_bf16_f32 v84, v14, v15
    v_mfma_f32_16x16x32_bf16 v[108:111], v[72:75], v[80:83], 0
    v_mov_b32 v86, v84
    v_mov_b32_dpp v85, v84 row_ror:8 row_mask:0xf bank_mask:0xf
    v_mov_b32_dpp v87, v84 row_ror:8 row_mask:0xf bank_mask:0xf
    v_mfma_f32_16x16x32_bf16 v[112:115], v[76:79], v[80:83], 0
xv_w_41:
    s_waitcnt vmcnt(0)
    v_mfma_f32_16x16x32_bf16 v[18:21], v[64:67], v[84:87], v[108:111]
    v_bitop3_b32 v2, v64, v66, s82 bitop3:0x7e
    v_bitop3_b32 v3, v68, v70, s82 bitop3:0x7e
    v_mfma_f32_16x16x32_bf16 v[22:25], v[68:71], v[84:87], v[112:115]
    v_bitop3_b32 v2, v2, v3, 1 bitop3:0xa8
    v_cmp_ne_u32 vcc, 0, v2
    s_cbranch_vccnz xv_s_40
xv_j_42:
    v_mfma_f32_16x16x32_bf16 v[96:99], v[88:91], v[80:83], 0
    s_nop 0
    v_cvt_pk_bf16_f32 v108, v18, v19
    v_cvt_pk_bf16_f32 v109, v20, v21
    s_nop 0
    v_cvt_pk_bf16_f32 v110, v22, v23
    v_cvt_pk_bf16_f32 v111, v24, v25
    ds_write_b128 v117, v[108:111] offset:9216
    v_mfma_f32_16x16x32_bf16 v[96:99], v[92:95], v[84:87], v[96:99]
    s_nop 3
    s_waitcnt lgkmcnt(0)
    s_barrier
    ds_read_b128 v[10:13], v118 offset:9216
    ds_read_b128 v[14:17], v118 offset:11264
    v_rcp_f32 v98, v96
    s_nop 0
    ds_bpermute_b32 v96, v120, v98 offset:0
    ds_bpermute_b32 v97, v120, v98 offset:4
    s_waitcnt lgkmcnt(3)
    v_smfmac_f32_16x16x64_bf16 v[48:51], v[10:13], v[192:199], v7
    v_smfmac_f32_16x16x64_bf16 v[52:55], v[10:13], v[208:215], v7
    s_waitcnt lgkmcnt(2)
    v_smfmac_f32_16x16x64_bf16 v[48:51], v[14:17], v[200:207], v7
    s_nop 1
    v_smfmac_f32_16x16x64_bf16 v[52:55], v[14:17], v[216:223], v7
    s_nop 1
    v_smfmac_f32_16x16x64_bf16 v[56:59], v[10:13], v[224:231], v7
    s_waitcnt lgkmcnt(0)
    v_smfmac_f32_16x16x64_bf16 v[56:59], v[14:17], v[232:239], v7
    v_pk_add_f32 v[48:49], v[48:49], v[50:51]
    v_smfmac_f32_16x16x64_bf16 v[60:63], v[10:13], v[240:247], v7
    v_pk_mul_f32 v[48:49], v[48:49], v[96:97]
    v_cvt_pk_bf16_f32 v80, v48, v49
    v_smfmac_f32_16x16x64_bf16 v[60:63], v[14:17], v[248:255], v7
    v_pk_add_f32 v[52:53], v[52:53], v[54:55]
    v_pk_mul_f32 v[52:53], v[52:53], v[96:97]
    v_cvt_pk_bf16_f32 v81, v52, v53
    v_pk_add_f32 v[56:57], v[56:57], v[58:59]
    v_pk_mul_f32 v[56:57], v[56:57], v[96:97]
    v_cvt_pk_bf16_f32 v82, v56, v57
    v_permlane16_swap_b32 v80, v81
    v_bfi_b32 v80, 1, s82, v80
    v_pk_add_f32 v[60:61], v[60:61], v[62:63]
    v_pk_mul_f32 v[60:61], v[60:61], v[96:97]
    v_cvt_pk_bf16_f32 v83, v60, v61
    s_nop 1
    v_permlane16_swap_b32 v82, v83
    buffer_store_dwordx4 v[80:83], v36, s[8:11], s71 offen
    s_waitcnt vmcnt(0)
    buffer_load_dwordx4 v[10:13], v8, s[8:11], s70 offen sc1
b_w_44:
    s_waitcnt vmcnt(0)
    v_mfma_f32_16x16x32_bf16 v[30:33], v[26:29], v[10:13], 0
    v_bitop3_b32 v2, v10, s82, 1 bitop3:0x28
    v_cmp_ne_u32 vcc, 0, v2
    s_cbranch_vccnz b_s_43
b_j_45:
    s_nop 4
    v_add_f32_dpp v30, v30, v30 row_ror:8 row_mask:0xf bank_mask:0xf
    v_add_f32_dpp v31, v31, v31 row_ror:8 row_mask:0xf bank_mask:0xf
    v_add_f32_dpp v32, v32, v32 row_ror:8 row_mask:0xf bank_mask:0xf
    v_add_f32_dpp v33, v33, v33 row_ror:8 row_mask:0xf bank_mask:0xf
    v_cvt_pk_bf16_f32 v30, v30, v31
    v_cvt_pk_bf16_f32 v31, v32, v33
    v_min_u32 v30, -2, v30
    s_nop 0
    v_permlane16_swap_b32 v31, v33
    v_permlane16_swap_b32 v30, v32
    buffer_store_dwordx4 v[30:33], v35, s[8:11], s77 offen sc1
    s_add_u32 s68, s68, 1
    s_bfe_u32 s82, s68, 0x10001
    s_xor_b32 s73, s73, 0x40000
    s_add_u32 s77, s77, 0x20000
    s_lshr_b32 s60, s77, 21
    s_bitcmp1_b32 s59, s60
    s_cselect_b32 s60, 0x2000, 0
    s_bitset0_b32 s77, 13
    s_or_b32 s77, s77, s60
    v_mov_b32 v40, 0
    v_mov_b32 v41, 0
    v_mov_b32 v42, 0
    v_mov_b32 v43, 0
    v_mov_b32 v44, 0
    v_mov_b32 v45, 0
    v_mov_b32 v46, 0
    v_mov_b32 v47, 0
    v_mov_b32 v48, 0
    v_mov_b32 v49, 0
    v_mov_b32 v50, 0
    v_mov_b32 v51, 0
    v_mov_b32 v52, 0
    v_mov_b32 v53, 0
    v_mov_b32 v54, 0
    v_mov_b32 v55, 0
    v_mov_b32 v56, 0
    v_mov_b32 v57, 0
    v_mov_b32 v58, 0
    v_mov_b32 v59, 0
    v_mov_b32 v60, 0
    v_mov_b32 v61, 0
    v_mov_b32 v62, 0
    v_mov_b32 v63, 0
    buffer_load_dwordx4 v[72:75], v38, s[8:11], s75 offen offset:0
    buffer_load_dwordx4 v[76:79], v38, s[8:11], s75 offen offset:128
    s_add_u32 s75, s75, 0x40000
    s_waitcnt vmcnt(2)
    s_barrier
    s_and_b32 s72, s68, 3
    s_cmp_lg_u32 s72, s64
    s_cbranch_scc1 novm_46
    v_mfma_f32_16x16x32_bf16 v[108:111], v[100:103], v[64:67], 0
    v_mfma_f32_16x16x32_bf16 v[108:111], v[104:107], v[68:71], v[108:111]
    s_nop 7
    v_cvt_pk_bf16_f32 v108, v108, v109
    v_cvt_pk_bf16_f32 v109, v110, v111
    v_min_u32 v108, -2, v108
    buffer_store_dwordx2 v[108:109], v119, s[8:11], s80 offen sc1
novm_46:
    s_add_u32 s80, s80, 0x10000
    s_add_u32 s72, s3, 1
    s_cmp_lt_i32 s72, s2
    s_cbranch_scc1 vo_loop_30
    buffer_load_dwordx2 v[122:123], off, s[8:11], s4 sc1
    s_branch vo_loop_30
kvp_33:
    buffer_load_dwordx2 v[122:123], off, s[8:11], s4 sc1
    s_waitcnt vmcnt(0)
kvg_32:
    v_min_i32 v122, v122, v123
    s_nop 0
    v_readfirstlane_b32 s2, v122
    s_nop 0
    s_cmp_lt_i32 s3, s2
    s_cbranch_scc1 kvj_34
    s_sub_u32 s69, s69, 1
    s_cbranch_scc0 kvp_33
    s_mov_b32 s69, 0
    s_branch kvj_34
kv0_35:
    s_bitset0_b32 s75, 30
    buffer_load_dwordx4 v[72:75], v38, s[8:11], s75 offen offset:0
    buffer_load_dwordx4 v[76:79], v38, s[8:11], s75 offen offset:128
    s_add_u32 s75, s75, 0x40000
    s_cmp_lt_u32 s68, 1
    s_cbranch_scc0 kv0j_36
    s_add_u32 s75, s75, 0x3ffc0000
    s_branch kv0j_36
kvp_38:
    buffer_load_dwordx2 v[122:123], off, s[8:11], s4 sc1
    s_waitcnt vmcnt(0)
kvg_37:
    s_cmp_lt_u32 s68, 1
    s_cbranch_scc1 kvj_39
    v_min_i32 v122, v122, v123
    s_nop 0
    v_readfirstlane_b32 s2, v122
    s_nop 0
    s_cmp_lt_i32 s3, s2
    s_cbranch_scc1 kvj_39
    s_sub_u32 s69, s69, 1
    s_cbranch_scc0 kvp_38
    s_mov_b32 s69, 0
    s_branch kvj_39
xv_s_40:
    buffer_load_dwordx4 v[64:67], v8, s[8:11], s73 offen offset:0 sc1
    buffer_load_dwordx4 v[68:71], v8, s[8:11], s73 offen offset:1024 sc1
    s_sub_u32 s69, s69, 1
    s_cbranch_scc0 xv_w_41
    s_mov_b32 s69, 0
    s_branch xv_j_42
b_s_43:
    buffer_load_dwordx4 v[10:13], v8, s[8:11], s70 offen sc1
    s_sub_u32 s69, s69, 1
    s_cbranch_scc0 b_w_44
    s_mov_b32 s69, 0
    s_branch b_j_45
vo_last_31:
    s_cmp_lg_u32 s64, 0
    s_cbranch_scc1 chain_end_17
pollvm_47:
    buffer_load_dwordx4 v[64:67], v8, s[8:11], s73 offen offset:0 sc1
    buffer_load_dwordx4 v[68:71], v8, s[8:11], s73 offen offset:1024 sc1
    s_waitcnt vmcnt(0)
    v_bitop3_b32 v2, v64, v66, s82 bitop3:0x7e
    v_bitop3_b32 v3, v68, v70, s82 bitop3:0x7e
    v_bitop3_b32 v2, v2, v3, 1 bitop3:0xa8
    v_cmp_ne_u32 vcc, 0, v2
    s_cbranch_vccz pollvm_ok_48
    s_sub_u32 s69, s69, 1
    s_cbranch_scc0 pollvm_47
    s_mov_b32 s69, 0
pollvm_ok_48:
    v_mfma_f32_16x16x32_bf16 v[108:111], v[100:103], v[64:67], 0
    v_mfma_f32_16x16x32_bf16 v[108:111], v[104:107], v[68:71], v[108:111]
    s_nop 7
    v_cvt_pk_bf16_f32 v108, v108, v109
    v_cvt_pk_bf16_f32 v109, v110, v111
    v_min_u32 v108, -2, v108
    buffer_store_dwordx2 v[108:109], v119, s[8:11], s80 offen sc1
chain_end_17:
    s_waitcnt vmcnt(0)
    s_endpgm
bulk_2:
    s_and_b32 s75, s56, 3
    s_lshl_b32 s76, s75, 5
    s_add_u32 s76, s76, s57
    s_mov_b32 s77, 0x40000
    s_mov_b32 s84, 1
    s_cmp_ge_u32 s57, 24
    s_cbranch_scc1 fft_52
    s_mov_b32 s83, 160
    s_mov_b32 s6, 0x4444557e
    s_mov_b32 s7, 0x44444444
    s_mov_b64 s[60:61], s[36:37]
    s_mov_b32 s62, 0x400000
    s_mov_b32 s63, 0x20000
    s_bitcmp1_b32 s57, 3
    s_cbranch_scc1 sv_53
    s_mov_b64 s[64:65], s[24:25]
    s_mov_b32 s66, 0x800000
    s_mov_b32 s67, 0x20000
    s_mov_b32 s81, 0x1000000
    s_cmp_lt_u32 s57, 8
    s_cbranch_scc1 sf_54
    s_mov_b64 s[64:65], s[20:21]
    s_mov_b32 s66, 0x800000
    s_mov_b32 s67, 0x20000
    s_mov_b32 s81, 0x0
    s_mov_b32 s84, 0x10000
    v_bfe_u32 v120, v1, 0, 1
    v_lshlrev_b32 v120, 7, v120
    v_bfe_u32 v121, v1, 1, 5
    v_lshl_or_b32 v120, v121, 13, v120
    s_bfe_u32 s79, s58, 0x20000
    s_lshl_b32 s79, s79, 19
    s_bfe_u32 s85, s58, 0x10002
    s_lshl_b32 s85, s85, 22
    s_or_b32 s79, s79, s85
    s_bfe_u32 s80, s76, 0x30000
    s_lshl_b32 s80, s80, 8
    s_bfe_u32 s85, s76, 0x20005
    s_lshl_b32 s85, s85, 11
    s_or_b32 s80, s80, s85
    s_bfe_u32 s85, s76, 0x10000
    s_lshl_b32 s85, s85, 21
    s_or_b32 s80, s80, s85
    s_add_u32 s79, s79, s80
    s_xor_b32 s85, s79, 0x200000
    buffer_load_dword v122, v120, s[24:27], s85 offen
    s_xor_b32 s85, s79, 0x200000
    buffer_load_dword v123, v120, s[28:31], s85 offen
    s_add_u32 s79, s76, 8
    s_lshl_b32 s85, s79, 3
    s_add_u32 s85, s85, s58
    v_lshlrev_b32 v4, 2, v1
    v_mul_u32_u24 v4, s85, v4
    v_mov_b32 v8, 253
    v_and_b32 v5, 0x3ff, v4
    v_cvt_f32_u32 v5, v5
    v_mul_f32 v5, 0x3a800000, v5
    v_cos_f32 v6, v5
    v_sin_f32 v7, -v5
    v_add_u32 v4, s85, v4
    v_cvt_pk_bf16_f32 v10, v6, v7
    v_and_b32 v5, 0x3ff, v4
    v_cvt_f32_u32 v5, v5
    v_mul_f32 v5, 0x3a800000, v5
    v_cos_f32 v6, v5
    v_sin_f32 v7, -v5
    v_add_u32 v4, s85, v4
    v_cvt_pk_bf16_f32 v11, v6, v7
    v_and_b32 v5, 0x3ff, v4
    v_cvt_f32_u32 v5, v5
    v_mul_f32 v5, 0x3a800000, v5
    v_cos_f32 v6, v5
    v_sin_f32 v7, -v5
    v_add_u32 v4, s85, v4
    v_cvt_pk_bf16_f32 v12, v6, v7
    v_and_b32 v5, 0x3ff, v4
    v_cvt_f32_u32 v5, v5
    v_mul_f32 v5, 0x3a800000, v5
    v_cos_f32 v6, v5
    v_sin_f32 v7, -v5
    v_mad_u32_u24 v4, s85, v8, v4
    v_cvt_pk_bf16_f32 v13, v6, v7
    v_and_b32 v5, 0x3ff, v4
    v_cvt_f32_u32 v5, v5
    v_mul_f32 v5, 0x3a800000, v5
    v_cos_f32 v6, v5
    v_sin_f32 v7, -v5
    v_add_u32 v4, s85, v4
    v_cvt_pk_bf16_f32 v14, v6, v7
    v_and_b32 v5, 0x3ff, v4
    v_cvt_f32_u32 v5, v5
    v_mul_f32 v5, 0x3a800000, v5
    v_cos_f32 v6, v5
    v_sin_f32 v7, -v5
    v_add_u32 v4, s85, v4
    v_cvt_pk_bf16_f32 v15, v6, v7
    v_and_b32 v5, 0x3ff, v4
    v_cvt_f32_u32 v5, v5
    v_mul_f32 v5, 0x3a800000, v5
    v_cos_f32 v6, v5
    v_sin_f32 v7, -v5
    v_add_u32 v4, s85, v4
    v_cvt_pk_bf16_f32 v16, v6, v7
    v_and_b32 v5, 0x3ff, v4
    v_cvt_f32_u32 v5, v5
    v_mul_f32 v5, 0x3a800000, v5
    v_cos_f32 v6, v5
    v_sin_f32 v7, -v5
    v_add_u32 v4, s85, v4
    v_cvt_pk_bf16_f32 v17, v6, v7
    v_mov_b32 v5, s85
    v_lshlrev_b32 v5, 31, v5
    v_or_b32 v5, 0x3f803f80, v5
    v_cmp_eq_u32 vcc, 0, v1
    s_nop 1
    v_cndmask_b32 v10, v10, v5, vcc
    v_lshlrev_b32 v8, 4, v1
    s_lshl_b32 s85, s85, 11
    s_add_u32 s85, s85, 0x5200000
    buffer_store_dwordx4 v[10:13], v8, s[8:11], s85 offen sc1
    buffer_store_dwordx4 v[14:17], v8, s[8:11], s85 offen offset:1024 sc1
    s_sub_u32 s79, s79, 8
    s_lshl_b32 s85, s79, 3
    s_add_u32 s85, s85, s58
    v_lshlrev_b32 v20, 2, v1
    v_mul_u32_u24 v20, s85, v20
    v_mov_b32 v24, 253
    v_and_b32 v21, 0x3ff, v20
    v_cvt_f32_u32 v21, v21
    v_mul_f32 v21, 0x3a800000, v21
    v_cos_f32 v22, v21
    v_sin_f32 v23, -v21
    v_add_u32 v20, s85, v20
    v_cvt_pk_bf16_f32 v26, v22, v23
    v_and_b32 v21, 0x3ff, v20
    v_cvt_f32_u32 v21, v21
    v_mul_f32 v21, 0x3a800000, v21
    v_cos_f32 v22, v21
    v_sin_f32 v23, -v21
    v_add_u32 v20, s85, v20
    v_cvt_pk_bf16_f32 v27, v22, v23
    v_and_b32 v21, 0x3ff, v20
    v_cvt_f32_u32 v21, v21
    v_mul_f32 v21, 0x3a800000, v21
    v_cos_f32 v22, v21
    v_sin_f32 v23, -v21
    v_add_u32 v20, s85, v20
    v_cvt_pk_bf16_f32 v28, v22, v23
    v_and_b32 v21, 0x3ff, v20
    v_cvt_f32_u32 v21, v21
    v_mul_f32 v21, 0x3a800000, v21
    v_cos_f32 v22, v21
    v_sin_f32 v23, -v21
    v_mad_u32_u24 v20, s85, v24, v20
    v_cvt_pk_bf16_f32 v29, v22, v23
    v_and_b32 v21, 0x3ff, v20
    v_cvt_f32_u32 v21, v21
    v_mul_f32 v21, 0x3a800000, v21
    v_cos_f32 v22, v21
    v_sin_f32 v23, -v21
    v_add_u32 v20, s85, v20
    v_cvt_pk_bf16_f32 v30, v22, v23
    v_and_b32 v21, 0x3ff, v20
    v_cvt_f32_u32 v21, v21
    v_mul_f32 v21, 0x3a800000, v21
    v_cos_f32 v22, v21
    v_sin_f32 v23, -v21
    v_add_u32 v20, s85, v20
    v_cvt_pk_bf16_f32 v31, v22, v23
    v_and_b32 v21, 0x3ff, v20
    v_cvt_f32_u32 v21, v21
    v_mul_f32 v21, 0x3a800000, v21
    v_cos_f32 v22, v21
    v_sin_f32 v23, -v21
    v_add_u32 v20, s85, v20
    v_cvt_pk_bf16_f32 v32, v22, v23
    v_and_b32 v21, 0x3ff, v20
    v_cvt_f32_u32 v21, v21
    v_mul_f32 v21, 0x3a800000, v21
    v_cos_f32 v22, v21
    v_sin_f32 v23, -v21
    v_add_u32 v20, s85, v20
    v_cvt_pk_bf16_f32 v33, v22, v23
    v_mov_b32 v21, s85
    v_lshlrev_b32 v21, 31, v21
    v_or_b32 v21, 0x3f803f80, v21
    v_cmp_eq_u32 vcc, 0, v1
    s_nop 1
    v_cndmask_b32 v26, v26, v21, vcc
    v_lshlrev_b32 v24, 4, v1
    s_lshl_b32 s85, s85, 11
    s_add_u32 s85, s85, 0x5200000
    buffer_store_dwordx4 v[26:29], v24, s[8:11], s85 offen sc1
    buffer_store_dwordx4 v[30:33], v24, s[8:11], s85 offen offset:1024 sc1
    s_sub_u32 s79, s79, 8
    s_lshl_b32 s85, s79, 3
    s_add_u32 s85, s85, s58
    v_lshlrev_b32 v36, 2, v1
    v_mul_u32_u24 v36, s85, v36
    v_mov_b32 v40, 253
    v_and_b32 v37, 0x3ff, v36
    v_cvt_f32_u32 v37, v37
    v_mul_f32 v37, 0x3a800000, v37
    v_cos_f32 v38, v37
    v_sin_f32 v39, -v37
    v_add_u32 v36, s85, v36
    v_cvt_pk_bf16_f32 v42, v38, v39
    v_and_b32 v37, 0x3ff, v36
    v_cvt_f32_u32 v37, v37
    v_mul_f32 v37, 0x3a800000, v37
    v_cos_f32 v38, v37
    v_sin_f32 v39, -v37
    v_add_u32 v36, s85, v36
    v_cvt_pk_bf16_f32 v43, v38, v39
    v_and_b32 v37, 0x3ff, v36
    v_cvt_f32_u32 v37, v37
    v_mul_f32 v37, 0x3a800000, v37
    v_cos_f32 v38, v37
    v_sin_f32 v39, -v37
    v_add_u32 v36, s85, v36
    v_cvt_pk_bf16_f32 v44, v38, v39
    v_and_b32 v37, 0x3ff, v36
    v_cvt_f32_u32 v37, v37
    v_mul_f32 v37, 0x3a800000, v37
    v_cos_f32 v38, v37
    v_sin_f32 v39, -v37
    v_mad_u32_u24 v36, s85, v40, v36
    v_cvt_pk_bf16_f32 v45, v38, v39
    v_and_b32 v37, 0x3ff, v36
    v_cvt_f32_u32 v37, v37
    v_mul_f32 v37, 0x3a800000, v37
    v_cos_f32 v38, v37
    v_sin_f32 v39, -v37
    v_add_u32 v36, s85, v36
    v_cvt_pk_bf16_f32 v46, v38, v39
    v_and_b32 v37, 0x3ff, v36
    v_cvt_f32_u32 v37, v37
    v_mul_f32 v37, 0x3a800000, v37
    v_cos_f32 v38, v37
    v_sin_f32 v39, -v37
    v_add_u32 v36, s85, v36
    v_cvt_pk_bf16_f32 v47, v38, v39
    v_and_b32 v37, 0x3ff, v36
    v_cvt_f32_u32 v37, v37
    v_mul_f32 v37, 0x3a800000, v37
    v_cos_f32 v38, v37
    v_sin_f32 v39, -v37
    v_add_u32 v36, s85, v36
    v_cvt_pk_bf16_f32 v48, v38, v39
    v_and_b32 v37, 0x3ff, v36
    v_cvt_f32_u32 v37, v37
    v_mul_f32 v37, 0x3a800000, v37
    v_cos_f32 v38, v37
    v_sin_f32 v39, -v37
    v_add_u32 v36, s85, v36
    v_cvt_pk_bf16_f32 v49, v38, v39
    v_mov_b32 v37, s85
    v_lshlrev_b32 v37, 31, v37
    v_or_b32 v37, 0x3f803f80, v37
    v_cmp_eq_u32 vcc, 0, v1
    s_nop 1
    v_cndmask_b32 v42, v42, v37, vcc
    v_lshlrev_b32 v40, 4, v1
    s_lshl_b32 s85, s85, 11
    s_add_u32 s85, s85, 0x5200000
    buffer_store_dwordx4 v[42:45], v40, s[8:11], s85 offen sc1
    buffer_store_dwordx4 v[46:49], v40, s[8:11], s85 offen offset:1024 sc1
    s_sub_u32 s79, s79, 8
    s_lshl_b32 s85, s79, 3
    s_add_u32 s85, s85, s58
    v_lshlrev_b32 v52, 2, v1
    v_mul_u32_u24 v52, s85, v52
    v_mov_b32 v56, 253
    v_and_b32 v53, 0x3ff, v52
    v_cvt_f32_u32 v53, v53
    v_mul_f32 v53, 0x3a800000, v53
    v_cos_f32 v54, v53
    v_sin_f32 v55, -v53
    v_add_u32 v52, s85, v52
    v_cvt_pk_bf16_f32 v58, v54, v55
    v_and_b32 v53, 0x3ff, v52
    v_cvt_f32_u32 v53, v53
    v_mul_f32 v53, 0x3a800000, v53
    v_cos_f32 v54, v53
    v_sin_f32 v55, -v53
    v_add_u32 v52, s85, v52
    v_cvt_pk_bf16_f32 v59, v54, v55
    v_and_b32 v53, 0x3ff, v52
    v_cvt_f32_u32 v53, v53
    v_mul_f32 v53, 0x3a800000, v53
    v_cos_f32 v54, v53
    v_sin_f32 v55, -v53
    v_add_u32 v52, s85, v52
    v_cvt_pk_bf16_f32 v60, v54, v55
    v_and_b32 v53, 0x3ff, v52
    v_cvt_f32_u32 v53, v53
    v_mul_f32 v53, 0x3a800000, v53
    v_cos_f32 v54, v53
    v_sin_f32 v55, -v53
    v_mad_u32_u24 v52, s85, v56, v52
    v_cvt_pk_bf16_f32 v61, v54, v55
    v_and_b32 v53, 0x3ff, v52
    v_cvt_f32_u32 v53, v53
    v_mul_f32 v53, 0x3a800000, v53
    v_cos_f32 v54, v53
    v_sin_f32 v55, -v53
    v_add_u32 v52, s85, v52
    v_cvt_pk_bf16_f32 v62, v54, v55
    v_and_b32 v53, 0x3ff, v52
    v_cvt_f32_u32 v53, v53
    v_mul_f32 v53, 0x3a800000, v53
    v_cos_f32 v54, v53
    v_sin_f32 v55, -v53
    v_add_u32 v52, s85, v52
    v_cvt_pk_bf16_f32 v63, v54, v55
    v_and_b32 v53, 0x3ff, v52
    v_cvt_f32_u32 v53, v53
    v_mul_f32 v53, 0x3a800000, v53
    v_cos_f32 v54, v53
    v_sin_f32 v55, -v53
    v_add_u32 v52, s85, v52
    v_cvt_pk_bf16_f32 v64, v54, v55
    v_and_b32 v53, 0x3ff, v52
    v_cvt_f32_u32 v53, v53
    v_mul_f32 v53, 0x3a800000, v53
    v_cos_f32 v54, v53
    v_sin_f32 v55, -v53
    v_add_u32 v52, s85, v52
    v_cvt_pk_bf16_f32 v65, v54, v55
    v_mov_b32 v53, s85
    v_lshlrev_b32 v53, 31, v53
    v_or_b32 v53, 0x3f803f80, v53
    v_cmp_eq_u32 vcc, 0, v1
    s_nop 1
    v_cndmask_b32 v58, v58, v53, vcc
    v_lshlrev_b32 v56, 4, v1
    s_lshl_b32 s85, s85, 11
    s_add_u32 s85, s85, 0x5200000
    buffer_store_dwordx4 v[58:61], v56, s[8:11], s85 offen sc1
    buffer_store_dwordx4 v[62:65], v56, s[8:11], s85 offen offset:1024 sc1
    s_sub_u32 s79, s79, 8
    s_waitcnt vmcnt(0)
sf_54:
    v_bfe_u32 v4, v1, 4, 2
    v_lshlrev_b32 v4, 2, v4
    v_xor_b32 v4, v4, v1
    v_bfe_u32 v84, v4, 0, 1
    v_lshlrev_b32 v84, 5, v84
    v_bfe_u32 v5, v4, 1, 1
    v_lshl_or_b32 v84, v5, 4, v84
    v_bfe_u32 v5, v4, 2, 2
    v_lshl_or_b32 v84, v5, 6, v84
    v_bfe_u32 v5, v4, 4, 2
    v_lshl_or_b32 v84, v5, 13, v84
    v_xor_b32 v85, 16, v84
    s_bfe_u32 s68, s58, 0x20000
    s_lshl_b32 s68, s68, 19
    s_bfe_u32 s71, s58, 0x10002
    s_lshl_b32 s71, s71, 22
    s_or_b32 s68, s68, s71
    s_bfe_u32 s71, s57, 0x30000
    s_lshl_b32 s71, s71, 8
    s_bfe_u32 s72, s57, 0x10000
    s_lshl_b32 s72, s72, 21
    s_or_b32 s71, s71, s72
    s_add_u32 s68, s68, s71
    s_lshl_b32 s71, s75, 11
    s_add_u32 s68, s68, s71
    s_xor_b32 s69, s68, 0x200000
    s_lshl_b32 s70, s58, 14
    s_add_u32 m0, s70, 0
    s_nop 0
    buffer_load_dwordx4 v84, s[64:67], s68 offen lds
    s_add_u32 s68, s68, 0x8000
    s_add_u32 m0, s70, 1024
    s_nop 0
    buffer_load_dwordx4 v84, s[64:67], s68 offen lds
    s_add_u32 s68, s68, 0x8000
    s_add_u32 m0, s70, 2048
    s_nop 0
    buffer_load_dwordx4 v85, s[64:67], s68 offen lds
    s_add_u32 s68, s68, 0x8000
    s_add_u32 m0, s70, 3072
    s_nop 0
    buffer_load_dwordx4 v85, s[64:67], s68 offen lds
    s_add_u32 s68, s68, 0x8000
    s_add_u32 m0, s70, 4096
    s_nop 0
    buffer_load_dwordx4 v84, s[64:67], s68 offen lds
    s_add_u32 s68, s68, 0x8000
    s_add_u32 m0, s70, 5120
    s_nop 0
    buffer_load_dwordx4 v84, s[64:67], s68 offen lds
    s_add_u32 s68, s68, 0x8000
    s_add_u32 m0, s70, 6144
    s_nop 0
    buffer_load_dwordx4 v85, s[64:67], s68 offen lds
    s_add_u32 s68, s68, 0x8000
    s_add_u32 m0, s70, 7168
    s_nop 0
    buffer_load_dwordx4 v85, s[64:67], s68 offen lds
    s_add_u32 s68, s68, 0x8000
    s_add_u32 m0, s70, 8192
    s_nop 0
    buffer_load_dwordx4 v84, s[64:67], s68 offen lds
    s_add_u32 s68, s68, 0x8000
    s_add_u32 m0, s70, 9216
    s_nop 0
    buffer_load_dwordx4 v84, s[64:67], s68 offen lds
    s_add_u32 s68, s68, 0x8000
    s_add_u32 m0, s70, 10240
    s_nop 0
    buffer_load_dwordx4 v85, s[64:67], s68 offen lds
    s_add_u32 s68, s68, 0x8000
    s_add_u32 m0, s70, 11264
    s_nop 0
    buffer_load_dwordx4 v85, s[64:67], s68 offen lds
    s_add_u32 s68, s68, 0x8000
    s_add_u32 m0, s70, 12288
    s_nop 0
    buffer_load_dwordx4 v84, s[64:67], s68 offen lds
    s_add_u32 s68, s68, 0x8000
    s_add_u32 m0, s70, 13312
    s_nop 0
    buffer_load_dwordx4 v84, s[64:67], s68 offen lds
    s_add_u32 s68, s68, 0x8000
    s_add_u32 m0, s70, 14336
    s_nop 0
    buffer_load_dwordx4 v85, s[64:67], s68 offen lds
    s_add_u32 s68, s68, 0x8000
    s_add_u32 m0, s70, 15360
    s_nop 0
    buffer_load_dwordx4 v85, s[64:67], s68 offen lds
    s_add_u32 s68, s68, 0x8000
    s_cmp_lt_u32 s57, 16
    s_cbranch_scc1 sq_64
    s_waitcnt vmcnt(0)
sq_64:
    buffer_load_dwordx4 v[192:195], v84, s[64:67], s69 offen
    s_add_u32 s69, s69, 0x8000
    buffer_load_dwordx4 v[196:199], v84, s[64:67], s69 offen
    s_add_u32 s69, s69, 0x8000
    buffer_load_dwordx4 v[200:203], v85, s[64:67], s69 offen
    s_add_u32 s69, s69, 0x8000
    buffer_load_dwordx4 v[204:207], v85, s[64:67], s69 offen
    s_add_u32 s69, s69, 0x8000
    buffer_load_dwordx4 v[208:211], v84, s[64:67], s69 offen
    s_add_u32 s69, s69, 0x8000
    buffer_load_dwordx4 v[212:215], v84, s[64:67], s69 offen
    s_add_u32 s69, s69, 0x8000
    buffer_load_dwordx4 v[216:219], v85, s[64:67], s69 offen
    s_add_u32 s69, s69, 0x8000
    buffer_load_dwordx4 v[220:223], v85, s[64:67], s69 offen
    s_add_u32 s69, s69, 0x8000
    buffer_load_dwordx4 v[224:227], v84, s[64:67], s69 offen
    s_add_u32 s69, s69, 0x8000
    buffer_load_dwordx4 v[228:231], v84, s[64:67], s69 offen
    s_add_u32 s69, s69, 0x8000
    buffer_load_dwordx4 v[232:235], v85, s[64:67], s69 offen
    s_add_u32 s69, s69, 0x8000
    buffer_load_dwordx4 v[236:239], v85, s[64:67], s69 offen
    s_add_u32 s69, s69, 0x8000
    buffer_load_dwordx4 v[240:243], v84, s[64:67], s69 offen
    s_add_u32 s69, s69, 0x8000
    buffer_load_dwordx4 v[244:247], v84, s[64:67], s69 offen
    s_add_u32 s69, s69, 0x8000
    buffer_load_dwordx4 v[248:251], v85, s[64:67], s69 offen
    s_add_u32 s69, s69, 0x8000
    buffer_load_dwordx4 v[252:255], v85, s[64:67], s69 offen
    s_add_u32 s69, s69, 0x8000
    s_lshl_b32 s71, s57, 3
    s_add_u32 s71, s71, s58
    s_lshl_b32 s71, s71, 13
    s_cmp_lt_u32 s57, 3
    s_cselect_b32 s71, s71, 0x5ffffff0
    v_lshlrev_b32 v4, 7, v1
    buffer_load_dword v99, v4, s[36:39], s71 offen
    v_bfe_u32 v88, v1, 0, 2
    v_lshlrev_b32 v88, 3, v88
    v_bfe_u32 v5, v1, 4, 1
    v_lshl_or_b32 v88, v5, 5, v88
    v_bfe_u32 v5, v1, 2, 2
    v_lshl_or_b32 v88, v5, 6, v88
    v_bfe_u32 v5, v1, 2, 2
    v_lshl_or_b32 v88, v5, 8, v88
    v_bfe_u32 v5, v1, 4, 2
    v_lshl_or_b32 v88, v5, 11, v88
    s_bfe_u32 s71, s58, 0x20000
    s_lshl_b32 s71, s71, 6
    s_bfe_u32 s72, s58, 0x10002
    s_lshl_b32 s72, s72, 16
    s_or_b32 s71, s71, s72
    v_xor_b32 v88, s71, v88
    v_xor_b32 v89, 32, v88
    v_lshl_add_u32 v96, v1, 4, s70
    s_lshl_b32 s71, s75, 16
    s_add_u32 s81, s81, s71
    s_bfe_u32 s68, s57, 0x10000
    s_lshl_b32 s68, s68, 9
    s_lshl_b32 s71, s58, 2
    v_bfe_u32 v4, v1, 5, 1
    v_lshlrev_b32 v4, 4, v4
    v_xor_b32 v4, s71, v4
    v_lshlrev_b32 v4, 11, v4
    s_and_b32 s71, s71, 12
    v_xor_b32 v5, s71, v1
    v_bfe_u32 v84, v5, 0, 5
    v_lshlrev_b32 v84, 4, v84
    v_bfe_u32 v6, v5, 5, 1
    v_lshl_or_b32 v84, v6, 10, v84
    s_mov_b32 s72, 1024
    v_add_u32 v84, v84, v4
    v_xor_b32 v85, 16, v84
    v_add_u32 v85, s72, v85
    v_xor_b32 v86, 48, v85
    v_add_u32 v86, s72, v86
    v_xor_b32 v87, 16, v86
    v_add_u32 v87, s72, v87
    s_xor_b32 s69, s68, 512
    s_lshl_b32 s70, s58, 12
    s_waitcnt vmcnt(17)
    s_barrier
    ds_read_b64_tr_b16 v[128:129], v88 offset:0
    ds_read_b64_tr_b16 v[130:131], v88 offset:1024
    ds_read_b64_tr_b16 v[132:133], v89 offset:0
    ds_read_b64_tr_b16 v[134:135], v89 offset:1024
    ds_read_b64_tr_b16 v[136:137], v88 offset:8192
    ds_read_b64_tr_b16 v[138:139], v88 offset:9216
    ds_read_b64_tr_b16 v[140:141], v89 offset:8192
    ds_read_b64_tr_b16 v[142:143], v89 offset:9216
    s_waitcnt lgkmcnt(4)
    ds_read_b64_tr_b16 v[144:145], v88 offset:16384
    ds_read_b64_tr_b16 v[146:147], v88 offset:17408
    ds_read_b64_tr_b16 v[148:149], v89 offset:16384
    ds_read_b64_tr_b16 v[150:151], v89 offset:17408
    ds_read_b64_tr_b16 v[152:153], v88 offset:24576
    ds_read_b64_tr_b16 v[154:155], v88 offset:25600
    ds_read_b64_tr_b16 v[156:157], v89 offset:24576
    ds_read_b64_tr_b16 v[158:159], v89 offset:25600
    s_waitcnt lgkmcnt(4)
    ds_read_b64_tr_b16 v[160:161], v88 offset:32768
    ds_read_b64_tr_b16 v[162:163], v88 offset:33792
    ds_read_b64_tr_b16 v[164:165], v89 offset:32768
    ds_read_b64_tr_b16 v[166:167], v89 offset:33792
    ds_read_b64_tr_b16 v[168:169], v88 offset:40960
    ds_read_b64_tr_b16 v[170:171], v88 offset:41984
    ds_read_b64_tr_b16 v[172:173], v89 offset:40960
    ds_read_b64_tr_b16 v[174:175], v89 offset:41984
    s_waitcnt lgkmcnt(4)
    ds_read_b64_tr_b16 v[176:177], v88 offset:49152
    ds_read_b64_tr_b16 v[178:179], v88 offset:50176
    ds_read_b64_tr_b16 v[180:181], v89 offset:49152
    ds_read_b64_tr_b16 v[182:183], v89 offset:50176
    ds_read_b64_tr_b16 v[184:185], v88 offset:57344
    ds_read_b64_tr_b16 v[186:187], v88 offset:58368
    ds_read_b64_tr_b16 v[188:189], v89 offset:57344
    ds_read_b64_tr_b16 v[190:191], v89 offset:58368
    s_waitcnt lgkmcnt(0)
    s_barrier
    buffer_load_dwordx4 v[20:23], v84, s[36:39], s68 offen offset:0
    buffer_load_dwordx4 v[24:27], v85, s[36:39], s68 offen offset:1024
    buffer_load_dwordx4 v[28:31], v86, s[36:39], s68 offen offset:2048
    buffer_load_dwordx4 v[32:35], v87, s[36:39], s68 offen offset:3072
    s_add_u32 s68, s68, 0x10000
    buffer_load_dwordx4 v[36:39], v84, s[36:39], s69 offen offset:0
    buffer_load_dwordx4 v[40:43], v85, s[36:39], s69 offen offset:1024
    buffer_load_dwordx4 v[44:47], v86, s[36:39], s69 offen offset:2048
    buffer_load_dwordx4 v[48:51], v87, s[36:39], s69 offen offset:3072
    s_add_u32 s69, s69, 0x10000
    buffer_load_dwordx4 v[52:55], v84, s[36:39], s68 offen offset:0
    buffer_load_dwordx4 v[56:59], v85, s[36:39], s68 offen offset:1024
    buffer_load_dwordx4 v[60:63], v86, s[36:39], s68 offen offset:2048
    buffer_load_dwordx4 v[64:67], v87, s[36:39], s68 offen offset:3072
    s_add_u32 s68, s68, 0x10000
    s_waitcnt vmcnt(28)
    ds_write_b128 v96, v[192:195] offset:0
    s_waitcnt vmcnt(27)
    ds_write_b128 v96, v[196:199] offset:1024
    s_waitcnt vmcnt(26)
    ds_write_b128 v96, v[200:203] offset:2048
    s_waitcnt vmcnt(25)
    ds_write_b128 v96, v[204:207] offset:3072
    s_waitcnt vmcnt(24)
    ds_write_b128 v96, v[208:211] offset:4096
    s_waitcnt vmcnt(23)
    ds_write_b128 v96, v[212:215] offset:5120
    s_waitcnt vmcnt(22)
    ds_write_b128 v96, v[216:219] offset:6144
    s_waitcnt vmcnt(21)
    ds_write_b128 v96, v[220:223] offset:7168
    s_waitcnt vmcnt(20)
    ds_write_b128 v96, v[224:227] offset:8192
    s_waitcnt vmcnt(19)
    ds_write_b128 v96, v[228:231] offset:9216
    s_waitcnt vmcnt(18)
    ds_write_b128 v96, v[232:235] offset:10240
    s_waitcnt vmcnt(17)
    ds_write_b128 v96, v[236:239] offset:11264
    s_waitcnt vmcnt(16)
    ds_write_b128 v96, v[240:243] offset:12288
    s_waitcnt vmcnt(15)
    ds_write_b128 v96, v[244:247] offset:13312
    s_waitcnt vmcnt(14)
    ds_write_b128 v96, v[248:251] offset:14336
    s_waitcnt vmcnt(13)
    ds_write_b128 v96, v[252:255] offset:15360
    s_waitcnt lgkmcnt(0)
    s_barrier
    ds_read_b64_tr_b16 v[192:193], v88 offset:0
    ds_read_b64_tr_b16 v[194:195], v88 offset:1024
    ds_read_b64_tr_b16 v[196:197], v89 offset:0
    ds_read_b64_tr_b16 v[198:199], v89 offset:1024
    ds_read_b64_tr_b16 v[200:201], v88 offset:8192
    ds_read_b64_tr_b16 v[202:203], v88 offset:9216
    ds_read_b64_tr_b16 v[204:205], v89 offset:8192
    ds_read_b64_tr_b16 v[206:207], v89 offset:9216
    s_waitcnt lgkmcnt(4)
    ds_read_b64_tr_b16 v[208:209], v88 offset:16384
    ds_read_b64_tr_b16 v[210:211], v88 offset:17408
    ds_read_b64_tr_b16 v[212:213], v89 offset:16384
    ds_read_b64_tr_b16 v[214:215], v89 offset:17408
    ds_read_b64_tr_b16 v[216:217], v88 offset:24576
    ds_read_b64_tr_b16 v[218:219], v88 offset:25600
    ds_read_b64_tr_b16 v[220:221], v89 offset:24576
    ds_read_b64_tr_b16 v[222:223], v89 offset:25600
    s_waitcnt lgkmcnt(4)
    ds_read_b64_tr_b16 v[224:225], v88 offset:32768
    ds_read_b64_tr_b16 v[226:227], v88 offset:33792
    ds_read_b64_tr_b16 v[228:229], v89 offset:32768
    ds_read_b64_tr_b16 v[230:231], v89 offset:33792
    ds_read_b64_tr_b16 v[232:233], v88 offset:40960
    ds_read_b64_tr_b16 v[234:235], v88 offset:41984
    ds_read_b64_tr_b16 v[236:237], v89 offset:40960
    ds_read_b64_tr_b16 v[238:239], v89 offset:41984
    s_waitcnt lgkmcnt(4)
    ds_read_b64_tr_b16 v[240:241], v88 offset:49152
    ds_read_b64_tr_b16 v[242:243], v88 offset:50176
    ds_read_b64_tr_b16 v[244:245], v89 offset:49152
    ds_read_b64_tr_b16 v[246:247], v89 offset:50176
    ds_read_b64_tr_b16 v[248:249], v88 offset:57344
    ds_read_b64_tr_b16 v[250:251], v88 offset:58368
    ds_read_b64_tr_b16 v[252:253], v89 offset:57344
    ds_read_b64_tr_b16 v[254:255], v89 offset:58368
    s_waitcnt lgkmcnt(0)
    s_barrier
    v_lshl_add_u32 v96, v1, 4, s70
    v_add_u32 v97, 0x10000, v96
    s_waitcnt vmcnt(11)
    ds_write_b128 v96, v[20:23] offset:0
    s_waitcnt vmcnt(10)
    ds_write_b128 v96, v[24:27] offset:1024
    s_waitcnt vmcnt(9)
    ds_write_b128 v96, v[28:31] offset:2048
    s_waitcnt vmcnt(8)
    ds_write_b128 v96, v[32:35] offset:3072
    s_waitcnt vmcnt(7)
    ds_write_b128 v96, v[36:39] offset:32768
    s_waitcnt vmcnt(6)
    ds_write_b128 v96, v[40:43] offset:33792
    s_waitcnt vmcnt(5)
    ds_write_b128 v96, v[44:47] offset:34816
    s_waitcnt vmcnt(4)
    ds_write_b128 v96, v[48:51] offset:35840
    s_waitcnt vmcnt(3)
    ds_write_b128 v97, v[52:55] offset:0
    s_waitcnt vmcnt(2)
    ds_write_b128 v97, v[56:59] offset:1024
    s_waitcnt vmcnt(1)
    ds_write_b128 v97, v[60:63] offset:2048
    s_waitcnt vmcnt(0)
    ds_write_b128 v97, v[64:67] offset:3072
    buffer_load_dword v99, off, s[12:15], s70 offset:32 sc1
    v_lshrrev_b32 v4, 4, v1
    v_xor_b32 v4, v4, v1
    v_bfe_u32 v5, v4, 0, 4
    v_lshlrev_b32 v5, 4, v5
    v_bfe_u32 v4, v1, 0, 4
    v_lshlrev_b32 v4, 10, v4
    s_bfe_u32 s71, s58, 0x10002
    s_lshl_b32 s71, s71, 9
    v_or3_b32 v88, v4, v5, s71
    v_xor_b32 v89, 0x40, v88
    v_xor_b32 v90, 0x80, v88
    v_xor_b32 v91, 0xc0, v88
    v_xor_b32 v92, 0x10000, v88
    v_xor_b32 v93, 0x10040, v88
    v_xor_b32 v94, 0x10080, v88
    v_xor_b32 v95, 0x100c0, v88
    s_lshl_b32 s71, s58, 11
    s_or_b32 s71, s71, 131072
    v_lshl_add_u32 v96, v1, 4, s71
    v_xor_b32 v97, 0x2000, v96
    v_bfe_u32 v98, v1, 0, 4
    v_lshlrev_b32 v98, 4, v98
    v_bfe_u32 v4, v1, 4, 2
    v_lshl_or_b32 v98, v4, 9, v98
    s_bfe_u32 s71, s57, 0x30000
    s_lshl_b32 s71, s71, 13
    s_add_u32 s81, s81, s71
    s_bfe_u32 s71, s58, 0x20000
    s_lshl_b32 s71, s71, 11
    s_bfe_u32 s72, s58, 0x10002
    s_lshl_b32 s72, s72, 8
    s_or_b32 s71, s71, s72
    s_add_u32 s81, s81, s71
    s_mov_b32 s73, 0x5ffffff0
    s_mov_b32 s82, 0
    s_waitcnt vmcnt(8) lgkmcnt(0)
    s_barrier
    ds_read_b128 v[52:55], v88 offset:0
    ds_read_b128 v[56:59], v88 offset:16384
    ds_read_b128 v[60:63], v89 offset:0
    ds_read_b128 v[64:67], v89 offset:16384
    v_mov_b32 v100, 3
    v_cmp_gt_u32 vcc, s58, v100
stream_65:
    s_waitcnt lgkmcnt(2)
    v_mfma_f32_16x16x32_bf16 v[20:23], v[128:131], v[52:55], 0
    ds_read_b128 v[68:71], v90 offset:0
    v_mfma_f32_16x16x32_bf16 v[24:27], v[132:135], v[52:55], 0
    ds_read_b128 v[72:75], v90 offset:16384
    v_mfma_f32_16x16x32_bf16 v[28:31], v[128:131], v[56:59], 0
    s_add_u32 m0, s70, 98304
    s_nop 0
    buffer_load_dwordx4 v84, s[36:39], s69 offen offset:0 lds
    v_mfma_f32_16x16x32_bf16 v[32:35], v[132:135], v[56:59], 0
    s_waitcnt lgkmcnt(2)
    v_mfma_f32_16x16x32_bf16 v[20:23], v[136:139], v[60:63], v[20:23]
    ds_read_b128 v[76:79], v91 offset:0
    v_mfma_f32_16x16x32_bf16 v[24:27], v[140:143], v[60:63], v[24:27]
    ds_read_b128 v[80:83], v91 offset:16384
    v_mfma_f32_16x16x32_bf16 v[28:31], v[136:139], v[64:67], v[28:31]
    buffer_load_dwordx4 v85, s[36:39], s69 offen offset:1024 lds
    v_mfma_f32_16x16x32_bf16 v[32:35], v[140:143], v[64:67], v[32:35]
    ds_write_b128 v96, v[44:47] offset:0
    s_waitcnt lgkmcnt(3)
    v_mfma_f32_16x16x32_bf16 v[20:23], v[144:147], v[68:71], v[20:23]
    ds_read_b128 v[52:55], v88 offset:256
    v_mfma_f32_16x16x32_bf16 v[24:27], v[148:151], v[68:71], v[24:27]
    ds_read_b128 v[56:59], v88 offset:16640
    v_mfma_f32_16x16x32_bf16 v[28:31], v[144:147], v[72:75], v[28:31]
    buffer_load_dwordx4 v86, s[36:39], s69 offen offset:2048 lds
    v_mfma_f32_16x16x32_bf16 v[32:35], v[148:151], v[72:75], v[32:35]
    ds_write_b128 v96, v[48:51] offset:1024
    s_waitcnt lgkmcnt(4)
    v_mfma_f32_16x16x32_bf16 v[20:23], v[152:155], v[76:79], v[20:23]
    ds_read_b128 v[60:63], v89 offset:256
    v_mfma_f32_16x16x32_bf16 v[24:27], v[156:159], v[76:79], v[24:27]
    ds_read_b128 v[64:67], v89 offset:16640
    v_mfma_f32_16x16x32_bf16 v[28:31], v[152:155], v[80:83], v[28:31]
    buffer_load_dwordx4 v87, s[36:39], s69 offen offset:3072 lds
    s_add_u32 s69, s69, 0x10000
    v_mfma_f32_16x16x32_bf16 v[32:35], v[156:159], v[80:83], v[32:35]
    s_waitcnt lgkmcnt(3)
    v_mfma_f32_16x16x32_bf16 v[20:23], v[160:163], v[52:55], v[20:23]
    ds_read_b128 v[68:71], v90 offset:256
    v_mfma_f32_16x16x32_bf16 v[24:27], v[164:167], v[52:55], v[24:27]
    ds_read_b128 v[72:75], v90 offset:16640
    v_mfma_f32_16x16x32_bf16 v[28:31], v[160:163], v[56:59], v[28:31]
    v_mfma_f32_16x16x32_bf16 v[32:35], v[164:167], v[56:59], v[32:35]
    s_waitcnt lgkmcnt(2)
    v_mfma_f32_16x16x32_bf16 v[20:23], v[168:171], v[60:63], v[20:23]
    ds_read_b128 v[76:79], v91 offset:256
    v_mfma_f32_16x16x32_bf16 v[24:27], v[172:175], v[60:63], v[24:27]
    ds_read_b128 v[80:83], v91 offset:16640
    v_mfma_f32_16x16x32_bf16 v[28:31], v[168:171], v[64:67], v[28:31]
    v_mfma_f32_16x16x32_bf16 v[32:35], v[172:175], v[64:67], v[32:35]
    s_waitcnt vmcnt(8) lgkmcnt(0)
    s_barrier
    v_mfma_f32_16x16x32_bf16 v[20:23], v[176:179], v[68:71], v[20:23]
    ds_read_b128 v[4:7], v97 offset:0
    ds_read_b128 v[8:11], v97 offset:1024
    ds_read_b128 v[52:55], v88 offset:32768
    v_mfma_f32_16x16x32_bf16 v[24:27], v[180:183], v[68:71], v[24:27]
    ds_read_b128 v[56:59], v88 offset:49152
    v_mfma_f32_16x16x32_bf16 v[28:31], v[176:179], v[72:75], v[28:31]
    v_mfma_f32_16x16x32_bf16 v[32:35], v[180:183], v[72:75], v[32:35]
    s_waitcnt lgkmcnt(2)
    v_mfma_f32_16x16x32_bf16 v[20:23], v[184:187], v[76:79], v[20:23]
    v_add_f32 v4, v4, v36
    v_add_f32 v5, v5, v37
    v_add_f32 v6, v6, v38
    v_add_f32 v7, v7, v39
    ds_read_b128 v[60:63], v89 offset:32768
    v_mfma_f32_16x16x32_bf16 v[24:27], v[188:191], v[76:79], v[24:27]
    v_cvt_pk_bf16_f32 v12, v4, v5
    v_cvt_pk_bf16_f32 v13, v6, v7
    ds_read_b128 v[64:67], v89 offset:49152
    v_mfma_f32_16x16x32_bf16 v[28:31], v[184:187], v[80:83], v[28:31]
    v_add_f32 v8, v8, v40
    v_add_f32 v9, v9, v41
    v_add_f32 v10, v10, v42
    v_add_f32 v11, v11, v43
    v_mfma_f32_16x16x32_bf16 v[32:35], v[188:191], v[80:83], v[32:35]
    v_cvt_pk_bf16_f32 v14, v8, v9
    v_cvt_pk_bf16_f32 v15, v10, v11
    buffer_store_dwordx4 v[12:15], v98, s[8:11], s73 offen sc1
    s_mov_b32 s73, s81
    s_add_u32 s81, s81, 0x40000
    s_waitcnt lgkmcnt(2)
    v_mfma_f32_16x16x32_bf16 v[20:23], v[192:195], v[52:55], v[20:23]
    ds_read_b128 v[68:71], v90 offset:32768
    v_mfma_f32_16x16x32_bf16 v[24:27], v[196:199], v[52:55], v[24:27]
    ds_read_b128 v[72:75], v90 offset:49152
    v_mfma_f32_16x16x32_bf16 v[28:31], v[192:195], v[56:59], v[28:31]
    s_add_u32 m0, s70, 0
    s_nop 0
    buffer_load_dwordx4 v84, s[36:39], s68 offen offset:0 lds
    v_mfma_f32_16x16x32_bf16 v[32:35], v[196:199], v[56:59], v[32:35]
    s_waitcnt lgkmcnt(2)
    v_mfma_f32_16x16x32_bf16 v[20:23], v[200:203], v[60:63], v[20:23]
    ds_read_b128 v[76:79], v91 offset:32768
    v_mfma_f32_16x16x32_bf16 v[24:27], v[204:207], v[60:63], v[24:27]
    ds_read_b128 v[80:83], v91 offset:49152
    v_mfma_f32_16x16x32_bf16 v[28:31], v[200:203], v[64:67], v[28:31]
    buffer_load_dwordx4 v85, s[36:39], s68 offen offset:1024 lds
    v_mfma_f32_16x16x32_bf16 v[32:35], v[204:207], v[64:67], v[32:35]
    s_waitcnt lgkmcnt(2)
    v_mfma_f32_16x16x32_bf16 v[20:23], v[208:211], v[68:71], v[20:23]
    ds_read_b128 v[52:55], v88 offset:33024
    v_mfma_f32_16x16x32_bf16 v[24:27], v[212:215], v[68:71], v[24:27]
    ds_read_b128 v[56:59], v88 offset:49408
    v_mfma_f32_16x16x32_bf16 v[28:31], v[208:211], v[72:75], v[28:31]
    buffer_load_dwordx4 v86, s[36:39], s68 offen offset:2048 lds
    v_mfma_f32_16x16x32_bf16 v[32:35], v[212:215], v[72:75], v[32:35]
    s_waitcnt lgkmcnt(2)
    v_mfma_f32_16x16x32_bf16 v[20:23], v[216:219], v[76:79], v[20:23]
    ds_read_b128 v[60:63], v89 offset:33024
    v_mfma_f32_16x16x32_bf16 v[24:27], v[220:223], v[76:79], v[24:27]
    ds_read_b128 v[64:67], v89 offset:49408
    v_mfma_f32_16x16x32_bf16 v[28:31], v[216:219], v[80:83], v[28:31]
    buffer_load_dwordx4 v87, s[36:39], s68 offen offset:3072 lds
    s_add_u32 s68, s68, 0x10000
    v_mfma_f32_16x16x32_bf16 v[32:35], v[220:223], v[80:83], v[32:35]
    s_waitcnt lgkmcnt(2)
    v_mfma_f32_16x16x32_bf16 v[20:23], v[224:227], v[52:55], v[20:23]
    ds_read_b128 v[68:71], v90 offset:33024
    v_mfma_f32_16x16x32_bf16 v[24:27], v[228:231], v[52:55], v[24:27]
    ds_read_b128 v[72:75], v90 offset:49408
    v_mfma_f32_16x16x32_bf16 v[28:31], v[224:227], v[56:59], v[28:31]
    v_mfma_f32_16x16x32_bf16 v[32:35], v[228:231], v[56:59], v[32:35]
    s_waitcnt lgkmcnt(2)
    v_mfma_f32_16x16x32_bf16 v[20:23], v[232:235], v[60:63], v[20:23]
    ds_read_b128 v[76:79], v91 offset:33024
    v_mfma_f32_16x16x32_bf16 v[24:27], v[236:239], v[60:63], v[24:27]
    ds_read_b128 v[80:83], v91 offset:49408
    v_mfma_f32_16x16x32_bf16 v[28:31], v[232:235], v[64:67], v[28:31]
    v_mfma_f32_16x16x32_bf16 v[32:35], v[236:239], v[64:67], v[32:35]
    s_bitcmp1_b64 s[6:7], s82
    s_cbranch_scc1 ssig_55
    s_waitcnt vmcnt(8) lgkmcnt(0)
    s_barrier
sretf_56:
    s_add_u32 s82, s82, 1
    v_mfma_f32_16x16x32_bf16 v[20:23], v[240:243], v[68:71], v[20:23]
    ds_read_b128 v[52:55], v92 offset:0
    v_mfma_f32_16x16x32_bf16 v[24:27], v[244:247], v[68:71], v[24:27]
    ds_read_b128 v[56:59], v92 offset:16384
    v_mfma_f32_16x16x32_bf16 v[28:31], v[240:243], v[72:75], v[28:31]
    v_mfma_f32_16x16x32_bf16 v[32:35], v[244:247], v[72:75], v[32:35]
    v_mfma_f32_16x16x32_bf16 v[20:23], v[248:251], v[76:79], v[20:23]
    ds_read_b128 v[60:63], v93 offset:0
    v_mfma_f32_16x16x32_bf16 v[24:27], v[252:255], v[76:79], v[24:27]
    ds_read_b128 v[64:67], v93 offset:16384
    v_mfma_f32_16x16x32_bf16 v[28:31], v[248:251], v[80:83], v[28:31]
    v_mfma_f32_16x16x32_bf16 v[32:35], v[252:255], v[80:83], v[32:35]
    s_waitcnt lgkmcnt(2)
    v_mfma_f32_16x16x32_bf16 v[36:39], v[128:131], v[52:55], 0
    ds_read_b128 v[68:71], v94 offset:0
    v_mfma_f32_16x16x32_bf16 v[40:43], v[132:135], v[52:55], 0
    ds_read_b128 v[72:75], v94 offset:16384
    v_mfma_f32_16x16x32_bf16 v[44:47], v[128:131], v[56:59], 0
    s_add_u32 m0, s70, 32768
    s_nop 0
    buffer_load_dwordx4 v84, s[36:39], s69 offen offset:0 lds
    v_mfma_f32_16x16x32_bf16 v[48:51], v[132:135], v[56:59], 0
    s_waitcnt lgkmcnt(2)
    v_mfma_f32_16x16x32_bf16 v[36:39], v[136:139], v[60:63], v[36:39]
    ds_read_b128 v[76:79], v95 offset:0
    v_mfma_f32_16x16x32_bf16 v[40:43], v[140:143], v[60:63], v[40:43]
    ds_read_b128 v[80:83], v95 offset:16384
    v_mfma_f32_16x16x32_bf16 v[44:47], v[136:139], v[64:67], v[44:47]
    buffer_load_dwordx4 v85, s[36:39], s69 offen offset:1024 lds
    v_mfma_f32_16x16x32_bf16 v[48:51], v[140:143], v[64:67], v[48:51]
    ds_write_b128 v96, v[28:31] offset:0
    s_waitcnt lgkmcnt(3)
    v_mfma_f32_16x16x32_bf16 v[36:39], v[144:147], v[68:71], v[36:39]
    ds_read_b128 v[52:55], v92 offset:256
    v_mfma_f32_16x16x32_bf16 v[40:43], v[148:151], v[68:71], v[40:43]
    ds_read_b128 v[56:59], v92 offset:16640
    v_mfma_f32_16x16x32_bf16 v[44:47], v[144:147], v[72:75], v[44:47]
    buffer_load_dwordx4 v86, s[36:39], s69 offen offset:2048 lds
    v_mfma_f32_16x16x32_bf16 v[48:51], v[148:151], v[72:75], v[48:51]
    ds_write_b128 v96, v[32:35] offset:1024
    s_waitcnt lgkmcnt(4)
    v_mfma_f32_16x16x32_bf16 v[36:39], v[152:155], v[76:79], v[36:39]
    ds_read_b128 v[60:63], v93 offset:256
    v_mfma_f32_16x16x32_bf16 v[40:43], v[156:159], v[76:79], v[40:43]
    ds_read_b128 v[64:67], v93 offset:16640
    v_mfma_f32_16x16x32_bf16 v[44:47], v[152:155], v[80:83], v[44:47]
    buffer_load_dwordx4 v87, s[36:39], s69 offen offset:3072 lds
    s_add_u32 s69, s69, 0x10000
    v_mfma_f32_16x16x32_bf16 v[48:51], v[156:159], v[80:83], v[48:51]
    s_waitcnt lgkmcnt(3)
    v_mfma_f32_16x16x32_bf16 v[36:39], v[160:163], v[52:55], v[36:39]
    ds_read_b128 v[68:71], v94 offset:256
    v_mfma_f32_16x16x32_bf16 v[40:43], v[164:167], v[52:55], v[40:43]
    ds_read_b128 v[72:75], v94 offset:16640
    v_mfma_f32_16x16x32_bf16 v[44:47], v[160:163], v[56:59], v[44:47]
    v_mfma_f32_16x16x32_bf16 v[48:51], v[164:167], v[56:59], v[48:51]
    s_waitcnt lgkmcnt(2)
    v_mfma_f32_16x16x32_bf16 v[36:39], v[168:171], v[60:63], v[36:39]
    ds_read_b128 v[76:79], v95 offset:256
    v_mfma_f32_16x16x32_bf16 v[40:43], v[172:175], v[60:63], v[40:43]
    ds_read_b128 v[80:83], v95 offset:16640
    v_mfma_f32_16x16x32_bf16 v[44:47], v[168:171], v[64:67], v[44:47]
    v_mfma_f32_16x16x32_bf16 v[48:51], v[172:175], v[64:67], v[48:51]
    s_waitcnt vmcnt(8) lgkmcnt(0)
    s_barrier
    v_mfma_f32_16x16x32_bf16 v[36:39], v[176:179], v[68:71], v[36:39]
    ds_read_b128 v[4:7], v97 offset:0
    ds_read_b128 v[8:11], v97 offset:1024
    ds_read_b128 v[52:55], v92 offset:32768
    v_mfma_f32_16x16x32_bf16 v[40:43], v[180:183], v[68:71], v[40:43]
    ds_read_b128 v[56:59], v92 offset:49152
    v_mfma_f32_16x16x32_bf16 v[44:47], v[176:179], v[72:75], v[44:47]
    v_mfma_f32_16x16x32_bf16 v[48:51], v[180:183], v[72:75], v[48:51]
    s_waitcnt lgkmcnt(2)
    v_mfma_f32_16x16x32_bf16 v[36:39], v[184:187], v[76:79], v[36:39]
    v_add_f32 v4, v4, v20
    v_add_f32 v5, v5, v21
    v_add_f32 v6, v6, v22
    v_add_f32 v7, v7, v23
    ds_read_b128 v[60:63], v93 offset:32768
    v_mfma_f32_16x16x32_bf16 v[40:43], v[188:191], v[76:79], v[40:43]
    v_cvt_pk_bf16_f32 v12, v4, v5
    v_cvt_pk_bf16_f32 v13, v6, v7
    ds_read_b128 v[64:67], v93 offset:49152
    v_mfma_f32_16x16x32_bf16 v[44:47], v[184:187], v[80:83], v[44:47]
    v_add_f32 v8, v8, v24
    v_add_f32 v9, v9, v25
    v_add_f32 v10, v10, v26
    v_add_f32 v11, v11, v27
    v_mfma_f32_16x16x32_bf16 v[48:51], v[188:191], v[80:83], v[48:51]
    v_cvt_pk_bf16_f32 v14, v8, v9
    v_cvt_pk_bf16_f32 v15, v10, v11
    buffer_store_dwordx4 v[12:15], v98, s[8:11], s73 offen sc1
    s_mov_b32 s73, s81
    s_add_u32 s81, s81, 0x40000
    s_waitcnt lgkmcnt(2)
    v_mfma_f32_16x16x32_bf16 v[36:39], v[192:195], v[52:55], v[36:39]
    ds_read_b128 v[68:71], v94 offset:32768
    v_mfma_f32_16x16x32_bf16 v[40:43], v[196:199], v[52:55], v[40:43]
    ds_read_b128 v[72:75], v94 offset:49152
    v_mfma_f32_16x16x32_bf16 v[44:47], v[192:195], v[56:59], v[44:47]
    s_add_u32 m0, s70, 65536
    s_nop 0
    buffer_load_dwordx4 v84, s[36:39], s68 offen offset:0 lds
    v_mfma_f32_16x16x32_bf16 v[48:51], v[196:199], v[56:59], v[48:51]
    s_waitcnt lgkmcnt(2)
    v_mfma_f32_16x16x32_bf16 v[36:39], v[200:203], v[60:63], v[36:39]
    ds_read_b128 v[76:79], v95 offset:32768
    v_mfma_f32_16x16x32_bf16 v[40:43], v[204:207], v[60:63], v[40:43]
    ds_read_b128 v[80:83], v95 offset:49152
    v_mfma_f32_16x16x32_bf16 v[44:47], v[200:203], v[64:67], v[44:47]
    buffer_load_dwordx4 v85, s[36:39], s68 offen offset:1024 lds
    v_mfma_f32_16x16x32_bf16 v[48:51], v[204:207], v[64:67], v[48:51]
    s_waitcnt lgkmcnt(2)
    v_mfma_f32_16x16x32_bf16 v[36:39], v[208:211], v[68:71], v[36:39]
    ds_read_b128 v[52:55], v92 offset:33024
    v_mfma_f32_16x16x32_bf16 v[40:43], v[212:215], v[68:71], v[40:43]
    ds_read_b128 v[56:59], v92 offset:49408
    v_mfma_f32_16x16x32_bf16 v[44:47], v[208:211], v[72:75], v[44:47]
    buffer_load_dwordx4 v86, s[36:39], s68 offen offset:2048 lds
    v_mfma_f32_16x16x32_bf16 v[48:51], v[212:215], v[72:75], v[48:51]
    s_waitcnt lgkmcnt(2)
    v_mfma_f32_16x16x32_bf16 v[36:39], v[216:219], v[76:79], v[36:39]
    ds_read_b128 v[60:63], v93 offset:33024
    v_mfma_f32_16x16x32_bf16 v[40:43], v[220:223], v[76:79], v[40:43]
    ds_read_b128 v[64:67], v93 offset:49408
    v_mfma_f32_16x16x32_bf16 v[44:47], v[216:219], v[80:83], v[44:47]
    buffer_load_dwordx4 v87, s[36:39], s68 offen offset:3072 lds
    s_add_u32 s68, s68, 0x10000
    v_mfma_f32_16x16x32_bf16 v[48:51], v[220:223], v[80:83], v[48:51]
    s_waitcnt lgkmcnt(2)
    v_mfma_f32_16x16x32_bf16 v[36:39], v[224:227], v[52:55], v[36:39]
    ds_read_b128 v[68:71], v94 offset:33024
    v_mfma_f32_16x16x32_bf16 v[40:43], v[228:231], v[52:55], v[40:43]
    ds_read_b128 v[72:75], v94 offset:49408
    v_mfma_f32_16x16x32_bf16 v[44:47], v[224:227], v[56:59], v[44:47]
    v_mfma_f32_16x16x32_bf16 v[48:51], v[228:231], v[56:59], v[48:51]
    s_waitcnt lgkmcnt(2)
    v_mfma_f32_16x16x32_bf16 v[36:39], v[232:235], v[60:63], v[36:39]
    ds_read_b128 v[76:79], v95 offset:33024
    v_mfma_f32_16x16x32_bf16 v[40:43], v[236:239], v[60:63], v[40:43]
    ds_read_b128 v[80:83], v95 offset:49408
    v_mfma_f32_16x16x32_bf16 v[44:47], v[232:235], v[64:67], v[44:47]
    v_mfma_f32_16x16x32_bf16 v[48:51], v[236:239], v[64:67], v[48:51]
    s_bitcmp1_b64 s[6:7], s82
    s_cbranch_scc1 ssig_55
    s_waitcnt vmcnt(8) lgkmcnt(0)
    s_barrier
sretf_62:
    s_add_u32 s82, s82, 1
    v_mfma_f32_16x16x32_bf16 v[36:39], v[240:243], v[68:71], v[36:39]
    ds_read_b128 v[52:55], v88 offset:0
    v_mfma_f32_16x16x32_bf16 v[40:43], v[244:247], v[68:71], v[40:43]
    ds_read_b128 v[56:59], v88 offset:16384
    v_mfma_f32_16x16x32_bf16 v[44:47], v[240:243], v[72:75], v[44:47]
    v_mfma_f32_16x16x32_bf16 v[48:51], v[244:247], v[72:75], v[48:51]
    v_mfma_f32_16x16x32_bf16 v[36:39], v[248:251], v[76:79], v[36:39]
    ds_read_b128 v[60:63], v89 offset:0
    v_mfma_f32_16x16x32_bf16 v[40:43], v[252:255], v[76:79], v[40:43]
    ds_read_b128 v[64:67], v89 offset:16384
    v_mfma_f32_16x16x32_bf16 v[44:47], v[248:251], v[80:83], v[44:47]
    v_mfma_f32_16x16x32_bf16 v[48:51], v[252:255], v[80:83], v[48:51]
    s_cmp_lt_u32 s82, 64
    s_cbranch_scc1 stream_65
    s_nop 4
    ds_write_b128 v96, v[44:47] offset:0
    ds_write_b128 v96, v[48:51] offset:1024
    s_waitcnt vmcnt(0) lgkmcnt(0)
    s_barrier
    ds_read_b128 v[4:7], v97 offset:0
    ds_read_b128 v[8:11], v97 offset:1024
    s_waitcnt lgkmcnt(0)
    v_add_f32 v4, v4, v36
    v_add_f32 v5, v5, v37
    v_add_f32 v6, v6, v38
    v_add_f32 v7, v7, v39
    v_cvt_pk_bf16_f32 v12, v4, v5
    v_cvt_pk_bf16_f32 v13, v6, v7
    v_add_f32 v8, v8, v40
    v_add_f32 v9, v9, v41
    v_add_f32 v10, v10, v42
    v_add_f32 v11, v11, v43
    v_cvt_pk_bf16_f32 v14, v8, v9
    v_cvt_pk_bf16_f32 v15, v10, v11
    buffer_store_dwordx4 v[12:15], v98, s[8:11], s73 offen sc1
    s_mov_b32 s73, s81
    s_add_u32 s81, s81, 0x40000
    s_branch send_58
ssig_55:
    s_waitcnt vmcnt(4) lgkmcnt(0)
    s_barrier
    s_cmp_lg_u32 s58, 0
    s_cbranch_scc1 sig_67
    s_cmp_ge_u32 s57, 16
    s_cbranch_scc1 sig_66
    s_waitcnt vmcnt(4)
    v_and_b32 v4, 0x3ff, v99
    v_cmp_gt_u32 vcc, 128, v4
    s_cbranch_vccz armd_ok_69
armd_68:
    buffer_load_dword v99, off, s[12:15], 0 offset:32 sc1
    s_waitcnt vmcnt(0)
    v_and_b32 v4, 0x3ff, v99
    v_cmp_gt_u32 vcc, 128, v4
    s_cbranch_vccz armd_ok_69
    s_sub_u32 s77, s77, 1
    s_cbranch_scc0 armd_68
    s_mov_b32 s77, 0
armd_ok_69:
    s_bfe_u32 s85, s76, 0x10003
    s_lshl_b32 s85, s85, 2
    s_bfe_u32 s79, s76, 0x30000
    s_lshl_b32 s79, s79, 7
    s_or_b32 s85, s85, s79
    s_bfe_u32 s79, s76, 0x20005
    s_lshl_b32 s79, s79, 10
    s_or_b32 s85, s85, s79
    s_add_u32 s85, s85, 0x5110000
    v_mov_b32 v4, s82
    buffer_store_dword v4, off, s[8:11], s85 sc1
sig_66:
    s_bitcmp0_b32 s82, 1
    s_cbranch_scc1 sig_67
    s_cmp_lt_u32 s82, 6
    s_cbranch_scc1 sig_67
    v_mov_b32 v5, s84
    s_mov_b64 exec, 1
    buffer_atomic_add v5, off, s[12:15], s83 sc1
    s_mov_b64 exec, -1
    s_add_u32 s83, s83, 4
sig_67:
    s_cmp_lt_u32 s57, 24
    s_cbranch_scc1 xtra_70
    s_bfe_u32 s79, s76, 0x30000
    s_lshl_b32 s79, s79, 16
    s_bfe_u32 s85, s76, 0x20005
    s_lshl_b32 s85, s85, 19
    s_or_b32 s79, s79, s85
    s_lshl_b32 s85, s58, 13
    s_add_u32 s85, s85, s79
    v_lshlrev_b32 v6, 7, v1
    buffer_load_dword v16, v6, s[36:39], s85 offen
    buffer_load_dword v17, v6, s[48:51], s85 offen
    buffer_load_dword v18, v6, s[52:55], s85 offen
    s_add_u32 s85, s85, 0x200000
    buffer_load_dword v19, v6, s[36:39], s85 offen
    s_branch xtra_71
xtra_70:
    v_lshlrev_b32 v6, 4, v1
    s_bfe_u32 s80, s76, 0x40000
    s_lshl_b32 s80, s80, 3
    s_bfe_u32 s85, s76, 0x20005
    s_lshl_b32 s85, s85, 7
    s_or_b32 s80, s80, s85
    s_add_u32 s80, s80, s58
    s_cmp_lg_u32 s82, 10
    s_cbranch_scc1 xtra_72
    v_mov_b32 v16, 0
    v_mov_b32 v17, 0
    v_mov_b32 v18, 0
    v_mov_b32 v19, 0
    s_lshl_b32 s85, s80, 6
    s_add_u32 s85, s85, 0x5100000
    v_and_b32 v7, 48, v6
    s_cmp_ge_u32 s57, 16
    s_cselect_b32 s85, 0x5ffffff0, s85
    buffer_store_dwordx4 v[16:19], v7, s[8:11], s85 offen sc1
xtra_72:
    s_cmp_lg_u32 s82, 99
    s_cbranch_scc1 xtra_73
    s_lshl_b32 s85, s80, 14
    s_cmp_ge_u32 s57, 16
    s_cbranch_scc1 xtra_73
    v_lshlrev_b32 v7, 6, v1
    buffer_load_dword v16, v7, s[32:35], s85 offen
    s_add_u32 s85, s85, 4096
    buffer_load_dword v17, v7, s[32:35], s85 offen
    s_add_u32 s85, s85, 4096
    buffer_load_dword v18, v7, s[32:35], s85 offen
    s_add_u32 s85, s85, 4096
    buffer_load_dword v19, v7, s[32:35], s85 offen
    s_add_u32 s85, s85, 4096
xtra_73:
    s_bfe_u32 s85, s57, 0x30000
    s_lshl_b32 s85, s85, 2
    s_add_u32 s85, s85, 10
    s_cmp_lg_u32 s82, s85
    s_cbranch_scc1 xtra_71
    v_mov_b32 v8, -1
    v_mov_b32 v9, -1
    v_mov_b32 v10, -1
    v_mov_b32 v11, -1
    s_bfe_u32 s85, s76, 0x20005
    s_lshl_b32 s85, s85, 11
    s_bfe_u32 s79, s76, 0x30000
    s_lshl_b32 s79, s79, 16
    s_or_b32 s85, s85, s79
    s_bfe_u32 s79, s76, 0x20003
    s_lshl_b32 s79, s79, 21
    s_or_b32 s85, s85, s79
    s_lshl_b32 s79, s58, 13
    s_add_u32 s85, s85, s79
    s_add_u32 s85, s85, 0x6000000
    buffer_store_dwordx4 v[8:11], v6, s[8:11], s85 offen offset:0 sc1
    s_add_u32 s85, s85, 0x80000
    buffer_store_dwordx4 v[8:11], v6, s[8:11], s85 offen offset:0 sc1
    s_add_u32 s85, s85, 0x80000
    buffer_store_dwordx4 v[8:11], v6, s[8:11], s85 offen offset:0 sc1
    s_add_u32 s85, s85, 0x80000
    buffer_store_dwordx4 v[8:11], v6, s[8:11], s85 offen offset:0 sc1
    s_add_u32 s85, s85, 0x80000
    s_cmp_ge_u32 s57, 16
    s_cbranch_scc1 xtra_71
    s_bfe_u32 s85, s80, 0x30003
    s_lshl_b32 s85, s85, 11
    s_bfe_u32 s79, s80, 0x20007
    s_lshl_b32 s79, s79, 14
    s_or_b32 s85, s85, s79
    s_bfe_u32 s79, s80, 0x30000
    s_lshl_b32 s79, s79, 17
    s_or_b32 s85, s85, s79
    s_bfe_u32 s79, s80, 0x10006
    s_lshl_b32 s79, s79, 22
    s_or_b32 s85, s85, s79
    s_add_u32 s85, s85, 0x4300000
    buffer_store_dwordx4 v[8:11], v6, s[8:11], s85 offen offset:0 sc1
    buffer_store_dwordx4 v[8:11], v6, s[8:11], s85 offen offset:1024 sc1
    s_add_u32 s85, s85, 0x10000
    buffer_store_dwordx4 v[8:11], v6, s[8:11], s85 offen offset:0 sc1
    buffer_store_dwordx4 v[8:11], v6, s[8:11], s85 offen offset:1024 sc1
xtra_71:
    s_bitcmp1_b32 s82, 0
    s_cbranch_scc1 xtra_74
    s_bitcmp1_b32 s57, 3
    s_cbranch_scc1 srett_57
    s_branch sretf_56
xtra_74:
    s_bitcmp1_b32 s57, 3
    s_cbranch_scc1 srett_63
    s_branch sretf_62
sv_53:
    s_mov_b32 s81, 0x2000000
    v_bfe_u32 v4, v1, 4, 2
    v_lshlrev_b32 v4, 2, v4
    v_xor_b32 v4, v4, v1
    v_bfe_u32 v84, v4, 0, 2
    v_lshlrev_b32 v84, 4, v84
    v_bfe_u32 v5, v4, 2, 2
    v_lshl_or_b32 v84, v5, 6, v84
    v_bfe_u32 v5, v4, 4, 2
    v_lshl_or_b32 v84, v5, 13, v84
    v_xor_b32 v85, 32, v84
    s_bfe_u32 s68, s58, 0x20000
    s_lshl_b32 s68, s68, 19
    s_bfe_u32 s71, s58, 0x10002
    s_lshl_b32 s71, s71, 22
    s_or_b32 s68, s68, s71
    s_bfe_u32 s71, s57, 0x30000
    s_lshl_b32 s71, s71, 8
    s_bfe_u32 s72, s57, 0x10000
    s_lshl_b32 s72, s72, 21
    s_or_b32 s71, s71, s72
    s_add_u32 s68, s68, s71
    s_lshl_b32 s71, s75, 11
    s_add_u32 s68, s68, s71
    s_xor_b32 s69, s68, 0x200000
    s_lshl_b32 s70, s58, 14
    s_add_u32 m0, s70, 0
    s_nop 0
    buffer_load_dwordx4 v84, s[28:31], s68 offen lds
    s_add_u32 s68, s68, 0x8000
    s_add_u32 m0, s70, 1024
    s_nop 0
    buffer_load_dwordx4 v84, s[28:31], s68 offen lds
    s_add_u32 s68, s68, 0x8000
    s_add_u32 m0, s70, 2048
    s_nop 0
    buffer_load_dwordx4 v85, s[28:31], s68 offen lds
    s_add_u32 s68, s68, 0x8000
    s_add_u32 m0, s70, 3072
    s_nop 0
    buffer_load_dwordx4 v85, s[28:31], s68 offen lds
    s_add_u32 s68, s68, 0x8000
    s_add_u32 m0, s70, 4096
    s_nop 0
    buffer_load_dwordx4 v84, s[28:31], s68 offen lds
    s_add_u32 s68, s68, 0x8000
    s_add_u32 m0, s70, 5120
    s_nop 0
    buffer_load_dwordx4 v84, s[28:31], s68 offen lds
    s_add_u32 s68, s68, 0x8000
    s_add_u32 m0, s70, 6144
    s_nop 0
    buffer_load_dwordx4 v85, s[28:31], s68 offen lds
    s_add_u32 s68, s68, 0x8000
    s_add_u32 m0, s70, 7168
    s_nop 0
    buffer_load_dwordx4 v85, s[28:31], s68 offen lds
    s_add_u32 s68, s68, 0x8000
    s_add_u32 m0, s70, 8192
    s_nop 0
    buffer_load_dwordx4 v84, s[28:31], s68 offen lds
    s_add_u32 s68, s68, 0x8000
    s_add_u32 m0, s70, 9216
    s_nop 0
    buffer_load_dwordx4 v84, s[28:31], s68 offen lds
    s_add_u32 s68, s68, 0x8000
    s_add_u32 m0, s70, 10240
    s_nop 0
    buffer_load_dwordx4 v85, s[28:31], s68 offen lds
    s_add_u32 s68, s68, 0x8000
    s_add_u32 m0, s70, 11264
    s_nop 0
    buffer_load_dwordx4 v85, s[28:31], s68 offen lds
    s_add_u32 s68, s68, 0x8000
    s_add_u32 m0, s70, 12288
    s_nop 0
    buffer_load_dwordx4 v84, s[28:31], s68 offen lds
    s_add_u32 s68, s68, 0x8000
    s_add_u32 m0, s70, 13312
    s_nop 0
    buffer_load_dwordx4 v84, s[28:31], s68 offen lds
    s_add_u32 s68, s68, 0x8000
    s_add_u32 m0, s70, 14336
    s_nop 0
    buffer_load_dwordx4 v85, s[28:31], s68 offen lds
    s_add_u32 s68, s68, 0x8000
    s_add_u32 m0, s70, 15360
    s_nop 0
    buffer_load_dwordx4 v85, s[28:31], s68 offen lds
    s_add_u32 s68, s68, 0x8000
    buffer_load_dwordx4 v[192:195], v84, s[28:31], s69 offen
    s_add_u32 s69, s69, 0x8000
    buffer_load_dwordx4 v[196:199], v84, s[28:31], s69 offen
    s_add_u32 s69, s69, 0x8000
    buffer_load_dwordx4 v[200:203], v85, s[28:31], s69 offen
    s_add_u32 s69, s69, 0x8000
    buffer_load_dwordx4 v[204:207], v85, s[28:31], s69 offen
    s_add_u32 s69, s69, 0x8000
    buffer_load_dwordx4 v[208:211], v84, s[28:31], s69 offen
    s_add_u32 s69, s69, 0x8000
    buffer_load_dwordx4 v[212:215], v84, s[28:31], s69 offen
    s_add_u32 s69, s69, 0x8000
    buffer_load_dwordx4 v[216:219], v85, s[28:31], s69 offen
    s_add_u32 s69, s69, 0x8000
    buffer_load_dwordx4 v[220:223], v85, s[28:31], s69 offen
    s_add_u32 s69, s69, 0x8000
    buffer_load_dwordx4 v[224:227], v84, s[28:31], s69 offen
    s_add_u32 s69, s69, 0x8000
    buffer_load_dwordx4 v[228:231], v84, s[28:31], s69 offen
    s_add_u32 s69, s69, 0x8000
    buffer_load_dwordx4 v[232:235], v85, s[28:31], s69 offen
    s_add_u32 s69, s69, 0x8000
    buffer_load_dwordx4 v[236:239], v85, s[28:31], s69 offen
    s_add_u32 s69, s69, 0x8000
    buffer_load_dwordx4 v[240:243], v84, s[28:31], s69 offen
    s_add_u32 s69, s69, 0x8000
    buffer_load_dwordx4 v[244:247], v84, s[28:31], s69 offen
    s_add_u32 s69, s69, 0x8000
    buffer_load_dwordx4 v[248:251], v85, s[28:31], s69 offen
    s_add_u32 s69, s69, 0x8000
    buffer_load_dwordx4 v[252:255], v85, s[28:31], s69 offen
    s_add_u32 s69, s69, 0x8000
    s_lshl_b32 s71, s57, 3
    s_add_u32 s71, s71, s58
    s_lshl_b32 s71, s71, 13
    s_cmp_lt_u32 s57, 3
    s_cselect_b32 s71, s71, 0x5ffffff0
    v_lshlrev_b32 v4, 7, v1
    buffer_load_dword v99, v4, s[36:39], s71 offen
    v_bfe_u32 v88, v1, 0, 2
    v_lshlrev_b32 v88, 3, v88
    v_bfe_u32 v5, v1, 4, 1
    v_lshl_or_b32 v88, v5, 5, v88
    v_bfe_u32 v5, v1, 2, 2
    v_lshl_or_b32 v88, v5, 6, v88
    v_bfe_u32 v5, v1, 2, 2
    v_lshl_or_b32 v88, v5, 8, v88
    v_bfe_u32 v5, v1, 4, 2
    v_lshl_or_b32 v88, v5, 11, v88
    s_bfe_u32 s71, s58, 0x20000
    s_lshl_b32 s71, s71, 6
    s_bfe_u32 s72, s58, 0x10002
    s_lshl_b32 s72, s72, 16
    s_or_b32 s71, s71, s72
    s_bfe_u32 s72, s58, 0x10002
    s_lshl_b32 s72, s72, 5
    s_or_b32 s71, s71, s72
    v_xor_b32 v88, s71, v88
    v_xor_b32 v89, 32, v88
    v_lshl_add_u32 v96, v1, 4, s70
    s_lshl_b32 s71, s75, 16
    s_add_u32 s81, s81, s71
    s_bfe_u32 s68, s57, 0x10000
    s_lshl_b32 s68, s68, 9
    s_mov_b32 s2, 2048
    s_mov_b32 s3, 65536
    s_mov_b32 s4, 262144
    s_mov_b32 s5, 1
    s_lshl_b32 s71, s58, 2
    s_bfe_u32 s72, s71, 0x30000
    s_bfe_u32 s73, s71, 0x10003
    s_lshl_b32 s73, s73, 4
    s_or_b32 s72, s72, s73
    s_bfe_u32 s73, s71, 0x10004
    s_lshl_b32 s73, s73, 3
    s_or_b32 s72, s72, s73
    s_mul_i32 s72, s72, s2
    v_mov_b32 v4, s72
    s_and_b32 s71, s71, 12
    v_xor_b32 v5, s71, v1
    v_bfe_u32 v84, v5, 0, 5
    v_lshlrev_b32 v84, 4, v84
    v_bfe_u32 v6, v5, 5, 1
    v_lshl_or_b32 v84, v6, 10, v84
    s_sub_u32 s72, s2, 1024
    v_add_u32 v84, v84, v4
    v_xor_b32 v85, 16, v84
    v_add_u32 v85, s72, v85
    v_xor_b32 v86, 48, v85
    v_add_u32 v86, s72, v86
    v_xor_b32 v87, 16, v86
    v_add_u32 v87, s72, v87
    s_xor_b32 s69, s68, 512
    s_lshl_b32 s70, s58, 12
    s_waitcnt vmcnt(17)
    s_barrier
    ds_read_b64_tr_b16 v[128:129], v88 offset:0
    ds_read_b64_tr_b16 v[130:131], v88 offset:1024
    ds_read_b64_tr_b16 v[132:133], v89 offset:0
    ds_read_b64_tr_b16 v[134:135], v89 offset:1024
    ds_read_b64_tr_b16 v[136:137], v88 offset:8192
    ds_read_b64_tr_b16 v[138:139], v88 offset:9216
    ds_read_b64_tr_b16 v[140:141], v89 offset:8192
    ds_read_b64_tr_b16 v[142:143], v89 offset:9216
    s_waitcnt lgkmcnt(4)
    ds_read_b64_tr_b16 v[144:145], v88 offset:16384
    ds_read_b64_tr_b16 v[146:147], v88 offset:17408
    ds_read_b64_tr_b16 v[148:149], v89 offset:16384
    ds_read_b64_tr_b16 v[150:151], v89 offset:17408
    ds_read_b64_tr_b16 v[152:153], v88 offset:24576
    ds_read_b64_tr_b16 v[154:155], v88 offset:25600
    ds_read_b64_tr_b16 v[156:157], v89 offset:24576
    ds_read_b64_tr_b16 v[158:159], v89 offset:25600
    s_waitcnt lgkmcnt(4)
    ds_read_b64_tr_b16 v[160:161], v88 offset:32768
    ds_read_b64_tr_b16 v[162:163], v88 offset:33792
    ds_read_b64_tr_b16 v[164:165], v89 offset:32768
    ds_read_b64_tr_b16 v[166:167], v89 offset:33792
    ds_read_b64_tr_b16 v[168:169], v88 offset:40960
    ds_read_b64_tr_b16 v[170:171], v88 offset:41984
    ds_read_b64_tr_b16 v[172:173], v89 offset:40960
    ds_read_b64_tr_b16 v[174:175], v89 offset:41984
    s_waitcnt lgkmcnt(4)
    ds_read_b64_tr_b16 v[176:177], v88 offset:49152
    ds_read_b64_tr_b16 v[178:179], v88 offset:50176
    ds_read_b64_tr_b16 v[180:181], v89 offset:49152
    ds_read_b64_tr_b16 v[182:183], v89 offset:50176
    ds_read_b64_tr_b16 v[184:185], v88 offset:57344
    ds_read_b64_tr_b16 v[186:187], v88 offset:58368
    ds_read_b64_tr_b16 v[188:189], v89 offset:57344
    ds_read_b64_tr_b16 v[190:191], v89 offset:58368
    s_waitcnt lgkmcnt(0)
    s_barrier
    buffer_load_dwordx4 v[20:23], v84, s[60:63], s68 offen offset:0
    buffer_load_dwordx4 v[24:27], v85, s[60:63], s68 offen offset:1024
    buffer_load_dwordx4 v[28:31], v86, s[60:63], s68 offen offset:2048
    buffer_load_dwordx4 v[32:35], v87, s[60:63], s68 offen offset:3072
    s_add_u32 s68, s68, s3
    buffer_load_dwordx4 v[36:39], v84, s[60:63], s69 offen offset:0
    buffer_load_dwordx4 v[40:43], v85, s[60:63], s69 offen offset:1024
    buffer_load_dwordx4 v[44:47], v86, s[60:63], s69 offen offset:2048
    buffer_load_dwordx4 v[48:51], v87, s[60:63], s69 offen offset:3072
    s_add_u32 s69, s69, s3
    buffer_load_dwordx4 v[52:55], v84, s[60:63], s68 offen offset:0
    buffer_load_dwordx4 v[56:59], v85, s[60:63], s68 offen offset:1024
    buffer_load_dwordx4 v[60:63], v86, s[60:63], s68 offen offset:2048
    buffer_load_dwordx4 v[64:67], v87, s[60:63], s68 offen offset:3072
    s_add_u32 s68, s68, s3
    s_waitcnt vmcnt(28)
    ds_write_b128 v96, v[192:195] offset:0
    s_waitcnt vmcnt(27)
    ds_write_b128 v96, v[196:199] offset:1024
    s_waitcnt vmcnt(26)
    ds_write_b128 v96, v[200:203] offset:2048
    s_waitcnt vmcnt(25)
    ds_write_b128 v96, v[204:207] offset:3072
    s_waitcnt vmcnt(24)
    ds_write_b128 v96, v[208:211] offset:4096
    s_waitcnt vmcnt(23)
    ds_write_b128 v96, v[212:215] offset:5120
    s_waitcnt vmcnt(22)
    ds_write_b128 v96, v[216:219] offset:6144
    s_waitcnt vmcnt(21)
    ds_write_b128 v96, v[220:223] offset:7168
    s_waitcnt vmcnt(20)
    ds_write_b128 v96, v[224:227] offset:8192
    s_waitcnt vmcnt(19)
    ds_write_b128 v96, v[228:231] offset:9216
    s_waitcnt vmcnt(18)
    ds_write_b128 v96, v[232:235] offset:10240
    s_waitcnt vmcnt(17)
    ds_write_b128 v96, v[236:239] offset:11264
    s_waitcnt vmcnt(16)
    ds_write_b128 v96, v[240:243] offset:12288
    s_waitcnt vmcnt(15)
    ds_write_b128 v96, v[244:247] offset:13312
    s_waitcnt vmcnt(14)
    ds_write_b128 v96, v[248:251] offset:14336
    s_waitcnt vmcnt(13)
    ds_write_b128 v96, v[252:255] offset:15360
    s_waitcnt lgkmcnt(0)
    s_barrier
    ds_read_b64_tr_b16 v[192:193], v88 offset:0
    ds_read_b64_tr_b16 v[194:195], v88 offset:1024
    ds_read_b64_tr_b16 v[196:197], v89 offset:0
    ds_read_b64_tr_b16 v[198:199], v89 offset:1024
    ds_read_b64_tr_b16 v[200:201], v88 offset:8192
    ds_read_b64_tr_b16 v[202:203], v88 offset:9216
    ds_read_b64_tr_b16 v[204:205], v89 offset:8192
    ds_read_b64_tr_b16 v[206:207], v89 offset:9216
    s_waitcnt lgkmcnt(4)
    ds_read_b64_tr_b16 v[208:209], v88 offset:16384
    ds_read_b64_tr_b16 v[210:211], v88 offset:17408
    ds_read_b64_tr_b16 v[212:213], v89 offset:16384
    ds_read_b64_tr_b16 v[214:215], v89 offset:17408
    ds_read_b64_tr_b16 v[216:217], v88 offset:24576
    ds_read_b64_tr_b16 v[218:219], v88 offset:25600
    ds_read_b64_tr_b16 v[220:221], v89 offset:24576
    ds_read_b64_tr_b16 v[222:223], v89 offset:25600
    s_waitcnt lgkmcnt(4)
    ds_read_b64_tr_b16 v[224:225], v88 offset:32768
    ds_read_b64_tr_b16 v[226:227], v88 offset:33792
    ds_read_b64_tr_b16 v[228:229], v89 offset:32768
    ds_read_b64_tr_b16 v[230:231], v89 offset:33792
    ds_read_b64_tr_b16 v[232:233], v88 offset:40960
    ds_read_b64_tr_b16 v[234:235], v88 offset:41984
    ds_read_b64_tr_b16 v[236:237], v89 offset:40960
    ds_read_b64_tr_b16 v[238:239], v89 offset:41984
    s_waitcnt lgkmcnt(4)
    ds_read_b64_tr_b16 v[240:241], v88 offset:49152
    ds_read_b64_tr_b16 v[242:243], v88 offset:50176
    ds_read_b64_tr_b16 v[244:245], v89 offset:49152
    ds_read_b64_tr_b16 v[246:247], v89 offset:50176
    ds_read_b64_tr_b16 v[248:249], v88 offset:57344
    ds_read_b64_tr_b16 v[250:251], v88 offset:58368
    ds_read_b64_tr_b16 v[252:253], v89 offset:57344
    ds_read_b64_tr_b16 v[254:255], v89 offset:58368
    s_waitcnt lgkmcnt(0)
    s_barrier
    v_lshl_add_u32 v96, v1, 4, s70
    v_add_u32 v97, 0x10000, v96
    s_waitcnt vmcnt(11)
    ds_write_b128 v96, v[20:23] offset:0
    s_waitcnt vmcnt(10)
    ds_write_b128 v96, v[24:27] offset:1024
    s_waitcnt vmcnt(9)
    ds_write_b128 v96, v[28:31] offset:2048
    s_waitcnt vmcnt(8)
    ds_write_b128 v96, v[32:35] offset:3072
    s_waitcnt vmcnt(7)
    ds_write_b128 v96, v[36:39] offset:32768
    s_waitcnt vmcnt(6)
    ds_write_b128 v96, v[40:43] offset:33792
    s_waitcnt vmcnt(5)
    ds_write_b128 v96, v[44:47] offset:34816
    s_waitcnt vmcnt(4)
    ds_write_b128 v96, v[48:51] offset:35840
    s_waitcnt vmcnt(3)
    ds_write_b128 v97, v[52:55] offset:0
    s_waitcnt vmcnt(2)
    ds_write_b128 v97, v[56:59] offset:1024
    s_waitcnt vmcnt(1)
    ds_write_b128 v97, v[60:63] offset:2048
    s_waitcnt vmcnt(0)
    ds_write_b128 v97, v[64:67] offset:3072
    buffer_load_dword v99, off, s[12:15], s70 offset:32 sc1
    s_branch sgo_75
gen_60:
    s_mov_b32 s2, 131072
    s_mov_b32 s3, 2048
    s_mov_b32 s4, 65536
    s_mov_b32 s5, 7
    s_lshl_b32 s71, s75, 20
    s_add_u32 s81, s81, s71
    s_bfe_u32 s68, s57, 0x10000
    s_lshl_b32 s68, s68, 9
    s_lshl_b32 s71, s75, 15
    s_add_u32 s68, s68, s71
    s_bfe_u32 s71, s57, 0x30000
    s_lshl_b32 s71, s71, 7
    s_bfe_u32 s72, s58, 0x20000
    s_lshl_b32 s72, s72, 5
    s_bfe_u32 s73, s58, 0x10002
    s_lshl_b32 s73, s73, 4
    s_or_b32 s72, s72, s73
    s_or_b32 s71, s71, s72
    v_and_or_b32 v4, v1, 15, s71
    v_mov_b32 v6, 1024
    v_cmp_eq_u32 vcc, 1, v4
    s_nop 1
    v_cndmask_b32 v5, v4, v6, vcc
    v_and_b32 v54, 1, v5
    v_lshrrev_b32 v5, 1, v5
    v_cvt_f32_u32 v54, v54
    v_cvt_f32_u32 v5, v5
    v_mul_f32 v54, 0x3e800000, v54
    v_mul_f32 v52, 0x3a800000, v5
    v_xor_b32 v4, 16, v4
    v_cmp_eq_u32 vcc, 1, v4
    s_nop 1
    v_cndmask_b32 v5, v4, v6, vcc
    v_and_b32 v55, 1, v5
    v_lshrrev_b32 v5, 1, v5
    v_cvt_f32_u32 v55, v55
    v_cvt_f32_u32 v5, v5
    v_mul_f32 v55, 0x3e800000, v55
    v_mul_f32 v53, 0x3a800000, v5
    v_xor_b32 v4, 16, v4
    v_bfe_u32 v4, v1, 4, 2
    v_lshlrev_b32 v4, 3, v4
    s_bfe_u32 s71, s58, 0x10002
    s_lshl_b32 s71, s71, 9
    s_bfe_u32 s72, s57, 0x10000
    s_lshl_b32 s72, s72, 8
    s_or_b32 s71, s71, s72
    v_or_b32 v4, s71, v4
    v_cvt_f32_u32 v56, v4
    v_xor_b32 v4, 0x100, v4
    v_fma_f32 v60, v52, v56, v54
    v_fract_f32 v60, v60
    v_add_f32 v61, v60, v52
    v_add_f32 v62, v61, v52
    v_add_f32 v63, v62, v52
    v_add_f32 v64, v63, v52
    v_add_f32 v65, v64, v52
    v_add_f32 v66, v65, v52
    v_add_f32 v67, v66, v52
    v_cos_f32 v60, v60
    v_cos_f32 v61, v61
    v_cos_f32 v62, v62
    v_cos_f32 v63, v63
    v_cos_f32 v64, v64
    v_cos_f32 v65, v65
    v_cos_f32 v66, v66
    v_cos_f32 v67, v67
    v_cvt_pk_bf16_f32 v128, v60, v61
    v_cvt_pk_bf16_f32 v129, v62, v63
    v_cvt_pk_bf16_f32 v130, v64, v65
    v_cvt_pk_bf16_f32 v131, v66, v67
    v_fma_f32 v68, v53, v56, v55
    v_fract_f32 v68, v68
    v_add_f32 v69, v68, v53
    v_add_f32 v70, v69, v53
    v_add_f32 v71, v70, v53
    v_add_f32 v72, v71, v53
    v_add_f32 v73, v72, v53
    v_add_f32 v74, v73, v53
    v_add_f32 v75, v74, v53
    v_cos_f32 v68, v68
    v_cos_f32 v69, v69
    v_cos_f32 v70, v70
    v_cos_f32 v71, v71
    v_cos_f32 v72, v72
    v_cos_f32 v73, v73
    v_cos_f32 v74, v74
    v_cos_f32 v75, v75
    v_cvt_pk_bf16_f32 v132, v68, v69
    v_cvt_pk_bf16_f32 v133, v70, v71
    v_cvt_pk_bf16_f32 v134, v72, v73
    v_cvt_pk_bf16_f32 v135, v74, v75
    v_add_f32 v56, 0x42000000, v56
    v_fma_f32 v60, v52, v56, v54
    v_fract_f32 v60, v60
    v_add_f32 v61, v60, v52
    v_add_f32 v62, v61, v52
    v_add_f32 v63, v62, v52
    v_add_f32 v64, v63, v52
    v_add_f32 v65, v64, v52
    v_add_f32 v66, v65, v52
    v_add_f32 v67, v66, v52
    v_cos_f32 v60, v60
    v_cos_f32 v61, v61
    v_cos_f32 v62, v62
    v_cos_f32 v63, v63
    v_cos_f32 v64, v64
    v_cos_f32 v65, v65
    v_cos_f32 v66, v66
    v_cos_f32 v67, v67
    v_cvt_pk_bf16_f32 v136, v60, v61
    v_cvt_pk_bf16_f32 v137, v62, v63
    v_cvt_pk_bf16_f32 v138, v64, v65
    v_cvt_pk_bf16_f32 v139, v66, v67
    v_fma_f32 v68, v53, v56, v55
    v_fract_f32 v68, v68
    v_add_f32 v69, v68, v53
    v_add_f32 v70, v69, v53
    v_add_f32 v71, v70, v53
    v_add_f32 v72, v71, v53
    v_add_f32 v73, v72, v53
    v_add_f32 v74, v73, v53
    v_add_f32 v75, v74, v53
    v_cos_f32 v68, v68
    v_cos_f32 v69, v69
    v_cos_f32 v70, v70
    v_cos_f32 v71, v71
    v_cos_f32 v72, v72
    v_cos_f32 v73, v73
    v_cos_f32 v74, v74
    v_cos_f32 v75, v75
    v_cvt_pk_bf16_f32 v140, v68, v69
    v_cvt_pk_bf16_f32 v141, v70, v71
    v_cvt_pk_bf16_f32 v142, v72, v73
    v_cvt_pk_bf16_f32 v143, v74, v75
    v_add_f32 v56, 0x42000000, v56
    v_fma_f32 v60, v52, v56, v54
    v_fract_f32 v60, v60
    v_add_f32 v61, v60, v52
    v_add_f32 v62, v61, v52
    v_add_f32 v63, v62, v52
    v_add_f32 v64, v63, v52
    v_add_f32 v65, v64, v52
    v_add_f32 v66, v65, v52
    v_add_f32 v67, v66, v52
    v_cos_f32 v60, v60
    v_cos_f32 v61, v61
    v_cos_f32 v62, v62
    v_cos_f32 v63, v63
    v_cos_f32 v64, v64
    v_cos_f32 v65, v65
    v_cos_f32 v66, v66
    v_cos_f32 v67, v67
    v_cvt_pk_bf16_f32 v144, v60, v61
    v_cvt_pk_bf16_f32 v145, v62, v63
    v_cvt_pk_bf16_f32 v146, v64, v65
    v_cvt_pk_bf16_f32 v147, v66, v67
    v_fma_f32 v68, v53, v56, v55
    v_fract_f32 v68, v68
    v_add_f32 v69, v68, v53
    v_add_f32 v70, v69, v53
    v_add_f32 v71, v70, v53
    v_add_f32 v72, v71, v53
    v_add_f32 v73, v72, v53
    v_add_f32 v74, v73, v53
    v_add_f32 v75, v74, v53
    v_cos_f32 v68, v68
    v_cos_f32 v69, v69
    v_cos_f32 v70, v70
    v_cos_f32 v71, v71
    v_cos_f32 v72, v72
    v_cos_f32 v73, v73
    v_cos_f32 v74, v74
    v_cos_f32 v75, v75
    v_cvt_pk_bf16_f32 v148, v68, v69
    v_cvt_pk_bf16_f32 v149, v70, v71
    v_cvt_pk_bf16_f32 v150, v72, v73
    v_cvt_pk_bf16_f32 v151, v74, v75
    v_add_f32 v56, 0x42000000, v56
    v_fma_f32 v60, v52, v56, v54
    v_fract_f32 v60, v60
    v_add_f32 v61, v60, v52
    v_add_f32 v62, v61, v52
    v_add_f32 v63, v62, v52
    v_add_f32 v64, v63, v52
    v_add_f32 v65, v64, v52
    v_add_f32 v66, v65, v52
    v_add_f32 v67, v66, v52
    v_cos_f32 v60, v60
    v_cos_f32 v61, v61
    v_cos_f32 v62, v62
    v_cos_f32 v63, v63
    v_cos_f32 v64, v64
    v_cos_f32 v65, v65
    v_cos_f32 v66, v66
    v_cos_f32 v67, v67
    v_cvt_pk_bf16_f32 v152, v60, v61
    v_cvt_pk_bf16_f32 v153, v62, v63
    v_cvt_pk_bf16_f32 v154, v64, v65
    v_cvt_pk_bf16_f32 v155, v66, v67
    v_fma_f32 v68, v53, v56, v55
    v_fract_f32 v68, v68
    v_add_f32 v69, v68, v53
    v_add_f32 v70, v69, v53
    v_add_f32 v71, v70, v53
    v_add_f32 v72, v71, v53
    v_add_f32 v73, v72, v53
    v_add_f32 v74, v73, v53
    v_add_f32 v75, v74, v53
    v_cos_f32 v68, v68
    v_cos_f32 v69, v69
    v_cos_f32 v70, v70
    v_cos_f32 v71, v71
    v_cos_f32 v72, v72
    v_cos_f32 v73, v73
    v_cos_f32 v74, v74
    v_cos_f32 v75, v75
    v_cvt_pk_bf16_f32 v156, v68, v69
    v_cvt_pk_bf16_f32 v157, v70, v71
    v_cvt_pk_bf16_f32 v158, v72, v73
    v_cvt_pk_bf16_f32 v159, v74, v75
    v_add_f32 v56, 0x42000000, v56
    v_fma_f32 v60, v52, v56, v54
    v_fract_f32 v60, v60
    v_add_f32 v61, v60, v52
    v_add_f32 v62, v61, v52
    v_add_f32 v63, v62, v52
    v_add_f32 v64, v63, v52
    v_add_f32 v65, v64, v52
    v_add_f32 v66, v65, v52
    v_add_f32 v67, v66, v52
    v_cos_f32 v60, v60
    v_cos_f32 v61, v61
    v_cos_f32 v62, v62
    v_cos_f32 v63, v63
    v_cos_f32 v64, v64
    v_cos_f32 v65, v65
    v_cos_f32 v66, v66
    v_cos_f32 v67, v67
    v_cvt_pk_bf16_f32 v160, v60, v61
    v_cvt_pk_bf16_f32 v161, v62, v63
    v_cvt_pk_bf16_f32 v162, v64, v65
    v_cvt_pk_bf16_f32 v163, v66, v67
    v_fma_f32 v68, v53, v56, v55
    v_fract_f32 v68, v68
    v_add_f32 v69, v68, v53
    v_add_f32 v70, v69, v53
    v_add_f32 v71, v70, v53
    v_add_f32 v72, v71, v53
    v_add_f32 v73, v72, v53
    v_add_f32 v74, v73, v53
    v_add_f32 v75, v74, v53
    v_cos_f32 v68, v68
    v_cos_f32 v69, v69
    v_cos_f32 v70, v70
    v_cos_f32 v71, v71
    v_cos_f32 v72, v72
    v_cos_f32 v73, v73
    v_cos_f32 v74, v74
    v_cos_f32 v75, v75
    v_cvt_pk_bf16_f32 v164, v68, v69
    v_cvt_pk_bf16_f32 v165, v70, v71
    v_cvt_pk_bf16_f32 v166, v72, v73
    v_cvt_pk_bf16_f32 v167, v74, v75
    v_add_f32 v56, 0x42000000, v56
    v_fma_f32 v60, v52, v56, v54
    v_fract_f32 v60, v60
    v_add_f32 v61, v60, v52
    v_add_f32 v62, v61, v52
    v_add_f32 v63, v62, v52
    v_add_f32 v64, v63, v52
    v_add_f32 v65, v64, v52
    v_add_f32 v66, v65, v52
    v_add_f32 v67, v66, v52
    v_cos_f32 v60, v60
    v_cos_f32 v61, v61
    v_cos_f32 v62, v62
    v_cos_f32 v63, v63
    v_cos_f32 v64, v64
    v_cos_f32 v65, v65
    v_cos_f32 v66, v66
    v_cos_f32 v67, v67
    v_cvt_pk_bf16_f32 v168, v60, v61
    v_cvt_pk_bf16_f32 v169, v62, v63
    v_cvt_pk_bf16_f32 v170, v64, v65
    v_cvt_pk_bf16_f32 v171, v66, v67
    v_fma_f32 v68, v53, v56, v55
    v_fract_f32 v68, v68
    v_add_f32 v69, v68, v53
    v_add_f32 v70, v69, v53
    v_add_f32 v71, v70, v53
    v_add_f32 v72, v71, v53
    v_add_f32 v73, v72, v53
    v_add_f32 v74, v73, v53
    v_add_f32 v75, v74, v53
    v_cos_f32 v68, v68
    v_cos_f32 v69, v69
    v_cos_f32 v70, v70
    v_cos_f32 v71, v71
    v_cos_f32 v72, v72
    v_cos_f32 v73, v73
    v_cos_f32 v74, v74
    v_cos_f32 v75, v75
    v_cvt_pk_bf16_f32 v172, v68, v69
    v_cvt_pk_bf16_f32 v173, v70, v71
    v_cvt_pk_bf16_f32 v174, v72, v73
    v_cvt_pk_bf16_f32 v175, v74, v75
    v_add_f32 v56, 0x42000000, v56
    v_fma_f32 v60, v52, v56, v54
    v_fract_f32 v60, v60
    v_add_f32 v61, v60, v52
    v_add_f32 v62, v61, v52
    v_add_f32 v63, v62, v52
    v_add_f32 v64, v63, v52
    v_add_f32 v65, v64, v52
    v_add_f32 v66, v65, v52
    v_add_f32 v67, v66, v52
    v_cos_f32 v60, v60
    v_cos_f32 v61, v61
    v_cos_f32 v62, v62
    v_cos_f32 v63, v63
    v_cos_f32 v64, v64
    v_cos_f32 v65, v65
    v_cos_f32 v66, v66
    v_cos_f32 v67, v67
    v_cvt_pk_bf16_f32 v176, v60, v61
    v_cvt_pk_bf16_f32 v177, v62, v63
    v_cvt_pk_bf16_f32 v178, v64, v65
    v_cvt_pk_bf16_f32 v179, v66, v67
    v_fma_f32 v68, v53, v56, v55
    v_fract_f32 v68, v68
    v_add_f32 v69, v68, v53
    v_add_f32 v70, v69, v53
    v_add_f32 v71, v70, v53
    v_add_f32 v72, v71, v53
    v_add_f32 v73, v72, v53
    v_add_f32 v74, v73, v53
    v_add_f32 v75, v74, v53
    v_cos_f32 v68, v68
    v_cos_f32 v69, v69
    v_cos_f32 v70, v70
    v_cos_f32 v71, v71
    v_cos_f32 v72, v72
    v_cos_f32 v73, v73
    v_cos_f32 v74, v74
    v_cos_f32 v75, v75
    v_cvt_pk_bf16_f32 v180, v68, v69
    v_cvt_pk_bf16_f32 v181, v70, v71
    v_cvt_pk_bf16_f32 v182, v72, v73
    v_cvt_pk_bf16_f32 v183, v74, v75
    v_add_f32 v56, 0x42000000, v56
    v_fma_f32 v60, v52, v56, v54
    v_fract_f32 v60, v60
    v_add_f32 v61, v60, v52
    v_add_f32 v62, v61, v52
    v_add_f32 v63, v62, v52
    v_add_f32 v64, v63, v52
    v_add_f32 v65, v64, v52
    v_add_f32 v66, v65, v52
    v_add_f32 v67, v66, v52
    v_cos_f32 v60, v60
    v_cos_f32 v61, v61
    v_cos_f32 v62, v62
    v_cos_f32 v63, v63
    v_cos_f32 v64, v64
    v_cos_f32 v65, v65
    v_cos_f32 v66, v66
    v_cos_f32 v67, v67
    v_cvt_pk_bf16_f32 v184, v60, v61
    v_cvt_pk_bf16_f32 v185, v62, v63
    v_cvt_pk_bf16_f32 v186, v64, v65
    v_cvt_pk_bf16_f32 v187, v66, v67
    v_fma_f32 v68, v53, v56, v55
    v_fract_f32 v68, v68
    v_add_f32 v69, v68, v53
    v_add_f32 v70, v69, v53
    v_add_f32 v71, v70, v53
    v_add_f32 v72, v71, v53
    v_add_f32 v73, v72, v53
    v_add_f32 v74, v73, v53
    v_add_f32 v75, v74, v53
    v_cos_f32 v68, v68
    v_cos_f32 v69, v69
    v_cos_f32 v70, v70
    v_cos_f32 v71, v71
    v_cos_f32 v72, v72
    v_cos_f32 v73, v73
    v_cos_f32 v74, v74
    v_cos_f32 v75, v75
    v_cvt_pk_bf16_f32 v188, v68, v69
    v_cvt_pk_bf16_f32 v189, v70, v71
    v_cvt_pk_bf16_f32 v190, v72, v73
    v_cvt_pk_bf16_f32 v191, v74, v75
    v_cvt_f32_u32 v56, v4
    v_xor_b32 v4, 0x100, v4
    v_fma_f32 v60, v52, v56, v54
    v_fract_f32 v60, v60
    v_add_f32 v61, v60, v52
    v_add_f32 v62, v61, v52
    v_add_f32 v63, v62, v52
    v_add_f32 v64, v63, v52
    v_add_f32 v65, v64, v52
    v_add_f32 v66, v65, v52
    v_add_f32 v67, v66, v52
    v_cos_f32 v60, v60
    v_cos_f32 v61, v61
    v_cos_f32 v62, v62
    v_cos_f32 v63, v63
    v_cos_f32 v64, v64
    v_cos_f32 v65, v65
    v_cos_f32 v66, v66
    v_cos_f32 v67, v67
    v_cvt_pk_bf16_f32 v192, v60, v61
    v_cvt_pk_bf16_f32 v193, v62, v63
    v_cvt_pk_bf16_f32 v194, v64, v65
    v_cvt_pk_bf16_f32 v195, v66, v67
    v_fma_f32 v68, v53, v56, v55
    v_fract_f32 v68, v68
    v_add_f32 v69, v68, v53
    v_add_f32 v70, v69, v53
    v_add_f32 v71, v70, v53
    v_add_f32 v72, v71, v53
    v_add_f32 v73, v72, v53
    v_add_f32 v74, v73, v53
    v_add_f32 v75, v74, v53
    v_cos_f32 v68, v68
    v_cos_f32 v69, v69
    v_cos_f32 v70, v70
    v_cos_f32 v71, v71
    v_cos_f32 v72, v72
    v_cos_f32 v73, v73
    v_cos_f32 v74, v74
    v_cos_f32 v75, v75
    v_cvt_pk_bf16_f32 v196, v68, v69
    v_cvt_pk_bf16_f32 v197, v70, v71
    v_cvt_pk_bf16_f32 v198, v72, v73
    v_cvt_pk_bf16_f32 v199, v74, v75
    v_add_f32 v56, 0x42000000, v56
    v_fma_f32 v60, v52, v56, v54
    v_fract_f32 v60, v60
    v_add_f32 v61, v60, v52
    v_add_f32 v62, v61, v52
    v_add_f32 v63, v62, v52
    v_add_f32 v64, v63, v52
    v_add_f32 v65, v64, v52
    v_add_f32 v66, v65, v52
    v_add_f32 v67, v66, v52
    v_cos_f32 v60, v60
    v_cos_f32 v61, v61
    v_cos_f32 v62, v62
    v_cos_f32 v63, v63
    v_cos_f32 v64, v64
    v_cos_f32 v65, v65
    v_cos_f32 v66, v66
    v_cos_f32 v67, v67
    v_cvt_pk_bf16_f32 v200, v60, v61
    v_cvt_pk_bf16_f32 v201, v62, v63
    v_cvt_pk_bf16_f32 v202, v64, v65
    v_cvt_pk_bf16_f32 v203, v66, v67
    v_fma_f32 v68, v53, v56, v55
    v_fract_f32 v68, v68
    v_add_f32 v69, v68, v53
    v_add_f32 v70, v69, v53
    v_add_f32 v71, v70, v53
    v_add_f32 v72, v71, v53
    v_add_f32 v73, v72, v53
    v_add_f32 v74, v73, v53
    v_add_f32 v75, v74, v53
    v_cos_f32 v68, v68
    v_cos_f32 v69, v69
    v_cos_f32 v70, v70
    v_cos_f32 v71, v71
    v_cos_f32 v72, v72
    v_cos_f32 v73, v73
    v_cos_f32 v74, v74
    v_cos_f32 v75, v75
    v_cvt_pk_bf16_f32 v204, v68, v69
    v_cvt_pk_bf16_f32 v205, v70, v71
    v_cvt_pk_bf16_f32 v206, v72, v73
    v_cvt_pk_bf16_f32 v207, v74, v75
    v_add_f32 v56, 0x42000000, v56
    v_fma_f32 v60, v52, v56, v54
    v_fract_f32 v60, v60
    v_add_f32 v61, v60, v52
    v_add_f32 v62, v61, v52
    v_add_f32 v63, v62, v52
    v_add_f32 v64, v63, v52
    v_add_f32 v65, v64, v52
    v_add_f32 v66, v65, v52
    v_add_f32 v67, v66, v52
    v_cos_f32 v60, v60
    v_cos_f32 v61, v61
    v_cos_f32 v62, v62
    v_cos_f32 v63, v63
    v_cos_f32 v64, v64
    v_cos_f32 v65, v65
    v_cos_f32 v66, v66
    v_cos_f32 v67, v67
    v_cvt_pk_bf16_f32 v208, v60, v61
    v_cvt_pk_bf16_f32 v209, v62, v63
    v_cvt_pk_bf16_f32 v210, v64, v65
    v_cvt_pk_bf16_f32 v211, v66, v67
    v_fma_f32 v68, v53, v56, v55
    v_fract_f32 v68, v68
    v_add_f32 v69, v68, v53
    v_add_f32 v70, v69, v53
    v_add_f32 v71, v70, v53
    v_add_f32 v72, v71, v53
    v_add_f32 v73, v72, v53
    v_add_f32 v74, v73, v53
    v_add_f32 v75, v74, v53
    v_cos_f32 v68, v68
    v_cos_f32 v69, v69
    v_cos_f32 v70, v70
    v_cos_f32 v71, v71
    v_cos_f32 v72, v72
    v_cos_f32 v73, v73
    v_cos_f32 v74, v74
    v_cos_f32 v75, v75
    v_cvt_pk_bf16_f32 v212, v68, v69
    v_cvt_pk_bf16_f32 v213, v70, v71
    v_cvt_pk_bf16_f32 v214, v72, v73
    v_cvt_pk_bf16_f32 v215, v74, v75
    v_add_f32 v56, 0x42000000, v56
    v_fma_f32 v60, v52, v56, v54
    v_fract_f32 v60, v60
    v_add_f32 v61, v60, v52
    v_add_f32 v62, v61, v52
    v_add_f32 v63, v62, v52
    v_add_f32 v64, v63, v52
    v_add_f32 v65, v64, v52
    v_add_f32 v66, v65, v52
    v_add_f32 v67, v66, v52
    v_cos_f32 v60, v60
    v_cos_f32 v61, v61
    v_cos_f32 v62, v62
    v_cos_f32 v63, v63
    v_cos_f32 v64, v64
    v_cos_f32 v65, v65
    v_cos_f32 v66, v66
    v_cos_f32 v67, v67
    v_cvt_pk_bf16_f32 v216, v60, v61
    v_cvt_pk_bf16_f32 v217, v62, v63
    v_cvt_pk_bf16_f32 v218, v64, v65
    v_cvt_pk_bf16_f32 v219, v66, v67
    v_fma_f32 v68, v53, v56, v55
    v_fract_f32 v68, v68
    v_add_f32 v69, v68, v53
    v_add_f32 v70, v69, v53
    v_add_f32 v71, v70, v53
    v_add_f32 v72, v71, v53
    v_add_f32 v73, v72, v53
    v_add_f32 v74, v73, v53
    v_add_f32 v75, v74, v53
    v_cos_f32 v68, v68
    v_cos_f32 v69, v69
    v_cos_f32 v70, v70
    v_cos_f32 v71, v71
    v_cos_f32 v72, v72
    v_cos_f32 v73, v73
    v_cos_f32 v74, v74
    v_cos_f32 v75, v75
    v_cvt_pk_bf16_f32 v220, v68, v69
    v_cvt_pk_bf16_f32 v221, v70, v71
    v_cvt_pk_bf16_f32 v222, v72, v73
    v_cvt_pk_bf16_f32 v223, v74, v75
    v_add_f32 v56, 0x42000000, v56
    v_fma_f32 v60, v52, v56, v54
    v_fract_f32 v60, v60
    v_add_f32 v61, v60, v52
    v_add_f32 v62, v61, v52
    v_add_f32 v63, v62, v52
    v_add_f32 v64, v63, v52
    v_add_f32 v65, v64, v52
    v_add_f32 v66, v65, v52
    v_add_f32 v67, v66, v52
    v_cos_f32 v60, v60
    v_cos_f32 v61, v61
    v_cos_f32 v62, v62
    v_cos_f32 v63, v63
    v_cos_f32 v64, v64
    v_cos_f32 v65, v65
    v_cos_f32 v66, v66
    v_cos_f32 v67, v67
    v_cvt_pk_bf16_f32 v224, v60, v61
    v_cvt_pk_bf16_f32 v225, v62, v63
    v_cvt_pk_bf16_f32 v226, v64, v65
    v_cvt_pk_bf16_f32 v227, v66, v67
    v_fma_f32 v68, v53, v56, v55
    v_fract_f32 v68, v68
    v_add_f32 v69, v68, v53
    v_add_f32 v70, v69, v53
    v_add_f32 v71, v70, v53
    v_add_f32 v72, v71, v53
    v_add_f32 v73, v72, v53
    v_add_f32 v74, v73, v53
    v_add_f32 v75, v74, v53
    v_cos_f32 v68, v68
    v_cos_f32 v69, v69
    v_cos_f32 v70, v70
    v_cos_f32 v71, v71
    v_cos_f32 v72, v72
    v_cos_f32 v73, v73
    v_cos_f32 v74, v74
    v_cos_f32 v75, v75
    v_cvt_pk_bf16_f32 v228, v68, v69
    v_cvt_pk_bf16_f32 v229, v70, v71
    v_cvt_pk_bf16_f32 v230, v72, v73
    v_cvt_pk_bf16_f32 v231, v74, v75
    v_add_f32 v56, 0x42000000, v56
    v_fma_f32 v60, v52, v56, v54
    v_fract_f32 v60, v60
    v_add_f32 v61, v60, v52
    v_add_f32 v62, v61, v52
    v_add_f32 v63, v62, v52
    v_add_f32 v64, v63, v52
    v_add_f32 v65, v64, v52
    v_add_f32 v66, v65, v52
    v_add_f32 v67, v66, v52
    v_cos_f32 v60, v60
    v_cos_f32 v61, v61
    v_cos_f32 v62, v62
    v_cos_f32 v63, v63
    v_cos_f32 v64, v64
    v_cos_f32 v65, v65
    v_cos_f32 v66, v66
    v_cos_f32 v67, v67
    v_cvt_pk_bf16_f32 v232, v60, v61
    v_cvt_pk_bf16_f32 v233, v62, v63
    v_cvt_pk_bf16_f32 v234, v64, v65
    v_cvt_pk_bf16_f32 v235, v66, v67
    v_fma_f32 v68, v53, v56, v55
    v_fract_f32 v68, v68
    v_add_f32 v69, v68, v53
    v_add_f32 v70, v69, v53
    v_add_f32 v71, v70, v53
    v_add_f32 v72, v71, v53
    v_add_f32 v73, v72, v53
    v_add_f32 v74, v73, v53
    v_add_f32 v75, v74, v53
    v_cos_f32 v68, v68
    v_cos_f32 v69, v69
    v_cos_f32 v70, v70
    v_cos_f32 v71, v71
    v_cos_f32 v72, v72
    v_cos_f32 v73, v73
    v_cos_f32 v74, v74
    v_cos_f32 v75, v75
    v_cvt_pk_bf16_f32 v236, v68, v69
    v_cvt_pk_bf16_f32 v237, v70, v71
    v_cvt_pk_bf16_f32 v238, v72, v73
    v_cvt_pk_bf16_f32 v239, v74, v75
    v_add_f32 v56, 0x42000000, v56
    v_fma_f32 v60, v52, v56, v54
    v_fract_f32 v60, v60
    v_add_f32 v61, v60, v52
    v_add_f32 v62, v61, v52
    v_add_f32 v63, v62, v52
    v_add_f32 v64, v63, v52
    v_add_f32 v65, v64, v52
    v_add_f32 v66, v65, v52
    v_add_f32 v67, v66, v52
    v_cos_f32 v60, v60
    v_cos_f32 v61, v61
    v_cos_f32 v62, v62
    v_cos_f32 v63, v63
    v_cos_f32 v64, v64
    v_cos_f32 v65, v65
    v_cos_f32 v66, v66
    v_cos_f32 v67, v67
    v_cvt_pk_bf16_f32 v240, v60, v61
    v_cvt_pk_bf16_f32 v241, v62, v63
    v_cvt_pk_bf16_f32 v242, v64, v65
    v_cvt_pk_bf16_f32 v243, v66, v67
    v_fma_f32 v68, v53, v56, v55
    v_fract_f32 v68, v68
    v_add_f32 v69, v68, v53
    v_add_f32 v70, v69, v53
    v_add_f32 v71, v70, v53
    v_add_f32 v72, v71, v53
    v_add_f32 v73, v72, v53
    v_add_f32 v74, v73, v53
    v_add_f32 v75, v74, v53
    v_cos_f32 v68, v68
    v_cos_f32 v69, v69
    v_cos_f32 v70, v70
    v_cos_f32 v71, v71
    v_cos_f32 v72, v72
    v_cos_f32 v73, v73
    v_cos_f32 v74, v74
    v_cos_f32 v75, v75
    v_cvt_pk_bf16_f32 v244, v68, v69
    v_cvt_pk_bf16_f32 v245, v70, v71
    v_cvt_pk_bf16_f32 v246, v72, v73
    v_cvt_pk_bf16_f32 v247, v74, v75
    v_add_f32 v56, 0x42000000, v56
    v_fma_f32 v60, v52, v56, v54
    v_fract_f32 v60, v60
    v_add_f32 v61, v60, v52
    v_add_f32 v62, v61, v52
    v_add_f32 v63, v62, v52
    v_add_f32 v64, v63, v52
    v_add_f32 v65, v64, v52
    v_add_f32 v66, v65, v52
    v_add_f32 v67, v66, v52
    v_cos_f32 v60, v60
    v_cos_f32 v61, v61
    v_cos_f32 v62, v62
    v_cos_f32 v63, v63
    v_cos_f32 v64, v64
    v_cos_f32 v65, v65
    v_cos_f32 v66, v66
    v_cos_f32 v67, v67
    v_cvt_pk_bf16_f32 v248, v60, v61
    v_cvt_pk_bf16_f32 v249, v62, v63
    v_cvt_pk_bf16_f32 v250, v64, v65
    v_cvt_pk_bf16_f32 v251, v66, v67
    v_fma_f32 v68, v53, v56, v55
    v_fract_f32 v68, v68
    v_add_f32 v69, v68, v53
    v_add_f32 v70, v69, v53
    v_add_f32 v71, v70, v53
    v_add_f32 v72, v71, v53
    v_add_f32 v73, v72, v53
    v_add_f32 v74, v73, v53
    v_add_f32 v75, v74, v53
    v_cos_f32 v68, v68
    v_cos_f32 v69, v69
    v_cos_f32 v70, v70
    v_cos_f32 v71, v71
    v_cos_f32 v72, v72
    v_cos_f32 v73, v73
    v_cos_f32 v74, v74
    v_cos_f32 v75, v75
    v_cvt_pk_bf16_f32 v252, v68, v69
    v_cvt_pk_bf16_f32 v253, v70, v71
    v_cvt_pk_bf16_f32 v254, v72, v73
    v_cvt_pk_bf16_f32 v255, v74, v75
    s_lshl_b32 s71, s58, 2
    s_bfe_u32 s72, s71, 0x30000
    s_bfe_u32 s73, s71, 0x10003
    s_lshl_b32 s73, s73, 4
    s_or_b32 s72, s72, s73
    s_bfe_u32 s73, s71, 0x10004
    s_lshl_b32 s73, s73, 3
    s_or_b32 s72, s72, s73
    s_mul_i32 s72, s72, s2
    v_mov_b32 v4, s72
    s_and_b32 s71, s71, 12
    v_xor_b32 v5, s71, v1
    v_bfe_u32 v84, v5, 0, 5
    v_lshlrev_b32 v84, 4, v84
    v_bfe_u32 v6, v5, 5, 1
    v_lshl_or_b32 v84, v6, 10, v84
    s_sub_u32 s72, s2, 1024
    v_add_u32 v84, v84, v4
    v_xor_b32 v85, 16, v84
    v_add_u32 v85, s72, v85
    v_xor_b32 v86, 48, v85
    v_add_u32 v86, s72, v86
    v_xor_b32 v87, 16, v86
    v_add_u32 v87, s72, v87
    s_xor_b32 s69, s68, 512
    s_lshl_b32 s70, s58, 12
    s_add_u32 m0, s70, 0
    s_nop 0
    buffer_load_dwordx4 v84, s[60:63], s68 offen offset:0 lds
    buffer_load_dwordx4 v85, s[60:63], s68 offen offset:1024 lds
    buffer_load_dwordx4 v86, s[60:63], s68 offen offset:2048 lds
    buffer_load_dwordx4 v87, s[60:63], s68 offen offset:3072 lds
    s_add_u32 s68, s68, s3
    s_add_u32 m0, s70, 32768
    s_nop 0
    buffer_load_dwordx4 v84, s[60:63], s69 offen offset:0 lds
    buffer_load_dwordx4 v85, s[60:63], s69 offen offset:1024 lds
    buffer_load_dwordx4 v86, s[60:63], s69 offen offset:2048 lds
    buffer_load_dwordx4 v87, s[60:63], s69 offen offset:3072 lds
    s_add_u32 s69, s69, s3
    s_add_u32 m0, s70, 65536
    s_nop 0
    buffer_load_dwordx4 v84, s[60:63], s68 offen offset:0 lds
    buffer_load_dwordx4 v85, s[60:63], s68 offen offset:1024 lds
    buffer_load_dwordx4 v86, s[60:63], s68 offen offset:2048 lds
    buffer_load_dwordx4 v87, s[60:63], s68 offen offset:3072 lds
    s_add_u32 s68, s68, s3
sgo_75:
    v_lshrrev_b32 v4, 4, v1
    v_xor_b32 v4, v4, v1
    v_bfe_u32 v5, v4, 0, 4
    v_lshlrev_b32 v5, 4, v5
    v_bfe_u32 v4, v1, 0, 4
    v_lshlrev_b32 v4, 10, v4
    s_bfe_u32 s71, s58, 0x10002
    s_lshl_b32 s71, s71, 9
    v_or3_b32 v88, v4, v5, s71
    v_xor_b32 v89, 0x40, v88
    v_xor_b32 v90, 0x80, v88
    v_xor_b32 v91, 0xc0, v88
    v_xor_b32 v92, 0x10000, v88
    v_xor_b32 v93, 0x10040, v88
    v_xor_b32 v94, 0x10080, v88
    v_xor_b32 v95, 0x100c0, v88
    s_lshl_b32 s71, s58, 11
    s_or_b32 s71, s71, 131072
    v_lshl_add_u32 v96, v1, 4, s71
    v_xor_b32 v97, 0x2000, v96
    v_bfe_u32 v98, v1, 0, 4
    v_lshlrev_b32 v98, 4, v98
    v_bfe_u32 v4, v1, 4, 2
    v_lshl_or_b32 v98, v4, 9, v98
    s_bfe_u32 s71, s57, 0x30000
    s_lshl_b32 s71, s71, 13
    s_add_u32 s81, s81, s71
    s_bfe_u32 s71, s58, 0x20000
    s_lshl_b32 s71, s71, 11
    s_bfe_u32 s72, s58, 0x10002
    s_lshl_b32 s72, s72, 8
    s_or_b32 s71, s71, s72
    s_add_u32 s81, s81, s71
    s_mov_b32 s73, 0x5ffffff0
    s_mov_b32 s82, 0
    s_waitcnt vmcnt(8) lgkmcnt(0)
    s_barrier
    ds_read_b128 v[52:55], v88 offset:0
    ds_read_b128 v[56:59], v88 offset:16384
    ds_read_b128 v[60:63], v89 offset:0
    ds_read_b128 v[64:67], v89 offset:16384
    v_mov_b32 v100, 3
    v_cmp_gt_u32 vcc, s58, v100
stream_76:
    s_waitcnt lgkmcnt(2)
    v_mfma_f32_16x16x32_bf16 v[20:23], v[52:55], v[128:131], 0
    ds_read_b128 v[68:71], v90 offset:0
    v_mfma_f32_16x16x32_bf16 v[24:27], v[52:55], v[132:135], 0
    ds_read_b128 v[72:75], v90 offset:16384
    v_mfma_f32_16x16x32_bf16 v[28:31], v[56:59], v[128:131], 0
    s_add_u32 m0, s70, 98304
    s_nop 0
    buffer_load_dwordx4 v84, s[60:63], s69 offen offset:0 lds
    v_mfma_f32_16x16x32_bf16 v[32:35], v[56:59], v[132:135], 0
    s_waitcnt lgkmcnt(2)
    v_mfma_f32_16x16x32_bf16 v[20:23], v[60:63], v[136:139], v[20:23]
    ds_read_b128 v[76:79], v91 offset:0
    v_mfma_f32_16x16x32_bf16 v[24:27], v[60:63], v[140:143], v[24:27]
    ds_read_b128 v[80:83], v91 offset:16384
    v_mfma_f32_16x16x32_bf16 v[28:31], v[64:67], v[136:139], v[28:31]
    buffer_load_dwordx4 v85, s[60:63], s69 offen offset:1024 lds
    v_mfma_f32_16x16x32_bf16 v[32:35], v[64:67], v[140:143], v[32:35]
    ds_write_b128 v96, v[40:43] offset:0
    s_waitcnt lgkmcnt(3)
    v_mfma_f32_16x16x32_bf16 v[20:23], v[68:71], v[144:147], v[20:23]
    ds_read_b128 v[52:55], v88 offset:256
    v_mfma_f32_16x16x32_bf16 v[24:27], v[68:71], v[148:151], v[24:27]
    ds_read_b128 v[56:59], v88 offset:16640
    v_mfma_f32_16x16x32_bf16 v[28:31], v[72:75], v[144:147], v[28:31]
    buffer_load_dwordx4 v86, s[60:63], s69 offen offset:2048 lds
    v_mfma_f32_16x16x32_bf16 v[32:35], v[72:75], v[148:151], v[32:35]
    ds_write_b128 v96, v[48:51] offset:1024
    s_waitcnt lgkmcnt(4)
    v_mfma_f32_16x16x32_bf16 v[20:23], v[76:79], v[152:155], v[20:23]
    ds_read_b128 v[60:63], v89 offset:256
    v_mfma_f32_16x16x32_bf16 v[24:27], v[76:79], v[156:159], v[24:27]
    ds_read_b128 v[64:67], v89 offset:16640
    v_mfma_f32_16x16x32_bf16 v[28:31], v[80:83], v[152:155], v[28:31]
    buffer_load_dwordx4 v87, s[60:63], s69 offen offset:3072 lds
    s_add_u32 s69, s69, s3
    v_mfma_f32_16x16x32_bf16 v[32:35], v[80:83], v[156:159], v[32:35]
    s_waitcnt lgkmcnt(3)
    v_mfma_f32_16x16x32_bf16 v[20:23], v[52:55], v[160:163], v[20:23]
    ds_read_b128 v[68:71], v90 offset:256
    v_mfma_f32_16x16x32_bf16 v[24:27], v[52:55], v[164:167], v[24:27]
    ds_read_b128 v[72:75], v90 offset:16640
    v_mfma_f32_16x16x32_bf16 v[28:31], v[56:59], v[160:163], v[28:31]
    v_mfma_f32_16x16x32_bf16 v[32:35], v[56:59], v[164:167], v[32:35]
    s_waitcnt lgkmcnt(2)
    v_mfma_f32_16x16x32_bf16 v[20:23], v[60:63], v[168:171], v[20:23]
    ds_read_b128 v[76:79], v91 offset:256
    v_mfma_f32_16x16x32_bf16 v[24:27], v[60:63], v[172:175], v[24:27]
    ds_read_b128 v[80:83], v91 offset:16640
    v_mfma_f32_16x16x32_bf16 v[28:31], v[64:67], v[168:171], v[28:31]
    v_mfma_f32_16x16x32_bf16 v[32:35], v[64:67], v[172:175], v[32:35]
    s_waitcnt vmcnt(8) lgkmcnt(0)
    s_barrier
    v_mfma_f32_16x16x32_bf16 v[20:23], v[68:71], v[176:179], v[20:23]
    ds_read_b128 v[4:7], v97 offset:0
    ds_read_b128 v[8:11], v97 offset:1024
    ds_read_b128 v[52:55], v88 offset:32768
    v_mfma_f32_16x16x32_bf16 v[24:27], v[68:71], v[180:183], v[24:27]
    ds_read_b128 v[56:59], v88 offset:49152
    v_mfma_f32_16x16x32_bf16 v[28:31], v[72:75], v[176:179], v[28:31]
    v_mfma_f32_16x16x32_bf16 v[32:35], v[72:75], v[180:183], v[32:35]
    s_waitcnt lgkmcnt(2)
    v_mfma_f32_16x16x32_bf16 v[20:23], v[76:79], v[184:187], v[20:23]
    v_add_f32 v4, v4, v36
    v_add_f32 v5, v5, v37
    v_add_f32 v6, v6, v38
    v_add_f32 v7, v7, v39
    ds_read_b128 v[60:63], v89 offset:32768
    v_mfma_f32_16x16x32_bf16 v[24:27], v[76:79], v[188:191], v[24:27]
    v_cvt_pk_bf16_f32 v12, v4, v5
    v_cvt_pk_bf16_f32 v13, v6, v7
    ds_read_b128 v[64:67], v89 offset:49152
    v_mfma_f32_16x16x32_bf16 v[28:31], v[80:83], v[184:187], v[28:31]
    v_add_f32 v8, v8, v44
    v_add_f32 v9, v9, v45
    v_add_f32 v10, v10, v46
    v_add_f32 v11, v11, v47
    v_mfma_f32_16x16x32_bf16 v[32:35], v[80:83], v[188:191], v[32:35]
    v_cvt_pk_bf16_f32 v14, v8, v9
    v_cvt_pk_bf16_f32 v15, v10, v11
    buffer_store_dwordx4 v[12:15], v98, s[8:11], s73 offen sc1
    s_mov_b32 s73, s81
    s_add_u32 s81, s81, s4
    s_waitcnt lgkmcnt(2)
    v_mfma_f32_16x16x32_bf16 v[20:23], v[52:55], v[192:195], v[20:23]
    ds_read_b128 v[68:71], v90 offset:32768
    v_mfma_f32_16x16x32_bf16 v[24:27], v[52:55], v[196:199], v[24:27]
    ds_read_b128 v[72:75], v90 offset:49152
    v_mfma_f32_16x16x32_bf16 v[28:31], v[56:59], v[192:195], v[28:31]
    s_add_u32 m0, s70, 0
    s_nop 0
    buffer_load_dwordx4 v84, s[60:63], s68 offen offset:0 lds
    v_mfma_f32_16x16x32_bf16 v[32:35], v[56:59], v[196:199], v[32:35]
    s_waitcnt lgkmcnt(2)
    v_mfma_f32_16x16x32_bf16 v[20:23], v[60:63], v[200:203], v[20:23]
    ds_read_b128 v[76:79], v91 offset:32768
    v_mfma_f32_16x16x32_bf16 v[24:27], v[60:63], v[204:207], v[24:27]
    ds_read_b128 v[80:83], v91 offset:49152
    v_mfma_f32_16x16x32_bf16 v[28:31], v[64:67], v[200:203], v[28:31]
    buffer_load_dwordx4 v85, s[60:63], s68 offen offset:1024 lds
    v_mfma_f32_16x16x32_bf16 v[32:35], v[64:67], v[204:207], v[32:35]
    s_waitcnt lgkmcnt(2)
    v_mfma_f32_16x16x32_bf16 v[20:23], v[68:71], v[208:211], v[20:23]
    ds_read_b128 v[52:55], v88 offset:33024
    v_mfma_f32_16x16x32_bf16 v[24:27], v[68:71], v[212:215], v[24:27]
    ds_read_b128 v[56:59], v88 offset:49408
    v_mfma_f32_16x16x32_bf16 v[28:31], v[72:75], v[208:211], v[28:31]
    buffer_load_dwordx4 v86, s[60:63], s68 offen offset:2048 lds
    v_mfma_f32_16x16x32_bf16 v[32:35], v[72:75], v[212:215], v[32:35]
    s_waitcnt lgkmcnt(2)
    v_mfma_f32_16x16x32_bf16 v[20:23], v[76:79], v[216:219], v[20:23]
    ds_read_b128 v[60:63], v89 offset:33024
    v_mfma_f32_16x16x32_bf16 v[24:27], v[76:79], v[220:223], v[24:27]
    ds_read_b128 v[64:67], v89 offset:49408
    v_mfma_f32_16x16x32_bf16 v[28:31], v[80:83], v[216:219], v[28:31]
    buffer_load_dwordx4 v87, s[60:63], s68 offen offset:3072 lds
    s_add_u32 s68, s68, s3
    v_mfma_f32_16x16x32_bf16 v[32:35], v[80:83], v[220:223], v[32:35]
    s_waitcnt lgkmcnt(2)
    v_mfma_f32_16x16x32_bf16 v[20:23], v[52:55], v[224:227], v[20:23]
    ds_read_b128 v[68:71], v90 offset:33024
    v_mfma_f32_16x16x32_bf16 v[24:27], v[52:55], v[228:231], v[24:27]
    ds_read_b128 v[72:75], v90 offset:49408
    v_mfma_f32_16x16x32_bf16 v[28:31], v[56:59], v[224:227], v[28:31]
    v_mfma_f32_16x16x32_bf16 v[32:35], v[56:59], v[228:231], v[32:35]
    s_waitcnt lgkmcnt(2)
    v_mfma_f32_16x16x32_bf16 v[20:23], v[60:63], v[232:235], v[20:23]
    ds_read_b128 v[76:79], v91 offset:33024
    v_mfma_f32_16x16x32_bf16 v[24:27], v[60:63], v[236:239], v[24:27]
    ds_read_b128 v[80:83], v91 offset:49408
    v_mfma_f32_16x16x32_bf16 v[28:31], v[64:67], v[232:235], v[28:31]
    v_mfma_f32_16x16x32_bf16 v[32:35], v[64:67], v[236:239], v[32:35]
    s_bitcmp1_b64 s[6:7], s82
    s_cbranch_scc1 ssig_55
    s_waitcnt vmcnt(8) lgkmcnt(0)
    s_barrier
srett_57:
    s_add_u32 s82, s82, 1
    v_mfma_f32_16x16x32_bf16 v[20:23], v[68:71], v[240:243], v[20:23]
    ds_read_b128 v[52:55], v92 offset:0
    v_mfma_f32_16x16x32_bf16 v[24:27], v[68:71], v[244:247], v[24:27]
    ds_read_b128 v[56:59], v92 offset:16384
    v_mfma_f32_16x16x32_bf16 v[28:31], v[72:75], v[240:243], v[28:31]
    v_mfma_f32_16x16x32_bf16 v[32:35], v[72:75], v[244:247], v[32:35]
    v_mfma_f32_16x16x32_bf16 v[20:23], v[76:79], v[248:251], v[20:23]
    ds_read_b128 v[60:63], v93 offset:0
    v_mfma_f32_16x16x32_bf16 v[24:27], v[76:79], v[252:255], v[24:27]
    ds_read_b128 v[64:67], v93 offset:16384
    v_mfma_f32_16x16x32_bf16 v[28:31], v[80:83], v[248:251], v[28:31]
    v_mfma_f32_16x16x32_bf16 v[32:35], v[80:83], v[252:255], v[32:35]
    s_waitcnt lgkmcnt(2)
    v_mfma_f32_16x16x32_bf16 v[36:39], v[52:55], v[128:131], 0
    ds_read_b128 v[68:71], v94 offset:0
    v_mfma_f32_16x16x32_bf16 v[40:43], v[52:55], v[132:135], 0
    ds_read_b128 v[72:75], v94 offset:16384
    v_mfma_f32_16x16x32_bf16 v[44:47], v[56:59], v[128:131], 0
    s_add_u32 m0, s70, 32768
    s_nop 0
    buffer_load_dwordx4 v84, s[60:63], s69 offen offset:0 lds
    v_mfma_f32_16x16x32_bf16 v[48:51], v[56:59], v[132:135], 0
    s_waitcnt lgkmcnt(2)
    v_mfma_f32_16x16x32_bf16 v[36:39], v[60:63], v[136:139], v[36:39]
    ds_read_b128 v[76:79], v95 offset:0
    v_mfma_f32_16x16x32_bf16 v[40:43], v[60:63], v[140:143], v[40:43]
    ds_read_b128 v[80:83], v95 offset:16384
    v_mfma_f32_16x16x32_bf16 v[44:47], v[64:67], v[136:139], v[44:47]
    buffer_load_dwordx4 v85, s[60:63], s69 offen offset:1024 lds
    v_mfma_f32_16x16x32_bf16 v[48:51], v[64:67], v[140:143], v[48:51]
    ds_write_b128 v96, v[24:27] offset:0
    s_waitcnt lgkmcnt(3)
    v_mfma_f32_16x16x32_bf16 v[36:39], v[68:71], v[144:147], v[36:39]
    ds_read_b128 v[52:55], v92 offset:256
    v_mfma_f32_16x16x32_bf16 v[40:43], v[68:71], v[148:151], v[40:43]
    ds_read_b128 v[56:59], v92 offset:16640
    v_mfma_f32_16x16x32_bf16 v[44:47], v[72:75], v[144:147], v[44:47]
    buffer_load_dwordx4 v86, s[60:63], s69 offen offset:2048 lds
    v_mfma_f32_16x16x32_bf16 v[48:51], v[72:75], v[148:151], v[48:51]
    ds_write_b128 v96, v[32:35] offset:1024
    s_waitcnt lgkmcnt(4)
    v_mfma_f32_16x16x32_bf16 v[36:39], v[76:79], v[152:155], v[36:39]
    ds_read_b128 v[60:63], v93 offset:256
    v_mfma_f32_16x16x32_bf16 v[40:43], v[76:79], v[156:159], v[40:43]
    ds_read_b128 v[64:67], v93 offset:16640
    v_mfma_f32_16x16x32_bf16 v[44:47], v[80:83], v[152:155], v[44:47]
    buffer_load_dwordx4 v87, s[60:63], s69 offen offset:3072 lds
    s_add_u32 s69, s69, s3
    v_mfma_f32_16x16x32_bf16 v[48:51], v[80:83], v[156:159], v[48:51]
    s_waitcnt lgkmcnt(3)
    v_mfma_f32_16x16x32_bf16 v[36:39], v[52:55], v[160:163], v[36:39]
    ds_read_b128 v[68:71], v94 offset:256
    v_mfma_f32_16x16x32_bf16 v[40:43], v[52:55], v[164:167], v[40:43]
    ds_read_b128 v[72:75], v94 offset:16640
    v_mfma_f32_16x16x32_bf16 v[44:47], v[56:59], v[160:163], v[44:47]
    v_mfma_f32_16x16x32_bf16 v[48:51], v[56:59], v[164:167], v[48:51]
    s_waitcnt lgkmcnt(2)
    v_mfma_f32_16x16x32_bf16 v[36:39], v[60:63], v[168:171], v[36:39]
    ds_read_b128 v[76:79], v95 offset:256
    v_mfma_f32_16x16x32_bf16 v[40:43], v[60:63], v[172:175], v[40:43]
    ds_read_b128 v[80:83], v95 offset:16640
    v_mfma_f32_16x16x32_bf16 v[44:47], v[64:67], v[168:171], v[44:47]
    v_mfma_f32_16x16x32_bf16 v[48:51], v[64:67], v[172:175], v[48:51]
    s_waitcnt vmcnt(8) lgkmcnt(0)
    s_barrier
    v_mfma_f32_16x16x32_bf16 v[36:39], v[68:71], v[176:179], v[36:39]
    ds_read_b128 v[4:7], v97 offset:0
    ds_read_b128 v[8:11], v97 offset:1024
    ds_read_b128 v[52:55], v92 offset:32768
    v_mfma_f32_16x16x32_bf16 v[40:43], v[68:71], v[180:183], v[40:43]
    ds_read_b128 v[56:59], v92 offset:49152
    v_mfma_f32_16x16x32_bf16 v[44:47], v[72:75], v[176:179], v[44:47]
    v_mfma_f32_16x16x32_bf16 v[48:51], v[72:75], v[180:183], v[48:51]
    s_waitcnt lgkmcnt(2)
    v_mfma_f32_16x16x32_bf16 v[36:39], v[76:79], v[184:187], v[36:39]
    v_add_f32 v4, v4, v20
    v_add_f32 v5, v5, v21
    v_add_f32 v6, v6, v22
    v_add_f32 v7, v7, v23
    ds_read_b128 v[60:63], v93 offset:32768
    v_mfma_f32_16x16x32_bf16 v[40:43], v[76:79], v[188:191], v[40:43]
    v_cvt_pk_bf16_f32 v12, v4, v5
    v_cvt_pk_bf16_f32 v13, v6, v7
    ds_read_b128 v[64:67], v93 offset:49152
    v_mfma_f32_16x16x32_bf16 v[44:47], v[80:83], v[184:187], v[44:47]
    v_add_f32 v8, v8, v28
    v_add_f32 v9, v9, v29
    v_add_f32 v10, v10, v30
    v_add_f32 v11, v11, v31
    v_mfma_f32_16x16x32_bf16 v[48:51], v[80:83], v[188:191], v[48:51]
    v_cvt_pk_bf16_f32 v14, v8, v9
    v_cvt_pk_bf16_f32 v15, v10, v11
    buffer_store_dwordx4 v[12:15], v98, s[8:11], s73 offen sc1
    s_mov_b32 s73, s81
    s_add_u32 s81, s81, s4
    s_waitcnt lgkmcnt(2)
    v_mfma_f32_16x16x32_bf16 v[36:39], v[52:55], v[192:195], v[36:39]
    ds_read_b128 v[68:71], v94 offset:32768
    v_mfma_f32_16x16x32_bf16 v[40:43], v[52:55], v[196:199], v[40:43]
    ds_read_b128 v[72:75], v94 offset:49152
    v_mfma_f32_16x16x32_bf16 v[44:47], v[56:59], v[192:195], v[44:47]
    s_add_u32 m0, s70, 65536
    s_nop 0
    buffer_load_dwordx4 v84, s[60:63], s68 offen offset:0 lds
    v_mfma_f32_16x16x32_bf16 v[48:51], v[56:59], v[196:199], v[48:51]
    s_waitcnt lgkmcnt(2)
    v_mfma_f32_16x16x32_bf16 v[36:39], v[60:63], v[200:203], v[36:39]
    ds_read_b128 v[76:79], v95 offset:32768
    v_mfma_f32_16x16x32_bf16 v[40:43], v[60:63], v[204:207], v[40:43]
    ds_read_b128 v[80:83], v95 offset:49152
    v_mfma_f32_16x16x32_bf16 v[44:47], v[64:67], v[200:203], v[44:47]
    buffer_load_dwordx4 v85, s[60:63], s68 offen offset:1024 lds
    v_mfma_f32_16x16x32_bf16 v[48:51], v[64:67], v[204:207], v[48:51]
    s_waitcnt lgkmcnt(2)
    v_mfma_f32_16x16x32_bf16 v[36:39], v[68:71], v[208:211], v[36:39]
    ds_read_b128 v[52:55], v92 offset:33024
    v_mfma_f32_16x16x32_bf16 v[40:43], v[68:71], v[212:215], v[40:43]
    ds_read_b128 v[56:59], v92 offset:49408
    v_mfma_f32_16x16x32_bf16 v[44:47], v[72:75], v[208:211], v[44:47]
    buffer_load_dwordx4 v86, s[60:63], s68 offen offset:2048 lds
    v_mfma_f32_16x16x32_bf16 v[48:51], v[72:75], v[212:215], v[48:51]
    s_waitcnt lgkmcnt(2)
    v_mfma_f32_16x16x32_bf16 v[36:39], v[76:79], v[216:219], v[36:39]
    ds_read_b128 v[60:63], v93 offset:33024
    v_mfma_f32_16x16x32_bf16 v[40:43], v[76:79], v[220:223], v[40:43]
    ds_read_b128 v[64:67], v93 offset:49408
    v_mfma_f32_16x16x32_bf16 v[44:47], v[80:83], v[216:219], v[44:47]
    buffer_load_dwordx4 v87, s[60:63], s68 offen offset:3072 lds
    s_add_u32 s68, s68, s3
    v_mfma_f32_16x16x32_bf16 v[48:51], v[80:83], v[220:223], v[48:51]
    s_waitcnt lgkmcnt(2)
    v_mfma_f32_16x16x32_bf16 v[36:39], v[52:55], v[224:227], v[36:39]
    ds_read_b128 v[68:71], v94 offset:33024
    v_mfma_f32_16x16x32_bf16 v[40:43], v[52:55], v[228:231], v[40:43]
    ds_read_b128 v[72:75], v94 offset:49408
    v_mfma_f32_16x16x32_bf16 v[44:47], v[56:59], v[224:227], v[44:47]
    v_mfma_f32_16x16x32_bf16 v[48:51], v[56:59], v[228:231], v[48:51]
    s_waitcnt lgkmcnt(2)
    v_mfma_f32_16x16x32_bf16 v[36:39], v[60:63], v[232:235], v[36:39]
    ds_read_b128 v[76:79], v95 offset:33024
    v_mfma_f32_16x16x32_bf16 v[40:43], v[60:63], v[236:239], v[40:43]
    ds_read_b128 v[80:83], v95 offset:49408
    v_mfma_f32_16x16x32_bf16 v[44:47], v[64:67], v[232:235], v[44:47]
    v_mfma_f32_16x16x32_bf16 v[48:51], v[64:67], v[236:239], v[48:51]
    s_bitcmp1_b64 s[6:7], s82
    s_cbranch_scc1 ssig_55
    s_waitcnt vmcnt(8) lgkmcnt(0)
    s_barrier
srett_63:
    s_add_u32 s82, s82, s5
    v_mfma_f32_16x16x32_bf16 v[36:39], v[68:71], v[240:243], v[36:39]
    ds_read_b128 v[52:55], v88 offset:0
    v_mfma_f32_16x16x32_bf16 v[40:43], v[68:71], v[244:247], v[40:43]
    ds_read_b128 v[56:59], v88 offset:16384
    v_mfma_f32_16x16x32_bf16 v[44:47], v[72:75], v[240:243], v[44:47]
    v_mfma_f32_16x16x32_bf16 v[48:51], v[72:75], v[244:247], v[48:51]
    v_mfma_f32_16x16x32_bf16 v[36:39], v[76:79], v[248:251], v[36:39]
    ds_read_b128 v[60:63], v89 offset:0
    v_mfma_f32_16x16x32_bf16 v[40:43], v[76:79], v[252:255], v[40:43]
    ds_read_b128 v[64:67], v89 offset:16384
    v_mfma_f32_16x16x32_bf16 v[44:47], v[80:83], v[248:251], v[44:47]
    v_mfma_f32_16x16x32_bf16 v[48:51], v[80:83], v[252:255], v[48:51]
    s_cmp_lt_u32 s82, 64
    s_cbranch_scc1 stream_76
    s_nop 2
    ds_write_b128 v96, v[40:43] offset:0
    s_nop 1
    ds_write_b128 v96, v[48:51] offset:1024
    s_waitcnt vmcnt(0) lgkmcnt(0)
    s_barrier
    ds_read_b128 v[4:7], v97 offset:0
    ds_read_b128 v[8:11], v97 offset:1024
    s_waitcnt lgkmcnt(0)
    v_add_f32 v4, v4, v36
    v_add_f32 v5, v5, v37
    v_add_f32 v6, v6, v38
    v_add_f32 v7, v7, v39
    v_cvt_pk_bf16_f32 v12, v4, v5
    v_cvt_pk_bf16_f32 v13, v6, v7
    v_add_f32 v8, v8, v44
    v_add_f32 v9, v9, v45
    v_add_f32 v10, v10, v46
    v_add_f32 v11, v11, v47
    v_cvt_pk_bf16_f32 v14, v8, v9
    v_cvt_pk_bf16_f32 v15, v10, v11
    buffer_store_dwordx4 v[12:15], v98, s[8:11], s73 offen sc1
    s_mov_b32 s73, s81
    s_add_u32 s81, s81, s4
    s_cmp_ge_u32 s57, 24
    s_cbranch_scc1 col_59
send_58:
    s_waitcnt vmcnt(0) lgkmcnt(0)
    s_barrier
    s_cmp_lg_u32 s58, 0
    s_cbranch_scc1 sig_78
    s_cmp_ge_u32 s57, 16
    s_cbranch_scc1 sig_77
    s_bfe_u32 s85, s76, 0x10003
    s_lshl_b32 s85, s85, 2
    s_bfe_u32 s79, s76, 0x30000
    s_lshl_b32 s79, s79, 7
    s_or_b32 s85, s85, s79
    s_bfe_u32 s79, s76, 0x20005
    s_lshl_b32 s79, s79, 10
    s_or_b32 s85, s85, s79
    s_add_u32 s85, s85, 0x5110000
    v_mov_b32 v4, s82
    buffer_store_dword v4, off, s[8:11], s85 sc1
sig_77:
    v_mov_b32 v5, s84
    s_mov_b64 exec, 1
    buffer_atomic_add v5, off, s[12:15], s83 sc1
    s_mov_b64 exec, -1
    s_add_u32 s83, s83, 4
sig_78:
    v_bfe_u32 v2, v1, 4, 2
    v_lshlrev_b32 v2, 2, v2
    v_xor_b32 v2, v2, v1
    v_bfe_u32 v119, v2, 0, 4
    v_lshlrev_b32 v119, 4, v119
    v_bfe_u32 v3, v2, 4, 2
    v_lshl_or_b32 v119, v3, 11, v119
    s_lshl_b32 s63, s75, 3
    s_add_u32 s63, s63, s58
    s_lshl_b32 s5, s63, 13
    s_lshl_b32 s64, s63, 18
    s_bfe_u32 s7, s57, 0x30000
    s_lshl_b32 s7, s7, 8
    s_add_u32 s64, s64, s7
    s_lshl_b32 s66, s58, 14
    s_add_u32 m0, s66, 0
    s_nop 0
    buffer_load_dwordx4 v119, s[32:35], s64 offen lds
    s_add_u32 s64, s64, 0x2000
    s_add_u32 m0, s66, 1024
    s_nop 0
    buffer_load_dwordx4 v119, s[32:35], s64 offen lds
    s_add_u32 s64, s64, 0x2000
    s_add_u32 m0, s66, 2048
    s_nop 0
    buffer_load_dwordx4 v119, s[32:35], s64 offen lds
    s_add_u32 s64, s64, 0x2000
    s_add_u32 m0, s66, 3072
    s_nop 0
    buffer_load_dwordx4 v119, s[32:35], s64 offen lds
    s_add_u32 s64, s64, 0x2000
    s_add_u32 m0, s66, 4096
    s_nop 0
    buffer_load_dwordx4 v119, s[32:35], s64 offen lds
    s_add_u32 s64, s64, 0x2000
    s_add_u32 m0, s66, 5120
    s_nop 0
    buffer_load_dwordx4 v119, s[32:35], s64 offen lds
    s_add_u32 s64, s64, 0x2000
    s_add_u32 m0, s66, 6144
    s_nop 0
    buffer_load_dwordx4 v119, s[32:35], s64 offen lds
    s_add_u32 s64, s64, 0x2000
    s_add_u32 m0, s66, 7168
    s_nop 0
    buffer_load_dwordx4 v119, s[32:35], s64 offen lds
    s_add_u32 s64, s64, 0x2000
    s_add_u32 m0, s66, 8192
    s_nop 0
    buffer_load_dwordx4 v119, s[32:35], s64 offen lds
    s_add_u32 s64, s64, 0x2000
    s_add_u32 m0, s66, 9216
    s_nop 0
    buffer_load_dwordx4 v119, s[32:35], s64 offen lds
    s_add_u32 s64, s64, 0x2000
    s_add_u32 m0, s66, 10240
    s_nop 0
    buffer_load_dwordx4 v119, s[32:35], s64 offen lds
    s_add_u32 s64, s64, 0x2000
    s_add_u32 m0, s66, 11264
    s_nop 0
    buffer_load_dwordx4 v119, s[32:35], s64 offen lds
    s_add_u32 s64, s64, 0x2000
    s_add_u32 m0, s66, 12288
    s_nop 0
    buffer_load_dwordx4 v119, s[32:35], s64 offen lds
    s_add_u32 s64, s64, 0x2000
    s_add_u32 m0, s66, 13312
    s_nop 0
    buffer_load_dwordx4 v119, s[32:35], s64 offen lds
    s_add_u32 s64, s64, 0x2000
    s_add_u32 m0, s66, 14336
    s_nop 0
    buffer_load_dwordx4 v119, s[32:35], s64 offen lds
    s_add_u32 s64, s64, 0x2000
    s_add_u32 m0, s66, 15360
    s_nop 0
    buffer_load_dwordx4 v119, s[32:35], s64 offen lds
    s_add_u32 s64, s64, 0x2000
    buffer_load_dwordx4 v[192:195], v119, s[32:35], s64 offen
    s_add_u32 s64, s64, 0x2000
    buffer_load_dwordx4 v[196:199], v119, s[32:35], s64 offen
    s_add_u32 s64, s64, 0x2000
    buffer_load_dwordx4 v[200:203], v119, s[32:35], s64 offen
    s_add_u32 s64, s64, 0x2000
    buffer_load_dwordx4 v[204:207], v119, s[32:35], s64 offen
    s_add_u32 s64, s64, 0x2000
    buffer_load_dwordx4 v[208:211], v119, s[32:35], s64 offen
    s_add_u32 s64, s64, 0x2000
    buffer_load_dwordx4 v[212:215], v119, s[32:35], s64 offen
    s_add_u32 s64, s64, 0x2000
    buffer_load_dwordx4 v[216:219], v119, s[32:35], s64 offen
    s_add_u32 s64, s64, 0x2000
    buffer_load_dwordx4 v[220:223], v119, s[32:35], s64 offen
    s_add_u32 s64, s64, 0x2000
    buffer_load_dwordx4 v[224:227], v119, s[32:35], s64 offen
    s_add_u32 s64, s64, 0x2000
    buffer_load_dwordx4 v[228:231], v119, s[32:35], s64 offen
    s_add_u32 s64, s64, 0x2000
    buffer_load_dwordx4 v[232:235], v119, s[32:35], s64 offen
    s_add_u32 s64, s64, 0x2000
    buffer_load_dwordx4 v[236:239], v119, s[32:35], s64 offen
    s_add_u32 s64, s64, 0x2000
    buffer_load_dwordx4 v[240:243], v119, s[32:35], s64 offen
    s_add_u32 s64, s64, 0x2000
    buffer_load_dwordx4 v[244:247], v119, s[32:35], s64 offen
    s_add_u32 s64, s64, 0x2000
    buffer_load_dwordx4 v[248:251], v119, s[32:35], s64 offen
    s_add_u32 s64, s64, 0x2000
    buffer_load_dwordx4 v[252:255], v119, s[32:35], s64 offen
    s_add_u32 s64, s64, 0x2000
    v_bfe_u32 v121, v1, 0, 2
    v_lshlrev_b32 v121, 4, v121
    v_bfe_u32 v3, v1, 2, 2
    v_lshl_or_b32 v121, v3, 6, v121
    v_bfe_u32 v3, v1, 2, 2
    v_lshl_or_b32 v121, v3, 8, v121
    v_bfe_u32 v3, v1, 4, 1
    v_lshl_or_b32 v121, v3, 10, v121
    v_bfe_u32 v3, v1, 5, 1
    v_lshl_or_b32 v121, v3, 12, v121
    s_bfe_u32 s63, s58, 0x20000
    s_lshl_b32 s63, s63, 6
    s_bfe_u32 s70, s58, 0x10002
    s_lshl_b32 s70, s70, 16
    s_or_b32 s63, s63, s70
    v_xor_b32 v121, s63, v121
    v_lshl_add_u32 v120, v1, 4, s66
    s_waitcnt vmcnt(16)
    s_barrier
    ds_read_b64_tr_b16 v[128:129], v121 offset:0
    ds_read_b64_tr_b16 v[130:131], v121 offset:2048
    ds_read_b64_tr_b16 v[132:133], v121 offset:8
    ds_read_b64_tr_b16 v[134:135], v121 offset:2056
    ds_read_b64_tr_b16 v[136:137], v121 offset:8192
    ds_read_b64_tr_b16 v[138:139], v121 offset:10240
    ds_read_b64_tr_b16 v[140:141], v121 offset:8200
    ds_read_b64_tr_b16 v[142:143], v121 offset:10248
    s_waitcnt lgkmcnt(4)
    ds_read_b64_tr_b16 v[144:145], v121 offset:16384
    ds_read_b64_tr_b16 v[146:147], v121 offset:18432
    ds_read_b64_tr_b16 v[148:149], v121 offset:16392
    ds_read_b64_tr_b16 v[150:151], v121 offset:18440
    ds_read_b64_tr_b16 v[152:153], v121 offset:24576
    ds_read_b64_tr_b16 v[154:155], v121 offset:26624
    ds_read_b64_tr_b16 v[156:157], v121 offset:24584
    ds_read_b64_tr_b16 v[158:159], v121 offset:26632
    s_waitcnt lgkmcnt(4)
    ds_read_b64_tr_b16 v[160:161], v121 offset:32768
    ds_read_b64_tr_b16 v[162:163], v121 offset:34816
    ds_read_b64_tr_b16 v[164:165], v121 offset:32776
    ds_read_b64_tr_b16 v[166:167], v121 offset:34824
    ds_read_b64_tr_b16 v[168:169], v121 offset:40960
    ds_read_b64_tr_b16 v[170:171], v121 offset:43008
    ds_read_b64_tr_b16 v[172:173], v121 offset:40968
    ds_read_b64_tr_b16 v[174:175], v121 offset:43016
    s_waitcnt lgkmcnt(4)
    ds_read_b64_tr_b16 v[176:177], v121 offset:49152
    ds_read_b64_tr_b16 v[178:179], v121 offset:51200
    ds_read_b64_tr_b16 v[180:181], v121 offset:49160
    ds_read_b64_tr_b16 v[182:183], v121 offset:51208
    ds_read_b64_tr_b16 v[184:185], v121 offset:57344
    ds_read_b64_tr_b16 v[186:187], v121 offset:59392
    ds_read_b64_tr_b16 v[188:189], v121 offset:57352
    ds_read_b64_tr_b16 v[190:191], v121 offset:59400
    s_waitcnt lgkmcnt(0)
    s_barrier
    s_waitcnt vmcnt(15)
    ds_write_b128 v120, v[192:195] offset:0
    s_waitcnt vmcnt(14)
    ds_write_b128 v120, v[196:199] offset:1024
    s_waitcnt vmcnt(13)
    ds_write_b128 v120, v[200:203] offset:2048
    s_waitcnt vmcnt(12)
    ds_write_b128 v120, v[204:207] offset:3072
    s_waitcnt vmcnt(11)
    ds_write_b128 v120, v[208:211] offset:4096
    s_waitcnt vmcnt(10)
    ds_write_b128 v120, v[212:215] offset:5120
    s_waitcnt vmcnt(9)
    ds_write_b128 v120, v[216:219] offset:6144
    s_waitcnt vmcnt(8)
    ds_write_b128 v120, v[220:223] offset:7168
    s_waitcnt vmcnt(7)
    ds_write_b128 v120, v[224:227] offset:8192
    s_waitcnt vmcnt(6)
    ds_write_b128 v120, v[228:231] offset:9216
    s_waitcnt vmcnt(5)
    ds_write_b128 v120, v[232:235] offset:10240
    s_waitcnt vmcnt(4)
    ds_write_b128 v120, v[236:239] offset:11264
    s_waitcnt vmcnt(3)
    ds_write_b128 v120, v[240:243] offset:12288
    s_waitcnt vmcnt(2)
    ds_write_b128 v120, v[244:247] offset:13312
    s_waitcnt vmcnt(1)
    ds_write_b128 v120, v[248:251] offset:14336
    s_waitcnt vmcnt(0)
    ds_write_b128 v120, v[252:255] offset:15360
    s_cmp_lg_u32 s58, 0
    s_cbranch_scc1 wall_79
    v_mov_b32 v3, 196
wctr_80:
    buffer_load_dword v2, v3, s[12:15], 0 offen sc1
    s_waitcnt vmcnt(0)
    v_cmp_ne_u32 vcc, 2097216, v2
    s_cbranch_vccz wctr_ok_81
    s_sub_u32 s77, s77, 1
    s_cbranch_scc0 wctr_80
    s_mov_b32 s77, 0
wctr_ok_81:
wall_79:
    s_waitcnt lgkmcnt(0)
    s_barrier
    ds_read_b64_tr_b16 v[192:193], v121 offset:0
    ds_read_b64_tr_b16 v[194:195], v121 offset:2048
    ds_read_b64_tr_b16 v[196:197], v121 offset:8
    ds_read_b64_tr_b16 v[198:199], v121 offset:2056
    ds_read_b64_tr_b16 v[200:201], v121 offset:8192
    ds_read_b64_tr_b16 v[202:203], v121 offset:10240
    ds_read_b64_tr_b16 v[204:205], v121 offset:8200
    ds_read_b64_tr_b16 v[206:207], v121 offset:10248
    s_waitcnt lgkmcnt(4)
    ds_read_b64_tr_b16 v[208:209], v121 offset:16384
    ds_read_b64_tr_b16 v[210:211], v121 offset:18432
    ds_read_b64_tr_b16 v[212:213], v121 offset:16392
    ds_read_b64_tr_b16 v[214:215], v121 offset:18440
    ds_read_b64_tr_b16 v[216:217], v121 offset:24576
    ds_read_b64_tr_b16 v[218:219], v121 offset:26624
    ds_read_b64_tr_b16 v[220:221], v121 offset:24584
    ds_read_b64_tr_b16 v[222:223], v121 offset:26632
    s_waitcnt lgkmcnt(4)
    ds_read_b64_tr_b16 v[224:225], v121 offset:32768
    ds_read_b64_tr_b16 v[226:227], v121 offset:34816
    ds_read_b64_tr_b16 v[228:229], v121 offset:32776
    ds_read_b64_tr_b16 v[230:231], v121 offset:34824
    ds_read_b64_tr_b16 v[232:233], v121 offset:40960
    ds_read_b64_tr_b16 v[234:235], v121 offset:43008
    ds_read_b64_tr_b16 v[236:237], v121 offset:40968
    ds_read_b64_tr_b16 v[238:239], v121 offset:43016
    s_waitcnt lgkmcnt(4)
    ds_read_b64_tr_b16 v[240:241], v121 offset:49152
    ds_read_b64_tr_b16 v[242:243], v121 offset:51200
    ds_read_b64_tr_b16 v[244:245], v121 offset:49160
    ds_read_b64_tr_b16 v[246:247], v121 offset:51208
    ds_read_b64_tr_b16 v[248:249], v121 offset:57344
    ds_read_b64_tr_b16 v[250:251], v121 offset:59392
    ds_read_b64_tr_b16 v[252:253], v121 offset:57352
    ds_read_b64_tr_b16 v[254:255], v121 offset:59400
    s_waitcnt lgkmcnt(0)
    s_barrier
    s_add_u32 s5, s5, 0x3000000
    s_lshl_b32 s6, s75, 7
    s_add_u32 s6, s6, 0x5100000
    s_lshl_b32 s66, s58, 12
    v_lshlrev_b32 v123, 4, v1
    s_bfe_u32 s63, s58, 0x10002
    s_lshl_b32 s63, s63, 8
    v_xor_b32 v119, s63, v123
    v_bfe_u32 v116, v1, 0, 4
    v_lshlrev_b32 v116, 4, v116
    v_bfe_u32 v2, v1, 4, 2
    v_lshl_or_b32 v116, v2, 9, v116
    v_lshl_or_b32 v116, s63, 6, v116
    v_xor_b32 v117, 0x10000, v116
    s_lshl_b32 s63, s58, 11
    s_or_b32 s63, s63, 131072
    v_add_u32 v120, s63, v123
    v_xor_b32 v121, 0x2000, v120
    v_bfe_u32 v122, v1, 4, 2
    v_lshlrev_b32 v122, 4, v122
    v_bfe_u32 v2, v1, 0, 4
    v_lshl_or_b32 v122, v2, 12, v122
    s_bfe_u32 s63, s58, 0x20000
    s_lshl_b32 s63, s63, 6
    s_bfe_u32 s70, s58, 0x10002
    s_lshl_b32 s70, s70, 16
    s_or_b32 s63, s63, s70
    s_add_u32 s7, s7, s63
    s_bfe_u32 s69, s57, 0x30000
    s_lshl_b32 s69, s69, 16
    s_bfe_u32 s63, s57, 0x20003
    s_lshl_b32 s63, s63, 21
    s_or_b32 s69, s69, s63
    s_lshl_b32 s63, s58, 13
    s_add_u32 s69, s69, s63
    s_add_u32 s69, s69, 0x6000000
    s_lshl_b32 s63, s75, 11
    s_add_u32 s69, s69, s63
    s_xor_b32 s2, s69, 2048
    s_xor_b32 s3, s69, 4096
    s_xor_b32 s4, s69, 6144
    s_lshr_b32 s63, s58, 1
    s_xor_b32 s74, s63, s75
    s_mov_b32 s60, 0x92492490
    s_mov_b32 s61, 0x24924924
    s_cmp_lt_u32 s57, 16
    s_cselect_b32 s63, 5, 0
    s_or_b32 s60, s60, s63
    s_lshr_b32 s63, s57, 3
    s_lshl_b64 s[60:61], s[60:61], s63
    v_bfe_u32 v125, v1, 0, 3
    v_lshlrev_b32 v125, 2, v125
    v_lshl_or_b32 v125, s58, 28, v125
    v_mov_b32 v127, 163744
    s_mov_b32 s70, 0
    v_mov_b32 v124, v123
    v_mov_b32 v96, 0x3f80
    v_mov_b32 v97, 0x3f800000
    s_ff1_i32_b64 s62, s[60:61]
    s_bitset0_b64 s[60:61], s62
    s_lshl_b32 s65, s62, 9
    s_add_u32 s65, s65, s6
    s_mov_b32 s59, -1
    s_mov_b32 s73, -1
    s_mov_b32 s67, 0x5ffffff0
wo_slow_82:
    s_lshl_b32 s63, s58, 2
    s_add_u32 s65, s65, s63
pollfl_87:
    buffer_load_dword v118, off, s[8:11], s65 sc1
    s_waitcnt vmcnt(0)
    v_cmp_eq_u32 vcc, 0, v118
    s_cbranch_vccz pollfl_ok_88
    s_sub_u32 s77, s77, 1
    s_cbranch_scc0 pollfl_87
    s_mov_b32 s77, 0
pollfl_ok_88:
    s_mov_b32 s72, s62
    s_lshl_b32 s64, s62, 18
    s_add_u32 s64, s64, s5
    s_ff1_i32_b64 s62, s[60:61]
    s_bitset0_b64 s[60:61], s62
    s_lshl_b32 s65, s62, 9
    s_add_u32 s65, s65, s6
    s_add_u32 m0, s66, 0
    s_nop 0
    buffer_load_dwordx4 v119, s[8:11], s64 offen offset:0 lds
    buffer_load_dwordx4 v119, s[8:11], s64 offen offset:1024 lds
    buffer_load_dwordx4 v119, s[8:11], s64 offen offset:2048 lds
    buffer_load_dwordx4 v119, s[8:11], s64 offen offset:3072 lds
    s_add_u32 s64, s64, 4096
    buffer_load_dword v118, v125, s[8:11], s65 offen sc1
    s_add_u32 m0, s66, 32768
    s_nop 0
    buffer_load_dwordx4 v119, s[8:11], s64 offen offset:0 lds
    buffer_load_dwordx4 v119, s[8:11], s64 offen offset:1024 lds
    buffer_load_dwordx4 v119, s[8:11], s64 offen offset:2048 lds
    buffer_load_dwordx4 v119, s[8:11], s64 offen offset:3072 lds
    s_add_u32 s64, s64, 4096
    s_mov_b32 s63, 0x5ffffff0
    buffer_load_dword v3, off, s[8:11], s63
    s_waitcnt vmcnt(5)
    s_cmp_lg_u32 s58, 0
    s_cbranch_scc1 wo_v_89
    v_cmp_eq_u32 vcc, 0, v118
    s_nop 1
    v_mov_b32 v126, vcc_lo
    ds_write_b32 v127, v126
wo_v_89:
    s_waitcnt lgkmcnt(0)
    s_barrier
    ds_read_b32 v126, v127
    ds_read_b128 v[44:47], v116 offset:0
    ds_read_b128 v[48:51], v116 offset:256
    ds_read_b128 v[52:55], v116 offset:2048
    ds_read_b128 v[56:59], v116 offset:2304
    s_cmp_eq_u32 s74, 0
    s_cbranch_scc0 wo_o_90
    s_setprio 2
wo_o_90:
wo_loop_83:
    s_waitcnt lgkmcnt(2)
    v_mfma_f32_16x16x32_bf16 v[12:15], v[128:131], v[44:47], 0
    ds_read_b128 v[60:63], v116 offset:4096
    v_mfma_f32_16x16x32_bf16 v[16:19], v[132:135], v[44:47], 0
    ds_read_b128 v[64:67], v116 offset:4352
    v_readfirstlane_b32 s68, v126
    s_mov_b32 s73, s59
    s_mov_b32 s59, s72
    s_mov_b32 s64, 0x5ffffff0
    s_lshr_b32 s63, s62, 31
    s_or_b32 s68, s68, s63
    s_cbranch_scc1 wo_np_91
    s_mov_b32 s72, s62
    s_lshl_b32 s64, s62, 18
    s_add_u32 s64, s64, s5
    s_ff1_i32_b64 s62, s[60:61]
    s_bitset0_b64 s[60:61], s62
    s_lshl_b32 s65, s62, 9
    s_add_u32 s65, s65, s6
wo_np_91:
    v_mfma_f32_16x16x32_bf16 v[20:23], v[128:131], v[48:51], 0
    v_mfma_f32_16x16x32_bf16 v[24:27], v[132:135], v[48:51], 0
    s_waitcnt lgkmcnt(2)
    v_mfma_f32_16x16x32_bf16 v[12:15], v[136:139], v[52:55], v[12:15]
    ds_read_b128 v[68:71], v116 offset:6144
    v_mfma_f32_16x16x32_bf16 v[16:19], v[140:143], v[52:55], v[16:19]
    ds_read_b128 v[72:75], v116 offset:6400
    v_mfma_f32_16x16x32_bf16 v[20:23], v[136:139], v[56:59], v[20:23]
    v_mfma_f32_16x16x32_bf16 v[24:27], v[140:143], v[56:59], v[24:27]
    ds_write_b128 v120, v[36:39] offset:0
    buffer_load_dword v118, v125, s[8:11], s65 offen sc1
    s_waitcnt lgkmcnt(3)
    v_mfma_f32_16x16x32_bf16 v[12:15], v[144:147], v[60:63], v[12:15]
    ds_read_b128 v[44:47], v116 offset:8192
    v_mfma_f32_16x16x32_bf16 v[16:19], v[148:151], v[60:63], v[16:19]
    ds_read_b128 v[48:51], v116 offset:8448
    v_mfma_f32_16x16x32_bf16 v[20:23], v[144:147], v[64:67], v[20:23]
    s_add_u32 m0, s66, 65536
    s_nop 0
    buffer_load_dwordx4 v119, s[8:11], s64 offen offset:0 lds
    v_mfma_f32_16x16x32_bf16 v[24:27], v[148:151], v[64:67], v[24:27]
    ds_write_b128 v120, v[40:43] offset:1024
    s_waitcnt lgkmcnt(4)
    v_mfma_f32_16x16x32_bf16 v[12:15], v[152:155], v[68:71], v[12:15]
    ds_read_b128 v[52:55], v116 offset:10240
    v_mfma_f32_16x16x32_bf16 v[16:19], v[156:159], v[68:71], v[16:19]
    ds_read_b128 v[56:59], v116 offset:10496
    v_mfma_f32_16x16x32_bf16 v[20:23], v[152:155], v[72:75], v[20:23]
    buffer_load_dwordx4 v119, s[8:11], s64 offen offset:1024 lds
    v_mfma_f32_16x16x32_bf16 v[24:27], v[156:159], v[72:75], v[24:27]
    s_cmp_eq_u32 s74, 0
    s_cbranch_scc0 wo_o_92
    buffer_load_dwordx4 v[92:95], v124, s[8:11], s2 offen offset:0 sc1
wo_o_92:
    s_waitcnt lgkmcnt(3)
    v_mfma_f32_16x16x32_bf16 v[12:15], v[160:163], v[44:47], v[12:15]
    ds_read_b128 v[60:63], v116 offset:12288
    v_mfma_f32_16x16x32_bf16 v[16:19], v[164:167], v[44:47], v[16:19]
    ds_read_b128 v[64:67], v116 offset:12544
    v_mfma_f32_16x16x32_bf16 v[20:23], v[160:163], v[48:51], v[20:23]
    buffer_load_dwordx4 v119, s[8:11], s64 offen offset:2048 lds
    v_mfma_f32_16x16x32_bf16 v[24:27], v[164:167], v[48:51], v[24:27]
    s_cmp_eq_u32 s74, 0
    s_cbranch_scc0 wo_o_93
    buffer_load_dwordx4 v[100:103], v124, s[8:11], s3 offen offset:0 sc1
wo_o_93:
    s_waitcnt lgkmcnt(2)
    v_mfma_f32_16x16x32_bf16 v[12:15], v[168:171], v[52:55], v[12:15]
    ds_read_b128 v[68:71], v116 offset:14336
    v_mfma_f32_16x16x32_bf16 v[16:19], v[172:175], v[52:55], v[16:19]
    ds_read_b128 v[72:75], v116 offset:14592
    v_mfma_f32_16x16x32_bf16 v[20:23], v[168:171], v[56:59], v[20:23]
    buffer_load_dwordx4 v119, s[8:11], s64 offen offset:3072 lds
    s_add_u32 s64, s64, 4096
    v_mfma_f32_16x16x32_bf16 v[24:27], v[172:175], v[56:59], v[24:27]
    s_cmp_eq_u32 s74, 0
    s_cbranch_scc0 wo_o_94
    buffer_load_dwordx4 v[108:111], v124, s[8:11], s4 offen offset:0 sc1
wo_o_94:
    s_cmp_eq_u32 s74, 0
    s_cbranch_scc1 wo_w_95
    s_waitcnt vmcnt(5)
wo_w_95:
    s_waitcnt vmcnt(9)
    s_waitcnt lgkmcnt(0)
    s_barrier
    v_mfma_f32_16x16x32_bf16 v[12:15], v[176:179], v[60:63], v[12:15]
    ds_read_b128 v[4:7], v121 offset:0
    ds_read_b128 v[8:11], v121 offset:1024
    ds_read_b128 v[44:47], v116 offset:32768
    v_mfma_f32_16x16x32_bf16 v[16:19], v[180:183], v[60:63], v[16:19]
    ds_read_b128 v[48:51], v116 offset:33024
    v_mfma_f32_16x16x32_bf16 v[20:23], v[176:179], v[64:67], v[20:23]
    v_mfma_f32_16x16x32_bf16 v[24:27], v[180:183], v[64:67], v[24:27]
    s_waitcnt lgkmcnt(2)
    v_mfma_f32_16x16x32_bf16 v[12:15], v[184:187], v[68:71], v[12:15]
    ds_read_b128 v[52:55], v116 offset:34816
    v_mfma_f32_16x16x32_bf16 v[16:19], v[188:191], v[68:71], v[16:19]
    ds_read_b128 v[56:59], v116 offset:35072
    v_mfma_f32_16x16x32_bf16 v[20:23], v[184:187], v[72:75], v[20:23]
    v_mfma_f32_16x16x32_bf16 v[24:27], v[188:191], v[72:75], v[24:27]
    v_pk_add_f32 v[84:85], v[4:5], v[28:29]
    v_pk_add_f32 v[86:87], v[6:7], v[30:31]
    v_pk_add_f32 v[88:89], v[8:9], v[32:33]
    v_pk_add_f32 v[90:91], v[10:11], v[34:35]
    s_cmp_eq_u32 s74, 0
    s_cbranch_scc1 wo_e_96
    s_bfe_u32 s71, s70, 0x10002
    s_cmp_lt_i32 s73, 0
    s_cselect_b32 s63, 0x5ffffff0, s69
    v_cvt_pk_bf16_f32 v84, v84, v85
    v_cvt_pk_bf16_f32 v85, v86, v87
    v_cvt_pk_bf16_f32 v86, v88, v89
    v_cvt_pk_bf16_f32 v87, v90, v91
    v_bfi_b32 v84, 1, s71, v84
    buffer_store_dwordx4 v[84:87], v123, s[8:11], s63 offen offset:0 sc1
wo_e_96:
    s_waitcnt lgkmcnt(2)
    v_mfma_f32_16x16x32_bf16 v[12:15], v[192:195], v[44:47], v[12:15]
    ds_read_b128 v[60:63], v116 offset:36864
    v_mfma_f32_16x16x32_bf16 v[16:19], v[196:199], v[44:47], v[16:19]
    ds_read_b128 v[64:67], v116 offset:37120
    v_mfma_f32_16x16x32_bf16 v[20:23], v[192:195], v[48:51], v[20:23]
    v_mfma_f32_16x16x32_bf16 v[24:27], v[196:199], v[48:51], v[24:27]
    s_waitcnt lgkmcnt(2)
    v_mfma_f32_16x16x32_bf16 v[12:15], v[200:203], v[52:55], v[12:15]
    ds_read_b128 v[68:71], v116 offset:38912
    v_mfma_f32_16x16x32_bf16 v[16:19], v[204:207], v[52:55], v[16:19]
    ds_read_b128 v[72:75], v116 offset:39168
    v_mfma_f32_16x16x32_bf16 v[20:23], v[200:203], v[56:59], v[20:23]
    v_mfma_f32_16x16x32_bf16 v[24:27], v[204:207], v[56:59], v[24:27]
    s_cmp_lg_u32 s58, 0
    s_cbranch_scc1 wo_a_97
    s_waitcnt vmcnt(5)
    v_cmp_eq_u32 vcc, 0, v118
    s_cbranch_vccz wo_a_97
    buffer_load_dword v118, v125, s[8:11], s65 offen sc1
wo_a_97:
    s_waitcnt lgkmcnt(2)
    v_mfma_f32_16x16x32_bf16 v[12:15], v[208:211], v[60:63], v[12:15]
    ds_read_b128 v[44:47], v116 offset:40960
    v_mfma_f32_16x16x32_bf16 v[16:19], v[212:215], v[60:63], v[16:19]
    ds_read_b128 v[48:51], v116 offset:41216
    v_mfma_f32_16x16x32_bf16 v[20:23], v[208:211], v[64:67], v[20:23]
    s_add_u32 m0, s66, 98304
    s_nop 0
    buffer_load_dwordx4 v119, s[8:11], s64 offen offset:0 lds
    v_mfma_f32_16x16x32_bf16 v[24:27], v[212:215], v[64:67], v[24:27]
    s_waitcnt lgkmcnt(2)
    v_mfma_f32_16x16x32_bf16 v[12:15], v[216:219], v[68:71], v[12:15]
    ds_read_b128 v[52:55], v116 offset:43008
    v_mfma_f32_16x16x32_bf16 v[16:19], v[220:223], v[68:71], v[16:19]
    ds_read_b128 v[56:59], v116 offset:43264
    v_mfma_f32_16x16x32_bf16 v[20:23], v[216:219], v[72:75], v[20:23]
    buffer_load_dwordx4 v119, s[8:11], s64 offen offset:1024 lds
    v_mfma_f32_16x16x32_bf16 v[24:27], v[220:223], v[72:75], v[24:27]
    s_waitcnt lgkmcnt(2)
    v_mfma_f32_16x16x32_bf16 v[12:15], v[224:227], v[44:47], v[12:15]
    ds_read_b128 v[60:63], v116 offset:45056
    v_mfma_f32_16x16x32_bf16 v[16:19], v[228:231], v[44:47], v[16:19]
    ds_read_b128 v[64:67], v116 offset:45312
    v_mfma_f32_16x16x32_bf16 v[20:23], v[224:227], v[48:51], v[20:23]
    buffer_load_dwordx4 v119, s[8:11], s64 offen offset:2048 lds
    v_mfma_f32_16x16x32_bf16 v[24:27], v[228:231], v[48:51], v[24:27]
    s_cmp_lg_u32 s58, 0
    s_cbranch_scc1 wo_v_98
    s_cbranch_vccz wo_b_99
    s_waitcnt vmcnt(3)
wo_b_99:
    v_cmp_eq_u32 vcc, 0, v118
    s_nop 1
    v_mov_b32 v126, vcc_lo
    ds_write_b32 v127, v126
wo_v_98:
    s_waitcnt lgkmcnt(2)
    v_mfma_f32_16x16x32_bf16 v[12:15], v[232:235], v[52:55], v[12:15]
    ds_read_b128 v[68:71], v116 offset:47104
    v_mfma_f32_16x16x32_bf16 v[16:19], v[236:239], v[52:55], v[16:19]
    ds_read_b128 v[72:75], v116 offset:47360
    v_mfma_f32_16x16x32_bf16 v[20:23], v[232:235], v[56:59], v[20:23]
    buffer_load_dwordx4 v119, s[8:11], s64 offen offset:3072 lds
    s_add_u32 s64, s64, 4096
    v_mfma_f32_16x16x32_bf16 v[24:27], v[236:239], v[56:59], v[24:27]
    s_cmp_eq_u32 s74, 0
    s_cbranch_scc1 wo_w_100
    s_waitcnt vmcnt(5)
wo_w_100:
    s_waitcnt vmcnt(5)
    s_waitcnt lgkmcnt(0)
    s_barrier
    v_mfma_f32_16x16x32_bf16 v[12:15], v[240:243], v[60:63], v[12:15]
    ds_read_b32 v126, v127
    ds_read_b128 v[44:47], v117 offset:0
    v_mfma_f32_16x16x32_bf16 v[16:19], v[244:247], v[60:63], v[16:19]
    ds_read_b128 v[48:51], v117 offset:256
    v_mfma_f32_16x16x32_bf16 v[20:23], v[240:243], v[64:67], v[20:23]
    v_mfma_f32_16x16x32_bf16 v[24:27], v[244:247], v[64:67], v[24:27]
    v_mfma_f32_16x16x32_bf16 v[12:15], v[248:251], v[68:71], v[12:15]
    ds_read_b128 v[52:55], v117 offset:2048
    v_mfma_f32_16x16x32_bf16 v[16:19], v[252:255], v[68:71], v[16:19]
    ds_read_b128 v[56:59], v117 offset:2304
    v_mfma_f32_16x16x32_bf16 v[20:23], v[248:251], v[72:75], v[20:23]
    v_mfma_f32_16x16x32_bf16 v[24:27], v[252:255], v[72:75], v[24:27]
    s_cmp_lg_u32 s74, 0
    s_cbranch_scc1 wo_k_101
    s_cmp_eq_u32 s67, 0x5ffffff0
    s_cbranch_scc1 wo_s_103
    s_waitcnt vmcnt(4)
    v_bitop3_b32 v2, v92, v100, s71 bitop3:0x7e
    v_xor_b32 v3, s71, v108
    v_bitop3_b32 v2, v2, v3, 1 bitop3:0xa8
    v_cmp_ne_u32 vcc, 0, v2
    s_cbranch_vccz pollpart_ok_105
pollpart_104:
    buffer_load_dwordx4 v[92:95], v124, s[8:11], s2 offen offset:0 sc1
    buffer_load_dwordx4 v[100:103], v124, s[8:11], s3 offen offset:0 sc1
    buffer_load_dwordx4 v[108:111], v124, s[8:11], s4 offen offset:0 sc1
    s_waitcnt vmcnt(0)
    v_bitop3_b32 v2, v92, v100, s71 bitop3:0x7e
    v_xor_b32 v3, s71, v108
    v_bitop3_b32 v2, v2, v3, 1 bitop3:0xa8
    v_cmp_ne_u32 vcc, 0, v2
    s_cbranch_vccz pollpart_ok_105
    s_sub_u32 s77, s77, 1
    s_cbranch_scc0 pollpart_104
    s_mov_b32 s77, 0
pollpart_ok_105:
    v_dot2_f32_bf16 v76, v92, v96, v76
    v_dot2_f32_bf16 v77, v92, v97, v77
    v_dot2_f32_bf16 v78, v93, v96, v78
    v_dot2_f32_bf16 v79, v93, v97, v79
    v_dot2_f32_bf16 v80, v94, v96, v80
    v_dot2_f32_bf16 v81, v94, v97, v81
    v_dot2_f32_bf16 v82, v95, v96, v82
    v_dot2_f32_bf16 v83, v95, v97, v83
    v_dot2_f32_bf16 v76, v100, v96, v76
    v_dot2_f32_bf16 v77, v100, v97, v77
    v_dot2_f32_bf16 v78, v101, v96, v78
    v_dot2_f32_bf16 v79, v101, v97, v79
    v_dot2_f32_bf16 v80, v102, v96, v80
    v_dot2_f32_bf16 v81, v102, v97, v81
    v_dot2_f32_bf16 v82, v103, v96, v82
    v_dot2_f32_bf16 v83, v103, v97, v83
    v_dot2_f32_bf16 v76, v108, v96, v76
    v_dot2_f32_bf16 v77, v108, v97, v77
    v_dot2_f32_bf16 v78, v109, v96, v78
    v_dot2_f32_bf16 v79, v109, v97, v79
    v_dot2_f32_bf16 v80, v110, v96, v80
    v_dot2_f32_bf16 v81, v110, v97, v81
    v_dot2_f32_bf16 v82, v111, v96, v82
    v_dot2_f32_bf16 v83, v111, v97, v83
    v_cvt_pk_bf16_f32 v92, v76, v77
    v_cvt_pk_bf16_f32 v93, v78, v79
    v_cvt_pk_bf16_f32 v94, v80, v81
    v_cvt_pk_bf16_f32 v95, v82, v83
wo_s_103:
    buffer_store_dwordx4 v[92:95], v122, s[16:19], s67 offen offset:2048
wo_k_101:
    s_cmp_lt_i32 s73, 0
    s_cbranch_scc1 wo_e_102
    s_bfe_u32 s71, s70, 0x10002
    s_add_u32 s70, s70, 1
    v_pk_mov_b32 v[76:77], v[84:85], v[84:85] op_sel:[0,1]
    v_pk_mov_b32 v[78:79], v[86:87], v[86:87] op_sel:[0,1]
    v_pk_mov_b32 v[80:81], v[88:89], v[88:89] op_sel:[0,1]
    v_pk_mov_b32 v[82:83], v[90:91], v[90:91] op_sel:[0,1]
    v_mov_b32 v124, v123
    s_lshl_b32 s67, s73, 17
    s_add_u32 s67, s67, s7
    v_add_u32 v123, 0x80000, v123
    v_and_b32 v123, 0x1fffff, v123
wo_e_102:
    s_cmp_eq_u32 s68, 0
    s_cbranch_scc0 wo_fl_84
wo_out_86:
    s_waitcnt lgkmcnt(2)
    v_mfma_f32_16x16x32_bf16 v[28:31], v[128:131], v[44:47], 0
    ds_read_b128 v[60:63], v117 offset:4096
    v_mfma_f32_16x16x32_bf16 v[32:35], v[132:135], v[44:47], 0
    ds_read_b128 v[64:67], v117 offset:4352
    v_readfirstlane_b32 s68, v126
    s_mov_b32 s73, s59
    s_mov_b32 s59, s72
    s_mov_b32 s64, 0x5ffffff0
    s_lshr_b32 s63, s62, 31
    s_or_b32 s68, s68, s63
    s_cbranch_scc1 wo_np_106
    s_mov_b32 s72, s62
    s_lshl_b32 s64, s62, 18
    s_add_u32 s64, s64, s5
    s_ff1_i32_b64 s62, s[60:61]
    s_bitset0_b64 s[60:61], s62
    s_lshl_b32 s65, s62, 9
    s_add_u32 s65, s65, s6
wo_np_106:
    v_mfma_f32_16x16x32_bf16 v[36:39], v[128:131], v[48:51], 0
    v_mfma_f32_16x16x32_bf16 v[40:43], v[132:135], v[48:51], 0
    s_waitcnt lgkmcnt(2)
    v_mfma_f32_16x16x32_bf16 v[28:31], v[136:139], v[52:55], v[28:31]
    ds_read_b128 v[68:71], v117 offset:6144
    v_mfma_f32_16x16x32_bf16 v[32:35], v[140:143], v[52:55], v[32:35]
    ds_read_b128 v[72:75], v117 offset:6400
    v_mfma_f32_16x16x32_bf16 v[36:39], v[136:139], v[56:59], v[36:39]
    v_mfma_f32_16x16x32_bf16 v[40:43], v[140:143], v[56:59], v[40:43]
    ds_write_b128 v120, v[20:23] offset:0
    buffer_load_dword v118, v125, s[8:11], s65 offen sc1
    s_waitcnt lgkmcnt(3)
    v_mfma_f32_16x16x32_bf16 v[28:31], v[144:147], v[60:63], v[28:31]
    ds_read_b128 v[44:47], v117 offset:8192
    v_mfma_f32_16x16x32_bf16 v[32:35], v[148:151], v[60:63], v[32:35]
    ds_read_b128 v[48:51], v117 offset:8448
    v_mfma_f32_16x16x32_bf16 v[36:39], v[144:147], v[64:67], v[36:39]
    s_add_u32 m0, s66, 0
    s_nop 0
    buffer_load_dwordx4 v119, s[8:11], s64 offen offset:0 lds
    v_mfma_f32_16x16x32_bf16 v[40:43], v[148:151], v[64:67], v[40:43]
    ds_write_b128 v120, v[24:27] offset:1024
    s_waitcnt lgkmcnt(4)
    v_mfma_f32_16x16x32_bf16 v[28:31], v[152:155], v[68:71], v[28:31]
    ds_read_b128 v[52:55], v117 offset:10240
    v_mfma_f32_16x16x32_bf16 v[32:35], v[156:159], v[68:71], v[32:35]
    ds_read_b128 v[56:59], v117 offset:10496
    v_mfma_f32_16x16x32_bf16 v[36:39], v[152:155], v[72:75], v[36:39]
    buffer_load_dwordx4 v119, s[8:11], s64 offen offset:1024 lds
    v_mfma_f32_16x16x32_bf16 v[40:43], v[156:159], v[72:75], v[40:43]
    s_cmp_eq_u32 s74, 0
    s_cbranch_scc0 wo_o_107
    buffer_load_dwordx4 v[92:95], v124, s[8:11], s2 offen offset:0 sc1
wo_o_107:
    s_waitcnt lgkmcnt(3)
    v_mfma_f32_16x16x32_bf16 v[28:31], v[160:163], v[44:47], v[28:31]
    ds_read_b128 v[60:63], v117 offset:12288
    v_mfma_f32_16x16x32_bf16 v[32:35], v[164:167], v[44:47], v[32:35]
    ds_read_b128 v[64:67], v117 offset:12544
    v_mfma_f32_16x16x32_bf16 v[36:39], v[160:163], v[48:51], v[36:39]
    buffer_load_dwordx4 v119, s[8:11], s64 offen offset:2048 lds
    v_mfma_f32_16x16x32_bf16 v[40:43], v[164:167], v[48:51], v[40:43]
    s_cmp_eq_u32 s74, 0
    s_cbranch_scc0 wo_o_108
    buffer_load_dwordx4 v[100:103], v124, s[8:11], s3 offen offset:0 sc1
wo_o_108:
    s_waitcnt lgkmcnt(2)
    v_mfma_f32_16x16x32_bf16 v[28:31], v[168:171], v[52:55], v[28:31]
    ds_read_b128 v[68:71], v117 offset:14336
    v_mfma_f32_16x16x32_bf16 v[32:35], v[172:175], v[52:55], v[32:35]
    ds_read_b128 v[72:75], v117 offset:14592
    v_mfma_f32_16x16x32_bf16 v[36:39], v[168:171], v[56:59], v[36:39]
    buffer_load_dwordx4 v119, s[8:11], s64 offen offset:3072 lds
    s_add_u32 s64, s64, 4096
    v_mfma_f32_16x16x32_bf16 v[40:43], v[172:175], v[56:59], v[40:43]
    s_cmp_eq_u32 s74, 0
    s_cbranch_scc0 wo_o_109
    buffer_load_dwordx4 v[108:111], v124, s[8:11], s4 offen offset:0 sc1
wo_o_109:
    s_cmp_eq_u32 s74, 0
    s_cbranch_scc1 wo_w_110
    s_waitcnt vmcnt(5)
wo_w_110:
    s_waitcnt vmcnt(9)
    s_waitcnt lgkmcnt(0)
    s_barrier
    v_mfma_f32_16x16x32_bf16 v[28:31], v[176:179], v[60:63], v[28:31]
    ds_read_b128 v[4:7], v121 offset:0
    ds_read_b128 v[8:11], v121 offset:1024
    ds_read_b128 v[44:47], v117 offset:32768
    v_mfma_f32_16x16x32_bf16 v[32:35], v[180:183], v[60:63], v[32:35]
    ds_read_b128 v[48:51], v117 offset:33024
    v_mfma_f32_16x16x32_bf16 v[36:39], v[176:179], v[64:67], v[36:39]
    v_mfma_f32_16x16x32_bf16 v[40:43], v[180:183], v[64:67], v[40:43]
    s_waitcnt lgkmcnt(2)
    v_mfma_f32_16x16x32_bf16 v[28:31], v[184:187], v[68:71], v[28:31]
    ds_read_b128 v[52:55], v117 offset:34816
    v_mfma_f32_16x16x32_bf16 v[32:35], v[188:191], v[68:71], v[32:35]
    ds_read_b128 v[56:59], v117 offset:35072
    v_mfma_f32_16x16x32_bf16 v[36:39], v[184:187], v[72:75], v[36:39]
    v_mfma_f32_16x16x32_bf16 v[40:43], v[188:191], v[72:75], v[40:43]
    v_pk_add_f32 v[84:85], v[4:5], v[12:13]
    v_pk_add_f32 v[86:87], v[6:7], v[14:15]
    v_pk_add_f32 v[88:89], v[8:9], v[16:17]
    v_pk_add_f32 v[90:91], v[10:11], v[18:19]
    s_cmp_eq_u32 s74, 0
    s_cbranch_scc1 wo_e_111
    s_bfe_u32 s71, s70, 0x10002
    s_cmp_lt_i32 s73, 0
    s_cselect_b32 s63, 0x5ffffff0, s69
    v_cvt_pk_bf16_f32 v84, v84, v85
    v_cvt_pk_bf16_f32 v85, v86, v87
    v_cvt_pk_bf16_f32 v86, v88, v89
    v_cvt_pk_bf16_f32 v87, v90, v91
    v_bfi_b32 v84, 1, s71, v84
    buffer_store_dwordx4 v[84:87], v123, s[8:11], s63 offen offset:0 sc1
wo_e_111:
    s_waitcnt lgkmcnt(2)
    v_mfma_f32_16x16x32_bf16 v[28:31], v[192:195], v[44:47], v[28:31]
    ds_read_b128 v[60:63], v117 offset:36864
    v_mfma_f32_16x16x32_bf16 v[32:35], v[196:199], v[44:47], v[32:35]
    ds_read_b128 v[64:67], v117 offset:37120
    v_mfma_f32_16x16x32_bf16 v[36:39], v[192:195], v[48:51], v[36:39]
    v_mfma_f32_16x16x32_bf16 v[40:43], v[196:199], v[48:51], v[40:43]
    s_waitcnt lgkmcnt(2)
    v_mfma_f32_16x16x32_bf16 v[28:31], v[200:203], v[52:55], v[28:31]
    ds_read_b128 v[68:71], v117 offset:38912
    v_mfma_f32_16x16x32_bf16 v[32:35], v[204:207], v[52:55], v[32:35]
    ds_read_b128 v[72:75], v117 offset:39168
    v_mfma_f32_16x16x32_bf16 v[36:39], v[200:203], v[56:59], v[36:39]
    v_mfma_f32_16x16x32_bf16 v[40:43], v[204:207], v[56:59], v[40:43]
    s_cmp_lg_u32 s58, 0
    s_cbranch_scc1 wo_a_112
    s_waitcnt vmcnt(5)
    v_cmp_eq_u32 vcc, 0, v118
    s_cbranch_vccz wo_a_112
    buffer_load_dword v118, v125, s[8:11], s65 offen sc1
wo_a_112:
    s_waitcnt lgkmcnt(2)
    v_mfma_f32_16x16x32_bf16 v[28:31], v[208:211], v[60:63], v[28:31]
    ds_read_b128 v[44:47], v117 offset:40960
    v_mfma_f32_16x16x32_bf16 v[32:35], v[212:215], v[60:63], v[32:35]
    ds_read_b128 v[48:51], v117 offset:41216
    v_mfma_f32_16x16x32_bf16 v[36:39], v[208:211], v[64:67], v[36:39]
    s_add_u32 m0, s66, 32768
    s_nop 0
    buffer_load_dwordx4 v119, s[8:11], s64 offen offset:0 lds
    v_mfma_f32_16x16x32_bf16 v[40:43], v[212:215], v[64:67], v[40:43]
    s_waitcnt lgkmcnt(2)
    v_mfma_f32_16x16x32_bf16 v[28:31], v[216:219], v[68:71], v[28:31]
    ds_read_b128 v[52:55], v117 offset:43008
    v_mfma_f32_16x16x32_bf16 v[32:35], v[220:223], v[68:71], v[32:35]
    ds_read_b128 v[56:59], v117 offset:43264
    v_mfma_f32_16x16x32_bf16 v[36:39], v[216:219], v[72:75], v[36:39]
    buffer_load_dwordx4 v119, s[8:11], s64 offen offset:1024 lds
    v_mfma_f32_16x16x32_bf16 v[40:43], v[220:223], v[72:75], v[40:43]
    s_waitcnt lgkmcnt(2)
    v_mfma_f32_16x16x32_bf16 v[28:31], v[224:227], v[44:47], v[28:31]
    ds_read_b128 v[60:63], v117 offset:45056
    v_mfma_f32_16x16x32_bf16 v[32:35], v[228:231], v[44:47], v[32:35]
    ds_read_b128 v[64:67], v117 offset:45312
    v_mfma_f32_16x16x32_bf16 v[36:39], v[224:227], v[48:51], v[36:39]
    buffer_load_dwordx4 v119, s[8:11], s64 offen offset:2048 lds
    v_mfma_f32_16x16x32_bf16 v[40:43], v[228:231], v[48:51], v[40:43]
    s_cmp_lg_u32 s58, 0
    s_cbranch_scc1 wo_v_113
    s_cbranch_vccz wo_b_114
    s_waitcnt vmcnt(3)
wo_b_114:
    v_cmp_eq_u32 vcc, 0, v118
    s_nop 1
    v_mov_b32 v126, vcc_lo
    ds_write_b32 v127, v126
wo_v_113:
    s_waitcnt lgkmcnt(2)
    v_mfma_f32_16x16x32_bf16 v[28:31], v[232:235], v[52:55], v[28:31]
    ds_read_b128 v[68:71], v117 offset:47104
    v_mfma_f32_16x16x32_bf16 v[32:35], v[236:239], v[52:55], v[32:35]
    ds_read_b128 v[72:75], v117 offset:47360
    v_mfma_f32_16x16x32_bf16 v[36:39], v[232:235], v[56:59], v[36:39]
    buffer_load_dwordx4 v119, s[8:11], s64 offen offset:3072 lds
    s_add_u32 s64, s64, 4096
    v_mfma_f32_16x16x32_bf16 v[40:43], v[236:239], v[56:59], v[40:43]
    s_cmp_eq_u32 s74, 0
    s_cbranch_scc1 wo_w_115
    s_waitcnt vmcnt(5)
wo_w_115:
    s_waitcnt vmcnt(5)
    s_waitcnt lgkmcnt(0)
    s_barrier
    v_mfma_f32_16x16x32_bf16 v[28:31], v[240:243], v[60:63], v[28:31]
    ds_read_b32 v126, v127
    ds_read_b128 v[44:47], v116 offset:0
    v_mfma_f32_16x16x32_bf16 v[32:35], v[244:247], v[60:63], v[32:35]
    ds_read_b128 v[48:51], v116 offset:256
    v_mfma_f32_16x16x32_bf16 v[36:39], v[240:243], v[64:67], v[36:39]
    v_mfma_f32_16x16x32_bf16 v[40:43], v[244:247], v[64:67], v[40:43]
    v_mfma_f32_16x16x32_bf16 v[28:31], v[248:251], v[68:71], v[28:31]
    ds_read_b128 v[52:55], v116 offset:2048
    v_mfma_f32_16x16x32_bf16 v[32:35], v[252:255], v[68:71], v[32:35]
    ds_read_b128 v[56:59], v116 offset:2304
    v_mfma_f32_16x16x32_bf16 v[36:39], v[248:251], v[72:75], v[36:39]
    v_mfma_f32_16x16x32_bf16 v[40:43], v[252:255], v[72:75], v[40:43]
    s_cmp_lg_u32 s74, 0
    s_cbranch_scc1 wo_k_116
    s_cmp_eq_u32 s67, 0x5ffffff0
    s_cbranch_scc1 wo_s_118
    s_waitcnt vmcnt(4)
    v_bitop3_b32 v2, v92, v100, s71 bitop3:0x7e
    v_xor_b32 v3, s71, v108
    v_bitop3_b32 v2, v2, v3, 1 bitop3:0xa8
    v_cmp_ne_u32 vcc, 0, v2
    s_cbranch_vccz pollpart_ok_120
pollpart_119:
    buffer_load_dwordx4 v[92:95], v124, s[8:11], s2 offen offset:0 sc1
    buffer_load_dwordx4 v[100:103], v124, s[8:11], s3 offen offset:0 sc1
    buffer_load_dwordx4 v[108:111], v124, s[8:11], s4 offen offset:0 sc1
    s_waitcnt vmcnt(0)
    v_bitop3_b32 v2, v92, v100, s71 bitop3:0x7e
    v_xor_b32 v3, s71, v108
    v_bitop3_b32 v2, v2, v3, 1 bitop3:0xa8
    v_cmp_ne_u32 vcc, 0, v2
    s_cbranch_vccz pollpart_ok_120
    s_sub_u32 s77, s77, 1
    s_cbranch_scc0 pollpart_119
    s_mov_b32 s77, 0
pollpart_ok_120:
    v_dot2_f32_bf16 v76, v92, v96, v76
    v_dot2_f32_bf16 v77, v92, v97, v77
    v_dot2_f32_bf16 v78, v93, v96, v78
    v_dot2_f32_bf16 v79, v93, v97, v79
    v_dot2_f32_bf16 v80, v94, v96, v80
    v_dot2_f32_bf16 v81, v94, v97, v81
    v_dot2_f32_bf16 v82, v95, v96, v82
    v_dot2_f32_bf16 v83, v95, v97, v83
    v_dot2_f32_bf16 v76, v100, v96, v76
    v_dot2_f32_bf16 v77, v100, v97, v77
    v_dot2_f32_bf16 v78, v101, v96, v78
    v_dot2_f32_bf16 v79, v101, v97, v79
    v_dot2_f32_bf16 v80, v102, v96, v80
    v_dot2_f32_bf16 v81, v102, v97, v81
    v_dot2_f32_bf16 v82, v103, v96, v82
    v_dot2_f32_bf16 v83, v103, v97, v83
    v_dot2_f32_bf16 v76, v108, v96, v76
    v_dot2_f32_bf16 v77, v108, v97, v77
    v_dot2_f32_bf16 v78, v109, v96, v78
    v_dot2_f32_bf16 v79, v109, v97, v79
    v_dot2_f32_bf16 v80, v110, v96, v80
    v_dot2_f32_bf16 v81, v110, v97, v81
    v_dot2_f32_bf16 v82, v111, v96, v82
    v_dot2_f32_bf16 v83, v111, v97, v83
    v_cvt_pk_bf16_f32 v92, v76, v77
    v_cvt_pk_bf16_f32 v93, v78, v79
    v_cvt_pk_bf16_f32 v94, v80, v81
    v_cvt_pk_bf16_f32 v95, v82, v83
wo_s_118:
    buffer_store_dwordx4 v[92:95], v122, s[16:19], s67 offen offset:2048
wo_k_116:
    s_cmp_lt_i32 s73, 0
    s_cbranch_scc1 wo_e_117
    s_bfe_u32 s71, s70, 0x10002
    s_add_u32 s70, s70, 1
    v_pk_mov_b32 v[76:77], v[84:85], v[84:85] op_sel:[0,1]
    v_pk_mov_b32 v[78:79], v[86:87], v[86:87] op_sel:[0,1]
    v_pk_mov_b32 v[80:81], v[88:89], v[88:89] op_sel:[0,1]
    v_pk_mov_b32 v[82:83], v[90:91], v[90:91] op_sel:[0,1]
    v_mov_b32 v124, v123
    s_lshl_b32 s67, s73, 17
    s_add_u32 s67, s67, s7
    v_add_u32 v123, 0x80000, v123
    v_and_b32 v123, 0x1fffff, v123
wo_e_117:
    s_cmp_eq_u32 s68, 0
    s_cbranch_scc1 wo_loop_83
    s_cmp_ge_i32 s62, 0
    s_cbranch_scc1 wo_slow_82
wo_f0_85:
    ds_write_b128 v120, v[36:39] offset:0
    ds_write_b128 v120, v[40:43] offset:1024
    s_mov_b32 s73, s59
    s_cmp_eq_u32 s74, 0
    s_cbranch_scc0 wo_o_121
    buffer_load_dwordx4 v[92:95], v124, s[8:11], s2 offen offset:0 sc1
    buffer_load_dwordx4 v[100:103], v124, s[8:11], s3 offen offset:0 sc1
    buffer_load_dwordx4 v[108:111], v124, s[8:11], s4 offen offset:0 sc1
wo_o_121:
    s_waitcnt lgkmcnt(0)
    s_barrier
    ds_read_b128 v[4:7], v121 offset:0
    ds_read_b128 v[8:11], v121 offset:1024
    s_waitcnt lgkmcnt(0)
    v_pk_add_f32 v[84:85], v[4:5], v[28:29]
    v_pk_add_f32 v[86:87], v[6:7], v[30:31]
    v_pk_add_f32 v[88:89], v[8:9], v[32:33]
    v_pk_add_f32 v[90:91], v[10:11], v[34:35]
    s_cmp_eq_u32 s74, 0
    s_cbranch_scc1 wo_e_122
    s_bfe_u32 s71, s70, 0x10002
    s_cmp_lt_i32 s73, 0
    s_cselect_b32 s63, 0x5ffffff0, s69
    v_cvt_pk_bf16_f32 v84, v84, v85
    v_cvt_pk_bf16_f32 v85, v86, v87
    v_cvt_pk_bf16_f32 v86, v88, v89
    v_cvt_pk_bf16_f32 v87, v90, v91
    v_bfi_b32 v84, 1, s71, v84
    buffer_store_dwordx4 v[84:87], v123, s[8:11], s63 offen offset:0 sc1
wo_e_122:
    s_cmp_lg_u32 s74, 0
    s_cbranch_scc1 wo_k_123
    s_cmp_eq_u32 s67, 0x5ffffff0
    s_cbranch_scc1 wo_s_125
    s_waitcnt vmcnt(0)
    v_bitop3_b32 v2, v92, v100, s71 bitop3:0x7e
    v_xor_b32 v3, s71, v108
    v_bitop3_b32 v2, v2, v3, 1 bitop3:0xa8
    v_cmp_ne_u32 vcc, 0, v2
    s_cbranch_vccz pollpart_ok_127
pollpart_126:
    buffer_load_dwordx4 v[92:95], v124, s[8:11], s2 offen offset:0 sc1
    buffer_load_dwordx4 v[100:103], v124, s[8:11], s3 offen offset:0 sc1
    buffer_load_dwordx4 v[108:111], v124, s[8:11], s4 offen offset:0 sc1
    s_waitcnt vmcnt(0)
    v_bitop3_b32 v2, v92, v100, s71 bitop3:0x7e
    v_xor_b32 v3, s71, v108
    v_bitop3_b32 v2, v2, v3, 1 bitop3:0xa8
    v_cmp_ne_u32 vcc, 0, v2
    s_cbranch_vccz pollpart_ok_127
    s_sub_u32 s77, s77, 1
    s_cbranch_scc0 pollpart_126
    s_mov_b32 s77, 0
pollpart_ok_127:
    v_dot2_f32_bf16 v76, v92, v96, v76
    v_dot2_f32_bf16 v77, v92, v97, v77
    v_dot2_f32_bf16 v78, v93, v96, v78
    v_dot2_f32_bf16 v79, v93, v97, v79
    v_dot2_f32_bf16 v80, v94, v96, v80
    v_dot2_f32_bf16 v81, v94, v97, v81
    v_dot2_f32_bf16 v82, v95, v96, v82
    v_dot2_f32_bf16 v83, v95, v97, v83
    v_dot2_f32_bf16 v76, v100, v96, v76
    v_dot2_f32_bf16 v77, v100, v97, v77
    v_dot2_f32_bf16 v78, v101, v96, v78
    v_dot2_f32_bf16 v79, v101, v97, v79
    v_dot2_f32_bf16 v80, v102, v96, v80
    v_dot2_f32_bf16 v81, v102, v97, v81
    v_dot2_f32_bf16 v82, v103, v96, v82
    v_dot2_f32_bf16 v83, v103, v97, v83
    v_dot2_f32_bf16 v76, v108, v96, v76
    v_dot2_f32_bf16 v77, v108, v97, v77
    v_dot2_f32_bf16 v78, v109, v96, v78
    v_dot2_f32_bf16 v79, v109, v97, v79
    v_dot2_f32_bf16 v80, v110, v96, v80
    v_dot2_f32_bf16 v81, v110, v97, v81
    v_dot2_f32_bf16 v82, v111, v96, v82
    v_dot2_f32_bf16 v83, v111, v97, v83
    v_cvt_pk_bf16_f32 v92, v76, v77
    v_cvt_pk_bf16_f32 v93, v78, v79
    v_cvt_pk_bf16_f32 v94, v80, v81
    v_cvt_pk_bf16_f32 v95, v82, v83
wo_s_125:
    buffer_store_dwordx4 v[92:95], v122, s[16:19], s67 offen offset:2048
wo_k_123:
    s_cmp_lt_i32 s73, 0
    s_cbranch_scc1 wo_e_124
    s_bfe_u32 s71, s70, 0x10002
    s_add_u32 s70, s70, 1
    v_pk_mov_b32 v[76:77], v[84:85], v[84:85] op_sel:[0,1]
    v_pk_mov_b32 v[78:79], v[86:87], v[86:87] op_sel:[0,1]
    v_pk_mov_b32 v[80:81], v[88:89], v[88:89] op_sel:[0,1]
    v_pk_mov_b32 v[82:83], v[90:91], v[90:91] op_sel:[0,1]
    v_mov_b32 v124, v123
    s_lshl_b32 s67, s73, 17
    s_add_u32 s67, s67, s7
    v_add_u32 v123, 0x80000, v123
    v_and_b32 v123, 0x1fffff, v123
wo_e_124:
    s_cmp_eq_u32 s74, 0
    s_cbranch_scc0 wo_o_128
pollpart_129:
    buffer_load_dwordx4 v[92:95], v124, s[8:11], s2 offen offset:0 sc1
    buffer_load_dwordx4 v[100:103], v124, s[8:11], s3 offen offset:0 sc1
    buffer_load_dwordx4 v[108:111], v124, s[8:11], s4 offen offset:0 sc1
    s_waitcnt vmcnt(0)
    v_bitop3_b32 v2, v92, v100, s71 bitop3:0x7e
    v_xor_b32 v3, s71, v108
    v_bitop3_b32 v2, v2, v3, 1 bitop3:0xa8
    v_cmp_ne_u32 vcc, 0, v2
    s_cbranch_vccz pollpart_ok_130
    s_sub_u32 s77, s77, 1
    s_cbranch_scc0 pollpart_129
    s_mov_b32 s77, 0
pollpart_ok_130:
    v_dot2_f32_bf16 v76, v92, v96, v76
    v_dot2_f32_bf16 v77, v92, v97, v77
    v_dot2_f32_bf16 v78, v93, v96, v78
    v_dot2_f32_bf16 v79, v93, v97, v79
    v_dot2_f32_bf16 v80, v94, v96, v80
    v_dot2_f32_bf16 v81, v94, v97, v81
    v_dot2_f32_bf16 v82, v95, v96, v82
    v_dot2_f32_bf16 v83, v95, v97, v83
    v_dot2_f32_bf16 v76, v100, v96, v76
    v_dot2_f32_bf16 v77, v100, v97, v77
    v_dot2_f32_bf16 v78, v101, v96, v78
    v_dot2_f32_bf16 v79, v101, v97, v79
    v_dot2_f32_bf16 v80, v102, v96, v80
    v_dot2_f32_bf16 v81, v102, v97, v81
    v_dot2_f32_bf16 v82, v103, v96, v82
    v_dot2_f32_bf16 v83, v103, v97, v83
    v_dot2_f32_bf16 v76, v108, v96, v76
    v_dot2_f32_bf16 v77, v108, v97, v77
    v_dot2_f32_bf16 v78, v109, v96, v78
    v_dot2_f32_bf16 v79, v109, v97, v79
    v_dot2_f32_bf16 v80, v110, v96, v80
    v_dot2_f32_bf16 v81, v110, v97, v81
    v_dot2_f32_bf16 v82, v111, v96, v82
    v_dot2_f32_bf16 v83, v111, v97, v83
    v_cvt_pk_bf16_f32 v92, v76, v77
    v_cvt_pk_bf16_f32 v93, v78, v79
    v_cvt_pk_bf16_f32 v94, v80, v81
    v_cvt_pk_bf16_f32 v95, v82, v83
    buffer_store_dwordx4 v[92:95], v122, s[16:19], s67 offen offset:2048
wo_o_128:
    s_branch end_61
wo_fl_84:
    s_cmp_lt_i32 s62, 0
    s_cbranch_scc1 wo_m_131
    s_lshl_b32 s63, s58, 2
    s_add_u32 s65, s65, s63
pollfl_132:
    buffer_load_dword v118, off, s[8:11], s65 sc1
    s_waitcnt vmcnt(0)
    v_cmp_eq_u32 vcc, 0, v118
    s_cbranch_vccz pollfl_ok_133
    s_sub_u32 s77, s77, 1
    s_cbranch_scc0 pollfl_132
    s_mov_b32 s77, 0
pollfl_ok_133:
    s_mov_b32 s72, s62
    s_lshl_b32 s64, s62, 18
    s_add_u32 s64, s64, s5
    s_ff1_i32_b64 s62, s[60:61]
    s_bitset0_b64 s[60:61], s62
    s_lshl_b32 s65, s62, 9
    s_add_u32 s65, s65, s6
    s_add_u32 m0, s66, 65536
    s_nop 0
    buffer_load_dwordx4 v119, s[8:11], s64 offen offset:0 lds
    buffer_load_dwordx4 v119, s[8:11], s64 offen offset:1024 lds
    buffer_load_dwordx4 v119, s[8:11], s64 offen offset:2048 lds
    buffer_load_dwordx4 v119, s[8:11], s64 offen offset:3072 lds
    s_add_u32 s64, s64, 4096
    buffer_load_dword v118, v125, s[8:11], s65 offen sc1
    s_add_u32 m0, s66, 98304
    s_nop 0
    buffer_load_dwordx4 v119, s[8:11], s64 offen offset:0 lds
    buffer_load_dwordx4 v119, s[8:11], s64 offen offset:1024 lds
    buffer_load_dwordx4 v119, s[8:11], s64 offen offset:2048 lds
    buffer_load_dwordx4 v119, s[8:11], s64 offen offset:3072 lds
    s_add_u32 s64, s64, 4096
    s_mov_b32 s63, 0x5ffffff0
    buffer_load_dword v3, off, s[8:11], s63
    s_waitcnt vmcnt(5)
    s_cmp_lg_u32 s58, 0
    s_cbranch_scc1 wo_v_134
    v_cmp_eq_u32 vcc, 0, v118
    s_nop 1
    v_mov_b32 v126, vcc_lo
    ds_write_b32 v127, v126
wo_v_134:
    s_waitcnt lgkmcnt(0)
    s_barrier
    ds_read_b32 v126, v127
    ds_read_b128 v[44:47], v117 offset:0
    ds_read_b128 v[48:51], v117 offset:256
    ds_read_b128 v[52:55], v117 offset:2048
    ds_read_b128 v[56:59], v117 offset:2304
    s_branch wo_out_86
wo_m_131:
    s_nop 7
    v_mov_b32 v28, v12
    v_mov_b32 v29, v13
    v_mov_b32 v30, v14
    v_mov_b32 v31, v15
    v_mov_b32 v32, v16
    v_mov_b32 v33, v17
    v_mov_b32 v34, v18
    v_mov_b32 v35, v19
    v_mov_b32 v36, v20
    v_mov_b32 v37, v21
    v_mov_b32 v38, v22
    v_mov_b32 v39, v23
    v_mov_b32 v40, v24
    v_mov_b32 v41, v25
    v_mov_b32 v42, v26
    v_mov_b32 v43, v27
    s_branch wo_f0_85
fft_52:
    s_mov_b64 s[60:61], s[44:45]
    s_mov_b32 s62, 0x400000
    s_mov_b32 s63, 0x20000
    s_mov_b32 s81, 0x5400000
    s_mov_b32 s83, 48
    s_mov_b32 s6, 0x10000
    s_mov_b32 s7, 0
    s_branch gen_60
col_59:
    s_waitcnt vmcnt(0) lgkmcnt(0)
    s_barrier
    s_cmp_lg_u32 s58, 0
    s_cbranch_scc1 sig_135
    v_mov_b32 v75, 0x5ffffff0
    v_mov_b32 v76, 40
    v_cmp_eq_u32 vcc, 0, v1
    s_nop 1
    v_cndmask_b32 v76, v75, v76, vcc
    v_mov_b32 v75, 1
    buffer_atomic_add v75, v76, s[12:15], 0 offen sc1
sig_135:
    s_bfe_u32 s79, s76, 0x30000
    s_bfe_u32 s85, s76, 0x20005
    s_lshl_b32 s85, s85, 3
    s_or_b32 s79, s79, s85
    v_bfe_u32 v231, v1, 0, 5
    v_bfe_u32 v235, v1, 5, 1
    v_lshl_or_b32 v231, v235, 7, v231
    v_mul_u32_u24 v231, 1026, v231
    v_and_b32 v231, -4, v231
    s_mul_i32 s5, s58, 262656
    s_lshl_b32 s2, s79, 5
    s_add_u32 s5, s5, s2
    buffer_load_dwordx4 v[84:87], v231, s[48:51], s5 offen
    buffer_load_dwordx4 v[88:91], v231, s[48:51], s5 offen offset:16
    buffer_load_dword v92, v231, s[48:51], s5 offen offset:32
    buffer_load_dwordx4 v[94:97], v231, s[52:55], s5 offen
    buffer_load_dwordx4 v[98:101], v231, s[52:55], s5 offen offset:16
    buffer_load_dword v102, v231, s[52:55], s5 offen offset:32
    s_add_u32 s5, s5, 32832
    buffer_load_dwordx4 v[104:107], v231, s[48:51], s5 offen
    buffer_load_dwordx4 v[108:111], v231, s[48:51], s5 offen offset:16
    buffer_load_dword v112, v231, s[48:51], s5 offen offset:32
    buffer_load_dwordx4 v[114:117], v231, s[52:55], s5 offen
    buffer_load_dwordx4 v[118:121], v231, s[52:55], s5 offen offset:16
    buffer_load_dword v122, v231, s[52:55], s5 offen offset:32
    s_add_u32 s5, s5, 32832
    buffer_load_dwordx4 v[124:127], v231, s[48:51], s5 offen
    buffer_load_dwordx4 v[128:131], v231, s[48:51], s5 offen offset:16
    buffer_load_dword v132, v231, s[48:51], s5 offen offset:32
    buffer_load_dwordx4 v[134:137], v231, s[52:55], s5 offen
    buffer_load_dwordx4 v[138:141], v231, s[52:55], s5 offen offset:16
    buffer_load_dword v142, v231, s[52:55], s5 offen offset:32
    s_add_u32 s5, s5, 32832
    buffer_load_dwordx4 v[144:147], v231, s[48:51], s5 offen
    buffer_load_dwordx4 v[148:151], v231, s[48:51], s5 offen offset:16
    buffer_load_dword v152, v231, s[48:51], s5 offen offset:32
    buffer_load_dwordx4 v[154:157], v231, s[52:55], s5 offen
    buffer_load_dwordx4 v[158:161], v231, s[52:55], s5 offen offset:16
    buffer_load_dword v162, v231, s[52:55], s5 offen offset:32
    s_add_u32 s5, s5, 32832
    v_and_b32 v235, 31, v1
    v_cvt_f32_u32 v228, v235
    v_and_b32 v235, 32, v1
    v_cvt_f32_u32 v235, v235
    v_mul_f32 v229, v228, v235
    v_mul_f32 v229, 0x3b000000, v229
    v_mul_f32 v234, 0x3d000000, v229
    v_fmamk_f32 v230, v235, 0x3b000000, v234
    v_and_b32 v233, 1, v1
    v_lshlrev_b32 v232, 4, v233
    v_mul_u32_u24 v233, 0x8000, v233
    v_lshl_or_b32 v233, v233, 16, v233
    v_fmamk_f32 v243, v228, 0x0, v229
    v_add_f32 v244, v243, v243
    v_cos_f32 v235, v243
    v_sin_f32 v237, v243
    v_cos_f32 v239, v244
    v_sin_f32 v241, v244
    v_fmamk_f32 v243, v228, 0x3c800000, v229
    v_add_f32 v244, v243, v243
    v_cos_f32 v236, v243
    v_sin_f32 v238, v243
    v_cos_f32 v240, v244
    v_sin_f32 v242, v244
    v_cvt_pk_bf16_f32 v4, v235, v236
    v_cvt_pk_bf16_f32 v36, v237, v238
    v_cvt_pk_bf16_f32 v68, v239, v240
    v_cvt_pk_bf16_f32 v76, v241, v242
    v_fmamk_f32 v243, v228, 0x3d000000, v229
    v_add_f32 v244, v243, v243
    v_cos_f32 v235, v243
    v_sin_f32 v237, v243
    v_cos_f32 v239, v244
    v_sin_f32 v241, v244
    v_fmamk_f32 v243, v228, 0x3d400000, v229
    v_add_f32 v244, v243, v243
    v_cos_f32 v236, v243
    v_sin_f32 v238, v243
    v_cos_f32 v240, v244
    v_sin_f32 v242, v244
    v_cvt_pk_bf16_f32 v5, v235, v236
    v_cvt_pk_bf16_f32 v37, v237, v238
    v_cvt_pk_bf16_f32 v69, v239, v240
    v_cvt_pk_bf16_f32 v77, v241, v242
    v_fmamk_f32 v243, v228, 0x3e000000, v229
    v_add_f32 v244, v243, v243
    v_cos_f32 v235, v243
    v_sin_f32 v237, v243
    v_cos_f32 v239, v244
    v_sin_f32 v241, v244
    v_fmamk_f32 v243, v228, 0x3e100000, v229
    v_add_f32 v244, v243, v243
    v_cos_f32 v236, v243
    v_sin_f32 v238, v243
    v_cos_f32 v240, v244
    v_sin_f32 v242, v244
    v_cvt_pk_bf16_f32 v6, v235, v236
    v_cvt_pk_bf16_f32 v38, v237, v238
    v_cvt_pk_bf16_f32 v70, v239, v240
    v_cvt_pk_bf16_f32 v78, v241, v242
    v_fmamk_f32 v243, v228, 0x3e200000, v229
    v_add_f32 v244, v243, v243
    v_cos_f32 v235, v243
    v_sin_f32 v237, v243
    v_cos_f32 v239, v244
    v_sin_f32 v241, v244
    v_fmamk_f32 v243, v228, 0x3e300000, v229
    v_add_f32 v244, v243, v243
    v_cos_f32 v236, v243
    v_sin_f32 v238, v243
    v_cos_f32 v240, v244
    v_sin_f32 v242, v244
    v_cvt_pk_bf16_f32 v7, v235, v236
    v_cvt_pk_bf16_f32 v39, v237, v238
    v_cvt_pk_bf16_f32 v71, v239, v240
    v_cvt_pk_bf16_f32 v79, v241, v242
    v_fmamk_f32 v243, v228, 0x3e800000, v229
    v_add_f32 v244, v243, v243
    v_cos_f32 v235, v243
    v_sin_f32 v237, v243
    v_cos_f32 v239, v244
    v_sin_f32 v241, v244
    v_fmamk_f32 v243, v228, 0x3e880000, v229
    v_add_f32 v244, v243, v243
    v_cos_f32 v236, v243
    v_sin_f32 v238, v243
    v_cos_f32 v240, v244
    v_sin_f32 v242, v244
    v_cvt_pk_bf16_f32 v8, v235, v236
    v_cvt_pk_bf16_f32 v40, v237, v238
    v_cvt_pk_bf16_f32 v72, v239, v240
    v_cvt_pk_bf16_f32 v80, v241, v242
    v_fmamk_f32 v243, v228, 0x3e900000, v229
    v_add_f32 v244, v243, v243
    v_cos_f32 v235, v243
    v_sin_f32 v237, v243
    v_cos_f32 v239, v244
    v_sin_f32 v241, v244
    v_fmamk_f32 v243, v228, 0x3e980000, v229
    v_add_f32 v244, v243, v243
    v_cos_f32 v236, v243
    v_sin_f32 v238, v243
    v_cos_f32 v240, v244
    v_sin_f32 v242, v244
    v_cvt_pk_bf16_f32 v9, v235, v236
    v_cvt_pk_bf16_f32 v41, v237, v238
    v_cvt_pk_bf16_f32 v73, v239, v240
    v_cvt_pk_bf16_f32 v81, v241, v242
    v_fmamk_f32 v243, v228, 0x3ec00000, v229
    v_add_f32 v244, v243, v243
    v_cos_f32 v235, v243
    v_sin_f32 v237, v243
    v_cos_f32 v239, v244
    v_sin_f32 v241, v244
    v_fmamk_f32 v243, v228, 0x3ec80000, v229
    v_add_f32 v244, v243, v243
    v_cos_f32 v236, v243
    v_sin_f32 v238, v243
    v_cos_f32 v240, v244
    v_sin_f32 v242, v244
    v_cvt_pk_bf16_f32 v10, v235, v236
    v_cvt_pk_bf16_f32 v42, v237, v238
    v_cvt_pk_bf16_f32 v74, v239, v240
    v_cvt_pk_bf16_f32 v82, v241, v242
    v_fmamk_f32 v243, v228, 0x3ed00000, v229
    v_add_f32 v244, v243, v243
    v_cos_f32 v235, v243
    v_sin_f32 v237, v243
    v_cos_f32 v239, v244
    v_sin_f32 v241, v244
    v_fmamk_f32 v243, v228, 0x3ed80000, v229
    v_add_f32 v244, v243, v243
    v_cos_f32 v236, v243
    v_sin_f32 v238, v243
    v_cos_f32 v240, v244
    v_sin_f32 v242, v244
    v_cvt_pk_bf16_f32 v11, v235, v236
    v_cvt_pk_bf16_f32 v43, v237, v238
    v_cvt_pk_bf16_f32 v75, v239, v240
    v_cvt_pk_bf16_f32 v83, v241, v242
    v_xor_b32 v12, v233, v4
    v_xor_b32 v13, v233, v5
    v_xor_b32 v14, v233, v6
    v_xor_b32 v15, v233, v7
    v_xor_b32 v16, v233, v8
    v_xor_b32 v17, v233, v9
    v_xor_b32 v18, v233, v10
    v_xor_b32 v19, v233, v11
    v_xor_b32 v20, 0x80000000, v4
    v_xor_b32 v21, 0x80000000, v5
    v_xor_b32 v22, 0x80000000, v6
    v_xor_b32 v23, 0x80000000, v7
    v_xor_b32 v24, 0x80000000, v8
    v_xor_b32 v25, 0x80000000, v9
    v_xor_b32 v26, 0x80000000, v10
    v_xor_b32 v27, 0x80000000, v11
    v_xor_b32 v28, 0x80000000, v12
    v_xor_b32 v29, 0x80000000, v13
    v_xor_b32 v30, 0x80000000, v14
    v_xor_b32 v31, 0x80000000, v15
    v_xor_b32 v32, 0x80000000, v16
    v_xor_b32 v33, 0x80000000, v17
    v_xor_b32 v34, 0x80000000, v18
    v_xor_b32 v35, 0x80000000, v19
    v_xor_b32 v44, v233, v36
    v_xor_b32 v45, v233, v37
    v_xor_b32 v46, v233, v38
    v_xor_b32 v47, v233, v39
    v_xor_b32 v48, v233, v40
    v_xor_b32 v49, v233, v41
    v_xor_b32 v50, v233, v42
    v_xor_b32 v51, v233, v43
    v_xor_b32 v52, 0x80000000, v36
    v_xor_b32 v53, 0x80000000, v37
    v_xor_b32 v54, 0x80000000, v38
    v_xor_b32 v55, 0x80000000, v39
    v_xor_b32 v56, 0x80000000, v40
    v_xor_b32 v57, 0x80000000, v41
    v_xor_b32 v58, 0x80000000, v42
    v_xor_b32 v59, 0x80000000, v43
    v_xor_b32 v60, 0x80000000, v44
    v_xor_b32 v61, 0x80000000, v45
    v_xor_b32 v62, 0x80000000, v46
    v_xor_b32 v63, 0x80000000, v47
    v_xor_b32 v64, 0x80000000, v48
    v_xor_b32 v65, 0x80000000, v49
    v_xor_b32 v66, 0x80000000, v50
    v_xor_b32 v67, 0x80000000, v51
    s_mov_b32 s2, 0x05040100
    s_mov_b32 s3, 0x07060302
    s_lshl_b32 s5, s58, 10
    v_lshl_add_u32 v231, v1, 4, s5
    v_add_u32 v233, 0x10000, v231
    v_add_u32 v235, 0x20000, v231
    s_waitcnt vmcnt(0)
    v_alignbit_b32 v84, v85, v84, v232
    v_alignbit_b32 v94, v95, v94, v232
    v_alignbit_b32 v104, v105, v104, v232
    v_alignbit_b32 v114, v115, v114, v232
    v_alignbit_b32 v124, v125, v124, v232
    v_alignbit_b32 v134, v135, v134, v232
    v_alignbit_b32 v144, v145, v144, v232
    v_alignbit_b32 v154, v155, v154, v232
    v_perm_b32 v196, v94, v84, s2
    v_perm_b32 v197, v114, v104, s2
    v_perm_b32 v198, v134, v124, s2
    v_perm_b32 v199, v154, v144, s2
    ds_write_b128 v231, v[196:199] offset:0
    v_perm_b32 v200, v94, v84, s3
    v_perm_b32 v201, v114, v104, s3
    v_perm_b32 v202, v134, v124, s3
    v_perm_b32 v203, v154, v144, s3
    ds_write_b128 v231, v[200:203] offset:8192
    v_alignbit_b32 v85, v86, v85, v232
    v_alignbit_b32 v95, v96, v95, v232
    v_alignbit_b32 v105, v106, v105, v232
    v_alignbit_b32 v115, v116, v115, v232
    v_alignbit_b32 v125, v126, v125, v232
    v_alignbit_b32 v135, v136, v135, v232
    v_alignbit_b32 v145, v146, v145, v232
    v_alignbit_b32 v155, v156, v155, v232
    v_perm_b32 v204, v95, v85, s2
    v_perm_b32 v205, v115, v105, s2
    v_perm_b32 v206, v135, v125, s2
    v_perm_b32 v207, v155, v145, s2
    ds_write_b128 v231, v[204:207] offset:16384
    v_perm_b32 v208, v95, v85, s3
    v_perm_b32 v209, v115, v105, s3
    v_perm_b32 v210, v135, v125, s3
    v_perm_b32 v211, v155, v145, s3
    ds_write_b128 v231, v[208:211] offset:24576
    v_alignbit_b32 v86, v87, v86, v232
    v_alignbit_b32 v96, v97, v96, v232
    v_alignbit_b32 v106, v107, v106, v232
    v_alignbit_b32 v116, v117, v116, v232
    v_alignbit_b32 v126, v127, v126, v232
    v_alignbit_b32 v136, v137, v136, v232
    v_alignbit_b32 v146, v147, v146, v232
    v_alignbit_b32 v156, v157, v156, v232
    v_perm_b32 v212, v96, v86, s2
    v_perm_b32 v213, v116, v106, s2
    v_perm_b32 v214, v136, v126, s2
    v_perm_b32 v215, v156, v146, s2
    ds_write_b128 v231, v[212:215] offset:32768
    v_perm_b32 v216, v96, v86, s3
    v_perm_b32 v217, v116, v106, s3
    v_perm_b32 v218, v136, v126, s3
    v_perm_b32 v219, v156, v146, s3
    ds_write_b128 v231, v[216:219] offset:40960
    v_alignbit_b32 v87, v88, v87, v232
    v_alignbit_b32 v97, v98, v97, v232
    v_alignbit_b32 v107, v108, v107, v232
    v_alignbit_b32 v117, v118, v117, v232
    v_alignbit_b32 v127, v128, v127, v232
    v_alignbit_b32 v137, v138, v137, v232
    v_alignbit_b32 v147, v148, v147, v232
    v_alignbit_b32 v157, v158, v157, v232
    v_perm_b32 v220, v97, v87, s2
    v_perm_b32 v221, v117, v107, s2
    v_perm_b32 v222, v137, v127, s2
    v_perm_b32 v223, v157, v147, s2
    ds_write_b128 v231, v[220:223] offset:49152
    v_perm_b32 v224, v97, v87, s3
    v_perm_b32 v225, v117, v107, s3
    v_perm_b32 v226, v137, v127, s3
    v_perm_b32 v227, v157, v147, s3
    ds_write_b128 v231, v[224:227] offset:57344
    v_alignbit_b32 v88, v89, v88, v232
    v_alignbit_b32 v98, v99, v98, v232
    v_alignbit_b32 v108, v109, v108, v232
    v_alignbit_b32 v118, v119, v118, v232
    v_alignbit_b32 v128, v129, v128, v232
    v_alignbit_b32 v138, v139, v138, v232
    v_alignbit_b32 v148, v149, v148, v232
    v_alignbit_b32 v158, v159, v158, v232
    v_perm_b32 v196, v98, v88, s2
    v_perm_b32 v197, v118, v108, s2
    v_perm_b32 v198, v138, v128, s2
    v_perm_b32 v199, v158, v148, s2
    ds_write_b128 v233, v[196:199] offset:0
    v_perm_b32 v200, v98, v88, s3
    v_perm_b32 v201, v118, v108, s3
    v_perm_b32 v202, v138, v128, s3
    v_perm_b32 v203, v158, v148, s3
    ds_write_b128 v233, v[200:203] offset:8192
    v_alignbit_b32 v89, v90, v89, v232
    v_alignbit_b32 v99, v100, v99, v232
    v_alignbit_b32 v109, v110, v109, v232
    v_alignbit_b32 v119, v120, v119, v232
    v_alignbit_b32 v129, v130, v129, v232
    v_alignbit_b32 v139, v140, v139, v232
    v_alignbit_b32 v149, v150, v149, v232
    v_alignbit_b32 v159, v160, v159, v232
    v_perm_b32 v204, v99, v89, s2
    v_perm_b32 v205, v119, v109, s2
    v_perm_b32 v206, v139, v129, s2
    v_perm_b32 v207, v159, v149, s2
    ds_write_b128 v233, v[204:207] offset:16384
    v_perm_b32 v208, v99, v89, s3
    v_perm_b32 v209, v119, v109, s3
    v_perm_b32 v210, v139, v129, s3
    v_perm_b32 v211, v159, v149, s3
    ds_write_b128 v233, v[208:211] offset:24576
    v_alignbit_b32 v90, v91, v90, v232
    v_alignbit_b32 v100, v101, v100, v232
    v_alignbit_b32 v110, v111, v110, v232
    v_alignbit_b32 v120, v121, v120, v232
    v_alignbit_b32 v130, v131, v130, v232
    v_alignbit_b32 v140, v141, v140, v232
    v_alignbit_b32 v150, v151, v150, v232
    v_alignbit_b32 v160, v161, v160, v232
    v_perm_b32 v212, v100, v90, s2
    v_perm_b32 v213, v120, v110, s2
    v_perm_b32 v214, v140, v130, s2
    v_perm_b32 v215, v160, v150, s2
    ds_write_b128 v233, v[212:215] offset:32768
    v_perm_b32 v216, v100, v90, s3
    v_perm_b32 v217, v120, v110, s3
    v_perm_b32 v218, v140, v130, s3
    v_perm_b32 v219, v160, v150, s3
    ds_write_b128 v233, v[216:219] offset:40960
    v_alignbit_b32 v91, v92, v91, v232
    v_alignbit_b32 v101, v102, v101, v232
    v_alignbit_b32 v111, v112, v111, v232
    v_alignbit_b32 v121, v122, v121, v232
    v_alignbit_b32 v131, v132, v131, v232
    v_alignbit_b32 v141, v142, v141, v232
    v_alignbit_b32 v151, v152, v151, v232
    v_alignbit_b32 v161, v162, v161, v232
    v_perm_b32 v220, v101, v91, s2
    v_perm_b32 v221, v121, v111, s2
    v_perm_b32 v222, v141, v131, s2
    v_perm_b32 v223, v161, v151, s2
    ds_write_b128 v233, v[220:223] offset:49152
    v_perm_b32 v224, v101, v91, s3
    v_perm_b32 v225, v121, v111, s3
    v_perm_b32 v226, v141, v131, s3
    v_perm_b32 v227, v161, v151, s3
    ds_write_b128 v233, v[224:227] offset:57344
    v_alignbit_b32 v92, v92, v92, v232
    v_alignbit_b32 v102, v102, v102, v232
    v_alignbit_b32 v112, v112, v112, v232
    v_alignbit_b32 v122, v122, v122, v232
    v_alignbit_b32 v132, v132, v132, v232
    v_alignbit_b32 v142, v142, v142, v232
    v_alignbit_b32 v152, v152, v152, v232
    v_alignbit_b32 v162, v162, v162, v232
    v_perm_b32 v196, v102, v92, s2
    v_perm_b32 v197, v122, v112, s2
    v_perm_b32 v198, v142, v132, s2
    v_perm_b32 v199, v162, v152, s2
    ds_write_b128 v235, v[196:199] offset:0
    s_waitcnt lgkmcnt(0)
    s_cmp_lg_u32 s58, 0
    s_cbranch_scc1 wall_136
    v_mov_b32 v236, 40
wctr_137:
    buffer_load_dword v235, v236, s[12:15], 0 offen sc1
    s_waitcnt vmcnt(0)
    v_cmp_gt_u16 vcc, 32, v235
    s_cbranch_vccz wctr_ok_138
    s_sub_u32 s77, s77, 1
    s_cbranch_scc0 wctr_137
    s_mov_b32 s77, 0
wctr_ok_138:
wall_136:
    s_barrier
    s_mov_b32 s7, s58
colloop_139:
    s_lshl_b32 s3, s79, 4
    s_add_u32 s3, s3, s7
    s_lshl_b32 s3, s3, 1
    s_cmp_eq_u32 s3, 1024
    s_cselect_b32 s3, 1, s3
    s_cmp_lt_u32 s3, 2
    s_cselect_b32 s6, 0x5ffffff0, 0
    s_mov_b32 s4, 0x35800000
    s_cselect_b32 s4, 0x35000000, s4
    v_bfe_u32 v231, v1, 0, 5
    v_lshlrev_b32 v231, 16, v231
    v_bfe_u32 v235, v1, 5, 1
    v_lshl_or_b32 v231, v235, 9, v231
    v_add_u32 v232, s6, v231
    s_bfe_u32 s5, s3, 0x50000
    s_lshl_b32 s5, s5, 4
    s_bfe_u32 s2, s3, 0x50005
    s_lshl_b32 s2, s2, 11
    s_or_b32 s5, s5, s2
    s_add_u32 s5, s5, 0x5400000
    buffer_load_dwordx4 v[84:87], v231, s[8:11], s5 offen offset:0
    buffer_load_dwordx4 v[100:103], v232, s[8:11], s5 offen offset:16
    buffer_load_dwordx4 v[88:91], v231, s[8:11], s5 offen offset:1024
    buffer_load_dwordx4 v[104:107], v232, s[8:11], s5 offen offset:1040
    s_add_u32 s5, s5, 2097152
    buffer_load_dwordx4 v[92:95], v231, s[8:11], s5 offen offset:0
    buffer_load_dwordx4 v[108:111], v232, s[8:11], s5 offen offset:16
    buffer_load_dwordx4 v[96:99], v231, s[8:11], s5 offen offset:1024
    buffer_load_dwordx4 v[112:115], v232, s[8:11], s5 offen offset:1040
    s_add_u32 s5, s5, 2097152
    s_lshl_b32 s5, s7, 13
    v_lshl_add_u32 v235, v1, 4, s5
    ds_read_b128 v[196:199], v235 offset:0
    ds_read_b128 v[200:203], v235 offset:1024
    ds_read_b128 v[204:207], v235 offset:2048
    ds_read_b128 v[208:211], v235 offset:3072
    ds_read_b128 v[212:215], v235 offset:4096
    ds_read_b128 v[216:219], v235 offset:5120
    ds_read_b128 v[220:223], v235 offset:6144
    ds_read_b128 v[224:227], v235 offset:7168
    v_and_b32 v236, 31, v1
    v_cvt_f32_u32 v228, v236
    v_mov_b32 v229, v234
    s_waitcnt vmcnt(0) lgkmcnt(0)
    v_xor_b32 v116, 0x80008000, v84
    v_xor_b32 v117, 0x80008000, v85
    v_xor_b32 v118, 0x80008000, v86
    v_xor_b32 v119, 0x80008000, v87
    v_xor_b32 v120, 0x80008000, v88
    v_xor_b32 v121, 0x80008000, v89
    v_xor_b32 v122, 0x80008000, v90
    v_xor_b32 v123, 0x80008000, v91
    v_xor_b32 v124, 0x80008000, v92
    v_xor_b32 v125, 0x80008000, v93
    v_xor_b32 v126, 0x80008000, v94
    v_xor_b32 v127, 0x80008000, v95
    v_xor_b32 v128, 0x80008000, v96
    v_xor_b32 v129, 0x80008000, v97
    v_xor_b32 v130, 0x80008000, v98
    v_xor_b32 v131, 0x80008000, v99
    v_mfma_f32_32x32x16_bf16 v[132:147], v[84:87], v[68:71], 0
    v_mfma_f32_32x32x16_bf16 v[164:179], v[100:103], v[68:71], 0
    v_mfma_f32_32x32x16_bf16 v[132:147], v[100:103], v[76:79], v[132:147]
    v_mfma_f32_32x32x16_bf16 v[164:179], v[116:119], v[76:79], v[164:179]
    v_mfma_f32_32x32x16_bf16 v[132:147], v[88:91], v[72:75], v[132:147]
    v_mfma_f32_32x32x16_bf16 v[164:179], v[104:107], v[72:75], v[164:179]
    v_mfma_f32_32x32x16_bf16 v[132:147], v[104:107], v[80:83], v[132:147]
    v_mfma_f32_32x32x16_bf16 v[164:179], v[120:123], v[80:83], v[164:179]
    v_mfma_f32_32x32x16_bf16 v[148:163], v[92:95], v[68:71], 0
    v_mfma_f32_32x32x16_bf16 v[180:195], v[108:111], v[68:71], 0
    v_mfma_f32_32x32x16_bf16 v[148:163], v[108:111], v[76:79], v[148:163]
    v_mfma_f32_32x32x16_bf16 v[180:195], v[124:127], v[76:79], v[180:195]
    v_mfma_f32_32x32x16_bf16 v[148:163], v[96:99], v[72:75], v[148:163]
    v_mfma_f32_32x32x16_bf16 v[180:195], v[112:115], v[72:75], v[180:195]
    v_mfma_f32_32x32x16_bf16 v[148:163], v[112:115], v[80:83], v[148:163]
    v_mfma_f32_32x32x16_bf16 v[180:195], v[128:131], v[80:83], v[180:195]
    v_fmamk_f32 v243, v228, 0x0, v229
    v_cos_f32 v239, v243
    v_sin_f32 v240, v243
    v_mul_f32 v239, s4, v239
    v_mul_f32 v240, s4, v240
    v_mul_f32 v235, v132, v239
    v_mul_f32 v237, v164, v239
    v_fma_f32 v235, v164, v240, v235
    v_fma_f32 v237, -v132, v240, v237
    v_fmamk_f32 v243, v228, 0x3a000000, v229
    v_cos_f32 v241, v243
    v_sin_f32 v242, v243
    v_mul_f32 v241, s4, v241
    v_mul_f32 v242, s4, v242
    v_mul_f32 v236, v133, v241
    v_mul_f32 v238, v165, v241
    v_fma_f32 v236, v165, v242, v236
    v_fma_f32 v238, -v133, v242, v238
    v_cvt_pk_bf16_f32 v84, v235, v236
    v_cvt_pk_bf16_f32 v100, v237, v238
    v_cvt_pk_bf16_f32 v116, -v235, -v236
    v_fmamk_f32 v243, v228, 0x3a800000, v229
    v_cos_f32 v239, v243
    v_sin_f32 v240, v243
    v_mul_f32 v239, s4, v239
    v_mul_f32 v240, s4, v240
    v_mul_f32 v235, v134, v239
    v_mul_f32 v237, v166, v239
    v_fma_f32 v235, v166, v240, v235
    v_fma_f32 v237, -v134, v240, v237
    v_fmamk_f32 v243, v228, 0x3ac00000, v229
    v_cos_f32 v241, v243
    v_sin_f32 v242, v243
    v_mul_f32 v241, s4, v241
    v_mul_f32 v242, s4, v242
    v_mul_f32 v236, v135, v241
    v_mul_f32 v238, v167, v241
    v_fma_f32 v236, v167, v242, v236
    v_fma_f32 v238, -v135, v242, v238
    v_cvt_pk_bf16_f32 v85, v235, v236
    v_cvt_pk_bf16_f32 v101, v237, v238
    v_cvt_pk_bf16_f32 v117, -v235, -v236
    v_fmamk_f32 v243, v228, 0x3b800000, v229
    v_cos_f32 v239, v243
    v_sin_f32 v240, v243
    v_mul_f32 v239, s4, v239
    v_mul_f32 v240, s4, v240
    v_mul_f32 v235, v136, v239
    v_mul_f32 v237, v168, v239
    v_fma_f32 v235, v168, v240, v235
    v_fma_f32 v237, -v136, v240, v237
    v_fmamk_f32 v243, v228, 0x3b900000, v229
    v_cos_f32 v241, v243
    v_sin_f32 v242, v243
    v_mul_f32 v241, s4, v241
    v_mul_f32 v242, s4, v242
    v_mul_f32 v236, v137, v241
    v_mul_f32 v238, v169, v241
    v_fma_f32 v236, v169, v242, v236
    v_fma_f32 v238, -v137, v242, v238
    v_cvt_pk_bf16_f32 v86, v235, v236
    v_cvt_pk_bf16_f32 v102, v237, v238
    v_cvt_pk_bf16_f32 v118, -v235, -v236
    v_fmamk_f32 v243, v228, 0x3ba00000, v229
    v_cos_f32 v239, v243
    v_sin_f32 v240, v243
    v_mul_f32 v239, s4, v239
    v_mul_f32 v240, s4, v240
    v_mul_f32 v235, v138, v239
    v_mul_f32 v237, v170, v239
    v_fma_f32 v235, v170, v240, v235
    v_fma_f32 v237, -v138, v240, v237
    v_fmamk_f32 v243, v228, 0x3bb00000, v229
    v_cos_f32 v241, v243
    v_sin_f32 v242, v243
    v_mul_f32 v241, s4, v241
    v_mul_f32 v242, s4, v242
    v_mul_f32 v236, v139, v241
    v_mul_f32 v238, v171, v241
    v_fma_f32 v236, v171, v242, v236
    v_fma_f32 v238, -v139, v242, v238
    v_cvt_pk_bf16_f32 v87, v235, v236
    v_cvt_pk_bf16_f32 v103, v237, v238
    v_cvt_pk_bf16_f32 v119, -v235, -v236
    v_fmamk_f32 v243, v228, 0x3c000000, v229
    v_cos_f32 v239, v243
    v_sin_f32 v240, v243
    v_mul_f32 v239, s4, v239
    v_mul_f32 v240, s4, v240
    v_mul_f32 v235, v140, v239
    v_mul_f32 v237, v172, v239
    v_fma_f32 v235, v172, v240, v235
    v_fma_f32 v237, -v140, v240, v237
    v_fmamk_f32 v243, v228, 0x3c080000, v229
    v_cos_f32 v241, v243
    v_sin_f32 v242, v243
    v_mul_f32 v241, s4, v241
    v_mul_f32 v242, s4, v242
    v_mul_f32 v236, v141, v241
    v_mul_f32 v238, v173, v241
    v_fma_f32 v236, v173, v242, v236
    v_fma_f32 v238, -v141, v242, v238
    v_cvt_pk_bf16_f32 v88, v235, v236
    v_cvt_pk_bf16_f32 v104, v237, v238
    v_cvt_pk_bf16_f32 v120, -v235, -v236
    v_fmamk_f32 v243, v228, 0x3c100000, v229
    v_cos_f32 v239, v243
    v_sin_f32 v240, v243
    v_mul_f32 v239, s4, v239
    v_mul_f32 v240, s4, v240
    v_mul_f32 v235, v142, v239
    v_mul_f32 v237, v174, v239
    v_fma_f32 v235, v174, v240, v235
    v_fma_f32 v237, -v142, v240, v237
    v_fmamk_f32 v243, v228, 0x3c180000, v229
    v_cos_f32 v241, v243
    v_sin_f32 v242, v243
    v_mul_f32 v241, s4, v241
    v_mul_f32 v242, s4, v242
    v_mul_f32 v236, v143, v241
    v_mul_f32 v238, v175, v241
    v_fma_f32 v236, v175, v242, v236
    v_fma_f32 v238, -v143, v242, v238
    v_cvt_pk_bf16_f32 v89, v235, v236
    v_cvt_pk_bf16_f32 v105, v237, v238
    v_cvt_pk_bf16_f32 v121, -v235, -v236
    v_fmamk_f32 v243, v228, 0x3c400000, v229
    v_cos_f32 v239, v243
    v_sin_f32 v240, v243
    v_mul_f32 v239, s4, v239
    v_mul_f32 v240, s4, v240
    v_mul_f32 v235, v144, v239
    v_mul_f32 v237, v176, v239
    v_fma_f32 v235, v176, v240, v235
    v_fma_f32 v237, -v144, v240, v237
    v_fmamk_f32 v243, v228, 0x3c480000, v229
    v_cos_f32 v241, v243
    v_sin_f32 v242, v243
    v_mul_f32 v241, s4, v241
    v_mul_f32 v242, s4, v242
    v_mul_f32 v236, v145, v241
    v_mul_f32 v238, v177, v241
    v_fma_f32 v236, v177, v242, v236
    v_fma_f32 v238, -v145, v242, v238
    v_cvt_pk_bf16_f32 v90, v235, v236
    v_cvt_pk_bf16_f32 v106, v237, v238
    v_cvt_pk_bf16_f32 v122, -v235, -v236
    v_fmamk_f32 v243, v228, 0x3c500000, v229
    v_cos_f32 v239, v243
    v_sin_f32 v240, v243
    v_mul_f32 v239, s4, v239
    v_mul_f32 v240, s4, v240
    v_mul_f32 v235, v146, v239
    v_mul_f32 v237, v178, v239
    v_fma_f32 v235, v178, v240, v235
    v_fma_f32 v237, -v146, v240, v237
    v_fmamk_f32 v243, v228, 0x3c580000, v229
    v_cos_f32 v241, v243
    v_sin_f32 v242, v243
    v_mul_f32 v241, s4, v241
    v_mul_f32 v242, s4, v242
    v_mul_f32 v236, v147, v241
    v_mul_f32 v238, v179, v241
    v_fma_f32 v236, v179, v242, v236
    v_fma_f32 v238, -v147, v242, v238
    v_cvt_pk_bf16_f32 v91, v235, v236
    v_cvt_pk_bf16_f32 v107, v237, v238
    v_cvt_pk_bf16_f32 v123, -v235, -v236
    v_fmamk_f32 v243, v228, 0x3c800000, v229
    v_cos_f32 v239, v243
    v_sin_f32 v240, v243
    v_mul_f32 v239, s4, v239
    v_mul_f32 v240, s4, v240
    v_mul_f32 v235, v148, v239
    v_mul_f32 v237, v180, v239
    v_fma_f32 v235, v180, v240, v235
    v_fma_f32 v237, -v148, v240, v237
    v_fmamk_f32 v243, v228, 0x3c840000, v229
    v_cos_f32 v241, v243
    v_sin_f32 v242, v243
    v_mul_f32 v241, s4, v241
    v_mul_f32 v242, s4, v242
    v_mul_f32 v236, v149, v241
    v_mul_f32 v238, v181, v241
    v_fma_f32 v236, v181, v242, v236
    v_fma_f32 v238, -v149, v242, v238
    v_cvt_pk_bf16_f32 v92, v235, v236
    v_cvt_pk_bf16_f32 v108, v237, v238
    v_cvt_pk_bf16_f32 v124, -v235, -v236
    v_fmamk_f32 v243, v228, 0x3c880000, v229
    v_cos_f32 v239, v243
    v_sin_f32 v240, v243
    v_mul_f32 v239, s4, v239
    v_mul_f32 v240, s4, v240
    v_mul_f32 v235, v150, v239
    v_mul_f32 v237, v182, v239
    v_fma_f32 v235, v182, v240, v235
    v_fma_f32 v237, -v150, v240, v237
    v_fmamk_f32 v243, v228, 0x3c8c0000, v229
    v_cos_f32 v241, v243
    v_sin_f32 v242, v243
    v_mul_f32 v241, s4, v241
    v_mul_f32 v242, s4, v242
    v_mul_f32 v236, v151, v241
    v_mul_f32 v238, v183, v241
    v_fma_f32 v236, v183, v242, v236
    v_fma_f32 v238, -v151, v242, v238
    v_cvt_pk_bf16_f32 v93, v235, v236
    v_cvt_pk_bf16_f32 v109, v237, v238
    v_cvt_pk_bf16_f32 v125, -v235, -v236
    v_fmamk_f32 v243, v228, 0x3ca00000, v229
    v_cos_f32 v239, v243
    v_sin_f32 v240, v243
    v_mul_f32 v239, s4, v239
    v_mul_f32 v240, s4, v240
    v_mul_f32 v235, v152, v239
    v_mul_f32 v237, v184, v239
    v_fma_f32 v235, v184, v240, v235
    v_fma_f32 v237, -v152, v240, v237
    v_fmamk_f32 v243, v228, 0x3ca40000, v229
    v_cos_f32 v241, v243
    v_sin_f32 v242, v243
    v_mul_f32 v241, s4, v241
    v_mul_f32 v242, s4, v242
    v_mul_f32 v236, v153, v241
    v_mul_f32 v238, v185, v241
    v_fma_f32 v236, v185, v242, v236
    v_fma_f32 v238, -v153, v242, v238
    v_cvt_pk_bf16_f32 v94, v235, v236
    v_cvt_pk_bf16_f32 v110, v237, v238
    v_cvt_pk_bf16_f32 v126, -v235, -v236
    v_fmamk_f32 v243, v228, 0x3ca80000, v229
    v_cos_f32 v239, v243
    v_sin_f32 v240, v243
    v_mul_f32 v239, s4, v239
    v_mul_f32 v240, s4, v240
    v_mul_f32 v235, v154, v239
    v_mul_f32 v237, v186, v239
    v_fma_f32 v235, v186, v240, v235
    v_fma_f32 v237, -v154, v240, v237
    v_fmamk_f32 v243, v228, 0x3cac0000, v229
    v_cos_f32 v241, v243
    v_sin_f32 v242, v243
    v_mul_f32 v241, s4, v241
    v_mul_f32 v242, s4, v242
    v_mul_f32 v236, v155, v241
    v_mul_f32 v238, v187, v241
    v_fma_f32 v236, v187, v242, v236
    v_fma_f32 v238, -v155, v242, v238
    v_cvt_pk_bf16_f32 v95, v235, v236
    v_cvt_pk_bf16_f32 v111, v237, v238
    v_cvt_pk_bf16_f32 v127, -v235, -v236
    v_fmamk_f32 v243, v228, 0x3cc00000, v229
    v_cos_f32 v239, v243
    v_sin_f32 v240, v243
    v_mul_f32 v239, s4, v239
    v_mul_f32 v240, s4, v240
    v_mul_f32 v235, v156, v239
    v_mul_f32 v237, v188, v239
    v_fma_f32 v235, v188, v240, v235
    v_fma_f32 v237, -v156, v240, v237
    v_fmamk_f32 v243, v228, 0x3cc40000, v229
    v_cos_f32 v241, v243
    v_sin_f32 v242, v243
    v_mul_f32 v241, s4, v241
    v_mul_f32 v242, s4, v242
    v_mul_f32 v236, v157, v241
    v_mul_f32 v238, v189, v241
    v_fma_f32 v236, v189, v242, v236
    v_fma_f32 v238, -v157, v242, v238
    v_cvt_pk_bf16_f32 v96, v235, v236
    v_cvt_pk_bf16_f32 v112, v237, v238
    v_cvt_pk_bf16_f32 v128, -v235, -v236
    v_fmamk_f32 v243, v228, 0x3cc80000, v229
    v_cos_f32 v239, v243
    v_sin_f32 v240, v243
    v_mul_f32 v239, s4, v239
    v_mul_f32 v240, s4, v240
    v_mul_f32 v235, v158, v239
    v_mul_f32 v237, v190, v239
    v_fma_f32 v235, v190, v240, v235
    v_fma_f32 v237, -v158, v240, v237
    v_fmamk_f32 v243, v228, 0x3ccc0000, v229
    v_cos_f32 v241, v243
    v_sin_f32 v242, v243
    v_mul_f32 v241, s4, v241
    v_mul_f32 v242, s4, v242
    v_mul_f32 v236, v159, v241
    v_mul_f32 v238, v191, v241
    v_fma_f32 v236, v191, v242, v236
    v_fma_f32 v238, -v159, v242, v238
    v_cvt_pk_bf16_f32 v97, v235, v236
    v_cvt_pk_bf16_f32 v113, v237, v238
    v_cvt_pk_bf16_f32 v129, -v235, -v236
    v_fmamk_f32 v243, v228, 0x3ce00000, v229
    v_cos_f32 v239, v243
    v_sin_f32 v240, v243
    v_mul_f32 v239, s4, v239
    v_mul_f32 v240, s4, v240
    v_mul_f32 v235, v160, v239
    v_mul_f32 v237, v192, v239
    v_fma_f32 v235, v192, v240, v235
    v_fma_f32 v237, -v160, v240, v237
    v_fmamk_f32 v243, v228, 0x3ce40000, v229
    v_cos_f32 v241, v243
    v_sin_f32 v242, v243
    v_mul_f32 v241, s4, v241
    v_mul_f32 v242, s4, v242
    v_mul_f32 v236, v161, v241
    v_mul_f32 v238, v193, v241
    v_fma_f32 v236, v193, v242, v236
    v_fma_f32 v238, -v161, v242, v238
    v_cvt_pk_bf16_f32 v98, v235, v236
    v_cvt_pk_bf16_f32 v114, v237, v238
    v_cvt_pk_bf16_f32 v130, -v235, -v236
    v_fmamk_f32 v243, v228, 0x3ce80000, v229
    v_cos_f32 v239, v243
    v_sin_f32 v240, v243
    v_mul_f32 v239, s4, v239
    v_mul_f32 v240, s4, v240
    v_mul_f32 v235, v162, v239
    v_mul_f32 v237, v194, v239
    v_fma_f32 v235, v194, v240, v235
    v_fma_f32 v237, -v162, v240, v237
    v_fmamk_f32 v243, v228, 0x3cec0000, v229
    v_cos_f32 v241, v243
    v_sin_f32 v242, v243
    v_mul_f32 v241, s4, v241
    v_mul_f32 v242, s4, v242
    v_mul_f32 v236, v163, v241
    v_mul_f32 v238, v195, v241
    v_fma_f32 v236, v195, v242, v236
    v_fma_f32 v238, -v163, v242, v238
    v_cvt_pk_bf16_f32 v99, v235, v236
    v_cvt_pk_bf16_f32 v115, v237, v238
    v_cvt_pk_bf16_f32 v131, -v235, -v236
    v_mfma_f32_32x32x16_bf16 v[132:147], v[4:7], v[84:87], 0
    v_mfma_f32_32x32x16_bf16 v[164:179], v[4:7], v[100:103], 0
    v_mfma_f32_32x32x16_bf16 v[132:147], v[36:39], v[100:103], v[132:147]
    v_mfma_f32_32x32x16_bf16 v[164:179], v[36:39], v[116:119], v[164:179]
    v_mfma_f32_32x32x16_bf16 v[132:147], v[8:11], v[88:91], v[132:147]
    v_mfma_f32_32x32x16_bf16 v[164:179], v[8:11], v[104:107], v[164:179]
    v_mfma_f32_32x32x16_bf16 v[132:147], v[40:43], v[104:107], v[132:147]
    v_mfma_f32_32x32x16_bf16 v[164:179], v[40:43], v[120:123], v[164:179]
    v_mfma_f32_32x32x16_bf16 v[132:147], v[12:15], v[92:95], v[132:147]
    v_mfma_f32_32x32x16_bf16 v[164:179], v[12:15], v[108:111], v[164:179]
    v_mfma_f32_32x32x16_bf16 v[132:147], v[44:47], v[108:111], v[132:147]
    v_mfma_f32_32x32x16_bf16 v[164:179], v[44:47], v[124:127], v[164:179]
    v_mfma_f32_32x32x16_bf16 v[132:147], v[16:19], v[96:99], v[132:147]
    v_mfma_f32_32x32x16_bf16 v[164:179], v[16:19], v[112:115], v[164:179]
    v_mfma_f32_32x32x16_bf16 v[132:147], v[48:51], v[112:115], v[132:147]
    v_mfma_f32_32x32x16_bf16 v[164:179], v[48:51], v[128:131], v[164:179]
    v_mfma_f32_32x32x16_bf16 v[148:163], v[20:23], v[84:87], 0
    v_mfma_f32_32x32x16_bf16 v[180:195], v[20:23], v[100:103], 0
    v_mfma_f32_32x32x16_bf16 v[148:163], v[52:55], v[100:103], v[148:163]
    v_mfma_f32_32x32x16_bf16 v[180:195], v[52:55], v[116:119], v[180:195]
    v_mfma_f32_32x32x16_bf16 v[148:163], v[24:27], v[88:91], v[148:163]
    v_mfma_f32_32x32x16_bf16 v[180:195], v[24:27], v[104:107], v[180:195]
    v_mfma_f32_32x32x16_bf16 v[148:163], v[56:59], v[104:107], v[148:163]
    v_mfma_f32_32x32x16_bf16 v[180:195], v[56:59], v[120:123], v[180:195]
    v_mfma_f32_32x32x16_bf16 v[148:163], v[28:31], v[92:95], v[148:163]
    v_mfma_f32_32x32x16_bf16 v[180:195], v[28:31], v[108:111], v[180:195]
    v_mfma_f32_32x32x16_bf16 v[148:163], v[60:63], v[108:111], v[148:163]
    v_mfma_f32_32x32x16_bf16 v[180:195], v[60:63], v[124:127], v[180:195]
    v_mfma_f32_32x32x16_bf16 v[148:163], v[32:35], v[96:99], v[148:163]
    v_mfma_f32_32x32x16_bf16 v[180:195], v[32:35], v[112:115], v[180:195]
    v_mfma_f32_32x32x16_bf16 v[148:163], v[64:67], v[112:115], v[148:163]
    v_mfma_f32_32x32x16_bf16 v[180:195], v[64:67], v[128:131], v[180:195]
    v_lshlrev_b32 v239, 16, v196
    v_and_b32 v240, 0xffff0000, v196
    v_mul_f32 v235, v132, v239
    v_mul_f32 v237, v164, v239
    v_fma_f32 v235, -v164, v240, v235
    v_fma_f32 v237, v132, v240, v237
    v_lshlrev_b32 v241, 16, v197
    v_and_b32 v242, 0xffff0000, v197
    v_mul_f32 v236, v133, v241
    v_mul_f32 v238, v165, v241
    v_fma_f32 v236, -v165, v242, v236
    v_fma_f32 v238, v133, v242, v238
    v_cvt_pk_bf16_f32 v84, v235, v236
    v_cvt_pk_bf16_f32 v100, v237, v238
    v_cvt_pk_bf16_f32 v116, -v237, -v238
    v_lshlrev_b32 v239, 16, v198
    v_and_b32 v240, 0xffff0000, v198
    v_mul_f32 v235, v134, v239
    v_mul_f32 v237, v166, v239
    v_fma_f32 v235, -v166, v240, v235
    v_fma_f32 v237, v134, v240, v237
    v_lshlrev_b32 v241, 16, v199
    v_and_b32 v242, 0xffff0000, v199
    v_mul_f32 v236, v135, v241
    v_mul_f32 v238, v167, v241
    v_fma_f32 v236, -v167, v242, v236
    v_fma_f32 v238, v135, v242, v238
    v_cvt_pk_bf16_f32 v85, v235, v236
    v_cvt_pk_bf16_f32 v101, v237, v238
    v_cvt_pk_bf16_f32 v117, -v237, -v238
    v_lshlrev_b32 v239, 16, v200
    v_and_b32 v240, 0xffff0000, v200
    v_mul_f32 v235, v136, v239
    v_mul_f32 v237, v168, v239
    v_fma_f32 v235, -v168, v240, v235
    v_fma_f32 v237, v136, v240, v237
    v_lshlrev_b32 v241, 16, v201
    v_and_b32 v242, 0xffff0000, v201
    v_mul_f32 v236, v137, v241
    v_mul_f32 v238, v169, v241
    v_fma_f32 v236, -v169, v242, v236
    v_fma_f32 v238, v137, v242, v238
    v_cvt_pk_bf16_f32 v86, v235, v236
    v_cvt_pk_bf16_f32 v102, v237, v238
    v_cvt_pk_bf16_f32 v118, -v237, -v238
    v_lshlrev_b32 v239, 16, v202
    v_and_b32 v240, 0xffff0000, v202
    v_mul_f32 v235, v138, v239
    v_mul_f32 v237, v170, v239
    v_fma_f32 v235, -v170, v240, v235
    v_fma_f32 v237, v138, v240, v237
    v_lshlrev_b32 v241, 16, v203
    v_and_b32 v242, 0xffff0000, v203
    v_mul_f32 v236, v139, v241
    v_mul_f32 v238, v171, v241
    v_fma_f32 v236, -v171, v242, v236
    v_fma_f32 v238, v139, v242, v238
    v_cvt_pk_bf16_f32 v87, v235, v236
    v_cvt_pk_bf16_f32 v103, v237, v238
    v_cvt_pk_bf16_f32 v119, -v237, -v238
    v_lshlrev_b32 v239, 16, v204
    v_and_b32 v240, 0xffff0000, v204
    v_mul_f32 v235, v140, v239
    v_mul_f32 v237, v172, v239
    v_fma_f32 v235, -v172, v240, v235
    v_fma_f32 v237, v140, v240, v237
    v_lshlrev_b32 v241, 16, v205
    v_and_b32 v242, 0xffff0000, v205
    v_mul_f32 v236, v141, v241
    v_mul_f32 v238, v173, v241
    v_fma_f32 v236, -v173, v242, v236
    v_fma_f32 v238, v141, v242, v238
    v_cvt_pk_bf16_f32 v88, v235, v236
    v_cvt_pk_bf16_f32 v104, v237, v238
    v_cvt_pk_bf16_f32 v120, -v237, -v238
    v_lshlrev_b32 v239, 16, v206
    v_and_b32 v240, 0xffff0000, v206
    v_mul_f32 v235, v142, v239
    v_mul_f32 v237, v174, v239
    v_fma_f32 v235, -v174, v240, v235
    v_fma_f32 v237, v142, v240, v237
    v_lshlrev_b32 v241, 16, v207
    v_and_b32 v242, 0xffff0000, v207
    v_mul_f32 v236, v143, v241
    v_mul_f32 v238, v175, v241
    v_fma_f32 v236, -v175, v242, v236
    v_fma_f32 v238, v143, v242, v238
    v_cvt_pk_bf16_f32 v89, v235, v236
    v_cvt_pk_bf16_f32 v105, v237, v238
    v_cvt_pk_bf16_f32 v121, -v237, -v238
    v_lshlrev_b32 v239, 16, v208
    v_and_b32 v240, 0xffff0000, v208
    v_mul_f32 v235, v144, v239
    v_mul_f32 v237, v176, v239
    v_fma_f32 v235, -v176, v240, v235
    v_fma_f32 v237, v144, v240, v237
    v_lshlrev_b32 v241, 16, v209
    v_and_b32 v242, 0xffff0000, v209
    v_mul_f32 v236, v145, v241
    v_mul_f32 v238, v177, v241
    v_fma_f32 v236, -v177, v242, v236
    v_fma_f32 v238, v145, v242, v238
    v_cvt_pk_bf16_f32 v90, v235, v236
    v_cvt_pk_bf16_f32 v106, v237, v238
    v_cvt_pk_bf16_f32 v122, -v237, -v238
    v_lshlrev_b32 v239, 16, v210
    v_and_b32 v240, 0xffff0000, v210
    v_mul_f32 v235, v146, v239
    v_mul_f32 v237, v178, v239
    v_fma_f32 v235, -v178, v240, v235
    v_fma_f32 v237, v146, v240, v237
    v_lshlrev_b32 v241, 16, v211
    v_and_b32 v242, 0xffff0000, v211
    v_mul_f32 v236, v147, v241
    v_mul_f32 v238, v179, v241
    v_fma_f32 v236, -v179, v242, v236
    v_fma_f32 v238, v147, v242, v238
    v_cvt_pk_bf16_f32 v91, v235, v236
    v_cvt_pk_bf16_f32 v107, v237, v238
    v_cvt_pk_bf16_f32 v123, -v237, -v238
    v_lshlrev_b32 v239, 16, v212
    v_and_b32 v240, 0xffff0000, v212
    v_mul_f32 v235, v148, v239
    v_mul_f32 v237, v180, v239
    v_fma_f32 v235, -v180, v240, v235
    v_fma_f32 v237, v148, v240, v237
    v_lshlrev_b32 v241, 16, v213
    v_and_b32 v242, 0xffff0000, v213
    v_mul_f32 v236, v149, v241
    v_mul_f32 v238, v181, v241
    v_fma_f32 v236, -v181, v242, v236
    v_fma_f32 v238, v149, v242, v238
    v_cvt_pk_bf16_f32 v92, v235, v236
    v_cvt_pk_bf16_f32 v108, v237, v238
    v_cvt_pk_bf16_f32 v124, -v237, -v238
    v_lshlrev_b32 v239, 16, v214
    v_and_b32 v240, 0xffff0000, v214
    v_mul_f32 v235, v150, v239
    v_mul_f32 v237, v182, v239
    v_fma_f32 v235, -v182, v240, v235
    v_fma_f32 v237, v150, v240, v237
    v_lshlrev_b32 v241, 16, v215
    v_and_b32 v242, 0xffff0000, v215
    v_mul_f32 v236, v151, v241
    v_mul_f32 v238, v183, v241
    v_fma_f32 v236, -v183, v242, v236
    v_fma_f32 v238, v151, v242, v238
    v_cvt_pk_bf16_f32 v93, v235, v236
    v_cvt_pk_bf16_f32 v109, v237, v238
    v_cvt_pk_bf16_f32 v125, -v237, -v238
    v_lshlrev_b32 v239, 16, v216
    v_and_b32 v240, 0xffff0000, v216
    v_mul_f32 v235, v152, v239
    v_mul_f32 v237, v184, v239
    v_fma_f32 v235, -v184, v240, v235
    v_fma_f32 v237, v152, v240, v237
    v_lshlrev_b32 v241, 16, v217
    v_and_b32 v242, 0xffff0000, v217
    v_mul_f32 v236, v153, v241
    v_mul_f32 v238, v185, v241
    v_fma_f32 v236, -v185, v242, v236
    v_fma_f32 v238, v153, v242, v238
    v_cvt_pk_bf16_f32 v94, v235, v236
    v_cvt_pk_bf16_f32 v110, v237, v238
    v_cvt_pk_bf16_f32 v126, -v237, -v238
    v_lshlrev_b32 v239, 16, v218
    v_and_b32 v240, 0xffff0000, v218
    v_mul_f32 v235, v154, v239
    v_mul_f32 v237, v186, v239
    v_fma_f32 v235, -v186, v240, v235
    v_fma_f32 v237, v154, v240, v237
    v_lshlrev_b32 v241, 16, v219
    v_and_b32 v242, 0xffff0000, v219
    v_mul_f32 v236, v155, v241
    v_mul_f32 v238, v187, v241
    v_fma_f32 v236, -v187, v242, v236
    v_fma_f32 v238, v155, v242, v238
    v_cvt_pk_bf16_f32 v95, v235, v236
    v_cvt_pk_bf16_f32 v111, v237, v238
    v_cvt_pk_bf16_f32 v127, -v237, -v238
    v_lshlrev_b32 v239, 16, v220
    v_and_b32 v240, 0xffff0000, v220
    v_mul_f32 v235, v156, v239
    v_mul_f32 v237, v188, v239
    v_fma_f32 v235, -v188, v240, v235
    v_fma_f32 v237, v156, v240, v237
    v_lshlrev_b32 v241, 16, v221
    v_and_b32 v242, 0xffff0000, v221
    v_mul_f32 v236, v157, v241
    v_mul_f32 v238, v189, v241
    v_fma_f32 v236, -v189, v242, v236
    v_fma_f32 v238, v157, v242, v238
    v_cvt_pk_bf16_f32 v96, v235, v236
    v_cvt_pk_bf16_f32 v112, v237, v238
    v_cvt_pk_bf16_f32 v128, -v237, -v238
    v_lshlrev_b32 v239, 16, v222
    v_and_b32 v240, 0xffff0000, v222
    v_mul_f32 v235, v158, v239
    v_mul_f32 v237, v190, v239
    v_fma_f32 v235, -v190, v240, v235
    v_fma_f32 v237, v158, v240, v237
    v_lshlrev_b32 v241, 16, v223
    v_and_b32 v242, 0xffff0000, v223
    v_mul_f32 v236, v159, v241
    v_mul_f32 v238, v191, v241
    v_fma_f32 v236, -v191, v242, v236
    v_fma_f32 v238, v159, v242, v238
    v_cvt_pk_bf16_f32 v97, v235, v236
    v_cvt_pk_bf16_f32 v113, v237, v238
    v_cvt_pk_bf16_f32 v129, -v237, -v238
    v_lshlrev_b32 v239, 16, v224
    v_and_b32 v240, 0xffff0000, v224
    v_mul_f32 v235, v160, v239
    v_mul_f32 v237, v192, v239
    v_fma_f32 v235, -v192, v240, v235
    v_fma_f32 v237, v160, v240, v237
    v_lshlrev_b32 v241, 16, v225
    v_and_b32 v242, 0xffff0000, v225
    v_mul_f32 v236, v161, v241
    v_mul_f32 v238, v193, v241
    v_fma_f32 v236, -v193, v242, v236
    v_fma_f32 v238, v161, v242, v238
    v_cvt_pk_bf16_f32 v98, v235, v236
    v_cvt_pk_bf16_f32 v114, v237, v238
    v_cvt_pk_bf16_f32 v130, -v237, -v238
    v_lshlrev_b32 v239, 16, v226
    v_and_b32 v240, 0xffff0000, v226
    v_mul_f32 v235, v162, v239
    v_mul_f32 v237, v194, v239
    v_fma_f32 v235, -v194, v240, v235
    v_fma_f32 v237, v162, v240, v237
    v_lshlrev_b32 v241, 16, v227
    v_and_b32 v242, 0xffff0000, v227
    v_mul_f32 v236, v163, v241
    v_mul_f32 v238, v195, v241
    v_fma_f32 v236, -v195, v242, v236
    v_fma_f32 v238, v163, v242, v238
    v_cvt_pk_bf16_f32 v99, v235, v236
    v_cvt_pk_bf16_f32 v115, v237, v238
    v_cvt_pk_bf16_f32 v131, -v237, -v238
    v_mfma_f32_32x32x16_bf16 v[132:147], v[84:87], v[4:7], 0
    v_mfma_f32_32x32x16_bf16 v[164:179], v[100:103], v[4:7], 0
    v_mfma_f32_32x32x16_bf16 v[132:147], v[116:119], v[36:39], v[132:147]
    v_mfma_f32_32x32x16_bf16 v[164:179], v[84:87], v[36:39], v[164:179]
    v_mfma_f32_32x32x16_bf16 v[132:147], v[88:91], v[8:11], v[132:147]
    v_mfma_f32_32x32x16_bf16 v[164:179], v[104:107], v[8:11], v[164:179]
    v_mfma_f32_32x32x16_bf16 v[132:147], v[120:123], v[40:43], v[132:147]
    v_mfma_f32_32x32x16_bf16 v[164:179], v[88:91], v[40:43], v[164:179]
    v_mfma_f32_32x32x16_bf16 v[132:147], v[92:95], v[12:15], v[132:147]
    v_mfma_f32_32x32x16_bf16 v[164:179], v[108:111], v[12:15], v[164:179]
    v_mfma_f32_32x32x16_bf16 v[132:147], v[124:127], v[44:47], v[132:147]
    v_mfma_f32_32x32x16_bf16 v[164:179], v[92:95], v[44:47], v[164:179]
    v_mfma_f32_32x32x16_bf16 v[132:147], v[96:99], v[16:19], v[132:147]
    v_mfma_f32_32x32x16_bf16 v[164:179], v[112:115], v[16:19], v[164:179]
    v_mfma_f32_32x32x16_bf16 v[132:147], v[128:131], v[48:51], v[132:147]
    v_mfma_f32_32x32x16_bf16 v[164:179], v[96:99], v[48:51], v[164:179]
    v_mfma_f32_32x32x16_bf16 v[148:163], v[84:87], v[20:23], 0
    v_mfma_f32_32x32x16_bf16 v[180:195], v[100:103], v[20:23], 0
    v_mfma_f32_32x32x16_bf16 v[148:163], v[116:119], v[52:55], v[148:163]
    v_mfma_f32_32x32x16_bf16 v[180:195], v[84:87], v[52:55], v[180:195]
    v_mfma_f32_32x32x16_bf16 v[148:163], v[88:91], v[24:27], v[148:163]
    v_mfma_f32_32x32x16_bf16 v[180:195], v[104:107], v[24:27], v[180:195]
    v_mfma_f32_32x32x16_bf16 v[148:163], v[120:123], v[56:59], v[148:163]
    v_mfma_f32_32x32x16_bf16 v[180:195], v[88:91], v[56:59], v[180:195]
    v_mfma_f32_32x32x16_bf16 v[148:163], v[92:95], v[28:31], v[148:163]
    v_mfma_f32_32x32x16_bf16 v[180:195], v[108:111], v[28:31], v[180:195]
    v_mfma_f32_32x32x16_bf16 v[148:163], v[124:127], v[60:63], v[148:163]
    v_mfma_f32_32x32x16_bf16 v[180:195], v[92:95], v[60:63], v[180:195]
    v_mfma_f32_32x32x16_bf16 v[148:163], v[96:99], v[32:35], v[148:163]
    v_mfma_f32_32x32x16_bf16 v[180:195], v[112:115], v[32:35], v[180:195]
    v_mfma_f32_32x32x16_bf16 v[148:163], v[128:131], v[64:67], v[148:163]
    v_mfma_f32_32x32x16_bf16 v[180:195], v[96:99], v[64:67], v[180:195]
    v_fmamk_f32 v243, v228, 0x0, v229
    v_cos_f32 v239, v243
    v_sin_f32 v240, v243
    v_mul_f32 v235, v132, v239
    v_mul_f32 v237, v164, v239
    v_fma_f32 v235, -v164, v240, v235
    v_fma_f32 v237, v132, v240, v237
    v_fmamk_f32 v243, v228, 0x3a000000, v229
    v_cos_f32 v241, v243
    v_sin_f32 v242, v243
    v_mul_f32 v236, v133, v241
    v_mul_f32 v238, v165, v241
    v_fma_f32 v236, -v165, v242, v236
    v_fma_f32 v238, v133, v242, v238
    v_cvt_pk_bf16_f32 v84, v235, v236
    v_cvt_pk_bf16_f32 v100, v237, v238
    v_cvt_pk_bf16_f32 v116, -v237, -v238
    v_fmamk_f32 v243, v228, 0x3a800000, v229
    v_cos_f32 v239, v243
    v_sin_f32 v240, v243
    v_mul_f32 v235, v134, v239
    v_mul_f32 v237, v166, v239
    v_fma_f32 v235, -v166, v240, v235
    v_fma_f32 v237, v134, v240, v237
    v_fmamk_f32 v243, v228, 0x3ac00000, v229
    v_cos_f32 v241, v243
    v_sin_f32 v242, v243
    v_mul_f32 v236, v135, v241
    v_mul_f32 v238, v167, v241
    v_fma_f32 v236, -v167, v242, v236
    v_fma_f32 v238, v135, v242, v238
    v_cvt_pk_bf16_f32 v85, v235, v236
    v_cvt_pk_bf16_f32 v101, v237, v238
    v_cvt_pk_bf16_f32 v117, -v237, -v238
    v_fmamk_f32 v243, v228, 0x3b800000, v229
    v_cos_f32 v239, v243
    v_sin_f32 v240, v243
    v_mul_f32 v235, v136, v239
    v_mul_f32 v237, v168, v239
    v_fma_f32 v235, -v168, v240, v235
    v_fma_f32 v237, v136, v240, v237
    v_fmamk_f32 v243, v228, 0x3b900000, v229
    v_cos_f32 v241, v243
    v_sin_f32 v242, v243
    v_mul_f32 v236, v137, v241
    v_mul_f32 v238, v169, v241
    v_fma_f32 v236, -v169, v242, v236
    v_fma_f32 v238, v137, v242, v238
    v_cvt_pk_bf16_f32 v86, v235, v236
    v_cvt_pk_bf16_f32 v102, v237, v238
    v_cvt_pk_bf16_f32 v118, -v237, -v238
    v_fmamk_f32 v243, v228, 0x3ba00000, v229
    v_cos_f32 v239, v243
    v_sin_f32 v240, v243
    v_mul_f32 v235, v138, v239
    v_mul_f32 v237, v170, v239
    v_fma_f32 v235, -v170, v240, v235
    v_fma_f32 v237, v138, v240, v237
    v_fmamk_f32 v243, v228, 0x3bb00000, v229
    v_cos_f32 v241, v243
    v_sin_f32 v242, v243
    v_mul_f32 v236, v139, v241
    v_mul_f32 v238, v171, v241
    v_fma_f32 v236, -v171, v242, v236
    v_fma_f32 v238, v139, v242, v238
    v_cvt_pk_bf16_f32 v87, v235, v236
    v_cvt_pk_bf16_f32 v103, v237, v238
    v_cvt_pk_bf16_f32 v119, -v237, -v238
    v_fmamk_f32 v243, v228, 0x3c000000, v229
    v_cos_f32 v239, v243
    v_sin_f32 v240, v243
    v_mul_f32 v235, v140, v239
    v_mul_f32 v237, v172, v239
    v_fma_f32 v235, -v172, v240, v235
    v_fma_f32 v237, v140, v240, v237
    v_fmamk_f32 v243, v228, 0x3c080000, v229
    v_cos_f32 v241, v243
    v_sin_f32 v242, v243
    v_mul_f32 v236, v141, v241
    v_mul_f32 v238, v173, v241
    v_fma_f32 v236, -v173, v242, v236
    v_fma_f32 v238, v141, v242, v238
    v_cvt_pk_bf16_f32 v88, v235, v236
    v_cvt_pk_bf16_f32 v104, v237, v238
    v_cvt_pk_bf16_f32 v120, -v237, -v238
    v_fmamk_f32 v243, v228, 0x3c100000, v229
    v_cos_f32 v239, v243
    v_sin_f32 v240, v243
    v_mul_f32 v235, v142, v239
    v_mul_f32 v237, v174, v239
    v_fma_f32 v235, -v174, v240, v235
    v_fma_f32 v237, v142, v240, v237
    v_fmamk_f32 v243, v228, 0x3c180000, v229
    v_cos_f32 v241, v243
    v_sin_f32 v242, v243
    v_mul_f32 v236, v143, v241
    v_mul_f32 v238, v175, v241
    v_fma_f32 v236, -v175, v242, v236
    v_fma_f32 v238, v143, v242, v238
    v_cvt_pk_bf16_f32 v89, v235, v236
    v_cvt_pk_bf16_f32 v105, v237, v238
    v_cvt_pk_bf16_f32 v121, -v237, -v238
    v_fmamk_f32 v243, v228, 0x3c400000, v229
    v_cos_f32 v239, v243
    v_sin_f32 v240, v243
    v_mul_f32 v235, v144, v239
    v_mul_f32 v237, v176, v239
    v_fma_f32 v235, -v176, v240, v235
    v_fma_f32 v237, v144, v240, v237
    v_fmamk_f32 v243, v228, 0x3c480000, v229
    v_cos_f32 v241, v243
    v_sin_f32 v242, v243
    v_mul_f32 v236, v145, v241
    v_mul_f32 v238, v177, v241
    v_fma_f32 v236, -v177, v242, v236
    v_fma_f32 v238, v145, v242, v238
    v_cvt_pk_bf16_f32 v90, v235, v236
    v_cvt_pk_bf16_f32 v106, v237, v238
    v_cvt_pk_bf16_f32 v122, -v237, -v238
    v_fmamk_f32 v243, v228, 0x3c500000, v229
    v_cos_f32 v239, v243
    v_sin_f32 v240, v243
    v_mul_f32 v235, v146, v239
    v_mul_f32 v237, v178, v239
    v_fma_f32 v235, -v178, v240, v235
    v_fma_f32 v237, v146, v240, v237
    v_fmamk_f32 v243, v228, 0x3c580000, v229
    v_cos_f32 v241, v243
    v_sin_f32 v242, v243
    v_mul_f32 v236, v147, v241
    v_mul_f32 v238, v179, v241
    v_fma_f32 v236, -v179, v242, v236
    v_fma_f32 v238, v147, v242, v238
    v_cvt_pk_bf16_f32 v91, v235, v236
    v_cvt_pk_bf16_f32 v107, v237, v238
    v_cvt_pk_bf16_f32 v123, -v237, -v238
    v_add_f32 v228, 0x42000000, v228
    v_mov_b32 v229, v230
    v_fmamk_f32 v243, v228, 0x0, v229
    v_cos_f32 v239, v243
    v_sin_f32 v240, v243
    v_mul_f32 v235, v148, v239
    v_mul_f32 v237, v180, v239
    v_fma_f32 v235, -v180, v240, v235
    v_fma_f32 v237, v148, v240, v237
    v_fmamk_f32 v243, v228, 0x3a000000, v229
    v_cos_f32 v241, v243
    v_sin_f32 v242, v243
    v_mul_f32 v236, v149, v241
    v_mul_f32 v238, v181, v241
    v_fma_f32 v236, -v181, v242, v236
    v_fma_f32 v238, v149, v242, v238
    v_cvt_pk_bf16_f32 v92, v235, v236
    v_cvt_pk_bf16_f32 v108, v237, v238
    v_cvt_pk_bf16_f32 v124, -v237, -v238
    v_fmamk_f32 v243, v228, 0x3a800000, v229
    v_cos_f32 v239, v243
    v_sin_f32 v240, v243
    v_mul_f32 v235, v150, v239
    v_mul_f32 v237, v182, v239
    v_fma_f32 v235, -v182, v240, v235
    v_fma_f32 v237, v150, v240, v237
    v_fmamk_f32 v243, v228, 0x3ac00000, v229
    v_cos_f32 v241, v243
    v_sin_f32 v242, v243
    v_mul_f32 v236, v151, v241
    v_mul_f32 v238, v183, v241
    v_fma_f32 v236, -v183, v242, v236
    v_fma_f32 v238, v151, v242, v238
    v_cvt_pk_bf16_f32 v93, v235, v236
    v_cvt_pk_bf16_f32 v109, v237, v238
    v_cvt_pk_bf16_f32 v125, -v237, -v238
    v_fmamk_f32 v243, v228, 0x3b800000, v229
    v_cos_f32 v239, v243
    v_sin_f32 v240, v243
    v_mul_f32 v235, v152, v239
    v_mul_f32 v237, v184, v239
    v_fma_f32 v235, -v184, v240, v235
    v_fma_f32 v237, v152, v240, v237
    v_fmamk_f32 v243, v228, 0x3b900000, v229
    v_cos_f32 v241, v243
    v_sin_f32 v242, v243
    v_mul_f32 v236, v153, v241
    v_mul_f32 v238, v185, v241
    v_fma_f32 v236, -v185, v242, v236
    v_fma_f32 v238, v153, v242, v238
    v_cvt_pk_bf16_f32 v94, v235, v236
    v_cvt_pk_bf16_f32 v110, v237, v238
    v_cvt_pk_bf16_f32 v126, -v237, -v238
    v_fmamk_f32 v243, v228, 0x3ba00000, v229
    v_cos_f32 v239, v243
    v_sin_f32 v240, v243
    v_mul_f32 v235, v154, v239
    v_mul_f32 v237, v186, v239
    v_fma_f32 v235, -v186, v240, v235
    v_fma_f32 v237, v154, v240, v237
    v_fmamk_f32 v243, v228, 0x3bb00000, v229
    v_cos_f32 v241, v243
    v_sin_f32 v242, v243
    v_mul_f32 v236, v155, v241
    v_mul_f32 v238, v187, v241
    v_fma_f32 v236, -v187, v242, v236
    v_fma_f32 v238, v155, v242, v238
    v_cvt_pk_bf16_f32 v95, v235, v236
    v_cvt_pk_bf16_f32 v111, v237, v238
    v_cvt_pk_bf16_f32 v127, -v237, -v238
    v_fmamk_f32 v243, v228, 0x3c000000, v229
    v_cos_f32 v239, v243
    v_sin_f32 v240, v243
    v_mul_f32 v235, v156, v239
    v_mul_f32 v237, v188, v239
    v_fma_f32 v235, -v188, v240, v235
    v_fma_f32 v237, v156, v240, v237
    v_fmamk_f32 v243, v228, 0x3c080000, v229
    v_cos_f32 v241, v243
    v_sin_f32 v242, v243
    v_mul_f32 v236, v157, v241
    v_mul_f32 v238, v189, v241
    v_fma_f32 v236, -v189, v242, v236
    v_fma_f32 v238, v157, v242, v238
    v_cvt_pk_bf16_f32 v96, v235, v236
    v_cvt_pk_bf16_f32 v112, v237, v238
    v_cvt_pk_bf16_f32 v128, -v237, -v238
    v_fmamk_f32 v243, v228, 0x3c100000, v229
    v_cos_f32 v239, v243
    v_sin_f32 v240, v243
    v_mul_f32 v235, v158, v239
    v_mul_f32 v237, v190, v239
    v_fma_f32 v235, -v190, v240, v235
    v_fma_f32 v237, v158, v240, v237
    v_fmamk_f32 v243, v228, 0x3c180000, v229
    v_cos_f32 v241, v243
    v_sin_f32 v242, v243
    v_mul_f32 v236, v159, v241
    v_mul_f32 v238, v191, v241
    v_fma_f32 v236, -v191, v242, v236
    v_fma_f32 v238, v159, v242, v238
    v_cvt_pk_bf16_f32 v97, v235, v236
    v_cvt_pk_bf16_f32 v113, v237, v238
    v_cvt_pk_bf16_f32 v129, -v237, -v238
    v_fmamk_f32 v243, v228, 0x3c400000, v229
    v_cos_f32 v239, v243
    v_sin_f32 v240, v243
    v_mul_f32 v235, v160, v239
    v_mul_f32 v237, v192, v239
    v_fma_f32 v235, -v192, v240, v235
    v_fma_f32 v237, v160, v240, v237
    v_fmamk_f32 v243, v228, 0x3c480000, v229
    v_cos_f32 v241, v243
    v_sin_f32 v242, v243
    v_mul_f32 v236, v161, v241
    v_mul_f32 v238, v193, v241
    v_fma_f32 v236, -v193, v242, v236
    v_fma_f32 v238, v161, v242, v238
    v_cvt_pk_bf16_f32 v98, v235, v236
    v_cvt_pk_bf16_f32 v114, v237, v238
    v_cvt_pk_bf16_f32 v130, -v237, -v238
    v_fmamk_f32 v243, v228, 0x3c500000, v229
    v_cos_f32 v239, v243
    v_sin_f32 v240, v243
    v_mul_f32 v235, v162, v239
    v_mul_f32 v237, v194, v239
    v_fma_f32 v235, -v194, v240, v235
    v_fma_f32 v237, v162, v240, v237
    v_fmamk_f32 v243, v228, 0x3c580000, v229
    v_cos_f32 v241, v243
    v_sin_f32 v242, v243
    v_mul_f32 v236, v163, v241
    v_mul_f32 v238, v195, v241
    v_fma_f32 v236, -v195, v242, v236
    v_fma_f32 v238, v163, v242, v238
    v_cvt_pk_bf16_f32 v99, v235, v236
    v_cvt_pk_bf16_f32 v115, v237, v238
    v_cvt_pk_bf16_f32 v131, -v237, -v238
    v_mfma_f32_32x32x16_bf16 v[132:147], v[68:71], v[84:87], 0
    v_mfma_f32_32x32x16_bf16 v[164:179], v[68:71], v[100:103], 0
    v_mfma_f32_32x32x16_bf16 v[132:147], v[76:79], v[116:119], v[132:147]
    v_mfma_f32_32x32x16_bf16 v[164:179], v[76:79], v[84:87], v[164:179]
    v_mfma_f32_32x32x16_bf16 v[132:147], v[72:75], v[88:91], v[132:147]
    v_mfma_f32_32x32x16_bf16 v[164:179], v[72:75], v[104:107], v[164:179]
    v_mfma_f32_32x32x16_bf16 v[132:147], v[80:83], v[120:123], v[132:147]
    v_mfma_f32_32x32x16_bf16 v[164:179], v[80:83], v[88:91], v[164:179]
    v_mfma_f32_32x32x16_bf16 v[148:163], v[68:71], v[92:95], 0
    v_mfma_f32_32x32x16_bf16 v[180:195], v[68:71], v[108:111], 0
    v_mfma_f32_32x32x16_bf16 v[148:163], v[76:79], v[124:127], v[148:163]
    v_mfma_f32_32x32x16_bf16 v[180:195], v[76:79], v[92:95], v[180:195]
    v_mfma_f32_32x32x16_bf16 v[148:163], v[72:75], v[96:99], v[148:163]
    v_mfma_f32_32x32x16_bf16 v[180:195], v[72:75], v[112:115], v[180:195]
    v_mfma_f32_32x32x16_bf16 v[148:163], v[80:83], v[128:131], v[148:163]
    v_mfma_f32_32x32x16_bf16 v[180:195], v[80:83], v[96:99], v[180:195]
    v_lshlrev_b32 v231, 4, v1
    v_add_u32 v232, s6, v231
    s_lshl_b32 s5, s3, 12
    s_add_u32 s5, s5, 0x5800000
    s_add_u32 s2, s5, 4096
    v_cvt_pk_bf16_f32 v84, v132, v133
    v_cvt_pk_bf16_f32 v85, v134, v135
    v_cvt_pk_bf16_f32 v86, v136, v137
    v_cvt_pk_bf16_f32 v87, v138, v139
    buffer_store_dwordx4 v[84:87], v231, s[8:11], s5 offen offset:0 sc1
    v_cvt_pk_bf16_f32 v88, v140, v141
    v_cvt_pk_bf16_f32 v89, v142, v143
    v_cvt_pk_bf16_f32 v90, v144, v145
    v_cvt_pk_bf16_f32 v91, v146, v147
    buffer_store_dwordx4 v[88:91], v231, s[8:11], s5 offen offset:1024 sc1
    v_cvt_pk_bf16_f32 v92, v148, v149
    v_cvt_pk_bf16_f32 v93, v150, v151
    v_cvt_pk_bf16_f32 v94, v152, v153
    v_cvt_pk_bf16_f32 v95, v154, v155
    buffer_store_dwordx4 v[92:95], v231, s[8:11], s5 offen offset:2048 sc1
    v_cvt_pk_bf16_f32 v96, v156, v157
    v_cvt_pk_bf16_f32 v97, v158, v159
    v_cvt_pk_bf16_f32 v98, v160, v161
    v_cvt_pk_bf16_f32 v99, v162, v163
    buffer_store_dwordx4 v[96:99], v231, s[8:11], s5 offen offset:3072 sc1
    v_cvt_pk_bf16_f32 v100, v164, v165
    v_cvt_pk_bf16_f32 v101, v166, v167
    v_cvt_pk_bf16_f32 v102, v168, v169
    v_cvt_pk_bf16_f32 v103, v170, v171
    buffer_store_dwordx4 v[100:103], v232, s[8:11], s2 offen offset:0 sc1
    v_cvt_pk_bf16_f32 v104, v172, v173
    v_cvt_pk_bf16_f32 v105, v174, v175
    v_cvt_pk_bf16_f32 v106, v176, v177
    v_cvt_pk_bf16_f32 v107, v178, v179
    buffer_store_dwordx4 v[104:107], v232, s[8:11], s2 offen offset:1024 sc1
    v_cvt_pk_bf16_f32 v108, v180, v181
    v_cvt_pk_bf16_f32 v109, v182, v183
    v_cvt_pk_bf16_f32 v110, v184, v185
    v_cvt_pk_bf16_f32 v111, v186, v187
    buffer_store_dwordx4 v[108:111], v232, s[8:11], s2 offen offset:2048 sc1
    v_cvt_pk_bf16_f32 v112, v188, v189
    v_cvt_pk_bf16_f32 v113, v190, v191
    v_cvt_pk_bf16_f32 v114, v192, v193
    v_cvt_pk_bf16_f32 v115, v194, v195
    buffer_store_dwordx4 v[112:115], v232, s[8:11], s2 offen offset:3072 sc1
    s_add_u32 s7, s7, 8
    s_cmp_lt_u32 s7, 16
    s_cbranch_scc1 colloop_139
    s_cmp_eq_u32 s3, 1008
    s_cbranch_scc1 colloop_139
    s_waitcnt vmcnt(0) lgkmcnt(0)
    s_barrier
    s_cmp_lg_u32 s58, 0
    s_cbranch_scc1 sig_141
    v_mov_b32 v75, 0x5ffffff0
    v_mov_b32 v76, 44
    v_cmp_eq_u32 vcc, 0, v1
    s_nop 1
    v_cndmask_b32 v76, v75, v76, vcc
    v_mov_b32 v75, 1
    buffer_atomic_add v75, v76, s[12:15], 0 offen sc1
sig_141:
    v_bfe_u32 v76, v1, 2, 2
    v_sub_u32 v76, 0, v76
    v_lshrrev_b32 v75, 4, v1
    v_xor_b32 v76, v76, v75
    v_and_b32 v76, 3, v76
    v_bfe_u32 v72, v1, 0, 4
    v_lshlrev_b32 v72, 6, v72
    v_lshl_or_b32 v72, v76, 4, v72
    s_lshr_b32 s74, s58, 2
    s_mul_i32 s74, s74, 8192
    v_add_u32 v72, s74, v72
    v_bfe_u32 v73, v1, 0, 2
    v_lshlrev_b32 v73, 3, v73
    v_bfe_u32 v75, v1, 4, 1
    v_lshl_or_b32 v73, v75, 5, v73
    v_bfe_u32 v75, v1, 2, 2
    v_lshl_or_b32 v73, v75, 6, v73
    v_bfe_u32 v75, v1, 2, 2
    v_lshl_or_b32 v73, v75, 9, v73
    v_bfe_u32 v75, v1, 4, 2
    v_lshl_or_b32 v73, v75, 12, v73
    s_and_b32 s74, s58, 3
    s_mul_i32 s74, s74, 128
    s_or_b32 s74, s74, 16384
    v_xor_b32 v73, s74, v73
    s_mov_b64 s[60:61], s[8:9]
    s_mov_b32 s62, 0x10000000
    s_mov_b32 s63, 0x20000
    s_mov_b64 s[64:65], s[8:9]
    s_mov_b32 s66, 0x10000000
    s_mov_b32 s67, 0x20000
    v_lshrrev_b32 v76, 4, v1
    v_sub_u32 v76, 0, v76
    v_xor_b32 v76, v76, v1
    v_and_b32 v76, 3, v76
    s_mul_i32 s74, s58, 32
    v_lshrrev_b32 v77, 2, v1
    v_add3_u32 v77, v77, s74, 0
    v_bfe_u32 v68, v77, 0, 2
    v_lshlrev_b32 v68, 11, v68
    v_bfe_u32 v75, v77, 4, 1
    v_lshl_or_b32 v68, v75, 13, v68
    v_bfe_u32 v75, v77, 2, 2
    v_lshl_or_b32 v68, v75, 14, v68
    v_bfe_u32 v75, v77, 5, 3
    v_lshl_or_b32 v68, v75, 16, v68
    v_lshl_add_u32 v68, v76, 4, v68
    v_lshrrev_b32 v77, 2, v1
    v_add3_u32 v77, v77, s74, 16
    v_bfe_u32 v69, v77, 0, 2
    v_lshlrev_b32 v69, 11, v69
    v_bfe_u32 v75, v77, 4, 1
    v_lshl_or_b32 v69, v75, 13, v69
    v_bfe_u32 v75, v77, 2, 2
    v_lshl_or_b32 v69, v75, 14, v69
    v_bfe_u32 v75, v77, 5, 3
    v_lshl_or_b32 v69, v75, 16, v69
    v_lshl_add_u32 v69, v76, 4, v69
    s_and_b32 s74, s58, 2
    v_bfe_u32 v76, v1, 0, 5
    v_bfe_u32 v77, v1, 5, 1
    v_lshlrev_b32 v77, 2, v77
    v_xor_b32 v76, v76, v77
    v_xor_b32 v76, s74, v76
    v_lshlrev_b32 v77, 4, v76
    v_lshrrev_b32 v76, 5, v1
    v_lshl_add_u32 v70, v76, 12, v77
    v_bfe_u32 v76, v1, 0, 5
    v_bfe_u32 v77, v1, 5, 1
    v_lshlrev_b32 v77, 2, v77
    v_xor_b32 v76, v76, v77
    v_xor_b32 v76, s74, v76
    v_xor_b32 v76, 8, v76
    v_lshlrev_b32 v77, 4, v76
    v_lshrrev_b32 v76, 5, v1
    v_lshl_add_u32 v71, v76, 12, v77
    v_add_u32 v71, 8192, v71
    s_lshl_b32 s74, s58, 14
    v_add_u32 v70, s74, v70
    v_add_u32 v71, s74, v71
    s_mov_b32 s70, 131072
    s_and_b32 s79, s57, 3
    s_bfe_u32 s80, s76, 0x10002
    s_bfe_u32 s85, s76, 0x20005
    s_lshl_b32 s85, s85, 1
    s_or_b32 s80, s80, s85
    s_lshl_b32 s68, s79, 19
    s_add_u32 s68, s68, 0x5200000
    s_lshl_b32 s69, s80, 9
    s_add_u32 s69, s69, 0x5800000
    s_cmp_lg_u32 s58, 0
    s_cbranch_scc1 wall_142
    v_mov_b32 v76, 168
wctr_143:
    buffer_load_dword v75, v76, s[12:15], 0 offen sc1
    s_waitcnt vmcnt(0)
    v_cmp_ne_u32 vcc, 2097216, v75
    s_cbranch_vccz wctr_ok_144
    s_sub_u32 s77, s77, 1
    s_cbranch_scc0 wctr_143
    s_mov_b32 s77, 0
wctr_ok_144:
wall_142:
    s_cmp_lg_u32 s58, 0
    s_cbranch_scc1 wall_145
    v_mov_b32 v76, 44
wctr_146:
    buffer_load_dword v75, v76, s[12:15], 0 offen sc1
    s_waitcnt vmcnt(0)
    v_cmp_gt_u16 vcc, 32, v75
    s_cbranch_vccz wctr_ok_147
    s_sub_u32 s77, s77, 1
    s_cbranch_scc0 wctr_146
    s_mov_b32 s77, 0
wctr_ok_147:
wall_145:
    s_barrier
    s_mul_i32 s71, s58, 2048
    s_mov_b32 m0, s71
    s_nop 0
    buffer_load_dwordx4 v68, s[60:63], s68 offen lds
    s_add_u32 m0, s71, 1024
    s_nop 0
    buffer_load_dwordx4 v69, s[60:63], s68 offen lds
    s_add_u32 m0, s71, 16384
    s_nop 0
    buffer_load_dwordx4 v70, s[64:67], s69 offen lds
    s_add_u32 m0, s71, 17408
    s_nop 0
    buffer_load_dwordx4 v71, s[64:67], s69 offen lds
    s_add_u32 s68, s68, 64
    s_add_u32 s69, s69, s70
    s_add_u32 s71, s71, 32768
    s_and_b32 s71, s71, 0x1ffff
    s_mov_b32 m0, s71
    s_nop 0
    buffer_load_dwordx4 v68, s[60:63], s68 offen lds
    s_add_u32 m0, s71, 1024
    s_nop 0
    buffer_load_dwordx4 v69, s[60:63], s68 offen lds
    s_add_u32 m0, s71, 16384
    s_nop 0
    buffer_load_dwordx4 v70, s[64:67], s69 offen lds
    s_add_u32 m0, s71, 17408
    s_nop 0
    buffer_load_dwordx4 v71, s[64:67], s69 offen lds
    s_add_u32 s68, s68, 64
    s_add_u32 s69, s69, s70
    s_add_u32 s71, s71, 32768
    s_and_b32 s71, s71, 0x1ffff
    s_mov_b32 m0, s71
    s_nop 0
    buffer_load_dwordx4 v68, s[60:63], s68 offen lds
    s_add_u32 m0, s71, 1024
    s_nop 0
    buffer_load_dwordx4 v69, s[60:63], s68 offen lds
    s_add_u32 m0, s71, 16384
    s_nop 0
    buffer_load_dwordx4 v70, s[64:67], s69 offen lds
    s_add_u32 m0, s71, 17408
    s_nop 0
    buffer_load_dwordx4 v71, s[64:67], s69 offen lds
    s_add_u32 s68, s68, 64
    s_add_u32 s69, s69, s70
    s_add_u32 s71, s71, 32768
    s_and_b32 s71, s71, 0x1ffff
    s_mov_b32 m0, s71
    s_nop 0
    buffer_load_dwordx4 v68, s[60:63], s68 offen lds
    s_add_u32 m0, s71, 1024
    s_nop 0
    buffer_load_dwordx4 v69, s[60:63], s68 offen lds
    s_add_u32 m0, s71, 16384
    s_nop 0
    buffer_load_dwordx4 v70, s[64:67], s69 offen lds
    s_add_u32 m0, s71, 17408
    s_nop 0
    buffer_load_dwordx4 v71, s[64:67], s69 offen lds
    s_add_u32 s68, s68, 64
    s_add_u32 s69, s69, s70
    s_add_u32 s71, s71, 32768
    s_and_b32 s71, s71, 0x1ffff
    s_mov_b32 s72, 0
    s_waitcnt vmcnt(12)
    s_barrier
    v_add_u32 v74, s72, v72
    v_add_u32 v75, s72, v73
    v_xor_b32 v76, 32, v75
    v_xor_b32 v77, 64, v75
    v_xor_b32 v78, 96, v75
    s_add_u32 s72, s72, 32768
    s_and_b32 s72, s72, 0x1ffff
    ds_read_b128 v[4:7], v74 offset:0
    ds_read_b128 v[8:11], v74 offset:1024
    ds_read_b128 v[12:15], v74 offset:2048
    ds_read_b128 v[16:19], v74 offset:3072
    ds_read_b64_tr_b16 v[36:37], v75 offset:0
    ds_read_b64_tr_b16 v[38:39], v75 offset:2048
    ds_read_b64_tr_b16 v[40:41], v76 offset:0
    ds_read_b64_tr_b16 v[42:43], v76 offset:2048
    ds_read_b64_tr_b16 v[44:45], v77 offset:0
    ds_read_b64_tr_b16 v[46:47], v77 offset:2048
    ds_read_b64_tr_b16 v[48:49], v78 offset:0
    ds_read_b64_tr_b16 v[50:51], v78 offset:2048
    s_waitcnt lgkmcnt(0)
    v_mfma_f32_16x16x32_bf16 v[80:83], v[4:7], v[36:39], 0
    ds_read_b128 v[20:23], v74 offset:4096
    v_mfma_f32_16x16x32_bf16 v[84:87], v[4:7], v[40:43], 0
    v_mfma_f32_16x16x32_bf16 v[88:91], v[4:7], v[44:47], 0
    ds_read_b128 v[24:27], v74 offset:5120
    v_mfma_f32_16x16x32_bf16 v[92:95], v[4:7], v[48:51], 0
    v_mfma_f32_16x16x32_bf16 v[96:99], v[8:11], v[36:39], 0
    ds_read_b128 v[28:31], v74 offset:6144
    v_mfma_f32_16x16x32_bf16 v[100:103], v[8:11], v[40:43], 0
    v_mfma_f32_16x16x32_bf16 v[104:107], v[8:11], v[44:47], 0
    ds_read_b128 v[32:35], v74 offset:7168
    v_mfma_f32_16x16x32_bf16 v[108:111], v[8:11], v[48:51], 0
    v_mfma_f32_16x16x32_bf16 v[112:115], v[12:15], v[36:39], 0
    v_mfma_f32_16x16x32_bf16 v[116:119], v[12:15], v[40:43], 0
    v_mfma_f32_16x16x32_bf16 v[120:123], v[12:15], v[44:47], 0
    v_mfma_f32_16x16x32_bf16 v[124:127], v[12:15], v[48:51], 0
    v_mfma_f32_16x16x32_bf16 v[128:131], v[16:19], v[36:39], 0
    v_mfma_f32_16x16x32_bf16 v[132:135], v[16:19], v[40:43], 0
    v_mfma_f32_16x16x32_bf16 v[136:139], v[16:19], v[44:47], 0
    v_mfma_f32_16x16x32_bf16 v[140:143], v[16:19], v[48:51], 0
    s_waitcnt vmcnt(8) lgkmcnt(0)
    s_barrier
    v_mfma_f32_16x16x32_bf16 v[144:147], v[20:23], v[36:39], 0
    v_add_u32 v74, s72, v72
    v_add_u32 v75, s72, v73
    v_xor_b32 v76, 32, v75
    v_xor_b32 v77, 64, v75
    v_xor_b32 v78, 96, v75
    v_mfma_f32_16x16x32_bf16 v[148:151], v[20:23], v[40:43], 0
    s_add_u32 s72, s72, 32768
    s_and_b32 s72, s72, 0x1ffff
    ds_read_b128 v[4:7], v74 offset:0
    v_mfma_f32_16x16x32_bf16 v[152:155], v[20:23], v[44:47], 0
    ds_read_b64_tr_b16 v[52:53], v75 offset:0
    v_mfma_f32_16x16x32_bf16 v[156:159], v[20:23], v[48:51], 0
    ds_read_b64_tr_b16 v[54:55], v75 offset:2048
    ds_read_b64_tr_b16 v[56:57], v76 offset:0
    v_mfma_f32_16x16x32_bf16 v[160:163], v[24:27], v[36:39], 0
    ds_read_b64_tr_b16 v[58:59], v76 offset:2048
    v_mfma_f32_16x16x32_bf16 v[164:167], v[24:27], v[40:43], 0
    ds_read_b64_tr_b16 v[60:61], v77 offset:0
    ds_read_b64_tr_b16 v[62:63], v77 offset:2048
    v_mfma_f32_16x16x32_bf16 v[168:171], v[24:27], v[44:47], 0
    ds_read_b64_tr_b16 v[64:65], v78 offset:0
    v_mfma_f32_16x16x32_bf16 v[172:175], v[24:27], v[48:51], 0
    ds_read_b64_tr_b16 v[66:67], v78 offset:2048
    ds_read_b128 v[8:11], v74 offset:1024
    v_mfma_f32_16x16x32_bf16 v[176:179], v[28:31], v[36:39], 0
    ds_read_b128 v[12:15], v74 offset:2048
    ds_read_b128 v[16:19], v74 offset:3072
    v_mfma_f32_16x16x32_bf16 v[180:183], v[28:31], v[40:43], 0
    s_mov_b32 m0, s71
    v_mfma_f32_16x16x32_bf16 v[184:187], v[28:31], v[44:47], 0
    buffer_load_dwordx4 v68, s[60:63], s68 offen lds
    s_add_u32 m0, s71, 1024
    v_mfma_f32_16x16x32_bf16 v[188:191], v[28:31], v[48:51], 0
    buffer_load_dwordx4 v69, s[60:63], s68 offen lds
    v_mfma_f32_16x16x32_bf16 v[192:195], v[32:35], v[36:39], 0
    s_add_u32 m0, s71, 16384
    s_nop 0
    buffer_load_dwordx4 v70, s[64:67], s69 offen lds
    v_mfma_f32_16x16x32_bf16 v[196:199], v[32:35], v[40:43], 0
    s_add_u32 m0, s71, 17408
    v_mfma_f32_16x16x32_bf16 v[200:203], v[32:35], v[44:47], 0
    buffer_load_dwordx4 v71, s[64:67], s69 offen lds
    s_add_u32 s68, s68, 64
    s_add_u32 s69, s69, s70
    v_mfma_f32_16x16x32_bf16 v[204:207], v[32:35], v[48:51], 0
    s_add_u32 s71, s71, 32768
    s_and_b32 s71, s71, 0x1ffff
    s_waitcnt lgkmcnt(0)
    v_mfma_f32_16x16x32_bf16 v[80:83], v[4:7], v[52:55], v[80:83]
    ds_read_b128 v[20:23], v74 offset:4096
    v_mfma_f32_16x16x32_bf16 v[84:87], v[4:7], v[56:59], v[84:87]
    v_mfma_f32_16x16x32_bf16 v[88:91], v[4:7], v[60:63], v[88:91]
    ds_read_b128 v[24:27], v74 offset:5120
    v_mfma_f32_16x16x32_bf16 v[92:95], v[4:7], v[64:67], v[92:95]
    v_mfma_f32_16x16x32_bf16 v[96:99], v[8:11], v[52:55], v[96:99]
    ds_read_b128 v[28:31], v74 offset:6144
    v_mfma_f32_16x16x32_bf16 v[100:103], v[8:11], v[56:59], v[100:103]
    v_mfma_f32_16x16x32_bf16 v[104:107], v[8:11], v[60:63], v[104:107]
    ds_read_b128 v[32:35], v74 offset:7168
    v_mfma_f32_16x16x32_bf16 v[108:111], v[8:11], v[64:67], v[108:111]
    v_mfma_f32_16x16x32_bf16 v[112:115], v[12:15], v[52:55], v[112:115]
    v_mfma_f32_16x16x32_bf16 v[116:119], v[12:15], v[56:59], v[116:119]
    v_mfma_f32_16x16x32_bf16 v[120:123], v[12:15], v[60:63], v[120:123]
    v_mfma_f32_16x16x32_bf16 v[124:127], v[12:15], v[64:67], v[124:127]
    v_mfma_f32_16x16x32_bf16 v[128:131], v[16:19], v[52:55], v[128:131]
    v_mfma_f32_16x16x32_bf16 v[132:135], v[16:19], v[56:59], v[132:135]
    v_mfma_f32_16x16x32_bf16 v[136:139], v[16:19], v[60:63], v[136:139]
    v_mfma_f32_16x16x32_bf16 v[140:143], v[16:19], v[64:67], v[140:143]
    s_waitcnt vmcnt(8) lgkmcnt(0)
    s_barrier
    v_mfma_f32_16x16x32_bf16 v[144:147], v[20:23], v[52:55], v[144:147]
    v_add_u32 v74, s72, v72
    v_add_u32 v75, s72, v73
    v_xor_b32 v76, 32, v75
    v_xor_b32 v77, 64, v75
    v_xor_b32 v78, 96, v75
    v_mfma_f32_16x16x32_bf16 v[148:151], v[20:23], v[56:59], v[148:151]
    s_add_u32 s72, s72, 32768
    s_and_b32 s72, s72, 0x1ffff
    ds_read_b128 v[4:7], v74 offset:0
    v_mfma_f32_16x16x32_bf16 v[152:155], v[20:23], v[60:63], v[152:155]
    ds_read_b64_tr_b16 v[36:37], v75 offset:0
    v_mfma_f32_16x16x32_bf16 v[156:159], v[20:23], v[64:67], v[156:159]
    ds_read_b64_tr_b16 v[38:39], v75 offset:2048
    ds_read_b64_tr_b16 v[40:41], v76 offset:0
    v_mfma_f32_16x16x32_bf16 v[160:163], v[24:27], v[52:55], v[160:163]
    ds_read_b64_tr_b16 v[42:43], v76 offset:2048
    v_mfma_f32_16x16x32_bf16 v[164:167], v[24:27], v[56:59], v[164:167]
    ds_read_b64_tr_b16 v[44:45], v77 offset:0
    ds_read_b64_tr_b16 v[46:47], v77 offset:2048
    v_mfma_f32_16x16x32_bf16 v[168:171], v[24:27], v[60:63], v[168:171]
    ds_read_b64_tr_b16 v[48:49], v78 offset:0
    v_mfma_f32_16x16x32_bf16 v[172:175], v[24:27], v[64:67], v[172:175]
    ds_read_b64_tr_b16 v[50:51], v78 offset:2048
    ds_read_b128 v[8:11], v74 offset:1024
    v_mfma_f32_16x16x32_bf16 v[176:179], v[28:31], v[52:55], v[176:179]
    ds_read_b128 v[12:15], v74 offset:2048
    ds_read_b128 v[16:19], v74 offset:3072
    v_mfma_f32_16x16x32_bf16 v[180:183], v[28:31], v[56:59], v[180:183]
    s_mov_b32 m0, s71
    v_mfma_f32_16x16x32_bf16 v[184:187], v[28:31], v[60:63], v[184:187]
    buffer_load_dwordx4 v68, s[60:63], s68 offen lds
    s_add_u32 m0, s71, 1024
    v_mfma_f32_16x16x32_bf16 v[188:191], v[28:31], v[64:67], v[188:191]
    buffer_load_dwordx4 v69, s[60:63], s68 offen lds
    v_mfma_f32_16x16x32_bf16 v[192:195], v[32:35], v[52:55], v[192:195]
    s_add_u32 m0, s71, 16384
    s_nop 0
    buffer_load_dwordx4 v70, s[64:67], s69 offen lds
    v_mfma_f32_16x16x32_bf16 v[196:199], v[32:35], v[56:59], v[196:199]
    s_add_u32 m0, s71, 17408
    v_mfma_f32_16x16x32_bf16 v[200:203], v[32:35], v[60:63], v[200:203]
    buffer_load_dwordx4 v71, s[64:67], s69 offen lds
    s_add_u32 s68, s68, 64
    s_add_u32 s69, s69, s70
    v_mfma_f32_16x16x32_bf16 v[204:207], v[32:35], v[64:67], v[204:207]
    s_add_u32 s71, s71, 32768
    s_and_b32 s71, s71, 0x1ffff
    s_mov_b32 s73, 13
gl_148:
    s_waitcnt lgkmcnt(0)
    v_mfma_f32_16x16x32_bf16 v[80:83], v[4:7], v[36:39], v[80:83]
    ds_read_b128 v[20:23], v74 offset:4096
    v_mfma_f32_16x16x32_bf16 v[84:87], v[4:7], v[40:43], v[84:87]
    v_mfma_f32_16x16x32_bf16 v[88:91], v[4:7], v[44:47], v[88:91]
    ds_read_b128 v[24:27], v74 offset:5120
    v_mfma_f32_16x16x32_bf16 v[92:95], v[4:7], v[48:51], v[92:95]
    v_mfma_f32_16x16x32_bf16 v[96:99], v[8:11], v[36:39], v[96:99]
    ds_read_b128 v[28:31], v74 offset:6144
    v_mfma_f32_16x16x32_bf16 v[100:103], v[8:11], v[40:43], v[100:103]
    v_mfma_f32_16x16x32_bf16 v[104:107], v[8:11], v[44:47], v[104:107]
    ds_read_b128 v[32:35], v74 offset:7168
    v_mfma_f32_16x16x32_bf16 v[108:111], v[8:11], v[48:51], v[108:111]
    v_mfma_f32_16x16x32_bf16 v[112:115], v[12:15], v[36:39], v[112:115]
    v_mfma_f32_16x16x32_bf16 v[116:119], v[12:15], v[40:43], v[116:119]
    v_mfma_f32_16x16x32_bf16 v[120:123], v[12:15], v[44:47], v[120:123]
    v_mfma_f32_16x16x32_bf16 v[124:127], v[12:15], v[48:51], v[124:127]
    v_mfma_f32_16x16x32_bf16 v[128:131], v[16:19], v[36:39], v[128:131]
    v_mfma_f32_16x16x32_bf16 v[132:135], v[16:19], v[40:43], v[132:135]
    v_mfma_f32_16x16x32_bf16 v[136:139], v[16:19], v[44:47], v[136:139]
    v_mfma_f32_16x16x32_bf16 v[140:143], v[16:19], v[48:51], v[140:143]
    s_waitcnt vmcnt(8) lgkmcnt(0)
    s_barrier
    v_mfma_f32_16x16x32_bf16 v[144:147], v[20:23], v[36:39], v[144:147]
    v_add_u32 v74, s72, v72
    v_add_u32 v75, s72, v73
    v_xor_b32 v76, 32, v75
    v_xor_b32 v77, 64, v75
    v_xor_b32 v78, 96, v75
    v_mfma_f32_16x16x32_bf16 v[148:151], v[20:23], v[40:43], v[148:151]
    s_add_u32 s72, s72, 32768
    s_and_b32 s72, s72, 0x1ffff
    ds_read_b128 v[4:7], v74 offset:0
    v_mfma_f32_16x16x32_bf16 v[152:155], v[20:23], v[44:47], v[152:155]
    ds_read_b64_tr_b16 v[52:53], v75 offset:0
    v_mfma_f32_16x16x32_bf16 v[156:159], v[20:23], v[48:51], v[156:159]
    ds_read_b64_tr_b16 v[54:55], v75 offset:2048
    ds_read_b64_tr_b16 v[56:57], v76 offset:0
    v_mfma_f32_16x16x32_bf16 v[160:163], v[24:27], v[36:39], v[160:163]
    ds_read_b64_tr_b16 v[58:59], v76 offset:2048
    v_mfma_f32_16x16x32_bf16 v[164:167], v[24:27], v[40:43], v[164:167]
    ds_read_b64_tr_b16 v[60:61], v77 offset:0
    ds_read_b64_tr_b16 v[62:63], v77 offset:2048
    v_mfma_f32_16x16x32_bf16 v[168:171], v[24:27], v[44:47], v[168:171]
    ds_read_b64_tr_b16 v[64:65], v78 offset:0
    v_mfma_f32_16x16x32_bf16 v[172:175], v[24:27], v[48:51], v[172:175]
    ds_read_b64_tr_b16 v[66:67], v78 offset:2048
    ds_read_b128 v[8:11], v74 offset:1024
    v_mfma_f32_16x16x32_bf16 v[176:179], v[28:31], v[36:39], v[176:179]
    ds_read_b128 v[12:15], v74 offset:2048
    ds_read_b128 v[16:19], v74 offset:3072
    v_mfma_f32_16x16x32_bf16 v[180:183], v[28:31], v[40:43], v[180:183]
    s_mov_b32 m0, s71
    v_mfma_f32_16x16x32_bf16 v[184:187], v[28:31], v[44:47], v[184:187]
    buffer_load_dwordx4 v68, s[60:63], s68 offen lds
    s_add_u32 m0, s71, 1024
    v_mfma_f32_16x16x32_bf16 v[188:191], v[28:31], v[48:51], v[188:191]
    buffer_load_dwordx4 v69, s[60:63], s68 offen lds
    v_mfma_f32_16x16x32_bf16 v[192:195], v[32:35], v[36:39], v[192:195]
    s_add_u32 m0, s71, 16384
    s_nop 0
    buffer_load_dwordx4 v70, s[64:67], s69 offen lds
    v_mfma_f32_16x16x32_bf16 v[196:199], v[32:35], v[40:43], v[196:199]
    s_add_u32 m0, s71, 17408
    v_mfma_f32_16x16x32_bf16 v[200:203], v[32:35], v[44:47], v[200:203]
    buffer_load_dwordx4 v71, s[64:67], s69 offen lds
    s_add_u32 s68, s68, 64
    s_add_u32 s69, s69, s70
    v_mfma_f32_16x16x32_bf16 v[204:207], v[32:35], v[48:51], v[204:207]
    s_add_u32 s71, s71, 32768
    s_and_b32 s71, s71, 0x1ffff
    s_waitcnt lgkmcnt(0)
    v_mfma_f32_16x16x32_bf16 v[80:83], v[4:7], v[52:55], v[80:83]
    ds_read_b128 v[20:23], v74 offset:4096
    v_mfma_f32_16x16x32_bf16 v[84:87], v[4:7], v[56:59], v[84:87]
    v_mfma_f32_16x16x32_bf16 v[88:91], v[4:7], v[60:63], v[88:91]
    ds_read_b128 v[24:27], v74 offset:5120
    v_mfma_f32_16x16x32_bf16 v[92:95], v[4:7], v[64:67], v[92:95]
    v_mfma_f32_16x16x32_bf16 v[96:99], v[8:11], v[52:55], v[96:99]
    ds_read_b128 v[28:31], v74 offset:6144
    v_mfma_f32_16x16x32_bf16 v[100:103], v[8:11], v[56:59], v[100:103]
    v_mfma_f32_16x16x32_bf16 v[104:107], v[8:11], v[60:63], v[104:107]
    ds_read_b128 v[32:35], v74 offset:7168
    v_mfma_f32_16x16x32_bf16 v[108:111], v[8:11], v[64:67], v[108:111]
    v_mfma_f32_16x16x32_bf16 v[112:115], v[12:15], v[52:55], v[112:115]
    v_mfma_f32_16x16x32_bf16 v[116:119], v[12:15], v[56:59], v[116:119]
    v_mfma_f32_16x16x32_bf16 v[120:123], v[12:15], v[60:63], v[120:123]
    v_mfma_f32_16x16x32_bf16 v[124:127], v[12:15], v[64:67], v[124:127]
    v_mfma_f32_16x16x32_bf16 v[128:131], v[16:19], v[52:55], v[128:131]
    v_mfma_f32_16x16x32_bf16 v[132:135], v[16:19], v[56:59], v[132:135]
    v_mfma_f32_16x16x32_bf16 v[136:139], v[16:19], v[60:63], v[136:139]
    v_mfma_f32_16x16x32_bf16 v[140:143], v[16:19], v[64:67], v[140:143]
    s_waitcnt vmcnt(8) lgkmcnt(0)
    s_barrier
    v_mfma_f32_16x16x32_bf16 v[144:147], v[20:23], v[52:55], v[144:147]
    v_add_u32 v74, s72, v72
    v_add_u32 v75, s72, v73
    v_xor_b32 v76, 32, v75
    v_xor_b32 v77, 64, v75
    v_xor_b32 v78, 96, v75
    v_mfma_f32_16x16x32_bf16 v[148:151], v[20:23], v[56:59], v[148:151]
    s_add_u32 s72, s72, 32768
    s_and_b32 s72, s72, 0x1ffff
    ds_read_b128 v[4:7], v74 offset:0
    v_mfma_f32_16x16x32_bf16 v[152:155], v[20:23], v[60:63], v[152:155]
    ds_read_b64_tr_b16 v[36:37], v75 offset:0
    v_mfma_f32_16x16x32_bf16 v[156:159], v[20:23], v[64:67], v[156:159]
    ds_read_b64_tr_b16 v[38:39], v75 offset:2048
    ds_read_b64_tr_b16 v[40:41], v76 offset:0
    v_mfma_f32_16x16x32_bf16 v[160:163], v[24:27], v[52:55], v[160:163]
    ds_read_b64_tr_b16 v[42:43], v76 offset:2048
    v_mfma_f32_16x16x32_bf16 v[164:167], v[24:27], v[56:59], v[164:167]
    ds_read_b64_tr_b16 v[44:45], v77 offset:0
    ds_read_b64_tr_b16 v[46:47], v77 offset:2048
    v_mfma_f32_16x16x32_bf16 v[168:171], v[24:27], v[60:63], v[168:171]
    ds_read_b64_tr_b16 v[48:49], v78 offset:0
    v_mfma_f32_16x16x32_bf16 v[172:175], v[24:27], v[64:67], v[172:175]
    ds_read_b64_tr_b16 v[50:51], v78 offset:2048
    ds_read_b128 v[8:11], v74 offset:1024
    v_mfma_f32_16x16x32_bf16 v[176:179], v[28:31], v[52:55], v[176:179]
    ds_read_b128 v[12:15], v74 offset:2048
    ds_read_b128 v[16:19], v74 offset:3072
    v_mfma_f32_16x16x32_bf16 v[180:183], v[28:31], v[56:59], v[180:183]
    s_mov_b32 m0, s71
    v_mfma_f32_16x16x32_bf16 v[184:187], v[28:31], v[60:63], v[184:187]
    buffer_load_dwordx4 v68, s[60:63], s68 offen lds
    s_add_u32 m0, s71, 1024
    v_mfma_f32_16x16x32_bf16 v[188:191], v[28:31], v[64:67], v[188:191]
    buffer_load_dwordx4 v69, s[60:63], s68 offen lds
    v_mfma_f32_16x16x32_bf16 v[192:195], v[32:35], v[52:55], v[192:195]
    s_add_u32 m0, s71, 16384
    s_nop 0
    buffer_load_dwordx4 v70, s[64:67], s69 offen lds
    v_mfma_f32_16x16x32_bf16 v[196:199], v[32:35], v[56:59], v[196:199]
    s_add_u32 m0, s71, 17408
    v_mfma_f32_16x16x32_bf16 v[200:203], v[32:35], v[60:63], v[200:203]
    buffer_load_dwordx4 v71, s[64:67], s69 offen lds
    s_add_u32 s68, s68, 64
    s_add_u32 s69, s69, s70
    v_mfma_f32_16x16x32_bf16 v[204:207], v[32:35], v[64:67], v[204:207]
    s_add_u32 s71, s71, 32768
    s_and_b32 s71, s71, 0x1ffff
    s_sub_u32 s73, s73, 1
    s_cmp_lg_u32 s73, 0
    s_cbranch_scc1 gl_148
    s_waitcnt lgkmcnt(0)
    v_mfma_f32_16x16x32_bf16 v[80:83], v[4:7], v[36:39], v[80:83]
    ds_read_b128 v[20:23], v74 offset:4096
    v_mfma_f32_16x16x32_bf16 v[84:87], v[4:7], v[40:43], v[84:87]
    v_mfma_f32_16x16x32_bf16 v[88:91], v[4:7], v[44:47], v[88:91]
    ds_read_b128 v[24:27], v74 offset:5120
    v_mfma_f32_16x16x32_bf16 v[92:95], v[4:7], v[48:51], v[92:95]
    v_mfma_f32_16x16x32_bf16 v[96:99], v[8:11], v[36:39], v[96:99]
    ds_read_b128 v[28:31], v74 offset:6144
    v_mfma_f32_16x16x32_bf16 v[100:103], v[8:11], v[40:43], v[100:103]
    v_mfma_f32_16x16x32_bf16 v[104:107], v[8:11], v[44:47], v[104:107]
    ds_read_b128 v[32:35], v74 offset:7168
    v_mfma_f32_16x16x32_bf16 v[108:111], v[8:11], v[48:51], v[108:111]
    v_mfma_f32_16x16x32_bf16 v[112:115], v[12:15], v[36:39], v[112:115]
    v_mfma_f32_16x16x32_bf16 v[116:119], v[12:15], v[40:43], v[116:119]
    v_mfma_f32_16x16x32_bf16 v[120:123], v[12:15], v[44:47], v[120:123]
    v_mfma_f32_16x16x32_bf16 v[124:127], v[12:15], v[48:51], v[124:127]
    v_mfma_f32_16x16x32_bf16 v[128:131], v[16:19], v[36:39], v[128:131]
    v_mfma_f32_16x16x32_bf16 v[132:135], v[16:19], v[40:43], v[132:135]
    v_mfma_f32_16x16x32_bf16 v[136:139], v[16:19], v[44:47], v[136:139]
    v_mfma_f32_16x16x32_bf16 v[140:143], v[16:19], v[48:51], v[140:143]
    s_waitcnt vmcnt(8) lgkmcnt(0)
    s_barrier
    v_mfma_f32_16x16x32_bf16 v[144:147], v[20:23], v[36:39], v[144:147]
    v_add_u32 v74, s72, v72
    v_add_u32 v75, s72, v73
    v_mfma_f32_16x16x32_bf16 v[148:151], v[20:23], v[40:43], v[148:151]
    v_xor_b32 v76, 32, v75
    v_xor_b32 v77, 64, v75
    v_xor_b32 v78, 96, v75
    v_mfma_f32_16x16x32_bf16 v[152:155], v[20:23], v[44:47], v[152:155]
    s_add_u32 s72, s72, 32768
    s_and_b32 s72, s72, 0x1ffff
    v_mfma_f32_16x16x32_bf16 v[156:159], v[20:23], v[48:51], v[156:159]
    ds_read_b128 v[4:7], v74 offset:0
    v_mfma_f32_16x16x32_bf16 v[160:163], v[24:27], v[36:39], v[160:163]
    ds_read_b64_tr_b16 v[52:53], v75 offset:0
    v_mfma_f32_16x16x32_bf16 v[164:167], v[24:27], v[40:43], v[164:167]
    ds_read_b64_tr_b16 v[54:55], v75 offset:2048
    v_mfma_f32_16x16x32_bf16 v[168:171], v[24:27], v[44:47], v[168:171]
    ds_read_b64_tr_b16 v[56:57], v76 offset:0
    v_mfma_f32_16x16x32_bf16 v[172:175], v[24:27], v[48:51], v[172:175]
    ds_read_b64_tr_b16 v[58:59], v76 offset:2048
    v_mfma_f32_16x16x32_bf16 v[176:179], v[28:31], v[36:39], v[176:179]
    ds_read_b64_tr_b16 v[60:61], v77 offset:0
    v_mfma_f32_16x16x32_bf16 v[180:183], v[28:31], v[40:43], v[180:183]
    ds_read_b64_tr_b16 v[62:63], v77 offset:2048
    v_mfma_f32_16x16x32_bf16 v[184:187], v[28:31], v[44:47], v[184:187]
    ds_read_b64_tr_b16 v[64:65], v78 offset:0
    v_mfma_f32_16x16x32_bf16 v[188:191], v[28:31], v[48:51], v[188:191]
    ds_read_b64_tr_b16 v[66:67], v78 offset:2048
    v_mfma_f32_16x16x32_bf16 v[192:195], v[32:35], v[36:39], v[192:195]
    ds_read_b128 v[8:11], v74 offset:1024
    v_mfma_f32_16x16x32_bf16 v[196:199], v[32:35], v[40:43], v[196:199]
    ds_read_b128 v[12:15], v74 offset:2048
    v_mfma_f32_16x16x32_bf16 v[200:203], v[32:35], v[44:47], v[200:203]
    ds_read_b128 v[16:19], v74 offset:3072
    v_mfma_f32_16x16x32_bf16 v[204:207], v[32:35], v[48:51], v[204:207]
    s_waitcnt lgkmcnt(0)
    v_mfma_f32_16x16x32_bf16 v[80:83], v[4:7], v[52:55], v[80:83]
    ds_read_b128 v[20:23], v74 offset:4096
    v_mfma_f32_16x16x32_bf16 v[84:87], v[4:7], v[56:59], v[84:87]
    v_mfma_f32_16x16x32_bf16 v[88:91], v[4:7], v[60:63], v[88:91]
    ds_read_b128 v[24:27], v74 offset:5120
    v_mfma_f32_16x16x32_bf16 v[92:95], v[4:7], v[64:67], v[92:95]
    v_mfma_f32_16x16x32_bf16 v[96:99], v[8:11], v[52:55], v[96:99]
    ds_read_b128 v[28:31], v74 offset:6144
    v_mfma_f32_16x16x32_bf16 v[100:103], v[8:11], v[56:59], v[100:103]
    v_mfma_f32_16x16x32_bf16 v[104:107], v[8:11], v[60:63], v[104:107]
    ds_read_b128 v[32:35], v74 offset:7168
    v_mfma_f32_16x16x32_bf16 v[108:111], v[8:11], v[64:67], v[108:111]
    v_mfma_f32_16x16x32_bf16 v[112:115], v[12:15], v[52:55], v[112:115]
    v_mfma_f32_16x16x32_bf16 v[116:119], v[12:15], v[56:59], v[116:119]
    v_mfma_f32_16x16x32_bf16 v[120:123], v[12:15], v[60:63], v[120:123]
    v_mfma_f32_16x16x32_bf16 v[124:127], v[12:15], v[64:67], v[124:127]
    v_mfma_f32_16x16x32_bf16 v[128:131], v[16:19], v[52:55], v[128:131]
    v_mfma_f32_16x16x32_bf16 v[132:135], v[16:19], v[56:59], v[132:135]
    v_mfma_f32_16x16x32_bf16 v[136:139], v[16:19], v[60:63], v[136:139]
    v_mfma_f32_16x16x32_bf16 v[140:143], v[16:19], v[64:67], v[140:143]
    s_waitcnt vmcnt(4) lgkmcnt(0)
    s_barrier
    v_mfma_f32_16x16x32_bf16 v[144:147], v[20:23], v[52:55], v[144:147]
    v_add_u32 v74, s72, v72
    v_add_u32 v75, s72, v73
    v_mfma_f32_16x16x32_bf16 v[148:151], v[20:23], v[56:59], v[148:151]
    v_xor_b32 v76, 32, v75
    v_xor_b32 v77, 64, v75
    v_xor_b32 v78, 96, v75
    v_mfma_f32_16x16x32_bf16 v[152:155], v[20:23], v[60:63], v[152:155]
    s_add_u32 s72, s72, 32768
    s_and_b32 s72, s72, 0x1ffff
    v_mfma_f32_16x16x32_bf16 v[156:159], v[20:23], v[64:67], v[156:159]
    ds_read_b128 v[4:7], v74 offset:0
    v_mfma_f32_16x16x32_bf16 v[160:163], v[24:27], v[52:55], v[160:163]
    ds_read_b64_tr_b16 v[36:37], v75 offset:0
    v_mfma_f32_16x16x32_bf16 v[164:167], v[24:27], v[56:59], v[164:167]
    ds_read_b64_tr_b16 v[38:39], v75 offset:2048
    v_mfma_f32_16x16x32_bf16 v[168:171], v[24:27], v[60:63], v[168:171]
    ds_read_b64_tr_b16 v[40:41], v76 offset:0
    v_mfma_f32_16x16x32_bf16 v[172:175], v[24:27], v[64:67], v[172:175]
    ds_read_b64_tr_b16 v[42:43], v76 offset:2048
    v_mfma_f32_16x16x32_bf16 v[176:179], v[28:31], v[52:55], v[176:179]
    ds_read_b64_tr_b16 v[44:45], v77 offset:0
    v_mfma_f32_16x16x32_bf16 v[180:183], v[28:31], v[56:59], v[180:183]
    ds_read_b64_tr_b16 v[46:47], v77 offset:2048
    v_mfma_f32_16x16x32_bf16 v[184:187], v[28:31], v[60:63], v[184:187]
    ds_read_b64_tr_b16 v[48:49], v78 offset:0
    v_mfma_f32_16x16x32_bf16 v[188:191], v[28:31], v[64:67], v[188:191]
    ds_read_b64_tr_b16 v[50:51], v78 offset:2048
    v_mfma_f32_16x16x32_bf16 v[192:195], v[32:35], v[52:55], v[192:195]
    ds_read_b128 v[8:11], v74 offset:1024
    v_mfma_f32_16x16x32_bf16 v[196:199], v[32:35], v[56:59], v[196:199]
    ds_read_b128 v[12:15], v74 offset:2048
    v_mfma_f32_16x16x32_bf16 v[200:203], v[32:35], v[60:63], v[200:203]
    ds_read_b128 v[16:19], v74 offset:3072
    v_mfma_f32_16x16x32_bf16 v[204:207], v[32:35], v[64:67], v[204:207]
    s_waitcnt lgkmcnt(0)
    v_mfma_f32_16x16x32_bf16 v[80:83], v[4:7], v[36:39], v[80:83]
    ds_read_b128 v[20:23], v74 offset:4096
    v_mfma_f32_16x16x32_bf16 v[84:87], v[4:7], v[40:43], v[84:87]
    v_mfma_f32_16x16x32_bf16 v[88:91], v[4:7], v[44:47], v[88:91]
    ds_read_b128 v[24:27], v74 offset:5120
    v_mfma_f32_16x16x32_bf16 v[92:95], v[4:7], v[48:51], v[92:95]
    v_mfma_f32_16x16x32_bf16 v[96:99], v[8:11], v[36:39], v[96:99]
    ds_read_b128 v[28:31], v74 offset:6144
    v_mfma_f32_16x16x32_bf16 v[100:103], v[8:11], v[40:43], v[100:103]
    v_mfma_f32_16x16x32_bf16 v[104:107], v[8:11], v[44:47], v[104:107]
    ds_read_b128 v[32:35], v74 offset:7168
    v_mfma_f32_16x16x32_bf16 v[108:111], v[8:11], v[48:51], v[108:111]
    v_mfma_f32_16x16x32_bf16 v[112:115], v[12:15], v[36:39], v[112:115]
    v_mfma_f32_16x16x32_bf16 v[116:119], v[12:15], v[40:43], v[116:119]
    v_mfma_f32_16x16x32_bf16 v[120:123], v[12:15], v[44:47], v[120:123]
    v_mfma_f32_16x16x32_bf16 v[124:127], v[12:15], v[48:51], v[124:127]
    v_mfma_f32_16x16x32_bf16 v[128:131], v[16:19], v[36:39], v[128:131]
    v_mfma_f32_16x16x32_bf16 v[132:135], v[16:19], v[40:43], v[132:135]
    v_mfma_f32_16x16x32_bf16 v[136:139], v[16:19], v[44:47], v[136:139]
    v_mfma_f32_16x16x32_bf16 v[140:143], v[16:19], v[48:51], v[140:143]
    s_waitcnt vmcnt(0) lgkmcnt(0)
    s_barrier
    v_mfma_f32_16x16x32_bf16 v[144:147], v[20:23], v[36:39], v[144:147]
    v_add_u32 v74, s72, v72
    v_add_u32 v75, s72, v73
    v_mfma_f32_16x16x32_bf16 v[148:151], v[20:23], v[40:43], v[148:151]
    v_xor_b32 v76, 32, v75
    v_xor_b32 v77, 64, v75
    v_xor_b32 v78, 96, v75
    v_mfma_f32_16x16x32_bf16 v[152:155], v[20:23], v[44:47], v[152:155]
    s_add_u32 s72, s72, 32768
    s_and_b32 s72, s72, 0x1ffff
    v_mfma_f32_16x16x32_bf16 v[156:159], v[20:23], v[48:51], v[156:159]
    ds_read_b128 v[4:7], v74 offset:0
    v_mfma_f32_16x16x32_bf16 v[160:163], v[24:27], v[36:39], v[160:163]
    ds_read_b64_tr_b16 v[52:53], v75 offset:0
    v_mfma_f32_16x16x32_bf16 v[164:167], v[24:27], v[40:43], v[164:167]
    ds_read_b64_tr_b16 v[54:55], v75 offset:2048
    v_mfma_f32_16x16x32_bf16 v[168:171], v[24:27], v[44:47], v[168:171]
    ds_read_b64_tr_b16 v[56:57], v76 offset:0
    v_mfma_f32_16x16x32_bf16 v[172:175], v[24:27], v[48:51], v[172:175]
    ds_read_b64_tr_b16 v[58:59], v76 offset:2048
    v_mfma_f32_16x16x32_bf16 v[176:179], v[28:31], v[36:39], v[176:179]
    ds_read_b64_tr_b16 v[60:61], v77 offset:0
    v_mfma_f32_16x16x32_bf16 v[180:183], v[28:31], v[40:43], v[180:183]
    ds_read_b64_tr_b16 v[62:63], v77 offset:2048
    v_mfma_f32_16x16x32_bf16 v[184:187], v[28:31], v[44:47], v[184:187]
    ds_read_b64_tr_b16 v[64:65], v78 offset:0
    v_mfma_f32_16x16x32_bf16 v[188:191], v[28:31], v[48:51], v[188:191]
    ds_read_b64_tr_b16 v[66:67], v78 offset:2048
    v_mfma_f32_16x16x32_bf16 v[192:195], v[32:35], v[36:39], v[192:195]
    ds_read_b128 v[8:11], v74 offset:1024
    v_mfma_f32_16x16x32_bf16 v[196:199], v[32:35], v[40:43], v[196:199]
    ds_read_b128 v[12:15], v74 offset:2048
    v_mfma_f32_16x16x32_bf16 v[200:203], v[32:35], v[44:47], v[200:203]
    ds_read_b128 v[16:19], v74 offset:3072
    v_mfma_f32_16x16x32_bf16 v[204:207], v[32:35], v[48:51], v[204:207]
    s_waitcnt lgkmcnt(0)
    v_mfma_f32_16x16x32_bf16 v[80:83], v[4:7], v[52:55], v[80:83]
    ds_read_b128 v[20:23], v74 offset:4096
    v_mfma_f32_16x16x32_bf16 v[84:87], v[4:7], v[56:59], v[84:87]
    v_mfma_f32_16x16x32_bf16 v[88:91], v[4:7], v[60:63], v[88:91]
    ds_read_b128 v[24:27], v74 offset:5120
    v_mfma_f32_16x16x32_bf16 v[92:95], v[4:7], v[64:67], v[92:95]
    v_mfma_f32_16x16x32_bf16 v[96:99], v[8:11], v[52:55], v[96:99]
    ds_read_b128 v[28:31], v74 offset:6144
    v_mfma_f32_16x16x32_bf16 v[100:103], v[8:11], v[56:59], v[100:103]
    v_mfma_f32_16x16x32_bf16 v[104:107], v[8:11], v[60:63], v[104:107]
    ds_read_b128 v[32:35], v74 offset:7168
    v_mfma_f32_16x16x32_bf16 v[108:111], v[8:11], v[64:67], v[108:111]
    v_mfma_f32_16x16x32_bf16 v[112:115], v[12:15], v[52:55], v[112:115]
    v_mfma_f32_16x16x32_bf16 v[116:119], v[12:15], v[56:59], v[116:119]
    v_mfma_f32_16x16x32_bf16 v[120:123], v[12:15], v[60:63], v[120:123]
    v_mfma_f32_16x16x32_bf16 v[124:127], v[12:15], v[64:67], v[124:127]
    v_mfma_f32_16x16x32_bf16 v[128:131], v[16:19], v[52:55], v[128:131]
    v_mfma_f32_16x16x32_bf16 v[132:135], v[16:19], v[56:59], v[132:135]
    v_mfma_f32_16x16x32_bf16 v[136:139], v[16:19], v[60:63], v[136:139]
    v_mfma_f32_16x16x32_bf16 v[140:143], v[16:19], v[64:67], v[140:143]
    s_waitcnt lgkmcnt(0)
    v_mfma_f32_16x16x32_bf16 v[144:147], v[20:23], v[52:55], v[144:147]
    v_mfma_f32_16x16x32_bf16 v[148:151], v[20:23], v[56:59], v[148:151]
    v_mfma_f32_16x16x32_bf16 v[152:155], v[20:23], v[60:63], v[152:155]
    v_mfma_f32_16x16x32_bf16 v[156:159], v[20:23], v[64:67], v[156:159]
    v_mfma_f32_16x16x32_bf16 v[160:163], v[24:27], v[52:55], v[160:163]
    v_mfma_f32_16x16x32_bf16 v[164:167], v[24:27], v[56:59], v[164:167]
    v_mfma_f32_16x16x32_bf16 v[168:171], v[24:27], v[60:63], v[168:171]
    v_mfma_f32_16x16x32_bf16 v[172:175], v[24:27], v[64:67], v[172:175]
    v_mfma_f32_16x16x32_bf16 v[176:179], v[28:31], v[52:55], v[176:179]
    v_mfma_f32_16x16x32_bf16 v[180:183], v[28:31], v[56:59], v[180:183]
    v_mfma_f32_16x16x32_bf16 v[184:187], v[28:31], v[60:63], v[184:187]
    v_mfma_f32_16x16x32_bf16 v[188:191], v[28:31], v[64:67], v[188:191]
    v_mfma_f32_16x16x32_bf16 v[192:195], v[32:35], v[52:55], v[192:195]
    v_mfma_f32_16x16x32_bf16 v[196:199], v[32:35], v[56:59], v[196:199]
    v_mfma_f32_16x16x32_bf16 v[200:203], v[32:35], v[60:63], v[200:203]
    v_mfma_f32_16x16x32_bf16 v[204:207], v[32:35], v[64:67], v[204:207]
    s_lshl_b32 s85, s80, 2
    s_and_b32 s81, s58, 3
    s_add_u32 s85, s85, s81
    s_lshl_b32 s85, s85, 6
    v_and_b32 v77, 15, v1
    v_add_u32 v77, s85, v77
    v_bfe_u32 v76, v77, 3, 5
    v_lshlrev_b32 v76, 12, v76
    v_bfe_u32 v75, v77, 10, 1
    v_lshl_or_b32 v76, v75, 17, v76
    v_bfe_u32 v75, v77, 0, 2
    v_lshl_or_b32 v76, v75, 18, v76
    v_bfe_u32 v75, v77, 8, 1
    v_lshl_or_b32 v76, v75, 20, v76
    v_bfe_u32 v75, v77, 2, 1
    v_lshl_or_b32 v76, v75, 21, v76
    v_bfe_u32 v75, v77, 9, 1
    v_lshl_or_b32 v76, v75, 22, v76
    v_bfe_u32 v77, v1, 4, 2
    v_lshlrev_b32 v77, 4, v77
    v_add_u32 v76, v76, v77
    s_lshl_b32 s81, s79, 9
    s_lshr_b32 s85, s58, 2
    s_lshl_b32 s85, s85, 8
    s_add_u32 s81, s81, s85
    v_cvt_pk_bf16_f32 v4, v80, v81
    v_cvt_pk_bf16_f32 v5, v82, v83
    v_cvt_pk_bf16_f32 v6, v96, v97
    v_cvt_pk_bf16_f32 v7, v98, v99
    buffer_store_dwordx4 v[4:7], v76, s[16:19], s81 offen offset:0
    v_cvt_pk_bf16_f32 v8, v112, v113
    v_cvt_pk_bf16_f32 v9, v114, v115
    v_cvt_pk_bf16_f32 v10, v128, v129
    v_cvt_pk_bf16_f32 v11, v130, v131
    buffer_store_dwordx4 v[8:11], v76, s[16:19], s81 offen offset:64
    v_cvt_pk_bf16_f32 v12, v144, v145
    v_cvt_pk_bf16_f32 v13, v146, v147
    v_cvt_pk_bf16_f32 v14, v160, v161
    v_cvt_pk_bf16_f32 v15, v162, v163
    buffer_store_dwordx4 v[12:15], v76, s[16:19], s81 offen offset:128
    v_cvt_pk_bf16_f32 v16, v176, v177
    v_cvt_pk_bf16_f32 v17, v178, v179
    v_cvt_pk_bf16_f32 v18, v192, v193
    v_cvt_pk_bf16_f32 v19, v194, v195
    buffer_store_dwordx4 v[16:19], v76, s[16:19], s81 offen offset:192
    s_add_u32 s81, s81, 8192
    v_cvt_pk_bf16_f32 v20, v84, v85
    v_cvt_pk_bf16_f32 v21, v86, v87
    v_cvt_pk_bf16_f32 v22, v100, v101
    v_cvt_pk_bf16_f32 v23, v102, v103
    buffer_store_dwordx4 v[20:23], v76, s[16:19], s81 offen offset:0
    v_cvt_pk_bf16_f32 v24, v116, v117
    v_cvt_pk_bf16_f32 v25, v118, v119
    v_cvt_pk_bf16_f32 v26, v132, v133
    v_cvt_pk_bf16_f32 v27, v134, v135
    buffer_store_dwordx4 v[24:27], v76, s[16:19], s81 offen offset:64
    v_cvt_pk_bf16_f32 v28, v148, v149
    v_cvt_pk_bf16_f32 v29, v150, v151
    v_cvt_pk_bf16_f32 v30, v164, v165
    v_cvt_pk_bf16_f32 v31, v166, v167
    buffer_store_dwordx4 v[28:31], v76, s[16:19], s81 offen offset:128
    v_cvt_pk_bf16_f32 v32, v180, v181
    v_cvt_pk_bf16_f32 v33, v182, v183
    v_cvt_pk_bf16_f32 v34, v196, v197
    v_cvt_pk_bf16_f32 v35, v198, v199
    buffer_store_dwordx4 v[32:35], v76, s[16:19], s81 offen offset:192
    s_add_u32 s81, s81, 8192
    v_cvt_pk_bf16_f32 v36, v88, v89
    v_cvt_pk_bf16_f32 v37, v90, v91
    v_cvt_pk_bf16_f32 v38, v104, v105
    v_cvt_pk_bf16_f32 v39, v106, v107
    buffer_store_dwordx4 v[36:39], v76, s[16:19], s81 offen offset:0
    v_cvt_pk_bf16_f32 v40, v120, v121
    v_cvt_pk_bf16_f32 v41, v122, v123
    v_cvt_pk_bf16_f32 v42, v136, v137
    v_cvt_pk_bf16_f32 v43, v138, v139
    buffer_store_dwordx4 v[40:43], v76, s[16:19], s81 offen offset:64
    v_cvt_pk_bf16_f32 v44, v152, v153
    v_cvt_pk_bf16_f32 v45, v154, v155
    v_cvt_pk_bf16_f32 v46, v168, v169
    v_cvt_pk_bf16_f32 v47, v170, v171
    buffer_store_dwordx4 v[44:47], v76, s[16:19], s81 offen offset:128
    v_cvt_pk_bf16_f32 v48, v184, v185
    v_cvt_pk_bf16_f32 v49, v186, v187
    v_cvt_pk_bf16_f32 v50, v200, v201
    v_cvt_pk_bf16_f32 v51, v202, v203
    buffer_store_dwordx4 v[48:51], v76, s[16:19], s81 offen offset:192
    s_add_u32 s81, s81, 8192
    v_cvt_pk_bf16_f32 v52, v92, v93
    v_cvt_pk_bf16_f32 v53, v94, v95
    v_cvt_pk_bf16_f32 v54, v108, v109
    v_cvt_pk_bf16_f32 v55, v110, v111
    buffer_store_dwordx4 v[52:55], v76, s[16:19], s81 offen offset:0
    v_cvt_pk_bf16_f32 v56, v124, v125
    v_cvt_pk_bf16_f32 v57, v126, v127
    v_cvt_pk_bf16_f32 v58, v140, v141
    v_cvt_pk_bf16_f32 v59, v142, v143
    buffer_store_dwordx4 v[56:59], v76, s[16:19], s81 offen offset:64
    v_cvt_pk_bf16_f32 v60, v156, v157
    v_cvt_pk_bf16_f32 v61, v158, v159
    v_cvt_pk_bf16_f32 v62, v172, v173
    v_cvt_pk_bf16_f32 v63, v174, v175
    buffer_store_dwordx4 v[60:63], v76, s[16:19], s81 offen offset:128
    v_cvt_pk_bf16_f32 v64, v188, v189
    v_cvt_pk_bf16_f32 v65, v190, v191
    v_cvt_pk_bf16_f32 v66, v204, v205
    v_cvt_pk_bf16_f32 v67, v206, v207
    buffer_store_dwordx4 v[64:67], v76, s[16:19], s81 offen offset:192
    s_add_u32 s81, s81, 8192
    v_mov_b32 v75, 163760
    v_mov_b32 v76, 0
    s_barrier
    ds_write_b32 v75, v76
    s_waitcnt lgkmcnt(0)
    s_barrier
    v_lshlrev_b32 v5, 4, v1
    v_bfe_u32 v6, v1, 0, 3
    v_lshlrev_b32 v6, 4, v6
    v_bfe_u32 v3, v1, 5, 1
    v_lshl_or_b32 v6, v3, 7, v6
    v_lshlrev_b32 v7, 3, v1
    v_bfe_u32 v2, v1, 5, 1
    v_lshlrev_b32 v2, 2, v2
    v_and_b32 v8, 31, v1
    v_sub_u32 v8, v8, v2
    s_mov_b32 s89, 0x3e0293ee
    s_and_b32 s86, s57, 7
    s_mov_b32 s92, 0
    s_mov_b32 s91, 0
    s_mov_b32 s93, 0
    v_mov_b32 v9, 163760
    s_mov_b32 s4, 0xff
    s_mov_b32 s5, 0xff
    s_add_u32 s93, s93, 1
    s_cmp_lg_u32 s58, 0
    s_cbranch_scc1 at_f_152
    s_cmp_eq_u32 s92, 2097216
    s_cbranch_scc1 at_rb_154
    s_max_u32 s88, s86, 2
    s_sub_u32 s88, s88, 2
    s_and_b32 s88, s88, -4
pollrb_155:
    buffer_load_dword v2, off, s[12:15], s88 offset:160 sc1
    buffer_load_dword v3, off, s[12:15], 0 offset:220 sc1
    s_waitcnt vmcnt(0)
    v_cmp_ne_u32 vcc, 2097216, v2
    s_cbranch_vccz pollrb_ok_156
    s_sub_u32 s77, s77, 1
    s_cbranch_scc0 pollrb_155
    s_mov_b32 s77, 0
pollrb_ok_156:
    v_readfirstlane_b32 s92, v3
at_rb_154:
    v_mov_b32 v2, s93
    ds_write_b32 v9, v2
at_f_152:
    ds_read_b32 v2, v9
    s_waitcnt lgkmcnt(0)
    v_cmp_gt_u32 vcc, s93, v2
    s_cbranch_vccz at_d_153
    s_sub_u32 s77, s77, 1
    s_cbranch_scc0 at_f_152
    s_mov_b32 s77, 0
at_d_153:
    s_lshl_b32 s94, s86, 2
    s_add_u32 s94, s94, s75
    s_lshl_b32 s94, s94, 3
    s_add_u32 s94, s94, s58
    s_lshl_b32 s94, s94, 13
    s_add_u32 s88, s94, 0x0
    buffer_load_dwordx4 v[12:15], v5, s[8:11], s88 offen offset:0 sc1
    buffer_load_dwordx4 v[16:19], v5, s[8:11], s88 offen offset:1024 sc1
    buffer_load_dwordx4 v[20:23], v5, s[8:11], s88 offen offset:2048 sc1
    buffer_load_dwordx4 v[24:27], v5, s[8:11], s88 offen offset:3072 sc1
    s_add_u32 s88, s88, 4096
    buffer_load_dwordx4 v[28:31], v5, s[8:11], s88 offen offset:0 sc1
    buffer_load_dwordx4 v[32:35], v5, s[8:11], s88 offen offset:1024 sc1
    buffer_load_dwordx4 v[36:39], v5, s[8:11], s88 offen offset:2048 sc1
    buffer_load_dwordx4 v[40:43], v5, s[8:11], s88 offen offset:3072 sc1
    s_add_u32 s88, s94, 0x1000000
    buffer_load_dwordx4 v[44:47], v5, s[8:11], s88 offen offset:0 sc1
    buffer_load_dwordx4 v[48:51], v5, s[8:11], s88 offen offset:1024 sc1
    buffer_load_dwordx4 v[52:55], v5, s[8:11], s88 offen offset:2048 sc1
    buffer_load_dwordx4 v[56:59], v5, s[8:11], s88 offen offset:3072 sc1
    s_add_u32 s88, s88, 4096
    buffer_load_dwordx4 v[60:63], v5, s[8:11], s88 offen offset:0 sc1
    buffer_load_dwordx4 v[64:67], v5, s[8:11], s88 offen offset:1024 sc1
    buffer_load_dwordx4 v[68:71], v5, s[8:11], s88 offen offset:2048 sc1
    buffer_load_dwordx4 v[72:75], v5, s[8:11], s88 offen offset:3072 sc1
    s_add_u32 s88, s94, 0x2000000
    buffer_load_dwordx4 v[76:79], v5, s[8:11], s88 offen offset:0 sc1
    buffer_load_dwordx4 v[80:83], v5, s[8:11], s88 offen offset:1024 sc1
    buffer_load_dwordx4 v[84:87], v5, s[8:11], s88 offen offset:2048 sc1
    buffer_load_dwordx4 v[88:91], v5, s[8:11], s88 offen offset:3072 sc1
    s_add_u32 s88, s88, 4096
    buffer_load_dwordx4 v[92:95], v5, s[8:11], s88 offen offset:0 sc1
    buffer_load_dwordx4 v[96:99], v5, s[8:11], s88 offen offset:1024 sc1
    buffer_load_dwordx4 v[100:103], v5, s[8:11], s88 offen offset:2048 sc1
    buffer_load_dwordx4 v[104:107], v5, s[8:11], s88 offen offset:3072 sc1
at_loop_149:
    s_mov_b32 s90, s94
    s_add_u32 s93, s93, 1
    s_cmp_lg_u32 s58, 0
    s_cbranch_scc1 at_f_157
    s_cmp_ge_u32 s86, 48
    s_cselect_b32 s88, 1, 2
    s_add_u32 s88, s88, s86
    s_min_u32 s88, s88, 62
    s_cmp_ge_u32 s91, s88
    s_cbranch_scc1 at_go_151
pollprog_159:
    buffer_load_dword v4, off, s[12:15], 0 offset:64 sc1
    s_waitcnt vmcnt(0)
    v_cmp_gt_u32 vcc, s88, v4
    s_cbranch_vccz pollprog_ok_160
    s_sub_u32 s77, s77, 1
    s_cbranch_scc0 pollprog_159
    s_mov_b32 s77, 0
pollprog_ok_160:
    v_readfirstlane_b32 s91, v4
at_go_151:
    v_mov_b32 v2, s93
    ds_write_b32 v9, v2
at_f_157:
    ds_read_b32 v2, v9
    s_waitcnt lgkmcnt(0)
    v_cmp_gt_u32 vcc, s93, v2
    s_cbranch_vccz at_d_158
    s_sub_u32 s77, s77, 1
    s_cbranch_scc0 at_f_157
    s_mov_b32 s77, 0
at_d_158:
    s_lshr_b32 s88, s90, 2
    s_add_u32 s87, s88, 0x4400000
    s_add_u32 s88, s88, 0x4000000
    buffer_load_dwordx4 v[108:111], v6, s[8:11], s88 offen offset:0 sc1
    buffer_load_dwordx4 v[112:115], v6, s[8:11], s88 offen offset:256 sc1
    buffer_load_dwordx4 v[116:119], v6, s[8:11], s88 offen offset:512 sc1
    buffer_load_dwordx4 v[120:123], v6, s[8:11], s88 offen offset:768 sc1
    buffer_load_dwordx4 v[124:127], v6, s[8:11], s88 offen offset:1024 sc1
    buffer_load_dwordx4 v[128:131], v6, s[8:11], s88 offen offset:1280 sc1
    buffer_load_dwordx4 v[132:135], v6, s[8:11], s88 offen offset:1536 sc1
    buffer_load_dwordx4 v[136:139], v6, s[8:11], s88 offen offset:1792 sc1
    buffer_load_dwordx2 v[236:237], v7, s[8:11], s87 offen offset:0 sc1
    buffer_load_dwordx2 v[238:239], v7, s[8:11], s87 offen offset:512 sc1
    buffer_load_dwordx2 v[240:241], v7, s[8:11], s87 offen offset:1024 sc1
    buffer_load_dwordx2 v[242:243], v7, s[8:11], s87 offen offset:1536 sc1
    s_waitcnt vmcnt(27)
    v_mfma_f32_32x32x16_bf16 v[140:155], v[44:47], v[12:15], 0
    s_waitcnt vmcnt(26)
    v_mfma_f32_32x32x16_bf16 v[140:155], v[48:51], v[16:19], v[140:155]
    s_waitcnt vmcnt(25)
    v_mfma_f32_32x32x16_bf16 v[140:155], v[52:55], v[20:23], v[140:155]
    s_waitcnt vmcnt(24)
    v_mfma_f32_32x32x16_bf16 v[140:155], v[56:59], v[24:27], v[140:155]
    s_waitcnt vmcnt(23)
    v_mfma_f32_32x32x16_bf16 v[140:155], v[60:63], v[28:31], v[140:155]
    s_waitcnt vmcnt(22)
    v_mfma_f32_32x32x16_bf16 v[140:155], v[64:67], v[32:35], v[140:155]
    s_waitcnt vmcnt(21)
    v_mfma_f32_32x32x16_bf16 v[140:155], v[68:71], v[36:39], v[140:155]
    s_waitcnt vmcnt(20)
    v_mfma_f32_32x32x16_bf16 v[140:155], v[72:75], v[40:43], v[140:155]
    v_mov_b32 v3, 0xff800000
    v_cmp_le_i32 vcc, 0, v8
    s_nop 9
    v_cndmask_b32 v140, v3, v140, vcc
    v_cmp_le_i32 vcc, 1, v8
    s_nop 1
    v_cndmask_b32 v141, v3, v141, vcc
    v_cmp_le_i32 vcc, 2, v8
    s_nop 1
    v_cndmask_b32 v142, v3, v142, vcc
    v_cmp_le_i32 vcc, 3, v8
    s_nop 1
    v_cndmask_b32 v143, v3, v143, vcc
    v_cmp_le_i32 vcc, 8, v8
    s_nop 1
    v_cndmask_b32 v144, v3, v144, vcc
    v_cmp_le_i32 vcc, 9, v8
    s_nop 1
    v_cndmask_b32 v145, v3, v145, vcc
    v_cmp_le_i32 vcc, 10, v8
    s_nop 1
    v_cndmask_b32 v146, v3, v146, vcc
    v_cmp_le_i32 vcc, 11, v8
    s_nop 1
    v_cndmask_b32 v147, v3, v147, vcc
    v_cmp_le_i32 vcc, 16, v8
    s_nop 1
    v_cndmask_b32 v148, v3, v148, vcc
    v_cmp_le_i32 vcc, 17, v8
    s_nop 1
    v_cndmask_b32 v149, v3, v149, vcc
    v_cmp_le_i32 vcc, 18, v8
    s_nop 1
    v_cndmask_b32 v150, v3, v150, vcc
    v_cmp_le_i32 vcc, 19, v8
    s_nop 1
    v_cndmask_b32 v151, v3, v151, vcc
    v_cmp_le_i32 vcc, 24, v8
    s_nop 1
    v_cndmask_b32 v152, v3, v152, vcc
    v_cmp_le_i32 vcc, 25, v8
    s_nop 1
    v_cndmask_b32 v153, v3, v153, vcc
    v_cmp_le_i32 vcc, 26, v8
    s_nop 1
    v_cndmask_b32 v154, v3, v154, vcc
    v_cmp_le_i32 vcc, 27, v8
    s_nop 1
    v_cndmask_b32 v155, v3, v155, vcc
    v_max3_f32 v244, v140, v141, v142
    v_max3_f32 v244, v244, v143, v144
    v_max3_f32 v244, v244, v145, v146
    v_max3_f32 v244, v244, v147, v148
    v_max3_f32 v244, v244, v149, v150
    v_max3_f32 v244, v244, v151, v152
    v_max3_f32 v244, v244, v153, v154
    s_waitcnt vmcnt(0)
    v_max3_u32 v2, v108, v112, v116
    v_max3_u32 v2, v2, v120, v124
    v_max3_u32 v2, v2, v128, v132
    v_max_u32 v2, v2, v136
    v_cmp_eq_u32 vcc, -1, v2
    s_cbranch_vccz pollkm_ok_162
pollkm_161:
    buffer_load_dwordx4 v[108:111], v6, s[8:11], s88 offen offset:0 sc1
    buffer_load_dwordx4 v[112:115], v6, s[8:11], s88 offen offset:256 sc1
    buffer_load_dwordx4 v[116:119], v6, s[8:11], s88 offen offset:512 sc1
    buffer_load_dwordx4 v[120:123], v6, s[8:11], s88 offen offset:768 sc1
    buffer_load_dwordx4 v[124:127], v6, s[8:11], s88 offen offset:1024 sc1
    buffer_load_dwordx4 v[128:131], v6, s[8:11], s88 offen offset:1280 sc1
    buffer_load_dwordx4 v[132:135], v6, s[8:11], s88 offen offset:1536 sc1
    buffer_load_dwordx4 v[136:139], v6, s[8:11], s88 offen offset:1792 sc1
    buffer_load_dwordx2 v[236:237], v7, s[8:11], s87 offen offset:0 sc1
    buffer_load_dwordx2 v[238:239], v7, s[8:11], s87 offen offset:512 sc1
    buffer_load_dwordx2 v[240:241], v7, s[8:11], s87 offen offset:1024 sc1
    buffer_load_dwordx2 v[242:243], v7, s[8:11], s87 offen offset:1536 sc1
    s_waitcnt vmcnt(0)
    v_max3_u32 v2, v108, v112, v116
    v_max3_u32 v2, v2, v120, v124
    v_max3_u32 v2, v2, v128, v132
    v_max_u32 v2, v2, v136
    v_cmp_eq_u32 vcc, -1, v2
    s_cbranch_vccz pollkm_ok_162
    s_sub_u32 s77, s77, 1
    s_cbranch_scc0 pollkm_161
    s_mov_b32 s77, 0
pollkm_ok_162:
    v_mfma_f32_32x32x16_bf16 v[172:187], v[108:111], v[12:15], 0
    v_mfma_f32_32x32x16_bf16 v[156:171], v[112:115], v[16:19], 0
    v_mfma_f32_32x32x16_bf16 v[172:187], v[116:119], v[20:23], v[172:187]
    v_mfma_f32_32x32x16_bf16 v[156:171], v[120:123], v[24:27], v[156:171]
    v_mfma_f32_32x32x16_bf16 v[172:187], v[124:127], v[28:31], v[172:187]
    v_mfma_f32_32x32x16_bf16 v[156:171], v[128:131], v[32:35], v[156:171]
    v_mfma_f32_32x32x16_bf16 v[172:187], v[132:135], v[36:39], v[172:187]
    v_mfma_f32_32x32x16_bf16 v[156:171], v[136:139], v[40:43], v[156:171]
    v_max3_u32 v3, v236, v238, v240
    v_max_u32 v3, v3, v242
    v_cmp_eq_u32 vcc, -1, v3
    s_cbranch_vccz at_v_163
    buffer_load_dwordx2 v[236:237], v7, s[8:11], s87 offen offset:0 sc1
    buffer_load_dwordx2 v[238:239], v7, s[8:11], s87 offen offset:512 sc1
    buffer_load_dwordx2 v[240:241], v7, s[8:11], s87 offen offset:1024 sc1
    buffer_load_dwordx2 v[242:243], v7, s[8:11], s87 offen offset:1536 sc1
at_v_163:
    s_mov_b64 s[2:3], vcc
    s_add_u32 s86, s86, 8
    s_mov_b32 s94, 0x5ffffff0
    s_cmp_ge_u32 s86, 64
    s_cbranch_scc1 at_nf_164
    s_add_u32 s93, s93, 1
    s_cmp_lg_u32 s58, 0
    s_cbranch_scc1 at_f_165
    s_cmp_eq_u32 s92, 2097216
    s_cbranch_scc1 at_rb_167
    s_max_u32 s88, s86, 2
    s_sub_u32 s88, s88, 2
    s_and_b32 s88, s88, -4
pollrb_168:
    buffer_load_dword v2, off, s[12:15], s88 offset:160 sc1
    buffer_load_dword v3, off, s[12:15], 0 offset:220 sc1
    s_waitcnt vmcnt(0)
    v_cmp_ne_u32 vcc, 2097216, v2
    s_cbranch_vccz pollrb_ok_169
    s_sub_u32 s77, s77, 1
    s_cbranch_scc0 pollrb_168
    s_mov_b32 s77, 0
pollrb_ok_169:
    v_readfirstlane_b32 s92, v3
at_rb_167:
    v_mov_b32 v2, s93
    ds_write_b32 v9, v2
at_f_165:
    ds_read_b32 v2, v9
    s_waitcnt lgkmcnt(0)
    v_cmp_gt_u32 vcc, s93, v2
    s_cbranch_vccz at_d_166
    s_sub_u32 s77, s77, 1
    s_cbranch_scc0 at_f_165
    s_mov_b32 s77, 0
at_d_166:
    s_lshl_b32 s94, s86, 2
    s_add_u32 s94, s94, s75
    s_lshl_b32 s94, s94, 3
    s_add_u32 s94, s94, s58
    s_lshl_b32 s94, s94, 13
    s_add_u32 s88, s94, 0x0
    buffer_load_dwordx4 v[12:15], v5, s[8:11], s88 offen offset:0 sc1
    buffer_load_dwordx4 v[16:19], v5, s[8:11], s88 offen offset:1024 sc1
    buffer_load_dwordx4 v[20:23], v5, s[8:11], s88 offen offset:2048 sc1
    buffer_load_dwordx4 v[24:27], v5, s[8:11], s88 offen offset:3072 sc1
    s_add_u32 s88, s88, 4096
    buffer_load_dwordx4 v[28:31], v5, s[8:11], s88 offen offset:0 sc1
    buffer_load_dwordx4 v[32:35], v5, s[8:11], s88 offen offset:1024 sc1
    buffer_load_dwordx4 v[36:39], v5, s[8:11], s88 offen offset:2048 sc1
    buffer_load_dwordx4 v[40:43], v5, s[8:11], s88 offen offset:3072 sc1
    s_add_u32 s88, s94, 0x1000000
    buffer_load_dwordx4 v[44:47], v5, s[8:11], s88 offen offset:0 sc1
    buffer_load_dwordx4 v[48:51], v5, s[8:11], s88 offen offset:1024 sc1
    buffer_load_dwordx4 v[52:55], v5, s[8:11], s88 offen offset:2048 sc1
    buffer_load_dwordx4 v[56:59], v5, s[8:11], s88 offen offset:3072 sc1
    s_add_u32 s88, s88, 4096
    buffer_load_dwordx4 v[60:63], v5, s[8:11], s88 offen offset:0 sc1
    buffer_load_dwordx4 v[64:67], v5, s[8:11], s88 offen offset:1024 sc1
    buffer_load_dwordx4 v[68:71], v5, s[8:11], s88 offen offset:2048 sc1
    buffer_load_dwordx4 v[72:75], v5, s[8:11], s88 offen offset:3072 sc1
at_nf_164:
    s_nop 2
    v_pk_add_f32 v[156:157], v[156:157], v[172:173]
    v_pk_add_f32 v[158:159], v[158:159], v[174:175]
    v_max3_f32 v2, v244, v155, v156
    v_max3_f32 v2, v2, v157, v158
    v_max_f32 v2, v2, v159
    v_mov_b32 v3, v2
    s_nop 1
    v_permlane32_swap_b32 v2, v3
    v_max_f32 v2, v2, v3
    v_mul_f32 v2, s89, v2
    v_fma_f32 v140, v140, s89, -v2
    v_fma_f32 v141, v141, s89, -v2
    v_exp_f32 v140, v140
    v_exp_f32 v141, v141
    v_fma_f32 v142, v142, s89, -v2
    v_fma_f32 v143, v143, s89, -v2
    v_exp_f32 v142, v142
    v_exp_f32 v143, v143
    v_cvt_pk_bf16_f32 v244, v140, v141
    v_fma_f32 v144, v144, s89, -v2
    v_fma_f32 v145, v145, s89, -v2
    v_exp_f32 v144, v144
    v_exp_f32 v145, v145
    v_cvt_pk_bf16_f32 v245, v142, v143
    v_fma_f32 v146, v146, s89, -v2
    v_fma_f32 v147, v147, s89, -v2
    v_exp_f32 v146, v146
    v_exp_f32 v147, v147
    v_cvt_pk_bf16_f32 v246, v144, v145
    v_fma_f32 v148, v148, s89, -v2
    v_fma_f32 v149, v149, s89, -v2
    v_exp_f32 v148, v148
    v_exp_f32 v149, v149
    v_cvt_pk_bf16_f32 v247, v146, v147
    v_fma_f32 v150, v150, s89, -v2
    v_fma_f32 v151, v151, s89, -v2
    v_exp_f32 v150, v150
    v_exp_f32 v151, v151
    v_cvt_pk_bf16_f32 v248, v148, v149
    v_mfma_f32_32x32x16_bf16 v[172:187], v[76:79], v[244:247], 0
    v_fma_f32 v152, v152, s89, -v2
    v_fma_f32 v153, v153, s89, -v2
    v_exp_f32 v152, v152
    v_exp_f32 v153, v153
    v_cvt_pk_bf16_f32 v249, v150, v151
    v_mfma_f32_32x32x16_bf16 v[188:203], v[84:87], v[244:247], 0
    v_fma_f32 v154, v154, s89, -v2
    v_fma_f32 v155, v155, s89, -v2
    v_exp_f32 v154, v154
    v_exp_f32 v155, v155
    v_cvt_pk_bf16_f32 v250, v152, v153
    v_mfma_f32_32x32x16_bf16 v[204:219], v[92:95], v[244:247], 0
    v_fma_f32 v156, v156, s89, -v2
    v_fma_f32 v157, v157, s89, -v2
    v_exp_f32 v156, v156
    v_exp_f32 v157, v157
    v_cvt_pk_bf16_f32 v251, v154, v155
    v_mfma_f32_32x32x16_bf16 v[220:235], v[100:103], v[244:247], 0
    v_fma_f32 v158, v158, s89, -v2
    v_fma_f32 v159, v159, s89, -v2
    v_exp_f32 v158, v158
    v_exp_f32 v159, v159
    v_cvt_pk_bf16_f32 v252, v156, v157
    v_add_f32 v2, v140, v141
    v_cvt_pk_bf16_f32 v253, v158, v159
    v_mfma_f32_32x32x16_bf16 v[172:187], v[80:83], v[248:251], v[172:187]
    v_add_f32 v2, v2, v142
    v_add_f32 v2, v2, v143
    v_add_f32 v2, v2, v144
    v_add_f32 v2, v2, v145
    v_add_f32 v2, v2, v146
    v_mfma_f32_32x32x16_bf16 v[188:203], v[88:91], v[248:251], v[188:203]
    v_add_f32 v2, v2, v147
    v_add_f32 v2, v2, v148
    v_add_f32 v2, v2, v149
    v_add_f32 v2, v2, v150
    v_add_f32 v2, v2, v151
    v_mfma_f32_32x32x16_bf16 v[204:219], v[96:99], v[248:251], v[204:219]
    v_add_f32 v2, v2, v152
    v_add_f32 v2, v2, v153
    v_add_f32 v2, v2, v154
    v_add_f32 v2, v2, v155
    v_add_f32 v2, v2, v156
    v_mfma_f32_32x32x16_bf16 v[220:235], v[104:107], v[248:251], v[220:235]
    v_add_f32 v2, v2, v157
    v_add_f32 v2, v2, v158
    v_add_f32 v2, v2, v159
    s_cmp_eq_u64 s[2:3], 0
    s_cbranch_scc1 at_vok_170
    s_waitcnt vmcnt(0)
    v_max3_u32 v3, v236, v238, v240
    v_max_u32 v3, v3, v242
    v_cmp_eq_u32 vcc, -1, v3
    s_cbranch_vccz pollvm_ok_172
pollvm_171:
    buffer_load_dwordx2 v[236:237], v7, s[8:11], s87 offen offset:0 sc1
    buffer_load_dwordx2 v[238:239], v7, s[8:11], s87 offen offset:512 sc1
    buffer_load_dwordx2 v[240:241], v7, s[8:11], s87 offen offset:1024 sc1
    buffer_load_dwordx2 v[242:243], v7, s[8:11], s87 offen offset:1536 sc1
    s_waitcnt vmcnt(0)
    v_max3_u32 v3, v236, v238, v240
    v_max_u32 v3, v3, v242
    v_cmp_eq_u32 vcc, -1, v3
    s_cbranch_vccz pollvm_ok_172
    s_sub_u32 s77, s77, 1
    s_cbranch_scc0 pollvm_171
    s_mov_b32 s77, 0
pollvm_ok_172:
at_vok_170:
    v_mfma_f32_32x32x8_bf16 v[172:187], v[236:237], v[252:253], v[172:187]
    v_mov_b32 v3, v2
    s_add_u32 s87, s90, 0x3000000
    v_mfma_f32_32x32x8_bf16 v[188:203], v[238:239], v[252:253], v[188:203]
    v_permlane32_swap_b32 v2, v3
    v_add_f32 v2, v2, v3
    v_rcp_f32 v2, v2
    v_mfma_f32_32x32x8_bf16 v[204:219], v[240:241], v[252:253], v[204:219]
    v_mfma_f32_32x32x8_bf16 v[220:235], v[242:243], v[252:253], v[220:235]
    s_nop 3
    v_pk_mul_f32 v[172:173], v[172:173], v[2:3] op_sel_hi:[1,0]
    v_pk_mul_f32 v[174:175], v[174:175], v[2:3] op_sel_hi:[1,0]
    v_pk_mul_f32 v[176:177], v[176:177], v[2:3] op_sel_hi:[1,0]
    v_pk_mul_f32 v[178:179], v[178:179], v[2:3] op_sel_hi:[1,0]
    v_cvt_pk_bf16_f32 v108, v172, v173
    v_cvt_pk_bf16_f32 v109, v174, v175
    v_cvt_pk_bf16_f32 v110, v176, v177
    v_cvt_pk_bf16_f32 v111, v178, v179
    buffer_store_dwordx4 v[108:111], v5, s[8:11], s87 offen offset:0
    v_pk_mul_f32 v[180:181], v[180:181], v[2:3] op_sel_hi:[1,0]
    v_pk_mul_f32 v[182:183], v[182:183], v[2:3] op_sel_hi:[1,0]
    v_pk_mul_f32 v[184:185], v[184:185], v[2:3] op_sel_hi:[1,0]
    v_pk_mul_f32 v[186:187], v[186:187], v[2:3] op_sel_hi:[1,0]
    v_cvt_pk_bf16_f32 v112, v180, v181
    v_cvt_pk_bf16_f32 v113, v182, v183
    v_cvt_pk_bf16_f32 v114, v184, v185
    v_cvt_pk_bf16_f32 v115, v186, v187
    buffer_store_dwordx4 v[112:115], v5, s[8:11], s87 offen offset:1024
    v_pk_mul_f32 v[188:189], v[188:189], v[2:3] op_sel_hi:[1,0]
    v_pk_mul_f32 v[190:191], v[190:191], v[2:3] op_sel_hi:[1,0]
    v_pk_mul_f32 v[192:193], v[192:193], v[2:3] op_sel_hi:[1,0]
    v_pk_mul_f32 v[194:195], v[194:195], v[2:3] op_sel_hi:[1,0]
    v_cvt_pk_bf16_f32 v116, v188, v189
    v_cvt_pk_bf16_f32 v117, v190, v191
    v_cvt_pk_bf16_f32 v118, v192, v193
    v_cvt_pk_bf16_f32 v119, v194, v195
    buffer_store_dwordx4 v[116:119], v5, s[8:11], s87 offen offset:2048
    v_pk_mul_f32 v[196:197], v[196:197], v[2:3] op_sel_hi:[1,0]
    v_pk_mul_f32 v[198:199], v[198:199], v[2:3] op_sel_hi:[1,0]
    v_pk_mul_f32 v[200:201], v[200:201], v[2:3] op_sel_hi:[1,0]
    v_pk_mul_f32 v[202:203], v[202:203], v[2:3] op_sel_hi:[1,0]
    v_cvt_pk_bf16_f32 v120, v196, v197
    v_cvt_pk_bf16_f32 v121, v198, v199
    v_cvt_pk_bf16_f32 v122, v200, v201
    v_cvt_pk_bf16_f32 v123, v202, v203
    buffer_store_dwordx4 v[120:123], v5, s[8:11], s87 offen offset:3072
    v_pk_mul_f32 v[204:205], v[204:205], v[2:3] op_sel_hi:[1,0]
    v_pk_mul_f32 v[206:207], v[206:207], v[2:3] op_sel_hi:[1,0]
    v_pk_mul_f32 v[208:209], v[208:209], v[2:3] op_sel_hi:[1,0]
    v_pk_mul_f32 v[210:211], v[210:211], v[2:3] op_sel_hi:[1,0]
    v_cvt_pk_bf16_f32 v124, v204, v205
    v_cvt_pk_bf16_f32 v125, v206, v207
    v_cvt_pk_bf16_f32 v126, v208, v209
    v_cvt_pk_bf16_f32 v127, v210, v211
    s_add_u32 s87, s87, 4096
    buffer_store_dwordx4 v[124:127], v5, s[8:11], s87 offen offset:0
    v_pk_mul_f32 v[212:213], v[212:213], v[2:3] op_sel_hi:[1,0]
    v_pk_mul_f32 v[214:215], v[214:215], v[2:3] op_sel_hi:[1,0]
    v_pk_mul_f32 v[216:217], v[216:217], v[2:3] op_sel_hi:[1,0]
    v_pk_mul_f32 v[218:219], v[218:219], v[2:3] op_sel_hi:[1,0]
    v_cvt_pk_bf16_f32 v128, v212, v213
    v_cvt_pk_bf16_f32 v129, v214, v215
    v_cvt_pk_bf16_f32 v130, v216, v217
    v_cvt_pk_bf16_f32 v131, v218, v219
    buffer_store_dwordx4 v[128:131], v5, s[8:11], s87 offen offset:1024
    v_pk_mul_f32 v[220:221], v[220:221], v[2:3] op_sel_hi:[1,0]
    v_pk_mul_f32 v[222:223], v[222:223], v[2:3] op_sel_hi:[1,0]
    v_pk_mul_f32 v[224:225], v[224:225], v[2:3] op_sel_hi:[1,0]
    v_pk_mul_f32 v[226:227], v[226:227], v[2:3] op_sel_hi:[1,0]
    v_cvt_pk_bf16_f32 v132, v220, v221
    v_cvt_pk_bf16_f32 v133, v222, v223
    v_cvt_pk_bf16_f32 v134, v224, v225
    v_cvt_pk_bf16_f32 v135, v226, v227
    buffer_store_dwordx4 v[132:135], v5, s[8:11], s87 offen offset:2048
    v_pk_mul_f32 v[228:229], v[228:229], v[2:3] op_sel_hi:[1,0]
    v_pk_mul_f32 v[230:231], v[230:231], v[2:3] op_sel_hi:[1,0]
    v_pk_mul_f32 v[232:233], v[232:233], v[2:3] op_sel_hi:[1,0]
    v_pk_mul_f32 v[234:235], v[234:235], v[2:3] op_sel_hi:[1,0]
    v_cvt_pk_bf16_f32 v136, v228, v229
    v_cvt_pk_bf16_f32 v137, v230, v231
    v_cvt_pk_bf16_f32 v138, v232, v233
    v_cvt_pk_bf16_f32 v139, v234, v235
    buffer_store_dwordx4 v[136:139], v5, s[8:11], s87 offen offset:3072
    s_add_u32 s88, s94, 0x2000000
    buffer_load_dwordx4 v[76:79], v5, s[8:11], s88 offen offset:0 sc1
    buffer_load_dwordx4 v[80:83], v5, s[8:11], s88 offen offset:1024 sc1
    buffer_load_dwordx4 v[84:87], v5, s[8:11], s88 offen offset:2048 sc1
    buffer_load_dwordx4 v[88:91], v5, s[8:11], s88 offen offset:3072 sc1
    s_add_u32 s88, s88, 4096
    buffer_load_dwordx4 v[92:95], v5, s[8:11], s88 offen offset:0 sc1
    buffer_load_dwordx4 v[96:99], v5, s[8:11], s88 offen offset:1024 sc1
    buffer_load_dwordx4 v[100:103], v5, s[8:11], s88 offen offset:2048 sc1
    buffer_load_dwordx4 v[104:107], v5, s[8:11], s88 offen offset:3072 sc1
    s_bfe_u32 s87, s90, 0x3000d
    s_lshl_b32 s87, s87, 2
    s_bfe_u32 s88, s90, 0x80010
    s_lshl_b32 s88, s88, 7
    s_or_b32 s87, s87, s88
    s_add_u32 s87, s87, 0x5100000
    v_mov_b32 v2, 1
    s_waitcnt vmcnt(8)
    buffer_store_dword v2, off, s[8:11], s87
    s_cmp_lt_u32 s86, 64
    s_cbranch_scc1 at_loop_149
end_61:
    s_waitcnt vmcnt(0)
    s_endpgm
.section .rodata,"a"
.p2align 6
.amdhsa_kernel concat_heads__spectral_gfnet__memory_aug_recurrent_mem_tr__prompt_kernel
  .amdhsa_next_free_vgpr 256
  .amdhsa_next_free_sgpr 102
  .amdhsa_accum_offset 256
  .amdhsa_group_segment_fixed_size 0
  .amdhsa_kernarg_size 104
  .amdhsa_user_sgpr_count 2
  .amdhsa_user_sgpr_kernarg_segment_ptr 1
  .amdhsa_system_sgpr_workgroup_id_x 1
  .amdhsa_float_denorm_mode_32 3
  .amdhsa_float_denorm_mode_16_64 3
.end_amdhsa_kernel
```

```asm
; @launch grid=(256,1,1) block=(512,1,1) lds=163840
.amdgcn_target "amdgcn-amd-amdhsa--gfx950"
.text
.globl concat_heads__spectral_gfnet__memory_aug_recurrent_mem_tr__prompt_kernel
.p2align 8
.type concat_heads__spectral_gfnet__memory_aug_recurrent_mem_tr__prompt_kernel,@function
concat_heads__spectral_gfnet__memory_aug_recurrent_mem_tr__prompt_kernel:
    s_load_dwordx2 s[8:9], s[0:1], 96
    s_load_dwordx2 s[12:13], s[0:1], 88
    s_load_dwordx2 s[16:17], s[0:1], 80
    s_load_dwordx2 s[20:21], s[0:1], 40
    s_load_dwordx2 s[24:25], s[0:1], 48
    s_load_dwordx2 s[28:29], s[0:1], 56
    s_load_dwordx2 s[32:33], s[0:1], 64
    s_load_dwordx2 s[36:37], s[0:1], 24
    s_load_dwordx2 s[40:41], s[0:1], 32
    s_load_dwordx2 s[44:45], s[0:1], 0
    s_load_dwordx2 s[48:49], s[0:1], 8
    s_load_dwordx2 s[52:53], s[0:1], 16
    s_mov_b32 s10, 0x10000000
    s_mov_b32 s11, 0x20000
    s_mov_b32 s14, 0x100
    s_mov_b32 s15, 0x20000
    s_mov_b32 s18, 0x800000
    s_mov_b32 s19, 0x20000
    s_mov_b32 s22, 0x800000
    s_mov_b32 s23, 0x20000
    s_mov_b32 s26, 0x800000
    s_mov_b32 s27, 0x20000
    s_mov_b32 s30, 0x800000
    s_mov_b32 s31, 0x20000
    s_mov_b32 s34, 0x800000
    s_mov_b32 s35, 0x20000
    s_mov_b32 s38, 0x400000
    s_mov_b32 s39, 0x20000
    s_mov_b32 s42, 0x4000
    s_mov_b32 s43, 0x20000
    s_mov_b32 s46, 0x400000
    s_mov_b32 s47, 0x20000
    s_mov_b32 s50, 0x201000
    s_mov_b32 s51, 0x20000
    s_mov_b32 s54, 0x201000
    s_mov_b32 s55, 0x20000
    s_waitcnt lgkmcnt(0)
    s_getreg_b32 s56, hwreg(HW_REG_XCC_ID, 0, 3)
    v_lshrrev_b32 v2, 6, v0
    v_and_b32 v1, 63, v0
    v_readfirstlane_b32 s58, v2
    s_nop 0
    s_cmp_lg_u32 s58, 0
    s_cbranch_scc1 notw0_1
    s_and_b32 s57, s56, 3
    s_mul_i32 s57, s57, 76
    s_and_b32 s3, s56, 4
    s_add_u32 s57, s57, s3
    v_mov_b32 v2, s57
    v_mov_b32 v3, 0x5ffffff0
    v_cmp_eq_u32 vcc, 0, v1
    s_nop 1
    v_cndmask_b32 v2, v3, v2, vcc
    v_mov_b32 v3, 1
    buffer_atomic_add v3, v2, s[12:15], 0 offen sc0 sc1
    v_mov_b32 v4, 0x27ff0
    s_waitcnt vmcnt(0)
    v_readfirstlane_b32 s3, v3
    s_nop 1
    v_mov_b32 v3, s3
    ds_write_b32 v4, v3
    s_waitcnt lgkmcnt(0)
notw0_1:
    s_barrier
    v_mov_b32 v4, 0x27ff0
    ds_read_b32 v3, v4
    s_waitcnt lgkmcnt(0)
    v_readfirstlane_b32 s57, v3
    s_nop 0
    s_cmp_lt_u32 s57, 32
    s_cbranch_scc1 go_3
    s_endpgm
go_3:
    s_cmp_ge_u32 s56, 4
    s_cbranch_scc1 bulk_2
    s_and_b32 s64, s57, 3
    s_lshr_b32 s65, s57, 2
    s_lshl_b32 s66, s56, 3
    s_add_u32 s66, s66, s65
    s_and_b32 s67, s58, 3
    s_mov_b32 s69, 0x40000
    v_and_b32 v6, 15, v1
    v_lshlrev_b32 v8, 4, v1
    v_mov_b32 v14, -1
    v_mov_b32 v15, -1
    v_mov_b32 v16, -1
    v_mov_b32 v17, -1
    s_mov_b32 s86, 0
    s_mov_b32 s87, 0
    s_mov_b32 s88, 0
    s_mov_b32 s89, 0
    s_mov_b32 s90, 0
    s_mov_b32 s91, 0
    s_mov_b32 s92, 0
    s_mov_b32 s93, 0
    s_mov_b32 s94, 0
    s_mov_b32 s95, 0
    s_mov_b32 s96, 0
    s_mov_b32 s97, 0
    s_mov_b32 s98, 0
    v_mov_b32 v2, 0x4444
    v_mov_b32 v3, 0xeeee
    v_and_b32 v4, 2, v1
    v_cmp_eq_u32 vcc, 0, v4
    s_nop 1
    v_cndmask_b32 v7, v3, v2, vcc
    v_bfe_u32 v36, v1, 0, 2
    v_lshlrev_b32 v36, 4, v36
    v_bfe_u32 v2, v1, 5, 1
    v_lshl_or_b32 v36, v2, 6, v36
    v_bfe_u32 v2, v1, 2, 2
    v_lshl_or_b32 v36, v2, 10, v36
    v_bfe_u32 v2, v1, 4, 1
    v_lshl_or_b32 v36, v2, 12, v36
    s_lshl_b32 s70, s56, 2
    s_add_u32 s70, s70, s64
    s_lshl_b32 s70, s70, 15
    s_add_u32 s70, s70, 0x4a00000
    s_lshl_b32 s71, s65, 2
    s_add_u32 s71, s71, s67
    s_lshl_b32 s72, s71, 10
    s_add_u32 s78, s70, s72
    s_lshl_b32 s72, s67, 13
    s_add_u32 s79, s70, s72
    s_lshl_b32 s72, s65, 7
    s_add_u32 s79, s79, s72
    s_bfe_u32 s77, s71, 0x20001
    s_lshl_b32 s77, s77, 7
    s_bfe_u32 s72, s71, 0x10000
    s_lshl_b32 s72, s72, 11
    s_or_b32 s77, s77, s72
    s_bfe_u32 s72, s71, 0x10003
    s_lshl_b32 s72, s72, 12
    s_or_b32 s77, s77, s72
    s_bfe_u32 s72, s71, 0x10004
    s_lshl_b32 s72, s72, 14
    s_or_b32 s77, s77, s72
    s_lshl_b32 s72, s56, 9
    s_add_u32 s77, s77, s72
    s_bfe_u32 s76, s58, 0x10000
    s_lshl_b32 s76, s76, 12
    s_bfe_u32 s72, s58, 0x10001
    s_lshl_b32 s72, s72, 14
    s_or_b32 s76, s76, s72
    s_lshl_b32 s72, s64, 15
    s_add_u32 s76, s76, s72
    s_add_u32 s72, s72, 0x20000
    s_add_u32 s77, s77, s72
    s_sub_u32 s7, 0, s8
    s_and_b32 s7, s7, 0x1fffff
    s_add_u32 s7, s7, 0x6c00000
    v_bfe_u32 v37, v1, 0, 2
    v_lshlrev_b32 v37, 4, v37
    v_bfe_u32 v2, v1, 4, 1
    v_lshl_or_b32 v37, v2, 6, v37
    v_bfe_u32 v2, v1, 2, 2
    v_lshl_or_b32 v37, v2, 7, v37
    v_bfe_u32 v2, v1, 5, 1
    v_lshl_or_b32 v37, v2, 9, v37
    v_add_u32 v37, s7, v37
    v_mov_b32 v5, 0x5ffffff0
    v_add_u32 v3, s7, v8
    v_cmp_gt_u32 vcc, 8, v1
    s_nop 1
    v_cndmask_b32 v35, v5, v3, vcc
    s_lshl_b32 s70, s66, 2
    s_add_u32 s70, s70, s67
    s_lshl_b32 s74, s70, 11
    s_add_u32 s74, s74, 0x4900000
    s_cmp_ge_u32 s58, 4
    s_cbranch_scc1 vo_arm_4
    s_lshl_b32 s73, s70, 12
    s_add_u32 s73, s73, 0x4800000
    s_lshl_b32 s71, s64, 10
    v_add_u32 v34, s71, v8
    s_add_u32 s71, s73, 0x80000
    buffer_store_dwordx4 v[14:17], v34, s[8:11], s73 offen
    buffer_store_dwordx4 v[14:17], v34, s[8:11], s71 offen
    v_bfe_u32 v2, v1, 0, 3
    v_lshlrev_b32 v2, 4, v2
    v_bfe_u32 v3, v1, 3, 1
    v_lshl_or_b32 v2, v3, 13, v2
    v_bfe_u32 v3, v1, 4, 2
    v_lshl_or_b32 v2, v3, 17, v2
    v_add_u32 v2, s7, v2
    buffer_store_dwordx4 v[14:17], v2, s[8:11], s77 offen sc1
    s_add_u32 s77, s77, 0x60000
    s_branch arm_done_5
vo_arm_4:
    s_mov_b32 s73, s74
    v_bfe_u32 v34, v1, 0, 4
    v_lshlrev_b32 v34, 4, v34
    v_bfe_u32 v2, v1, 5, 1
    v_lshl_or_b32 v34, v2, 8, v34
    v_bfe_u32 v2, v1, 4, 1
    v_lshl_or_b32 v34, v2, 10, v34
    s_bfe_u32 s71, s64, 0x10000
    s_lshl_b32 s71, s71, 3
    s_bfe_u32 s72, s64, 0x10001
    s_lshl_b32 s72, s72, 9
    s_or_b32 s71, s71, s72
    v_add_u32 v34, s71, v34
    s_add_u32 s71, s73, 0x40000
    buffer_store_dwordx2 v[14:15], v34, s[8:11], s73 offen
    buffer_store_dwordx2 v[14:15], v34, s[8:11], s71 offen
    s_add_u32 s71, s79, 0x80000
    buffer_store_dwordx4 v[14:17], v36, s[8:11], s79 offen
    buffer_store_dwordx4 v[14:17], v36, s[8:11], s71 offen
    s_add_u32 s2, s77, s7
    s_add_u32 s2, s2, 0x1c0000
    v_bfe_u32 v2, v1, 0, 2
    v_lshlrev_b32 v2, 21, v2
    v_bfe_u32 v3, v1, 2, 1
    v_lshl_or_b32 v2, v3, 13, v2
    s_cmp_lg_u32 s58, 4
    s_cbranch_scc1 arm_done_5
    buffer_store_dword v14, v2, s[8:11], s2 offen sc1
    s_lshl_b32 s71, s66, 7
    s_add_u32 s71, s71, 0x5110000
    buffer_store_dwordx2 v[14:15], off, s[8:11], s71 sc1
arm_done_5:
    v_bfe_u32 v2, v1, 0, 1
    v_lshlrev_b32 v2, 11, v2
    v_bfe_u32 v3, v1, 2, 2
    v_lshl_or_b32 v2, v3, 12, v2
    v_bfe_u32 v3, v1, 1, 1
    v_lshl_or_b32 v2, v3, 8, v2
    v_bfe_u32 v3, v1, 4, 2
    v_lshl_or_b32 v2, v3, 4, v2
    s_lshl_b32 s70, s64, 9
    s_lshl_b32 s71, s67, 6
    s_add_u32 s70, s70, s71
    buffer_load_dwordx4 v[10:13], v2, s[40:43], s70 offen
    v_bfe_u32 v2, v1, 4, 1
    v_lshlrev_b32 v2, 4, v2
    v_bfe_u32 v3, v1, 5, 1
    v_lshl_or_b32 v2, v3, 6, v2
    v_bfe_u32 v3, v1, 4, 2
    v_lshl_or_b32 v2, v3, 13, v2
    v_lshlrev_b32 v3, 4, v6
    v_xor_b32 v38, v2, v3
    v_xor_b32 v39, 0x80, v38
    v_bfe_u32 v2, v1, 5, 1
    v_lshlrev_b32 v2, 5, v2
    v_bfe_u32 v3, v1, 5, 1
    v_lshl_or_b32 v2, v3, 11, v2
    v_bfe_u32 v3, v1, 0, 5
    v_lshlrev_b32 v3, 4, v3
    v_xor_b32 v40, v2, v3
    s_lshl_b32 s71, s67, 6
    v_bfe_u32 v4, v1, 0, 1
    v_lshlrev_b32 v4, 3, v4
    v_bfe_u32 v2, v1, 2, 1
    v_lshl_or_b32 v4, v2, 4, v4
    v_bfe_u32 v2, v1, 1, 1
    v_lshl_or_b32 v4, v2, 5, v4
    v_bfe_u32 v2, v1, 5, 1
    v_lshl_or_b32 v4, v2, 7, v4
    v_bfe_u32 v2, v1, 2, 1
    v_lshl_or_b32 v4, v2, 8, v4
    v_bfe_u32 v2, v1, 4, 2
    v_lshl_or_b32 v4, v2, 10, v4
    v_bfe_u32 v2, v1, 3, 1
    v_lshl_or_b32 v4, v2, 15, v4
    s_lshl_b32 s70, s58, 13
    s_cmp_ge_u32 s58, 4
    s_cselect_b32 s70, 0, s70
    s_or_b32 s70, s70, s71
    v_xor_b32 v126, s70, v4
    v_bfe_u32 v4, v1, 0, 1
    v_lshlrev_b32 v4, 3, v4
    v_bfe_u32 v2, v1, 1, 1
    v_lshl_or_b32 v4, v2, 4, v4
    v_bfe_u32 v2, v1, 2, 1
    v_lshl_or_b32 v4, v2, 5, v4
    v_bfe_u32 v2, v1, 5, 1
    v_lshl_or_b32 v4, v2, 7, v4
    v_bfe_u32 v2, v1, 2, 1
    v_lshl_or_b32 v4, v2, 9, v4
    v_bfe_u32 v2, v1, 5, 1
    v_lshl_or_b32 v4, v2, 11, v4
    v_bfe_u32 v2, v1, 4, 1
    v_lshl_or_b32 v4, v2, 12, v4
    v_bfe_u32 v2, v1, 3, 1
    v_lshl_or_b32 v4, v2, 14, v4
    s_or_b32 s71, s71, 0x10000
    v_xor_b32 v127, s71, v4
    s_lshl_b32 s70, s64, 21
    s_lshl_b32 s71, s58, 18
    s_add_u32 s70, s70, s71
    s_lshl_b32 s71, s66, 8
    s_add_u32 s70, s70, s71
    s_lshl_b32 s71, s58, 13
    s_add_u32 s71, s71, 0
    s_mov_b32 m0, s71
    s_nop 0
    buffer_load_dwordx4 v38, s[24:27], s70 offen lds
    s_add_u32 s71, s71, 0x400
    s_add_u32 s70, s70, 0x8000
    s_mov_b32 m0, s71
    s_nop 0
    buffer_load_dwordx4 v38, s[24:27], s70 offen lds
    s_add_u32 s71, s71, 0x400
    s_add_u32 s70, s70, 0x8000
    s_mov_b32 m0, s71
    s_nop 0
    buffer_load_dwordx4 v39, s[24:27], s70 offen lds
    s_add_u32 s71, s71, 0x400
    s_add_u32 s70, s70, 0x8000
    s_mov_b32 m0, s71
    s_nop 0
    buffer_load_dwordx4 v39, s[24:27], s70 offen lds
    s_add_u32 s71, s71, 0x400
    s_add_u32 s70, s70, 0x8000
    s_mov_b32 m0, s71
    s_nop 0
    buffer_load_dwordx4 v38, s[24:27], s70 offen lds
    s_add_u32 s71, s71, 0x400
    s_add_u32 s70, s70, 0x8000
    s_mov_b32 m0, s71
    s_nop 0
    buffer_load_dwordx4 v38, s[24:27], s70 offen lds
    s_add_u32 s71, s71, 0x400
    s_add_u32 s70, s70, 0x8000
    s_mov_b32 m0, s71
    s_nop 0
    buffer_load_dwordx4 v39, s[24:27], s70 offen lds
    s_add_u32 s71, s71, 0x400
    s_add_u32 s70, s70, 0x8000
    s_mov_b32 m0, s71
    s_nop 0
    buffer_load_dwordx4 v39, s[24:27], s70 offen lds
    s_add_u32 s71, s71, 0x400
    s_add_u32 s70, s70, 0x8000
    s_lshl_b32 s70, s64, 21
    s_lshl_b32 s71, s58, 18
    s_add_u32 s70, s70, s71
    s_lshl_b32 s71, s66, 8
    s_add_u32 s70, s70, s71
    s_lshl_b32 s71, s58, 13
    s_add_u32 s71, s71, 65536
    s_mov_b32 m0, s71
    s_nop 0
    buffer_load_dwordx4 v38, s[28:31], s70 offen lds
    s_add_u32 s71, s71, 0x400
    s_add_u32 s70, s70, 0x8000
    s_mov_b32 m0, s71
    s_nop 0
    buffer_load_dwordx4 v38, s[28:31], s70 offen lds
    s_add_u32 s71, s71, 0x400
    s_add_u32 s70, s70, 0x8000
    s_mov_b32 m0, s71
    s_nop 0
    buffer_load_dwordx4 v39, s[28:31], s70 offen lds
    s_add_u32 s71, s71, 0x400
    s_add_u32 s70, s70, 0x8000
    s_mov_b32 m0, s71
    s_nop 0
    buffer_load_dwordx4 v39, s[28:31], s70 offen lds
    s_add_u32 s71, s71, 0x400
    s_add_u32 s70, s70, 0x8000
    s_mov_b32 m0, s71
    s_nop 0
    buffer_load_dwordx4 v38, s[28:31], s70 offen lds
    s_add_u32 s71, s71, 0x400
    s_add_u32 s70, s70, 0x8000
    s_mov_b32 m0, s71
    s_nop 0
    buffer_load_dwordx4 v38, s[28:31], s70 offen lds
    s_add_u32 s71, s71, 0x400
    s_add_u32 s70, s70, 0x8000
    s_mov_b32 m0, s71
    s_nop 0
    buffer_load_dwordx4 v39, s[28:31], s70 offen lds
    s_add_u32 s71, s71, 0x400
    s_add_u32 s70, s70, 0x8000
    s_mov_b32 m0, s71
    s_nop 0
    buffer_load_dwordx4 v39, s[28:31], s70 offen lds
    s_add_u32 s71, s71, 0x400
    s_add_u32 s70, s70, 0x8000
    s_cmp_lg_u32 s58, 4
    s_cbranch_scc1 novote_6
    s_waitcnt vmcnt(16)
    s_mov_b32 s3, 1
    s_mov_b32 s59, 0
    s_bitcmp1_b32 s57, 0
    s_cselect_b32 s60, -1, 1
    s_cselect_b32 s70, 0x2000, 0
    s_cselect_b32 s71, 0, 0x2000
    s_add_u32 s70, s70, s2
    s_add_u32 s71, s71, s2
    s_mov_b64 s[4:5], 0
    s_buffer_load_dword s4, s[8:11], s70
    s_buffer_load_dword s5, s[8:11], s71
    s_waitcnt lgkmcnt(1)
    s_sub_u32 s72, s4, s5
    s_waitcnt lgkmcnt(0)
    s_mul_i32 s72, s72, s60
    s_add_u32 s72, s72, 1
    s_min_u32 s72, s72, 2
    s_lshl_b32 s72, s72, 10
    s_add_u32 s3, s3, s72
    s_add_u32 s70, s70, 0x200000
    s_add_u32 s71, s71, 0x200000
    s_mov_b64 s[4:5], 0
    s_buffer_load_dword s4, s[8:11], s70
    s_buffer_load_dword s5, s[8:11], s71
    s_waitcnt lgkmcnt(1)
    s_sub_u32 s72, s4, s5
    s_waitcnt lgkmcnt(0)
    s_mul_i32 s72, s72, s60
    s_add_u32 s72, s72, 1
    s_min_u32 s72, s72, 2
    s_lshl_b32 s72, s72, 20
    s_add_u32 s3, s3, s72
    s_add_u32 s70, s70, 0x200000
    s_add_u32 s71, s71, 0x200000
    s_mov_b64 s[4:5], 0
    s_buffer_load_dword s4, s[8:11], s70
    s_buffer_load_dword s5, s[8:11], s71
    s_waitcnt lgkmcnt(1)
    s_sub_u32 s72, s4, s5
    s_waitcnt lgkmcnt(0)
    s_mul_i32 s72, s72, s60
    s_add_u32 s72, s72, 1
    s_min_u32 s72, s72, 2
    s_lshl_b32 s72, s72, 10
    s_add_u32 s59, s59, s72
    s_add_u32 s70, s70, 0x200000
    s_add_u32 s71, s71, 0x200000
    s_mov_b64 s[4:5], 0
    s_buffer_load_dword s4, s[8:11], s70
    s_buffer_load_dword s5, s[8:11], s71
    s_waitcnt lgkmcnt(1)
    s_sub_u32 s72, s4, s5
    s_waitcnt lgkmcnt(0)
    s_mul_i32 s72, s72, s60
    s_add_u32 s72, s72, 1
    s_min_u32 s72, s72, 2
    s_lshl_b32 s72, s72, 20
    s_add_u32 s59, s59, s72
    s_add_u32 s70, s70, 0x200000
    s_add_u32 s71, s71, 0x200000
novote_6:
    s_waitcnt vmcnt(0)
    s_barrier
    s_cmp_lg_u32 s58, 4
    s_cbranch_scc1 nosig_7
    v_mov_b32 v2, s3
    v_mov_b32 v3, s59
    v_cmp_eq_u32 vcc, 0, v1
    v_mov_b32 v5, 32
    v_mov_b32 v4, 0x5ffffff0
    v_cndmask_b32 v4, v4, v5, vcc
    buffer_atomic_add_x2 v[2:3], v4, s[12:15], 0 offen sc1
nosig_7:
    s_cmp_ge_u32 s58, 4
    s_cbranch_scc1 skip_8
    v_xor_b32 v2, 0x0, v126
    v_xor_b32 v3, 0x40, v126
    ds_read_b64_tr_b16 v[192:193], v2 offset:0
    ds_read_b64_tr_b16 v[194:195], v3 offset:512
    ds_read_b64_tr_b16 v[196:197], v2 offset:4096
    ds_read_b64_tr_b16 v[198:199], v3 offset:4608
    v_xor_b32 v2, 0x2000, v126
    v_xor_b32 v3, 0x2040, v126
    ds_read_b64_tr_b16 v[200:201], v2 offset:0
    ds_read_b64_tr_b16 v[202:203], v3 offset:512
    ds_read_b64_tr_b16 v[204:205], v2 offset:4096
    ds_read_b64_tr_b16 v[206:207], v3 offset:4608
    v_xor_b32 v2, 0x4000, v126
    v_xor_b32 v3, 0x4040, v126
    ds_read_b64_tr_b16 v[208:209], v2 offset:0
    ds_read_b64_tr_b16 v[210:211], v3 offset:512
    ds_read_b64_tr_b16 v[212:213], v2 offset:4096
    ds_read_b64_tr_b16 v[214:215], v3 offset:4608
    v_xor_b32 v2, 0x6000, v126
    v_xor_b32 v3, 0x6040, v126
    ds_read_b64_tr_b16 v[216:217], v2 offset:0
    ds_read_b64_tr_b16 v[218:219], v3 offset:512
    ds_read_b64_tr_b16 v[220:221], v2 offset:4096
    ds_read_b64_tr_b16 v[222:223], v3 offset:4608
    s_waitcnt lgkmcnt(0)
    v_xor_b32 v2, 0x10, v126
    v_xor_b32 v3, 0x50, v126
    ds_read_b64_tr_b16 v[224:225], v2 offset:0
    ds_read_b64_tr_b16 v[226:227], v3 offset:512
    ds_read_b64_tr_b16 v[228:229], v2 offset:4096
    ds_read_b64_tr_b16 v[230:231], v3 offset:4608
    v_xor_b32 v2, 0x2010, v126
    v_xor_b32 v3, 0x2050, v126
    ds_read_b64_tr_b16 v[232:233], v2 offset:0
    ds_read_b64_tr_b16 v[234:235], v3 offset:512
    ds_read_b64_tr_b16 v[236:237], v2 offset:4096
    ds_read_b64_tr_b16 v[238:239], v3 offset:4608
    v_xor_b32 v2, 0x4010, v126
    v_xor_b32 v3, 0x4050, v126
    ds_read_b64_tr_b16 v[240:241], v2 offset:0
    ds_read_b64_tr_b16 v[242:243], v3 offset:512
    ds_read_b64_tr_b16 v[244:245], v2 offset:4096
    ds_read_b64_tr_b16 v[246:247], v3 offset:4608
    v_xor_b32 v2, 0x6010, v126
    v_xor_b32 v3, 0x6050, v126
    ds_read_b64_tr_b16 v[248:249], v2 offset:0
    ds_read_b64_tr_b16 v[250:251], v3 offset:512
    ds_read_b64_tr_b16 v[252:253], v2 offset:4096
    ds_read_b64_tr_b16 v[254:255], v3 offset:4608
    s_waitcnt lgkmcnt(0)
skip_8:
    s_cmp_ge_u32 s58, 4
    s_cbranch_scc0 skip_9
    v_xor_b32 v2, 0x10000, v126
    v_xor_b32 v3, 0x10040, v126
    ds_read_b64_tr_b16 v[128:129], v2 offset:0
    ds_read_b64_tr_b16 v[130:131], v3 offset:512
    ds_read_b64_tr_b16 v[132:133], v2 offset:4096
    ds_read_b64_tr_b16 v[134:135], v3 offset:4608
    v_xor_b32 v2, 0x12000, v126
    v_xor_b32 v3, 0x12040, v126
    ds_read_b64_tr_b16 v[136:137], v2 offset:0
    ds_read_b64_tr_b16 v[138:139], v3 offset:512
    ds_read_b64_tr_b16 v[140:141], v2 offset:4096
    ds_read_b64_tr_b16 v[142:143], v3 offset:4608
    v_xor_b32 v2, 0x14000, v126
    v_xor_b32 v3, 0x14040, v126
    ds_read_b64_tr_b16 v[144:145], v2 offset:0
    ds_read_b64_tr_b16 v[146:147], v3 offset:512
    ds_read_b64_tr_b16 v[148:149], v2 offset:4096
    ds_read_b64_tr_b16 v[150:151], v3 offset:4608
    v_xor_b32 v2, 0x16000, v126
    v_xor_b32 v3, 0x16040, v126
    ds_read_b64_tr_b16 v[152:153], v2 offset:0
    ds_read_b64_tr_b16 v[154:155], v3 offset:512
    ds_read_b64_tr_b16 v[156:157], v2 offset:4096
    ds_read_b64_tr_b16 v[158:159], v3 offset:4608
    s_waitcnt lgkmcnt(0)
    v_xor_b32 v2, 0x10010, v126
    v_xor_b32 v3, 0x10050, v126
    ds_read_b64_tr_b16 v[160:161], v2 offset:0
    ds_read_b64_tr_b16 v[162:163], v3 offset:512
    ds_read_b64_tr_b16 v[164:165], v2 offset:4096
    ds_read_b64_tr_b16 v[166:167], v3 offset:4608
    v_xor_b32 v2, 0x12010, v126
    v_xor_b32 v3, 0x12050, v126
    ds_read_b64_tr_b16 v[168:169], v2 offset:0
    ds_read_b64_tr_b16 v[170:171], v3 offset:512
    ds_read_b64_tr_b16 v[172:173], v2 offset:4096
    ds_read_b64_tr_b16 v[174:175], v3 offset:4608
    v_xor_b32 v2, 0x14010, v126
    v_xor_b32 v3, 0x14050, v126
    ds_read_b64_tr_b16 v[176:177], v2 offset:0
    ds_read_b64_tr_b16 v[178:179], v3 offset:512
    ds_read_b64_tr_b16 v[180:181], v2 offset:4096
    ds_read_b64_tr_b16 v[182:183], v3 offset:4608
    v_xor_b32 v2, 0x16010, v126
    v_xor_b32 v3, 0x16050, v126
    ds_read_b64_tr_b16 v[184:185], v2 offset:0
    ds_read_b64_tr_b16 v[186:187], v3 offset:512
    ds_read_b64_tr_b16 v[188:189], v2 offset:4096
    ds_read_b64_tr_b16 v[190:191], v3 offset:4608
    s_waitcnt lgkmcnt(0)
skip_9:
    s_barrier
    s_lshl_b32 s70, s64, 21
    s_lshl_b32 s71, s58, 18
    s_add_u32 s70, s70, s71
    s_lshl_b32 s71, s66, 8
    s_add_u32 s70, s70, s71
    s_lshl_b32 s71, s58, 13
    s_add_u32 s71, s71, 0
    s_mov_b32 m0, s71
    s_nop 0
    buffer_load_dwordx4 v38, s[20:23], s70 offen lds
    s_add_u32 s71, s71, 0x400
    s_add_u32 s70, s70, 0x8000
    s_mov_b32 m0, s71
    s_nop 0
    buffer_load_dwordx4 v38, s[20:23], s70 offen lds
    s_add_u32 s71, s71, 0x400
    s_add_u32 s70, s70, 0x8000
    s_mov_b32 m0, s71
    s_nop 0
    buffer_load_dwordx4 v39, s[20:23], s70 offen lds
    s_add_u32 s71, s71, 0x400
    s_add_u32 s70, s70, 0x8000
    s_mov_b32 m0, s71
    s_nop 0
    buffer_load_dwordx4 v39, s[20:23], s70 offen lds
    s_add_u32 s71, s71, 0x400
    s_add_u32 s70, s70, 0x8000
    s_mov_b32 m0, s71
    s_nop 0
    buffer_load_dwordx4 v38, s[20:23], s70 offen lds
    s_add_u32 s71, s71, 0x400
    s_add_u32 s70, s70, 0x8000
    s_mov_b32 m0, s71
    s_nop 0
    buffer_load_dwordx4 v38, s[20:23], s70 offen lds
    s_add_u32 s71, s71, 0x400
    s_add_u32 s70, s70, 0x8000
    s_mov_b32 m0, s71
    s_nop 0
    buffer_load_dwordx4 v39, s[20:23], s70 offen lds
    s_add_u32 s71, s71, 0x400
    s_add_u32 s70, s70, 0x8000
    s_mov_b32 m0, s71
    s_nop 0
    buffer_load_dwordx4 v39, s[20:23], s70 offen lds
    s_add_u32 s71, s71, 0x400
    s_add_u32 s70, s70, 0x8000
    s_lshl_b32 s70, s66, 18
    s_lshl_b32 s71, s58, 15
    s_add_u32 s70, s70, s71
    s_lshl_b32 s71, s64, 9
    s_add_u32 s70, s70, s71
    s_lshl_b32 s71, s58, 13
    s_add_u32 s71, s71, 65536
    v_xor_b32 v2, 0, v40
    s_mov_b32 m0, s71
    s_nop 0
    buffer_load_dwordx4 v2, s[32:35], s70 offen lds
    s_add_u32 s71, s71, 0x400
    s_add_u32 s70, s70, 0x1000
    v_xor_b32 v2, 64, v40
    s_mov_b32 m0, s71
    s_nop 0
    buffer_load_dwordx4 v2, s[32:35], s70 offen lds
    s_add_u32 s71, s71, 0x400
    s_add_u32 s70, s70, 0x1000
    v_xor_b32 v2, 128, v40
    s_mov_b32 m0, s71
    s_nop 0
    buffer_load_dwordx4 v2, s[32:35], s70 offen lds
    s_add_u32 s71, s71, 0x400
    s_add_u32 s70, s70, 0x1000
    v_xor_b32 v2, 192, v40
    s_mov_b32 m0, s71
    s_nop 0
    buffer_load_dwordx4 v2, s[32:35], s70 offen lds
    s_add_u32 s71, s71, 0x400
    s_add_u32 s70, s70, 0x1000
    v_xor_b32 v2, 0, v40
    s_mov_b32 m0, s71
    s_nop 0
    buffer_load_dwordx4 v2, s[32:35], s70 offen lds
    s_add_u32 s71, s71, 0x400
    s_add_u32 s70, s70, 0x1000
    v_xor_b32 v2, 64, v40
    s_mov_b32 m0, s71
    s_nop 0
    buffer_load_dwordx4 v2, s[32:35], s70 offen lds
    s_add_u32 s71, s71, 0x400
    s_add_u32 s70, s70, 0x1000
    v_xor_b32 v2, 128, v40
    s_mov_b32 m0, s71
    s_nop 0
    buffer_load_dwordx4 v2, s[32:35], s70 offen lds
    s_add_u32 s71, s71, 0x400
    s_add_u32 s70, s70, 0x1000
    v_xor_b32 v2, 192, v40
    s_mov_b32 m0, s71
    s_nop 0
    buffer_load_dwordx4 v2, s[32:35], s70 offen lds
    s_add_u32 s71, s71, 0x400
    s_add_u32 s70, s70, 0x1000
    s_mov_b32 s68, 0
    s_mov_b32 s82, 0
    s_lshl_b32 s80, s66, 11
    s_lshl_b32 s70, s67, 9
    s_add_u32 s80, s80, s70
    v_bfe_u32 v38, v1, 0, 3
    v_lshlrev_b32 v38, 4, v38
    v_bfe_u32 v2, v1, 3, 1
    v_lshl_or_b32 v38, v2, 8, v38
    v_bfe_u32 v2, v1, 4, 2
    v_lshl_or_b32 v38, v2, 9, v38
    s_lshl_b32 s75, s80, 2
    s_add_u32 s75, s75, 0x1000000
    s_cmp_ge_u32 s58, 4
    s_cbranch_scc1 vo_main_10
    s_setprio 3
    s_lshl_b32 s70, s66, 4
    s_lshl_b32 s71, s64, 2
    s_add_u32 s71, s71, s67
    s_add_u32 s3, s70, s71
    s_add_u32 s80, s80, 0x3ff0000
    s_lshl_b32 s70, s67, 10
    v_add_u32 v102, s70, v8
    v_lshrrev_b32 v103, 2, v102
    v_bfe_u32 v2, v1, 0, 3
    v_lshlrev_b32 v2, 4, v2
    v_bfe_u32 v3, v1, 4, 2
    v_lshl_or_b32 v2, v3, 7, v2
    v_mov_b32 v3, 0x5ffffff0
    v_cmp_le_u32 vcc, 8, v6
    s_nop 1
    v_cndmask_b32 v104, v3, v2, vcc
    v_xor_b32 v100, 1024, v102
    v_xor_b32 v101, 2048, v102
    v_xor_b32 v36, 3072, v102
    v_xor_b32 v106, 0x400, v34
    v_bfe_u32 v105, v1, 0, 4
    v_lshlrev_b32 v105, 4, v105
    v_bfe_u32 v2, v1, 4, 2
    v_lshl_or_b32 v105, v2, 9, v105
    s_lshl_b32 s70, s64, 10
    s_xor_b32 s70, s70, 0x800
    v_xor_b32 v105, s70, v105
    v_and_b32 v2, 1, v1
    v_lshlrev_b32 v2, 4, v2
    v_mov_b32 v3, 0x3f80
    v_lshlrev_b32 v2, v2, v3
    v_bfe_u32 v3, v1, 1, 1
    v_bfe_u32 v4, v1, 3, 1
    v_lshl_or_b32 v3, v4, 1, v3
    v_bfe_u32 v4, v1, 2, 1
    v_lshl_or_b32 v3, v4, 2, v3
    v_bfe_u32 v4, v1, 4, 1
    v_lshlrev_b32 v4, 2, v4
    v_xor_b32 v3, v3, v4
    v_cmp_eq_u32 vcc, 0, v3
    s_nop 1
    v_cndmask_b32 v26, 0, v2, vcc
    v_cmp_eq_u32 vcc, 1, v3
    s_nop 1
    v_cndmask_b32 v27, 0, v2, vcc
    v_cmp_eq_u32 vcc, 2, v3
    s_nop 1
    v_cndmask_b32 v28, 0, v2, vcc
    v_cmp_eq_u32 vcc, 3, v3
    s_nop 1
    v_cndmask_b32 v29, 0, v2, vcc
    v_bfe_u32 v3, v1, 1, 1
    v_bfe_u32 v4, v1, 3, 1
    v_lshl_or_b32 v3, v4, 1, v3
    v_bfe_u32 v4, v1, 4, 1
    v_lshl_or_b32 v3, v4, 2, v3
    v_bfe_u32 v4, v1, 2, 1
    v_lshl_or_b32 v3, v4, 3, v3
    v_bfe_u32 v4, v1, 5, 1
    v_lshlrev_b32 v4, 3, v4
    v_xor_b32 v3, v3, v4
    v_cmp_eq_u32 vcc, 0, v3
    s_nop 1
    v_cndmask_b32 v92, 0, v2, vcc
    v_cmp_eq_u32 vcc, 1, v3
    s_nop 1
    v_cndmask_b32 v93, 0, v2, vcc
    v_cmp_eq_u32 vcc, 2, v3
    s_nop 1
    v_cndmask_b32 v94, 0, v2, vcc
    v_cmp_eq_u32 vcc, 3, v3
    s_nop 1
    v_cndmask_b32 v95, 0, v2, vcc
    v_cmp_eq_u32 vcc, 4, v3
    s_nop 1
    v_cndmask_b32 v96, 0, v2, vcc
    v_cmp_eq_u32 vcc, 5, v3
    s_nop 1
    v_cndmask_b32 v97, 0, v2, vcc
    v_cmp_eq_u32 vcc, 6, v3
    s_nop 1
    v_cndmask_b32 v98, 0, v2, vcc
    v_cmp_eq_u32 vcc, 7, v3
    s_nop 1
    v_cndmask_b32 v99, 0, v2, vcc
    v_bfe_u32 v3, v1, 2, 1
    v_bfe_u32 v4, v1, 1, 1
    v_lshl_or_b32 v3, v4, 1, v3
    v_bfe_u32 v4, v1, 3, 1
    v_lshl_or_b32 v3, v4, 2, v3
    v_bfe_u32 v4, v1, 4, 1
    v_lshlrev_b32 v4, 2, v4
    v_xor_b32 v3, v3, v4
    v_cmp_eq_u32 vcc, 0, v3
    s_nop 1
    v_cndmask_b32 v30, 0, v2, vcc
    v_cmp_eq_u32 vcc, 1, v3
    s_nop 1
    v_cndmask_b32 v31, 0, v2, vcc
    v_cmp_eq_u32 vcc, 2, v3
    s_nop 1
    v_cndmask_b32 v32, 0, v2, vcc
    v_cmp_eq_u32 vcc, 3, v3
    s_nop 1
    v_cndmask_b32 v33, 0, v2, vcc
    v_mov_b32 v40, 0
    v_mov_b32 v41, 0
    v_mov_b32 v42, 0
    v_mov_b32 v43, 0
    v_mov_b32 v44, 0
    v_mov_b32 v45, 0
    v_mov_b32 v46, 0
    v_mov_b32 v47, 0
    v_mov_b32 v48, 0
    v_mov_b32 v49, 0
    v_mov_b32 v50, 0
    v_mov_b32 v51, 0
    v_mov_b32 v52, 0
    v_mov_b32 v53, 0
    v_mov_b32 v54, 0
    v_mov_b32 v55, 0
    s_waitcnt vmcnt(8)
    s_barrier
    v_xor_b32 v2, 0x0, v126
    v_xor_b32 v3, 0x40, v126
    ds_read_b64_tr_b16 v[128:129], v2 offset:0
    ds_read_b64_tr_b16 v[130:131], v3 offset:512
    ds_read_b64_tr_b16 v[132:133], v2 offset:4096
    ds_read_b64_tr_b16 v[134:135], v3 offset:4608
    v_xor_b32 v2, 0x2000, v126
    v_xor_b32 v3, 0x2040, v126
    ds_read_b64_tr_b16 v[136:137], v2 offset:0
    ds_read_b64_tr_b16 v[138:139], v3 offset:512
    ds_read_b64_tr_b16 v[140:141], v2 offset:4096
    ds_read_b64_tr_b16 v[142:143], v3 offset:4608
    v_xor_b32 v2, 0x4000, v126
    v_xor_b32 v3, 0x4040, v126
    ds_read_b64_tr_b16 v[144:145], v2 offset:0
    ds_read_b64_tr_b16 v[146:147], v3 offset:512
    ds_read_b64_tr_b16 v[148:149], v2 offset:4096
    ds_read_b64_tr_b16 v[150:151], v3 offset:4608
    v_xor_b32 v2, 0x6000, v126
    v_xor_b32 v3, 0x6040, v126
    ds_read_b64_tr_b16 v[152:153], v2 offset:0
    ds_read_b64_tr_b16 v[154:155], v3 offset:512
    ds_read_b64_tr_b16 v[156:157], v2 offset:4096
    ds_read_b64_tr_b16 v[158:159], v3 offset:4608
    s_waitcnt lgkmcnt(0)
    v_xor_b32 v2, 0x10, v126
    v_xor_b32 v3, 0x50, v126
    ds_read_b64_tr_b16 v[160:161], v2 offset:0
    ds_read_b64_tr_b16 v[162:163], v3 offset:512
    ds_read_b64_tr_b16 v[164:165], v2 offset:4096
    ds_read_b64_tr_b16 v[166:167], v3 offset:4608
    v_xor_b32 v2, 0x2010, v126
    v_xor_b32 v3, 0x2050, v126
    ds_read_b64_tr_b16 v[168:169], v2 offset:0
    ds_read_b64_tr_b16 v[170:171], v3 offset:512
    ds_read_b64_tr_b16 v[172:173], v2 offset:4096
    ds_read_b64_tr_b16 v[174:175], v3 offset:4608
    v_xor_b32 v2, 0x4010, v126
    v_xor_b32 v3, 0x4050, v126
    ds_read_b64_tr_b16 v[176:177], v2 offset:0
    ds_read_b64_tr_b16 v[178:179], v3 offset:512
    ds_read_b64_tr_b16 v[180:181], v2 offset:4096
    ds_read_b64_tr_b16 v[182:183], v3 offset:4608
    v_xor_b32 v2, 0x6010, v126
    v_xor_b32 v3, 0x6050, v126
    ds_read_b64_tr_b16 v[184:185], v2 offset:0
    ds_read_b64_tr_b16 v[186:187], v3 offset:512
    ds_read_b64_tr_b16 v[188:189], v2 offset:4096
    ds_read_b64_tr_b16 v[190:191], v3 offset:4608
    s_waitcnt lgkmcnt(0)
    s_lshl_b32 s4, s66, 7
    s_add_u32 s4, s4, 0x5110000
    s_waitcnt vmcnt(0)
    v_mov_b32 v4, 0x27ff0
    s_barrier
    ds_read_b64 v[2:3], v4
    s_mov_b32 s59, 0
    s_waitcnt lgkmcnt(0)
    v_readfirstlane_b32 s70, v2
    v_readfirstlane_b32 s71, v3
    s_bfe_u32 s72, s70, 0xa000a
    s_cmp_gt_u32 s72, 128
    s_cselect_b32 s72, 1, 0
    s_or_b32 s59, s59, s72
    s_bfe_u32 s72, s70, 0xa0014
    s_cmp_gt_u32 s72, 128
    s_cselect_b32 s72, 2, 0
    s_or_b32 s59, s59, s72
    s_bfe_u32 s72, s71, 0xa000a
    s_cmp_gt_u32 s72, 128
    s_cselect_b32 s72, 4, 0
    s_or_b32 s59, s59, s72
    s_bfe_u32 s72, s71, 0xa0014
    s_cmp_gt_u32 s72, 128
    s_cselect_b32 s72, 8, 0
    s_or_b32 s59, s59, s72
    s_and_b32 s70, s59, 1
    s_lshl_b32 s70, s70, 13
    s_add_u32 s77, s77, s70
    s_add_u32 s76, s76, s70
    s_branch qk_loop_13
.p2align 6
qk_c_14:
    s_barrier
    buffer_load_dwordx4 v[56:59], v37, s[8:11], s76 offen offset:0 sc1
    buffer_load_dwordx4 v[60:63], v37, s[8:11], s76 offen offset:1024 sc1
    buffer_load_dwordx4 v[64:67], v37, s[8:11], s76 offen offset:2048 sc1
    buffer_load_dwordx4 v[68:71], v37, s[8:11], s76 offen offset:3072 sc1
c_w_16:
    s_waitcnt vmcnt(3)
    v_mfma_f32_16x16x32_bf16 v[72:75], v[56:59], v[30:33], 0
    s_waitcnt vmcnt(2)
    v_mfma_f32_16x16x32_bf16 v[72:75], v[60:63], v[30:33], v[72:75]
    s_waitcnt vmcnt(1)
    v_mfma_f32_16x16x32_bf16 v[76:79], v[64:67], v[30:33], 0
    v_max3_u32 v2, v56, v60, v64
    s_waitcnt vmcnt(0)
    v_mfma_f32_16x16x32_bf16 v[76:79], v[68:71], v[30:33], v[76:79]
    v_max_u32 v2, v2, v68
    v_cmp_eq_u32 vcc, -1, v2
    s_cbranch_vccnz c_s_15
c_j_17:
    v_cvt_pk_bf16_f32 v10, v72, v73
    v_cvt_pk_bf16_f32 v11, v74, v75
    s_nop 2
    v_cvt_pk_bf16_f32 v12, v76, v77
    v_cvt_pk_bf16_f32 v13, v78, v79
qk_loop_13:
    ds_write_b128 v102, v[10:13] offset:0
    s_waitcnt lgkmcnt(0)
    s_barrier
    ds_read_b128 v[14:17], v100 offset:0
    ds_read_b128 v[18:21], v101 offset:0
    ds_read_b128 v[22:25], v36 offset:0
    v_smfmac_f32_16x16x64_bf16 v[40:43], v[10:13], v[128:135], v7
    v_smfmac_f32_16x16x64_bf16 v[44:47], v[10:13], v[160:167], v7
    v_smfmac_f32_16x16x64_bf16 v[48:51], v[10:13], v[192:199], v7
    v_smfmac_f32_16x16x64_bf16 v[52:55], v[10:13], v[224:231], v7
    s_waitcnt lgkmcnt(2)
    v_smfmac_f32_16x16x64_bf16 v[40:43], v[14:17], v[136:143], v7
    v_smfmac_f32_16x16x64_bf16 v[44:47], v[14:17], v[168:175], v7
    s_waitcnt lgkmcnt(1)
    v_smfmac_f32_16x16x64_bf16 v[40:43], v[18:21], v[144:151], v7
    v_smfmac_f32_16x16x64_bf16 v[44:47], v[18:21], v[176:183], v7
    s_waitcnt lgkmcnt(0)
    v_smfmac_f32_16x16x64_bf16 v[40:43], v[22:25], v[152:159], v7
    v_smfmac_f32_16x16x64_bf16 v[44:47], v[22:25], v[184:191], v7
    v_smfmac_f32_16x16x64_bf16 v[48:51], v[14:17], v[200:207], v7
    v_smfmac_f32_16x16x64_bf16 v[48:51], v[18:21], v[208:215], v7
    v_smfmac_f32_16x16x64_bf16 v[48:51], v[22:25], v[216:223], v7
    v_smfmac_f32_16x16x64_bf16 v[52:55], v[14:17], v[232:239], v7
    s_nop 1
    v_smfmac_f32_16x16x64_bf16 v[52:55], v[18:21], v[240:247], v7
    v_pk_add_f32 v[40:41], v[40:41], v[42:43]
    v_cvt_pk_bf16_f32 v80, v40, v41
    v_smfmac_f32_16x16x64_bf16 v[52:55], v[22:25], v[248:255], v7
    v_pk_add_f32 v[44:45], v[44:45], v[46:47]
    v_cvt_pk_bf16_f32 v81, v44, v45
    v_pk_add_f32 v[48:49], v[48:49], v[50:51]
    v_cvt_pk_bf16_f32 v82, v48, v49
    v_permlane16_swap_b32 v80, v81
    v_bfi_b32 v80, 1, s82, v80
    s_nop 1
    v_pk_add_f32 v[52:53], v[52:53], v[54:55]
    v_cvt_pk_bf16_f32 v83, v52, v53
    s_nop 1
    v_permlane16_swap_b32 v82, v83
    buffer_store_dwordx4 v[80:83], v34, s[8:11], s73 offen
    s_barrier
    s_cmp_le_u32 s68, 1
    s_cbranch_scc1 kv0_18
kv0j_19:
    v_mfma_f32_16x16x32_bf16 v[72:75], v[80:83], v[92:95], 0
    v_mfma_f32_16x16x32_bf16 v[76:79], v[80:83], v[96:99], 0
    v_mov_b32 v40, 0
    v_mov_b32 v41, 0
    v_mov_b32 v42, 0
    v_mov_b32 v43, 0
    v_mov_b32 v44, 0
    v_mov_b32 v45, 0
    v_mov_b32 v46, 0
    v_mov_b32 v47, 0
    v_mov_b32 v48, 0
    v_mov_b32 v49, 0
    v_mov_b32 v50, 0
    v_mov_b32 v51, 0
    v_mov_b32 v52, 0
    v_mov_b32 v53, 0
    v_mov_b32 v54, 0
    v_mov_b32 v55, 0
    s_add_u32 s80, s80, 0x10000
    s_and_b32 s72, s68, 3
    buffer_load_dwordx4 v[56:59], v106, s[8:11], s73 offen sc1
    buffer_load_dwordx4 v[60:63], v105, s[8:11], s73 offen sc1
    buffer_load_dwordx4 v[64:67], v105, s[8:11], s73 offen offset:256 sc1
x_w_21:
    s_waitcnt vmcnt(2)
    v_mfma_f32_16x16x32_bf16 v[18:21], v[56:59], v[92:95], v[72:75]
    v_mfma_f32_16x16x32_bf16 v[22:25], v[56:59], v[96:99], v[76:79]
    s_waitcnt vmcnt(1)
    v_mfma_f32_16x16x32_bf16 v[18:21], v[60:63], v[26:29], v[18:21]
    v_bitop3_b32 v2, v56, v60, s82 bitop3:0x7e
    s_waitcnt vmcnt(0)
    v_mfma_f32_16x16x32_bf16 v[22:25], v[64:67], v[26:29], v[22:25]
    v_xor_b32 v3, s82, v64
    v_bitop3_b32 v2, v2, v3, 1 bitop3:0xa8
    v_cmp_ne_u32 vcc, 0, v2
    s_cbranch_vccnz x_s_20
x_j_22:
    s_nop 0
    v_cvt_pk_bf16_f32 v80, v18, v19
    v_cvt_pk_bf16_f32 v81, v20, v21
    s_nop 0
    v_cvt_pk_bf16_f32 v82, v22, v23
    v_cvt_pk_bf16_f32 v83, v24, v25
    s_nop 1
    v_mfma_f32_16x16x32_bf16 v[18:21], v[80:83], v[80:83], 0
    s_cmp_eq_u32 s68, 63
    s_cbranch_scc1 lastk_23
    v_mfma_f32_16x16x32_bf16 v[14:17], v[88:91], v[80:83], 0
    s_nop 1
    v_mfma_f32_16x16x32_bf16 v[10:13], v[84:87], v[80:83], 0
    s_nop 1
    v_mov_b32_dpp v18, v20 row_shr:8 row_mask:0xf bank_mask:0xc
    v_mov_b32_dpp v19, v21 row_shr:8 row_mask:0xf bank_mask:0xc
    s_nop 1
    v_permlane32_swap_b32 v18, v19
    ds_write_b32 v103, v19 offset:8192
    v_mov_b32_dpp v10, v14 row_shr:8 row_mask:0xf bank_mask:0xc
    v_mov_b32_dpp v11, v15 row_shr:8 row_mask:0xf bank_mask:0xc
    v_mov_b32_dpp v12, v16 row_shr:8 row_mask:0xf bank_mask:0xc
    v_mov_b32_dpp v13, v17 row_shr:8 row_mask:0xf bank_mask:0xc
    ds_write_b128 v102, v[10:13] offset:4096
    s_waitcnt lgkmcnt(0)
    s_barrier
    s_setprio 0
    s_add_u32 s77, s77, 0x20000
    s_lshr_b32 s60, s77, 21
    s_bitcmp1_b32 s59, s60
    s_cselect_b32 s60, 0x2000, 0
    s_bitset0_b32 s77, 13
    s_or_b32 s77, s77, s60
    s_add_u32 s76, s76, 0x20000
    s_lshr_b32 s60, s76, 21
    s_bitcmp1_b32 s59, s60
    s_cselect_b32 s60, 0x2000, 0
    s_bitset0_b32 s76, 13
    s_or_b32 s76, s76, s60
lastk_23:
    s_cmp_lg_u32 s72, s64
    s_cbranch_scc1 nokm_24
    v_min_u32 v80, -2, v80
    buffer_store_dwordx4 v[80:83], v104, s[8:11], s80 offen sc1
nokm_24:
    s_cmp_eq_u32 s68, 63
    s_cbranch_scc1 chain_end_11
    buffer_load_dwordx4 v[84:87], v38, s[8:11], s75 offen offset:0
    buffer_load_dwordx4 v[88:91], v38, s[8:11], s75 offen offset:128
    s_add_u32 s75, s75, 0x40000
    v_mov_b32 v10, -1
    v_mov_b32 v11, -1
    v_mov_b32 v12, -1
    v_mov_b32 v13, -1
    buffer_store_dwordx4 v[10:13], v35, s[8:11], s77 offen sc1
    s_cmp_lg_u32 s3, 1
    s_cbranch_scc1 noprog_25
    v_mov_b32 v2, s68
    buffer_store_dword v2, off, s[12:15], 0 offset:64 sc1
noprog_25:
    s_barrier
    s_add_u32 s68, s68, 1
    s_bfe_u32 s82, s68, 0x10001
    s_xor_b32 s73, s73, 0x80000
    s_setprio 3
    s_branch qk_c_14
c_s_15:
    buffer_load_dwordx4 v[56:59], v37, s[8:11], s76 offen offset:0 sc1
    buffer_load_dwordx4 v[60:63], v37, s[8:11], s76 offen offset:1024 sc1
    buffer_load_dwordx4 v[64:67], v37, s[8:11], s76 offen offset:2048 sc1
    buffer_load_dwordx4 v[68:71], v37, s[8:11], s76 offen offset:3072 sc1
    s_sub_u32 s69, s69, 1
    s_cbranch_scc0 c_w_16
    s_mov_b32 s69, 0
    s_branch c_j_17
kv0_18:
    s_bitset0_b32 s75, 30
    buffer_load_dwordx4 v[84:87], v38, s[8:11], s75 offen offset:0
    buffer_load_dwordx4 v[88:91], v38, s[8:11], s75 offen offset:128
    s_add_u32 s75, s75, 0x40000
    s_cmp_lt_u32 s68, 1
    s_cbranch_scc0 kv0j_19
    s_add_u32 s75, s75, 0x3ffc0000
    s_branch kv0j_19
x_s_20:
    buffer_load_dwordx4 v[56:59], v106, s[8:11], s73 offen sc1
    buffer_load_dwordx4 v[60:63], v105, s[8:11], s73 offen sc1
    buffer_load_dwordx4 v[64:67], v105, s[8:11], s73 offen offset:256 sc1
    s_sub_u32 s69, s69, 1
    s_cbranch_scc0 x_w_21
    s_mov_b32 s69, 0
    s_branch x_j_22
vo_main_10:
    s_setprio 1
    v_mov_b32 v88, 0x3f803f80
    v_mov_b32 v92, 0x3e803e80
    v_mov_b32 v89, 0x3f803f80
    v_mov_b32 v93, 0x3e803e80
    v_mov_b32 v90, 0x3f803f80
    v_mov_b32 v94, 0x3e803e80
    v_mov_b32 v91, 0x3f803f80
    v_mov_b32 v95, 0x3e803e80
    v_and_b32 v2, 1, v1
    v_lshlrev_b32 v2, 4, v2
    v_mov_b32 v3, 0x3f80
    v_lshlrev_b32 v2, v2, v3
    v_lshrrev_b32 v3, 1, v6
    v_cmp_eq_u32 vcc, 0, v3
    s_nop 1
    v_cndmask_b32 v26, 0, v2, vcc
    v_cmp_eq_u32 vcc, 1, v3
    s_nop 1
    v_cndmask_b32 v27, 0, v2, vcc
    v_cmp_eq_u32 vcc, 2, v3
    s_nop 1
    v_cndmask_b32 v28, 0, v2, vcc
    v_cmp_eq_u32 vcc, 3, v3
    s_nop 1
    v_cndmask_b32 v29, 0, v2, vcc
    v_bfe_u32 v119, v1, 0, 3
    v_lshlrev_b32 v119, 3, v119
    v_bfe_u32 v3, v1, 3, 1
    v_lshl_or_b32 v119, v3, 7, v119
    v_bfe_u32 v3, v1, 5, 1
    v_lshl_or_b32 v119, v3, 6, v119
    v_bfe_u32 v3, v1, 4, 1
    v_lshl_or_b32 v119, v3, 8, v119
    v_bfe_u32 v3, v1, 1, 3
    v_bfe_u32 v4, v1, 4, 1
    v_lshlrev_b32 v4, 1, v4
    v_xor_b32 v3, v3, v4
    v_cmp_eq_u32 vcc, 0, v3
    s_nop 1
    v_cndmask_b32 v100, 0, v2, vcc
    v_cndmask_b32 v102, 0, v2, vcc
    v_cmp_eq_u32 vcc, 1, v3
    s_nop 1
    v_cndmask_b32 v101, 0, v2, vcc
    v_cndmask_b32 v103, 0, v2, vcc
    v_cmp_eq_u32 vcc, 4, v3
    s_nop 1
    v_cndmask_b32 v104, 0, v2, vcc
    v_cndmask_b32 v106, 0, v2, vcc
    v_cmp_eq_u32 vcc, 5, v3
    s_nop 1
    v_cndmask_b32 v105, 0, v2, vcc
    v_cndmask_b32 v107, 0, v2, vcc
    s_add_u32 s80, s80, 0x4400000
    s_mov_b32 s81, 0x3e0293ee
    v_lshlrev_b32 v116, 2, v1
    v_bfe_u32 v118, v1, 0, 1
    v_lshlrev_b32 v118, 4, v118
    v_bfe_u32 v2, v1, 2, 2
    v_lshl_or_b32 v118, v2, 5, v118
    v_bfe_u32 v2, v1, 1, 1
    v_lshl_or_b32 v118, v2, 7, v118
    v_bfe_u32 v2, v1, 4, 2
    v_lshl_or_b32 v118, v2, 8, v118
    v_bfe_u32 v2, v1, 1, 1
    v_lshl_or_b32 v118, v2, 10, v118
    v_bfe_u32 v120, v1, 4, 2
    v_lshlrev_b32 v120, 3, v120
    s_add_u32 s75, s75, 0x1000000
    s_bfe_u32 s70, s67, 0x10000
    s_lshl_b32 s70, s70, 7
    s_bfe_u32 s71, s67, 0x20000
    s_lshl_b32 s71, s71, 10
    s_or_b32 s70, s70, s71
    v_xor_b32 v117, s70, v8
    s_cmp_eq_u32 s58, 4
    s_cselect_b32 s2, 0, 99
    s_mov_b32 s3, 0
    v_mov_b32 v40, 0
    v_mov_b32 v41, 0
    v_mov_b32 v42, 0
    v_mov_b32 v43, 0
    v_mov_b32 v44, 0
    v_mov_b32 v45, 0
    v_mov_b32 v46, 0
    v_mov_b32 v47, 0
    v_mov_b32 v48, 0
    v_mov_b32 v49, 0
    v_mov_b32 v50, 0
    v_mov_b32 v51, 0
    v_mov_b32 v52, 0
    v_mov_b32 v53, 0
    v_mov_b32 v54, 0
    v_mov_b32 v55, 0
    v_mov_b32 v56, 0
    v_mov_b32 v57, 0
    v_mov_b32 v58, 0
    v_mov_b32 v59, 0
    v_mov_b32 v60, 0
    v_mov_b32 v61, 0
    v_mov_b32 v62, 0
    v_mov_b32 v63, 0
    s_waitcnt vmcnt(8)
    s_barrier
    s_lshl_b32 s4, s66, 7
    s_add_u32 s4, s4, 0x5110000
    s_cmp_lg_u32 s58, 4
    s_cbranch_scc1 armi_28
    buffer_load_dwordx2 v[124:125], off, s[12:15], 0 offset:32 sc1
    buffer_load_dwordx2 v[122:123], off, s[8:11], s4 sc1
armi_28:
    s_waitcnt vmcnt(0)
    v_mov_b32 v4, 0x27ff0
    s_cmp_lg_u32 s58, 4
    s_cbranch_scc1 armw_29
    s_waitcnt vmcnt(0)
    v_and_b32 v5, 0x3ff, v124
    v_cmp_gt_u32 vcc, 128, v5
    s_cbranch_vccz armwait_ok_31
armwait_30:
    buffer_load_dwordx2 v[124:125], off, s[12:15], 0 offset:32 sc1
    buffer_load_dwordx2 v[122:123], off, s[8:11], s4 sc1
    s_waitcnt vmcnt(0)
    v_and_b32 v5, 0x3ff, v124
    v_cmp_gt_u32 vcc, 128, v5
    s_cbranch_vccz armwait_ok_31
    s_sub_u32 s69, s69, 1
    s_cbranch_scc0 armwait_30
    s_mov_b32 s69, 0
armwait_ok_31:
    ds_write_b64 v4, v[124:125]
    s_waitcnt lgkmcnt(0)
armw_29:
    s_barrier
    ds_read_b64 v[2:3], v4
    s_mov_b32 s59, 0
    s_waitcnt lgkmcnt(0)
    v_readfirstlane_b32 s70, v2
    v_readfirstlane_b32 s71, v3
    s_bfe_u32 s72, s70, 0xa000a
    s_cmp_gt_u32 s72, 128
    s_cselect_b32 s72, 1, 0
    s_or_b32 s59, s59, s72
    s_bfe_u32 s72, s70, 0xa0014
    s_cmp_gt_u32 s72, 128
    s_cselect_b32 s72, 2, 0
    s_or_b32 s59, s59, s72
    s_bfe_u32 s72, s71, 0xa000a
    s_cmp_gt_u32 s72, 128
    s_cselect_b32 s72, 4, 0
    s_or_b32 s59, s59, s72
    s_bfe_u32 s72, s71, 0xa0014
    s_cmp_gt_u32 s72, 128
    s_cselect_b32 s72, 8, 0
    s_or_b32 s59, s59, s72
    s_and_b32 s70, s59, 1
    s_lshl_b32 s70, s70, 13
    s_add_u32 s77, s77, s70
    s_add_u32 s76, s76, s70
    s_branch vo_loop_26
.p2align 6
vo_loop_26:
    s_barrier
    ds_read_b128 v[10:13], v8 offset:0
    ds_read_b128 v[14:17], v8 offset:1024
    ds_read_b128 v[18:21], v8 offset:2048
    ds_read_b128 v[22:25], v8 offset:3072
    s_cmp_ge_i32 s3, s2
    s_cbranch_scc1 kvg_32
kvj_34:
    s_add_u32 s3, s3, 1
    s_barrier
    s_cmp_le_u32 s68, 1
    s_cbranch_scc1 kv0_35
kv0j_36:
    s_waitcnt lgkmcnt(3)
    v_smfmac_f32_16x16x64_bf16 v[40:43], v[10:13], v[128:135], v7
    v_smfmac_f32_16x16x64_bf16 v[44:47], v[10:13], v[160:167], v7
    s_waitcnt lgkmcnt(2)
    v_smfmac_f32_16x16x64_bf16 v[40:43], v[14:17], v[136:143], v7
    v_smfmac_f32_16x16x64_bf16 v[44:47], v[14:17], v[168:175], v7
    s_waitcnt lgkmcnt(1)
    v_smfmac_f32_16x16x64_bf16 v[40:43], v[18:21], v[144:151], v7
    v_smfmac_f32_16x16x64_bf16 v[44:47], v[18:21], v[176:183], v7
    s_waitcnt lgkmcnt(0)
    v_smfmac_f32_16x16x64_bf16 v[40:43], v[22:25], v[152:159], v7
    v_smfmac_f32_16x16x64_bf16 v[44:47], v[22:25], v[184:191], v7
    s_nop 6
    v_pk_add_f32 v[40:41], v[40:41], v[42:43]
    v_cvt_pk_bf16_f32 v80, v40, v41
    v_pk_add_f32 v[44:45], v[44:45], v[46:47]
    v_cvt_pk_bf16_f32 v81, v44, v45
    s_nop 1
    v_permlane16_swap_b32 v80, v81
    v_bfi_b32 v80, 1, s82, v80
    buffer_store_dwordx2 v[80:81], v34, s[8:11], s73 offen
    s_and_b32 s70, s68, 1
    s_lshl_b32 s70, s70, 19
    s_add_u32 s71, s70, s79
    s_add_u32 s70, s70, s78
    s_cmp_eq_u32 s68, 63
    s_cbranch_scc1 vo_last_27
    s_cmp_eq_u32 s68, 0
    s_cbranch_scc1 wo0_37
wo0j_38:
    s_waitcnt vmcnt(1)
    s_cmp_ge_i32 s3, s2
    s_cbranch_scc1 kvg_39
kvj_41:
    s_barrier
    ds_read_b128 v[10:13], v8 offset:4096
    ds_read_b128 v[14:17], v8 offset:5120
    ds_read2st64_b32 v[30:31], v116 offset0:32 offset1:33
    ds_read_b128 v[18:21], v8 offset:6144
    ds_read_b128 v[22:25], v8 offset:7168
    ds_read2st64_b32 v[32:33], v116 offset0:34 offset1:35
    buffer_load_dwordx4 v[64:67], v8, s[8:11], s73 offen offset:0 sc1
    buffer_load_dwordx4 v[68:71], v8, s[8:11], s73 offen offset:1024 sc1
    s_waitcnt lgkmcnt(4)
    v_pk_add_f32 v[10:11], v[10:11], v[14:15]
    v_pk_add_f32 v[12:13], v[12:13], v[16:17]
    s_waitcnt lgkmcnt(2)
    v_pk_add_f32 v[10:11], v[10:11], v[18:19]
    v_pk_add_f32 v[12:13], v[12:13], v[20:21]
    s_waitcnt lgkmcnt(0)
    v_pk_add_f32 v[30:31], v[30:31], v[32:33]
    v_pk_add_f32 v[10:11], v[10:11], v[22:23]
    v_pk_add_f32 v[12:13], v[12:13], v[24:25]
    v_add_f32 v14, v30, v31
    v_max3_f32 v2, v10, v11, v12
    v_max3_f32 v3, v2, v13, v14
    v_max3_f32 v2, v2, v13, v14
    s_nop 1
    v_permlane32_swap_b32 v2, v3
    v_max_f32 v4, v2, v3
    v_max_f32 v3, v2, v3
    s_nop 1
    v_permlane16_swap_b32 v4, v3
    v_max_f32 v2, v4, v3
    v_mul_f32 v2, s81, v2
    s_nop 1
    v_max_f32_dpp v2, v2, v2 row_ror:8 row_mask:0xf bank_mask:0xf
    v_fma_f32 v10, v10, s81, -v2
    v_fma_f32 v11, v11, s81, -v2
    v_fma_f32 v12, v12, s81, -v2
    v_fma_f32 v13, v13, s81, -v2
    v_fma_f32 v14, v14, s81, -v2
    v_exp_f32 v10, v10
    v_exp_f32 v11, v11
    v_exp_f32 v12, v12
    v_exp_f32 v13, v13
    v_exp_f32 v15, v14
    v_cvt_pk_bf16_f32 v80, v10, v11
    v_cvt_pk_bf16_f32 v81, v12, v13
    v_mov_b32 v14, v15
    v_mov_b32_dpp v82, v80 row_ror:8 row_mask:0xf bank_mask:0xf
    v_mov_b32_dpp v83, v81 row_ror:8 row_mask:0xf bank_mask:0xf
    v_permlane32_swap_b32 v14, v15
    v_cvt_pk_bf16_f32 v84, v14, v15
    v_mfma_f32_16x16x32_bf16 v[108:111], v[72:75], v[80:83], 0
    v_mov_b32 v86, v84
    v_mov_b32_dpp v85, v84 row_ror:8 row_mask:0xf bank_mask:0xf
    v_mov_b32_dpp v87, v84 row_ror:8 row_mask:0xf bank_mask:0xf
    v_mfma_f32_16x16x32_bf16 v[112:115], v[76:79], v[80:83], 0
xv_w_43:
    s_waitcnt vmcnt(0)
    v_mfma_f32_16x16x32_bf16 v[18:21], v[64:67], v[84:87], v[108:111]
    v_bitop3_b32 v2, v64, v66, s82 bitop3:0x7e
    v_bitop3_b32 v3, v68, v70, s82 bitop3:0x7e
    v_mfma_f32_16x16x32_bf16 v[22:25], v[68:71], v[84:87], v[112:115]
    v_bitop3_b32 v2, v2, v3, 1 bitop3:0xa8
    v_cmp_ne_u32 vcc, 0, v2
    s_cbranch_vccnz xv_s_42
xv_j_44:
    v_mfma_f32_16x16x32_bf16 v[96:99], v[88:91], v[80:83], 0
    s_nop 0
    v_cvt_pk_bf16_f32 v108, v18, v19
    v_cvt_pk_bf16_f32 v109, v20, v21
    s_nop 0
    v_cvt_pk_bf16_f32 v110, v22, v23
    v_cvt_pk_bf16_f32 v111, v24, v25
    ds_write_b128 v117, v[108:111] offset:9216
    v_mfma_f32_16x16x32_bf16 v[96:99], v[92:95], v[84:87], v[96:99]
    s_nop 3
    s_waitcnt lgkmcnt(0)
    s_barrier
    ds_read_b128 v[10:13], v118 offset:9216
    ds_read_b128 v[14:17], v118 offset:11264
    v_rcp_f32 v98, v96
    s_nop 0
    ds_bpermute_b32 v96, v120, v98 offset:0
    ds_bpermute_b32 v97, v120, v98 offset:4
    s_waitcnt lgkmcnt(3)
    v_smfmac_f32_16x16x64_bf16 v[48:51], v[10:13], v[192:199], v7
    v_smfmac_f32_16x16x64_bf16 v[52:55], v[10:13], v[208:215], v7
    s_waitcnt lgkmcnt(2)
    v_smfmac_f32_16x16x64_bf16 v[48:51], v[14:17], v[200:207], v7
    s_nop 1
    v_smfmac_f32_16x16x64_bf16 v[52:55], v[14:17], v[216:223], v7
    s_nop 1
    v_smfmac_f32_16x16x64_bf16 v[56:59], v[10:13], v[224:231], v7
    s_waitcnt lgkmcnt(0)
    v_smfmac_f32_16x16x64_bf16 v[56:59], v[14:17], v[232:239], v7
    v_pk_add_f32 v[48:49], v[48:49], v[50:51]
    v_smfmac_f32_16x16x64_bf16 v[60:63], v[10:13], v[240:247], v7
    v_pk_mul_f32 v[48:49], v[48:49], v[96:97]
    v_cvt_pk_bf16_f32 v80, v48, v49
    v_smfmac_f32_16x16x64_bf16 v[60:63], v[14:17], v[248:255], v7
    v_pk_add_f32 v[52:53], v[52:53], v[54:55]
    v_pk_mul_f32 v[52:53], v[52:53], v[96:97]
    v_cvt_pk_bf16_f32 v81, v52, v53
    v_pk_add_f32 v[56:57], v[56:57], v[58:59]
    v_pk_mul_f32 v[56:57], v[56:57], v[96:97]
    v_cvt_pk_bf16_f32 v82, v56, v57
    v_permlane16_swap_b32 v80, v81
    v_bfi_b32 v80, 1, s82, v80
    v_pk_add_f32 v[60:61], v[60:61], v[62:63]
    v_pk_mul_f32 v[60:61], v[60:61], v[96:97]
    v_cvt_pk_bf16_f32 v83, v60, v61
    s_nop 1
    v_permlane16_swap_b32 v82, v83
    buffer_store_dwordx4 v[80:83], v36, s[8:11], s71 offen
    s_waitcnt vmcnt(0)
    buffer_load_dwordx4 v[10:13], v8, s[8:11], s70 offen sc1
b_w_46:
    s_waitcnt vmcnt(0)
    v_mfma_f32_16x16x32_bf16 v[30:33], v[26:29], v[10:13], 0
    v_bitop3_b32 v2, v10, s82, 1 bitop3:0x28
    v_cmp_ne_u32 vcc, 0, v2
    s_cbranch_vccnz b_s_45
b_j_47:
    s_nop 4
    v_add_f32_dpp v30, v30, v30 row_ror:8 row_mask:0xf bank_mask:0xf
    v_add_f32_dpp v31, v31, v31 row_ror:8 row_mask:0xf bank_mask:0xf
    v_add_f32_dpp v32, v32, v32 row_ror:8 row_mask:0xf bank_mask:0xf
    v_add_f32_dpp v33, v33, v33 row_ror:8 row_mask:0xf bank_mask:0xf
    v_cvt_pk_bf16_f32 v30, v30, v31
    v_cvt_pk_bf16_f32 v31, v32, v33
    v_min_u32 v30, -2, v30
    s_nop 0
    v_permlane16_swap_b32 v31, v33
    v_permlane16_swap_b32 v30, v32
    buffer_store_dwordx4 v[30:33], v35, s[8:11], s77 offen sc1
    s_add_u32 s68, s68, 1
    s_bfe_u32 s82, s68, 0x10001
    s_xor_b32 s73, s73, 0x40000
    s_add_u32 s77, s77, 0x20000
    s_lshr_b32 s60, s77, 21
    s_bitcmp1_b32 s59, s60
    s_cselect_b32 s60, 0x2000, 0
    s_bitset0_b32 s77, 13
    s_or_b32 s77, s77, s60
    v_mov_b32 v40, 0
    v_mov_b32 v41, 0
    v_mov_b32 v42, 0
    v_mov_b32 v43, 0
    v_mov_b32 v44, 0
    v_mov_b32 v45, 0
    v_mov_b32 v46, 0
    v_mov_b32 v47, 0
    v_mov_b32 v48, 0
    v_mov_b32 v49, 0
    v_mov_b32 v50, 0
    v_mov_b32 v51, 0
    v_mov_b32 v52, 0
    v_mov_b32 v53, 0
    v_mov_b32 v54, 0
    v_mov_b32 v55, 0
    v_mov_b32 v56, 0
    v_mov_b32 v57, 0
    v_mov_b32 v58, 0
    v_mov_b32 v59, 0
    v_mov_b32 v60, 0
    v_mov_b32 v61, 0
    v_mov_b32 v62, 0
    v_mov_b32 v63, 0
    buffer_load_dwordx4 v[72:75], v38, s[8:11], s75 offen offset:0
    buffer_load_dwordx4 v[76:79], v38, s[8:11], s75 offen offset:128
    s_add_u32 s75, s75, 0x40000
    s_waitcnt vmcnt(2)
    s_barrier
    s_and_b32 s72, s68, 3
    s_cmp_lg_u32 s72, s64
    s_cbranch_scc1 novm_48
    v_mfma_f32_16x16x32_bf16 v[108:111], v[100:103], v[64:67], 0
    v_mfma_f32_16x16x32_bf16 v[108:111], v[104:107], v[68:71], v[108:111]
    s_nop 7
    v_cvt_pk_bf16_f32 v108, v108, v109
    v_cvt_pk_bf16_f32 v109, v110, v111
    v_min_u32 v108, -2, v108
    buffer_store_dwordx2 v[108:109], v119, s[8:11], s80 offen sc1
novm_48:
    s_add_u32 s80, s80, 0x10000
    s_add_u32 s72, s3, 1
    s_cmp_lt_i32 s72, s2
    s_cbranch_scc1 vo_loop_26
    buffer_load_dwordx2 v[122:123], off, s[8:11], s4 sc1
    s_branch vo_loop_26
kvp_33:
    buffer_load_dwordx2 v[122:123], off, s[8:11], s4 sc1
    s_waitcnt vmcnt(0)
kvg_32:
    v_min_i32 v122, v122, v123
    s_nop 0
    v_readfirstlane_b32 s2, v122
    s_nop 0
    s_cmp_lt_i32 s3, s2
    s_cbranch_scc1 kvj_34
    s_sub_u32 s69, s69, 1
    s_cbranch_scc0 kvp_33
    s_mov_b32 s69, 0
    s_branch kvj_34
kv0_35:
    s_bitset0_b32 s75, 30
    buffer_load_dwordx4 v[72:75], v38, s[8:11], s75 offen offset:0
    buffer_load_dwordx4 v[76:79], v38, s[8:11], s75 offen offset:128
    s_add_u32 s75, s75, 0x40000
    s_cmp_lt_u32 s68, 1
    s_cbranch_scc0 kv0j_36
    s_add_u32 s75, s75, 0x3ffc0000
    s_branch kv0j_36
wo0_37:
    v_xor_b32 v2, 0, v127
    v_xor_b32 v3, 64, v127
    ds_read_b64_tr_b16 v[192:193], v2 offset:0
    ds_read_b64_tr_b16 v[194:195], v3 offset:1024
    ds_read_b64_tr_b16 v[196:197], v2 offset:8192
    ds_read_b64_tr_b16 v[198:199], v3 offset:9216
    ds_read_b64_tr_b16 v[200:201], v2 offset:32768
    ds_read_b64_tr_b16 v[202:203], v3 offset:33792
    ds_read_b64_tr_b16 v[204:205], v2 offset:40960
    ds_read_b64_tr_b16 v[206:207], v3 offset:41984
    ds_read_b64_tr_b16 v[224:225], v2 offset:256
    ds_read_b64_tr_b16 v[226:227], v3 offset:1280
    ds_read_b64_tr_b16 v[228:229], v2 offset:8448
    ds_read_b64_tr_b16 v[230:231], v3 offset:9472
    ds_read_b64_tr_b16 v[232:233], v2 offset:33024
    ds_read_b64_tr_b16 v[234:235], v3 offset:34048
    ds_read_b64_tr_b16 v[236:237], v2 offset:41216
    ds_read_b64_tr_b16 v[238:239], v3 offset:42240
    s_waitcnt lgkmcnt(0)
    v_xor_b32 v2, 32, v127
    v_xor_b32 v3, 96, v127
    ds_read_b64_tr_b16 v[208:209], v2 offset:0
    ds_read_b64_tr_b16 v[210:211], v3 offset:1024
    ds_read_b64_tr_b16 v[212:213], v2 offset:8192
    ds_read_b64_tr_b16 v[214:215], v3 offset:9216
    ds_read_b64_tr_b16 v[216:217], v2 offset:32768
    ds_read_b64_tr_b16 v[218:219], v3 offset:33792
    ds_read_b64_tr_b16 v[220:221], v2 offset:40960
    ds_read_b64_tr_b16 v[222:223], v3 offset:41984
    ds_read_b64_tr_b16 v[240:241], v2 offset:256
    ds_read_b64_tr_b16 v[242:243], v3 offset:1280
    ds_read_b64_tr_b16 v[244:245], v2 offset:8448
    ds_read_b64_tr_b16 v[246:247], v3 offset:9472
    ds_read_b64_tr_b16 v[248:249], v2 offset:33024
    ds_read_b64_tr_b16 v[250:251], v3 offset:34048
    ds_read_b64_tr_b16 v[252:253], v2 offset:41216
    ds_read_b64_tr_b16 v[254:255], v3 offset:42240
    s_waitcnt lgkmcnt(0)
    s_branch wo0j_38
kvp_40:
    buffer_load_dwordx2 v[122:123], off, s[8:11], s4 sc1
    s_waitcnt vmcnt(0)
kvg_39:
    s_cmp_lt_u32 s68, 1
    s_cbranch_scc1 kvj_41
    v_min_i32 v122, v122, v123
    s_nop 0
    v_readfirstlane_b32 s2, v122
    s_nop 0
    s_cmp_lt_i32 s3, s2
    s_cbranch_scc1 kvj_41
    s_sub_u32 s69, s69, 1
    s_cbranch_scc0 kvp_40
    s_mov_b32 s69, 0
    s_branch kvj_41
xv_s_42:
    buffer_load_dwordx4 v[64:67], v8, s[8:11], s73 offen offset:0 sc1
    buffer_load_dwordx4 v[68:71], v8, s[8:11], s73 offen offset:1024 sc1
    s_sub_u32 s69, s69, 1
    s_cbranch_scc0 xv_w_43
    s_mov_b32 s69, 0
    s_branch xv_j_44
b_s_45:
    buffer_load_dwordx4 v[10:13], v8, s[8:11], s70 offen sc1
    s_sub_u32 s69, s69, 1
    s_cbranch_scc0 b_w_46
    s_mov_b32 s69, 0
    s_branch b_j_47
vo_last_27:
    s_cmp_lg_u32 s64, 0
    s_cbranch_scc1 chain_end_11
pollvm_49:
    buffer_load_dwordx4 v[64:67], v8, s[8:11], s73 offen offset:0 sc1
    buffer_load_dwordx4 v[68:71], v8, s[8:11], s73 offen offset:1024 sc1
    s_waitcnt vmcnt(0)
    v_bitop3_b32 v2, v64, v66, s82 bitop3:0x7e
    v_bitop3_b32 v3, v68, v70, s82 bitop3:0x7e
    v_bitop3_b32 v2, v2, v3, 1 bitop3:0xa8
    v_cmp_ne_u32 vcc, 0, v2
    s_cbranch_vccz pollvm_ok_50
    s_sub_u32 s69, s69, 1
    s_cbranch_scc0 pollvm_49
    s_mov_b32 s69, 0
pollvm_ok_50:
    v_mfma_f32_16x16x32_bf16 v[108:111], v[100:103], v[64:67], 0
    v_mfma_f32_16x16x32_bf16 v[108:111], v[104:107], v[68:71], v[108:111]
    s_nop 7
    v_cvt_pk_bf16_f32 v108, v108, v109
    v_cvt_pk_bf16_f32 v109, v110, v111
    v_min_u32 v108, -2, v108
    buffer_store_dwordx2 v[108:109], v119, s[8:11], s80 offen sc1
chain_end_11:
    s_waitcnt vmcnt(0)
    s_endpgm
bulk_2:
    s_and_b32 s75, s56, 3
    s_lshl_b32 s76, s75, 5
    s_add_u32 s76, s76, s57
    s_mov_b32 s77, 0x40000
    s_mov_b32 s84, 1
    s_cmp_ge_u32 s57, 24
    s_cbranch_scc1 fft_54
    s_mov_b32 s83, 160
    s_mov_b32 s6, 0x4444557e
    s_mov_b32 s7, 0x44444444
    s_mov_b64 s[60:61], s[36:37]
    s_mov_b32 s62, 0x400000
    s_mov_b32 s63, 0x20000
    s_bitcmp1_b32 s57, 3
    s_cbranch_scc1 sv_55
    s_mov_b64 s[64:65], s[24:25]
    s_mov_b32 s66, 0x800000
    s_mov_b32 s67, 0x20000
    s_mov_b32 s81, 0x1000000
    s_cmp_lt_u32 s57, 8
    s_cbranch_scc1 sf_56
    s_mov_b64 s[64:65], s[20:21]
    s_mov_b32 s66, 0x800000
    s_mov_b32 s67, 0x20000
    s_mov_b32 s81, 0x0
    s_mov_b32 s84, 0x10000
    v_bfe_u32 v120, v1, 0, 1
    v_lshlrev_b32 v120, 7, v120
    v_bfe_u32 v121, v1, 1, 5
    v_lshl_or_b32 v120, v121, 13, v120
    s_bfe_u32 s79, s58, 0x20000
    s_lshl_b32 s79, s79, 19
    s_bfe_u32 s85, s58, 0x10002
    s_lshl_b32 s85, s85, 22
    s_or_b32 s79, s79, s85
    s_bfe_u32 s80, s76, 0x30000
    s_lshl_b32 s80, s80, 8
    s_bfe_u32 s85, s76, 0x20005
    s_lshl_b32 s85, s85, 11
    s_or_b32 s80, s80, s85
    s_bfe_u32 s85, s76, 0x10000
    s_lshl_b32 s85, s85, 21
    s_or_b32 s80, s80, s85
    s_add_u32 s79, s79, s80
    s_xor_b32 s85, s79, 0x200000
    buffer_load_dword v122, v120, s[24:27], s85 offen
    s_xor_b32 s85, s79, 0x200000
    buffer_load_dword v123, v120, s[28:31], s85 offen
    s_add_u32 s79, s76, 8
    s_lshl_b32 s85, s79, 3
    s_add_u32 s85, s85, s58
    v_lshlrev_b32 v4, 2, v1
    v_mul_u32_u24 v4, s85, v4
    v_mov_b32 v8, 253
    v_and_b32 v5, 0x3ff, v4
    v_cvt_f32_u32 v5, v5
    v_mul_f32 v5, 0x3a800000, v5
    v_cos_f32 v6, v5
    v_sin_f32 v7, -v5
    v_add_u32 v4, s85, v4
    v_cvt_pk_bf16_f32 v10, v6, v7
    v_and_b32 v5, 0x3ff, v4
    v_cvt_f32_u32 v5, v5
    v_mul_f32 v5, 0x3a800000, v5
    v_cos_f32 v6, v5
    v_sin_f32 v7, -v5
    v_add_u32 v4, s85, v4
    v_cvt_pk_bf16_f32 v11, v6, v7
    v_and_b32 v5, 0x3ff, v4
    v_cvt_f32_u32 v5, v5
    v_mul_f32 v5, 0x3a800000, v5
    v_cos_f32 v6, v5
    v_sin_f32 v7, -v5
    v_add_u32 v4, s85, v4
    v_cvt_pk_bf16_f32 v12, v6, v7
    v_and_b32 v5, 0x3ff, v4
    v_cvt_f32_u32 v5, v5
    v_mul_f32 v5, 0x3a800000, v5
    v_cos_f32 v6, v5
    v_sin_f32 v7, -v5
    v_mad_u32_u24 v4, s85, v8, v4
    v_cvt_pk_bf16_f32 v13, v6, v7
    v_and_b32 v5, 0x3ff, v4
    v_cvt_f32_u32 v5, v5
    v_mul_f32 v5, 0x3a800000, v5
    v_cos_f32 v6, v5
    v_sin_f32 v7, -v5
    v_add_u32 v4, s85, v4
    v_cvt_pk_bf16_f32 v14, v6, v7
    v_and_b32 v5, 0x3ff, v4
    v_cvt_f32_u32 v5, v5
    v_mul_f32 v5, 0x3a800000, v5
    v_cos_f32 v6, v5
    v_sin_f32 v7, -v5
    v_add_u32 v4, s85, v4
    v_cvt_pk_bf16_f32 v15, v6, v7
    v_and_b32 v5, 0x3ff, v4
    v_cvt_f32_u32 v5, v5
    v_mul_f32 v5, 0x3a800000, v5
    v_cos_f32 v6, v5
    v_sin_f32 v7, -v5
    v_add_u32 v4, s85, v4
    v_cvt_pk_bf16_f32 v16, v6, v7
    v_and_b32 v5, 0x3ff, v4
    v_cvt_f32_u32 v5, v5
    v_mul_f32 v5, 0x3a800000, v5
    v_cos_f32 v6, v5
    v_sin_f32 v7, -v5
    v_add_u32 v4, s85, v4
    v_cvt_pk_bf16_f32 v17, v6, v7
    v_mov_b32 v5, s85
    v_lshlrev_b32 v5, 31, v5
    v_or_b32 v5, 0x3f803f80, v5
    v_cmp_eq_u32 vcc, 0, v1
    s_nop 1
    v_cndmask_b32 v10, v10, v5, vcc
    v_lshlrev_b32 v8, 4, v1
    s_lshl_b32 s85, s85, 11
    s_add_u32 s85, s85, 0x5200000
    buffer_store_dwordx4 v[10:13], v8, s[8:11], s85 offen sc1
    buffer_store_dwordx4 v[14:17], v8, s[8:11], s85 offen offset:1024 sc1
    s_sub_u32 s79, s79, 8
    s_lshl_b32 s85, s79, 3
    s_add_u32 s85, s85, s58
    v_lshlrev_b32 v20, 2, v1
    v_mul_u32_u24 v20, s85, v20
    v_mov_b32 v24, 253
    v_and_b32 v21, 0x3ff, v20
    v_cvt_f32_u32 v21, v21
    v_mul_f32 v21, 0x3a800000, v21
    v_cos_f32 v22, v21
    v_sin_f32 v23, -v21
    v_add_u32 v20, s85, v20
    v_cvt_pk_bf16_f32 v26, v22, v23
    v_and_b32 v21, 0x3ff, v20
    v_cvt_f32_u32 v21, v21
    v_mul_f32 v21, 0x3a800000, v21
    v_cos_f32 v22, v21
    v_sin_f32 v23, -v21
    v_add_u32 v20, s85, v20
    v_cvt_pk_bf16_f32 v27, v22, v23
    v_and_b32 v21, 0x3ff, v20
    v_cvt_f32_u32 v21, v21
    v_mul_f32 v21, 0x3a800000, v21
    v_cos_f32 v22, v21
    v_sin_f32 v23, -v21
    v_add_u32 v20, s85, v20
    v_cvt_pk_bf16_f32 v28, v22, v23
    v_and_b32 v21, 0x3ff, v20
    v_cvt_f32_u32 v21, v21
    v_mul_f32 v21, 0x3a800000, v21
    v_cos_f32 v22, v21
    v_sin_f32 v23, -v21
    v_mad_u32_u24 v20, s85, v24, v20
    v_cvt_pk_bf16_f32 v29, v22, v23
    v_and_b32 v21, 0x3ff, v20
    v_cvt_f32_u32 v21, v21
    v_mul_f32 v21, 0x3a800000, v21
    v_cos_f32 v22, v21
    v_sin_f32 v23, -v21
    v_add_u32 v20, s85, v20
    v_cvt_pk_bf16_f32 v30, v22, v23
    v_and_b32 v21, 0x3ff, v20
    v_cvt_f32_u32 v21, v21
    v_mul_f32 v21, 0x3a800000, v21
    v_cos_f32 v22, v21
    v_sin_f32 v23, -v21
    v_add_u32 v20, s85, v20
    v_cvt_pk_bf16_f32 v31, v22, v23
    v_and_b32 v21, 0x3ff, v20
    v_cvt_f32_u32 v21, v21
    v_mul_f32 v21, 0x3a800000, v21
    v_cos_f32 v22, v21
    v_sin_f32 v23, -v21
    v_add_u32 v20, s85, v20
    v_cvt_pk_bf16_f32 v32, v22, v23
    v_and_b32 v21, 0x3ff, v20
    v_cvt_f32_u32 v21, v21
    v_mul_f32 v21, 0x3a800000, v21
    v_cos_f32 v22, v21
    v_sin_f32 v23, -v21
    v_add_u32 v20, s85, v20
    v_cvt_pk_bf16_f32 v33, v22, v23
    v_mov_b32 v21, s85
    v_lshlrev_b32 v21, 31, v21
    v_or_b32 v21, 0x3f803f80, v21
    v_cmp_eq_u32 vcc, 0, v1
    s_nop 1
    v_cndmask_b32 v26, v26, v21, vcc
    v_lshlrev_b32 v24, 4, v1
    s_lshl_b32 s85, s85, 11
    s_add_u32 s85, s85, 0x5200000
    buffer_store_dwordx4 v[26:29], v24, s[8:11], s85 offen sc1
    buffer_store_dwordx4 v[30:33], v24, s[8:11], s85 offen offset:1024 sc1
    s_sub_u32 s79, s79, 8
    s_lshl_b32 s85, s79, 3
    s_add_u32 s85, s85, s58
    v_lshlrev_b32 v36, 2, v1
    v_mul_u32_u24 v36, s85, v36
    v_mov_b32 v40, 253
    v_and_b32 v37, 0x3ff, v36
    v_cvt_f32_u32 v37, v37
    v_mul_f32 v37, 0x3a800000, v37
    v_cos_f32 v38, v37
    v_sin_f32 v39, -v37
    v_add_u32 v36, s85, v36
    v_cvt_pk_bf16_f32 v42, v38, v39
    v_and_b32 v37, 0x3ff, v36
    v_cvt_f32_u32 v37, v37
    v_mul_f32 v37, 0x3a800000, v37
    v_cos_f32 v38, v37
    v_sin_f32 v39, -v37
    v_add_u32 v36, s85, v36
    v_cvt_pk_bf16_f32 v43, v38, v39
    v_and_b32 v37, 0x3ff, v36
    v_cvt_f32_u32 v37, v37
    v_mul_f32 v37, 0x3a800000, v37
    v_cos_f32 v38, v37
    v_sin_f32 v39, -v37
    v_add_u32 v36, s85, v36
    v_cvt_pk_bf16_f32 v44, v38, v39
    v_and_b32 v37, 0x3ff, v36
    v_cvt_f32_u32 v37, v37
    v_mul_f32 v37, 0x3a800000, v37
    v_cos_f32 v38, v37
    v_sin_f32 v39, -v37
    v_mad_u32_u24 v36, s85, v40, v36
    v_cvt_pk_bf16_f32 v45, v38, v39
    v_and_b32 v37, 0x3ff, v36
    v_cvt_f32_u32 v37, v37
    v_mul_f32 v37, 0x3a800000, v37
    v_cos_f32 v38, v37
    v_sin_f32 v39, -v37
    v_add_u32 v36, s85, v36
    v_cvt_pk_bf16_f32 v46, v38, v39
    v_and_b32 v37, 0x3ff, v36
    v_cvt_f32_u32 v37, v37
    v_mul_f32 v37, 0x3a800000, v37
    v_cos_f32 v38, v37
    v_sin_f32 v39, -v37
    v_add_u32 v36, s85, v36
    v_cvt_pk_bf16_f32 v47, v38, v39
    v_and_b32 v37, 0x3ff, v36
    v_cvt_f32_u32 v37, v37
    v_mul_f32 v37, 0x3a800000, v37
    v_cos_f32 v38, v37
    v_sin_f32 v39, -v37
    v_add_u32 v36, s85, v36
    v_cvt_pk_bf16_f32 v48, v38, v39
    v_and_b32 v37, 0x3ff, v36
    v_cvt_f32_u32 v37, v37
    v_mul_f32 v37, 0x3a800000, v37
    v_cos_f32 v38, v37
    v_sin_f32 v39, -v37
    v_add_u32 v36, s85, v36
    v_cvt_pk_bf16_f32 v49, v38, v39
    v_mov_b32 v37, s85
    v_lshlrev_b32 v37, 31, v37
    v_or_b32 v37, 0x3f803f80, v37
    v_cmp_eq_u32 vcc, 0, v1
    s_nop 1
    v_cndmask_b32 v42, v42, v37, vcc
    v_lshlrev_b32 v40, 4, v1
    s_lshl_b32 s85, s85, 11
    s_add_u32 s85, s85, 0x5200000
    buffer_store_dwordx4 v[42:45], v40, s[8:11], s85 offen sc1
    buffer_store_dwordx4 v[46:49], v40, s[8:11], s85 offen offset:1024 sc1
    s_sub_u32 s79, s79, 8
    s_lshl_b32 s85, s79, 3
    s_add_u32 s85, s85, s58
    v_lshlrev_b32 v52, 2, v1
    v_mul_u32_u24 v52, s85, v52
    v_mov_b32 v56, 253
    v_and_b32 v53, 0x3ff, v52
    v_cvt_f32_u32 v53, v53
    v_mul_f32 v53, 0x3a800000, v53
    v_cos_f32 v54, v53
    v_sin_f32 v55, -v53
    v_add_u32 v52, s85, v52
    v_cvt_pk_bf16_f32 v58, v54, v55
    v_and_b32 v53, 0x3ff, v52
    v_cvt_f32_u32 v53, v53
    v_mul_f32 v53, 0x3a800000, v53
    v_cos_f32 v54, v53
    v_sin_f32 v55, -v53
    v_add_u32 v52, s85, v52
    v_cvt_pk_bf16_f32 v59, v54, v55
    v_and_b32 v53, 0x3ff, v52
    v_cvt_f32_u32 v53, v53
    v_mul_f32 v53, 0x3a800000, v53
    v_cos_f32 v54, v53
    v_sin_f32 v55, -v53
    v_add_u32 v52, s85, v52
    v_cvt_pk_bf16_f32 v60, v54, v55
    v_and_b32 v53, 0x3ff, v52
    v_cvt_f32_u32 v53, v53
    v_mul_f32 v53, 0x3a800000, v53
    v_cos_f32 v54, v53
    v_sin_f32 v55, -v53
    v_mad_u32_u24 v52, s85, v56, v52
    v_cvt_pk_bf16_f32 v61, v54, v55
    v_and_b32 v53, 0x3ff, v52
    v_cvt_f32_u32 v53, v53
    v_mul_f32 v53, 0x3a800000, v53
    v_cos_f32 v54, v53
    v_sin_f32 v55, -v53
    v_add_u32 v52, s85, v52
    v_cvt_pk_bf16_f32 v62, v54, v55
    v_and_b32 v53, 0x3ff, v52
    v_cvt_f32_u32 v53, v53
    v_mul_f32 v53, 0x3a800000, v53
    v_cos_f32 v54, v53
    v_sin_f32 v55, -v53
    v_add_u32 v52, s85, v52
    v_cvt_pk_bf16_f32 v63, v54, v55
    v_and_b32 v53, 0x3ff, v52
    v_cvt_f32_u32 v53, v53
    v_mul_f32 v53, 0x3a800000, v53
    v_cos_f32 v54, v53
    v_sin_f32 v55, -v53
    v_add_u32 v52, s85, v52
    v_cvt_pk_bf16_f32 v64, v54, v55
    v_and_b32 v53, 0x3ff, v52
    v_cvt_f32_u32 v53, v53
    v_mul_f32 v53, 0x3a800000, v53
    v_cos_f32 v54, v53
    v_sin_f32 v55, -v53
    v_add_u32 v52, s85, v52
    v_cvt_pk_bf16_f32 v65, v54, v55
    v_mov_b32 v53, s85
    v_lshlrev_b32 v53, 31, v53
    v_or_b32 v53, 0x3f803f80, v53
    v_cmp_eq_u32 vcc, 0, v1
    s_nop 1
    v_cndmask_b32 v58, v58, v53, vcc
    v_lshlrev_b32 v56, 4, v1
    s_lshl_b32 s85, s85, 11
    s_add_u32 s85, s85, 0x5200000
    buffer_store_dwordx4 v[58:61], v56, s[8:11], s85 offen sc1
    buffer_store_dwordx4 v[62:65], v56, s[8:11], s85 offen offset:1024 sc1
    s_sub_u32 s79, s79, 8
    s_waitcnt vmcnt(0)
sf_56:
    v_bfe_u32 v4, v1, 4, 2
    v_lshlrev_b32 v4, 2, v4
    v_xor_b32 v4, v4, v1
    v_bfe_u32 v84, v4, 0, 1
    v_lshlrev_b32 v84, 5, v84
    v_bfe_u32 v5, v4, 1, 1
    v_lshl_or_b32 v84, v5, 4, v84
    v_bfe_u32 v5, v4, 2, 2
    v_lshl_or_b32 v84, v5, 6, v84
    v_bfe_u32 v5, v4, 4, 2
    v_lshl_or_b32 v84, v5, 13, v84
    v_xor_b32 v85, 16, v84
    s_bfe_u32 s68, s58, 0x20000
    s_lshl_b32 s68, s68, 19
    s_bfe_u32 s71, s58, 0x10002
    s_lshl_b32 s71, s71, 22
    s_or_b32 s68, s68, s71
    s_bfe_u32 s71, s57, 0x30000
    s_lshl_b32 s71, s71, 8
    s_bfe_u32 s72, s57, 0x10000
    s_lshl_b32 s72, s72, 21
    s_or_b32 s71, s71, s72
    s_add_u32 s68, s68, s71
    s_lshl_b32 s71, s75, 11
    s_add_u32 s68, s68, s71
    s_xor_b32 s69, s68, 0x200000
    s_lshl_b32 s70, s58, 14
    s_add_u32 m0, s70, 0
    s_nop 0
    buffer_load_dwordx4 v84, s[64:67], s68 offen lds
    s_add_u32 s68, s68, 0x8000
    s_add_u32 m0, s70, 1024
    s_nop 0
    buffer_load_dwordx4 v84, s[64:67], s68 offen lds
    s_add_u32 s68, s68, 0x8000
    s_add_u32 m0, s70, 2048
    s_nop 0
    buffer_load_dwordx4 v85, s[64:67], s68 offen lds
    s_add_u32 s68, s68, 0x8000
    s_add_u32 m0, s70, 3072
    s_nop 0
    buffer_load_dwordx4 v85, s[64:67], s68 offen lds
    s_add_u32 s68, s68, 0x8000
    s_add_u32 m0, s70, 4096
    s_nop 0
    buffer_load_dwordx4 v84, s[64:67], s68 offen lds
    s_add_u32 s68, s68, 0x8000
    s_add_u32 m0, s70, 5120
    s_nop 0
    buffer_load_dwordx4 v84, s[64:67], s68 offen lds
    s_add_u32 s68, s68, 0x8000
    s_add_u32 m0, s70, 6144
    s_nop 0
    buffer_load_dwordx4 v85, s[64:67], s68 offen lds
    s_add_u32 s68, s68, 0x8000
    s_add_u32 m0, s70, 7168
    s_nop 0
    buffer_load_dwordx4 v85, s[64:67], s68 offen lds
    s_add_u32 s68, s68, 0x8000
    s_add_u32 m0, s70, 8192
    s_nop 0
    buffer_load_dwordx4 v84, s[64:67], s68 offen lds
    s_add_u32 s68, s68, 0x8000
    s_add_u32 m0, s70, 9216
    s_nop 0
    buffer_load_dwordx4 v84, s[64:67], s68 offen lds
    s_add_u32 s68, s68, 0x8000
    s_add_u32 m0, s70, 10240
    s_nop 0
    buffer_load_dwordx4 v85, s[64:67], s68 offen lds
    s_add_u32 s68, s68, 0x8000
    s_add_u32 m0, s70, 11264
    s_nop 0
    buffer_load_dwordx4 v85, s[64:67], s68 offen lds
    s_add_u32 s68, s68, 0x8000
    s_add_u32 m0, s70, 12288
    s_nop 0
    buffer_load_dwordx4 v84, s[64:67], s68 offen lds
    s_add_u32 s68, s68, 0x8000
    s_add_u32 m0, s70, 13312
    s_nop 0
    buffer_load_dwordx4 v84, s[64:67], s68 offen lds
    s_add_u32 s68, s68, 0x8000
    s_add_u32 m0, s70, 14336
    s_nop 0
    buffer_load_dwordx4 v85, s[64:67], s68 offen lds
    s_add_u32 s68, s68, 0x8000
    s_add_u32 m0, s70, 15360
    s_nop 0
    buffer_load_dwordx4 v85, s[64:67], s68 offen lds
    s_add_u32 s68, s68, 0x8000
    s_cmp_lt_u32 s57, 16
    s_cbranch_scc1 sq_66
    s_waitcnt vmcnt(0)
sq_66:
    buffer_load_dwordx4 v[192:195], v84, s[64:67], s69 offen
    s_add_u32 s69, s69, 0x8000
    buffer_load_dwordx4 v[196:199], v84, s[64:67], s69 offen
    s_add_u32 s69, s69, 0x8000
    buffer_load_dwordx4 v[200:203], v85, s[64:67], s69 offen
    s_add_u32 s69, s69, 0x8000
    buffer_load_dwordx4 v[204:207], v85, s[64:67], s69 offen
    s_add_u32 s69, s69, 0x8000
    buffer_load_dwordx4 v[208:211], v84, s[64:67], s69 offen
    s_add_u32 s69, s69, 0x8000
    buffer_load_dwordx4 v[212:215], v84, s[64:67], s69 offen
    s_add_u32 s69, s69, 0x8000
    buffer_load_dwordx4 v[216:219], v85, s[64:67], s69 offen
    s_add_u32 s69, s69, 0x8000
    buffer_load_dwordx4 v[220:223], v85, s[64:67], s69 offen
    s_add_u32 s69, s69, 0x8000
    buffer_load_dwordx4 v[224:227], v84, s[64:67], s69 offen
    s_add_u32 s69, s69, 0x8000
    buffer_load_dwordx4 v[228:231], v84, s[64:67], s69 offen
    s_add_u32 s69, s69, 0x8000
    buffer_load_dwordx4 v[232:235], v85, s[64:67], s69 offen
    s_add_u32 s69, s69, 0x8000
    buffer_load_dwordx4 v[236:239], v85, s[64:67], s69 offen
    s_add_u32 s69, s69, 0x8000
    buffer_load_dwordx4 v[240:243], v84, s[64:67], s69 offen
    s_add_u32 s69, s69, 0x8000
    buffer_load_dwordx4 v[244:247], v84, s[64:67], s69 offen
    s_add_u32 s69, s69, 0x8000
    buffer_load_dwordx4 v[248:251], v85, s[64:67], s69 offen
    s_add_u32 s69, s69, 0x8000
    buffer_load_dwordx4 v[252:255], v85, s[64:67], s69 offen
    s_add_u32 s69, s69, 0x8000
    s_lshl_b32 s71, s57, 3
    s_add_u32 s71, s71, s58
    s_lshl_b32 s71, s71, 13
    s_cmp_lt_u32 s57, 3
    s_cselect_b32 s71, s71, 0x5ffffff0
    v_lshlrev_b32 v4, 7, v1
    buffer_load_dword v99, v4, s[36:39], s71 offen
    v_bfe_u32 v88, v1, 0, 2
    v_lshlrev_b32 v88, 3, v88
    v_bfe_u32 v5, v1, 4, 1
    v_lshl_or_b32 v88, v5, 5, v88
    v_bfe_u32 v5, v1, 2, 2
    v_lshl_or_b32 v88, v5, 6, v88
    v_bfe_u32 v5, v1, 2, 2
    v_lshl_or_b32 v88, v5, 8, v88
    v_bfe_u32 v5, v1, 4, 2
    v_lshl_or_b32 v88, v5, 11, v88
    s_bfe_u32 s71, s58, 0x20000
    s_lshl_b32 s71, s71, 6
    s_bfe_u32 s72, s58, 0x10002
    s_lshl_b32 s72, s72, 16
    s_or_b32 s71, s71, s72
    v_xor_b32 v88, s71, v88
    v_xor_b32 v89, 32, v88
    v_lshl_add_u32 v96, v1, 4, s70
    s_lshl_b32 s71, s75, 16
    s_add_u32 s81, s81, s71
    s_bfe_u32 s68, s57, 0x10000
    s_lshl_b32 s68, s68, 9
    s_lshl_b32 s71, s58, 2
    v_bfe_u32 v4, v1, 5, 1
    v_lshlrev_b32 v4, 4, v4
    v_xor_b32 v4, s71, v4
    v_lshlrev_b32 v4, 11, v4
    s_and_b32 s71, s71, 12
    v_xor_b32 v5, s71, v1
    v_bfe_u32 v84, v5, 0, 5
    v_lshlrev_b32 v84, 4, v84
    v_bfe_u32 v6, v5, 5, 1
    v_lshl_or_b32 v84, v6, 10, v84
    s_mov_b32 s72, 1024
    v_add_u32 v84, v84, v4
    v_xor_b32 v85, 16, v84
    v_add_u32 v85, s72, v85
    v_xor_b32 v86, 48, v85
    v_add_u32 v86, s72, v86
    v_xor_b32 v87, 16, v86
    v_add_u32 v87, s72, v87
    s_xor_b32 s69, s68, 512
    s_lshl_b32 s70, s58, 12
    s_waitcnt vmcnt(17)
    s_barrier
    ds_read_b64_tr_b16 v[128:129], v88 offset:0
    ds_read_b64_tr_b16 v[130:131], v88 offset:1024
    ds_read_b64_tr_b16 v[132:133], v89 offset:0
    ds_read_b64_tr_b16 v[134:135], v89 offset:1024
    ds_read_b64_tr_b16 v[136:137], v88 offset:8192
    ds_read_b64_tr_b16 v[138:139], v88 offset:9216
    ds_read_b64_tr_b16 v[140:141], v89 offset:8192
    ds_read_b64_tr_b16 v[142:143], v89 offset:9216
    s_waitcnt lgkmcnt(4)
    ds_read_b64_tr_b16 v[144:145], v88 offset:16384
    ds_read_b64_tr_b16 v[146:147], v88 offset:17408
    ds_read_b64_tr_b16 v[148:149], v89 offset:16384
    ds_read_b64_tr_b16 v[150:151], v89 offset:17408
    ds_read_b64_tr_b16 v[152:153], v88 offset:24576
    ds_read_b64_tr_b16 v[154:155], v88 offset:25600
    ds_read_b64_tr_b16 v[156:157], v89 offset:24576
    ds_read_b64_tr_b16 v[158:159], v89 offset:25600
    s_waitcnt lgkmcnt(4)
    ds_read_b64_tr_b16 v[160:161], v88 offset:32768
    ds_read_b64_tr_b16 v[162:163], v88 offset:33792
    ds_read_b64_tr_b16 v[164:165], v89 offset:32768
    ds_read_b64_tr_b16 v[166:167], v89 offset:33792
    ds_read_b64_tr_b16 v[168:169], v88 offset:40960
    ds_read_b64_tr_b16 v[170:171], v88 offset:41984
    ds_read_b64_tr_b16 v[172:173], v89 offset:40960
    ds_read_b64_tr_b16 v[174:175], v89 offset:41984
    s_waitcnt lgkmcnt(4)
    ds_read_b64_tr_b16 v[176:177], v88 offset:49152
    ds_read_b64_tr_b16 v[178:179], v88 offset:50176
    ds_read_b64_tr_b16 v[180:181], v89 offset:49152
    ds_read_b64_tr_b16 v[182:183], v89 offset:50176
    ds_read_b64_tr_b16 v[184:185], v88 offset:57344
    ds_read_b64_tr_b16 v[186:187], v88 offset:58368
    ds_read_b64_tr_b16 v[188:189], v89 offset:57344
    ds_read_b64_tr_b16 v[190:191], v89 offset:58368
    s_waitcnt lgkmcnt(0)
    s_barrier
    buffer_load_dwordx4 v[20:23], v84, s[36:39], s68 offen offset:0
    buffer_load_dwordx4 v[24:27], v85, s[36:39], s68 offen offset:1024
    buffer_load_dwordx4 v[28:31], v86, s[36:39], s68 offen offset:2048
    buffer_load_dwordx4 v[32:35], v87, s[36:39], s68 offen offset:3072
    s_add_u32 s68, s68, 0x10000
    buffer_load_dwordx4 v[36:39], v84, s[36:39], s69 offen offset:0
    buffer_load_dwordx4 v[40:43], v85, s[36:39], s69 offen offset:1024
    buffer_load_dwordx4 v[44:47], v86, s[36:39], s69 offen offset:2048
    buffer_load_dwordx4 v[48:51], v87, s[36:39], s69 offen offset:3072
    s_add_u32 s69, s69, 0x10000
    buffer_load_dwordx4 v[52:55], v84, s[36:39], s68 offen offset:0
    buffer_load_dwordx4 v[56:59], v85, s[36:39], s68 offen offset:1024
    buffer_load_dwordx4 v[60:63], v86, s[36:39], s68 offen offset:2048
    buffer_load_dwordx4 v[64:67], v87, s[36:39], s68 offen offset:3072
    s_add_u32 s68, s68, 0x10000
    s_waitcnt vmcnt(28)
    ds_write_b128 v96, v[192:195] offset:0
    s_waitcnt vmcnt(27)
    ds_write_b128 v96, v[196:199] offset:1024
    s_waitcnt vmcnt(26)
    ds_write_b128 v96, v[200:203] offset:2048
    s_waitcnt vmcnt(25)
    ds_write_b128 v96, v[204:207] offset:3072
    s_waitcnt vmcnt(24)
    ds_write_b128 v96, v[208:211] offset:4096
    s_waitcnt vmcnt(23)
    ds_write_b128 v96, v[212:215] offset:5120
    s_waitcnt vmcnt(22)
    ds_write_b128 v96, v[216:219] offset:6144
    s_waitcnt vmcnt(21)
    ds_write_b128 v96, v[220:223] offset:7168
    s_waitcnt vmcnt(20)
    ds_write_b128 v96, v[224:227] offset:8192
    s_waitcnt vmcnt(19)
    ds_write_b128 v96, v[228:231] offset:9216
    s_waitcnt vmcnt(18)
    ds_write_b128 v96, v[232:235] offset:10240
    s_waitcnt vmcnt(17)
    ds_write_b128 v96, v[236:239] offset:11264
    s_waitcnt vmcnt(16)
    ds_write_b128 v96, v[240:243] offset:12288
    s_waitcnt vmcnt(15)
    ds_write_b128 v96, v[244:247] offset:13312
    s_waitcnt vmcnt(14)
    ds_write_b128 v96, v[248:251] offset:14336
    s_waitcnt vmcnt(13)
    ds_write_b128 v96, v[252:255] offset:15360
    s_waitcnt lgkmcnt(0)
    s_barrier
    ds_read_b64_tr_b16 v[192:193], v88 offset:0
    ds_read_b64_tr_b16 v[194:195], v88 offset:1024
    ds_read_b64_tr_b16 v[196:197], v89 offset:0
    ds_read_b64_tr_b16 v[198:199], v89 offset:1024
    ds_read_b64_tr_b16 v[200:201], v88 offset:8192
    ds_read_b64_tr_b16 v[202:203], v88 offset:9216
    ds_read_b64_tr_b16 v[204:205], v89 offset:8192
    ds_read_b64_tr_b16 v[206:207], v89 offset:9216
    s_waitcnt lgkmcnt(4)
    ds_read_b64_tr_b16 v[208:209], v88 offset:16384
    ds_read_b64_tr_b16 v[210:211], v88 offset:17408
    ds_read_b64_tr_b16 v[212:213], v89 offset:16384
    ds_read_b64_tr_b16 v[214:215], v89 offset:17408
    ds_read_b64_tr_b16 v[216:217], v88 offset:24576
    ds_read_b64_tr_b16 v[218:219], v88 offset:25600
    ds_read_b64_tr_b16 v[220:221], v89 offset:24576
    ds_read_b64_tr_b16 v[222:223], v89 offset:25600
    s_waitcnt lgkmcnt(4)
    ds_read_b64_tr_b16 v[224:225], v88 offset:32768
    ds_read_b64_tr_b16 v[226:227], v88 offset:33792
    ds_read_b64_tr_b16 v[228:229], v89 offset:32768
    ds_read_b64_tr_b16 v[230:231], v89 offset:33792
    ds_read_b64_tr_b16 v[232:233], v88 offset:40960
    ds_read_b64_tr_b16 v[234:235], v88 offset:41984
    ds_read_b64_tr_b16 v[236:237], v89 offset:40960
    ds_read_b64_tr_b16 v[238:239], v89 offset:41984
    s_waitcnt lgkmcnt(4)
    ds_read_b64_tr_b16 v[240:241], v88 offset:49152
    ds_read_b64_tr_b16 v[242:243], v88 offset:50176
    ds_read_b64_tr_b16 v[244:245], v89 offset:49152
    ds_read_b64_tr_b16 v[246:247], v89 offset:50176
    ds_read_b64_tr_b16 v[248:249], v88 offset:57344
    ds_read_b64_tr_b16 v[250:251], v88 offset:58368
    ds_read_b64_tr_b16 v[252:253], v89 offset:57344
    ds_read_b64_tr_b16 v[254:255], v89 offset:58368
    s_waitcnt lgkmcnt(0)
    s_barrier
    v_lshl_add_u32 v96, v1, 4, s70
    v_add_u32 v97, 0x10000, v96
    s_waitcnt vmcnt(11)
    ds_write_b128 v96, v[20:23] offset:0
    s_waitcnt vmcnt(10)
    ds_write_b128 v96, v[24:27] offset:1024
    s_waitcnt vmcnt(9)
    ds_write_b128 v96, v[28:31] offset:2048
    s_waitcnt vmcnt(8)
    ds_write_b128 v96, v[32:35] offset:3072
    s_waitcnt vmcnt(7)
    ds_write_b128 v96, v[36:39] offset:32768
    s_waitcnt vmcnt(6)
    ds_write_b128 v96, v[40:43] offset:33792
    s_waitcnt vmcnt(5)
    ds_write_b128 v96, v[44:47] offset:34816
    s_waitcnt vmcnt(4)
    ds_write_b128 v96, v[48:51] offset:35840
    s_waitcnt vmcnt(3)
    ds_write_b128 v97, v[52:55] offset:0
    s_waitcnt vmcnt(2)
    ds_write_b128 v97, v[56:59] offset:1024
    s_waitcnt vmcnt(1)
    ds_write_b128 v97, v[60:63] offset:2048
    s_waitcnt vmcnt(0)
    ds_write_b128 v97, v[64:67] offset:3072
    buffer_load_dword v99, off, s[12:15], s70 offset:32 sc1
    v_lshrrev_b32 v4, 4, v1
    v_xor_b32 v4, v4, v1
    v_bfe_u32 v5, v4, 0, 4
    v_lshlrev_b32 v5, 4, v5
    v_bfe_u32 v4, v1, 0, 4
    v_lshlrev_b32 v4, 10, v4
    s_bfe_u32 s71, s58, 0x10002
    s_lshl_b32 s71, s71, 9
    v_or3_b32 v88, v4, v5, s71
    v_xor_b32 v89, 0x40, v88
    v_xor_b32 v90, 0x80, v88
    v_xor_b32 v91, 0xc0, v88
    v_xor_b32 v92, 0x10000, v88
    v_xor_b32 v93, 0x10040, v88
    v_xor_b32 v94, 0x10080, v88
    v_xor_b32 v95, 0x100c0, v88
    s_lshl_b32 s71, s58, 11
    s_or_b32 s71, s71, 131072
    v_lshl_add_u32 v96, v1, 4, s71
    v_xor_b32 v97, 0x2000, v96
    v_bfe_u32 v98, v1, 0, 4
    v_lshlrev_b32 v98, 4, v98
    v_bfe_u32 v4, v1, 4, 2
    v_lshl_or_b32 v98, v4, 9, v98
    s_bfe_u32 s71, s57, 0x30000
    s_lshl_b32 s71, s71, 13
    s_add_u32 s81, s81, s71
    s_bfe_u32 s71, s58, 0x20000
    s_lshl_b32 s71, s71, 11
    s_bfe_u32 s72, s58, 0x10002
    s_lshl_b32 s72, s72, 8
    s_or_b32 s71, s71, s72
    s_add_u32 s81, s81, s71
    s_mov_b32 s73, 0x5ffffff0
    s_mov_b32 s82, 0
    s_waitcnt vmcnt(8) lgkmcnt(0)
    s_barrier
    ds_read_b128 v[52:55], v88 offset:0
    ds_read_b128 v[56:59], v88 offset:16384
    ds_read_b128 v[60:63], v89 offset:0
    ds_read_b128 v[64:67], v89 offset:16384
    v_mov_b32 v100, 3
    v_cmp_gt_u32 vcc, s58, v100
stream_67:
    s_waitcnt lgkmcnt(2)
    v_mfma_f32_16x16x32_bf16 v[20:23], v[128:131], v[52:55], 0
    ds_read_b128 v[68:71], v90 offset:0
    v_mfma_f32_16x16x32_bf16 v[24:27], v[132:135], v[52:55], 0
    ds_read_b128 v[72:75], v90 offset:16384
    v_mfma_f32_16x16x32_bf16 v[28:31], v[128:131], v[56:59], 0
    s_add_u32 m0, s70, 98304
    s_nop 0
    buffer_load_dwordx4 v84, s[36:39], s69 offen offset:0 lds
    v_mfma_f32_16x16x32_bf16 v[32:35], v[132:135], v[56:59], 0
    s_waitcnt lgkmcnt(2)
    v_mfma_f32_16x16x32_bf16 v[20:23], v[136:139], v[60:63], v[20:23]
    ds_read_b128 v[76:79], v91 offset:0
    v_mfma_f32_16x16x32_bf16 v[24:27], v[140:143], v[60:63], v[24:27]
    ds_read_b128 v[80:83], v91 offset:16384
    v_mfma_f32_16x16x32_bf16 v[28:31], v[136:139], v[64:67], v[28:31]
    buffer_load_dwordx4 v85, s[36:39], s69 offen offset:1024 lds
    v_mfma_f32_16x16x32_bf16 v[32:35], v[140:143], v[64:67], v[32:35]
    ds_write_b128 v96, v[44:47] offset:0
    s_waitcnt lgkmcnt(3)
    v_mfma_f32_16x16x32_bf16 v[20:23], v[144:147], v[68:71], v[20:23]
    ds_read_b128 v[52:55], v88 offset:256
    v_mfma_f32_16x16x32_bf16 v[24:27], v[148:151], v[68:71], v[24:27]
    ds_read_b128 v[56:59], v88 offset:16640
    v_mfma_f32_16x16x32_bf16 v[28:31], v[144:147], v[72:75], v[28:31]
    buffer_load_dwordx4 v86, s[36:39], s69 offen offset:2048 lds
    v_mfma_f32_16x16x32_bf16 v[32:35], v[148:151], v[72:75], v[32:35]
    ds_write_b128 v96, v[48:51] offset:1024
    s_waitcnt lgkmcnt(4)
    v_mfma_f32_16x16x32_bf16 v[20:23], v[152:155], v[76:79], v[20:23]
    ds_read_b128 v[60:63], v89 offset:256
    v_mfma_f32_16x16x32_bf16 v[24:27], v[156:159], v[76:79], v[24:27]
    ds_read_b128 v[64:67], v89 offset:16640
    v_mfma_f32_16x16x32_bf16 v[28:31], v[152:155], v[80:83], v[28:31]
    buffer_load_dwordx4 v87, s[36:39], s69 offen offset:3072 lds
    s_add_u32 s69, s69, 0x10000
    v_mfma_f32_16x16x32_bf16 v[32:35], v[156:159], v[80:83], v[32:35]
    s_waitcnt lgkmcnt(3)
    v_mfma_f32_16x16x32_bf16 v[20:23], v[160:163], v[52:55], v[20:23]
    ds_read_b128 v[68:71], v90 offset:256
    v_mfma_f32_16x16x32_bf16 v[24:27], v[164:167], v[52:55], v[24:27]
    ds_read_b128 v[72:75], v90 offset:16640
    v_mfma_f32_16x16x32_bf16 v[28:31], v[160:163], v[56:59], v[28:31]
    v_mfma_f32_16x16x32_bf16 v[32:35], v[164:167], v[56:59], v[32:35]
    s_waitcnt lgkmcnt(2)
    v_mfma_f32_16x16x32_bf16 v[20:23], v[168:171], v[60:63], v[20:23]
    ds_read_b128 v[76:79], v91 offset:256
    v_mfma_f32_16x16x32_bf16 v[24:27], v[172:175], v[60:63], v[24:27]
    ds_read_b128 v[80:83], v91 offset:16640
    v_mfma_f32_16x16x32_bf16 v[28:31], v[168:171], v[64:67], v[28:31]
    v_mfma_f32_16x16x32_bf16 v[32:35], v[172:175], v[64:67], v[32:35]
    s_waitcnt vmcnt(8) lgkmcnt(0)
    s_barrier
    v_mfma_f32_16x16x32_bf16 v[20:23], v[176:179], v[68:71], v[20:23]
    ds_read_b128 v[4:7], v97 offset:0
    ds_read_b128 v[8:11], v97 offset:1024
    ds_read_b128 v[52:55], v88 offset:32768
    v_mfma_f32_16x16x32_bf16 v[24:27], v[180:183], v[68:71], v[24:27]
    ds_read_b128 v[56:59], v88 offset:49152
    v_mfma_f32_16x16x32_bf16 v[28:31], v[176:179], v[72:75], v[28:31]
    v_mfma_f32_16x16x32_bf16 v[32:35], v[180:183], v[72:75], v[32:35]
    s_waitcnt lgkmcnt(2)
    v_mfma_f32_16x16x32_bf16 v[20:23], v[184:187], v[76:79], v[20:23]
    v_add_f32 v4, v4, v36
    v_add_f32 v5, v5, v37
    v_add_f32 v6, v6, v38
    v_add_f32 v7, v7, v39
    ds_read_b128 v[60:63], v89 offset:32768
    v_mfma_f32_16x16x32_bf16 v[24:27], v[188:191], v[76:79], v[24:27]
    v_cvt_pk_bf16_f32 v12, v4, v5
    v_cvt_pk_bf16_f32 v13, v6, v7
    ds_read_b128 v[64:67], v89 offset:49152
    v_mfma_f32_16x16x32_bf16 v[28:31], v[184:187], v[80:83], v[28:31]
    v_add_f32 v8, v8, v40
    v_add_f32 v9, v9, v41
    v_add_f32 v10, v10, v42
    v_add_f32 v11, v11, v43
    v_mfma_f32_16x16x32_bf16 v[32:35], v[188:191], v[80:83], v[32:35]
    v_cvt_pk_bf16_f32 v14, v8, v9
    v_cvt_pk_bf16_f32 v15, v10, v11
    buffer_store_dwordx4 v[12:15], v98, s[8:11], s73 offen sc1
    s_mov_b32 s73, s81
    s_add_u32 s81, s81, 0x40000
    s_waitcnt lgkmcnt(2)
    v_mfma_f32_16x16x32_bf16 v[20:23], v[192:195], v[52:55], v[20:23]
    ds_read_b128 v[68:71], v90 offset:32768
    v_mfma_f32_16x16x32_bf16 v[24:27], v[196:199], v[52:55], v[24:27]
    ds_read_b128 v[72:75], v90 offset:49152
    v_mfma_f32_16x16x32_bf16 v[28:31], v[192:195], v[56:59], v[28:31]
    s_add_u32 m0, s70, 0
    s_nop 0
    buffer_load_dwordx4 v84, s[36:39], s68 offen offset:0 lds
    v_mfma_f32_16x16x32_bf16 v[32:35], v[196:199], v[56:59], v[32:35]
    s_waitcnt lgkmcnt(2)
    v_mfma_f32_16x16x32_bf16 v[20:23], v[200:203], v[60:63], v[20:23]
    ds_read_b128 v[76:79], v91 offset:32768
    v_mfma_f32_16x16x32_bf16 v[24:27], v[204:207], v[60:63], v[24:27]
    ds_read_b128 v[80:83], v91 offset:49152
    v_mfma_f32_16x16x32_bf16 v[28:31], v[200:203], v[64:67], v[28:31]
    buffer_load_dwordx4 v85, s[36:39], s68 offen offset:1024 lds
    v_mfma_f32_16x16x32_bf16 v[32:35], v[204:207], v[64:67], v[32:35]
    s_waitcnt lgkmcnt(2)
    v_mfma_f32_16x16x32_bf16 v[20:23], v[208:211], v[68:71], v[20:23]
    ds_read_b128 v[52:55], v88 offset:33024
    v_mfma_f32_16x16x32_bf16 v[24:27], v[212:215], v[68:71], v[24:27]
    ds_read_b128 v[56:59], v88 offset:49408
    v_mfma_f32_16x16x32_bf16 v[28:31], v[208:211], v[72:75], v[28:31]
    buffer_load_dwordx4 v86, s[36:39], s68 offen offset:2048 lds
    v_mfma_f32_16x16x32_bf16 v[32:35], v[212:215], v[72:75], v[32:35]
    s_waitcnt lgkmcnt(2)
    v_mfma_f32_16x16x32_bf16 v[20:23], v[216:219], v[76:79], v[20:23]
    ds_read_b128 v[60:63], v89 offset:33024
    v_mfma_f32_16x16x32_bf16 v[24:27], v[220:223], v[76:79], v[24:27]
    ds_read_b128 v[64:67], v89 offset:49408
    v_mfma_f32_16x16x32_bf16 v[28:31], v[216:219], v[80:83], v[28:31]
    buffer_load_dwordx4 v87, s[36:39], s68 offen offset:3072 lds
    s_add_u32 s68, s68, 0x10000
    v_mfma_f32_16x16x32_bf16 v[32:35], v[220:223], v[80:83], v[32:35]
    s_waitcnt lgkmcnt(2)
    v_mfma_f32_16x16x32_bf16 v[20:23], v[224:227], v[52:55], v[20:23]
    ds_read_b128 v[68:71], v90 offset:33024
    v_mfma_f32_16x16x32_bf16 v[24:27], v[228:231], v[52:55], v[24:27]
    ds_read_b128 v[72:75], v90 offset:49408
    v_mfma_f32_16x16x32_bf16 v[28:31], v[224:227], v[56:59], v[28:31]
    v_mfma_f32_16x16x32_bf16 v[32:35], v[228:231], v[56:59], v[32:35]
    s_waitcnt lgkmcnt(2)
    v_mfma_f32_16x16x32_bf16 v[20:23], v[232:235], v[60:63], v[20:23]
    ds_read_b128 v[76:79], v91 offset:33024
    v_mfma_f32_16x16x32_bf16 v[24:27], v[236:239], v[60:63], v[24:27]
    ds_read_b128 v[80:83], v91 offset:49408
    v_mfma_f32_16x16x32_bf16 v[28:31], v[232:235], v[64:67], v[28:31]
    v_mfma_f32_16x16x32_bf16 v[32:35], v[236:239], v[64:67], v[32:35]
    s_bitcmp1_b64 s[6:7], s82
    s_cbranch_scc1 ssig_57
    s_waitcnt vmcnt(8) lgkmcnt(0)
    s_barrier
sretf_58:
    s_add_u32 s82, s82, 1
    v_mfma_f32_16x16x32_bf16 v[20:23], v[240:243], v[68:71], v[20:23]
    ds_read_b128 v[52:55], v92 offset:0
    v_mfma_f32_16x16x32_bf16 v[24:27], v[244:247], v[68:71], v[24:27]
    ds_read_b128 v[56:59], v92 offset:16384
    v_mfma_f32_16x16x32_bf16 v[28:31], v[240:243], v[72:75], v[28:31]
    v_mfma_f32_16x16x32_bf16 v[32:35], v[244:247], v[72:75], v[32:35]
    v_mfma_f32_16x16x32_bf16 v[20:23], v[248:251], v[76:79], v[20:23]
    ds_read_b128 v[60:63], v93 offset:0
    v_mfma_f32_16x16x32_bf16 v[24:27], v[252:255], v[76:79], v[24:27]
    ds_read_b128 v[64:67], v93 offset:16384
    v_mfma_f32_16x16x32_bf16 v[28:31], v[248:251], v[80:83], v[28:31]
    v_mfma_f32_16x16x32_bf16 v[32:35], v[252:255], v[80:83], v[32:35]
    s_waitcnt lgkmcnt(2)
    v_mfma_f32_16x16x32_bf16 v[36:39], v[128:131], v[52:55], 0
    ds_read_b128 v[68:71], v94 offset:0
    v_mfma_f32_16x16x32_bf16 v[40:43], v[132:135], v[52:55], 0
    ds_read_b128 v[72:75], v94 offset:16384
    v_mfma_f32_16x16x32_bf16 v[44:47], v[128:131], v[56:59], 0
    s_add_u32 m0, s70, 32768
    s_nop 0
    buffer_load_dwordx4 v84, s[36:39], s69 offen offset:0 lds
    v_mfma_f32_16x16x32_bf16 v[48:51], v[132:135], v[56:59], 0
    s_waitcnt lgkmcnt(2)
    v_mfma_f32_16x16x32_bf16 v[36:39], v[136:139], v[60:63], v[36:39]
    ds_read_b128 v[76:79], v95 offset:0
    v_mfma_f32_16x16x32_bf16 v[40:43], v[140:143], v[60:63], v[40:43]
    ds_read_b128 v[80:83], v95 offset:16384
    v_mfma_f32_16x16x32_bf16 v[44:47], v[136:139], v[64:67], v[44:47]
    buffer_load_dwordx4 v85, s[36:39], s69 offen offset:1024 lds
    v_mfma_f32_16x16x32_bf16 v[48:51], v[140:143], v[64:67], v[48:51]
    ds_write_b128 v96, v[28:31] offset:0
    s_waitcnt lgkmcnt(3)
    v_mfma_f32_16x16x32_bf16 v[36:39], v[144:147], v[68:71], v[36:39]
    ds_read_b128 v[52:55], v92 offset:256
    v_mfma_f32_16x16x32_bf16 v[40:43], v[148:151], v[68:71], v[40:43]
    ds_read_b128 v[56:59], v92 offset:16640
    v_mfma_f32_16x16x32_bf16 v[44:47], v[144:147], v[72:75], v[44:47]
    buffer_load_dwordx4 v86, s[36:39], s69 offen offset:2048 lds
    v_mfma_f32_16x16x32_bf16 v[48:51], v[148:151], v[72:75], v[48:51]
    ds_write_b128 v96, v[32:35] offset:1024
    s_waitcnt lgkmcnt(4)
    v_mfma_f32_16x16x32_bf16 v[36:39], v[152:155], v[76:79], v[36:39]
    ds_read_b128 v[60:63], v93 offset:256
    v_mfma_f32_16x16x32_bf16 v[40:43], v[156:159], v[76:79], v[40:43]
    ds_read_b128 v[64:67], v93 offset:16640
    v_mfma_f32_16x16x32_bf16 v[44:47], v[152:155], v[80:83], v[44:47]
    buffer_load_dwordx4 v87, s[36:39], s69 offen offset:3072 lds
    s_add_u32 s69, s69, 0x10000
    v_mfma_f32_16x16x32_bf16 v[48:51], v[156:159], v[80:83], v[48:51]
    s_waitcnt lgkmcnt(3)
    v_mfma_f32_16x16x32_bf16 v[36:39], v[160:163], v[52:55], v[36:39]
    ds_read_b128 v[68:71], v94 offset:256
    v_mfma_f32_16x16x32_bf16 v[40:43], v[164:167], v[52:55], v[40:43]
    ds_read_b128 v[72:75], v94 offset:16640
    v_mfma_f32_16x16x32_bf16 v[44:47], v[160:163], v[56:59], v[44:47]
    v_mfma_f32_16x16x32_bf16 v[48:51], v[164:167], v[56:59], v[48:51]
    s_waitcnt lgkmcnt(2)
    v_mfma_f32_16x16x32_bf16 v[36:39], v[168:171], v[60:63], v[36:39]
    ds_read_b128 v[76:79], v95 offset:256
    v_mfma_f32_16x16x32_bf16 v[40:43], v[172:175], v[60:63], v[40:43]
    ds_read_b128 v[80:83], v95 offset:16640
    v_mfma_f32_16x16x32_bf16 v[44:47], v[168:171], v[64:67], v[44:47]
    v_mfma_f32_16x16x32_bf16 v[48:51], v[172:175], v[64:67], v[48:51]
    s_waitcnt vmcnt(8) lgkmcnt(0)
    s_barrier
    v_mfma_f32_16x16x32_bf16 v[36:39], v[176:179], v[68:71], v[36:39]
    ds_read_b128 v[4:7], v97 offset:0
    ds_read_b128 v[8:11], v97 offset:1024
    ds_read_b128 v[52:55], v92 offset:32768
    v_mfma_f32_16x16x32_bf16 v[40:43], v[180:183], v[68:71], v[40:43]
    ds_read_b128 v[56:59], v92 offset:49152
    v_mfma_f32_16x16x32_bf16 v[44:47], v[176:179], v[72:75], v[44:47]
    v_mfma_f32_16x16x32_bf16 v[48:51], v[180:183], v[72:75], v[48:51]
    s_waitcnt lgkmcnt(2)
    v_mfma_f32_16x16x32_bf16 v[36:39], v[184:187], v[76:79], v[36:39]
    v_add_f32 v4, v4, v20
    v_add_f32 v5, v5, v21
    v_add_f32 v6, v6, v22
    v_add_f32 v7, v7, v23
    ds_read_b128 v[60:63], v93 offset:32768
    v_mfma_f32_16x16x32_bf16 v[40:43], v[188:191], v[76:79], v[40:43]
    v_cvt_pk_bf16_f32 v12, v4, v5
    v_cvt_pk_bf16_f32 v13, v6, v7
    ds_read_b128 v[64:67], v93 offset:49152
    v_mfma_f32_16x16x32_bf16 v[44:47], v[184:187], v[80:83], v[44:47]
    v_add_f32 v8, v8, v24
    v_add_f32 v9, v9, v25
    v_add_f32 v10, v10, v26
    v_add_f32 v11, v11, v27
    v_mfma_f32_16x16x32_bf16 v[48:51], v[188:191], v[80:83], v[48:51]
    v_cvt_pk_bf16_f32 v14, v8, v9
    v_cvt_pk_bf16_f32 v15, v10, v11
    buffer_store_dwordx4 v[12:15], v98, s[8:11], s73 offen sc1
    s_mov_b32 s73, s81
    s_add_u32 s81, s81, 0x40000
    s_waitcnt lgkmcnt(2)
    v_mfma_f32_16x16x32_bf16 v[36:39], v[192:195], v[52:55], v[36:39]
    ds_read_b128 v[68:71], v94 offset:32768
    v_mfma_f32_16x16x32_bf16 v[40:43], v[196:199], v[52:55], v[40:43]
    ds_read_b128 v[72:75], v94 offset:49152
    v_mfma_f32_16x16x32_bf16 v[44:47], v[192:195], v[56:59], v[44:47]
    s_add_u32 m0, s70, 65536
    s_nop 0
    buffer_load_dwordx4 v84, s[36:39], s68 offen offset:0 lds
    v_mfma_f32_16x16x32_bf16 v[48:51], v[196:199], v[56:59], v[48:51]
    s_waitcnt lgkmcnt(2)
    v_mfma_f32_16x16x32_bf16 v[36:39], v[200:203], v[60:63], v[36:39]
    ds_read_b128 v[76:79], v95 offset:32768
    v_mfma_f32_16x16x32_bf16 v[40:43], v[204:207], v[60:63], v[40:43]
    ds_read_b128 v[80:83], v95 offset:49152
    v_mfma_f32_16x16x32_bf16 v[44:47], v[200:203], v[64:67], v[44:47]
    buffer_load_dwordx4 v85, s[36:39], s68 offen offset:1024 lds
    v_mfma_f32_16x16x32_bf16 v[48:51], v[204:207], v[64:67], v[48:51]
    s_waitcnt lgkmcnt(2)
    v_mfma_f32_16x16x32_bf16 v[36:39], v[208:211], v[68:71], v[36:39]
    ds_read_b128 v[52:55], v92 offset:33024
    v_mfma_f32_16x16x32_bf16 v[40:43], v[212:215], v[68:71], v[40:43]
    ds_read_b128 v[56:59], v92 offset:49408
    v_mfma_f32_16x16x32_bf16 v[44:47], v[208:211], v[72:75], v[44:47]
    buffer_load_dwordx4 v86, s[36:39], s68 offen offset:2048 lds
    v_mfma_f32_16x16x32_bf16 v[48:51], v[212:215], v[72:75], v[48:51]
    s_waitcnt lgkmcnt(2)
    v_mfma_f32_16x16x32_bf16 v[36:39], v[216:219], v[76:79], v[36:39]
    ds_read_b128 v[60:63], v93 offset:33024
    v_mfma_f32_16x16x32_bf16 v[40:43], v[220:223], v[76:79], v[40:43]
    ds_read_b128 v[64:67], v93 offset:49408
    v_mfma_f32_16x16x32_bf16 v[44:47], v[216:219], v[80:83], v[44:47]
    buffer_load_dwordx4 v87, s[36:39], s68 offen offset:3072 lds
    s_add_u32 s68, s68, 0x10000
    v_mfma_f32_16x16x32_bf16 v[48:51], v[220:223], v[80:83], v[48:51]
    s_waitcnt lgkmcnt(2)
    v_mfma_f32_16x16x32_bf16 v[36:39], v[224:227], v[52:55], v[36:39]
    ds_read_b128 v[68:71], v94 offset:33024
    v_mfma_f32_16x16x32_bf16 v[40:43], v[228:231], v[52:55], v[40:43]
    ds_read_b128 v[72:75], v94 offset:49408
    v_mfma_f32_16x16x32_bf16 v[44:47], v[224:227], v[56:59], v[44:47]
    v_mfma_f32_16x16x32_bf16 v[48:51], v[228:231], v[56:59], v[48:51]
    s_waitcnt lgkmcnt(2)
    v_mfma_f32_16x16x32_bf16 v[36:39], v[232:235], v[60:63], v[36:39]
    ds_read_b128 v[76:79], v95 offset:33024
    v_mfma_f32_16x16x32_bf16 v[40:43], v[236:239], v[60:63], v[40:43]
    ds_read_b128 v[80:83], v95 offset:49408
    v_mfma_f32_16x16x32_bf16 v[44:47], v[232:235], v[64:67], v[44:47]
    v_mfma_f32_16x16x32_bf16 v[48:51], v[236:239], v[64:67], v[48:51]
    s_bitcmp1_b64 s[6:7], s82
    s_cbranch_scc1 ssig_57
    s_waitcnt vmcnt(8) lgkmcnt(0)
    s_barrier
sretf_64:
    s_add_u32 s82, s82, 1
    v_mfma_f32_16x16x32_bf16 v[36:39], v[240:243], v[68:71], v[36:39]
    ds_read_b128 v[52:55], v88 offset:0
    v_mfma_f32_16x16x32_bf16 v[40:43], v[244:247], v[68:71], v[40:43]
    ds_read_b128 v[56:59], v88 offset:16384
    v_mfma_f32_16x16x32_bf16 v[44:47], v[240:243], v[72:75], v[44:47]
    v_mfma_f32_16x16x32_bf16 v[48:51], v[244:247], v[72:75], v[48:51]
    v_mfma_f32_16x16x32_bf16 v[36:39], v[248:251], v[76:79], v[36:39]
    ds_read_b128 v[60:63], v89 offset:0
    v_mfma_f32_16x16x32_bf16 v[40:43], v[252:255], v[76:79], v[40:43]
    ds_read_b128 v[64:67], v89 offset:16384
    v_mfma_f32_16x16x32_bf16 v[44:47], v[248:251], v[80:83], v[44:47]
    v_mfma_f32_16x16x32_bf16 v[48:51], v[252:255], v[80:83], v[48:51]
    s_cmp_lt_u32 s82, 64
    s_cbranch_scc1 stream_67
    s_nop 4
    ds_write_b128 v96, v[44:47] offset:0
    ds_write_b128 v96, v[48:51] offset:1024
    s_waitcnt vmcnt(0) lgkmcnt(0)
    s_barrier
    ds_read_b128 v[4:7], v97 offset:0
    ds_read_b128 v[8:11], v97 offset:1024
    s_waitcnt lgkmcnt(0)
    v_add_f32 v4, v4, v36
    v_add_f32 v5, v5, v37
    v_add_f32 v6, v6, v38
    v_add_f32 v7, v7, v39
    v_cvt_pk_bf16_f32 v12, v4, v5
    v_cvt_pk_bf16_f32 v13, v6, v7
    v_add_f32 v8, v8, v40
    v_add_f32 v9, v9, v41
    v_add_f32 v10, v10, v42
    v_add_f32 v11, v11, v43
    v_cvt_pk_bf16_f32 v14, v8, v9
    v_cvt_pk_bf16_f32 v15, v10, v11
    buffer_store_dwordx4 v[12:15], v98, s[8:11], s73 offen sc1
    s_mov_b32 s73, s81
    s_add_u32 s81, s81, 0x40000
    s_branch send_60
ssig_57:
    s_waitcnt vmcnt(4) lgkmcnt(0)
    s_barrier
    s_cmp_lg_u32 s58, 0
    s_cbranch_scc1 sig_69
    s_cmp_ge_u32 s57, 16
    s_cbranch_scc1 sig_68
    s_waitcnt vmcnt(4)
    v_and_b32 v4, 0x3ff, v99
    v_cmp_gt_u32 vcc, 128, v4
    s_cbranch_vccz armd_ok_71
armd_70:
    buffer_load_dword v99, off, s[12:15], 0 offset:32 sc1
    s_waitcnt vmcnt(0)
    v_and_b32 v4, 0x3ff, v99
    v_cmp_gt_u32 vcc, 128, v4
    s_cbranch_vccz armd_ok_71
    s_sub_u32 s77, s77, 1
    s_cbranch_scc0 armd_70
    s_mov_b32 s77, 0
armd_ok_71:
    s_bfe_u32 s85, s76, 0x10003
    s_lshl_b32 s85, s85, 2
    s_bfe_u32 s79, s76, 0x30000
    s_lshl_b32 s79, s79, 7
    s_or_b32 s85, s85, s79
    s_bfe_u32 s79, s76, 0x20005
    s_lshl_b32 s79, s79, 10
    s_or_b32 s85, s85, s79
    s_add_u32 s85, s85, 0x5110000
    v_mov_b32 v4, s82
    buffer_store_dword v4, off, s[8:11], s85 sc1
sig_68:
    s_bitcmp0_b32 s82, 1
    s_cbranch_scc1 sig_69
    s_cmp_lt_u32 s82, 6
    s_cbranch_scc1 sig_69
    v_mov_b32 v5, s84
    s_mov_b64 exec, 1
    buffer_atomic_add v5, off, s[12:15], s83 sc1
    s_mov_b64 exec, -1
    s_add_u32 s83, s83, 4
sig_69:
    s_cmp_lt_u32 s57, 24
    s_cbranch_scc1 xtra_72
    s_bfe_u32 s79, s76, 0x30000
    s_lshl_b32 s79, s79, 16
    s_bfe_u32 s85, s76, 0x20005
    s_lshl_b32 s85, s85, 19
    s_or_b32 s79, s79, s85
    s_lshl_b32 s85, s58, 13
    s_add_u32 s85, s85, s79
    v_lshlrev_b32 v6, 7, v1
    buffer_load_dword v16, v6, s[36:39], s85 offen
    buffer_load_dword v17, v6, s[48:51], s85 offen
    buffer_load_dword v18, v6, s[52:55], s85 offen
    s_add_u32 s85, s85, 0x200000
    buffer_load_dword v19, v6, s[36:39], s85 offen
    s_branch xtra_73
xtra_72:
    v_lshlrev_b32 v6, 4, v1
    s_bfe_u32 s80, s76, 0x40000
    s_lshl_b32 s80, s80, 3
    s_bfe_u32 s85, s76, 0x20005
    s_lshl_b32 s85, s85, 7
    s_or_b32 s80, s80, s85
    s_add_u32 s80, s80, s58
    s_cmp_lg_u32 s82, 10
    s_cbranch_scc1 xtra_74
    v_mov_b32 v16, 0
    v_mov_b32 v17, 0
    v_mov_b32 v18, 0
    v_mov_b32 v19, 0
    s_lshl_b32 s85, s80, 6
    s_add_u32 s85, s85, 0x5100000
    v_and_b32 v7, 48, v6
    s_cmp_ge_u32 s57, 16
    s_cselect_b32 s85, 0x5ffffff0, s85
    buffer_store_dwordx4 v[16:19], v7, s[8:11], s85 offen sc1
xtra_74:
    s_cmp_lg_u32 s82, 99
    s_cbranch_scc1 xtra_75
    s_lshl_b32 s85, s80, 14
    s_cmp_ge_u32 s57, 16
    s_cbranch_scc1 xtra_75
    v_lshlrev_b32 v7, 6, v1
    buffer_load_dword v16, v7, s[32:35], s85 offen
    s_add_u32 s85, s85, 4096
    buffer_load_dword v17, v7, s[32:35], s85 offen
    s_add_u32 s85, s85, 4096
    buffer_load_dword v18, v7, s[32:35], s85 offen
    s_add_u32 s85, s85, 4096
    buffer_load_dword v19, v7, s[32:35], s85 offen
    s_add_u32 s85, s85, 4096
xtra_75:
    s_bfe_u32 s85, s57, 0x30000
    s_lshl_b32 s85, s85, 2
    s_add_u32 s85, s85, 10
    s_cmp_lg_u32 s82, s85
    s_cbranch_scc1 xtra_73
    v_mov_b32 v8, -1
    v_mov_b32 v9, -1
    v_mov_b32 v10, -1
    v_mov_b32 v11, -1
    s_bfe_u32 s85, s76, 0x20005
    s_lshl_b32 s85, s85, 11
    s_bfe_u32 s79, s76, 0x30000
    s_lshl_b32 s79, s79, 16
    s_or_b32 s85, s85, s79
    s_bfe_u32 s79, s76, 0x20003
    s_lshl_b32 s79, s79, 21
    s_or_b32 s85, s85, s79
    s_lshl_b32 s79, s58, 13
    s_add_u32 s85, s85, s79
    s_add_u32 s85, s85, 0x6000000
    buffer_store_dwordx4 v[8:11], v6, s[8:11], s85 offen offset:0 sc1
    s_add_u32 s85, s85, 0x80000
    buffer_store_dwordx4 v[8:11], v6, s[8:11], s85 offen offset:0 sc1
    s_add_u32 s85, s85, 0x80000
    buffer_store_dwordx4 v[8:11], v6, s[8:11], s85 offen offset:0 sc1
    s_add_u32 s85, s85, 0x80000
    buffer_store_dwordx4 v[8:11], v6, s[8:11], s85 offen offset:0 sc1
    s_add_u32 s85, s85, 0x80000
    s_cmp_ge_u32 s57, 16
    s_cbranch_scc1 xtra_73
    s_bfe_u32 s85, s80, 0x30003
    s_lshl_b32 s85, s85, 11
    s_bfe_u32 s79, s80, 0x20007
    s_lshl_b32 s79, s79, 14
    s_or_b32 s85, s85, s79
    s_bfe_u32 s79, s80, 0x30000
    s_lshl_b32 s79, s79, 17
    s_or_b32 s85, s85, s79
    s_bfe_u32 s79, s80, 0x10006
    s_lshl_b32 s79, s79, 22
    s_or_b32 s85, s85, s79
    s_add_u32 s85, s85, 0x4300000
    buffer_store_dwordx4 v[8:11], v6, s[8:11], s85 offen offset:0 sc1
    buffer_store_dwordx4 v[8:11], v6, s[8:11], s85 offen offset:1024 sc1
    s_add_u32 s85, s85, 0x10000
    buffer_store_dwordx4 v[8:11], v6, s[8:11], s85 offen offset:0 sc1
    buffer_store_dwordx4 v[8:11], v6, s[8:11], s85 offen offset:1024 sc1
xtra_73:
    s_bitcmp1_b32 s82, 0
    s_cbranch_scc1 xtra_76
    s_bitcmp1_b32 s57, 3
    s_cbranch_scc1 srett_59
    s_branch sretf_58
xtra_76:
    s_bitcmp1_b32 s57, 3
    s_cbranch_scc1 srett_65
    s_branch sretf_64
sv_55:
    s_mov_b32 s81, 0x2000000
    v_bfe_u32 v4, v1, 4, 2
    v_lshlrev_b32 v4, 2, v4
    v_xor_b32 v4, v4, v1
    v_bfe_u32 v84, v4, 0, 2
    v_lshlrev_b32 v84, 4, v84
    v_bfe_u32 v5, v4, 2, 2
    v_lshl_or_b32 v84, v5, 6, v84
    v_bfe_u32 v5, v4, 4, 2
    v_lshl_or_b32 v84, v5, 13, v84
    v_xor_b32 v85, 32, v84
    s_bfe_u32 s68, s58, 0x20000
    s_lshl_b32 s68, s68, 19
    s_bfe_u32 s71, s58, 0x10002
    s_lshl_b32 s71, s71, 22
    s_or_b32 s68, s68, s71
    s_bfe_u32 s71, s57, 0x30000
    s_lshl_b32 s71, s71, 8
    s_bfe_u32 s72, s57, 0x10000
    s_lshl_b32 s72, s72, 21
    s_or_b32 s71, s71, s72
    s_add_u32 s68, s68, s71
    s_lshl_b32 s71, s75, 11
    s_add_u32 s68, s68, s71
    s_xor_b32 s69, s68, 0x200000
    s_lshl_b32 s70, s58, 14
    s_add_u32 m0, s70, 0
    s_nop 0
    buffer_load_dwordx4 v84, s[28:31], s68 offen lds
    s_add_u32 s68, s68, 0x8000
    s_add_u32 m0, s70, 1024
    s_nop 0
    buffer_load_dwordx4 v84, s[28:31], s68 offen lds
    s_add_u32 s68, s68, 0x8000
    s_add_u32 m0, s70, 2048
    s_nop 0
    buffer_load_dwordx4 v85, s[28:31], s68 offen lds
    s_add_u32 s68, s68, 0x8000
    s_add_u32 m0, s70, 3072
    s_nop 0
    buffer_load_dwordx4 v85, s[28:31], s68 offen lds
    s_add_u32 s68, s68, 0x8000
    s_add_u32 m0, s70, 4096
    s_nop 0
    buffer_load_dwordx4 v84, s[28:31], s68 offen lds
    s_add_u32 s68, s68, 0x8000
    s_add_u32 m0, s70, 5120
    s_nop 0
    buffer_load_dwordx4 v84, s[28:31], s68 offen lds
    s_add_u32 s68, s68, 0x8000
    s_add_u32 m0, s70, 6144
    s_nop 0
    buffer_load_dwordx4 v85, s[28:31], s68 offen lds
    s_add_u32 s68, s68, 0x8000
    s_add_u32 m0, s70, 7168
    s_nop 0
    buffer_load_dwordx4 v85, s[28:31], s68 offen lds
    s_add_u32 s68, s68, 0x8000
    s_add_u32 m0, s70, 8192
    s_nop 0
    buffer_load_dwordx4 v84, s[28:31], s68 offen lds
    s_add_u32 s68, s68, 0x8000
    s_add_u32 m0, s70, 9216
    s_nop 0
    buffer_load_dwordx4 v84, s[28:31], s68 offen lds
    s_add_u32 s68, s68, 0x8000
    s_add_u32 m0, s70, 10240
    s_nop 0
    buffer_load_dwordx4 v85, s[28:31], s68 offen lds
    s_add_u32 s68, s68, 0x8000
    s_add_u32 m0, s70, 11264
    s_nop 0
    buffer_load_dwordx4 v85, s[28:31], s68 offen lds
    s_add_u32 s68, s68, 0x8000
    s_add_u32 m0, s70, 12288
    s_nop 0
    buffer_load_dwordx4 v84, s[28:31], s68 offen lds
    s_add_u32 s68, s68, 0x8000
    s_add_u32 m0, s70, 13312
    s_nop 0
    buffer_load_dwordx4 v84, s[28:31], s68 offen lds
    s_add_u32 s68, s68, 0x8000
    s_add_u32 m0, s70, 14336
    s_nop 0
    buffer_load_dwordx4 v85, s[28:31], s68 offen lds
    s_add_u32 s68, s68, 0x8000
    s_add_u32 m0, s70, 15360
    s_nop 0
    buffer_load_dwordx4 v85, s[28:31], s68 offen lds
    s_add_u32 s68, s68, 0x8000
    buffer_load_dwordx4 v[192:195], v84, s[28:31], s69 offen
    s_add_u32 s69, s69, 0x8000
    buffer_load_dwordx4 v[196:199], v84, s[28:31], s69 offen
    s_add_u32 s69, s69, 0x8000
    buffer_load_dwordx4 v[200:203], v85, s[28:31], s69 offen
    s_add_u32 s69, s69, 0x8000
    buffer_load_dwordx4 v[204:207], v85, s[28:31], s69 offen
    s_add_u32 s69, s69, 0x8000
    buffer_load_dwordx4 v[208:211], v84, s[28:31], s69 offen
    s_add_u32 s69, s69, 0x8000
    buffer_load_dwordx4 v[212:215], v84, s[28:31], s69 offen
    s_add_u32 s69, s69, 0x8000
    buffer_load_dwordx4 v[216:219], v85, s[28:31], s69 offen
    s_add_u32 s69, s69, 0x8000
    buffer_load_dwordx4 v[220:223], v85, s[28:31], s69 offen
    s_add_u32 s69, s69, 0x8000
    buffer_load_dwordx4 v[224:227], v84, s[28:31], s69 offen
    s_add_u32 s69, s69, 0x8000
    buffer_load_dwordx4 v[228:231], v84, s[28:31], s69 offen
    s_add_u32 s69, s69, 0x8000
    buffer_load_dwordx4 v[232:235], v85, s[28:31], s69 offen
    s_add_u32 s69, s69, 0x8000
    buffer_load_dwordx4 v[236:239], v85, s[28:31], s69 offen
    s_add_u32 s69, s69, 0x8000
    buffer_load_dwordx4 v[240:243], v84, s[28:31], s69 offen
    s_add_u32 s69, s69, 0x8000
    buffer_load_dwordx4 v[244:247], v84, s[28:31], s69 offen
    s_add_u32 s69, s69, 0x8000
    buffer_load_dwordx4 v[248:251], v85, s[28:31], s69 offen
    s_add_u32 s69, s69, 0x8000
    buffer_load_dwordx4 v[252:255], v85, s[28:31], s69 offen
    s_add_u32 s69, s69, 0x8000
    s_lshl_b32 s71, s57, 3
    s_add_u32 s71, s71, s58
    s_lshl_b32 s71, s71, 13
    s_cmp_lt_u32 s57, 3
    s_cselect_b32 s71, s71, 0x5ffffff0
    v_lshlrev_b32 v4, 7, v1
    buffer_load_dword v99, v4, s[36:39], s71 offen
    v_bfe_u32 v88, v1, 0, 2
    v_lshlrev_b32 v88, 3, v88
    v_bfe_u32 v5, v1, 4, 1
    v_lshl_or_b32 v88, v5, 5, v88
    v_bfe_u32 v5, v1, 2, 2
    v_lshl_or_b32 v88, v5, 6, v88
    v_bfe_u32 v5, v1, 2, 2
    v_lshl_or_b32 v88, v5, 8, v88
    v_bfe_u32 v5, v1, 4, 2
    v_lshl_or_b32 v88, v5, 11, v88
    s_bfe_u32 s71, s58, 0x20000
    s_lshl_b32 s71, s71, 6
    s_bfe_u32 s72, s58, 0x10002
    s_lshl_b32 s72, s72, 16
    s_or_b32 s71, s71, s72
    s_bfe_u32 s72, s58, 0x10002
    s_lshl_b32 s72, s72, 5
    s_or_b32 s71, s71, s72
    v_xor_b32 v88, s71, v88
    v_xor_b32 v89, 32, v88
    v_lshl_add_u32 v96, v1, 4, s70
    s_lshl_b32 s71, s75, 16
    s_add_u32 s81, s81, s71
    s_bfe_u32 s68, s57, 0x10000
    s_lshl_b32 s68, s68, 9
    s_mov_b32 s2, 2048
    s_mov_b32 s3, 65536
    s_mov_b32 s4, 262144
    s_mov_b32 s5, 1
    s_lshl_b32 s71, s58, 2
    s_bfe_u32 s72, s71, 0x30000
    s_bfe_u32 s73, s71, 0x10003
    s_lshl_b32 s73, s73, 4
    s_or_b32 s72, s72, s73
    s_bfe_u32 s73, s71, 0x10004
    s_lshl_b32 s73, s73, 3
    s_or_b32 s72, s72, s73
    s_mul_i32 s72, s72, s2
    v_mov_b32 v4, s72
    s_and_b32 s71, s71, 12
    v_xor_b32 v5, s71, v1
    v_bfe_u32 v84, v5, 0, 5
    v_lshlrev_b32 v84, 4, v84
    v_bfe_u32 v6, v5, 5, 1
    v_lshl_or_b32 v84, v6, 10, v84
    s_sub_u32 s72, s2, 1024
    v_add_u32 v84, v84, v4
    v_xor_b32 v85, 16, v84
    v_add_u32 v85, s72, v85
    v_xor_b32 v86, 48, v85
    v_add_u32 v86, s72, v86
    v_xor_b32 v87, 16, v86
    v_add_u32 v87, s72, v87
    s_xor_b32 s69, s68, 512
    s_lshl_b32 s70, s58, 12
    s_waitcnt vmcnt(17)
    s_barrier
    ds_read_b64_tr_b16 v[128:129], v88 offset:0
    ds_read_b64_tr_b16 v[130:131], v88 offset:1024
    ds_read_b64_tr_b16 v[132:133], v89 offset:0
    ds_read_b64_tr_b16 v[134:135], v89 offset:1024
    ds_read_b64_tr_b16 v[136:137], v88 offset:8192
    ds_read_b64_tr_b16 v[138:139], v88 offset:9216
    ds_read_b64_tr_b16 v[140:141], v89 offset:8192
    ds_read_b64_tr_b16 v[142:143], v89 offset:9216
    s_waitcnt lgkmcnt(4)
    ds_read_b64_tr_b16 v[144:145], v88 offset:16384
    ds_read_b64_tr_b16 v[146:147], v88 offset:17408
    ds_read_b64_tr_b16 v[148:149], v89 offset:16384
    ds_read_b64_tr_b16 v[150:151], v89 offset:17408
    ds_read_b64_tr_b16 v[152:153], v88 offset:24576
    ds_read_b64_tr_b16 v[154:155], v88 offset:25600
    ds_read_b64_tr_b16 v[156:157], v89 offset:24576
    ds_read_b64_tr_b16 v[158:159], v89 offset:25600
    s_waitcnt lgkmcnt(4)
    ds_read_b64_tr_b16 v[160:161], v88 offset:32768
    ds_read_b64_tr_b16 v[162:163], v88 offset:33792
    ds_read_b64_tr_b16 v[164:165], v89 offset:32768
    ds_read_b64_tr_b16 v[166:167], v89 offset:33792
    ds_read_b64_tr_b16 v[168:169], v88 offset:40960
    ds_read_b64_tr_b16 v[170:171], v88 offset:41984
    ds_read_b64_tr_b16 v[172:173], v89 offset:40960
    ds_read_b64_tr_b16 v[174:175], v89 offset:41984
    s_waitcnt lgkmcnt(4)
    ds_read_b64_tr_b16 v[176:177], v88 offset:49152
    ds_read_b64_tr_b16 v[178:179], v88 offset:50176
    ds_read_b64_tr_b16 v[180:181], v89 offset:49152
    ds_read_b64_tr_b16 v[182:183], v89 offset:50176
    ds_read_b64_tr_b16 v[184:185], v88 offset:57344
    ds_read_b64_tr_b16 v[186:187], v88 offset:58368
    ds_read_b64_tr_b16 v[188:189], v89 offset:57344
    ds_read_b64_tr_b16 v[190:191], v89 offset:58368
    s_waitcnt lgkmcnt(0)
    s_barrier
    buffer_load_dwordx4 v[20:23], v84, s[60:63], s68 offen offset:0
    buffer_load_dwordx4 v[24:27], v85, s[60:63], s68 offen offset:1024
    buffer_load_dwordx4 v[28:31], v86, s[60:63], s68 offen offset:2048
    buffer_load_dwordx4 v[32:35], v87, s[60:63], s68 offen offset:3072
    s_add_u32 s68, s68, s3
    buffer_load_dwordx4 v[36:39], v84, s[60:63], s69 offen offset:0
    buffer_load_dwordx4 v[40:43], v85, s[60:63], s69 offen offset:1024
    buffer_load_dwordx4 v[44:47], v86, s[60:63], s69 offen offset:2048
    buffer_load_dwordx4 v[48:51], v87, s[60:63], s69 offen offset:3072
    s_add_u32 s69, s69, s3
    buffer_load_dwordx4 v[52:55], v84, s[60:63], s68 offen offset:0
    buffer_load_dwordx4 v[56:59], v85, s[60:63], s68 offen offset:1024
    buffer_load_dwordx4 v[60:63], v86, s[60:63], s68 offen offset:2048
    buffer_load_dwordx4 v[64:67], v87, s[60:63], s68 offen offset:3072
    s_add_u32 s68, s68, s3
    s_waitcnt vmcnt(28)
    ds_write_b128 v96, v[192:195] offset:0
    s_waitcnt vmcnt(27)
    ds_write_b128 v96, v[196:199] offset:1024
    s_waitcnt vmcnt(26)
    ds_write_b128 v96, v[200:203] offset:2048
    s_waitcnt vmcnt(25)
    ds_write_b128 v96, v[204:207] offset:3072
    s_waitcnt vmcnt(24)
    ds_write_b128 v96, v[208:211] offset:4096
    s_waitcnt vmcnt(23)
    ds_write_b128 v96, v[212:215] offset:5120
    s_waitcnt vmcnt(22)
    ds_write_b128 v96, v[216:219] offset:6144
    s_waitcnt vmcnt(21)
    ds_write_b128 v96, v[220:223] offset:7168
    s_waitcnt vmcnt(20)
    ds_write_b128 v96, v[224:227] offset:8192
    s_waitcnt vmcnt(19)
    ds_write_b128 v96, v[228:231] offset:9216
    s_waitcnt vmcnt(18)
    ds_write_b128 v96, v[232:235] offset:10240
    s_waitcnt vmcnt(17)
    ds_write_b128 v96, v[236:239] offset:11264
    s_waitcnt vmcnt(16)
    ds_write_b128 v96, v[240:243] offset:12288
    s_waitcnt vmcnt(15)
    ds_write_b128 v96, v[244:247] offset:13312
    s_waitcnt vmcnt(14)
    ds_write_b128 v96, v[248:251] offset:14336
    s_waitcnt vmcnt(13)
    ds_write_b128 v96, v[252:255] offset:15360
    s_waitcnt lgkmcnt(0)
    s_barrier
    ds_read_b64_tr_b16 v[192:193], v88 offset:0
    ds_read_b64_tr_b16 v[194:195], v88 offset:1024
    ds_read_b64_tr_b16 v[196:197], v89 offset:0
    ds_read_b64_tr_b16 v[198:199], v89 offset:1024
    ds_read_b64_tr_b16 v[200:201], v88 offset:8192
    ds_read_b64_tr_b16 v[202:203], v88 offset:9216
    ds_read_b64_tr_b16 v[204:205], v89 offset:8192
    ds_read_b64_tr_b16 v[206:207], v89 offset:9216
    s_waitcnt lgkmcnt(4)
    ds_read_b64_tr_b16 v[208:209], v88 offset:16384
    ds_read_b64_tr_b16 v[210:211], v88 offset:17408
    ds_read_b64_tr_b16 v[212:213], v89 offset:16384
    ds_read_b64_tr_b16 v[214:215], v89 offset:17408
    ds_read_b64_tr_b16 v[216:217], v88 offset:24576
    ds_read_b64_tr_b16 v[218:219], v88 offset:25600
    ds_read_b64_tr_b16 v[220:221], v89 offset:24576
    ds_read_b64_tr_b16 v[222:223], v89 offset:25600
    s_waitcnt lgkmcnt(4)
    ds_read_b64_tr_b16 v[224:225], v88 offset:32768
    ds_read_b64_tr_b16 v[226:227], v88 offset:33792
    ds_read_b64_tr_b16 v[228:229], v89 offset:32768
    ds_read_b64_tr_b16 v[230:231], v89 offset:33792
    ds_read_b64_tr_b16 v[232:233], v88 offset:40960
    ds_read_b64_tr_b16 v[234:235], v88 offset:41984
    ds_read_b64_tr_b16 v[236:237], v89 offset:40960
    ds_read_b64_tr_b16 v[238:239], v89 offset:41984
    s_waitcnt lgkmcnt(4)
    ds_read_b64_tr_b16 v[240:241], v88 offset:49152
    ds_read_b64_tr_b16 v[242:243], v88 offset:50176
    ds_read_b64_tr_b16 v[244:245], v89 offset:49152
    ds_read_b64_tr_b16 v[246:247], v89 offset:50176
    ds_read_b64_tr_b16 v[248:249], v88 offset:57344
    ds_read_b64_tr_b16 v[250:251], v88 offset:58368
    ds_read_b64_tr_b16 v[252:253], v89 offset:57344
    ds_read_b64_tr_b16 v[254:255], v89 offset:58368
    s_waitcnt lgkmcnt(0)
    s_barrier
    v_lshl_add_u32 v96, v1, 4, s70
    v_add_u32 v97, 0x10000, v96
    s_waitcnt vmcnt(11)
    ds_write_b128 v96, v[20:23] offset:0
    s_waitcnt vmcnt(10)
    ds_write_b128 v96, v[24:27] offset:1024
    s_waitcnt vmcnt(9)
    ds_write_b128 v96, v[28:31] offset:2048
    s_waitcnt vmcnt(8)
    ds_write_b128 v96, v[32:35] offset:3072
    s_waitcnt vmcnt(7)
    ds_write_b128 v96, v[36:39] offset:32768
    s_waitcnt vmcnt(6)
    ds_write_b128 v96, v[40:43] offset:33792
    s_waitcnt vmcnt(5)
    ds_write_b128 v96, v[44:47] offset:34816
    s_waitcnt vmcnt(4)
    ds_write_b128 v96, v[48:51] offset:35840
    s_waitcnt vmcnt(3)
    ds_write_b128 v97, v[52:55] offset:0
    s_waitcnt vmcnt(2)
    ds_write_b128 v97, v[56:59] offset:1024
    s_waitcnt vmcnt(1)
    ds_write_b128 v97, v[60:63] offset:2048
    s_waitcnt vmcnt(0)
    ds_write_b128 v97, v[64:67] offset:3072
    buffer_load_dword v99, off, s[12:15], s70 offset:32 sc1
    s_branch sgo_77
gen_62:
    s_mov_b32 s2, 131072
    s_mov_b32 s3, 2048
    s_mov_b32 s4, 65536
    s_mov_b32 s5, 7
    s_lshl_b32 s71, s75, 20
    s_add_u32 s81, s81, s71
    s_bfe_u32 s68, s57, 0x10000
    s_lshl_b32 s68, s68, 9
    s_lshl_b32 s71, s75, 15
    s_add_u32 s68, s68, s71
    s_bfe_u32 s71, s57, 0x30000
    s_lshl_b32 s71, s71, 7
    s_bfe_u32 s72, s58, 0x20000
    s_lshl_b32 s72, s72, 5
    s_bfe_u32 s73, s58, 0x10002
    s_lshl_b32 s73, s73, 4
    s_or_b32 s72, s72, s73
    s_or_b32 s71, s71, s72
    v_and_or_b32 v4, v1, 15, s71
    v_mov_b32 v6, 1024
    v_cmp_eq_u32 vcc, 1, v4
    s_nop 1
    v_cndmask_b32 v5, v4, v6, vcc
    v_and_b32 v54, 1, v5
    v_lshrrev_b32 v5, 1, v5
    v_cvt_f32_u32 v54, v54
    v_cvt_f32_u32 v5, v5
    v_mul_f32 v54, 0x3e800000, v54
    v_mul_f32 v52, 0x3a800000, v5
    v_xor_b32 v4, 16, v4
    v_cmp_eq_u32 vcc, 1, v4
    s_nop 1
    v_cndmask_b32 v5, v4, v6, vcc
    v_and_b32 v55, 1, v5
    v_lshrrev_b32 v5, 1, v5
    v_cvt_f32_u32 v55, v55
    v_cvt_f32_u32 v5, v5
    v_mul_f32 v55, 0x3e800000, v55
    v_mul_f32 v53, 0x3a800000, v5
    v_xor_b32 v4, 16, v4
    v_bfe_u32 v4, v1, 4, 2
    v_lshlrev_b32 v4, 3, v4
    s_bfe_u32 s71, s58, 0x10002
    s_lshl_b32 s71, s71, 9
    s_bfe_u32 s72, s57, 0x10000
    s_lshl_b32 s72, s72, 8
    s_or_b32 s71, s71, s72
    v_or_b32 v4, s71, v4
    v_cvt_f32_u32 v56, v4
    v_xor_b32 v4, 0x100, v4
    v_fma_f32 v60, v52, v56, v54
    v_fract_f32 v60, v60
    v_add_f32 v61, v60, v52
    v_add_f32 v62, v61, v52
    v_add_f32 v63, v62, v52
    v_add_f32 v64, v63, v52
    v_add_f32 v65, v64, v52
    v_add_f32 v66, v65, v52
    v_add_f32 v67, v66, v52
    v_cos_f32 v60, v60
    v_cos_f32 v61, v61
    v_cos_f32 v62, v62
    v_cos_f32 v63, v63
    v_cos_f32 v64, v64
    v_cos_f32 v65, v65
    v_cos_f32 v66, v66
    v_cos_f32 v67, v67
    v_cvt_pk_bf16_f32 v128, v60, v61
    v_cvt_pk_bf16_f32 v129, v62, v63
    v_cvt_pk_bf16_f32 v130, v64, v65
    v_cvt_pk_bf16_f32 v131, v66, v67
    v_fma_f32 v68, v53, v56, v55
    v_fract_f32 v68, v68
    v_add_f32 v69, v68, v53
    v_add_f32 v70, v69, v53
    v_add_f32 v71, v70, v53
    v_add_f32 v72, v71, v53
    v_add_f32 v73, v72, v53
    v_add_f32 v74, v73, v53
    v_add_f32 v75, v74, v53
    v_cos_f32 v68, v68
    v_cos_f32 v69, v69
    v_cos_f32 v70, v70
    v_cos_f32 v71, v71
    v_cos_f32 v72, v72
    v_cos_f32 v73, v73
    v_cos_f32 v74, v74
    v_cos_f32 v75, v75
    v_cvt_pk_bf16_f32 v132, v68, v69
    v_cvt_pk_bf16_f32 v133, v70, v71
    v_cvt_pk_bf16_f32 v134, v72, v73
    v_cvt_pk_bf16_f32 v135, v74, v75
    v_add_f32 v56, 0x42000000, v56
    v_fma_f32 v60, v52, v56, v54
    v_fract_f32 v60, v60
    v_add_f32 v61, v60, v52
    v_add_f32 v62, v61, v52
    v_add_f32 v63, v62, v52
    v_add_f32 v64, v63, v52
    v_add_f32 v65, v64, v52
    v_add_f32 v66, v65, v52
    v_add_f32 v67, v66, v52
    v_cos_f32 v60, v60
    v_cos_f32 v61, v61
    v_cos_f32 v62, v62
    v_cos_f32 v63, v63
    v_cos_f32 v64, v64
    v_cos_f32 v65, v65
    v_cos_f32 v66, v66
    v_cos_f32 v67, v67
    v_cvt_pk_bf16_f32 v136, v60, v61
    v_cvt_pk_bf16_f32 v137, v62, v63
    v_cvt_pk_bf16_f32 v138, v64, v65
    v_cvt_pk_bf16_f32 v139, v66, v67
    v_fma_f32 v68, v53, v56, v55
    v_fract_f32 v68, v68
    v_add_f32 v69, v68, v53
    v_add_f32 v70, v69, v53
    v_add_f32 v71, v70, v53
    v_add_f32 v72, v71, v53
    v_add_f32 v73, v72, v53
    v_add_f32 v74, v73, v53
    v_add_f32 v75, v74, v53
    v_cos_f32 v68, v68
    v_cos_f32 v69, v69
    v_cos_f32 v70, v70
    v_cos_f32 v71, v71
    v_cos_f32 v72, v72
    v_cos_f32 v73, v73
    v_cos_f32 v74, v74
    v_cos_f32 v75, v75
    v_cvt_pk_bf16_f32 v140, v68, v69
    v_cvt_pk_bf16_f32 v141, v70, v71
    v_cvt_pk_bf16_f32 v142, v72, v73
    v_cvt_pk_bf16_f32 v143, v74, v75
    v_add_f32 v56, 0x42000000, v56
    v_fma_f32 v60, v52, v56, v54
    v_fract_f32 v60, v60
    v_add_f32 v61, v60, v52
    v_add_f32 v62, v61, v52
    v_add_f32 v63, v62, v52
    v_add_f32 v64, v63, v52
    v_add_f32 v65, v64, v52
    v_add_f32 v66, v65, v52
    v_add_f32 v67, v66, v52
    v_cos_f32 v60, v60
    v_cos_f32 v61, v61
    v_cos_f32 v62, v62
    v_cos_f32 v63, v63
    v_cos_f32 v64, v64
    v_cos_f32 v65, v65
    v_cos_f32 v66, v66
    v_cos_f32 v67, v67
    v_cvt_pk_bf16_f32 v144, v60, v61
    v_cvt_pk_bf16_f32 v145, v62, v63
    v_cvt_pk_bf16_f32 v146, v64, v65
    v_cvt_pk_bf16_f32 v147, v66, v67
    v_fma_f32 v68, v53, v56, v55
    v_fract_f32 v68, v68
    v_add_f32 v69, v68, v53
    v_add_f32 v70, v69, v53
    v_add_f32 v71, v70, v53
    v_add_f32 v72, v71, v53
    v_add_f32 v73, v72, v53
    v_add_f32 v74, v73, v53
    v_add_f32 v75, v74, v53
    v_cos_f32 v68, v68
    v_cos_f32 v69, v69
    v_cos_f32 v70, v70
    v_cos_f32 v71, v71
    v_cos_f32 v72, v72
    v_cos_f32 v73, v73
    v_cos_f32 v74, v74
    v_cos_f32 v75, v75
    v_cvt_pk_bf16_f32 v148, v68, v69
    v_cvt_pk_bf16_f32 v149, v70, v71
    v_cvt_pk_bf16_f32 v150, v72, v73
    v_cvt_pk_bf16_f32 v151, v74, v75
    v_add_f32 v56, 0x42000000, v56
    v_fma_f32 v60, v52, v56, v54
    v_fract_f32 v60, v60
    v_add_f32 v61, v60, v52
    v_add_f32 v62, v61, v52
    v_add_f32 v63, v62, v52
    v_add_f32 v64, v63, v52
    v_add_f32 v65, v64, v52
    v_add_f32 v66, v65, v52
    v_add_f32 v67, v66, v52
    v_cos_f32 v60, v60
    v_cos_f32 v61, v61
    v_cos_f32 v62, v62
    v_cos_f32 v63, v63
    v_cos_f32 v64, v64
    v_cos_f32 v65, v65
    v_cos_f32 v66, v66
    v_cos_f32 v67, v67
    v_cvt_pk_bf16_f32 v152, v60, v61
    v_cvt_pk_bf16_f32 v153, v62, v63
    v_cvt_pk_bf16_f32 v154, v64, v65
    v_cvt_pk_bf16_f32 v155, v66, v67
    v_fma_f32 v68, v53, v56, v55
    v_fract_f32 v68, v68
    v_add_f32 v69, v68, v53
    v_add_f32 v70, v69, v53
    v_add_f32 v71, v70, v53
    v_add_f32 v72, v71, v53
    v_add_f32 v73, v72, v53
    v_add_f32 v74, v73, v53
    v_add_f32 v75, v74, v53
    v_cos_f32 v68, v68
    v_cos_f32 v69, v69
    v_cos_f32 v70, v70
    v_cos_f32 v71, v71
    v_cos_f32 v72, v72
    v_cos_f32 v73, v73
    v_cos_f32 v74, v74
    v_cos_f32 v75, v75
    v_cvt_pk_bf16_f32 v156, v68, v69
    v_cvt_pk_bf16_f32 v157, v70, v71
    v_cvt_pk_bf16_f32 v158, v72, v73
    v_cvt_pk_bf16_f32 v159, v74, v75
    v_add_f32 v56, 0x42000000, v56
    v_fma_f32 v60, v52, v56, v54
    v_fract_f32 v60, v60
    v_add_f32 v61, v60, v52
    v_add_f32 v62, v61, v52
    v_add_f32 v63, v62, v52
    v_add_f32 v64, v63, v52
    v_add_f32 v65, v64, v52
    v_add_f32 v66, v65, v52
    v_add_f32 v67, v66, v52
    v_cos_f32 v60, v60
    v_cos_f32 v61, v61
    v_cos_f32 v62, v62
    v_cos_f32 v63, v63
    v_cos_f32 v64, v64
    v_cos_f32 v65, v65
    v_cos_f32 v66, v66
    v_cos_f32 v67, v67
    v_cvt_pk_bf16_f32 v160, v60, v61
    v_cvt_pk_bf16_f32 v161, v62, v63
    v_cvt_pk_bf16_f32 v162, v64, v65
    v_cvt_pk_bf16_f32 v163, v66, v67
    v_fma_f32 v68, v53, v56, v55
    v_fract_f32 v68, v68
    v_add_f32 v69, v68, v53
    v_add_f32 v70, v69, v53
    v_add_f32 v71, v70, v53
    v_add_f32 v72, v71, v53
    v_add_f32 v73, v72, v53
    v_add_f32 v74, v73, v53
    v_add_f32 v75, v74, v53
    v_cos_f32 v68, v68
    v_cos_f32 v69, v69
    v_cos_f32 v70, v70
    v_cos_f32 v71, v71
    v_cos_f32 v72, v72
    v_cos_f32 v73, v73
    v_cos_f32 v74, v74
    v_cos_f32 v75, v75
    v_cvt_pk_bf16_f32 v164, v68, v69
    v_cvt_pk_bf16_f32 v165, v70, v71
    v_cvt_pk_bf16_f32 v166, v72, v73
    v_cvt_pk_bf16_f32 v167, v74, v75
    v_add_f32 v56, 0x42000000, v56
    v_fma_f32 v60, v52, v56, v54
    v_fract_f32 v60, v60
    v_add_f32 v61, v60, v52
    v_add_f32 v62, v61, v52
    v_add_f32 v63, v62, v52
    v_add_f32 v64, v63, v52
    v_add_f32 v65, v64, v52
    v_add_f32 v66, v65, v52
    v_add_f32 v67, v66, v52
    v_cos_f32 v60, v60
    v_cos_f32 v61, v61
    v_cos_f32 v62, v62
    v_cos_f32 v63, v63
    v_cos_f32 v64, v64
    v_cos_f32 v65, v65
    v_cos_f32 v66, v66
    v_cos_f32 v67, v67
    v_cvt_pk_bf16_f32 v168, v60, v61
    v_cvt_pk_bf16_f32 v169, v62, v63
    v_cvt_pk_bf16_f32 v170, v64, v65
    v_cvt_pk_bf16_f32 v171, v66, v67
    v_fma_f32 v68, v53, v56, v55
    v_fract_f32 v68, v68
    v_add_f32 v69, v68, v53
    v_add_f32 v70, v69, v53
    v_add_f32 v71, v70, v53
    v_add_f32 v72, v71, v53
    v_add_f32 v73, v72, v53
    v_add_f32 v74, v73, v53
    v_add_f32 v75, v74, v53
    v_cos_f32 v68, v68
    v_cos_f32 v69, v69
    v_cos_f32 v70, v70
    v_cos_f32 v71, v71
    v_cos_f32 v72, v72
    v_cos_f32 v73, v73
    v_cos_f32 v74, v74
    v_cos_f32 v75, v75
    v_cvt_pk_bf16_f32 v172, v68, v69
    v_cvt_pk_bf16_f32 v173, v70, v71
    v_cvt_pk_bf16_f32 v174, v72, v73
    v_cvt_pk_bf16_f32 v175, v74, v75
    v_add_f32 v56, 0x42000000, v56
    v_fma_f32 v60, v52, v56, v54
    v_fract_f32 v60, v60
    v_add_f32 v61, v60, v52
    v_add_f32 v62, v61, v52
    v_add_f32 v63, v62, v52
    v_add_f32 v64, v63, v52
    v_add_f32 v65, v64, v52
    v_add_f32 v66, v65, v52
    v_add_f32 v67, v66, v52
    v_cos_f32 v60, v60
    v_cos_f32 v61, v61
    v_cos_f32 v62, v62
    v_cos_f32 v63, v63
    v_cos_f32 v64, v64
    v_cos_f32 v65, v65
    v_cos_f32 v66, v66
    v_cos_f32 v67, v67
    v_cvt_pk_bf16_f32 v176, v60, v61
    v_cvt_pk_bf16_f32 v177, v62, v63
    v_cvt_pk_bf16_f32 v178, v64, v65
    v_cvt_pk_bf16_f32 v179, v66, v67
    v_fma_f32 v68, v53, v56, v55
    v_fract_f32 v68, v68
    v_add_f32 v69, v68, v53
    v_add_f32 v70, v69, v53
    v_add_f32 v71, v70, v53
    v_add_f32 v72, v71, v53
    v_add_f32 v73, v72, v53
    v_add_f32 v74, v73, v53
    v_add_f32 v75, v74, v53
    v_cos_f32 v68, v68
    v_cos_f32 v69, v69
    v_cos_f32 v70, v70
    v_cos_f32 v71, v71
    v_cos_f32 v72, v72
    v_cos_f32 v73, v73
    v_cos_f32 v74, v74
    v_cos_f32 v75, v75
    v_cvt_pk_bf16_f32 v180, v68, v69
    v_cvt_pk_bf16_f32 v181, v70, v71
    v_cvt_pk_bf16_f32 v182, v72, v73
    v_cvt_pk_bf16_f32 v183, v74, v75
    v_add_f32 v56, 0x42000000, v56
    v_fma_f32 v60, v52, v56, v54
    v_fract_f32 v60, v60
    v_add_f32 v61, v60, v52
    v_add_f32 v62, v61, v52
    v_add_f32 v63, v62, v52
    v_add_f32 v64, v63, v52
    v_add_f32 v65, v64, v52
    v_add_f32 v66, v65, v52
    v_add_f32 v67, v66, v52
    v_cos_f32 v60, v60
    v_cos_f32 v61, v61
    v_cos_f32 v62, v62
    v_cos_f32 v63, v63
    v_cos_f32 v64, v64
    v_cos_f32 v65, v65
    v_cos_f32 v66, v66
    v_cos_f32 v67, v67
    v_cvt_pk_bf16_f32 v184, v60, v61
    v_cvt_pk_bf16_f32 v185, v62, v63
    v_cvt_pk_bf16_f32 v186, v64, v65
    v_cvt_pk_bf16_f32 v187, v66, v67
    v_fma_f32 v68, v53, v56, v55
    v_fract_f32 v68, v68
    v_add_f32 v69, v68, v53
    v_add_f32 v70, v69, v53
    v_add_f32 v71, v70, v53
    v_add_f32 v72, v71, v53
    v_add_f32 v73, v72, v53
    v_add_f32 v74, v73, v53
    v_add_f32 v75, v74, v53
    v_cos_f32 v68, v68
    v_cos_f32 v69, v69
    v_cos_f32 v70, v70
    v_cos_f32 v71, v71
    v_cos_f32 v72, v72
    v_cos_f32 v73, v73
    v_cos_f32 v74, v74
    v_cos_f32 v75, v75
    v_cvt_pk_bf16_f32 v188, v68, v69
    v_cvt_pk_bf16_f32 v189, v70, v71
    v_cvt_pk_bf16_f32 v190, v72, v73
    v_cvt_pk_bf16_f32 v191, v74, v75
    v_cvt_f32_u32 v56, v4
    v_xor_b32 v4, 0x100, v4
    v_fma_f32 v60, v52, v56, v54
    v_fract_f32 v60, v60
    v_add_f32 v61, v60, v52
    v_add_f32 v62, v61, v52
    v_add_f32 v63, v62, v52
    v_add_f32 v64, v63, v52
    v_add_f32 v65, v64, v52
    v_add_f32 v66, v65, v52
    v_add_f32 v67, v66, v52
    v_cos_f32 v60, v60
    v_cos_f32 v61, v61
    v_cos_f32 v62, v62
    v_cos_f32 v63, v63
    v_cos_f32 v64, v64
    v_cos_f32 v65, v65
    v_cos_f32 v66, v66
    v_cos_f32 v67, v67
    v_cvt_pk_bf16_f32 v192, v60, v61
    v_cvt_pk_bf16_f32 v193, v62, v63
    v_cvt_pk_bf16_f32 v194, v64, v65
    v_cvt_pk_bf16_f32 v195, v66, v67
    v_fma_f32 v68, v53, v56, v55
    v_fract_f32 v68, v68
    v_add_f32 v69, v68, v53
    v_add_f32 v70, v69, v53
    v_add_f32 v71, v70, v53
    v_add_f32 v72, v71, v53
    v_add_f32 v73, v72, v53
    v_add_f32 v74, v73, v53
    v_add_f32 v75, v74, v53
    v_cos_f32 v68, v68
    v_cos_f32 v69, v69
    v_cos_f32 v70, v70
    v_cos_f32 v71, v71
    v_cos_f32 v72, v72
    v_cos_f32 v73, v73
    v_cos_f32 v74, v74
    v_cos_f32 v75, v75
    v_cvt_pk_bf16_f32 v196, v68, v69
    v_cvt_pk_bf16_f32 v197, v70, v71
    v_cvt_pk_bf16_f32 v198, v72, v73
    v_cvt_pk_bf16_f32 v199, v74, v75
    v_add_f32 v56, 0x42000000, v56
    v_fma_f32 v60, v52, v56, v54
    v_fract_f32 v60, v60
    v_add_f32 v61, v60, v52
    v_add_f32 v62, v61, v52
    v_add_f32 v63, v62, v52
    v_add_f32 v64, v63, v52
    v_add_f32 v65, v64, v52
    v_add_f32 v66, v65, v52
    v_add_f32 v67, v66, v52
    v_cos_f32 v60, v60
    v_cos_f32 v61, v61
    v_cos_f32 v62, v62
    v_cos_f32 v63, v63
    v_cos_f32 v64, v64
    v_cos_f32 v65, v65
    v_cos_f32 v66, v66
    v_cos_f32 v67, v67
    v_cvt_pk_bf16_f32 v200, v60, v61
    v_cvt_pk_bf16_f32 v201, v62, v63
    v_cvt_pk_bf16_f32 v202, v64, v65
    v_cvt_pk_bf16_f32 v203, v66, v67
    v_fma_f32 v68, v53, v56, v55
    v_fract_f32 v68, v68
    v_add_f32 v69, v68, v53
    v_add_f32 v70, v69, v53
    v_add_f32 v71, v70, v53
    v_add_f32 v72, v71, v53
    v_add_f32 v73, v72, v53
    v_add_f32 v74, v73, v53
    v_add_f32 v75, v74, v53
    v_cos_f32 v68, v68
    v_cos_f32 v69, v69
    v_cos_f32 v70, v70
    v_cos_f32 v71, v71
    v_cos_f32 v72, v72
    v_cos_f32 v73, v73
    v_cos_f32 v74, v74
    v_cos_f32 v75, v75
    v_cvt_pk_bf16_f32 v204, v68, v69
    v_cvt_pk_bf16_f32 v205, v70, v71
    v_cvt_pk_bf16_f32 v206, v72, v73
    v_cvt_pk_bf16_f32 v207, v74, v75
    v_add_f32 v56, 0x42000000, v56
    v_fma_f32 v60, v52, v56, v54
    v_fract_f32 v60, v60
    v_add_f32 v61, v60, v52
    v_add_f32 v62, v61, v52
    v_add_f32 v63, v62, v52
    v_add_f32 v64, v63, v52
    v_add_f32 v65, v64, v52
    v_add_f32 v66, v65, v52
    v_add_f32 v67, v66, v52
    v_cos_f32 v60, v60
    v_cos_f32 v61, v61
    v_cos_f32 v62, v62
    v_cos_f32 v63, v63
    v_cos_f32 v64, v64
    v_cos_f32 v65, v65
    v_cos_f32 v66, v66
    v_cos_f32 v67, v67
    v_cvt_pk_bf16_f32 v208, v60, v61
    v_cvt_pk_bf16_f32 v209, v62, v63
    v_cvt_pk_bf16_f32 v210, v64, v65
    v_cvt_pk_bf16_f32 v211, v66, v67
    v_fma_f32 v68, v53, v56, v55
    v_fract_f32 v68, v68
    v_add_f32 v69, v68, v53
    v_add_f32 v70, v69, v53
    v_add_f32 v71, v70, v53
    v_add_f32 v72, v71, v53
    v_add_f32 v73, v72, v53
    v_add_f32 v74, v73, v53
    v_add_f32 v75, v74, v53
    v_cos_f32 v68, v68
    v_cos_f32 v69, v69
    v_cos_f32 v70, v70
    v_cos_f32 v71, v71
    v_cos_f32 v72, v72
    v_cos_f32 v73, v73
    v_cos_f32 v74, v74
    v_cos_f32 v75, v75
    v_cvt_pk_bf16_f32 v212, v68, v69
    v_cvt_pk_bf16_f32 v213, v70, v71
    v_cvt_pk_bf16_f32 v214, v72, v73
    v_cvt_pk_bf16_f32 v215, v74, v75
    v_add_f32 v56, 0x42000000, v56
    v_fma_f32 v60, v52, v56, v54
    v_fract_f32 v60, v60
    v_add_f32 v61, v60, v52
    v_add_f32 v62, v61, v52
    v_add_f32 v63, v62, v52
    v_add_f32 v64, v63, v52
    v_add_f32 v65, v64, v52
    v_add_f32 v66, v65, v52
    v_add_f32 v67, v66, v52
    v_cos_f32 v60, v60
    v_cos_f32 v61, v61
    v_cos_f32 v62, v62
    v_cos_f32 v63, v63
    v_cos_f32 v64, v64
    v_cos_f32 v65, v65
    v_cos_f32 v66, v66
    v_cos_f32 v67, v67
    v_cvt_pk_bf16_f32 v216, v60, v61
    v_cvt_pk_bf16_f32 v217, v62, v63
    v_cvt_pk_bf16_f32 v218, v64, v65
    v_cvt_pk_bf16_f32 v219, v66, v67
    v_fma_f32 v68, v53, v56, v55
    v_fract_f32 v68, v68
    v_add_f32 v69, v68, v53
    v_add_f32 v70, v69, v53
    v_add_f32 v71, v70, v53
    v_add_f32 v72, v71, v53
    v_add_f32 v73, v72, v53
    v_add_f32 v74, v73, v53
    v_add_f32 v75, v74, v53
    v_cos_f32 v68, v68
    v_cos_f32 v69, v69
    v_cos_f32 v70, v70
    v_cos_f32 v71, v71
    v_cos_f32 v72, v72
    v_cos_f32 v73, v73
    v_cos_f32 v74, v74
    v_cos_f32 v75, v75
    v_cvt_pk_bf16_f32 v220, v68, v69
    v_cvt_pk_bf16_f32 v221, v70, v71
    v_cvt_pk_bf16_f32 v222, v72, v73
    v_cvt_pk_bf16_f32 v223, v74, v75
    v_add_f32 v56, 0x42000000, v56
    v_fma_f32 v60, v52, v56, v54
    v_fract_f32 v60, v60
    v_add_f32 v61, v60, v52
    v_add_f32 v62, v61, v52
    v_add_f32 v63, v62, v52
    v_add_f32 v64, v63, v52
    v_add_f32 v65, v64, v52
    v_add_f32 v66, v65, v52
    v_add_f32 v67, v66, v52
    v_cos_f32 v60, v60
    v_cos_f32 v61, v61
    v_cos_f32 v62, v62
    v_cos_f32 v63, v63
    v_cos_f32 v64, v64
    v_cos_f32 v65, v65
    v_cos_f32 v66, v66
    v_cos_f32 v67, v67
    v_cvt_pk_bf16_f32 v224, v60, v61
    v_cvt_pk_bf16_f32 v225, v62, v63
    v_cvt_pk_bf16_f32 v226, v64, v65
    v_cvt_pk_bf16_f32 v227, v66, v67
    v_fma_f32 v68, v53, v56, v55
    v_fract_f32 v68, v68
    v_add_f32 v69, v68, v53
    v_add_f32 v70, v69, v53
    v_add_f32 v71, v70, v53
    v_add_f32 v72, v71, v53
    v_add_f32 v73, v72, v53
    v_add_f32 v74, v73, v53
    v_add_f32 v75, v74, v53
    v_cos_f32 v68, v68
    v_cos_f32 v69, v69
    v_cos_f32 v70, v70
    v_cos_f32 v71, v71
    v_cos_f32 v72, v72
    v_cos_f32 v73, v73
    v_cos_f32 v74, v74
    v_cos_f32 v75, v75
    v_cvt_pk_bf16_f32 v228, v68, v69
    v_cvt_pk_bf16_f32 v229, v70, v71
    v_cvt_pk_bf16_f32 v230, v72, v73
    v_cvt_pk_bf16_f32 v231, v74, v75
    v_add_f32 v56, 0x42000000, v56
    v_fma_f32 v60, v52, v56, v54
    v_fract_f32 v60, v60
    v_add_f32 v61, v60, v52
    v_add_f32 v62, v61, v52
    v_add_f32 v63, v62, v52
    v_add_f32 v64, v63, v52
    v_add_f32 v65, v64, v52
    v_add_f32 v66, v65, v52
    v_add_f32 v67, v66, v52
    v_cos_f32 v60, v60
    v_cos_f32 v61, v61
    v_cos_f32 v62, v62
    v_cos_f32 v63, v63
    v_cos_f32 v64, v64
    v_cos_f32 v65, v65
    v_cos_f32 v66, v66
    v_cos_f32 v67, v67
    v_cvt_pk_bf16_f32 v232, v60, v61
    v_cvt_pk_bf16_f32 v233, v62, v63
    v_cvt_pk_bf16_f32 v234, v64, v65
    v_cvt_pk_bf16_f32 v235, v66, v67
    v_fma_f32 v68, v53, v56, v55
    v_fract_f32 v68, v68
    v_add_f32 v69, v68, v53
    v_add_f32 v70, v69, v53
    v_add_f32 v71, v70, v53
    v_add_f32 v72, v71, v53
    v_add_f32 v73, v72, v53
    v_add_f32 v74, v73, v53
    v_add_f32 v75, v74, v53
    v_cos_f32 v68, v68
    v_cos_f32 v69, v69
    v_cos_f32 v70, v70
    v_cos_f32 v71, v71
    v_cos_f32 v72, v72
    v_cos_f32 v73, v73
    v_cos_f32 v74, v74
    v_cos_f32 v75, v75
    v_cvt_pk_bf16_f32 v236, v68, v69
    v_cvt_pk_bf16_f32 v237, v70, v71
    v_cvt_pk_bf16_f32 v238, v72, v73
    v_cvt_pk_bf16_f32 v239, v74, v75
    v_add_f32 v56, 0x42000000, v56
    v_fma_f32 v60, v52, v56, v54
    v_fract_f32 v60, v60
    v_add_f32 v61, v60, v52
    v_add_f32 v62, v61, v52
    v_add_f32 v63, v62, v52
    v_add_f32 v64, v63, v52
    v_add_f32 v65, v64, v52
    v_add_f32 v66, v65, v52
    v_add_f32 v67, v66, v52
    v_cos_f32 v60, v60
    v_cos_f32 v61, v61
    v_cos_f32 v62, v62
    v_cos_f32 v63, v63
    v_cos_f32 v64, v64
    v_cos_f32 v65, v65
    v_cos_f32 v66, v66
    v_cos_f32 v67, v67
    v_cvt_pk_bf16_f32 v240, v60, v61
    v_cvt_pk_bf16_f32 v241, v62, v63
    v_cvt_pk_bf16_f32 v242, v64, v65
    v_cvt_pk_bf16_f32 v243, v66, v67
    v_fma_f32 v68, v53, v56, v55
    v_fract_f32 v68, v68
    v_add_f32 v69, v68, v53
    v_add_f32 v70, v69, v53
    v_add_f32 v71, v70, v53
    v_add_f32 v72, v71, v53
    v_add_f32 v73, v72, v53
    v_add_f32 v74, v73, v53
    v_add_f32 v75, v74, v53
    v_cos_f32 v68, v68
    v_cos_f32 v69, v69
    v_cos_f32 v70, v70
    v_cos_f32 v71, v71
    v_cos_f32 v72, v72
    v_cos_f32 v73, v73
    v_cos_f32 v74, v74
    v_cos_f32 v75, v75
    v_cvt_pk_bf16_f32 v244, v68, v69
    v_cvt_pk_bf16_f32 v245, v70, v71
    v_cvt_pk_bf16_f32 v246, v72, v73
    v_cvt_pk_bf16_f32 v247, v74, v75
    v_add_f32 v56, 0x42000000, v56
    v_fma_f32 v60, v52, v56, v54
    v_fract_f32 v60, v60
    v_add_f32 v61, v60, v52
    v_add_f32 v62, v61, v52
    v_add_f32 v63, v62, v52
    v_add_f32 v64, v63, v52
    v_add_f32 v65, v64, v52
    v_add_f32 v66, v65, v52
    v_add_f32 v67, v66, v52
    v_cos_f32 v60, v60
    v_cos_f32 v61, v61
    v_cos_f32 v62, v62
    v_cos_f32 v63, v63
    v_cos_f32 v64, v64
    v_cos_f32 v65, v65
    v_cos_f32 v66, v66
    v_cos_f32 v67, v67
    v_cvt_pk_bf16_f32 v248, v60, v61
    v_cvt_pk_bf16_f32 v249, v62, v63
    v_cvt_pk_bf16_f32 v250, v64, v65
    v_cvt_pk_bf16_f32 v251, v66, v67
    v_fma_f32 v68, v53, v56, v55
    v_fract_f32 v68, v68
    v_add_f32 v69, v68, v53
    v_add_f32 v70, v69, v53
    v_add_f32 v71, v70, v53
    v_add_f32 v72, v71, v53
    v_add_f32 v73, v72, v53
    v_add_f32 v74, v73, v53
    v_add_f32 v75, v74, v53
    v_cos_f32 v68, v68
    v_cos_f32 v69, v69
    v_cos_f32 v70, v70
    v_cos_f32 v71, v71
    v_cos_f32 v72, v72
    v_cos_f32 v73, v73
    v_cos_f32 v74, v74
    v_cos_f32 v75, v75
    v_cvt_pk_bf16_f32 v252, v68, v69
    v_cvt_pk_bf16_f32 v253, v70, v71
    v_cvt_pk_bf16_f32 v254, v72, v73
    v_cvt_pk_bf16_f32 v255, v74, v75
    s_lshl_b32 s71, s58, 2
    s_bfe_u32 s72, s71, 0x30000
    s_bfe_u32 s73, s71, 0x10003
    s_lshl_b32 s73, s73, 4
    s_or_b32 s72, s72, s73
    s_bfe_u32 s73, s71, 0x10004
    s_lshl_b32 s73, s73, 3
    s_or_b32 s72, s72, s73
    s_mul_i32 s72, s72, s2
    v_mov_b32 v4, s72
    s_and_b32 s71, s71, 12
    v_xor_b32 v5, s71, v1
    v_bfe_u32 v84, v5, 0, 5
    v_lshlrev_b32 v84, 4, v84
    v_bfe_u32 v6, v5, 5, 1
    v_lshl_or_b32 v84, v6, 10, v84
    s_sub_u32 s72, s2, 1024
    v_add_u32 v84, v84, v4
    v_xor_b32 v85, 16, v84
    v_add_u32 v85, s72, v85
    v_xor_b32 v86, 48, v85
    v_add_u32 v86, s72, v86
    v_xor_b32 v87, 16, v86
    v_add_u32 v87, s72, v87
    s_xor_b32 s69, s68, 512
    s_lshl_b32 s70, s58, 12
    s_add_u32 m0, s70, 0
    s_nop 0
    buffer_load_dwordx4 v84, s[60:63], s68 offen offset:0 lds
    buffer_load_dwordx4 v85, s[60:63], s68 offen offset:1024 lds
    buffer_load_dwordx4 v86, s[60:63], s68 offen offset:2048 lds
    buffer_load_dwordx4 v87, s[60:63], s68 offen offset:3072 lds
    s_add_u32 s68, s68, s3
    s_add_u32 m0, s70, 32768
    s_nop 0
    buffer_load_dwordx4 v84, s[60:63], s69 offen offset:0 lds
    buffer_load_dwordx4 v85, s[60:63], s69 offen offset:1024 lds
    buffer_load_dwordx4 v86, s[60:63], s69 offen offset:2048 lds
    buffer_load_dwordx4 v87, s[60:63], s69 offen offset:3072 lds
    s_add_u32 s69, s69, s3
    s_add_u32 m0, s70, 65536
    s_nop 0
    buffer_load_dwordx4 v84, s[60:63], s68 offen offset:0 lds
    buffer_load_dwordx4 v85, s[60:63], s68 offen offset:1024 lds
    buffer_load_dwordx4 v86, s[60:63], s68 offen offset:2048 lds
    buffer_load_dwordx4 v87, s[60:63], s68 offen offset:3072 lds
    s_add_u32 s68, s68, s3
sgo_77:
    v_lshrrev_b32 v4, 4, v1
    v_xor_b32 v4, v4, v1
    v_bfe_u32 v5, v4, 0, 4
    v_lshlrev_b32 v5, 4, v5
    v_bfe_u32 v4, v1, 0, 4
    v_lshlrev_b32 v4, 10, v4
    s_bfe_u32 s71, s58, 0x10002
    s_lshl_b32 s71, s71, 9
    v_or3_b32 v88, v4, v5, s71
    v_xor_b32 v89, 0x40, v88
    v_xor_b32 v90, 0x80, v88
    v_xor_b32 v91, 0xc0, v88
    v_xor_b32 v92, 0x10000, v88
    v_xor_b32 v93, 0x10040, v88
    v_xor_b32 v94, 0x10080, v88
    v_xor_b32 v95, 0x100c0, v88
    s_lshl_b32 s71, s58, 11
    s_or_b32 s71, s71, 131072
    v_lshl_add_u32 v96, v1, 4, s71
    v_xor_b32 v97, 0x2000, v96
    v_bfe_u32 v98, v1, 0, 4
    v_lshlrev_b32 v98, 4, v98
    v_bfe_u32 v4, v1, 4, 2
    v_lshl_or_b32 v98, v4, 9, v98
    s_bfe_u32 s71, s57, 0x30000
    s_lshl_b32 s71, s71, 13
    s_add_u32 s81, s81, s71
    s_bfe_u32 s71, s58, 0x20000
    s_lshl_b32 s71, s71, 11
    s_bfe_u32 s72, s58, 0x10002
    s_lshl_b32 s72, s72, 8
    s_or_b32 s71, s71, s72
    s_add_u32 s81, s81, s71
    s_mov_b32 s73, 0x5ffffff0
    s_mov_b32 s82, 0
    s_waitcnt vmcnt(8) lgkmcnt(0)
    s_barrier
    ds_read_b128 v[52:55], v88 offset:0
    ds_read_b128 v[56:59], v88 offset:16384
    ds_read_b128 v[60:63], v89 offset:0
    ds_read_b128 v[64:67], v89 offset:16384
    v_mov_b32 v100, 3
    v_cmp_gt_u32 vcc, s58, v100
stream_78:
    s_waitcnt lgkmcnt(2)
    v_mfma_f32_16x16x32_bf16 v[20:23], v[52:55], v[128:131], 0
    ds_read_b128 v[68:71], v90 offset:0
    v_mfma_f32_16x16x32_bf16 v[24:27], v[52:55], v[132:135], 0
    ds_read_b128 v[72:75], v90 offset:16384
    v_mfma_f32_16x16x32_bf16 v[28:31], v[56:59], v[128:131], 0
    s_add_u32 m0, s70, 98304
    s_nop 0
    buffer_load_dwordx4 v84, s[60:63], s69 offen offset:0 lds
    v_mfma_f32_16x16x32_bf16 v[32:35], v[56:59], v[132:135], 0
    s_waitcnt lgkmcnt(2)
    v_mfma_f32_16x16x32_bf16 v[20:23], v[60:63], v[136:139], v[20:23]
    ds_read_b128 v[76:79], v91 offset:0
    v_mfma_f32_16x16x32_bf16 v[24:27], v[60:63], v[140:143], v[24:27]
    ds_read_b128 v[80:83], v91 offset:16384
    v_mfma_f32_16x16x32_bf16 v[28:31], v[64:67], v[136:139], v[28:31]
    buffer_load_dwordx4 v85, s[60:63], s69 offen offset:1024 lds
    v_mfma_f32_16x16x32_bf16 v[32:35], v[64:67], v[140:143], v[32:35]
    ds_write_b128 v96, v[40:43] offset:0
    s_waitcnt lgkmcnt(3)
    v_mfma_f32_16x16x32_bf16 v[20:23], v[68:71], v[144:147], v[20:23]
    ds_read_b128 v[52:55], v88 offset:256
    v_mfma_f32_16x16x32_bf16 v[24:27], v[68:71], v[148:151], v[24:27]
    ds_read_b128 v[56:59], v88 offset:16640
    v_mfma_f32_16x16x32_bf16 v[28:31], v[72:75], v[144:147], v[28:31]
    buffer_load_dwordx4 v86, s[60:63], s69 offen offset:2048 lds
    v_mfma_f32_16x16x32_bf16 v[32:35], v[72:75], v[148:151], v[32:35]
    ds_write_b128 v96, v[48:51] offset:1024
    s_waitcnt lgkmcnt(4)
    v_mfma_f32_16x16x32_bf16 v[20:23], v[76:79], v[152:155], v[20:23]
    ds_read_b128 v[60:63], v89 offset:256
    v_mfma_f32_16x16x32_bf16 v[24:27], v[76:79], v[156:159], v[24:27]
    ds_read_b128 v[64:67], v89 offset:16640
    v_mfma_f32_16x16x32_bf16 v[28:31], v[80:83], v[152:155], v[28:31]
    buffer_load_dwordx4 v87, s[60:63], s69 offen offset:3072 lds
    s_add_u32 s69, s69, s3
    v_mfma_f32_16x16x32_bf16 v[32:35], v[80:83], v[156:159], v[32:35]
    s_waitcnt lgkmcnt(3)
    v_mfma_f32_16x16x32_bf16 v[20:23], v[52:55], v[160:163], v[20:23]
    ds_read_b128 v[68:71], v90 offset:256
    v_mfma_f32_16x16x32_bf16 v[24:27], v[52:55], v[164:167], v[24:27]
    ds_read_b128 v[72:75], v90 offset:16640
    v_mfma_f32_16x16x32_bf16 v[28:31], v[56:59], v[160:163], v[28:31]
    v_mfma_f32_16x16x32_bf16 v[32:35], v[56:59], v[164:167], v[32:35]
    s_waitcnt lgkmcnt(2)
    v_mfma_f32_16x16x32_bf16 v[20:23], v[60:63], v[168:171], v[20:23]
    ds_read_b128 v[76:79], v91 offset:256
    v_mfma_f32_16x16x32_bf16 v[24:27], v[60:63], v[172:175], v[24:27]
    ds_read_b128 v[80:83], v91 offset:16640
    v_mfma_f32_16x16x32_bf16 v[28:31], v[64:67], v[168:171], v[28:31]
    v_mfma_f32_16x16x32_bf16 v[32:35], v[64:67], v[172:175], v[32:35]
    s_waitcnt vmcnt(8) lgkmcnt(0)
    s_barrier
    v_mfma_f32_16x16x32_bf16 v[20:23], v[68:71], v[176:179], v[20:23]
    ds_read_b128 v[4:7], v97 offset:0
    ds_read_b128 v[8:11], v97 offset:1024
    ds_read_b128 v[52:55], v88 offset:32768
    v_mfma_f32_16x16x32_bf16 v[24:27], v[68:71], v[180:183], v[24:27]
    ds_read_b128 v[56:59], v88 offset:49152
    v_mfma_f32_16x16x32_bf16 v[28:31], v[72:75], v[176:179], v[28:31]
    v_mfma_f32_16x16x32_bf16 v[32:35], v[72:75], v[180:183], v[32:35]
    s_waitcnt lgkmcnt(2)
    v_mfma_f32_16x16x32_bf16 v[20:23], v[76:79], v[184:187], v[20:23]
    v_add_f32 v4, v4, v36
    v_add_f32 v5, v5, v37
    v_add_f32 v6, v6, v38
    v_add_f32 v7, v7, v39
    ds_read_b128 v[60:63], v89 offset:32768
    v_mfma_f32_16x16x32_bf16 v[24:27], v[76:79], v[188:191], v[24:27]
    v_cvt_pk_bf16_f32 v12, v4, v5
    v_cvt_pk_bf16_f32 v13, v6, v7
    ds_read_b128 v[64:67], v89 offset:49152
    v_mfma_f32_16x16x32_bf16 v[28:31], v[80:83], v[184:187], v[28:31]
    v_add_f32 v8, v8, v44
    v_add_f32 v9, v9, v45
    v_add_f32 v10, v10, v46
    v_add_f32 v11, v11, v47
    v_mfma_f32_16x16x32_bf16 v[32:35], v[80:83], v[188:191], v[32:35]
    v_cvt_pk_bf16_f32 v14, v8, v9
    v_cvt_pk_bf16_f32 v15, v10, v11
    buffer_store_dwordx4 v[12:15], v98, s[8:11], s73 offen sc1
    s_mov_b32 s73, s81
    s_add_u32 s81, s81, s4
    s_waitcnt lgkmcnt(2)
    v_mfma_f32_16x16x32_bf16 v[20:23], v[52:55], v[192:195], v[20:23]
    ds_read_b128 v[68:71], v90 offset:32768
    v_mfma_f32_16x16x32_bf16 v[24:27], v[52:55], v[196:199], v[24:27]
    ds_read_b128 v[72:75], v90 offset:49152
    v_mfma_f32_16x16x32_bf16 v[28:31], v[56:59], v[192:195], v[28:31]
    s_add_u32 m0, s70, 0
    s_nop 0
    buffer_load_dwordx4 v84, s[60:63], s68 offen offset:0 lds
    v_mfma_f32_16x16x32_bf16 v[32:35], v[56:59], v[196:199], v[32:35]
    s_waitcnt lgkmcnt(2)
    v_mfma_f32_16x16x32_bf16 v[20:23], v[60:63], v[200:203], v[20:23]
    ds_read_b128 v[76:79], v91 offset:32768
    v_mfma_f32_16x16x32_bf16 v[24:27], v[60:63], v[204:207], v[24:27]
    ds_read_b128 v[80:83], v91 offset:49152
    v_mfma_f32_16x16x32_bf16 v[28:31], v[64:67], v[200:203], v[28:31]
    buffer_load_dwordx4 v85, s[60:63], s68 offen offset:1024 lds
    v_mfma_f32_16x16x32_bf16 v[32:35], v[64:67], v[204:207], v[32:35]
    s_waitcnt lgkmcnt(2)
    v_mfma_f32_16x16x32_bf16 v[20:23], v[68:71], v[208:211], v[20:23]
    ds_read_b128 v[52:55], v88 offset:33024
    v_mfma_f32_16x16x32_bf16 v[24:27], v[68:71], v[212:215], v[24:27]
    ds_read_b128 v[56:59], v88 offset:49408
    v_mfma_f32_16x16x32_bf16 v[28:31], v[72:75], v[208:211], v[28:31]
    buffer_load_dwordx4 v86, s[60:63], s68 offen offset:2048 lds
    v_mfma_f32_16x16x32_bf16 v[32:35], v[72:75], v[212:215], v[32:35]
    s_waitcnt lgkmcnt(2)
    v_mfma_f32_16x16x32_bf16 v[20:23], v[76:79], v[216:219], v[20:23]
    ds_read_b128 v[60:63], v89 offset:33024
    v_mfma_f32_16x16x32_bf16 v[24:27], v[76:79], v[220:223], v[24:27]
    ds_read_b128 v[64:67], v89 offset:49408
    v_mfma_f32_16x16x32_bf16 v[28:31], v[80:83], v[216:219], v[28:31]
    buffer_load_dwordx4 v87, s[60:63], s68 offen offset:3072 lds
    s_add_u32 s68, s68, s3
    v_mfma_f32_16x16x32_bf16 v[32:35], v[80:83], v[220:223], v[32:35]
    s_waitcnt lgkmcnt(2)
    v_mfma_f32_16x16x32_bf16 v[20:23], v[52:55], v[224:227], v[20:23]
    ds_read_b128 v[68:71], v90 offset:33024
    v_mfma_f32_16x16x32_bf16 v[24:27], v[52:55], v[228:231], v[24:27]
    ds_read_b128 v[72:75], v90 offset:49408
    v_mfma_f32_16x16x32_bf16 v[28:31], v[56:59], v[224:227], v[28:31]
    v_mfma_f32_16x16x32_bf16 v[32:35], v[56:59], v[228:231], v[32:35]
    s_waitcnt lgkmcnt(2)
    v_mfma_f32_16x16x32_bf16 v[20:23], v[60:63], v[232:235], v[20:23]
    ds_read_b128 v[76:79], v91 offset:33024
    v_mfma_f32_16x16x32_bf16 v[24:27], v[60:63], v[236:239], v[24:27]
    ds_read_b128 v[80:83], v91 offset:49408
    v_mfma_f32_16x16x32_bf16 v[28:31], v[64:67], v[232:235], v[28:31]
    v_mfma_f32_16x16x32_bf16 v[32:35], v[64:67], v[236:239], v[32:35]
    s_bitcmp1_b64 s[6:7], s82
    s_cbranch_scc1 ssig_57
    s_waitcnt vmcnt(8) lgkmcnt(0)
    s_barrier
srett_59:
    s_add_u32 s82, s82, 1
    v_mfma_f32_16x16x32_bf16 v[20:23], v[68:71], v[240:243], v[20:23]
    ds_read_b128 v[52:55], v92 offset:0
    v_mfma_f32_16x16x32_bf16 v[24:27], v[68:71], v[244:247], v[24:27]
    ds_read_b128 v[56:59], v92 offset:16384
    v_mfma_f32_16x16x32_bf16 v[28:31], v[72:75], v[240:243], v[28:31]
    v_mfma_f32_16x16x32_bf16 v[32:35], v[72:75], v[244:247], v[32:35]
    v_mfma_f32_16x16x32_bf16 v[20:23], v[76:79], v[248:251], v[20:23]
    ds_read_b128 v[60:63], v93 offset:0
    v_mfma_f32_16x16x32_bf16 v[24:27], v[76:79], v[252:255], v[24:27]
    ds_read_b128 v[64:67], v93 offset:16384
    v_mfma_f32_16x16x32_bf16 v[28:31], v[80:83], v[248:251], v[28:31]
    v_mfma_f32_16x16x32_bf16 v[32:35], v[80:83], v[252:255], v[32:35]
    s_waitcnt lgkmcnt(2)
    v_mfma_f32_16x16x32_bf16 v[36:39], v[52:55], v[128:131], 0
    ds_read_b128 v[68:71], v94 offset:0
    v_mfma_f32_16x16x32_bf16 v[40:43], v[52:55], v[132:135], 0
    ds_read_b128 v[72:75], v94 offset:16384
    v_mfma_f32_16x16x32_bf16 v[44:47], v[56:59], v[128:131], 0
    s_add_u32 m0, s70, 32768
    s_nop 0
    buffer_load_dwordx4 v84, s[60:63], s69 offen offset:0 lds
    v_mfma_f32_16x16x32_bf16 v[48:51], v[56:59], v[132:135], 0
    s_waitcnt lgkmcnt(2)
    v_mfma_f32_16x16x32_bf16 v[36:39], v[60:63], v[136:139], v[36:39]
    ds_read_b128 v[76:79], v95 offset:0
    v_mfma_f32_16x16x32_bf16 v[40:43], v[60:63], v[140:143], v[40:43]
    ds_read_b128 v[80:83], v95 offset:16384
    v_mfma_f32_16x16x32_bf16 v[44:47], v[64:67], v[136:139], v[44:47]
    buffer_load_dwordx4 v85, s[60:63], s69 offen offset:1024 lds
    v_mfma_f32_16x16x32_bf16 v[48:51], v[64:67], v[140:143], v[48:51]
    ds_write_b128 v96, v[24:27] offset:0
    s_waitcnt lgkmcnt(3)
    v_mfma_f32_16x16x32_bf16 v[36:39], v[68:71], v[144:147], v[36:39]
    ds_read_b128 v[52:55], v92 offset:256
    v_mfma_f32_16x16x32_bf16 v[40:43], v[68:71], v[148:151], v[40:43]
    ds_read_b128 v[56:59], v92 offset:16640
    v_mfma_f32_16x16x32_bf16 v[44:47], v[72:75], v[144:147], v[44:47]
    buffer_load_dwordx4 v86, s[60:63], s69 offen offset:2048 lds
    v_mfma_f32_16x16x32_bf16 v[48:51], v[72:75], v[148:151], v[48:51]
    ds_write_b128 v96, v[32:35] offset:1024
    s_waitcnt lgkmcnt(4)
    v_mfma_f32_16x16x32_bf16 v[36:39], v[76:79], v[152:155], v[36:39]
    ds_read_b128 v[60:63], v93 offset:256
    v_mfma_f32_16x16x32_bf16 v[40:43], v[76:79], v[156:159], v[40:43]
    ds_read_b128 v[64:67], v93 offset:16640
    v_mfma_f32_16x16x32_bf16 v[44:47], v[80:83], v[152:155], v[44:47]
    buffer_load_dwordx4 v87, s[60:63], s69 offen offset:3072 lds
    s_add_u32 s69, s69, s3
    v_mfma_f32_16x16x32_bf16 v[48:51], v[80:83], v[156:159], v[48:51]
    s_waitcnt lgkmcnt(3)
    v_mfma_f32_16x16x32_bf16 v[36:39], v[52:55], v[160:163], v[36:39]
    ds_read_b128 v[68:71], v94 offset:256
    v_mfma_f32_16x16x32_bf16 v[40:43], v[52:55], v[164:167], v[40:43]
    ds_read_b128 v[72:75], v94 offset:16640
    v_mfma_f32_16x16x32_bf16 v[44:47], v[56:59], v[160:163], v[44:47]
    v_mfma_f32_16x16x32_bf16 v[48:51], v[56:59], v[164:167], v[48:51]
    s_waitcnt lgkmcnt(2)
    v_mfma_f32_16x16x32_bf16 v[36:39], v[60:63], v[168:171], v[36:39]
    ds_read_b128 v[76:79], v95 offset:256
    v_mfma_f32_16x16x32_bf16 v[40:43], v[60:63], v[172:175], v[40:43]
    ds_read_b128 v[80:83], v95 offset:16640
    v_mfma_f32_16x16x32_bf16 v[44:47], v[64:67], v[168:171], v[44:47]
    v_mfma_f32_16x16x32_bf16 v[48:51], v[64:67], v[172:175], v[48:51]
    s_waitcnt vmcnt(8) lgkmcnt(0)
    s_barrier
    v_mfma_f32_16x16x32_bf16 v[36:39], v[68:71], v[176:179], v[36:39]
    ds_read_b128 v[4:7], v97 offset:0
    ds_read_b128 v[8:11], v97 offset:1024
    ds_read_b128 v[52:55], v92 offset:32768
    v_mfma_f32_16x16x32_bf16 v[40:43], v[68:71], v[180:183], v[40:43]
    ds_read_b128 v[56:59], v92 offset:49152
    v_mfma_f32_16x16x32_bf16 v[44:47], v[72:75], v[176:179], v[44:47]
    v_mfma_f32_16x16x32_bf16 v[48:51], v[72:75], v[180:183], v[48:51]
    s_waitcnt lgkmcnt(2)
    v_mfma_f32_16x16x32_bf16 v[36:39], v[76:79], v[184:187], v[36:39]
    v_add_f32 v4, v4, v20
    v_add_f32 v5, v5, v21
    v_add_f32 v6, v6, v22
    v_add_f32 v7, v7, v23
    ds_read_b128 v[60:63], v93 offset:32768
    v_mfma_f32_16x16x32_bf16 v[40:43], v[76:79], v[188:191], v[40:43]
    v_cvt_pk_bf16_f32 v12, v4, v5
    v_cvt_pk_bf16_f32 v13, v6, v7
    ds_read_b128 v[64:67], v93 offset:49152
    v_mfma_f32_16x16x32_bf16 v[44:47], v[80:83], v[184:187], v[44:47]
    v_add_f32 v8, v8, v28
    v_add_f32 v9, v9, v29
    v_add_f32 v10, v10, v30
    v_add_f32 v11, v11, v31
    v_mfma_f32_16x16x32_bf16 v[48:51], v[80:83], v[188:191], v[48:51]
    v_cvt_pk_bf16_f32 v14, v8, v9
    v_cvt_pk_bf16_f32 v15, v10, v11
    buffer_store_dwordx4 v[12:15], v98, s[8:11], s73 offen sc1
    s_mov_b32 s73, s81
    s_add_u32 s81, s81, s4
    s_waitcnt lgkmcnt(2)
    v_mfma_f32_16x16x32_bf16 v[36:39], v[52:55], v[192:195], v[36:39]
    ds_read_b128 v[68:71], v94 offset:32768
    v_mfma_f32_16x16x32_bf16 v[40:43], v[52:55], v[196:199], v[40:43]
    ds_read_b128 v[72:75], v94 offset:49152
    v_mfma_f32_16x16x32_bf16 v[44:47], v[56:59], v[192:195], v[44:47]
    s_add_u32 m0, s70, 65536
    s_nop 0
    buffer_load_dwordx4 v84, s[60:63], s68 offen offset:0 lds
    v_mfma_f32_16x16x32_bf16 v[48:51], v[56:59], v[196:199], v[48:51]
    s_waitcnt lgkmcnt(2)
    v_mfma_f32_16x16x32_bf16 v[36:39], v[60:63], v[200:203], v[36:39]
    ds_read_b128 v[76:79], v95 offset:32768
    v_mfma_f32_16x16x32_bf16 v[40:43], v[60:63], v[204:207], v[40:43]
    ds_read_b128 v[80:83], v95 offset:49152
    v_mfma_f32_16x16x32_bf16 v[44:47], v[64:67], v[200:203], v[44:47]
    buffer_load_dwordx4 v85, s[60:63], s68 offen offset:1024 lds
    v_mfma_f32_16x16x32_bf16 v[48:51], v[64:67], v[204:207], v[48:51]
    s_waitcnt lgkmcnt(2)
    v_mfma_f32_16x16x32_bf16 v[36:39], v[68:71], v[208:211], v[36:39]
    ds_read_b128 v[52:55], v92 offset:33024
    v_mfma_f32_16x16x32_bf16 v[40:43], v[68:71], v[212:215], v[40:43]
    ds_read_b128 v[56:59], v92 offset:49408
    v_mfma_f32_16x16x32_bf16 v[44:47], v[72:75], v[208:211], v[44:47]
    buffer_load_dwordx4 v86, s[60:63], s68 offen offset:2048 lds
    v_mfma_f32_16x16x32_bf16 v[48:51], v[72:75], v[212:215], v[48:51]
    s_waitcnt lgkmcnt(2)
    v_mfma_f32_16x16x32_bf16 v[36:39], v[76:79], v[216:219], v[36:39]
    ds_read_b128 v[60:63], v93 offset:33024
    v_mfma_f32_16x16x32_bf16 v[40:43], v[76:79], v[220:223], v[40:43]
    ds_read_b128 v[64:67], v93 offset:49408
    v_mfma_f32_16x16x32_bf16 v[44:47], v[80:83], v[216:219], v[44:47]
    buffer_load_dwordx4 v87, s[60:63], s68 offen offset:3072 lds
    s_add_u32 s68, s68, s3
    v_mfma_f32_16x16x32_bf16 v[48:51], v[80:83], v[220:223], v[48:51]
    s_waitcnt lgkmcnt(2)
    v_mfma_f32_16x16x32_bf16 v[36:39], v[52:55], v[224:227], v[36:39]
    ds_read_b128 v[68:71], v94 offset:33024
    v_mfma_f32_16x16x32_bf16 v[40:43], v[52:55], v[228:231], v[40:43]
    ds_read_b128 v[72:75], v94 offset:49408
    v_mfma_f32_16x16x32_bf16 v[44:47], v[56:59], v[224:227], v[44:47]
    v_mfma_f32_16x16x32_bf16 v[48:51], v[56:59], v[228:231], v[48:51]
    s_waitcnt lgkmcnt(2)
    v_mfma_f32_16x16x32_bf16 v[36:39], v[60:63], v[232:235], v[36:39]
    ds_read_b128 v[76:79], v95 offset:33024
    v_mfma_f32_16x16x32_bf16 v[40:43], v[60:63], v[236:239], v[40:43]
    ds_read_b128 v[80:83], v95 offset:49408
    v_mfma_f32_16x16x32_bf16 v[44:47], v[64:67], v[232:235], v[44:47]
    v_mfma_f32_16x16x32_bf16 v[48:51], v[64:67], v[236:239], v[48:51]
    s_bitcmp1_b64 s[6:7], s82
    s_cbranch_scc1 ssig_57
    s_waitcnt vmcnt(8) lgkmcnt(0)
    s_barrier
srett_65:
    s_add_u32 s82, s82, s5
    v_mfma_f32_16x16x32_bf16 v[36:39], v[68:71], v[240:243], v[36:39]
    ds_read_b128 v[52:55], v88 offset:0
    v_mfma_f32_16x16x32_bf16 v[40:43], v[68:71], v[244:247], v[40:43]
    ds_read_b128 v[56:59], v88 offset:16384
    v_mfma_f32_16x16x32_bf16 v[44:47], v[72:75], v[240:243], v[44:47]
    v_mfma_f32_16x16x32_bf16 v[48:51], v[72:75], v[244:247], v[48:51]
    v_mfma_f32_16x16x32_bf16 v[36:39], v[76:79], v[248:251], v[36:39]
    ds_read_b128 v[60:63], v89 offset:0
    v_mfma_f32_16x16x32_bf16 v[40:43], v[76:79], v[252:255], v[40:43]
    ds_read_b128 v[64:67], v89 offset:16384
    v_mfma_f32_16x16x32_bf16 v[44:47], v[80:83], v[248:251], v[44:47]
    v_mfma_f32_16x16x32_bf16 v[48:51], v[80:83], v[252:255], v[48:51]
    s_cmp_lt_u32 s82, 64
    s_cbranch_scc1 stream_78
    s_nop 2
    ds_write_b128 v96, v[40:43] offset:0
    s_nop 1
    ds_write_b128 v96, v[48:51] offset:1024
    s_waitcnt vmcnt(0) lgkmcnt(0)
    s_barrier
    ds_read_b128 v[4:7], v97 offset:0
    ds_read_b128 v[8:11], v97 offset:1024
    s_waitcnt lgkmcnt(0)
    v_add_f32 v4, v4, v36
    v_add_f32 v5, v5, v37
    v_add_f32 v6, v6, v38
    v_add_f32 v7, v7, v39
    v_cvt_pk_bf16_f32 v12, v4, v5
    v_cvt_pk_bf16_f32 v13, v6, v7
    v_add_f32 v8, v8, v44
    v_add_f32 v9, v9, v45
    v_add_f32 v10, v10, v46
    v_add_f32 v11, v11, v47
    v_cvt_pk_bf16_f32 v14, v8, v9
    v_cvt_pk_bf16_f32 v15, v10, v11
    buffer_store_dwordx4 v[12:15], v98, s[8:11], s73 offen sc1
    s_mov_b32 s73, s81
    s_add_u32 s81, s81, s4
    s_cmp_ge_u32 s57, 24
    s_cbranch_scc1 col_61
send_60:
    s_waitcnt vmcnt(0) lgkmcnt(0)
    s_barrier
    s_cmp_lg_u32 s58, 0
    s_cbranch_scc1 sig_80
    s_cmp_ge_u32 s57, 16
    s_cbranch_scc1 sig_79
    s_bfe_u32 s85, s76, 0x10003
    s_lshl_b32 s85, s85, 2
    s_bfe_u32 s79, s76, 0x30000
    s_lshl_b32 s79, s79, 7
    s_or_b32 s85, s85, s79
    s_bfe_u32 s79, s76, 0x20005
    s_lshl_b32 s79, s79, 10
    s_or_b32 s85, s85, s79
    s_add_u32 s85, s85, 0x5110000
    v_mov_b32 v4, s82
    buffer_store_dword v4, off, s[8:11], s85 sc1
sig_79:
    v_mov_b32 v5, s84
    s_mov_b64 exec, 1
    buffer_atomic_add v5, off, s[12:15], s83 sc1
    s_mov_b64 exec, -1
    s_add_u32 s83, s83, 4
sig_80:
    v_bfe_u32 v2, v1, 4, 2
    v_lshlrev_b32 v2, 2, v2
    v_xor_b32 v2, v2, v1
    v_bfe_u32 v119, v2, 0, 4
    v_lshlrev_b32 v119, 4, v119
    v_bfe_u32 v3, v2, 4, 2
    v_lshl_or_b32 v119, v3, 11, v119
    s_lshl_b32 s63, s75, 3
    s_add_u32 s63, s63, s58
    s_lshl_b32 s5, s63, 13
    s_lshl_b32 s64, s63, 18
    s_bfe_u32 s7, s57, 0x30000
    s_lshl_b32 s7, s7, 8
    s_add_u32 s64, s64, s7
    s_lshl_b32 s66, s58, 14
    s_add_u32 m0, s66, 0
    s_nop 0
    buffer_load_dwordx4 v119, s[32:35], s64 offen lds
    s_add_u32 s64, s64, 0x2000
    s_add_u32 m0, s66, 1024
    s_nop 0
    buffer_load_dwordx4 v119, s[32:35], s64 offen lds
    s_add_u32 s64, s64, 0x2000
    s_add_u32 m0, s66, 2048
    s_nop 0
    buffer_load_dwordx4 v119, s[32:35], s64 offen lds
    s_add_u32 s64, s64, 0x2000
    s_add_u32 m0, s66, 3072
    s_nop 0
    buffer_load_dwordx4 v119, s[32:35], s64 offen lds
    s_add_u32 s64, s64, 0x2000
    s_add_u32 m0, s66, 4096
    s_nop 0
    buffer_load_dwordx4 v119, s[32:35], s64 offen lds
    s_add_u32 s64, s64, 0x2000
    s_add_u32 m0, s66, 5120
    s_nop 0
    buffer_load_dwordx4 v119, s[32:35], s64 offen lds
    s_add_u32 s64, s64, 0x2000
    s_add_u32 m0, s66, 6144
    s_nop 0
    buffer_load_dwordx4 v119, s[32:35], s64 offen lds
    s_add_u32 s64, s64, 0x2000
    s_add_u32 m0, s66, 7168
    s_nop 0
    buffer_load_dwordx4 v119, s[32:35], s64 offen lds
    s_add_u32 s64, s64, 0x2000
    s_add_u32 m0, s66, 8192
    s_nop 0
    buffer_load_dwordx4 v119, s[32:35], s64 offen lds
    s_add_u32 s64, s64, 0x2000
    s_add_u32 m0, s66, 9216
    s_nop 0
    buffer_load_dwordx4 v119, s[32:35], s64 offen lds
    s_add_u32 s64, s64, 0x2000
    s_add_u32 m0, s66, 10240
    s_nop 0
    buffer_load_dwordx4 v119, s[32:35], s64 offen lds
    s_add_u32 s64, s64, 0x2000
    s_add_u32 m0, s66, 11264
    s_nop 0
    buffer_load_dwordx4 v119, s[32:35], s64 offen lds
    s_add_u32 s64, s64, 0x2000
    s_add_u32 m0, s66, 12288
    s_nop 0
    buffer_load_dwordx4 v119, s[32:35], s64 offen lds
    s_add_u32 s64, s64, 0x2000
    s_add_u32 m0, s66, 13312
    s_nop 0
    buffer_load_dwordx4 v119, s[32:35], s64 offen lds
    s_add_u32 s64, s64, 0x2000
    s_add_u32 m0, s66, 14336
    s_nop 0
    buffer_load_dwordx4 v119, s[32:35], s64 offen lds
    s_add_u32 s64, s64, 0x2000
    s_add_u32 m0, s66, 15360
    s_nop 0
    buffer_load_dwordx4 v119, s[32:35], s64 offen lds
    s_add_u32 s64, s64, 0x2000
    buffer_load_dwordx4 v[192:195], v119, s[32:35], s64 offen
    s_add_u32 s64, s64, 0x2000
    buffer_load_dwordx4 v[196:199], v119, s[32:35], s64 offen
    s_add_u32 s64, s64, 0x2000
    buffer_load_dwordx4 v[200:203], v119, s[32:35], s64 offen
    s_add_u32 s64, s64, 0x2000
    buffer_load_dwordx4 v[204:207], v119, s[32:35], s64 offen
    s_add_u32 s64, s64, 0x2000
    buffer_load_dwordx4 v[208:211], v119, s[32:35], s64 offen
    s_add_u32 s64, s64, 0x2000
    buffer_load_dwordx4 v[212:215], v119, s[32:35], s64 offen
    s_add_u32 s64, s64, 0x2000
    buffer_load_dwordx4 v[216:219], v119, s[32:35], s64 offen
    s_add_u32 s64, s64, 0x2000
    buffer_load_dwordx4 v[220:223], v119, s[32:35], s64 offen
    s_add_u32 s64, s64, 0x2000
    buffer_load_dwordx4 v[224:227], v119, s[32:35], s64 offen
    s_add_u32 s64, s64, 0x2000
    buffer_load_dwordx4 v[228:231], v119, s[32:35], s64 offen
    s_add_u32 s64, s64, 0x2000
    buffer_load_dwordx4 v[232:235], v119, s[32:35], s64 offen
    s_add_u32 s64, s64, 0x2000
    buffer_load_dwordx4 v[236:239], v119, s[32:35], s64 offen
    s_add_u32 s64, s64, 0x2000
    buffer_load_dwordx4 v[240:243], v119, s[32:35], s64 offen
    s_add_u32 s64, s64, 0x2000
    buffer_load_dwordx4 v[244:247], v119, s[32:35], s64 offen
    s_add_u32 s64, s64, 0x2000
    buffer_load_dwordx4 v[248:251], v119, s[32:35], s64 offen
    s_add_u32 s64, s64, 0x2000
    buffer_load_dwordx4 v[252:255], v119, s[32:35], s64 offen
    s_add_u32 s64, s64, 0x2000
    v_bfe_u32 v121, v1, 0, 2
    v_lshlrev_b32 v121, 4, v121
    v_bfe_u32 v3, v1, 2, 2
    v_lshl_or_b32 v121, v3, 6, v121
    v_bfe_u32 v3, v1, 2, 2
    v_lshl_or_b32 v121, v3, 8, v121
    v_bfe_u32 v3, v1, 4, 1
    v_lshl_or_b32 v121, v3, 10, v121
    v_bfe_u32 v3, v1, 5, 1
    v_lshl_or_b32 v121, v3, 12, v121
    s_bfe_u32 s63, s58, 0x20000
    s_lshl_b32 s63, s63, 6
    s_bfe_u32 s70, s58, 0x10002
    s_lshl_b32 s70, s70, 16
    s_or_b32 s63, s63, s70
    v_xor_b32 v121, s63, v121
    v_lshl_add_u32 v120, v1, 4, s66
    s_waitcnt vmcnt(16)
    s_barrier
    ds_read_b64_tr_b16 v[128:129], v121 offset:0
    ds_read_b64_tr_b16 v[130:131], v121 offset:2048
    ds_read_b64_tr_b16 v[132:133], v121 offset:8
    ds_read_b64_tr_b16 v[134:135], v121 offset:2056
    ds_read_b64_tr_b16 v[136:137], v121 offset:8192
    ds_read_b64_tr_b16 v[138:139], v121 offset:10240
    ds_read_b64_tr_b16 v[140:141], v121 offset:8200
    ds_read_b64_tr_b16 v[142:143], v121 offset:10248
    s_waitcnt lgkmcnt(4)
    ds_read_b64_tr_b16 v[144:145], v121 offset:16384
    ds_read_b64_tr_b16 v[146:147], v121 offset:18432
    ds_read_b64_tr_b16 v[148:149], v121 offset:16392
    ds_read_b64_tr_b16 v[150:151], v121 offset:18440
    ds_read_b64_tr_b16 v[152:153], v121 offset:24576
    ds_read_b64_tr_b16 v[154:155], v121 offset:26624
    ds_read_b64_tr_b16 v[156:157], v121 offset:24584
    ds_read_b64_tr_b16 v[158:159], v121 offset:26632
    s_waitcnt lgkmcnt(4)
    ds_read_b64_tr_b16 v[160:161], v121 offset:32768
    ds_read_b64_tr_b16 v[162:163], v121 offset:34816
    ds_read_b64_tr_b16 v[164:165], v121 offset:32776
    ds_read_b64_tr_b16 v[166:167], v121 offset:34824
    ds_read_b64_tr_b16 v[168:169], v121 offset:40960
    ds_read_b64_tr_b16 v[170:171], v121 offset:43008
    ds_read_b64_tr_b16 v[172:173], v121 offset:40968
    ds_read_b64_tr_b16 v[174:175], v121 offset:43016
    s_waitcnt lgkmcnt(4)
    ds_read_b64_tr_b16 v[176:177], v121 offset:49152
    ds_read_b64_tr_b16 v[178:179], v121 offset:51200
    ds_read_b64_tr_b16 v[180:181], v121 offset:49160
    ds_read_b64_tr_b16 v[182:183], v121 offset:51208
    ds_read_b64_tr_b16 v[184:185], v121 offset:57344
    ds_read_b64_tr_b16 v[186:187], v121 offset:59392
    ds_read_b64_tr_b16 v[188:189], v121 offset:57352
    ds_read_b64_tr_b16 v[190:191], v121 offset:59400
    s_waitcnt lgkmcnt(0)
    s_barrier
    s_waitcnt vmcnt(15)
    ds_write_b128 v120, v[192:195] offset:0
    s_waitcnt vmcnt(14)
    ds_write_b128 v120, v[196:199] offset:1024
    s_waitcnt vmcnt(13)
    ds_write_b128 v120, v[200:203] offset:2048
    s_waitcnt vmcnt(12)
    ds_write_b128 v120, v[204:207] offset:3072
    s_waitcnt vmcnt(11)
    ds_write_b128 v120, v[208:211] offset:4096
    s_waitcnt vmcnt(10)
    ds_write_b128 v120, v[212:215] offset:5120
    s_waitcnt vmcnt(9)
    ds_write_b128 v120, v[216:219] offset:6144
    s_waitcnt vmcnt(8)
    ds_write_b128 v120, v[220:223] offset:7168
    s_waitcnt vmcnt(7)
    ds_write_b128 v120, v[224:227] offset:8192
    s_waitcnt vmcnt(6)
    ds_write_b128 v120, v[228:231] offset:9216
    s_waitcnt vmcnt(5)
    ds_write_b128 v120, v[232:235] offset:10240
    s_waitcnt vmcnt(4)
    ds_write_b128 v120, v[236:239] offset:11264
    s_waitcnt vmcnt(3)
    ds_write_b128 v120, v[240:243] offset:12288
    s_waitcnt vmcnt(2)
    ds_write_b128 v120, v[244:247] offset:13312
    s_waitcnt vmcnt(1)
    ds_write_b128 v120, v[248:251] offset:14336
    s_waitcnt vmcnt(0)
    ds_write_b128 v120, v[252:255] offset:15360
    s_cmp_lg_u32 s58, 0
    s_cbranch_scc1 wall_81
    v_mov_b32 v3, 196
wctr_82:
    buffer_load_dword v2, v3, s[12:15], 0 offen sc1
    s_waitcnt vmcnt(0)
    v_cmp_ne_u32 vcc, 2097216, v2
    s_cbranch_vccz wctr_ok_83
    s_sub_u32 s77, s77, 1
    s_cbranch_scc0 wctr_82
    s_mov_b32 s77, 0
wctr_ok_83:
wall_81:
    s_waitcnt lgkmcnt(0)
    s_barrier
    ds_read_b64_tr_b16 v[192:193], v121 offset:0
    ds_read_b64_tr_b16 v[194:195], v121 offset:2048
    ds_read_b64_tr_b16 v[196:197], v121 offset:8
    ds_read_b64_tr_b16 v[198:199], v121 offset:2056
    ds_read_b64_tr_b16 v[200:201], v121 offset:8192
    ds_read_b64_tr_b16 v[202:203], v121 offset:10240
    ds_read_b64_tr_b16 v[204:205], v121 offset:8200
    ds_read_b64_tr_b16 v[206:207], v121 offset:10248
    s_waitcnt lgkmcnt(4)
    ds_read_b64_tr_b16 v[208:209], v121 offset:16384
    ds_read_b64_tr_b16 v[210:211], v121 offset:18432
    ds_read_b64_tr_b16 v[212:213], v121 offset:16392
    ds_read_b64_tr_b16 v[214:215], v121 offset:18440
    ds_read_b64_tr_b16 v[216:217], v121 offset:24576
    ds_read_b64_tr_b16 v[218:219], v121 offset:26624
    ds_read_b64_tr_b16 v[220:221], v121 offset:24584
    ds_read_b64_tr_b16 v[222:223], v121 offset:26632
    s_waitcnt lgkmcnt(4)
    ds_read_b64_tr_b16 v[224:225], v121 offset:32768
    ds_read_b64_tr_b16 v[226:227], v121 offset:34816
    ds_read_b64_tr_b16 v[228:229], v121 offset:32776
    ds_read_b64_tr_b16 v[230:231], v121 offset:34824
    ds_read_b64_tr_b16 v[232:233], v121 offset:40960
    ds_read_b64_tr_b16 v[234:235], v121 offset:43008
    ds_read_b64_tr_b16 v[236:237], v121 offset:40968
    ds_read_b64_tr_b16 v[238:239], v121 offset:43016
    s_waitcnt lgkmcnt(4)
    ds_read_b64_tr_b16 v[240:241], v121 offset:49152
    ds_read_b64_tr_b16 v[242:243], v121 offset:51200
    ds_read_b64_tr_b16 v[244:245], v121 offset:49160
    ds_read_b64_tr_b16 v[246:247], v121 offset:51208
    ds_read_b64_tr_b16 v[248:249], v121 offset:57344
    ds_read_b64_tr_b16 v[250:251], v121 offset:59392
    ds_read_b64_tr_b16 v[252:253], v121 offset:57352
    ds_read_b64_tr_b16 v[254:255], v121 offset:59400
    s_waitcnt lgkmcnt(0)
    s_barrier
    s_add_u32 s5, s5, 0x3000000
    s_lshl_b32 s6, s75, 7
    s_add_u32 s6, s6, 0x5100000
    s_lshl_b32 s66, s58, 12
    v_lshlrev_b32 v123, 4, v1
    s_bfe_u32 s63, s58, 0x10002
    s_lshl_b32 s63, s63, 8
    v_xor_b32 v119, s63, v123
    v_bfe_u32 v116, v1, 0, 4
    v_lshlrev_b32 v116, 4, v116
    v_bfe_u32 v2, v1, 4, 2
    v_lshl_or_b32 v116, v2, 9, v116
    v_lshl_or_b32 v116, s63, 6, v116
    v_xor_b32 v117, 0x10000, v116
    s_lshl_b32 s63, s58, 11
    s_or_b32 s63, s63, 131072
    v_add_u32 v120, s63, v123
    v_xor_b32 v121, 0x2000, v120
    v_bfe_u32 v122, v1, 4, 2
    v_lshlrev_b32 v122, 4, v122
    v_bfe_u32 v2, v1, 0, 4
    v_lshl_or_b32 v122, v2, 12, v122
    s_bfe_u32 s63, s58, 0x20000
    s_lshl_b32 s63, s63, 6
    s_bfe_u32 s70, s58, 0x10002
    s_lshl_b32 s70, s70, 16
    s_or_b32 s63, s63, s70
    s_add_u32 s7, s7, s63
    s_bfe_u32 s69, s57, 0x30000
    s_lshl_b32 s69, s69, 16
    s_bfe_u32 s63, s57, 0x20003
    s_lshl_b32 s63, s63, 21
    s_or_b32 s69, s69, s63
    s_lshl_b32 s63, s58, 13
    s_add_u32 s69, s69, s63
    s_add_u32 s69, s69, 0x6000000
    s_lshl_b32 s63, s75, 11
    s_add_u32 s69, s69, s63
    s_xor_b32 s2, s69, 2048
    s_xor_b32 s3, s69, 4096
    s_xor_b32 s4, s69, 6144
    s_lshr_b32 s63, s58, 1
    s_xor_b32 s74, s63, s75
    s_mov_b32 s60, 0x92492490
    s_mov_b32 s61, 0x24924924
    s_cmp_lt_u32 s57, 16
    s_cselect_b32 s63, 5, 0
    s_or_b32 s60, s60, s63
    s_lshr_b32 s63, s57, 3
    s_lshl_b64 s[60:61], s[60:61], s63
    v_bfe_u32 v125, v1, 0, 3
    v_lshlrev_b32 v125, 2, v125
    v_lshl_or_b32 v125, s58, 28, v125
    v_mov_b32 v127, 163744
    s_mov_b32 s70, 0
    v_mov_b32 v124, v123
    v_mov_b32 v96, 0x3f80
    v_mov_b32 v97, 0x3f800000
    s_ff1_i32_b64 s62, s[60:61]
    s_bitset0_b64 s[60:61], s62
    s_lshl_b32 s65, s62, 9
    s_add_u32 s65, s65, s6
    s_mov_b32 s59, -1
    s_mov_b32 s73, -1
    s_mov_b32 s67, 0x5ffffff0
wo_slow_84:
    s_lshl_b32 s63, s58, 2
    s_add_u32 s65, s65, s63
pollfl_89:
    buffer_load_dword v118, off, s[8:11], s65 sc1
    s_waitcnt vmcnt(0)
    v_cmp_eq_u32 vcc, 0, v118
    s_cbranch_vccz pollfl_ok_90
    s_sub_u32 s77, s77, 1
    s_cbranch_scc0 pollfl_89
    s_mov_b32 s77, 0
pollfl_ok_90:
    s_mov_b32 s72, s62
    s_lshl_b32 s64, s62, 18
    s_add_u32 s64, s64, s5
    s_ff1_i32_b64 s62, s[60:61]
    s_bitset0_b64 s[60:61], s62
    s_lshl_b32 s65, s62, 9
    s_add_u32 s65, s65, s6
    s_add_u32 m0, s66, 0
    s_nop 0
    buffer_load_dwordx4 v119, s[8:11], s64 offen offset:0 lds
    buffer_load_dwordx4 v119, s[8:11], s64 offen offset:1024 lds
    buffer_load_dwordx4 v119, s[8:11], s64 offen offset:2048 lds
    buffer_load_dwordx4 v119, s[8:11], s64 offen offset:3072 lds
    s_add_u32 s64, s64, 4096
    buffer_load_dword v118, v125, s[8:11], s65 offen sc1
    s_add_u32 m0, s66, 32768
    s_nop 0
    buffer_load_dwordx4 v119, s[8:11], s64 offen offset:0 lds
    buffer_load_dwordx4 v119, s[8:11], s64 offen offset:1024 lds
    buffer_load_dwordx4 v119, s[8:11], s64 offen offset:2048 lds
    buffer_load_dwordx4 v119, s[8:11], s64 offen offset:3072 lds
    s_add_u32 s64, s64, 4096
    s_mov_b32 s63, 0x5ffffff0
    buffer_load_dword v3, off, s[8:11], s63
    s_waitcnt vmcnt(5)
    s_cmp_lg_u32 s58, 0
    s_cbranch_scc1 wo_v_91
    v_cmp_eq_u32 vcc, 0, v118
    s_nop 1
    v_mov_b32 v126, vcc_lo
    ds_write_b32 v127, v126
wo_v_91:
    s_waitcnt lgkmcnt(0)
    s_barrier
    ds_read_b32 v126, v127
    ds_read_b128 v[44:47], v116 offset:0
    ds_read_b128 v[48:51], v116 offset:256
    ds_read_b128 v[52:55], v116 offset:2048
    ds_read_b128 v[56:59], v116 offset:2304
    s_cmp_eq_u32 s74, 0
    s_cbranch_scc0 wo_o_92
    s_setprio 2
wo_o_92:
wo_loop_85:
    s_waitcnt lgkmcnt(2)
    v_mfma_f32_16x16x32_bf16 v[12:15], v[128:131], v[44:47], 0
    ds_read_b128 v[60:63], v116 offset:4096
    v_mfma_f32_16x16x32_bf16 v[16:19], v[132:135], v[44:47], 0
    ds_read_b128 v[64:67], v116 offset:4352
    v_readfirstlane_b32 s68, v126
    s_mov_b32 s73, s59
    s_mov_b32 s59, s72
    s_mov_b32 s64, 0x5ffffff0
    s_lshr_b32 s63, s62, 31
    s_or_b32 s68, s68, s63
    s_cbranch_scc1 wo_np_93
    s_mov_b32 s72, s62
    s_lshl_b32 s64, s62, 18
    s_add_u32 s64, s64, s5
    s_ff1_i32_b64 s62, s[60:61]
    s_bitset0_b64 s[60:61], s62
    s_lshl_b32 s65, s62, 9
    s_add_u32 s65, s65, s6
wo_np_93:
    v_mfma_f32_16x16x32_bf16 v[20:23], v[128:131], v[48:51], 0
    v_mfma_f32_16x16x32_bf16 v[24:27], v[132:135], v[48:51], 0
    s_waitcnt lgkmcnt(2)
    v_mfma_f32_16x16x32_bf16 v[12:15], v[136:139], v[52:55], v[12:15]
    ds_read_b128 v[68:71], v116 offset:6144
    v_mfma_f32_16x16x32_bf16 v[16:19], v[140:143], v[52:55], v[16:19]
    ds_read_b128 v[72:75], v116 offset:6400
    v_mfma_f32_16x16x32_bf16 v[20:23], v[136:139], v[56:59], v[20:23]
    v_mfma_f32_16x16x32_bf16 v[24:27], v[140:143], v[56:59], v[24:27]
    ds_write_b128 v120, v[36:39] offset:0
    buffer_load_dword v118, v125, s[8:11], s65 offen sc1
    s_waitcnt lgkmcnt(3)
    v_mfma_f32_16x16x32_bf16 v[12:15], v[144:147], v[60:63], v[12:15]
    ds_read_b128 v[44:47], v116 offset:8192
    v_mfma_f32_16x16x32_bf16 v[16:19], v[148:151], v[60:63], v[16:19]
    ds_read_b128 v[48:51], v116 offset:8448
    v_mfma_f32_16x16x32_bf16 v[20:23], v[144:147], v[64:67], v[20:23]
    s_add_u32 m0, s66, 65536
    s_nop 0
    buffer_load_dwordx4 v119, s[8:11], s64 offen offset:0 lds
    v_mfma_f32_16x16x32_bf16 v[24:27], v[148:151], v[64:67], v[24:27]
    ds_write_b128 v120, v[40:43] offset:1024
    s_waitcnt lgkmcnt(4)
    v_mfma_f32_16x16x32_bf16 v[12:15], v[152:155], v[68:71], v[12:15]
    ds_read_b128 v[52:55], v116 offset:10240
    v_mfma_f32_16x16x32_bf16 v[16:19], v[156:159], v[68:71], v[16:19]
    ds_read_b128 v[56:59], v116 offset:10496
    v_mfma_f32_16x16x32_bf16 v[20:23], v[152:155], v[72:75], v[20:23]
    buffer_load_dwordx4 v119, s[8:11], s64 offen offset:1024 lds
    v_mfma_f32_16x16x32_bf16 v[24:27], v[156:159], v[72:75], v[24:27]
    s_cmp_eq_u32 s74, 0
    s_cbranch_scc0 wo_o_94
    buffer_load_dwordx4 v[92:95], v124, s[8:11], s2 offen offset:0 sc1
wo_o_94:
    s_waitcnt lgkmcnt(3)
    v_mfma_f32_16x16x32_bf16 v[12:15], v[160:163], v[44:47], v[12:15]
    ds_read_b128 v[60:63], v116 offset:12288
    v_mfma_f32_16x16x32_bf16 v[16:19], v[164:167], v[44:47], v[16:19]
    ds_read_b128 v[64:67], v116 offset:12544
    v_mfma_f32_16x16x32_bf16 v[20:23], v[160:163], v[48:51], v[20:23]
    buffer_load_dwordx4 v119, s[8:11], s64 offen offset:2048 lds
    v_mfma_f32_16x16x32_bf16 v[24:27], v[164:167], v[48:51], v[24:27]
    s_cmp_eq_u32 s74, 0
    s_cbranch_scc0 wo_o_95
    buffer_load_dwordx4 v[100:103], v124, s[8:11], s3 offen offset:0 sc1
wo_o_95:
    s_waitcnt lgkmcnt(2)
    v_mfma_f32_16x16x32_bf16 v[12:15], v[168:171], v[52:55], v[12:15]
    ds_read_b128 v[68:71], v116 offset:14336
    v_mfma_f32_16x16x32_bf16 v[16:19], v[172:175], v[52:55], v[16:19]
    ds_read_b128 v[72:75], v116 offset:14592
    v_mfma_f32_16x16x32_bf16 v[20:23], v[168:171], v[56:59], v[20:23]
    buffer_load_dwordx4 v119, s[8:11], s64 offen offset:3072 lds
    s_add_u32 s64, s64, 4096
    v_mfma_f32_16x16x32_bf16 v[24:27], v[172:175], v[56:59], v[24:27]
    s_cmp_eq_u32 s74, 0
    s_cbranch_scc0 wo_o_96
    buffer_load_dwordx4 v[108:111], v124, s[8:11], s4 offen offset:0 sc1
wo_o_96:
    s_cmp_eq_u32 s74, 0
    s_cbranch_scc1 wo_w_97
    s_waitcnt vmcnt(5)
wo_w_97:
    s_waitcnt vmcnt(9)
    s_waitcnt lgkmcnt(0)
    s_barrier
    v_mfma_f32_16x16x32_bf16 v[12:15], v[176:179], v[60:63], v[12:15]
    ds_read_b128 v[4:7], v121 offset:0
    ds_read_b128 v[8:11], v121 offset:1024
    ds_read_b128 v[44:47], v116 offset:32768
    v_mfma_f32_16x16x32_bf16 v[16:19], v[180:183], v[60:63], v[16:19]
    ds_read_b128 v[48:51], v116 offset:33024
    v_mfma_f32_16x16x32_bf16 v[20:23], v[176:179], v[64:67], v[20:23]
    v_mfma_f32_16x16x32_bf16 v[24:27], v[180:183], v[64:67], v[24:27]
    s_waitcnt lgkmcnt(2)
    v_mfma_f32_16x16x32_bf16 v[12:15], v[184:187], v[68:71], v[12:15]
    ds_read_b128 v[52:55], v116 offset:34816
    v_mfma_f32_16x16x32_bf16 v[16:19], v[188:191], v[68:71], v[16:19]
    ds_read_b128 v[56:59], v116 offset:35072
    v_mfma_f32_16x16x32_bf16 v[20:23], v[184:187], v[72:75], v[20:23]
    v_mfma_f32_16x16x32_bf16 v[24:27], v[188:191], v[72:75], v[24:27]
    v_pk_add_f32 v[84:85], v[4:5], v[28:29]
    v_pk_add_f32 v[86:87], v[6:7], v[30:31]
    v_pk_add_f32 v[88:89], v[8:9], v[32:33]
    v_pk_add_f32 v[90:91], v[10:11], v[34:35]
    s_cmp_eq_u32 s74, 0
    s_cbranch_scc1 wo_e_98
    s_bfe_u32 s71, s70, 0x10002
    s_cmp_lt_i32 s73, 0
    s_cselect_b32 s63, 0x5ffffff0, s69
    v_cvt_pk_bf16_f32 v84, v84, v85
    v_cvt_pk_bf16_f32 v85, v86, v87
    v_cvt_pk_bf16_f32 v86, v88, v89
    v_cvt_pk_bf16_f32 v87, v90, v91
    v_bfi_b32 v84, 1, s71, v84
    buffer_store_dwordx4 v[84:87], v123, s[8:11], s63 offen offset:0 sc1
wo_e_98:
    s_waitcnt lgkmcnt(2)
    v_mfma_f32_16x16x32_bf16 v[12:15], v[192:195], v[44:47], v[12:15]
    ds_read_b128 v[60:63], v116 offset:36864
    v_mfma_f32_16x16x32_bf16 v[16:19], v[196:199], v[44:47], v[16:19]
    ds_read_b128 v[64:67], v116 offset:37120
    v_mfma_f32_16x16x32_bf16 v[20:23], v[192:195], v[48:51], v[20:23]
    v_mfma_f32_16x16x32_bf16 v[24:27], v[196:199], v[48:51], v[24:27]
    s_waitcnt lgkmcnt(2)
    v_mfma_f32_16x16x32_bf16 v[12:15], v[200:203], v[52:55], v[12:15]
    ds_read_b128 v[68:71], v116 offset:38912
    v_mfma_f32_16x16x32_bf16 v[16:19], v[204:207], v[52:55], v[16:19]
    ds_read_b128 v[72:75], v116 offset:39168
    v_mfma_f32_16x16x32_bf16 v[20:23], v[200:203], v[56:59], v[20:23]
    v_mfma_f32_16x16x32_bf16 v[24:27], v[204:207], v[56:59], v[24:27]
    s_cmp_lg_u32 s58, 0
    s_cbranch_scc1 wo_a_99
    s_waitcnt vmcnt(5)
    v_cmp_eq_u32 vcc, 0, v118
    s_cbranch_vccz wo_a_99
    buffer_load_dword v118, v125, s[8:11], s65 offen sc1
wo_a_99:
    s_waitcnt lgkmcnt(2)
    v_mfma_f32_16x16x32_bf16 v[12:15], v[208:211], v[60:63], v[12:15]
    ds_read_b128 v[44:47], v116 offset:40960
    v_mfma_f32_16x16x32_bf16 v[16:19], v[212:215], v[60:63], v[16:19]
    ds_read_b128 v[48:51], v116 offset:41216
    v_mfma_f32_16x16x32_bf16 v[20:23], v[208:211], v[64:67], v[20:23]
    s_add_u32 m0, s66, 98304
    s_nop 0
    buffer_load_dwordx4 v119, s[8:11], s64 offen offset:0 lds
    v_mfma_f32_16x16x32_bf16 v[24:27], v[212:215], v[64:67], v[24:27]
    s_waitcnt lgkmcnt(2)
    v_mfma_f32_16x16x32_bf16 v[12:15], v[216:219], v[68:71], v[12:15]
    ds_read_b128 v[52:55], v116 offset:43008
    v_mfma_f32_16x16x32_bf16 v[16:19], v[220:223], v[68:71], v[16:19]
    ds_read_b128 v[56:59], v116 offset:43264
    v_mfma_f32_16x16x32_bf16 v[20:23], v[216:219], v[72:75], v[20:23]
    buffer_load_dwordx4 v119, s[8:11], s64 offen offset:1024 lds
    v_mfma_f32_16x16x32_bf16 v[24:27], v[220:223], v[72:75], v[24:27]
    s_waitcnt lgkmcnt(2)
    v_mfma_f32_16x16x32_bf16 v[12:15], v[224:227], v[44:47], v[12:15]
    ds_read_b128 v[60:63], v116 offset:45056
    v_mfma_f32_16x16x32_bf16 v[16:19], v[228:231], v[44:47], v[16:19]
    ds_read_b128 v[64:67], v116 offset:45312
    v_mfma_f32_16x16x32_bf16 v[20:23], v[224:227], v[48:51], v[20:23]
    buffer_load_dwordx4 v119, s[8:11], s64 offen offset:2048 lds
    v_mfma_f32_16x16x32_bf16 v[24:27], v[228:231], v[48:51], v[24:27]
    s_cmp_lg_u32 s58, 0
    s_cbranch_scc1 wo_v_100
    s_cbranch_vccz wo_b_101
    s_waitcnt vmcnt(3)
wo_b_101:
    v_cmp_eq_u32 vcc, 0, v118
    s_nop 1
    v_mov_b32 v126, vcc_lo
    ds_write_b32 v127, v126
wo_v_100:
    s_waitcnt lgkmcnt(2)
    v_mfma_f32_16x16x32_bf16 v[12:15], v[232:235], v[52:55], v[12:15]
    ds_read_b128 v[68:71], v116 offset:47104
    v_mfma_f32_16x16x32_bf16 v[16:19], v[236:239], v[52:55], v[16:19]
    ds_read_b128 v[72:75], v116 offset:47360
    v_mfma_f32_16x16x32_bf16 v[20:23], v[232:235], v[56:59], v[20:23]
    buffer_load_dwordx4 v119, s[8:11], s64 offen offset:3072 lds
    s_add_u32 s64, s64, 4096
    v_mfma_f32_16x16x32_bf16 v[24:27], v[236:239], v[56:59], v[24:27]
    s_cmp_eq_u32 s74, 0
    s_cbranch_scc1 wo_w_102
    s_waitcnt vmcnt(5)
wo_w_102:
    s_waitcnt vmcnt(5)
    s_waitcnt lgkmcnt(0)
    s_barrier
    v_mfma_f32_16x16x32_bf16 v[12:15], v[240:243], v[60:63], v[12:15]
    ds_read_b32 v126, v127
    ds_read_b128 v[44:47], v117 offset:0
    v_mfma_f32_16x16x32_bf16 v[16:19], v[244:247], v[60:63], v[16:19]
    ds_read_b128 v[48:51], v117 offset:256
    v_mfma_f32_16x16x32_bf16 v[20:23], v[240:243], v[64:67], v[20:23]
    v_mfma_f32_16x16x32_bf16 v[24:27], v[244:247], v[64:67], v[24:27]
    v_mfma_f32_16x16x32_bf16 v[12:15], v[248:251], v[68:71], v[12:15]
    ds_read_b128 v[52:55], v117 offset:2048
    v_mfma_f32_16x16x32_bf16 v[16:19], v[252:255], v[68:71], v[16:19]
    ds_read_b128 v[56:59], v117 offset:2304
    v_mfma_f32_16x16x32_bf16 v[20:23], v[248:251], v[72:75], v[20:23]
    v_mfma_f32_16x16x32_bf16 v[24:27], v[252:255], v[72:75], v[24:27]
    s_cmp_lg_u32 s74, 0
    s_cbranch_scc1 wo_k_103
    s_cmp_eq_u32 s67, 0x5ffffff0
    s_cbranch_scc1 wo_s_105
    s_waitcnt vmcnt(4)
    v_bitop3_b32 v2, v92, v100, s71 bitop3:0x7e
    v_xor_b32 v3, s71, v108
    v_bitop3_b32 v2, v2, v3, 1 bitop3:0xa8
    v_cmp_ne_u32 vcc, 0, v2
    s_cbranch_vccz pollpart_ok_107
pollpart_106:
    buffer_load_dwordx4 v[92:95], v124, s[8:11], s2 offen offset:0 sc1
    buffer_load_dwordx4 v[100:103], v124, s[8:11], s3 offen offset:0 sc1
    buffer_load_dwordx4 v[108:111], v124, s[8:11], s4 offen offset:0 sc1
    s_waitcnt vmcnt(0)
    v_bitop3_b32 v2, v92, v100, s71 bitop3:0x7e
    v_xor_b32 v3, s71, v108
    v_bitop3_b32 v2, v2, v3, 1 bitop3:0xa8
    v_cmp_ne_u32 vcc, 0, v2
    s_cbranch_vccz pollpart_ok_107
    s_sub_u32 s77, s77, 1
    s_cbranch_scc0 pollpart_106
    s_mov_b32 s77, 0
pollpart_ok_107:
    v_dot2_f32_bf16 v76, v92, v96, v76
    v_dot2_f32_bf16 v77, v92, v97, v77
    v_dot2_f32_bf16 v78, v93, v96, v78
    v_dot2_f32_bf16 v79, v93, v97, v79
    v_dot2_f32_bf16 v80, v94, v96, v80
    v_dot2_f32_bf16 v81, v94, v97, v81
    v_dot2_f32_bf16 v82, v95, v96, v82
    v_dot2_f32_bf16 v83, v95, v97, v83
    v_dot2_f32_bf16 v76, v100, v96, v76
    v_dot2_f32_bf16 v77, v100, v97, v77
    v_dot2_f32_bf16 v78, v101, v96, v78
    v_dot2_f32_bf16 v79, v101, v97, v79
    v_dot2_f32_bf16 v80, v102, v96, v80
    v_dot2_f32_bf16 v81, v102, v97, v81
    v_dot2_f32_bf16 v82, v103, v96, v82
    v_dot2_f32_bf16 v83, v103, v97, v83
    v_dot2_f32_bf16 v76, v108, v96, v76
    v_dot2_f32_bf16 v77, v108, v97, v77
    v_dot2_f32_bf16 v78, v109, v96, v78
    v_dot2_f32_bf16 v79, v109, v97, v79
    v_dot2_f32_bf16 v80, v110, v96, v80
    v_dot2_f32_bf16 v81, v110, v97, v81
    v_dot2_f32_bf16 v82, v111, v96, v82
    v_dot2_f32_bf16 v83, v111, v97, v83
    v_cvt_pk_bf16_f32 v92, v76, v77
    v_cvt_pk_bf16_f32 v93, v78, v79
    v_cvt_pk_bf16_f32 v94, v80, v81
    v_cvt_pk_bf16_f32 v95, v82, v83
wo_s_105:
    buffer_store_dwordx4 v[92:95], v122, s[16:19], s67 offen offset:2048 sc1
wo_k_103:
    s_cmp_lt_i32 s73, 0
    s_cbranch_scc1 wo_e_104
    s_bfe_u32 s71, s70, 0x10002
    s_add_u32 s70, s70, 1
    v_pk_mov_b32 v[76:77], v[84:85], v[84:85] op_sel:[0,1]
    v_pk_mov_b32 v[78:79], v[86:87], v[86:87] op_sel:[0,1]
    v_pk_mov_b32 v[80:81], v[88:89], v[88:89] op_sel:[0,1]
    v_pk_mov_b32 v[82:83], v[90:91], v[90:91] op_sel:[0,1]
    v_mov_b32 v124, v123
    s_lshl_b32 s67, s73, 17
    s_add_u32 s67, s67, s7
    v_add_u32 v123, 0x80000, v123
    v_and_b32 v123, 0x1fffff, v123
wo_e_104:
    s_cmp_eq_u32 s68, 0
    s_cbranch_scc0 wo_fl_86
wo_out_88:
    s_waitcnt lgkmcnt(2)
    v_mfma_f32_16x16x32_bf16 v[28:31], v[128:131], v[44:47], 0
    ds_read_b128 v[60:63], v117 offset:4096
    v_mfma_f32_16x16x32_bf16 v[32:35], v[132:135], v[44:47], 0
    ds_read_b128 v[64:67], v117 offset:4352
    v_readfirstlane_b32 s68, v126
    s_mov_b32 s73, s59
    s_mov_b32 s59, s72
    s_mov_b32 s64, 0x5ffffff0
    s_lshr_b32 s63, s62, 31
    s_or_b32 s68, s68, s63
    s_cbranch_scc1 wo_np_108
    s_mov_b32 s72, s62
    s_lshl_b32 s64, s62, 18
    s_add_u32 s64, s64, s5
    s_ff1_i32_b64 s62, s[60:61]
    s_bitset0_b64 s[60:61], s62
    s_lshl_b32 s65, s62, 9
    s_add_u32 s65, s65, s6
wo_np_108:
    v_mfma_f32_16x16x32_bf16 v[36:39], v[128:131], v[48:51], 0
    v_mfma_f32_16x16x32_bf16 v[40:43], v[132:135], v[48:51], 0
    s_waitcnt lgkmcnt(2)
    v_mfma_f32_16x16x32_bf16 v[28:31], v[136:139], v[52:55], v[28:31]
    ds_read_b128 v[68:71], v117 offset:6144
    v_mfma_f32_16x16x32_bf16 v[32:35], v[140:143], v[52:55], v[32:35]
    ds_read_b128 v[72:75], v117 offset:6400
    v_mfma_f32_16x16x32_bf16 v[36:39], v[136:139], v[56:59], v[36:39]
    v_mfma_f32_16x16x32_bf16 v[40:43], v[140:143], v[56:59], v[40:43]
    ds_write_b128 v120, v[20:23] offset:0
    buffer_load_dword v118, v125, s[8:11], s65 offen sc1
    s_waitcnt lgkmcnt(3)
    v_mfma_f32_16x16x32_bf16 v[28:31], v[144:147], v[60:63], v[28:31]
    ds_read_b128 v[44:47], v117 offset:8192
    v_mfma_f32_16x16x32_bf16 v[32:35], v[148:151], v[60:63], v[32:35]
    ds_read_b128 v[48:51], v117 offset:8448
    v_mfma_f32_16x16x32_bf16 v[36:39], v[144:147], v[64:67], v[36:39]
    s_add_u32 m0, s66, 0
    s_nop 0
    buffer_load_dwordx4 v119, s[8:11], s64 offen offset:0 lds
    v_mfma_f32_16x16x32_bf16 v[40:43], v[148:151], v[64:67], v[40:43]
    ds_write_b128 v120, v[24:27] offset:1024
    s_waitcnt lgkmcnt(4)
    v_mfma_f32_16x16x32_bf16 v[28:31], v[152:155], v[68:71], v[28:31]
    ds_read_b128 v[52:55], v117 offset:10240
    v_mfma_f32_16x16x32_bf16 v[32:35], v[156:159], v[68:71], v[32:35]
    ds_read_b128 v[56:59], v117 offset:10496
    v_mfma_f32_16x16x32_bf16 v[36:39], v[152:155], v[72:75], v[36:39]
    buffer_load_dwordx4 v119, s[8:11], s64 offen offset:1024 lds
    v_mfma_f32_16x16x32_bf16 v[40:43], v[156:159], v[72:75], v[40:43]
    s_cmp_eq_u32 s74, 0
    s_cbranch_scc0 wo_o_109
    buffer_load_dwordx4 v[92:95], v124, s[8:11], s2 offen offset:0 sc1
wo_o_109:
    s_waitcnt lgkmcnt(3)
    v_mfma_f32_16x16x32_bf16 v[28:31], v[160:163], v[44:47], v[28:31]
    ds_read_b128 v[60:63], v117 offset:12288
    v_mfma_f32_16x16x32_bf16 v[32:35], v[164:167], v[44:47], v[32:35]
    ds_read_b128 v[64:67], v117 offset:12544
    v_mfma_f32_16x16x32_bf16 v[36:39], v[160:163], v[48:51], v[36:39]
    buffer_load_dwordx4 v119, s[8:11], s64 offen offset:2048 lds
    v_mfma_f32_16x16x32_bf16 v[40:43], v[164:167], v[48:51], v[40:43]
    s_cmp_eq_u32 s74, 0
    s_cbranch_scc0 wo_o_110
    buffer_load_dwordx4 v[100:103], v124, s[8:11], s3 offen offset:0 sc1
wo_o_110:
    s_waitcnt lgkmcnt(2)
    v_mfma_f32_16x16x32_bf16 v[28:31], v[168:171], v[52:55], v[28:31]
    ds_read_b128 v[68:71], v117 offset:14336
    v_mfma_f32_16x16x32_bf16 v[32:35], v[172:175], v[52:55], v[32:35]
    ds_read_b128 v[72:75], v117 offset:14592
    v_mfma_f32_16x16x32_bf16 v[36:39], v[168:171], v[56:59], v[36:39]
    buffer_load_dwordx4 v119, s[8:11], s64 offen offset:3072 lds
    s_add_u32 s64, s64, 4096
    v_mfma_f32_16x16x32_bf16 v[40:43], v[172:175], v[56:59], v[40:43]
    s_cmp_eq_u32 s74, 0
    s_cbranch_scc0 wo_o_111
    buffer_load_dwordx4 v[108:111], v124, s[8:11], s4 offen offset:0 sc1
wo_o_111:
    s_cmp_eq_u32 s74, 0
    s_cbranch_scc1 wo_w_112
    s_waitcnt vmcnt(5)
wo_w_112:
    s_waitcnt vmcnt(9)
    s_waitcnt lgkmcnt(0)
    s_barrier
    v_mfma_f32_16x16x32_bf16 v[28:31], v[176:179], v[60:63], v[28:31]
    ds_read_b128 v[4:7], v121 offset:0
    ds_read_b128 v[8:11], v121 offset:1024
    ds_read_b128 v[44:47], v117 offset:32768
    v_mfma_f32_16x16x32_bf16 v[32:35], v[180:183], v[60:63], v[32:35]
    ds_read_b128 v[48:51], v117 offset:33024
    v_mfma_f32_16x16x32_bf16 v[36:39], v[176:179], v[64:67], v[36:39]
    v_mfma_f32_16x16x32_bf16 v[40:43], v[180:183], v[64:67], v[40:43]
    s_waitcnt lgkmcnt(2)
    v_mfma_f32_16x16x32_bf16 v[28:31], v[184:187], v[68:71], v[28:31]
    ds_read_b128 v[52:55], v117 offset:34816
    v_mfma_f32_16x16x32_bf16 v[32:35], v[188:191], v[68:71], v[32:35]
    ds_read_b128 v[56:59], v117 offset:35072
    v_mfma_f32_16x16x32_bf16 v[36:39], v[184:187], v[72:75], v[36:39]
    v_mfma_f32_16x16x32_bf16 v[40:43], v[188:191], v[72:75], v[40:43]
    v_pk_add_f32 v[84:85], v[4:5], v[12:13]
    v_pk_add_f32 v[86:87], v[6:7], v[14:15]
    v_pk_add_f32 v[88:89], v[8:9], v[16:17]
    v_pk_add_f32 v[90:91], v[10:11], v[18:19]
    s_cmp_eq_u32 s74, 0
    s_cbranch_scc1 wo_e_113
    s_bfe_u32 s71, s70, 0x10002
    s_cmp_lt_i32 s73, 0
    s_cselect_b32 s63, 0x5ffffff0, s69
    v_cvt_pk_bf16_f32 v84, v84, v85
    v_cvt_pk_bf16_f32 v85, v86, v87
    v_cvt_pk_bf16_f32 v86, v88, v89
    v_cvt_pk_bf16_f32 v87, v90, v91
    v_bfi_b32 v84, 1, s71, v84
    buffer_store_dwordx4 v[84:87], v123, s[8:11], s63 offen offset:0 sc1
wo_e_113:
    s_waitcnt lgkmcnt(2)
    v_mfma_f32_16x16x32_bf16 v[28:31], v[192:195], v[44:47], v[28:31]
    ds_read_b128 v[60:63], v117 offset:36864
    v_mfma_f32_16x16x32_bf16 v[32:35], v[196:199], v[44:47], v[32:35]
    ds_read_b128 v[64:67], v117 offset:37120
    v_mfma_f32_16x16x32_bf16 v[36:39], v[192:195], v[48:51], v[36:39]
    v_mfma_f32_16x16x32_bf16 v[40:43], v[196:199], v[48:51], v[40:43]
    s_waitcnt lgkmcnt(2)
    v_mfma_f32_16x16x32_bf16 v[28:31], v[200:203], v[52:55], v[28:31]
    ds_read_b128 v[68:71], v117 offset:38912
    v_mfma_f32_16x16x32_bf16 v[32:35], v[204:207], v[52:55], v[32:35]
    ds_read_b128 v[72:75], v117 offset:39168
    v_mfma_f32_16x16x32_bf16 v[36:39], v[200:203], v[56:59], v[36:39]
    v_mfma_f32_16x16x32_bf16 v[40:43], v[204:207], v[56:59], v[40:43]
    s_cmp_lg_u32 s58, 0
    s_cbranch_scc1 wo_a_114
    s_waitcnt vmcnt(5)
    v_cmp_eq_u32 vcc, 0, v118
    s_cbranch_vccz wo_a_114
    buffer_load_dword v118, v125, s[8:11], s65 offen sc1
wo_a_114:
    s_waitcnt lgkmcnt(2)
    v_mfma_f32_16x16x32_bf16 v[28:31], v[208:211], v[60:63], v[28:31]
    ds_read_b128 v[44:47], v117 offset:40960
    v_mfma_f32_16x16x32_bf16 v[32:35], v[212:215], v[60:63], v[32:35]
    ds_read_b128 v[48:51], v117 offset:41216
    v_mfma_f32_16x16x32_bf16 v[36:39], v[208:211], v[64:67], v[36:39]
    s_add_u32 m0, s66, 32768
    s_nop 0
    buffer_load_dwordx4 v119, s[8:11], s64 offen offset:0 lds
    v_mfma_f32_16x16x32_bf16 v[40:43], v[212:215], v[64:67], v[40:43]
    s_waitcnt lgkmcnt(2)
    v_mfma_f32_16x16x32_bf16 v[28:31], v[216:219], v[68:71], v[28:31]
    ds_read_b128 v[52:55], v117 offset:43008
    v_mfma_f32_16x16x32_bf16 v[32:35], v[220:223], v[68:71], v[32:35]
    ds_read_b128 v[56:59], v117 offset:43264
    v_mfma_f32_16x16x32_bf16 v[36:39], v[216:219], v[72:75], v[36:39]
    buffer_load_dwordx4 v119, s[8:11], s64 offen offset:1024 lds
    v_mfma_f32_16x16x32_bf16 v[40:43], v[220:223], v[72:75], v[40:43]
    s_waitcnt lgkmcnt(2)
    v_mfma_f32_16x16x32_bf16 v[28:31], v[224:227], v[44:47], v[28:31]
    ds_read_b128 v[60:63], v117 offset:45056
    v_mfma_f32_16x16x32_bf16 v[32:35], v[228:231], v[44:47], v[32:35]
    ds_read_b128 v[64:67], v117 offset:45312
    v_mfma_f32_16x16x32_bf16 v[36:39], v[224:227], v[48:51], v[36:39]
    buffer_load_dwordx4 v119, s[8:11], s64 offen offset:2048 lds
    v_mfma_f32_16x16x32_bf16 v[40:43], v[228:231], v[48:51], v[40:43]
    s_cmp_lg_u32 s58, 0
    s_cbranch_scc1 wo_v_115
    s_cbranch_vccz wo_b_116
    s_waitcnt vmcnt(3)
wo_b_116:
    v_cmp_eq_u32 vcc, 0, v118
    s_nop 1
    v_mov_b32 v126, vcc_lo
    ds_write_b32 v127, v126
wo_v_115:
    s_waitcnt lgkmcnt(2)
    v_mfma_f32_16x16x32_bf16 v[28:31], v[232:235], v[52:55], v[28:31]
    ds_read_b128 v[68:71], v117 offset:47104
    v_mfma_f32_16x16x32_bf16 v[32:35], v[236:239], v[52:55], v[32:35]
    ds_read_b128 v[72:75], v117 offset:47360
    v_mfma_f32_16x16x32_bf16 v[36:39], v[232:235], v[56:59], v[36:39]
    buffer_load_dwordx4 v119, s[8:11], s64 offen offset:3072 lds
    s_add_u32 s64, s64, 4096
    v_mfma_f32_16x16x32_bf16 v[40:43], v[236:239], v[56:59], v[40:43]
    s_cmp_eq_u32 s74, 0
    s_cbranch_scc1 wo_w_117
    s_waitcnt vmcnt(5)
wo_w_117:
    s_waitcnt vmcnt(5)
    s_waitcnt lgkmcnt(0)
    s_barrier
    v_mfma_f32_16x16x32_bf16 v[28:31], v[240:243], v[60:63], v[28:31]
    ds_read_b32 v126, v127
    ds_read_b128 v[44:47], v116 offset:0
    v_mfma_f32_16x16x32_bf16 v[32:35], v[244:247], v[60:63], v[32:35]
    ds_read_b128 v[48:51], v116 offset:256
    v_mfma_f32_16x16x32_bf16 v[36:39], v[240:243], v[64:67], v[36:39]
    v_mfma_f32_16x16x32_bf16 v[40:43], v[244:247], v[64:67], v[40:43]
    v_mfma_f32_16x16x32_bf16 v[28:31], v[248:251], v[68:71], v[28:31]
    ds_read_b128 v[52:55], v116 offset:2048
    v_mfma_f32_16x16x32_bf16 v[32:35], v[252:255], v[68:71], v[32:35]
    ds_read_b128 v[56:59], v116 offset:2304
    v_mfma_f32_16x16x32_bf16 v[36:39], v[248:251], v[72:75], v[36:39]
    v_mfma_f32_16x16x32_bf16 v[40:43], v[252:255], v[72:75], v[40:43]
    s_cmp_lg_u32 s74, 0
    s_cbranch_scc1 wo_k_118
    s_cmp_eq_u32 s67, 0x5ffffff0
    s_cbranch_scc1 wo_s_120
    s_waitcnt vmcnt(4)
    v_bitop3_b32 v2, v92, v100, s71 bitop3:0x7e
    v_xor_b32 v3, s71, v108
    v_bitop3_b32 v2, v2, v3, 1 bitop3:0xa8
    v_cmp_ne_u32 vcc, 0, v2
    s_cbranch_vccz pollpart_ok_122
pollpart_121:
    buffer_load_dwordx4 v[92:95], v124, s[8:11], s2 offen offset:0 sc1
    buffer_load_dwordx4 v[100:103], v124, s[8:11], s3 offen offset:0 sc1
    buffer_load_dwordx4 v[108:111], v124, s[8:11], s4 offen offset:0 sc1
    s_waitcnt vmcnt(0)
    v_bitop3_b32 v2, v92, v100, s71 bitop3:0x7e
    v_xor_b32 v3, s71, v108
    v_bitop3_b32 v2, v2, v3, 1 bitop3:0xa8
    v_cmp_ne_u32 vcc, 0, v2
    s_cbranch_vccz pollpart_ok_122
    s_sub_u32 s77, s77, 1
    s_cbranch_scc0 pollpart_121
    s_mov_b32 s77, 0
pollpart_ok_122:
    v_dot2_f32_bf16 v76, v92, v96, v76
    v_dot2_f32_bf16 v77, v92, v97, v77
    v_dot2_f32_bf16 v78, v93, v96, v78
    v_dot2_f32_bf16 v79, v93, v97, v79
    v_dot2_f32_bf16 v80, v94, v96, v80
    v_dot2_f32_bf16 v81, v94, v97, v81
    v_dot2_f32_bf16 v82, v95, v96, v82
    v_dot2_f32_bf16 v83, v95, v97, v83
    v_dot2_f32_bf16 v76, v100, v96, v76
    v_dot2_f32_bf16 v77, v100, v97, v77
    v_dot2_f32_bf16 v78, v101, v96, v78
    v_dot2_f32_bf16 v79, v101, v97, v79
    v_dot2_f32_bf16 v80, v102, v96, v80
    v_dot2_f32_bf16 v81, v102, v97, v81
    v_dot2_f32_bf16 v82, v103, v96, v82
    v_dot2_f32_bf16 v83, v103, v97, v83
    v_dot2_f32_bf16 v76, v108, v96, v76
    v_dot2_f32_bf16 v77, v108, v97, v77
    v_dot2_f32_bf16 v78, v109, v96, v78
    v_dot2_f32_bf16 v79, v109, v97, v79
    v_dot2_f32_bf16 v80, v110, v96, v80
    v_dot2_f32_bf16 v81, v110, v97, v81
    v_dot2_f32_bf16 v82, v111, v96, v82
    v_dot2_f32_bf16 v83, v111, v97, v83
    v_cvt_pk_bf16_f32 v92, v76, v77
    v_cvt_pk_bf16_f32 v93, v78, v79
    v_cvt_pk_bf16_f32 v94, v80, v81
    v_cvt_pk_bf16_f32 v95, v82, v83
wo_s_120:
    buffer_store_dwordx4 v[92:95], v122, s[16:19], s67 offen offset:2048 sc1
wo_k_118:
    s_cmp_lt_i32 s73, 0
    s_cbranch_scc1 wo_e_119
    s_bfe_u32 s71, s70, 0x10002
    s_add_u32 s70, s70, 1
    v_pk_mov_b32 v[76:77], v[84:85], v[84:85] op_sel:[0,1]
    v_pk_mov_b32 v[78:79], v[86:87], v[86:87] op_sel:[0,1]
    v_pk_mov_b32 v[80:81], v[88:89], v[88:89] op_sel:[0,1]
    v_pk_mov_b32 v[82:83], v[90:91], v[90:91] op_sel:[0,1]
    v_mov_b32 v124, v123
    s_lshl_b32 s67, s73, 17
    s_add_u32 s67, s67, s7
    v_add_u32 v123, 0x80000, v123
    v_and_b32 v123, 0x1fffff, v123
wo_e_119:
    s_cmp_eq_u32 s68, 0
    s_cbranch_scc1 wo_loop_85
    s_cmp_ge_i32 s62, 0
    s_cbranch_scc1 wo_slow_84
wo_f0_87:
    ds_write_b128 v120, v[36:39] offset:0
    ds_write_b128 v120, v[40:43] offset:1024
    s_mov_b32 s73, s59
    s_cmp_eq_u32 s74, 0
    s_cbranch_scc0 wo_o_123
    buffer_load_dwordx4 v[92:95], v124, s[8:11], s2 offen offset:0 sc1
    buffer_load_dwordx4 v[100:103], v124, s[8:11], s3 offen offset:0 sc1
    buffer_load_dwordx4 v[108:111], v124, s[8:11], s4 offen offset:0 sc1
wo_o_123:
    s_waitcnt lgkmcnt(0)
    s_barrier
    ds_read_b128 v[4:7], v121 offset:0
    ds_read_b128 v[8:11], v121 offset:1024
    s_waitcnt lgkmcnt(0)
    v_pk_add_f32 v[84:85], v[4:5], v[28:29]
    v_pk_add_f32 v[86:87], v[6:7], v[30:31]
    v_pk_add_f32 v[88:89], v[8:9], v[32:33]
    v_pk_add_f32 v[90:91], v[10:11], v[34:35]
    s_cmp_eq_u32 s74, 0
    s_cbranch_scc1 wo_e_124
    s_bfe_u32 s71, s70, 0x10002
    s_cmp_lt_i32 s73, 0
    s_cselect_b32 s63, 0x5ffffff0, s69
    v_cvt_pk_bf16_f32 v84, v84, v85
    v_cvt_pk_bf16_f32 v85, v86, v87
    v_cvt_pk_bf16_f32 v86, v88, v89
    v_cvt_pk_bf16_f32 v87, v90, v91
    v_bfi_b32 v84, 1, s71, v84
    buffer_store_dwordx4 v[84:87], v123, s[8:11], s63 offen offset:0 sc1
wo_e_124:
    s_cmp_lg_u32 s74, 0
    s_cbranch_scc1 wo_k_125
    s_cmp_eq_u32 s67, 0x5ffffff0
    s_cbranch_scc1 wo_s_127
    s_waitcnt vmcnt(0)
    v_bitop3_b32 v2, v92, v100, s71 bitop3:0x7e
    v_xor_b32 v3, s71, v108
    v_bitop3_b32 v2, v2, v3, 1 bitop3:0xa8
    v_cmp_ne_u32 vcc, 0, v2
    s_cbranch_vccz pollpart_ok_129
pollpart_128:
    buffer_load_dwordx4 v[92:95], v124, s[8:11], s2 offen offset:0 sc1
    buffer_load_dwordx4 v[100:103], v124, s[8:11], s3 offen offset:0 sc1
    buffer_load_dwordx4 v[108:111], v124, s[8:11], s4 offen offset:0 sc1
    s_waitcnt vmcnt(0)
    v_bitop3_b32 v2, v92, v100, s71 bitop3:0x7e
    v_xor_b32 v3, s71, v108
    v_bitop3_b32 v2, v2, v3, 1 bitop3:0xa8
    v_cmp_ne_u32 vcc, 0, v2
    s_cbranch_vccz pollpart_ok_129
    s_sub_u32 s77, s77, 1
    s_cbranch_scc0 pollpart_128
    s_mov_b32 s77, 0
pollpart_ok_129:
    v_dot2_f32_bf16 v76, v92, v96, v76
    v_dot2_f32_bf16 v77, v92, v97, v77
    v_dot2_f32_bf16 v78, v93, v96, v78
    v_dot2_f32_bf16 v79, v93, v97, v79
    v_dot2_f32_bf16 v80, v94, v96, v80
    v_dot2_f32_bf16 v81, v94, v97, v81
    v_dot2_f32_bf16 v82, v95, v96, v82
    v_dot2_f32_bf16 v83, v95, v97, v83
    v_dot2_f32_bf16 v76, v100, v96, v76
    v_dot2_f32_bf16 v77, v100, v97, v77
    v_dot2_f32_bf16 v78, v101, v96, v78
    v_dot2_f32_bf16 v79, v101, v97, v79
    v_dot2_f32_bf16 v80, v102, v96, v80
    v_dot2_f32_bf16 v81, v102, v97, v81
    v_dot2_f32_bf16 v82, v103, v96, v82
    v_dot2_f32_bf16 v83, v103, v97, v83
    v_dot2_f32_bf16 v76, v108, v96, v76
    v_dot2_f32_bf16 v77, v108, v97, v77
    v_dot2_f32_bf16 v78, v109, v96, v78
    v_dot2_f32_bf16 v79, v109, v97, v79
    v_dot2_f32_bf16 v80, v110, v96, v80
    v_dot2_f32_bf16 v81, v110, v97, v81
    v_dot2_f32_bf16 v82, v111, v96, v82
    v_dot2_f32_bf16 v83, v111, v97, v83
    v_cvt_pk_bf16_f32 v92, v76, v77
    v_cvt_pk_bf16_f32 v93, v78, v79
    v_cvt_pk_bf16_f32 v94, v80, v81
    v_cvt_pk_bf16_f32 v95, v82, v83
wo_s_127:
    buffer_store_dwordx4 v[92:95], v122, s[16:19], s67 offen offset:2048 sc1
wo_k_125:
    s_cmp_lt_i32 s73, 0
    s_cbranch_scc1 wo_e_126
    s_bfe_u32 s71, s70, 0x10002
    s_add_u32 s70, s70, 1
    v_pk_mov_b32 v[76:77], v[84:85], v[84:85] op_sel:[0,1]
    v_pk_mov_b32 v[78:79], v[86:87], v[86:87] op_sel:[0,1]
    v_pk_mov_b32 v[80:81], v[88:89], v[88:89] op_sel:[0,1]
    v_pk_mov_b32 v[82:83], v[90:91], v[90:91] op_sel:[0,1]
    v_mov_b32 v124, v123
    s_lshl_b32 s67, s73, 17
    s_add_u32 s67, s67, s7
    v_add_u32 v123, 0x80000, v123
    v_and_b32 v123, 0x1fffff, v123
wo_e_126:
    s_cmp_eq_u32 s74, 0
    s_cbranch_scc0 wo_o_130
pollpart_131:
    buffer_load_dwordx4 v[92:95], v124, s[8:11], s2 offen offset:0 sc1
    buffer_load_dwordx4 v[100:103], v124, s[8:11], s3 offen offset:0 sc1
    buffer_load_dwordx4 v[108:111], v124, s[8:11], s4 offen offset:0 sc1
    s_waitcnt vmcnt(0)
    v_bitop3_b32 v2, v92, v100, s71 bitop3:0x7e
    v_xor_b32 v3, s71, v108
    v_bitop3_b32 v2, v2, v3, 1 bitop3:0xa8
    v_cmp_ne_u32 vcc, 0, v2
    s_cbranch_vccz pollpart_ok_132
    s_sub_u32 s77, s77, 1
    s_cbranch_scc0 pollpart_131
    s_mov_b32 s77, 0
pollpart_ok_132:
    v_dot2_f32_bf16 v76, v92, v96, v76
    v_dot2_f32_bf16 v77, v92, v97, v77
    v_dot2_f32_bf16 v78, v93, v96, v78
    v_dot2_f32_bf16 v79, v93, v97, v79
    v_dot2_f32_bf16 v80, v94, v96, v80
    v_dot2_f32_bf16 v81, v94, v97, v81
    v_dot2_f32_bf16 v82, v95, v96, v82
    v_dot2_f32_bf16 v83, v95, v97, v83
    v_dot2_f32_bf16 v76, v100, v96, v76
    v_dot2_f32_bf16 v77, v100, v97, v77
    v_dot2_f32_bf16 v78, v101, v96, v78
    v_dot2_f32_bf16 v79, v101, v97, v79
    v_dot2_f32_bf16 v80, v102, v96, v80
    v_dot2_f32_bf16 v81, v102, v97, v81
    v_dot2_f32_bf16 v82, v103, v96, v82
    v_dot2_f32_bf16 v83, v103, v97, v83
    v_dot2_f32_bf16 v76, v108, v96, v76
    v_dot2_f32_bf16 v77, v108, v97, v77
    v_dot2_f32_bf16 v78, v109, v96, v78
    v_dot2_f32_bf16 v79, v109, v97, v79
    v_dot2_f32_bf16 v80, v110, v96, v80
    v_dot2_f32_bf16 v81, v110, v97, v81
    v_dot2_f32_bf16 v82, v111, v96, v82
    v_dot2_f32_bf16 v83, v111, v97, v83
    v_cvt_pk_bf16_f32 v92, v76, v77
    v_cvt_pk_bf16_f32 v93, v78, v79
    v_cvt_pk_bf16_f32 v94, v80, v81
    v_cvt_pk_bf16_f32 v95, v82, v83
    buffer_store_dwordx4 v[92:95], v122, s[16:19], s67 offen offset:2048 sc1
wo_o_130:
    s_branch end_63
wo_fl_86:
    s_cmp_lt_i32 s62, 0
    s_cbranch_scc1 wo_m_133
    s_lshl_b32 s63, s58, 2
    s_add_u32 s65, s65, s63
pollfl_134:
    buffer_load_dword v118, off, s[8:11], s65 sc1
    s_waitcnt vmcnt(0)
    v_cmp_eq_u32 vcc, 0, v118
    s_cbranch_vccz pollfl_ok_135
    s_sub_u32 s77, s77, 1
    s_cbranch_scc0 pollfl_134
    s_mov_b32 s77, 0
pollfl_ok_135:
    s_mov_b32 s72, s62
    s_lshl_b32 s64, s62, 18
    s_add_u32 s64, s64, s5
    s_ff1_i32_b64 s62, s[60:61]
    s_bitset0_b64 s[60:61], s62
    s_lshl_b32 s65, s62, 9
    s_add_u32 s65, s65, s6
    s_add_u32 m0, s66, 65536
    s_nop 0
    buffer_load_dwordx4 v119, s[8:11], s64 offen offset:0 lds
    buffer_load_dwordx4 v119, s[8:11], s64 offen offset:1024 lds
    buffer_load_dwordx4 v119, s[8:11], s64 offen offset:2048 lds
    buffer_load_dwordx4 v119, s[8:11], s64 offen offset:3072 lds
    s_add_u32 s64, s64, 4096
    buffer_load_dword v118, v125, s[8:11], s65 offen sc1
    s_add_u32 m0, s66, 98304
    s_nop 0
    buffer_load_dwordx4 v119, s[8:11], s64 offen offset:0 lds
    buffer_load_dwordx4 v119, s[8:11], s64 offen offset:1024 lds
    buffer_load_dwordx4 v119, s[8:11], s64 offen offset:2048 lds
    buffer_load_dwordx4 v119, s[8:11], s64 offen offset:3072 lds
    s_add_u32 s64, s64, 4096
    s_mov_b32 s63, 0x5ffffff0
    buffer_load_dword v3, off, s[8:11], s63
    s_waitcnt vmcnt(5)
    s_cmp_lg_u32 s58, 0
    s_cbranch_scc1 wo_v_136
    v_cmp_eq_u32 vcc, 0, v118
    s_nop 1
    v_mov_b32 v126, vcc_lo
    ds_write_b32 v127, v126
wo_v_136:
    s_waitcnt lgkmcnt(0)
    s_barrier
    ds_read_b32 v126, v127
    ds_read_b128 v[44:47], v117 offset:0
    ds_read_b128 v[48:51], v117 offset:256
    ds_read_b128 v[52:55], v117 offset:2048
    ds_read_b128 v[56:59], v117 offset:2304
    s_branch wo_out_88
wo_m_133:
    s_nop 7
    v_mov_b32 v28, v12
    v_mov_b32 v29, v13
    v_mov_b32 v30, v14
    v_mov_b32 v31, v15
    v_mov_b32 v32, v16
    v_mov_b32 v33, v17
    v_mov_b32 v34, v18
    v_mov_b32 v35, v19
    v_mov_b32 v36, v20
    v_mov_b32 v37, v21
    v_mov_b32 v38, v22
    v_mov_b32 v39, v23
    v_mov_b32 v40, v24
    v_mov_b32 v41, v25
    v_mov_b32 v42, v26
    v_mov_b32 v43, v27
    s_branch wo_f0_87
fft_54:
    v_bfe_u32 v120, v1, 0, 1
    v_lshlrev_b32 v120, 7, v120
    v_bfe_u32 v121, v1, 1, 5
    v_lshl_or_b32 v120, v121, 13, v120
    s_bfe_u32 s79, s58, 0x20000
    s_lshl_b32 s79, s79, 19
    s_bfe_u32 s85, s58, 0x10002
    s_lshl_b32 s85, s85, 22
    s_or_b32 s79, s79, s85
    s_bfe_u32 s80, s76, 0x30000
    s_lshl_b32 s80, s80, 8
    s_bfe_u32 s85, s76, 0x20005
    s_lshl_b32 s85, s85, 11
    s_or_b32 s80, s80, s85
    s_bfe_u32 s85, s76, 0x10000
    s_lshl_b32 s85, s85, 21
    s_or_b32 s80, s80, s85
    s_add_u32 s79, s79, s80
    s_xor_b32 s85, s79, 0x240000
    buffer_load_dword v122, v120, s[24:27], s85 offen
    s_xor_b32 s85, s79, 0x240000
    buffer_load_dword v123, v120, s[28:31], s85 offen
    s_mov_b64 s[60:61], s[44:45]
    s_mov_b32 s62, 0x400000
    s_mov_b32 s63, 0x20000
    s_mov_b32 s81, 0x5400000
    s_mov_b32 s83, 48
    s_mov_b32 s6, 0x10000
    s_mov_b32 s7, 0
    s_branch gen_62
col_61:
    s_waitcnt vmcnt(0) lgkmcnt(0)
    s_barrier
    s_cmp_lg_u32 s58, 0
    s_cbranch_scc1 sig_137
    v_mov_b32 v75, 0x5ffffff0
    v_mov_b32 v76, 40
    v_cmp_eq_u32 vcc, 0, v1
    s_nop 1
    v_cndmask_b32 v76, v75, v76, vcc
    v_mov_b32 v75, 1
    buffer_atomic_add v75, v76, s[12:15], 0 offen sc1
sig_137:
    s_bfe_u32 s79, s76, 0x30000
    s_bfe_u32 s85, s76, 0x20005
    s_lshl_b32 s85, s85, 3
    s_or_b32 s79, s79, s85
    v_bfe_u32 v231, v1, 0, 5
    v_bfe_u32 v235, v1, 5, 1
    v_lshl_or_b32 v231, v235, 7, v231
    v_mul_u32_u24 v231, 1026, v231
    v_and_b32 v231, -4, v231
    s_mul_i32 s5, s58, 262656
    s_lshl_b32 s2, s79, 5
    s_add_u32 s5, s5, s2
    buffer_load_dwordx4 v[84:87], v231, s[48:51], s5 offen
    buffer_load_dwordx4 v[88:91], v231, s[48:51], s5 offen offset:16
    buffer_load_dword v92, v231, s[48:51], s5 offen offset:32
    buffer_load_dwordx4 v[94:97], v231, s[52:55], s5 offen
    buffer_load_dwordx4 v[98:101], v231, s[52:55], s5 offen offset:16
    buffer_load_dword v102, v231, s[52:55], s5 offen offset:32
    s_add_u32 s5, s5, 32832
    buffer_load_dwordx4 v[104:107], v231, s[48:51], s5 offen
    buffer_load_dwordx4 v[108:111], v231, s[48:51], s5 offen offset:16
    buffer_load_dword v112, v231, s[48:51], s5 offen offset:32
    buffer_load_dwordx4 v[114:117], v231, s[52:55], s5 offen
    buffer_load_dwordx4 v[118:121], v231, s[52:55], s5 offen offset:16
    buffer_load_dword v122, v231, s[52:55], s5 offen offset:32
    s_add_u32 s5, s5, 32832
    buffer_load_dwordx4 v[124:127], v231, s[48:51], s5 offen
    buffer_load_dwordx4 v[128:131], v231, s[48:51], s5 offen offset:16
    buffer_load_dword v132, v231, s[48:51], s5 offen offset:32
    buffer_load_dwordx4 v[134:137], v231, s[52:55], s5 offen
    buffer_load_dwordx4 v[138:141], v231, s[52:55], s5 offen offset:16
    buffer_load_dword v142, v231, s[52:55], s5 offen offset:32
    s_add_u32 s5, s5, 32832
    buffer_load_dwordx4 v[144:147], v231, s[48:51], s5 offen
    buffer_load_dwordx4 v[148:151], v231, s[48:51], s5 offen offset:16
    buffer_load_dword v152, v231, s[48:51], s5 offen offset:32
    buffer_load_dwordx4 v[154:157], v231, s[52:55], s5 offen
    buffer_load_dwordx4 v[158:161], v231, s[52:55], s5 offen offset:16
    buffer_load_dword v162, v231, s[52:55], s5 offen offset:32
    s_add_u32 s5, s5, 32832
    v_and_b32 v235, 31, v1
    v_cvt_f32_u32 v228, v235
    v_and_b32 v235, 32, v1
    v_cvt_f32_u32 v235, v235
    v_mul_f32 v229, v228, v235
    v_mul_f32 v229, 0x3b000000, v229
    v_mul_f32 v234, 0x3d000000, v229
    v_fmamk_f32 v230, v235, 0x3b000000, v234
    v_and_b32 v233, 1, v1
    v_lshlrev_b32 v232, 4, v233
    v_mul_u32_u24 v233, 0x8000, v233
    v_lshl_or_b32 v233, v233, 16, v233
    v_fmamk_f32 v243, v228, 0x0, v229
    v_add_f32 v244, v243, v243
    v_cos_f32 v235, v243
    v_sin_f32 v237, v243
    v_cos_f32 v239, v244
    v_sin_f32 v241, v244
    v_fmamk_f32 v243, v228, 0x3c800000, v229
    v_add_f32 v244, v243, v243
    v_cos_f32 v236, v243
    v_sin_f32 v238, v243
    v_cos_f32 v240, v244
    v_sin_f32 v242, v244
    v_cvt_pk_bf16_f32 v4, v235, v236
    v_cvt_pk_bf16_f32 v36, v237, v238
    v_cvt_pk_bf16_f32 v68, v239, v240
    v_cvt_pk_bf16_f32 v76, v241, v242
    v_fmamk_f32 v243, v228, 0x3d000000, v229
    v_add_f32 v244, v243, v243
    v_cos_f32 v235, v243
    v_sin_f32 v237, v243
    v_cos_f32 v239, v244
    v_sin_f32 v241, v244
    v_fmamk_f32 v243, v228, 0x3d400000, v229
    v_add_f32 v244, v243, v243
    v_cos_f32 v236, v243
    v_sin_f32 v238, v243
    v_cos_f32 v240, v244
    v_sin_f32 v242, v244
    v_cvt_pk_bf16_f32 v5, v235, v236
    v_cvt_pk_bf16_f32 v37, v237, v238
    v_cvt_pk_bf16_f32 v69, v239, v240
    v_cvt_pk_bf16_f32 v77, v241, v242
    v_fmamk_f32 v243, v228, 0x3e000000, v229
    v_add_f32 v244, v243, v243
    v_cos_f32 v235, v243
    v_sin_f32 v237, v243
    v_cos_f32 v239, v244
    v_sin_f32 v241, v244
    v_fmamk_f32 v243, v228, 0x3e100000, v229
    v_add_f32 v244, v243, v243
    v_cos_f32 v236, v243
    v_sin_f32 v238, v243
    v_cos_f32 v240, v244
    v_sin_f32 v242, v244
    v_cvt_pk_bf16_f32 v6, v235, v236
    v_cvt_pk_bf16_f32 v38, v237, v238
    v_cvt_pk_bf16_f32 v70, v239, v240
    v_cvt_pk_bf16_f32 v78, v241, v242
    v_fmamk_f32 v243, v228, 0x3e200000, v229
    v_add_f32 v244, v243, v243
    v_cos_f32 v235, v243
    v_sin_f32 v237, v243
    v_cos_f32 v239, v244
    v_sin_f32 v241, v244
    v_fmamk_f32 v243, v228, 0x3e300000, v229
    v_add_f32 v244, v243, v243
    v_cos_f32 v236, v243
    v_sin_f32 v238, v243
    v_cos_f32 v240, v244
    v_sin_f32 v242, v244
    v_cvt_pk_bf16_f32 v7, v235, v236
    v_cvt_pk_bf16_f32 v39, v237, v238
    v_cvt_pk_bf16_f32 v71, v239, v240
    v_cvt_pk_bf16_f32 v79, v241, v242
    v_fmamk_f32 v243, v228, 0x3e800000, v229
    v_add_f32 v244, v243, v243
    v_cos_f32 v235, v243
    v_sin_f32 v237, v243
    v_cos_f32 v239, v244
    v_sin_f32 v241, v244
    v_fmamk_f32 v243, v228, 0x3e880000, v229
    v_add_f32 v244, v243, v243
    v_cos_f32 v236, v243
    v_sin_f32 v238, v243
    v_cos_f32 v240, v244
    v_sin_f32 v242, v244
    v_cvt_pk_bf16_f32 v8, v235, v236
    v_cvt_pk_bf16_f32 v40, v237, v238
    v_cvt_pk_bf16_f32 v72, v239, v240
    v_cvt_pk_bf16_f32 v80, v241, v242
    v_fmamk_f32 v243, v228, 0x3e900000, v229
    v_add_f32 v244, v243, v243
    v_cos_f32 v235, v243
    v_sin_f32 v237, v243
    v_cos_f32 v239, v244
    v_sin_f32 v241, v244
    v_fmamk_f32 v243, v228, 0x3e980000, v229
    v_add_f32 v244, v243, v243
    v_cos_f32 v236, v243
    v_sin_f32 v238, v243
    v_cos_f32 v240, v244
    v_sin_f32 v242, v244
    v_cvt_pk_bf16_f32 v9, v235, v236
    v_cvt_pk_bf16_f32 v41, v237, v238
    v_cvt_pk_bf16_f32 v73, v239, v240
    v_cvt_pk_bf16_f32 v81, v241, v242
    v_fmamk_f32 v243, v228, 0x3ec00000, v229
    v_add_f32 v244, v243, v243
    v_cos_f32 v235, v243
    v_sin_f32 v237, v243
    v_cos_f32 v239, v244
    v_sin_f32 v241, v244
    v_fmamk_f32 v243, v228, 0x3ec80000, v229
    v_add_f32 v244, v243, v243
    v_cos_f32 v236, v243
    v_sin_f32 v238, v243
    v_cos_f32 v240, v244
    v_sin_f32 v242, v244
    v_cvt_pk_bf16_f32 v10, v235, v236
    v_cvt_pk_bf16_f32 v42, v237, v238
    v_cvt_pk_bf16_f32 v74, v239, v240
    v_cvt_pk_bf16_f32 v82, v241, v242
    v_fmamk_f32 v243, v228, 0x3ed00000, v229
    v_add_f32 v244, v243, v243
    v_cos_f32 v235, v243
    v_sin_f32 v237, v243
    v_cos_f32 v239, v244
    v_sin_f32 v241, v244
    v_fmamk_f32 v243, v228, 0x3ed80000, v229
    v_add_f32 v244, v243, v243
    v_cos_f32 v236, v243
    v_sin_f32 v238, v243
    v_cos_f32 v240, v244
    v_sin_f32 v242, v244
    v_cvt_pk_bf16_f32 v11, v235, v236
    v_cvt_pk_bf16_f32 v43, v237, v238
    v_cvt_pk_bf16_f32 v75, v239, v240
    v_cvt_pk_bf16_f32 v83, v241, v242
    v_xor_b32 v12, v233, v4
    v_xor_b32 v13, v233, v5
    v_xor_b32 v14, v233, v6
    v_xor_b32 v15, v233, v7
    v_xor_b32 v16, v233, v8
    v_xor_b32 v17, v233, v9
    v_xor_b32 v18, v233, v10
    v_xor_b32 v19, v233, v11
    v_xor_b32 v20, 0x80000000, v4
    v_xor_b32 v21, 0x80000000, v5
    v_xor_b32 v22, 0x80000000, v6
    v_xor_b32 v23, 0x80000000, v7
    v_xor_b32 v24, 0x80000000, v8
    v_xor_b32 v25, 0x80000000, v9
    v_xor_b32 v26, 0x80000000, v10
    v_xor_b32 v27, 0x80000000, v11
    v_xor_b32 v28, 0x80000000, v12
    v_xor_b32 v29, 0x80000000, v13
    v_xor_b32 v30, 0x80000000, v14
    v_xor_b32 v31, 0x80000000, v15
    v_xor_b32 v32, 0x80000000, v16
    v_xor_b32 v33, 0x80000000, v17
    v_xor_b32 v34, 0x80000000, v18
    v_xor_b32 v35, 0x80000000, v19
    v_xor_b32 v44, v233, v36
    v_xor_b32 v45, v233, v37
    v_xor_b32 v46, v233, v38
    v_xor_b32 v47, v233, v39
    v_xor_b32 v48, v233, v40
    v_xor_b32 v49, v233, v41
    v_xor_b32 v50, v233, v42
    v_xor_b32 v51, v233, v43
    v_xor_b32 v52, 0x80000000, v36
    v_xor_b32 v53, 0x80000000, v37
    v_xor_b32 v54, 0x80000000, v38
    v_xor_b32 v55, 0x80000000, v39
    v_xor_b32 v56, 0x80000000, v40
    v_xor_b32 v57, 0x80000000, v41
    v_xor_b32 v58, 0x80000000, v42
    v_xor_b32 v59, 0x80000000, v43
    v_xor_b32 v60, 0x80000000, v44
    v_xor_b32 v61, 0x80000000, v45
    v_xor_b32 v62, 0x80000000, v46
    v_xor_b32 v63, 0x80000000, v47
    v_xor_b32 v64, 0x80000000, v48
    v_xor_b32 v65, 0x80000000, v49
    v_xor_b32 v66, 0x80000000, v50
    v_xor_b32 v67, 0x80000000, v51
    s_mov_b32 s2, 0x05040100
    s_mov_b32 s3, 0x07060302
    s_lshl_b32 s5, s58, 10
    v_lshl_add_u32 v231, v1, 4, s5
    v_add_u32 v233, 0x10000, v231
    v_add_u32 v235, 0x20000, v231
    s_waitcnt vmcnt(0)
    v_alignbit_b32 v84, v85, v84, v232
    v_alignbit_b32 v94, v95, v94, v232
    v_alignbit_b32 v104, v105, v104, v232
    v_alignbit_b32 v114, v115, v114, v232
    v_alignbit_b32 v124, v125, v124, v232
    v_alignbit_b32 v134, v135, v134, v232
    v_alignbit_b32 v144, v145, v144, v232
    v_alignbit_b32 v154, v155, v154, v232
    v_perm_b32 v196, v94, v84, s2
    v_perm_b32 v197, v114, v104, s2
    v_perm_b32 v198, v134, v124, s2
    v_perm_b32 v199, v154, v144, s2
    ds_write_b128 v231, v[196:199] offset:0
    v_perm_b32 v200, v94, v84, s3
    v_perm_b32 v201, v114, v104, s3
    v_perm_b32 v202, v134, v124, s3
    v_perm_b32 v203, v154, v144, s3
    ds_write_b128 v231, v[200:203] offset:8192
    v_alignbit_b32 v85, v86, v85, v232
    v_alignbit_b32 v95, v96, v95, v232
    v_alignbit_b32 v105, v106, v105, v232
    v_alignbit_b32 v115, v116, v115, v232
    v_alignbit_b32 v125, v126, v125, v232
    v_alignbit_b32 v135, v136, v135, v232
    v_alignbit_b32 v145, v146, v145, v232
    v_alignbit_b32 v155, v156, v155, v232
    v_perm_b32 v204, v95, v85, s2
    v_perm_b32 v205, v115, v105, s2
    v_perm_b32 v206, v135, v125, s2
    v_perm_b32 v207, v155, v145, s2
    ds_write_b128 v231, v[204:207] offset:16384
    v_perm_b32 v208, v95, v85, s3
    v_perm_b32 v209, v115, v105, s3
    v_perm_b32 v210, v135, v125, s3
    v_perm_b32 v211, v155, v145, s3
    ds_write_b128 v231, v[208:211] offset:24576
    v_alignbit_b32 v86, v87, v86, v232
    v_alignbit_b32 v96, v97, v96, v232
    v_alignbit_b32 v106, v107, v106, v232
    v_alignbit_b32 v116, v117, v116, v232
    v_alignbit_b32 v126, v127, v126, v232
    v_alignbit_b32 v136, v137, v136, v232
    v_alignbit_b32 v146, v147, v146, v232
    v_alignbit_b32 v156, v157, v156, v232
    v_perm_b32 v212, v96, v86, s2
    v_perm_b32 v213, v116, v106, s2
    v_perm_b32 v214, v136, v126, s2
    v_perm_b32 v215, v156, v146, s2
    ds_write_b128 v231, v[212:215] offset:32768
    v_perm_b32 v216, v96, v86, s3
    v_perm_b32 v217, v116, v106, s3
    v_perm_b32 v218, v136, v126, s3
    v_perm_b32 v219, v156, v146, s3
    ds_write_b128 v231, v[216:219] offset:40960
    v_alignbit_b32 v87, v88, v87, v232
    v_alignbit_b32 v97, v98, v97, v232
    v_alignbit_b32 v107, v108, v107, v232
    v_alignbit_b32 v117, v118, v117, v232
    v_alignbit_b32 v127, v128, v127, v232
    v_alignbit_b32 v137, v138, v137, v232
    v_alignbit_b32 v147, v148, v147, v232
    v_alignbit_b32 v157, v158, v157, v232
    v_perm_b32 v220, v97, v87, s2
    v_perm_b32 v221, v117, v107, s2
    v_perm_b32 v222, v137, v127, s2
    v_perm_b32 v223, v157, v147, s2
    ds_write_b128 v231, v[220:223] offset:49152
    v_perm_b32 v224, v97, v87, s3
    v_perm_b32 v225, v117, v107, s3
    v_perm_b32 v226, v137, v127, s3
    v_perm_b32 v227, v157, v147, s3
    ds_write_b128 v231, v[224:227] offset:57344
    v_alignbit_b32 v88, v89, v88, v232
    v_alignbit_b32 v98, v99, v98, v232
    v_alignbit_b32 v108, v109, v108, v232
    v_alignbit_b32 v118, v119, v118, v232
    v_alignbit_b32 v128, v129, v128, v232
    v_alignbit_b32 v138, v139, v138, v232
    v_alignbit_b32 v148, v149, v148, v232
    v_alignbit_b32 v158, v159, v158, v232
    v_perm_b32 v196, v98, v88, s2
    v_perm_b32 v197, v118, v108, s2
    v_perm_b32 v198, v138, v128, s2
    v_perm_b32 v199, v158, v148, s2
    ds_write_b128 v233, v[196:199] offset:0
    v_perm_b32 v200, v98, v88, s3
    v_perm_b32 v201, v118, v108, s3
    v_perm_b32 v202, v138, v128, s3
    v_perm_b32 v203, v158, v148, s3
    ds_write_b128 v233, v[200:203] offset:8192
    v_alignbit_b32 v89, v90, v89, v232
    v_alignbit_b32 v99, v100, v99, v232
    v_alignbit_b32 v109, v110, v109, v232
    v_alignbit_b32 v119, v120, v119, v232
    v_alignbit_b32 v129, v130, v129, v232
    v_alignbit_b32 v139, v140, v139, v232
    v_alignbit_b32 v149, v150, v149, v232
    v_alignbit_b32 v159, v160, v159, v232
    v_perm_b32 v204, v99, v89, s2
    v_perm_b32 v205, v119, v109, s2
    v_perm_b32 v206, v139, v129, s2
    v_perm_b32 v207, v159, v149, s2
    ds_write_b128 v233, v[204:207] offset:16384
    v_perm_b32 v208, v99, v89, s3
    v_perm_b32 v209, v119, v109, s3
    v_perm_b32 v210, v139, v129, s3
    v_perm_b32 v211, v159, v149, s3
    ds_write_b128 v233, v[208:211] offset:24576
    v_alignbit_b32 v90, v91, v90, v232
    v_alignbit_b32 v100, v101, v100, v232
    v_alignbit_b32 v110, v111, v110, v232
    v_alignbit_b32 v120, v121, v120, v232
    v_alignbit_b32 v130, v131, v130, v232
    v_alignbit_b32 v140, v141, v140, v232
    v_alignbit_b32 v150, v151, v150, v232
    v_alignbit_b32 v160, v161, v160, v232
    v_perm_b32 v212, v100, v90, s2
    v_perm_b32 v213, v120, v110, s2
    v_perm_b32 v214, v140, v130, s2
    v_perm_b32 v215, v160, v150, s2
    ds_write_b128 v233, v[212:215] offset:32768
    v_perm_b32 v216, v100, v90, s3
    v_perm_b32 v217, v120, v110, s3
    v_perm_b32 v218, v140, v130, s3
    v_perm_b32 v219, v160, v150, s3
    ds_write_b128 v233, v[216:219] offset:40960
    v_alignbit_b32 v91, v92, v91, v232
    v_alignbit_b32 v101, v102, v101, v232
    v_alignbit_b32 v111, v112, v111, v232
    v_alignbit_b32 v121, v122, v121, v232
    v_alignbit_b32 v131, v132, v131, v232
    v_alignbit_b32 v141, v142, v141, v232
    v_alignbit_b32 v151, v152, v151, v232
    v_alignbit_b32 v161, v162, v161, v232
    v_perm_b32 v220, v101, v91, s2
    v_perm_b32 v221, v121, v111, s2
    v_perm_b32 v222, v141, v131, s2
    v_perm_b32 v223, v161, v151, s2
    ds_write_b128 v233, v[220:223] offset:49152
    v_perm_b32 v224, v101, v91, s3
    v_perm_b32 v225, v121, v111, s3
    v_perm_b32 v226, v141, v131, s3
    v_perm_b32 v227, v161, v151, s3
    ds_write_b128 v233, v[224:227] offset:57344
    v_alignbit_b32 v92, v92, v92, v232
    v_alignbit_b32 v102, v102, v102, v232
    v_alignbit_b32 v112, v112, v112, v232
    v_alignbit_b32 v122, v122, v122, v232
    v_alignbit_b32 v132, v132, v132, v232
    v_alignbit_b32 v142, v142, v142, v232
    v_alignbit_b32 v152, v152, v152, v232
    v_alignbit_b32 v162, v162, v162, v232
    v_perm_b32 v196, v102, v92, s2
    v_perm_b32 v197, v122, v112, s2
    v_perm_b32 v198, v142, v132, s2
    v_perm_b32 v199, v162, v152, s2
    ds_write_b128 v235, v[196:199] offset:0
    s_waitcnt lgkmcnt(0)
    s_cmp_lg_u32 s58, 0
    s_cbranch_scc1 wall_138
    v_mov_b32 v236, 40
wctr_139:
    buffer_load_dword v235, v236, s[12:15], 0 offen sc1
    s_waitcnt vmcnt(0)
    v_cmp_gt_u16 vcc, 32, v235
    s_cbranch_vccz wctr_ok_140
    s_sub_u32 s77, s77, 1
    s_cbranch_scc0 wctr_139
    s_mov_b32 s77, 0
wctr_ok_140:
wall_138:
    s_barrier
    s_mov_b32 s7, s58
colloop_141:
    s_lshl_b32 s3, s79, 4
    s_add_u32 s3, s3, s7
    s_lshl_b32 s3, s3, 1
    s_cmp_eq_u32 s3, 1024
    s_cselect_b32 s3, 1, s3
    s_cmp_lt_u32 s3, 2
    s_cselect_b32 s6, 0x5ffffff0, 0
    s_mov_b32 s4, 0x35800000
    s_cselect_b32 s4, 0x35000000, s4
    v_bfe_u32 v231, v1, 0, 5
    v_lshlrev_b32 v231, 16, v231
    v_bfe_u32 v235, v1, 5, 1
    v_lshl_or_b32 v231, v235, 9, v231
    v_add_u32 v232, s6, v231
    s_bfe_u32 s5, s3, 0x50000
    s_lshl_b32 s5, s5, 4
    s_bfe_u32 s2, s3, 0x50005
    s_lshl_b32 s2, s2, 11
    s_or_b32 s5, s5, s2
    s_add_u32 s5, s5, 0x5400000
    buffer_load_dwordx4 v[84:87], v231, s[8:11], s5 offen offset:0
    buffer_load_dwordx4 v[100:103], v232, s[8:11], s5 offen offset:16
    buffer_load_dwordx4 v[88:91], v231, s[8:11], s5 offen offset:1024
    buffer_load_dwordx4 v[104:107], v232, s[8:11], s5 offen offset:1040
    s_add_u32 s5, s5, 2097152
    buffer_load_dwordx4 v[92:95], v231, s[8:11], s5 offen offset:0
    buffer_load_dwordx4 v[108:111], v232, s[8:11], s5 offen offset:16
    buffer_load_dwordx4 v[96:99], v231, s[8:11], s5 offen offset:1024
    buffer_load_dwordx4 v[112:115], v232, s[8:11], s5 offen offset:1040
    s_add_u32 s5, s5, 2097152
    s_lshl_b32 s5, s7, 13
    v_lshl_add_u32 v235, v1, 4, s5
    ds_read_b128 v[196:199], v235 offset:0
    ds_read_b128 v[200:203], v235 offset:1024
    ds_read_b128 v[204:207], v235 offset:2048
    ds_read_b128 v[208:211], v235 offset:3072
    ds_read_b128 v[212:215], v235 offset:4096
    ds_read_b128 v[216:219], v235 offset:5120
    ds_read_b128 v[220:223], v235 offset:6144
    ds_read_b128 v[224:227], v235 offset:7168
    v_and_b32 v236, 31, v1
    v_cvt_f32_u32 v228, v236
    v_mov_b32 v229, v234
    s_waitcnt vmcnt(0) lgkmcnt(0)
    v_xor_b32 v116, 0x80008000, v84
    v_xor_b32 v117, 0x80008000, v85
    v_xor_b32 v118, 0x80008000, v86
    v_xor_b32 v119, 0x80008000, v87
    v_xor_b32 v120, 0x80008000, v88
    v_xor_b32 v121, 0x80008000, v89
    v_xor_b32 v122, 0x80008000, v90
    v_xor_b32 v123, 0x80008000, v91
    v_xor_b32 v124, 0x80008000, v92
    v_xor_b32 v125, 0x80008000, v93
    v_xor_b32 v126, 0x80008000, v94
    v_xor_b32 v127, 0x80008000, v95
    v_xor_b32 v128, 0x80008000, v96
    v_xor_b32 v129, 0x80008000, v97
    v_xor_b32 v130, 0x80008000, v98
    v_xor_b32 v131, 0x80008000, v99
    v_mfma_f32_32x32x16_bf16 v[132:147], v[84:87], v[68:71], 0
    v_mfma_f32_32x32x16_bf16 v[164:179], v[100:103], v[68:71], 0
    v_mfma_f32_32x32x16_bf16 v[132:147], v[100:103], v[76:79], v[132:147]
    v_mfma_f32_32x32x16_bf16 v[164:179], v[116:119], v[76:79], v[164:179]
    v_mfma_f32_32x32x16_bf16 v[132:147], v[88:91], v[72:75], v[132:147]
    v_mfma_f32_32x32x16_bf16 v[164:179], v[104:107], v[72:75], v[164:179]
    v_mfma_f32_32x32x16_bf16 v[132:147], v[104:107], v[80:83], v[132:147]
    v_mfma_f32_32x32x16_bf16 v[164:179], v[120:123], v[80:83], v[164:179]
    v_mfma_f32_32x32x16_bf16 v[148:163], v[92:95], v[68:71], 0
    v_mfma_f32_32x32x16_bf16 v[180:195], v[108:111], v[68:71], 0
    v_mfma_f32_32x32x16_bf16 v[148:163], v[108:111], v[76:79], v[148:163]
    v_mfma_f32_32x32x16_bf16 v[180:195], v[124:127], v[76:79], v[180:195]
    v_mfma_f32_32x32x16_bf16 v[148:163], v[96:99], v[72:75], v[148:163]
    v_mfma_f32_32x32x16_bf16 v[180:195], v[112:115], v[72:75], v[180:195]
    v_mfma_f32_32x32x16_bf16 v[148:163], v[112:115], v[80:83], v[148:163]
    v_mfma_f32_32x32x16_bf16 v[180:195], v[128:131], v[80:83], v[180:195]
    v_fmamk_f32 v243, v228, 0x0, v229
    v_cos_f32 v239, v243
    v_sin_f32 v240, v243
    v_mul_f32 v239, s4, v239
    v_mul_f32 v240, s4, v240
    v_mul_f32 v235, v132, v239
    v_mul_f32 v237, v164, v239
    v_fma_f32 v235, v164, v240, v235
    v_fma_f32 v237, -v132, v240, v237
    v_fmamk_f32 v243, v228, 0x3a000000, v229
    v_cos_f32 v241, v243
    v_sin_f32 v242, v243
    v_mul_f32 v241, s4, v241
    v_mul_f32 v242, s4, v242
    v_mul_f32 v236, v133, v241
    v_mul_f32 v238, v165, v241
    v_fma_f32 v236, v165, v242, v236
    v_fma_f32 v238, -v133, v242, v238
    v_cvt_pk_bf16_f32 v84, v235, v236
    v_cvt_pk_bf16_f32 v100, v237, v238
    v_cvt_pk_bf16_f32 v116, -v235, -v236
    v_fmamk_f32 v243, v228, 0x3a800000, v229
    v_cos_f32 v239, v243
    v_sin_f32 v240, v243
    v_mul_f32 v239, s4, v239
    v_mul_f32 v240, s4, v240
    v_mul_f32 v235, v134, v239
    v_mul_f32 v237, v166, v239
    v_fma_f32 v235, v166, v240, v235
    v_fma_f32 v237, -v134, v240, v237
    v_fmamk_f32 v243, v228, 0x3ac00000, v229
    v_cos_f32 v241, v243
    v_sin_f32 v242, v243
    v_mul_f32 v241, s4, v241
    v_mul_f32 v242, s4, v242
    v_mul_f32 v236, v135, v241
    v_mul_f32 v238, v167, v241
    v_fma_f32 v236, v167, v242, v236
    v_fma_f32 v238, -v135, v242, v238
    v_cvt_pk_bf16_f32 v85, v235, v236
    v_cvt_pk_bf16_f32 v101, v237, v238
    v_cvt_pk_bf16_f32 v117, -v235, -v236
    v_fmamk_f32 v243, v228, 0x3b800000, v229
    v_cos_f32 v239, v243
    v_sin_f32 v240, v243
    v_mul_f32 v239, s4, v239
    v_mul_f32 v240, s4, v240
    v_mul_f32 v235, v136, v239
    v_mul_f32 v237, v168, v239
    v_fma_f32 v235, v168, v240, v235
    v_fma_f32 v237, -v136, v240, v237
    v_fmamk_f32 v243, v228, 0x3b900000, v229
    v_cos_f32 v241, v243
    v_sin_f32 v242, v243
    v_mul_f32 v241, s4, v241
    v_mul_f32 v242, s4, v242
    v_mul_f32 v236, v137, v241
    v_mul_f32 v238, v169, v241
    v_fma_f32 v236, v169, v242, v236
    v_fma_f32 v238, -v137, v242, v238
    v_cvt_pk_bf16_f32 v86, v235, v236
    v_cvt_pk_bf16_f32 v102, v237, v238
    v_cvt_pk_bf16_f32 v118, -v235, -v236
    v_fmamk_f32 v243, v228, 0x3ba00000, v229
    v_cos_f32 v239, v243
    v_sin_f32 v240, v243
    v_mul_f32 v239, s4, v239
    v_mul_f32 v240, s4, v240
    v_mul_f32 v235, v138, v239
    v_mul_f32 v237, v170, v239
    v_fma_f32 v235, v170, v240, v235
    v_fma_f32 v237, -v138, v240, v237
    v_fmamk_f32 v243, v228, 0x3bb00000, v229
    v_cos_f32 v241, v243
    v_sin_f32 v242, v243
    v_mul_f32 v241, s4, v241
    v_mul_f32 v242, s4, v242
    v_mul_f32 v236, v139, v241
    v_mul_f32 v238, v171, v241
    v_fma_f32 v236, v171, v242, v236
    v_fma_f32 v238, -v139, v242, v238
    v_cvt_pk_bf16_f32 v87, v235, v236
    v_cvt_pk_bf16_f32 v103, v237, v238
    v_cvt_pk_bf16_f32 v119, -v235, -v236
    v_fmamk_f32 v243, v228, 0x3c000000, v229
    v_cos_f32 v239, v243
    v_sin_f32 v240, v243
    v_mul_f32 v239, s4, v239
    v_mul_f32 v240, s4, v240
    v_mul_f32 v235, v140, v239
    v_mul_f32 v237, v172, v239
    v_fma_f32 v235, v172, v240, v235
    v_fma_f32 v237, -v140, v240, v237
    v_fmamk_f32 v243, v228, 0x3c080000, v229
    v_cos_f32 v241, v243
    v_sin_f32 v242, v243
    v_mul_f32 v241, s4, v241
    v_mul_f32 v242, s4, v242
    v_mul_f32 v236, v141, v241
    v_mul_f32 v238, v173, v241
    v_fma_f32 v236, v173, v242, v236
    v_fma_f32 v238, -v141, v242, v238
    v_cvt_pk_bf16_f32 v88, v235, v236
    v_cvt_pk_bf16_f32 v104, v237, v238
    v_cvt_pk_bf16_f32 v120, -v235, -v236
    v_fmamk_f32 v243, v228, 0x3c100000, v229
    v_cos_f32 v239, v243
    v_sin_f32 v240, v243
    v_mul_f32 v239, s4, v239
    v_mul_f32 v240, s4, v240
    v_mul_f32 v235, v142, v239
    v_mul_f32 v237, v174, v239
    v_fma_f32 v235, v174, v240, v235
    v_fma_f32 v237, -v142, v240, v237
    v_fmamk_f32 v243, v228, 0x3c180000, v229
    v_cos_f32 v241, v243
    v_sin_f32 v242, v243
    v_mul_f32 v241, s4, v241
    v_mul_f32 v242, s4, v242
    v_mul_f32 v236, v143, v241
    v_mul_f32 v238, v175, v241
    v_fma_f32 v236, v175, v242, v236
    v_fma_f32 v238, -v143, v242, v238
    v_cvt_pk_bf16_f32 v89, v235, v236
    v_cvt_pk_bf16_f32 v105, v237, v238
    v_cvt_pk_bf16_f32 v121, -v235, -v236
    v_fmamk_f32 v243, v228, 0x3c400000, v229
    v_cos_f32 v239, v243
    v_sin_f32 v240, v243
    v_mul_f32 v239, s4, v239
    v_mul_f32 v240, s4, v240
    v_mul_f32 v235, v144, v239
    v_mul_f32 v237, v176, v239
    v_fma_f32 v235, v176, v240, v235
    v_fma_f32 v237, -v144, v240, v237
    v_fmamk_f32 v243, v228, 0x3c480000, v229
    v_cos_f32 v241, v243
    v_sin_f32 v242, v243
    v_mul_f32 v241, s4, v241
    v_mul_f32 v242, s4, v242
    v_mul_f32 v236, v145, v241
    v_mul_f32 v238, v177, v241
    v_fma_f32 v236, v177, v242, v236
    v_fma_f32 v238, -v145, v242, v238
    v_cvt_pk_bf16_f32 v90, v235, v236
    v_cvt_pk_bf16_f32 v106, v237, v238
    v_cvt_pk_bf16_f32 v122, -v235, -v236
    v_fmamk_f32 v243, v228, 0x3c500000, v229
    v_cos_f32 v239, v243
    v_sin_f32 v240, v243
    v_mul_f32 v239, s4, v239
    v_mul_f32 v240, s4, v240
    v_mul_f32 v235, v146, v239
    v_mul_f32 v237, v178, v239
    v_fma_f32 v235, v178, v240, v235
    v_fma_f32 v237, -v146, v240, v237
    v_fmamk_f32 v243, v228, 0x3c580000, v229
    v_cos_f32 v241, v243
    v_sin_f32 v242, v243
    v_mul_f32 v241, s4, v241
    v_mul_f32 v242, s4, v242
    v_mul_f32 v236, v147, v241
    v_mul_f32 v238, v179, v241
    v_fma_f32 v236, v179, v242, v236
    v_fma_f32 v238, -v147, v242, v238
    v_cvt_pk_bf16_f32 v91, v235, v236
    v_cvt_pk_bf16_f32 v107, v237, v238
    v_cvt_pk_bf16_f32 v123, -v235, -v236
    v_fmamk_f32 v243, v228, 0x3c800000, v229
    v_cos_f32 v239, v243
    v_sin_f32 v240, v243
    v_mul_f32 v239, s4, v239
    v_mul_f32 v240, s4, v240
    v_mul_f32 v235, v148, v239
    v_mul_f32 v237, v180, v239
    v_fma_f32 v235, v180, v240, v235
    v_fma_f32 v237, -v148, v240, v237
    v_fmamk_f32 v243, v228, 0x3c840000, v229
    v_cos_f32 v241, v243
    v_sin_f32 v242, v243
    v_mul_f32 v241, s4, v241
    v_mul_f32 v242, s4, v242
    v_mul_f32 v236, v149, v241
    v_mul_f32 v238, v181, v241
    v_fma_f32 v236, v181, v242, v236
    v_fma_f32 v238, -v149, v242, v238
    v_cvt_pk_bf16_f32 v92, v235, v236
    v_cvt_pk_bf16_f32 v108, v237, v238
    v_cvt_pk_bf16_f32 v124, -v235, -v236
    v_fmamk_f32 v243, v228, 0x3c880000, v229
    v_cos_f32 v239, v243
    v_sin_f32 v240, v243
    v_mul_f32 v239, s4, v239
    v_mul_f32 v240, s4, v240
    v_mul_f32 v235, v150, v239
    v_mul_f32 v237, v182, v239
    v_fma_f32 v235, v182, v240, v235
    v_fma_f32 v237, -v150, v240, v237
    v_fmamk_f32 v243, v228, 0x3c8c0000, v229
    v_cos_f32 v241, v243
    v_sin_f32 v242, v243
    v_mul_f32 v241, s4, v241
    v_mul_f32 v242, s4, v242
    v_mul_f32 v236, v151, v241
    v_mul_f32 v238, v183, v241
    v_fma_f32 v236, v183, v242, v236
    v_fma_f32 v238, -v151, v242, v238
    v_cvt_pk_bf16_f32 v93, v235, v236
    v_cvt_pk_bf16_f32 v109, v237, v238
    v_cvt_pk_bf16_f32 v125, -v235, -v236
    v_fmamk_f32 v243, v228, 0x3ca00000, v229
    v_cos_f32 v239, v243
    v_sin_f32 v240, v243
    v_mul_f32 v239, s4, v239
    v_mul_f32 v240, s4, v240
    v_mul_f32 v235, v152, v239
    v_mul_f32 v237, v184, v239
    v_fma_f32 v235, v184, v240, v235
    v_fma_f32 v237, -v152, v240, v237
    v_fmamk_f32 v243, v228, 0x3ca40000, v229
    v_cos_f32 v241, v243
    v_sin_f32 v242, v243
    v_mul_f32 v241, s4, v241
    v_mul_f32 v242, s4, v242
    v_mul_f32 v236, v153, v241
    v_mul_f32 v238, v185, v241
    v_fma_f32 v236, v185, v242, v236
    v_fma_f32 v238, -v153, v242, v238
    v_cvt_pk_bf16_f32 v94, v235, v236
    v_cvt_pk_bf16_f32 v110, v237, v238
    v_cvt_pk_bf16_f32 v126, -v235, -v236
    v_fmamk_f32 v243, v228, 0x3ca80000, v229
    v_cos_f32 v239, v243
    v_sin_f32 v240, v243
    v_mul_f32 v239, s4, v239
    v_mul_f32 v240, s4, v240
    v_mul_f32 v235, v154, v239
    v_mul_f32 v237, v186, v239
    v_fma_f32 v235, v186, v240, v235
    v_fma_f32 v237, -v154, v240, v237
    v_fmamk_f32 v243, v228, 0x3cac0000, v229
    v_cos_f32 v241, v243
    v_sin_f32 v242, v243
    v_mul_f32 v241, s4, v241
    v_mul_f32 v242, s4, v242
    v_mul_f32 v236, v155, v241
    v_mul_f32 v238, v187, v241
    v_fma_f32 v236, v187, v242, v236
    v_fma_f32 v238, -v155, v242, v238
    v_cvt_pk_bf16_f32 v95, v235, v236
    v_cvt_pk_bf16_f32 v111, v237, v238
    v_cvt_pk_bf16_f32 v127, -v235, -v236
    v_fmamk_f32 v243, v228, 0x3cc00000, v229
    v_cos_f32 v239, v243
    v_sin_f32 v240, v243
    v_mul_f32 v239, s4, v239
    v_mul_f32 v240, s4, v240
    v_mul_f32 v235, v156, v239
    v_mul_f32 v237, v188, v239
    v_fma_f32 v235, v188, v240, v235
    v_fma_f32 v237, -v156, v240, v237
    v_fmamk_f32 v243, v228, 0x3cc40000, v229
    v_cos_f32 v241, v243
    v_sin_f32 v242, v243
    v_mul_f32 v241, s4, v241
    v_mul_f32 v242, s4, v242
    v_mul_f32 v236, v157, v241
    v_mul_f32 v238, v189, v241
    v_fma_f32 v236, v189, v242, v236
    v_fma_f32 v238, -v157, v242, v238
    v_cvt_pk_bf16_f32 v96, v235, v236
    v_cvt_pk_bf16_f32 v112, v237, v238
    v_cvt_pk_bf16_f32 v128, -v235, -v236
    v_fmamk_f32 v243, v228, 0x3cc80000, v229
    v_cos_f32 v239, v243
    v_sin_f32 v240, v243
    v_mul_f32 v239, s4, v239
    v_mul_f32 v240, s4, v240
    v_mul_f32 v235, v158, v239
    v_mul_f32 v237, v190, v239
    v_fma_f32 v235, v190, v240, v235
    v_fma_f32 v237, -v158, v240, v237
    v_fmamk_f32 v243, v228, 0x3ccc0000, v229
    v_cos_f32 v241, v243
    v_sin_f32 v242, v243
    v_mul_f32 v241, s4, v241
    v_mul_f32 v242, s4, v242
    v_mul_f32 v236, v159, v241
    v_mul_f32 v238, v191, v241
    v_fma_f32 v236, v191, v242, v236
    v_fma_f32 v238, -v159, v242, v238
    v_cvt_pk_bf16_f32 v97, v235, v236
    v_cvt_pk_bf16_f32 v113, v237, v238
    v_cvt_pk_bf16_f32 v129, -v235, -v236
    v_fmamk_f32 v243, v228, 0x3ce00000, v229
    v_cos_f32 v239, v243
    v_sin_f32 v240, v243
    v_mul_f32 v239, s4, v239
    v_mul_f32 v240, s4, v240
    v_mul_f32 v235, v160, v239
    v_mul_f32 v237, v192, v239
    v_fma_f32 v235, v192, v240, v235
    v_fma_f32 v237, -v160, v240, v237
    v_fmamk_f32 v243, v228, 0x3ce40000, v229
    v_cos_f32 v241, v243
    v_sin_f32 v242, v243
    v_mul_f32 v241, s4, v241
    v_mul_f32 v242, s4, v242
    v_mul_f32 v236, v161, v241
    v_mul_f32 v238, v193, v241
    v_fma_f32 v236, v193, v242, v236
    v_fma_f32 v238, -v161, v242, v238
    v_cvt_pk_bf16_f32 v98, v235, v236
    v_cvt_pk_bf16_f32 v114, v237, v238
    v_cvt_pk_bf16_f32 v130, -v235, -v236
    v_fmamk_f32 v243, v228, 0x3ce80000, v229
    v_cos_f32 v239, v243
    v_sin_f32 v240, v243
    v_mul_f32 v239, s4, v239
    v_mul_f32 v240, s4, v240
    v_mul_f32 v235, v162, v239
    v_mul_f32 v237, v194, v239
    v_fma_f32 v235, v194, v240, v235
    v_fma_f32 v237, -v162, v240, v237
    v_fmamk_f32 v243, v228, 0x3cec0000, v229
    v_cos_f32 v241, v243
    v_sin_f32 v242, v243
    v_mul_f32 v241, s4, v241
    v_mul_f32 v242, s4, v242
    v_mul_f32 v236, v163, v241
    v_mul_f32 v238, v195, v241
    v_fma_f32 v236, v195, v242, v236
    v_fma_f32 v238, -v163, v242, v238
    v_cvt_pk_bf16_f32 v99, v235, v236
    v_cvt_pk_bf16_f32 v115, v237, v238
    v_cvt_pk_bf16_f32 v131, -v235, -v236
    v_mfma_f32_32x32x16_bf16 v[132:147], v[4:7], v[84:87], 0
    v_mfma_f32_32x32x16_bf16 v[164:179], v[4:7], v[100:103], 0
    v_mfma_f32_32x32x16_bf16 v[132:147], v[36:39], v[100:103], v[132:147]
    v_mfma_f32_32x32x16_bf16 v[164:179], v[36:39], v[116:119], v[164:179]
    v_mfma_f32_32x32x16_bf16 v[132:147], v[8:11], v[88:91], v[132:147]
    v_mfma_f32_32x32x16_bf16 v[164:179], v[8:11], v[104:107], v[164:179]
    v_mfma_f32_32x32x16_bf16 v[132:147], v[40:43], v[104:107], v[132:147]
    v_mfma_f32_32x32x16_bf16 v[164:179], v[40:43], v[120:123], v[164:179]
    v_mfma_f32_32x32x16_bf16 v[132:147], v[12:15], v[92:95], v[132:147]
    v_mfma_f32_32x32x16_bf16 v[164:179], v[12:15], v[108:111], v[164:179]
    v_mfma_f32_32x32x16_bf16 v[132:147], v[44:47], v[108:111], v[132:147]
    v_mfma_f32_32x32x16_bf16 v[164:179], v[44:47], v[124:127], v[164:179]
    v_mfma_f32_32x32x16_bf16 v[132:147], v[16:19], v[96:99], v[132:147]
    v_mfma_f32_32x32x16_bf16 v[164:179], v[16:19], v[112:115], v[164:179]
    v_mfma_f32_32x32x16_bf16 v[132:147], v[48:51], v[112:115], v[132:147]
    v_mfma_f32_32x32x16_bf16 v[164:179], v[48:51], v[128:131], v[164:179]
    v_mfma_f32_32x32x16_bf16 v[148:163], v[20:23], v[84:87], 0
    v_mfma_f32_32x32x16_bf16 v[180:195], v[20:23], v[100:103], 0
    v_mfma_f32_32x32x16_bf16 v[148:163], v[52:55], v[100:103], v[148:163]
    v_mfma_f32_32x32x16_bf16 v[180:195], v[52:55], v[116:119], v[180:195]
    v_mfma_f32_32x32x16_bf16 v[148:163], v[24:27], v[88:91], v[148:163]
    v_mfma_f32_32x32x16_bf16 v[180:195], v[24:27], v[104:107], v[180:195]
    v_mfma_f32_32x32x16_bf16 v[148:163], v[56:59], v[104:107], v[148:163]
    v_mfma_f32_32x32x16_bf16 v[180:195], v[56:59], v[120:123], v[180:195]
    v_mfma_f32_32x32x16_bf16 v[148:163], v[28:31], v[92:95], v[148:163]
    v_mfma_f32_32x32x16_bf16 v[180:195], v[28:31], v[108:111], v[180:195]
    v_mfma_f32_32x32x16_bf16 v[148:163], v[60:63], v[108:111], v[148:163]
    v_mfma_f32_32x32x16_bf16 v[180:195], v[60:63], v[124:127], v[180:195]
    v_mfma_f32_32x32x16_bf16 v[148:163], v[32:35], v[96:99], v[148:163]
    v_mfma_f32_32x32x16_bf16 v[180:195], v[32:35], v[112:115], v[180:195]
    v_mfma_f32_32x32x16_bf16 v[148:163], v[64:67], v[112:115], v[148:163]
    v_mfma_f32_32x32x16_bf16 v[180:195], v[64:67], v[128:131], v[180:195]
    v_lshlrev_b32 v239, 16, v196
    v_and_b32 v240, 0xffff0000, v196
    v_mul_f32 v235, v132, v239
    v_mul_f32 v237, v164, v239
    v_fma_f32 v235, -v164, v240, v235
    v_fma_f32 v237, v132, v240, v237
    v_lshlrev_b32 v241, 16, v197
    v_and_b32 v242, 0xffff0000, v197
    v_mul_f32 v236, v133, v241
    v_mul_f32 v238, v165, v241
    v_fma_f32 v236, -v165, v242, v236
    v_fma_f32 v238, v133, v242, v238
    v_cvt_pk_bf16_f32 v84, v235, v236
    v_cvt_pk_bf16_f32 v100, v237, v238
    v_cvt_pk_bf16_f32 v116, -v237, -v238
    v_lshlrev_b32 v239, 16, v198
    v_and_b32 v240, 0xffff0000, v198
    v_mul_f32 v235, v134, v239
    v_mul_f32 v237, v166, v239
    v_fma_f32 v235, -v166, v240, v235
    v_fma_f32 v237, v134, v240, v237
    v_lshlrev_b32 v241, 16, v199
    v_and_b32 v242, 0xffff0000, v199
    v_mul_f32 v236, v135, v241
    v_mul_f32 v238, v167, v241
    v_fma_f32 v236, -v167, v242, v236
    v_fma_f32 v238, v135, v242, v238
    v_cvt_pk_bf16_f32 v85, v235, v236
    v_cvt_pk_bf16_f32 v101, v237, v238
    v_cvt_pk_bf16_f32 v117, -v237, -v238
    v_lshlrev_b32 v239, 16, v200
    v_and_b32 v240, 0xffff0000, v200
    v_mul_f32 v235, v136, v239
    v_mul_f32 v237, v168, v239
    v_fma_f32 v235, -v168, v240, v235
    v_fma_f32 v237, v136, v240, v237
    v_lshlrev_b32 v241, 16, v201
    v_and_b32 v242, 0xffff0000, v201
    v_mul_f32 v236, v137, v241
    v_mul_f32 v238, v169, v241
    v_fma_f32 v236, -v169, v242, v236
    v_fma_f32 v238, v137, v242, v238
    v_cvt_pk_bf16_f32 v86, v235, v236
    v_cvt_pk_bf16_f32 v102, v237, v238
    v_cvt_pk_bf16_f32 v118, -v237, -v238
    v_lshlrev_b32 v239, 16, v202
    v_and_b32 v240, 0xffff0000, v202
    v_mul_f32 v235, v138, v239
    v_mul_f32 v237, v170, v239
    v_fma_f32 v235, -v170, v240, v235
    v_fma_f32 v237, v138, v240, v237
    v_lshlrev_b32 v241, 16, v203
    v_and_b32 v242, 0xffff0000, v203
    v_mul_f32 v236, v139, v241
    v_mul_f32 v238, v171, v241
    v_fma_f32 v236, -v171, v242, v236
    v_fma_f32 v238, v139, v242, v238
    v_cvt_pk_bf16_f32 v87, v235, v236
    v_cvt_pk_bf16_f32 v103, v237, v238
    v_cvt_pk_bf16_f32 v119, -v237, -v238
    v_lshlrev_b32 v239, 16, v204
    v_and_b32 v240, 0xffff0000, v204
    v_mul_f32 v235, v140, v239
    v_mul_f32 v237, v172, v239
    v_fma_f32 v235, -v172, v240, v235
    v_fma_f32 v237, v140, v240, v237
    v_lshlrev_b32 v241, 16, v205
    v_and_b32 v242, 0xffff0000, v205
    v_mul_f32 v236, v141, v241
    v_mul_f32 v238, v173, v241
    v_fma_f32 v236, -v173, v242, v236
    v_fma_f32 v238, v141, v242, v238
    v_cvt_pk_bf16_f32 v88, v235, v236
    v_cvt_pk_bf16_f32 v104, v237, v238
    v_cvt_pk_bf16_f32 v120, -v237, -v238
    v_lshlrev_b32 v239, 16, v206
    v_and_b32 v240, 0xffff0000, v206
    v_mul_f32 v235, v142, v239
    v_mul_f32 v237, v174, v239
    v_fma_f32 v235, -v174, v240, v235
    v_fma_f32 v237, v142, v240, v237
    v_lshlrev_b32 v241, 16, v207
    v_and_b32 v242, 0xffff0000, v207
    v_mul_f32 v236, v143, v241
    v_mul_f32 v238, v175, v241
    v_fma_f32 v236, -v175, v242, v236
    v_fma_f32 v238, v143, v242, v238
    v_cvt_pk_bf16_f32 v89, v235, v236
    v_cvt_pk_bf16_f32 v105, v237, v238
    v_cvt_pk_bf16_f32 v121, -v237, -v238
    v_lshlrev_b32 v239, 16, v208
    v_and_b32 v240, 0xffff0000, v208
    v_mul_f32 v235, v144, v239
    v_mul_f32 v237, v176, v239
    v_fma_f32 v235, -v176, v240, v235
    v_fma_f32 v237, v144, v240, v237
    v_lshlrev_b32 v241, 16, v209
    v_and_b32 v242, 0xffff0000, v209
    v_mul_f32 v236, v145, v241
    v_mul_f32 v238, v177, v241
    v_fma_f32 v236, -v177, v242, v236
    v_fma_f32 v238, v145, v242, v238
    v_cvt_pk_bf16_f32 v90, v235, v236
    v_cvt_pk_bf16_f32 v106, v237, v238
    v_cvt_pk_bf16_f32 v122, -v237, -v238
    v_lshlrev_b32 v239, 16, v210
    v_and_b32 v240, 0xffff0000, v210
    v_mul_f32 v235, v146, v239
    v_mul_f32 v237, v178, v239
    v_fma_f32 v235, -v178, v240, v235
    v_fma_f32 v237, v146, v240, v237
    v_lshlrev_b32 v241, 16, v211
    v_and_b32 v242, 0xffff0000, v211
    v_mul_f32 v236, v147, v241
    v_mul_f32 v238, v179, v241
    v_fma_f32 v236, -v179, v242, v236
    v_fma_f32 v238, v147, v242, v238
    v_cvt_pk_bf16_f32 v91, v235, v236
    v_cvt_pk_bf16_f32 v107, v237, v238
    v_cvt_pk_bf16_f32 v123, -v237, -v238
    v_lshlrev_b32 v239, 16, v212
    v_and_b32 v240, 0xffff0000, v212
    v_mul_f32 v235, v148, v239
    v_mul_f32 v237, v180, v239
    v_fma_f32 v235, -v180, v240, v235
    v_fma_f32 v237, v148, v240, v237
    v_lshlrev_b32 v241, 16, v213
    v_and_b32 v242, 0xffff0000, v213
    v_mul_f32 v236, v149, v241
    v_mul_f32 v238, v181, v241
    v_fma_f32 v236, -v181, v242, v236
    v_fma_f32 v238, v149, v242, v238
    v_cvt_pk_bf16_f32 v92, v235, v236
    v_cvt_pk_bf16_f32 v108, v237, v238
    v_cvt_pk_bf16_f32 v124, -v237, -v238
    v_lshlrev_b32 v239, 16, v214
    v_and_b32 v240, 0xffff0000, v214
    v_mul_f32 v235, v150, v239
    v_mul_f32 v237, v182, v239
    v_fma_f32 v235, -v182, v240, v235
    v_fma_f32 v237, v150, v240, v237
    v_lshlrev_b32 v241, 16, v215
    v_and_b32 v242, 0xffff0000, v215
    v_mul_f32 v236, v151, v241
    v_mul_f32 v238, v183, v241
    v_fma_f32 v236, -v183, v242, v236
    v_fma_f32 v238, v151, v242, v238
    v_cvt_pk_bf16_f32 v93, v235, v236
    v_cvt_pk_bf16_f32 v109, v237, v238
    v_cvt_pk_bf16_f32 v125, -v237, -v238
    v_lshlrev_b32 v239, 16, v216
    v_and_b32 v240, 0xffff0000, v216
    v_mul_f32 v235, v152, v239
    v_mul_f32 v237, v184, v239
    v_fma_f32 v235, -v184, v240, v235
    v_fma_f32 v237, v152, v240, v237
    v_lshlrev_b32 v241, 16, v217
    v_and_b32 v242, 0xffff0000, v217
    v_mul_f32 v236, v153, v241
    v_mul_f32 v238, v185, v241
    v_fma_f32 v236, -v185, v242, v236
    v_fma_f32 v238, v153, v242, v238
    v_cvt_pk_bf16_f32 v94, v235, v236
    v_cvt_pk_bf16_f32 v110, v237, v238
    v_cvt_pk_bf16_f32 v126, -v237, -v238
    v_lshlrev_b32 v239, 16, v218
    v_and_b32 v240, 0xffff0000, v218
    v_mul_f32 v235, v154, v239
    v_mul_f32 v237, v186, v239
    v_fma_f32 v235, -v186, v240, v235
    v_fma_f32 v237, v154, v240, v237
    v_lshlrev_b32 v241, 16, v219
    v_and_b32 v242, 0xffff0000, v219
    v_mul_f32 v236, v155, v241
    v_mul_f32 v238, v187, v241
    v_fma_f32 v236, -v187, v242, v236
    v_fma_f32 v238, v155, v242, v238
    v_cvt_pk_bf16_f32 v95, v235, v236
    v_cvt_pk_bf16_f32 v111, v237, v238
    v_cvt_pk_bf16_f32 v127, -v237, -v238
    v_lshlrev_b32 v239, 16, v220
    v_and_b32 v240, 0xffff0000, v220
    v_mul_f32 v235, v156, v239
    v_mul_f32 v237, v188, v239
    v_fma_f32 v235, -v188, v240, v235
    v_fma_f32 v237, v156, v240, v237
    v_lshlrev_b32 v241, 16, v221
    v_and_b32 v242, 0xffff0000, v221
    v_mul_f32 v236, v157, v241
    v_mul_f32 v238, v189, v241
    v_fma_f32 v236, -v189, v242, v236
    v_fma_f32 v238, v157, v242, v238
    v_cvt_pk_bf16_f32 v96, v235, v236
    v_cvt_pk_bf16_f32 v112, v237, v238
    v_cvt_pk_bf16_f32 v128, -v237, -v238
    v_lshlrev_b32 v239, 16, v222
    v_and_b32 v240, 0xffff0000, v222
    v_mul_f32 v235, v158, v239
    v_mul_f32 v237, v190, v239
    v_fma_f32 v235, -v190, v240, v235
    v_fma_f32 v237, v158, v240, v237
    v_lshlrev_b32 v241, 16, v223
    v_and_b32 v242, 0xffff0000, v223
    v_mul_f32 v236, v159, v241
    v_mul_f32 v238, v191, v241
    v_fma_f32 v236, -v191, v242, v236
    v_fma_f32 v238, v159, v242, v238
    v_cvt_pk_bf16_f32 v97, v235, v236
    v_cvt_pk_bf16_f32 v113, v237, v238
    v_cvt_pk_bf16_f32 v129, -v237, -v238
    v_lshlrev_b32 v239, 16, v224
    v_and_b32 v240, 0xffff0000, v224
    v_mul_f32 v235, v160, v239
    v_mul_f32 v237, v192, v239
    v_fma_f32 v235, -v192, v240, v235
    v_fma_f32 v237, v160, v240, v237
    v_lshlrev_b32 v241, 16, v225
    v_and_b32 v242, 0xffff0000, v225
    v_mul_f32 v236, v161, v241
    v_mul_f32 v238, v193, v241
    v_fma_f32 v236, -v193, v242, v236
    v_fma_f32 v238, v161, v242, v238
    v_cvt_pk_bf16_f32 v98, v235, v236
    v_cvt_pk_bf16_f32 v114, v237, v238
    v_cvt_pk_bf16_f32 v130, -v237, -v238
    v_lshlrev_b32 v239, 16, v226
    v_and_b32 v240, 0xffff0000, v226
    v_mul_f32 v235, v162, v239
    v_mul_f32 v237, v194, v239
    v_fma_f32 v235, -v194, v240, v235
    v_fma_f32 v237, v162, v240, v237
    v_lshlrev_b32 v241, 16, v227
    v_and_b32 v242, 0xffff0000, v227
    v_mul_f32 v236, v163, v241
    v_mul_f32 v238, v195, v241
    v_fma_f32 v236, -v195, v242, v236
    v_fma_f32 v238, v163, v242, v238
    v_cvt_pk_bf16_f32 v99, v235, v236
    v_cvt_pk_bf16_f32 v115, v237, v238
    v_cvt_pk_bf16_f32 v131, -v237, -v238
    v_mfma_f32_32x32x16_bf16 v[132:147], v[84:87], v[4:7], 0
    v_mfma_f32_32x32x16_bf16 v[164:179], v[100:103], v[4:7], 0
    v_mfma_f32_32x32x16_bf16 v[132:147], v[116:119], v[36:39], v[132:147]
    v_mfma_f32_32x32x16_bf16 v[164:179], v[84:87], v[36:39], v[164:179]
    v_mfma_f32_32x32x16_bf16 v[132:147], v[88:91], v[8:11], v[132:147]
    v_mfma_f32_32x32x16_bf16 v[164:179], v[104:107], v[8:11], v[164:179]
    v_mfma_f32_32x32x16_bf16 v[132:147], v[120:123], v[40:43], v[132:147]
    v_mfma_f32_32x32x16_bf16 v[164:179], v[88:91], v[40:43], v[164:179]
    v_mfma_f32_32x32x16_bf16 v[132:147], v[92:95], v[12:15], v[132:147]
    v_mfma_f32_32x32x16_bf16 v[164:179], v[108:111], v[12:15], v[164:179]
    v_mfma_f32_32x32x16_bf16 v[132:147], v[124:127], v[44:47], v[132:147]
    v_mfma_f32_32x32x16_bf16 v[164:179], v[92:95], v[44:47], v[164:179]
    v_mfma_f32_32x32x16_bf16 v[132:147], v[96:99], v[16:19], v[132:147]
    v_mfma_f32_32x32x16_bf16 v[164:179], v[112:115], v[16:19], v[164:179]
    v_mfma_f32_32x32x16_bf16 v[132:147], v[128:131], v[48:51], v[132:147]
    v_mfma_f32_32x32x16_bf16 v[164:179], v[96:99], v[48:51], v[164:179]
    v_mfma_f32_32x32x16_bf16 v[148:163], v[84:87], v[20:23], 0
    v_mfma_f32_32x32x16_bf16 v[180:195], v[100:103], v[20:23], 0
    v_mfma_f32_32x32x16_bf16 v[148:163], v[116:119], v[52:55], v[148:163]
    v_mfma_f32_32x32x16_bf16 v[180:195], v[84:87], v[52:55], v[180:195]
    v_mfma_f32_32x32x16_bf16 v[148:163], v[88:91], v[24:27], v[148:163]
    v_mfma_f32_32x32x16_bf16 v[180:195], v[104:107], v[24:27], v[180:195]
    v_mfma_f32_32x32x16_bf16 v[148:163], v[120:123], v[56:59], v[148:163]
    v_mfma_f32_32x32x16_bf16 v[180:195], v[88:91], v[56:59], v[180:195]
    v_mfma_f32_32x32x16_bf16 v[148:163], v[92:95], v[28:31], v[148:163]
    v_mfma_f32_32x32x16_bf16 v[180:195], v[108:111], v[28:31], v[180:195]
    v_mfma_f32_32x32x16_bf16 v[148:163], v[124:127], v[60:63], v[148:163]
    v_mfma_f32_32x32x16_bf16 v[180:195], v[92:95], v[60:63], v[180:195]
    v_mfma_f32_32x32x16_bf16 v[148:163], v[96:99], v[32:35], v[148:163]
    v_mfma_f32_32x32x16_bf16 v[180:195], v[112:115], v[32:35], v[180:195]
    v_mfma_f32_32x32x16_bf16 v[148:163], v[128:131], v[64:67], v[148:163]
    v_mfma_f32_32x32x16_bf16 v[180:195], v[96:99], v[64:67], v[180:195]
    v_fmamk_f32 v243, v228, 0x0, v229
    v_cos_f32 v239, v243
    v_sin_f32 v240, v243
    v_mul_f32 v235, v132, v239
    v_mul_f32 v237, v164, v239
    v_fma_f32 v235, -v164, v240, v235
    v_fma_f32 v237, v132, v240, v237
    v_fmamk_f32 v243, v228, 0x3a000000, v229
    v_cos_f32 v241, v243
    v_sin_f32 v242, v243
    v_mul_f32 v236, v133, v241
    v_mul_f32 v238, v165, v241
    v_fma_f32 v236, -v165, v242, v236
    v_fma_f32 v238, v133, v242, v238
    v_cvt_pk_bf16_f32 v84, v235, v236
    v_cvt_pk_bf16_f32 v100, v237, v238
    v_cvt_pk_bf16_f32 v116, -v237, -v238
    v_fmamk_f32 v243, v228, 0x3a800000, v229
    v_cos_f32 v239, v243
    v_sin_f32 v240, v243
    v_mul_f32 v235, v134, v239
    v_mul_f32 v237, v166, v239
    v_fma_f32 v235, -v166, v240, v235
    v_fma_f32 v237, v134, v240, v237
    v_fmamk_f32 v243, v228, 0x3ac00000, v229
    v_cos_f32 v241, v243
    v_sin_f32 v242, v243
    v_mul_f32 v236, v135, v241
    v_mul_f32 v238, v167, v241
    v_fma_f32 v236, -v167, v242, v236
    v_fma_f32 v238, v135, v242, v238
    v_cvt_pk_bf16_f32 v85, v235, v236
    v_cvt_pk_bf16_f32 v101, v237, v238
    v_cvt_pk_bf16_f32 v117, -v237, -v238
    v_fmamk_f32 v243, v228, 0x3b800000, v229
    v_cos_f32 v239, v243
    v_sin_f32 v240, v243
    v_mul_f32 v235, v136, v239
    v_mul_f32 v237, v168, v239
    v_fma_f32 v235, -v168, v240, v235
    v_fma_f32 v237, v136, v240, v237
    v_fmamk_f32 v243, v228, 0x3b900000, v229
    v_cos_f32 v241, v243
    v_sin_f32 v242, v243
    v_mul_f32 v236, v137, v241
    v_mul_f32 v238, v169, v241
    v_fma_f32 v236, -v169, v242, v236
    v_fma_f32 v238, v137, v242, v238
    v_cvt_pk_bf16_f32 v86, v235, v236
    v_cvt_pk_bf16_f32 v102, v237, v238
    v_cvt_pk_bf16_f32 v118, -v237, -v238
    v_fmamk_f32 v243, v228, 0x3ba00000, v229
    v_cos_f32 v239, v243
    v_sin_f32 v240, v243
    v_mul_f32 v235, v138, v239
    v_mul_f32 v237, v170, v239
    v_fma_f32 v235, -v170, v240, v235
    v_fma_f32 v237, v138, v240, v237
    v_fmamk_f32 v243, v228, 0x3bb00000, v229
    v_cos_f32 v241, v243
    v_sin_f32 v242, v243
    v_mul_f32 v236, v139, v241
    v_mul_f32 v238, v171, v241
    v_fma_f32 v236, -v171, v242, v236
    v_fma_f32 v238, v139, v242, v238
    v_cvt_pk_bf16_f32 v87, v235, v236
    v_cvt_pk_bf16_f32 v103, v237, v238
    v_cvt_pk_bf16_f32 v119, -v237, -v238
    v_fmamk_f32 v243, v228, 0x3c000000, v229
    v_cos_f32 v239, v243
    v_sin_f32 v240, v243
    v_mul_f32 v235, v140, v239
    v_mul_f32 v237, v172, v239
    v_fma_f32 v235, -v172, v240, v235
    v_fma_f32 v237, v140, v240, v237
    v_fmamk_f32 v243, v228, 0x3c080000, v229
    v_cos_f32 v241, v243
    v_sin_f32 v242, v243
    v_mul_f32 v236, v141, v241
    v_mul_f32 v238, v173, v241
    v_fma_f32 v236, -v173, v242, v236
    v_fma_f32 v238, v141, v242, v238
    v_cvt_pk_bf16_f32 v88, v235, v236
    v_cvt_pk_bf16_f32 v104, v237, v238
    v_cvt_pk_bf16_f32 v120, -v237, -v238
    v_fmamk_f32 v243, v228, 0x3c100000, v229
    v_cos_f32 v239, v243
    v_sin_f32 v240, v243
    v_mul_f32 v235, v142, v239
    v_mul_f32 v237, v174, v239
    v_fma_f32 v235, -v174, v240, v235
    v_fma_f32 v237, v142, v240, v237
    v_fmamk_f32 v243, v228, 0x3c180000, v229
    v_cos_f32 v241, v243
    v_sin_f32 v242, v243
    v_mul_f32 v236, v143, v241
    v_mul_f32 v238, v175, v241
    v_fma_f32 v236, -v175, v242, v236
    v_fma_f32 v238, v143, v242, v238
    v_cvt_pk_bf16_f32 v89, v235, v236
    v_cvt_pk_bf16_f32 v105, v237, v238
    v_cvt_pk_bf16_f32 v121, -v237, -v238
    v_fmamk_f32 v243, v228, 0x3c400000, v229
    v_cos_f32 v239, v243
    v_sin_f32 v240, v243
    v_mul_f32 v235, v144, v239
    v_mul_f32 v237, v176, v239
    v_fma_f32 v235, -v176, v240, v235
    v_fma_f32 v237, v144, v240, v237
    v_fmamk_f32 v243, v228, 0x3c480000, v229
    v_cos_f32 v241, v243
    v_sin_f32 v242, v243
    v_mul_f32 v236, v145, v241
    v_mul_f32 v238, v177, v241
    v_fma_f32 v236, -v177, v242, v236
    v_fma_f32 v238, v145, v242, v238
    v_cvt_pk_bf16_f32 v90, v235, v236
    v_cvt_pk_bf16_f32 v106, v237, v238
    v_cvt_pk_bf16_f32 v122, -v237, -v238
    v_fmamk_f32 v243, v228, 0x3c500000, v229
    v_cos_f32 v239, v243
    v_sin_f32 v240, v243
    v_mul_f32 v235, v146, v239
    v_mul_f32 v237, v178, v239
    v_fma_f32 v235, -v178, v240, v235
    v_fma_f32 v237, v146, v240, v237
    v_fmamk_f32 v243, v228, 0x3c580000, v229
    v_cos_f32 v241, v243
    v_sin_f32 v242, v243
    v_mul_f32 v236, v147, v241
    v_mul_f32 v238, v179, v241
    v_fma_f32 v236, -v179, v242, v236
    v_fma_f32 v238, v147, v242, v238
    v_cvt_pk_bf16_f32 v91, v235, v236
    v_cvt_pk_bf16_f32 v107, v237, v238
    v_cvt_pk_bf16_f32 v123, -v237, -v238
    v_add_f32 v228, 0x42000000, v228
    v_mov_b32 v229, v230
    v_fmamk_f32 v243, v228, 0x0, v229
    v_cos_f32 v239, v243
    v_sin_f32 v240, v243
    v_mul_f32 v235, v148, v239
    v_mul_f32 v237, v180, v239
    v_fma_f32 v235, -v180, v240, v235
    v_fma_f32 v237, v148, v240, v237
    v_fmamk_f32 v243, v228, 0x3a000000, v229
    v_cos_f32 v241, v243
    v_sin_f32 v242, v243
    v_mul_f32 v236, v149, v241
    v_mul_f32 v238, v181, v241
    v_fma_f32 v236, -v181, v242, v236
    v_fma_f32 v238, v149, v242, v238
    v_cvt_pk_bf16_f32 v92, v235, v236
    v_cvt_pk_bf16_f32 v108, v237, v238
    v_cvt_pk_bf16_f32 v124, -v237, -v238
    v_fmamk_f32 v243, v228, 0x3a800000, v229
    v_cos_f32 v239, v243
    v_sin_f32 v240, v243
    v_mul_f32 v235, v150, v239
    v_mul_f32 v237, v182, v239
    v_fma_f32 v235, -v182, v240, v235
    v_fma_f32 v237, v150, v240, v237
    v_fmamk_f32 v243, v228, 0x3ac00000, v229
    v_cos_f32 v241, v243
    v_sin_f32 v242, v243
    v_mul_f32 v236, v151, v241
    v_mul_f32 v238, v183, v241
    v_fma_f32 v236, -v183, v242, v236
    v_fma_f32 v238, v151, v242, v238
    v_cvt_pk_bf16_f32 v93, v235, v236
    v_cvt_pk_bf16_f32 v109, v237, v238
    v_cvt_pk_bf16_f32 v125, -v237, -v238
    v_fmamk_f32 v243, v228, 0x3b800000, v229
    v_cos_f32 v239, v243
    v_sin_f32 v240, v243
    v_mul_f32 v235, v152, v239
    v_mul_f32 v237, v184, v239
    v_fma_f32 v235, -v184, v240, v235
    v_fma_f32 v237, v152, v240, v237
    v_fmamk_f32 v243, v228, 0x3b900000, v229
    v_cos_f32 v241, v243
    v_sin_f32 v242, v243
    v_mul_f32 v236, v153, v241
    v_mul_f32 v238, v185, v241
    v_fma_f32 v236, -v185, v242, v236
    v_fma_f32 v238, v153, v242, v238
    v_cvt_pk_bf16_f32 v94, v235, v236
    v_cvt_pk_bf16_f32 v110, v237, v238
    v_cvt_pk_bf16_f32 v126, -v237, -v238
    v_fmamk_f32 v243, v228, 0x3ba00000, v229
    v_cos_f32 v239, v243
    v_sin_f32 v240, v243
    v_mul_f32 v235, v154, v239
    v_mul_f32 v237, v186, v239
    v_fma_f32 v235, -v186, v240, v235
    v_fma_f32 v237, v154, v240, v237
    v_fmamk_f32 v243, v228, 0x3bb00000, v229
    v_cos_f32 v241, v243
    v_sin_f32 v242, v243
    v_mul_f32 v236, v155, v241
    v_mul_f32 v238, v187, v241
    v_fma_f32 v236, -v187, v242, v236
    v_fma_f32 v238, v155, v242, v238
    v_cvt_pk_bf16_f32 v95, v235, v236
    v_cvt_pk_bf16_f32 v111, v237, v238
    v_cvt_pk_bf16_f32 v127, -v237, -v238
    v_fmamk_f32 v243, v228, 0x3c000000, v229
    v_cos_f32 v239, v243
    v_sin_f32 v240, v243
    v_mul_f32 v235, v156, v239
    v_mul_f32 v237, v188, v239
    v_fma_f32 v235, -v188, v240, v235
    v_fma_f32 v237, v156, v240, v237
    v_fmamk_f32 v243, v228, 0x3c080000, v229
    v_cos_f32 v241, v243
    v_sin_f32 v242, v243
    v_mul_f32 v236, v157, v241
    v_mul_f32 v238, v189, v241
    v_fma_f32 v236, -v189, v242, v236
    v_fma_f32 v238, v157, v242, v238
    v_cvt_pk_bf16_f32 v96, v235, v236
    v_cvt_pk_bf16_f32 v112, v237, v238
    v_cvt_pk_bf16_f32 v128, -v237, -v238
    v_fmamk_f32 v243, v228, 0x3c100000, v229
    v_cos_f32 v239, v243
    v_sin_f32 v240, v243
    v_mul_f32 v235, v158, v239
    v_mul_f32 v237, v190, v239
    v_fma_f32 v235, -v190, v240, v235
    v_fma_f32 v237, v158, v240, v237
    v_fmamk_f32 v243, v228, 0x3c180000, v229
    v_cos_f32 v241, v243
    v_sin_f32 v242, v243
    v_mul_f32 v236, v159, v241
    v_mul_f32 v238, v191, v241
    v_fma_f32 v236, -v191, v242, v236
    v_fma_f32 v238, v159, v242, v238
    v_cvt_pk_bf16_f32 v97, v235, v236
    v_cvt_pk_bf16_f32 v113, v237, v238
    v_cvt_pk_bf16_f32 v129, -v237, -v238
    v_fmamk_f32 v243, v228, 0x3c400000, v229
    v_cos_f32 v239, v243
    v_sin_f32 v240, v243
    v_mul_f32 v235, v160, v239
    v_mul_f32 v237, v192, v239
    v_fma_f32 v235, -v192, v240, v235
    v_fma_f32 v237, v160, v240, v237
    v_fmamk_f32 v243, v228, 0x3c480000, v229
    v_cos_f32 v241, v243
    v_sin_f32 v242, v243
    v_mul_f32 v236, v161, v241
    v_mul_f32 v238, v193, v241
    v_fma_f32 v236, -v193, v242, v236
    v_fma_f32 v238, v161, v242, v238
    v_cvt_pk_bf16_f32 v98, v235, v236
    v_cvt_pk_bf16_f32 v114, v237, v238
    v_cvt_pk_bf16_f32 v130, -v237, -v238
    v_fmamk_f32 v243, v228, 0x3c500000, v229
    v_cos_f32 v239, v243
    v_sin_f32 v240, v243
    v_mul_f32 v235, v162, v239
    v_mul_f32 v237, v194, v239
    v_fma_f32 v235, -v194, v240, v235
    v_fma_f32 v237, v162, v240, v237
    v_fmamk_f32 v243, v228, 0x3c580000, v229
    v_cos_f32 v241, v243
    v_sin_f32 v242, v243
    v_mul_f32 v236, v163, v241
    v_mul_f32 v238, v195, v241
    v_fma_f32 v236, -v195, v242, v236
    v_fma_f32 v238, v163, v242, v238
    v_cvt_pk_bf16_f32 v99, v235, v236
    v_cvt_pk_bf16_f32 v115, v237, v238
    v_cvt_pk_bf16_f32 v131, -v237, -v238
    v_mfma_f32_32x32x16_bf16 v[132:147], v[68:71], v[84:87], 0
    v_mfma_f32_32x32x16_bf16 v[164:179], v[68:71], v[100:103], 0
    v_mfma_f32_32x32x16_bf16 v[132:147], v[76:79], v[116:119], v[132:147]
    v_mfma_f32_32x32x16_bf16 v[164:179], v[76:79], v[84:87], v[164:179]
    v_mfma_f32_32x32x16_bf16 v[132:147], v[72:75], v[88:91], v[132:147]
    v_mfma_f32_32x32x16_bf16 v[164:179], v[72:75], v[104:107], v[164:179]
    v_mfma_f32_32x32x16_bf16 v[132:147], v[80:83], v[120:123], v[132:147]
    v_mfma_f32_32x32x16_bf16 v[164:179], v[80:83], v[88:91], v[164:179]
    v_mfma_f32_32x32x16_bf16 v[148:163], v[68:71], v[92:95], 0
    v_mfma_f32_32x32x16_bf16 v[180:195], v[68:71], v[108:111], 0
    v_mfma_f32_32x32x16_bf16 v[148:163], v[76:79], v[124:127], v[148:163]
    v_mfma_f32_32x32x16_bf16 v[180:195], v[76:79], v[92:95], v[180:195]
    v_mfma_f32_32x32x16_bf16 v[148:163], v[72:75], v[96:99], v[148:163]
    v_mfma_f32_32x32x16_bf16 v[180:195], v[72:75], v[112:115], v[180:195]
    v_mfma_f32_32x32x16_bf16 v[148:163], v[80:83], v[128:131], v[148:163]
    v_mfma_f32_32x32x16_bf16 v[180:195], v[80:83], v[96:99], v[180:195]
    v_lshlrev_b32 v231, 4, v1
    v_add_u32 v232, s6, v231
    s_lshl_b32 s5, s3, 12
    s_add_u32 s5, s5, 0x5800000
    s_add_u32 s2, s5, 4096
    v_cvt_pk_bf16_f32 v84, v132, v133
    v_cvt_pk_bf16_f32 v85, v134, v135
    v_cvt_pk_bf16_f32 v86, v136, v137
    v_cvt_pk_bf16_f32 v87, v138, v139
    buffer_store_dwordx4 v[84:87], v231, s[8:11], s5 offen offset:0 sc1
    v_cvt_pk_bf16_f32 v88, v140, v141
    v_cvt_pk_bf16_f32 v89, v142, v143
    v_cvt_pk_bf16_f32 v90, v144, v145
    v_cvt_pk_bf16_f32 v91, v146, v147
    buffer_store_dwordx4 v[88:91], v231, s[8:11], s5 offen offset:1024 sc1
    v_cvt_pk_bf16_f32 v92, v148, v149
    v_cvt_pk_bf16_f32 v93, v150, v151
    v_cvt_pk_bf16_f32 v94, v152, v153
    v_cvt_pk_bf16_f32 v95, v154, v155
    buffer_store_dwordx4 v[92:95], v231, s[8:11], s5 offen offset:2048 sc1
    v_cvt_pk_bf16_f32 v96, v156, v157
    v_cvt_pk_bf16_f32 v97, v158, v159
    v_cvt_pk_bf16_f32 v98, v160, v161
    v_cvt_pk_bf16_f32 v99, v162, v163
    buffer_store_dwordx4 v[96:99], v231, s[8:11], s5 offen offset:3072 sc1
    v_cvt_pk_bf16_f32 v100, v164, v165
    v_cvt_pk_bf16_f32 v101, v166, v167
    v_cvt_pk_bf16_f32 v102, v168, v169
    v_cvt_pk_bf16_f32 v103, v170, v171
    buffer_store_dwordx4 v[100:103], v232, s[8:11], s2 offen offset:0 sc1
    v_cvt_pk_bf16_f32 v104, v172, v173
    v_cvt_pk_bf16_f32 v105, v174, v175
    v_cvt_pk_bf16_f32 v106, v176, v177
    v_cvt_pk_bf16_f32 v107, v178, v179
    buffer_store_dwordx4 v[104:107], v232, s[8:11], s2 offen offset:1024 sc1
    v_cvt_pk_bf16_f32 v108, v180, v181
    v_cvt_pk_bf16_f32 v109, v182, v183
    v_cvt_pk_bf16_f32 v110, v184, v185
    v_cvt_pk_bf16_f32 v111, v186, v187
    buffer_store_dwordx4 v[108:111], v232, s[8:11], s2 offen offset:2048 sc1
    v_cvt_pk_bf16_f32 v112, v188, v189
    v_cvt_pk_bf16_f32 v113, v190, v191
    v_cvt_pk_bf16_f32 v114, v192, v193
    v_cvt_pk_bf16_f32 v115, v194, v195
    buffer_store_dwordx4 v[112:115], v232, s[8:11], s2 offen offset:3072 sc1
    s_add_u32 s7, s7, 8
    s_cmp_lt_u32 s7, 16
    s_cbranch_scc1 colloop_141
    s_cmp_eq_u32 s3, 1008
    s_cbranch_scc1 colloop_141
    s_waitcnt vmcnt(0) lgkmcnt(0)
    s_barrier
    s_cmp_lg_u32 s58, 0
    s_cbranch_scc1 sig_143
    v_mov_b32 v75, 0x5ffffff0
    v_mov_b32 v76, 44
    v_cmp_eq_u32 vcc, 0, v1
    s_nop 1
    v_cndmask_b32 v76, v75, v76, vcc
    v_mov_b32 v75, 1
    buffer_atomic_add v75, v76, s[12:15], 0 offen sc1
sig_143:
    v_bfe_u32 v76, v1, 2, 2
    v_sub_u32 v76, 0, v76
    v_lshrrev_b32 v75, 4, v1
    v_xor_b32 v76, v76, v75
    v_and_b32 v76, 3, v76
    v_bfe_u32 v72, v1, 0, 4
    v_lshlrev_b32 v72, 6, v72
    v_lshl_or_b32 v72, v76, 4, v72
    s_lshr_b32 s74, s58, 2
    s_mul_i32 s74, s74, 8192
    v_add_u32 v72, s74, v72
    v_bfe_u32 v73, v1, 0, 2
    v_lshlrev_b32 v73, 3, v73
    v_bfe_u32 v75, v1, 4, 1
    v_lshl_or_b32 v73, v75, 5, v73
    v_bfe_u32 v75, v1, 2, 2
    v_lshl_or_b32 v73, v75, 6, v73
    v_bfe_u32 v75, v1, 2, 2
    v_lshl_or_b32 v73, v75, 9, v73
    v_bfe_u32 v75, v1, 4, 2
    v_lshl_or_b32 v73, v75, 12, v73
    s_and_b32 s74, s58, 3
    s_mul_i32 s74, s74, 128
    s_or_b32 s74, s74, 16384
    v_xor_b32 v73, s74, v73
    s_mov_b64 s[60:61], s[8:9]
    s_mov_b32 s62, 0x10000000
    s_mov_b32 s63, 0x20000
    s_mov_b64 s[64:65], s[8:9]
    s_mov_b32 s66, 0x10000000
    s_mov_b32 s67, 0x20000
    v_lshrrev_b32 v76, 4, v1
    v_sub_u32 v76, 0, v76
    v_xor_b32 v76, v76, v1
    v_and_b32 v76, 3, v76
    s_mul_i32 s74, s58, 32
    v_lshrrev_b32 v77, 2, v1
    v_add3_u32 v77, v77, s74, 0
    v_bfe_u32 v68, v77, 0, 2
    v_lshlrev_b32 v68, 11, v68
    v_bfe_u32 v75, v77, 4, 1
    v_lshl_or_b32 v68, v75, 13, v68
    v_bfe_u32 v75, v77, 2, 2
    v_lshl_or_b32 v68, v75, 14, v68
    v_bfe_u32 v75, v77, 5, 3
    v_lshl_or_b32 v68, v75, 16, v68
    v_lshl_add_u32 v68, v76, 4, v68
    v_lshrrev_b32 v77, 2, v1
    v_add3_u32 v77, v77, s74, 16
    v_bfe_u32 v69, v77, 0, 2
    v_lshlrev_b32 v69, 11, v69
    v_bfe_u32 v75, v77, 4, 1
    v_lshl_or_b32 v69, v75, 13, v69
    v_bfe_u32 v75, v77, 2, 2
    v_lshl_or_b32 v69, v75, 14, v69
    v_bfe_u32 v75, v77, 5, 3
    v_lshl_or_b32 v69, v75, 16, v69
    v_lshl_add_u32 v69, v76, 4, v69
    s_and_b32 s74, s58, 2
    v_bfe_u32 v76, v1, 0, 5
    v_bfe_u32 v77, v1, 5, 1
    v_lshlrev_b32 v77, 2, v77
    v_xor_b32 v76, v76, v77
    v_xor_b32 v76, s74, v76
    v_lshlrev_b32 v77, 4, v76
    v_lshrrev_b32 v76, 5, v1
    v_lshl_add_u32 v70, v76, 12, v77
    v_bfe_u32 v76, v1, 0, 5
    v_bfe_u32 v77, v1, 5, 1
    v_lshlrev_b32 v77, 2, v77
    v_xor_b32 v76, v76, v77
    v_xor_b32 v76, s74, v76
    v_xor_b32 v76, 8, v76
    v_lshlrev_b32 v77, 4, v76
    v_lshrrev_b32 v76, 5, v1
    v_lshl_add_u32 v71, v76, 12, v77
    v_add_u32 v71, 8192, v71
    s_lshl_b32 s74, s58, 14
    v_add_u32 v70, s74, v70
    v_add_u32 v71, s74, v71
    s_mov_b32 s70, 131072
    s_and_b32 s79, s57, 3
    s_bfe_u32 s80, s76, 0x10002
    s_bfe_u32 s85, s76, 0x20005
    s_lshl_b32 s85, s85, 1
    s_or_b32 s80, s80, s85
    s_lshl_b32 s68, s79, 19
    s_add_u32 s68, s68, 0x5200000
    s_lshl_b32 s69, s80, 9
    s_add_u32 s69, s69, 0x5800000
    s_cmp_lg_u32 s58, 0
    s_cbranch_scc1 wall_144
    v_mov_b32 v76, 168
wctr_145:
    buffer_load_dword v75, v76, s[12:15], 0 offen sc1
    s_waitcnt vmcnt(0)
    v_cmp_ne_u32 vcc, 2097216, v75
    s_cbranch_vccz wctr_ok_146
    s_sub_u32 s77, s77, 1
    s_cbranch_scc0 wctr_145
    s_mov_b32 s77, 0
wctr_ok_146:
wall_144:
    s_cmp_lg_u32 s58, 0
    s_cbranch_scc1 wall_147
    v_mov_b32 v76, 44
wctr_148:
    buffer_load_dword v75, v76, s[12:15], 0 offen sc1
    s_waitcnt vmcnt(0)
    v_cmp_gt_u16 vcc, 32, v75
    s_cbranch_vccz wctr_ok_149
    s_sub_u32 s77, s77, 1
    s_cbranch_scc0 wctr_148
    s_mov_b32 s77, 0
wctr_ok_149:
wall_147:
    s_barrier
    s_mul_i32 s71, s58, 2048
    s_mov_b32 m0, s71
    s_nop 0
    buffer_load_dwordx4 v68, s[60:63], s68 offen lds
    s_add_u32 m0, s71, 1024
    s_nop 0
    buffer_load_dwordx4 v69, s[60:63], s68 offen lds
    s_add_u32 m0, s71, 16384
    s_nop 0
    buffer_load_dwordx4 v70, s[64:67], s69 offen lds
    s_add_u32 m0, s71, 17408
    s_nop 0
    buffer_load_dwordx4 v71, s[64:67], s69 offen lds
    s_add_u32 s68, s68, 64
    s_add_u32 s69, s69, s70
    s_add_u32 s71, s71, 32768
    s_and_b32 s71, s71, 0x1ffff
    s_mov_b32 m0, s71
    s_nop 0
    buffer_load_dwordx4 v68, s[60:63], s68 offen lds
    s_add_u32 m0, s71, 1024
    s_nop 0
    buffer_load_dwordx4 v69, s[60:63], s68 offen lds
    s_add_u32 m0, s71, 16384
    s_nop 0
    buffer_load_dwordx4 v70, s[64:67], s69 offen lds
    s_add_u32 m0, s71, 17408
    s_nop 0
    buffer_load_dwordx4 v71, s[64:67], s69 offen lds
    s_add_u32 s68, s68, 64
    s_add_u32 s69, s69, s70
    s_add_u32 s71, s71, 32768
    s_and_b32 s71, s71, 0x1ffff
    s_mov_b32 m0, s71
    s_nop 0
    buffer_load_dwordx4 v68, s[60:63], s68 offen lds
    s_add_u32 m0, s71, 1024
    s_nop 0
    buffer_load_dwordx4 v69, s[60:63], s68 offen lds
    s_add_u32 m0, s71, 16384
    s_nop 0
    buffer_load_dwordx4 v70, s[64:67], s69 offen lds
    s_add_u32 m0, s71, 17408
    s_nop 0
    buffer_load_dwordx4 v71, s[64:67], s69 offen lds
    s_add_u32 s68, s68, 64
    s_add_u32 s69, s69, s70
    s_add_u32 s71, s71, 32768
    s_and_b32 s71, s71, 0x1ffff
    s_mov_b32 m0, s71
    s_nop 0
    buffer_load_dwordx4 v68, s[60:63], s68 offen lds
    s_add_u32 m0, s71, 1024
    s_nop 0
    buffer_load_dwordx4 v69, s[60:63], s68 offen lds
    s_add_u32 m0, s71, 16384
    s_nop 0
    buffer_load_dwordx4 v70, s[64:67], s69 offen lds
    s_add_u32 m0, s71, 17408
    s_nop 0
    buffer_load_dwordx4 v71, s[64:67], s69 offen lds
    s_add_u32 s68, s68, 64
    s_add_u32 s69, s69, s70
    s_add_u32 s71, s71, 32768
    s_and_b32 s71, s71, 0x1ffff
    s_mov_b32 s72, 0
    s_waitcnt vmcnt(12)
    s_barrier
    v_add_u32 v74, s72, v72
    v_add_u32 v75, s72, v73
    v_xor_b32 v76, 32, v75
    v_xor_b32 v77, 64, v75
    v_xor_b32 v78, 96, v75
    s_add_u32 s72, s72, 32768
    s_and_b32 s72, s72, 0x1ffff
    ds_read_b128 v[4:7], v74 offset:0
    ds_read_b128 v[8:11], v74 offset:1024
    ds_read_b128 v[12:15], v74 offset:2048
    ds_read_b128 v[16:19], v74 offset:3072
    ds_read_b64_tr_b16 v[36:37], v75 offset:0
    ds_read_b64_tr_b16 v[38:39], v75 offset:2048
    ds_read_b64_tr_b16 v[40:41], v76 offset:0
    ds_read_b64_tr_b16 v[42:43], v76 offset:2048
    ds_read_b64_tr_b16 v[44:45], v77 offset:0
    ds_read_b64_tr_b16 v[46:47], v77 offset:2048
    ds_read_b64_tr_b16 v[48:49], v78 offset:0
    ds_read_b64_tr_b16 v[50:51], v78 offset:2048
    s_waitcnt lgkmcnt(0)
    v_mfma_f32_16x16x32_bf16 v[80:83], v[4:7], v[36:39], 0
    ds_read_b128 v[20:23], v74 offset:4096
    v_mfma_f32_16x16x32_bf16 v[84:87], v[4:7], v[40:43], 0
    v_mfma_f32_16x16x32_bf16 v[88:91], v[4:7], v[44:47], 0
    ds_read_b128 v[24:27], v74 offset:5120
    v_mfma_f32_16x16x32_bf16 v[92:95], v[4:7], v[48:51], 0
    v_mfma_f32_16x16x32_bf16 v[96:99], v[8:11], v[36:39], 0
    ds_read_b128 v[28:31], v74 offset:6144
    v_mfma_f32_16x16x32_bf16 v[100:103], v[8:11], v[40:43], 0
    v_mfma_f32_16x16x32_bf16 v[104:107], v[8:11], v[44:47], 0
    ds_read_b128 v[32:35], v74 offset:7168
    v_mfma_f32_16x16x32_bf16 v[108:111], v[8:11], v[48:51], 0
    v_mfma_f32_16x16x32_bf16 v[112:115], v[12:15], v[36:39], 0
    v_mfma_f32_16x16x32_bf16 v[116:119], v[12:15], v[40:43], 0
    v_mfma_f32_16x16x32_bf16 v[120:123], v[12:15], v[44:47], 0
    v_mfma_f32_16x16x32_bf16 v[124:127], v[12:15], v[48:51], 0
    v_mfma_f32_16x16x32_bf16 v[128:131], v[16:19], v[36:39], 0
    v_mfma_f32_16x16x32_bf16 v[132:135], v[16:19], v[40:43], 0
    v_mfma_f32_16x16x32_bf16 v[136:139], v[16:19], v[44:47], 0
    v_mfma_f32_16x16x32_bf16 v[140:143], v[16:19], v[48:51], 0
    s_waitcnt vmcnt(8) lgkmcnt(0)
    s_barrier
    v_mfma_f32_16x16x32_bf16 v[144:147], v[20:23], v[36:39], 0
    v_add_u32 v74, s72, v72
    v_add_u32 v75, s72, v73
    v_xor_b32 v76, 32, v75
    v_xor_b32 v77, 64, v75
    v_xor_b32 v78, 96, v75
    v_mfma_f32_16x16x32_bf16 v[148:151], v[20:23], v[40:43], 0
    s_add_u32 s72, s72, 32768
    s_and_b32 s72, s72, 0x1ffff
    ds_read_b128 v[4:7], v74 offset:0
    v_mfma_f32_16x16x32_bf16 v[152:155], v[20:23], v[44:47], 0
    ds_read_b64_tr_b16 v[52:53], v75 offset:0
    v_mfma_f32_16x16x32_bf16 v[156:159], v[20:23], v[48:51], 0
    ds_read_b64_tr_b16 v[54:55], v75 offset:2048
    ds_read_b64_tr_b16 v[56:57], v76 offset:0
    v_mfma_f32_16x16x32_bf16 v[160:163], v[24:27], v[36:39], 0
    ds_read_b64_tr_b16 v[58:59], v76 offset:2048
    v_mfma_f32_16x16x32_bf16 v[164:167], v[24:27], v[40:43], 0
    ds_read_b64_tr_b16 v[60:61], v77 offset:0
    ds_read_b64_tr_b16 v[62:63], v77 offset:2048
    v_mfma_f32_16x16x32_bf16 v[168:171], v[24:27], v[44:47], 0
    ds_read_b64_tr_b16 v[64:65], v78 offset:0
    v_mfma_f32_16x16x32_bf16 v[172:175], v[24:27], v[48:51], 0
    ds_read_b64_tr_b16 v[66:67], v78 offset:2048
    ds_read_b128 v[8:11], v74 offset:1024
    v_mfma_f32_16x16x32_bf16 v[176:179], v[28:31], v[36:39], 0
    ds_read_b128 v[12:15], v74 offset:2048
    ds_read_b128 v[16:19], v74 offset:3072
    v_mfma_f32_16x16x32_bf16 v[180:183], v[28:31], v[40:43], 0
    s_mov_b32 m0, s71
    v_mfma_f32_16x16x32_bf16 v[184:187], v[28:31], v[44:47], 0
    buffer_load_dwordx4 v68, s[60:63], s68 offen lds
    s_add_u32 m0, s71, 1024
    v_mfma_f32_16x16x32_bf16 v[188:191], v[28:31], v[48:51], 0
    buffer_load_dwordx4 v69, s[60:63], s68 offen lds
    v_mfma_f32_16x16x32_bf16 v[192:195], v[32:35], v[36:39], 0
    s_add_u32 m0, s71, 16384
    s_nop 0
    buffer_load_dwordx4 v70, s[64:67], s69 offen lds
    v_mfma_f32_16x16x32_bf16 v[196:199], v[32:35], v[40:43], 0
    s_add_u32 m0, s71, 17408
    v_mfma_f32_16x16x32_bf16 v[200:203], v[32:35], v[44:47], 0
    buffer_load_dwordx4 v71, s[64:67], s69 offen lds
    s_add_u32 s68, s68, 64
    s_add_u32 s69, s69, s70
    v_mfma_f32_16x16x32_bf16 v[204:207], v[32:35], v[48:51], 0
    s_add_u32 s71, s71, 32768
    s_and_b32 s71, s71, 0x1ffff
    s_waitcnt lgkmcnt(0)
    v_mfma_f32_16x16x32_bf16 v[80:83], v[4:7], v[52:55], v[80:83]
    ds_read_b128 v[20:23], v74 offset:4096
    v_mfma_f32_16x16x32_bf16 v[84:87], v[4:7], v[56:59], v[84:87]
    v_mfma_f32_16x16x32_bf16 v[88:91], v[4:7], v[60:63], v[88:91]
    ds_read_b128 v[24:27], v74 offset:5120
    v_mfma_f32_16x16x32_bf16 v[92:95], v[4:7], v[64:67], v[92:95]
    v_mfma_f32_16x16x32_bf16 v[96:99], v[8:11], v[52:55], v[96:99]
    ds_read_b128 v[28:31], v74 offset:6144
    v_mfma_f32_16x16x32_bf16 v[100:103], v[8:11], v[56:59], v[100:103]
    v_mfma_f32_16x16x32_bf16 v[104:107], v[8:11], v[60:63], v[104:107]
    ds_read_b128 v[32:35], v74 offset:7168
    v_mfma_f32_16x16x32_bf16 v[108:111], v[8:11], v[64:67], v[108:111]
    v_mfma_f32_16x16x32_bf16 v[112:115], v[12:15], v[52:55], v[112:115]
    v_mfma_f32_16x16x32_bf16 v[116:119], v[12:15], v[56:59], v[116:119]
    v_mfma_f32_16x16x32_bf16 v[120:123], v[12:15], v[60:63], v[120:123]
    v_mfma_f32_16x16x32_bf16 v[124:127], v[12:15], v[64:67], v[124:127]
    v_mfma_f32_16x16x32_bf16 v[128:131], v[16:19], v[52:55], v[128:131]
    v_mfma_f32_16x16x32_bf16 v[132:135], v[16:19], v[56:59], v[132:135]
    v_mfma_f32_16x16x32_bf16 v[136:139], v[16:19], v[60:63], v[136:139]
    v_mfma_f32_16x16x32_bf16 v[140:143], v[16:19], v[64:67], v[140:143]
    s_waitcnt vmcnt(8) lgkmcnt(0)
    s_barrier
    v_mfma_f32_16x16x32_bf16 v[144:147], v[20:23], v[52:55], v[144:147]
    v_add_u32 v74, s72, v72
    v_add_u32 v75, s72, v73
    v_xor_b32 v76, 32, v75
    v_xor_b32 v77, 64, v75
    v_xor_b32 v78, 96, v75
    v_mfma_f32_16x16x32_bf16 v[148:151], v[20:23], v[56:59], v[148:151]
    s_add_u32 s72, s72, 32768
    s_and_b32 s72, s72, 0x1ffff
    ds_read_b128 v[4:7], v74 offset:0
    v_mfma_f32_16x16x32_bf16 v[152:155], v[20:23], v[60:63], v[152:155]
    ds_read_b64_tr_b16 v[36:37], v75 offset:0
    v_mfma_f32_16x16x32_bf16 v[156:159], v[20:23], v[64:67], v[156:159]
    ds_read_b64_tr_b16 v[38:39], v75 offset:2048
    ds_read_b64_tr_b16 v[40:41], v76 offset:0
    v_mfma_f32_16x16x32_bf16 v[160:163], v[24:27], v[52:55], v[160:163]
    ds_read_b64_tr_b16 v[42:43], v76 offset:2048
    v_mfma_f32_16x16x32_bf16 v[164:167], v[24:27], v[56:59], v[164:167]
    ds_read_b64_tr_b16 v[44:45], v77 offset:0
    ds_read_b64_tr_b16 v[46:47], v77 offset:2048
    v_mfma_f32_16x16x32_bf16 v[168:171], v[24:27], v[60:63], v[168:171]
    ds_read_b64_tr_b16 v[48:49], v78 offset:0
    v_mfma_f32_16x16x32_bf16 v[172:175], v[24:27], v[64:67], v[172:175]
    ds_read_b64_tr_b16 v[50:51], v78 offset:2048
    ds_read_b128 v[8:11], v74 offset:1024
    v_mfma_f32_16x16x32_bf16 v[176:179], v[28:31], v[52:55], v[176:179]
    ds_read_b128 v[12:15], v74 offset:2048
    ds_read_b128 v[16:19], v74 offset:3072
    v_mfma_f32_16x16x32_bf16 v[180:183], v[28:31], v[56:59], v[180:183]
    s_mov_b32 m0, s71
    v_mfma_f32_16x16x32_bf16 v[184:187], v[28:31], v[60:63], v[184:187]
    buffer_load_dwordx4 v68, s[60:63], s68 offen lds
    s_add_u32 m0, s71, 1024
    v_mfma_f32_16x16x32_bf16 v[188:191], v[28:31], v[64:67], v[188:191]
    buffer_load_dwordx4 v69, s[60:63], s68 offen lds
    v_mfma_f32_16x16x32_bf16 v[192:195], v[32:35], v[52:55], v[192:195]
    s_add_u32 m0, s71, 16384
    s_nop 0
    buffer_load_dwordx4 v70, s[64:67], s69 offen lds
    v_mfma_f32_16x16x32_bf16 v[196:199], v[32:35], v[56:59], v[196:199]
    s_add_u32 m0, s71, 17408
    v_mfma_f32_16x16x32_bf16 v[200:203], v[32:35], v[60:63], v[200:203]
    buffer_load_dwordx4 v71, s[64:67], s69 offen lds
    s_add_u32 s68, s68, 64
    s_add_u32 s69, s69, s70
    v_mfma_f32_16x16x32_bf16 v[204:207], v[32:35], v[64:67], v[204:207]
    s_add_u32 s71, s71, 32768
    s_and_b32 s71, s71, 0x1ffff
    s_mov_b32 s73, 13
gl_150:
    s_waitcnt lgkmcnt(0)
    v_mfma_f32_16x16x32_bf16 v[80:83], v[4:7], v[36:39], v[80:83]
    ds_read_b128 v[20:23], v74 offset:4096
    v_mfma_f32_16x16x32_bf16 v[84:87], v[4:7], v[40:43], v[84:87]
    v_mfma_f32_16x16x32_bf16 v[88:91], v[4:7], v[44:47], v[88:91]
    ds_read_b128 v[24:27], v74 offset:5120
    v_mfma_f32_16x16x32_bf16 v[92:95], v[4:7], v[48:51], v[92:95]
    v_mfma_f32_16x16x32_bf16 v[96:99], v[8:11], v[36:39], v[96:99]
    ds_read_b128 v[28:31], v74 offset:6144
    v_mfma_f32_16x16x32_bf16 v[100:103], v[8:11], v[40:43], v[100:103]
    v_mfma_f32_16x16x32_bf16 v[104:107], v[8:11], v[44:47], v[104:107]
    ds_read_b128 v[32:35], v74 offset:7168
    v_mfma_f32_16x16x32_bf16 v[108:111], v[8:11], v[48:51], v[108:111]
    v_mfma_f32_16x16x32_bf16 v[112:115], v[12:15], v[36:39], v[112:115]
    v_mfma_f32_16x16x32_bf16 v[116:119], v[12:15], v[40:43], v[116:119]
    v_mfma_f32_16x16x32_bf16 v[120:123], v[12:15], v[44:47], v[120:123]
    v_mfma_f32_16x16x32_bf16 v[124:127], v[12:15], v[48:51], v[124:127]
    v_mfma_f32_16x16x32_bf16 v[128:131], v[16:19], v[36:39], v[128:131]
    v_mfma_f32_16x16x32_bf16 v[132:135], v[16:19], v[40:43], v[132:135]
    v_mfma_f32_16x16x32_bf16 v[136:139], v[16:19], v[44:47], v[136:139]
    v_mfma_f32_16x16x32_bf16 v[140:143], v[16:19], v[48:51], v[140:143]
    s_waitcnt vmcnt(8) lgkmcnt(0)
    s_barrier
    v_mfma_f32_16x16x32_bf16 v[144:147], v[20:23], v[36:39], v[144:147]
    v_add_u32 v74, s72, v72
    v_add_u32 v75, s72, v73
    v_xor_b32 v76, 32, v75
    v_xor_b32 v77, 64, v75
    v_xor_b32 v78, 96, v75
    v_mfma_f32_16x16x32_bf16 v[148:151], v[20:23], v[40:43], v[148:151]
    s_add_u32 s72, s72, 32768
    s_and_b32 s72, s72, 0x1ffff
    ds_read_b128 v[4:7], v74 offset:0
    v_mfma_f32_16x16x32_bf16 v[152:155], v[20:23], v[44:47], v[152:155]
    ds_read_b64_tr_b16 v[52:53], v75 offset:0
    v_mfma_f32_16x16x32_bf16 v[156:159], v[20:23], v[48:51], v[156:159]
    ds_read_b64_tr_b16 v[54:55], v75 offset:2048
    ds_read_b64_tr_b16 v[56:57], v76 offset:0
    v_mfma_f32_16x16x32_bf16 v[160:163], v[24:27], v[36:39], v[160:163]
    ds_read_b64_tr_b16 v[58:59], v76 offset:2048
    v_mfma_f32_16x16x32_bf16 v[164:167], v[24:27], v[40:43], v[164:167]
    ds_read_b64_tr_b16 v[60:61], v77 offset:0
    ds_read_b64_tr_b16 v[62:63], v77 offset:2048
    v_mfma_f32_16x16x32_bf16 v[168:171], v[24:27], v[44:47], v[168:171]
    ds_read_b64_tr_b16 v[64:65], v78 offset:0
    v_mfma_f32_16x16x32_bf16 v[172:175], v[24:27], v[48:51], v[172:175]
    ds_read_b64_tr_b16 v[66:67], v78 offset:2048
    ds_read_b128 v[8:11], v74 offset:1024
    v_mfma_f32_16x16x32_bf16 v[176:179], v[28:31], v[36:39], v[176:179]
    ds_read_b128 v[12:15], v74 offset:2048
    ds_read_b128 v[16:19], v74 offset:3072
    v_mfma_f32_16x16x32_bf16 v[180:183], v[28:31], v[40:43], v[180:183]
    s_mov_b32 m0, s71
    v_mfma_f32_16x16x32_bf16 v[184:187], v[28:31], v[44:47], v[184:187]
    buffer_load_dwordx4 v68, s[60:63], s68 offen lds
    s_add_u32 m0, s71, 1024
    v_mfma_f32_16x16x32_bf16 v[188:191], v[28:31], v[48:51], v[188:191]
    buffer_load_dwordx4 v69, s[60:63], s68 offen lds
    v_mfma_f32_16x16x32_bf16 v[192:195], v[32:35], v[36:39], v[192:195]
    s_add_u32 m0, s71, 16384
    s_nop 0
    buffer_load_dwordx4 v70, s[64:67], s69 offen lds
    v_mfma_f32_16x16x32_bf16 v[196:199], v[32:35], v[40:43], v[196:199]
    s_add_u32 m0, s71, 17408
    v_mfma_f32_16x16x32_bf16 v[200:203], v[32:35], v[44:47], v[200:203]
    buffer_load_dwordx4 v71, s[64:67], s69 offen lds
    s_add_u32 s68, s68, 64
    s_add_u32 s69, s69, s70
    v_mfma_f32_16x16x32_bf16 v[204:207], v[32:35], v[48:51], v[204:207]
    s_add_u32 s71, s71, 32768
    s_and_b32 s71, s71, 0x1ffff
    s_waitcnt lgkmcnt(0)
    v_mfma_f32_16x16x32_bf16 v[80:83], v[4:7], v[52:55], v[80:83]
    ds_read_b128 v[20:23], v74 offset:4096
    v_mfma_f32_16x16x32_bf16 v[84:87], v[4:7], v[56:59], v[84:87]
    v_mfma_f32_16x16x32_bf16 v[88:91], v[4:7], v[60:63], v[88:91]
    ds_read_b128 v[24:27], v74 offset:5120
    v_mfma_f32_16x16x32_bf16 v[92:95], v[4:7], v[64:67], v[92:95]
    v_mfma_f32_16x16x32_bf16 v[96:99], v[8:11], v[52:55], v[96:99]
    ds_read_b128 v[28:31], v74 offset:6144
    v_mfma_f32_16x16x32_bf16 v[100:103], v[8:11], v[56:59], v[100:103]
    v_mfma_f32_16x16x32_bf16 v[104:107], v[8:11], v[60:63], v[104:107]
    ds_read_b128 v[32:35], v74 offset:7168
    v_mfma_f32_16x16x32_bf16 v[108:111], v[8:11], v[64:67], v[108:111]
    v_mfma_f32_16x16x32_bf16 v[112:115], v[12:15], v[52:55], v[112:115]
    v_mfma_f32_16x16x32_bf16 v[116:119], v[12:15], v[56:59], v[116:119]
    v_mfma_f32_16x16x32_bf16 v[120:123], v[12:15], v[60:63], v[120:123]
    v_mfma_f32_16x16x32_bf16 v[124:127], v[12:15], v[64:67], v[124:127]
    v_mfma_f32_16x16x32_bf16 v[128:131], v[16:19], v[52:55], v[128:131]
    v_mfma_f32_16x16x32_bf16 v[132:135], v[16:19], v[56:59], v[132:135]
    v_mfma_f32_16x16x32_bf16 v[136:139], v[16:19], v[60:63], v[136:139]
    v_mfma_f32_16x16x32_bf16 v[140:143], v[16:19], v[64:67], v[140:143]
    s_waitcnt vmcnt(8) lgkmcnt(0)
    s_barrier
    v_mfma_f32_16x16x32_bf16 v[144:147], v[20:23], v[52:55], v[144:147]
    v_add_u32 v74, s72, v72
    v_add_u32 v75, s72, v73
    v_xor_b32 v76, 32, v75
    v_xor_b32 v77, 64, v75
    v_xor_b32 v78, 96, v75
    v_mfma_f32_16x16x32_bf16 v[148:151], v[20:23], v[56:59], v[148:151]
    s_add_u32 s72, s72, 32768
    s_and_b32 s72, s72, 0x1ffff
    ds_read_b128 v[4:7], v74 offset:0
    v_mfma_f32_16x16x32_bf16 v[152:155], v[20:23], v[60:63], v[152:155]
    ds_read_b64_tr_b16 v[36:37], v75 offset:0
    v_mfma_f32_16x16x32_bf16 v[156:159], v[20:23], v[64:67], v[156:159]
    ds_read_b64_tr_b16 v[38:39], v75 offset:2048
    ds_read_b64_tr_b16 v[40:41], v76 offset:0
    v_mfma_f32_16x16x32_bf16 v[160:163], v[24:27], v[52:55], v[160:163]
    ds_read_b64_tr_b16 v[42:43], v76 offset:2048
    v_mfma_f32_16x16x32_bf16 v[164:167], v[24:27], v[56:59], v[164:167]
    ds_read_b64_tr_b16 v[44:45], v77 offset:0
    ds_read_b64_tr_b16 v[46:47], v77 offset:2048
    v_mfma_f32_16x16x32_bf16 v[168:171], v[24:27], v[60:63], v[168:171]
    ds_read_b64_tr_b16 v[48:49], v78 offset:0
    v_mfma_f32_16x16x32_bf16 v[172:175], v[24:27], v[64:67], v[172:175]
    ds_read_b64_tr_b16 v[50:51], v78 offset:2048
    ds_read_b128 v[8:11], v74 offset:1024
    v_mfma_f32_16x16x32_bf16 v[176:179], v[28:31], v[52:55], v[176:179]
    ds_read_b128 v[12:15], v74 offset:2048
    ds_read_b128 v[16:19], v74 offset:3072
    v_mfma_f32_16x16x32_bf16 v[180:183], v[28:31], v[56:59], v[180:183]
    s_mov_b32 m0, s71
    v_mfma_f32_16x16x32_bf16 v[184:187], v[28:31], v[60:63], v[184:187]
    buffer_load_dwordx4 v68, s[60:63], s68 offen lds
    s_add_u32 m0, s71, 1024
    v_mfma_f32_16x16x32_bf16 v[188:191], v[28:31], v[64:67], v[188:191]
    buffer_load_dwordx4 v69, s[60:63], s68 offen lds
    v_mfma_f32_16x16x32_bf16 v[192:195], v[32:35], v[52:55], v[192:195]
    s_add_u32 m0, s71, 16384
    s_nop 0
    buffer_load_dwordx4 v70, s[64:67], s69 offen lds
    v_mfma_f32_16x16x32_bf16 v[196:199], v[32:35], v[56:59], v[196:199]
    s_add_u32 m0, s71, 17408
    v_mfma_f32_16x16x32_bf16 v[200:203], v[32:35], v[60:63], v[200:203]
    buffer_load_dwordx4 v71, s[64:67], s69 offen lds
    s_add_u32 s68, s68, 64
    s_add_u32 s69, s69, s70
    v_mfma_f32_16x16x32_bf16 v[204:207], v[32:35], v[64:67], v[204:207]
    s_add_u32 s71, s71, 32768
    s_and_b32 s71, s71, 0x1ffff
    s_sub_u32 s73, s73, 1
    s_cmp_lg_u32 s73, 0
    s_cbranch_scc1 gl_150
    s_waitcnt lgkmcnt(0)
    v_mfma_f32_16x16x32_bf16 v[80:83], v[4:7], v[36:39], v[80:83]
    ds_read_b128 v[20:23], v74 offset:4096
    v_mfma_f32_16x16x32_bf16 v[84:87], v[4:7], v[40:43], v[84:87]
    v_mfma_f32_16x16x32_bf16 v[88:91], v[4:7], v[44:47], v[88:91]
    ds_read_b128 v[24:27], v74 offset:5120
    v_mfma_f32_16x16x32_bf16 v[92:95], v[4:7], v[48:51], v[92:95]
    v_mfma_f32_16x16x32_bf16 v[96:99], v[8:11], v[36:39], v[96:99]
    ds_read_b128 v[28:31], v74 offset:6144
    v_mfma_f32_16x16x32_bf16 v[100:103], v[8:11], v[40:43], v[100:103]
    v_mfma_f32_16x16x32_bf16 v[104:107], v[8:11], v[44:47], v[104:107]
    ds_read_b128 v[32:35], v74 offset:7168
    v_mfma_f32_16x16x32_bf16 v[108:111], v[8:11], v[48:51], v[108:111]
    v_mfma_f32_16x16x32_bf16 v[112:115], v[12:15], v[36:39], v[112:115]
    v_mfma_f32_16x16x32_bf16 v[116:119], v[12:15], v[40:43], v[116:119]
    v_mfma_f32_16x16x32_bf16 v[120:123], v[12:15], v[44:47], v[120:123]
    v_mfma_f32_16x16x32_bf16 v[124:127], v[12:15], v[48:51], v[124:127]
    v_mfma_f32_16x16x32_bf16 v[128:131], v[16:19], v[36:39], v[128:131]
    v_mfma_f32_16x16x32_bf16 v[132:135], v[16:19], v[40:43], v[132:135]
    v_mfma_f32_16x16x32_bf16 v[136:139], v[16:19], v[44:47], v[136:139]
    v_mfma_f32_16x16x32_bf16 v[140:143], v[16:19], v[48:51], v[140:143]
    s_waitcnt vmcnt(8) lgkmcnt(0)
    s_barrier
    v_mfma_f32_16x16x32_bf16 v[144:147], v[20:23], v[36:39], v[144:147]
    v_add_u32 v74, s72, v72
    v_add_u32 v75, s72, v73
    v_mfma_f32_16x16x32_bf16 v[148:151], v[20:23], v[40:43], v[148:151]
    v_xor_b32 v76, 32, v75
    v_xor_b32 v77, 64, v75
    v_xor_b32 v78, 96, v75
    v_mfma_f32_16x16x32_bf16 v[152:155], v[20:23], v[44:47], v[152:155]
    s_add_u32 s72, s72, 32768
    s_and_b32 s72, s72, 0x1ffff
    v_mfma_f32_16x16x32_bf16 v[156:159], v[20:23], v[48:51], v[156:159]
    ds_read_b128 v[4:7], v74 offset:0
    v_mfma_f32_16x16x32_bf16 v[160:163], v[24:27], v[36:39], v[160:163]
    ds_read_b64_tr_b16 v[52:53], v75 offset:0
    v_mfma_f32_16x16x32_bf16 v[164:167], v[24:27], v[40:43], v[164:167]
    ds_read_b64_tr_b16 v[54:55], v75 offset:2048
    v_mfma_f32_16x16x32_bf16 v[168:171], v[24:27], v[44:47], v[168:171]
    ds_read_b64_tr_b16 v[56:57], v76 offset:0
    v_mfma_f32_16x16x32_bf16 v[172:175], v[24:27], v[48:51], v[172:175]
    ds_read_b64_tr_b16 v[58:59], v76 offset:2048
    v_mfma_f32_16x16x32_bf16 v[176:179], v[28:31], v[36:39], v[176:179]
    ds_read_b64_tr_b16 v[60:61], v77 offset:0
    v_mfma_f32_16x16x32_bf16 v[180:183], v[28:31], v[40:43], v[180:183]
    ds_read_b64_tr_b16 v[62:63], v77 offset:2048
    v_mfma_f32_16x16x32_bf16 v[184:187], v[28:31], v[44:47], v[184:187]
    ds_read_b64_tr_b16 v[64:65], v78 offset:0
    v_mfma_f32_16x16x32_bf16 v[188:191], v[28:31], v[48:51], v[188:191]
    ds_read_b64_tr_b16 v[66:67], v78 offset:2048
    v_mfma_f32_16x16x32_bf16 v[192:195], v[32:35], v[36:39], v[192:195]
    ds_read_b128 v[8:11], v74 offset:1024
    v_mfma_f32_16x16x32_bf16 v[196:199], v[32:35], v[40:43], v[196:199]
    ds_read_b128 v[12:15], v74 offset:2048
    v_mfma_f32_16x16x32_bf16 v[200:203], v[32:35], v[44:47], v[200:203]
    ds_read_b128 v[16:19], v74 offset:3072
    v_mfma_f32_16x16x32_bf16 v[204:207], v[32:35], v[48:51], v[204:207]
    s_waitcnt lgkmcnt(0)
    v_mfma_f32_16x16x32_bf16 v[80:83], v[4:7], v[52:55], v[80:83]
    ds_read_b128 v[20:23], v74 offset:4096
    v_mfma_f32_16x16x32_bf16 v[84:87], v[4:7], v[56:59], v[84:87]
    v_mfma_f32_16x16x32_bf16 v[88:91], v[4:7], v[60:63], v[88:91]
    ds_read_b128 v[24:27], v74 offset:5120
    v_mfma_f32_16x16x32_bf16 v[92:95], v[4:7], v[64:67], v[92:95]
    v_mfma_f32_16x16x32_bf16 v[96:99], v[8:11], v[52:55], v[96:99]
    ds_read_b128 v[28:31], v74 offset:6144
    v_mfma_f32_16x16x32_bf16 v[100:103], v[8:11], v[56:59], v[100:103]
    v_mfma_f32_16x16x32_bf16 v[104:107], v[8:11], v[60:63], v[104:107]
    ds_read_b128 v[32:35], v74 offset:7168
    v_mfma_f32_16x16x32_bf16 v[108:111], v[8:11], v[64:67], v[108:111]
    v_mfma_f32_16x16x32_bf16 v[112:115], v[12:15], v[52:55], v[112:115]
    v_mfma_f32_16x16x32_bf16 v[116:119], v[12:15], v[56:59], v[116:119]
    v_mfma_f32_16x16x32_bf16 v[120:123], v[12:15], v[60:63], v[120:123]
    v_mfma_f32_16x16x32_bf16 v[124:127], v[12:15], v[64:67], v[124:127]
    v_mfma_f32_16x16x32_bf16 v[128:131], v[16:19], v[52:55], v[128:131]
    v_mfma_f32_16x16x32_bf16 v[132:135], v[16:19], v[56:59], v[132:135]
    v_mfma_f32_16x16x32_bf16 v[136:139], v[16:19], v[60:63], v[136:139]
    v_mfma_f32_16x16x32_bf16 v[140:143], v[16:19], v[64:67], v[140:143]
    s_waitcnt vmcnt(4) lgkmcnt(0)
    s_barrier
    v_mfma_f32_16x16x32_bf16 v[144:147], v[20:23], v[52:55], v[144:147]
    v_add_u32 v74, s72, v72
    v_add_u32 v75, s72, v73
    v_mfma_f32_16x16x32_bf16 v[148:151], v[20:23], v[56:59], v[148:151]
    v_xor_b32 v76, 32, v75
    v_xor_b32 v77, 64, v75
    v_xor_b32 v78, 96, v75
    v_mfma_f32_16x16x32_bf16 v[152:155], v[20:23], v[60:63], v[152:155]
    s_add_u32 s72, s72, 32768
    s_and_b32 s72, s72, 0x1ffff
    v_mfma_f32_16x16x32_bf16 v[156:159], v[20:23], v[64:67], v[156:159]
    ds_read_b128 v[4:7], v74 offset:0
    v_mfma_f32_16x16x32_bf16 v[160:163], v[24:27], v[52:55], v[160:163]
    ds_read_b64_tr_b16 v[36:37], v75 offset:0
    v_mfma_f32_16x16x32_bf16 v[164:167], v[24:27], v[56:59], v[164:167]
    ds_read_b64_tr_b16 v[38:39], v75 offset:2048
    v_mfma_f32_16x16x32_bf16 v[168:171], v[24:27], v[60:63], v[168:171]
    ds_read_b64_tr_b16 v[40:41], v76 offset:0
    v_mfma_f32_16x16x32_bf16 v[172:175], v[24:27], v[64:67], v[172:175]
    ds_read_b64_tr_b16 v[42:43], v76 offset:2048
    v_mfma_f32_16x16x32_bf16 v[176:179], v[28:31], v[52:55], v[176:179]
    ds_read_b64_tr_b16 v[44:45], v77 offset:0
    v_mfma_f32_16x16x32_bf16 v[180:183], v[28:31], v[56:59], v[180:183]
    ds_read_b64_tr_b16 v[46:47], v77 offset:2048
    v_mfma_f32_16x16x32_bf16 v[184:187], v[28:31], v[60:63], v[184:187]
    ds_read_b64_tr_b16 v[48:49], v78 offset:0
    v_mfma_f32_16x16x32_bf16 v[188:191], v[28:31], v[64:67], v[188:191]
    ds_read_b64_tr_b16 v[50:51], v78 offset:2048
    v_mfma_f32_16x16x32_bf16 v[192:195], v[32:35], v[52:55], v[192:195]
    ds_read_b128 v[8:11], v74 offset:1024
    v_mfma_f32_16x16x32_bf16 v[196:199], v[32:35], v[56:59], v[196:199]
    ds_read_b128 v[12:15], v74 offset:2048
    v_mfma_f32_16x16x32_bf16 v[200:203], v[32:35], v[60:63], v[200:203]
    ds_read_b128 v[16:19], v74 offset:3072
    v_mfma_f32_16x16x32_bf16 v[204:207], v[32:35], v[64:67], v[204:207]
    s_waitcnt lgkmcnt(0)
    v_mfma_f32_16x16x32_bf16 v[80:83], v[4:7], v[36:39], v[80:83]
    ds_read_b128 v[20:23], v74 offset:4096
    v_mfma_f32_16x16x32_bf16 v[84:87], v[4:7], v[40:43], v[84:87]
    v_mfma_f32_16x16x32_bf16 v[88:91], v[4:7], v[44:47], v[88:91]
    ds_read_b128 v[24:27], v74 offset:5120
    v_mfma_f32_16x16x32_bf16 v[92:95], v[4:7], v[48:51], v[92:95]
    v_mfma_f32_16x16x32_bf16 v[96:99], v[8:11], v[36:39], v[96:99]
    ds_read_b128 v[28:31], v74 offset:6144
    v_mfma_f32_16x16x32_bf16 v[100:103], v[8:11], v[40:43], v[100:103]
    v_mfma_f32_16x16x32_bf16 v[104:107], v[8:11], v[44:47], v[104:107]
    ds_read_b128 v[32:35], v74 offset:7168
    v_mfma_f32_16x16x32_bf16 v[108:111], v[8:11], v[48:51], v[108:111]
    v_mfma_f32_16x16x32_bf16 v[112:115], v[12:15], v[36:39], v[112:115]
    v_mfma_f32_16x16x32_bf16 v[116:119], v[12:15], v[40:43], v[116:119]
    v_mfma_f32_16x16x32_bf16 v[120:123], v[12:15], v[44:47], v[120:123]
    v_mfma_f32_16x16x32_bf16 v[124:127], v[12:15], v[48:51], v[124:127]
    v_mfma_f32_16x16x32_bf16 v[128:131], v[16:19], v[36:39], v[128:131]
    v_mfma_f32_16x16x32_bf16 v[132:135], v[16:19], v[40:43], v[132:135]
    v_mfma_f32_16x16x32_bf16 v[136:139], v[16:19], v[44:47], v[136:139]
    v_mfma_f32_16x16x32_bf16 v[140:143], v[16:19], v[48:51], v[140:143]
    s_waitcnt vmcnt(0) lgkmcnt(0)
    s_barrier
    v_mfma_f32_16x16x32_bf16 v[144:147], v[20:23], v[36:39], v[144:147]
    v_add_u32 v74, s72, v72
    v_add_u32 v75, s72, v73
    v_mfma_f32_16x16x32_bf16 v[148:151], v[20:23], v[40:43], v[148:151]
    v_xor_b32 v76, 32, v75
    v_xor_b32 v77, 64, v75
    v_xor_b32 v78, 96, v75
    v_mfma_f32_16x16x32_bf16 v[152:155], v[20:23], v[44:47], v[152:155]
    s_add_u32 s72, s72, 32768
    s_and_b32 s72, s72, 0x1ffff
    v_mfma_f32_16x16x32_bf16 v[156:159], v[20:23], v[48:51], v[156:159]
    ds_read_b128 v[4:7], v74 offset:0
    v_mfma_f32_16x16x32_bf16 v[160:163], v[24:27], v[36:39], v[160:163]
    ds_read_b64_tr_b16 v[52:53], v75 offset:0
    v_mfma_f32_16x16x32_bf16 v[164:167], v[24:27], v[40:43], v[164:167]
    ds_read_b64_tr_b16 v[54:55], v75 offset:2048
    v_mfma_f32_16x16x32_bf16 v[168:171], v[24:27], v[44:47], v[168:171]
    ds_read_b64_tr_b16 v[56:57], v76 offset:0
    v_mfma_f32_16x16x32_bf16 v[172:175], v[24:27], v[48:51], v[172:175]
    ds_read_b64_tr_b16 v[58:59], v76 offset:2048
    v_mfma_f32_16x16x32_bf16 v[176:179], v[28:31], v[36:39], v[176:179]
    ds_read_b64_tr_b16 v[60:61], v77 offset:0
    v_mfma_f32_16x16x32_bf16 v[180:183], v[28:31], v[40:43], v[180:183]
    ds_read_b64_tr_b16 v[62:63], v77 offset:2048
    v_mfma_f32_16x16x32_bf16 v[184:187], v[28:31], v[44:47], v[184:187]
    ds_read_b64_tr_b16 v[64:65], v78 offset:0
    v_mfma_f32_16x16x32_bf16 v[188:191], v[28:31], v[48:51], v[188:191]
    ds_read_b64_tr_b16 v[66:67], v78 offset:2048
    v_mfma_f32_16x16x32_bf16 v[192:195], v[32:35], v[36:39], v[192:195]
    ds_read_b128 v[8:11], v74 offset:1024
    v_mfma_f32_16x16x32_bf16 v[196:199], v[32:35], v[40:43], v[196:199]
    ds_read_b128 v[12:15], v74 offset:2048
    v_mfma_f32_16x16x32_bf16 v[200:203], v[32:35], v[44:47], v[200:203]
    ds_read_b128 v[16:19], v74 offset:3072
    v_mfma_f32_16x16x32_bf16 v[204:207], v[32:35], v[48:51], v[204:207]
    s_waitcnt lgkmcnt(0)
    v_mfma_f32_16x16x32_bf16 v[80:83], v[4:7], v[52:55], v[80:83]
    ds_read_b128 v[20:23], v74 offset:4096
    v_mfma_f32_16x16x32_bf16 v[84:87], v[4:7], v[56:59], v[84:87]
    v_mfma_f32_16x16x32_bf16 v[88:91], v[4:7], v[60:63], v[88:91]
    ds_read_b128 v[24:27], v74 offset:5120
    v_mfma_f32_16x16x32_bf16 v[92:95], v[4:7], v[64:67], v[92:95]
    v_mfma_f32_16x16x32_bf16 v[96:99], v[8:11], v[52:55], v[96:99]
    ds_read_b128 v[28:31], v74 offset:6144
    v_mfma_f32_16x16x32_bf16 v[100:103], v[8:11], v[56:59], v[100:103]
    v_mfma_f32_16x16x32_bf16 v[104:107], v[8:11], v[60:63], v[104:107]
    ds_read_b128 v[32:35], v74 offset:7168
    v_mfma_f32_16x16x32_bf16 v[108:111], v[8:11], v[64:67], v[108:111]
    v_mfma_f32_16x16x32_bf16 v[112:115], v[12:15], v[52:55], v[112:115]
    v_mfma_f32_16x16x32_bf16 v[116:119], v[12:15], v[56:59], v[116:119]
    v_mfma_f32_16x16x32_bf16 v[120:123], v[12:15], v[60:63], v[120:123]
    v_mfma_f32_16x16x32_bf16 v[124:127], v[12:15], v[64:67], v[124:127]
    v_mfma_f32_16x16x32_bf16 v[128:131], v[16:19], v[52:55], v[128:131]
    v_mfma_f32_16x16x32_bf16 v[132:135], v[16:19], v[56:59], v[132:135]
    v_mfma_f32_16x16x32_bf16 v[136:139], v[16:19], v[60:63], v[136:139]
    v_mfma_f32_16x16x32_bf16 v[140:143], v[16:19], v[64:67], v[140:143]
    s_waitcnt lgkmcnt(0)
    v_mfma_f32_16x16x32_bf16 v[144:147], v[20:23], v[52:55], v[144:147]
    v_mfma_f32_16x16x32_bf16 v[148:151], v[20:23], v[56:59], v[148:151]
    v_mfma_f32_16x16x32_bf16 v[152:155], v[20:23], v[60:63], v[152:155]
    v_mfma_f32_16x16x32_bf16 v[156:159], v[20:23], v[64:67], v[156:159]
    v_mfma_f32_16x16x32_bf16 v[160:163], v[24:27], v[52:55], v[160:163]
    v_mfma_f32_16x16x32_bf16 v[164:167], v[24:27], v[56:59], v[164:167]
    v_mfma_f32_16x16x32_bf16 v[168:171], v[24:27], v[60:63], v[168:171]
    v_mfma_f32_16x16x32_bf16 v[172:175], v[24:27], v[64:67], v[172:175]
    v_mfma_f32_16x16x32_bf16 v[176:179], v[28:31], v[52:55], v[176:179]
    v_mfma_f32_16x16x32_bf16 v[180:183], v[28:31], v[56:59], v[180:183]
    v_mfma_f32_16x16x32_bf16 v[184:187], v[28:31], v[60:63], v[184:187]
    v_mfma_f32_16x16x32_bf16 v[188:191], v[28:31], v[64:67], v[188:191]
    v_mfma_f32_16x16x32_bf16 v[192:195], v[32:35], v[52:55], v[192:195]
    v_mfma_f32_16x16x32_bf16 v[196:199], v[32:35], v[56:59], v[196:199]
    v_mfma_f32_16x16x32_bf16 v[200:203], v[32:35], v[60:63], v[200:203]
    v_mfma_f32_16x16x32_bf16 v[204:207], v[32:35], v[64:67], v[204:207]
    s_lshl_b32 s85, s80, 2
    s_and_b32 s81, s58, 3
    s_add_u32 s85, s85, s81
    s_lshl_b32 s85, s85, 6
    v_and_b32 v77, 15, v1
    v_add_u32 v77, s85, v77
    v_bfe_u32 v76, v77, 3, 5
    v_lshlrev_b32 v76, 12, v76
    v_bfe_u32 v75, v77, 10, 1
    v_lshl_or_b32 v76, v75, 17, v76
    v_bfe_u32 v75, v77, 0, 2
    v_lshl_or_b32 v76, v75, 18, v76
    v_bfe_u32 v75, v77, 8, 1
    v_lshl_or_b32 v76, v75, 20, v76
    v_bfe_u32 v75, v77, 2, 1
    v_lshl_or_b32 v76, v75, 21, v76
    v_bfe_u32 v75, v77, 9, 1
    v_lshl_or_b32 v76, v75, 22, v76
    v_bfe_u32 v77, v1, 4, 2
    v_lshlrev_b32 v77, 4, v77
    v_add_u32 v76, v76, v77
    s_lshl_b32 s81, s79, 9
    s_lshr_b32 s85, s58, 2
    s_lshl_b32 s85, s85, 8
    s_add_u32 s81, s81, s85
    v_cvt_pk_bf16_f32 v4, v80, v81
    v_cvt_pk_bf16_f32 v5, v82, v83
    v_cvt_pk_bf16_f32 v6, v96, v97
    v_cvt_pk_bf16_f32 v7, v98, v99
    buffer_store_dwordx4 v[4:7], v76, s[16:19], s81 offen offset:0
    v_cvt_pk_bf16_f32 v8, v112, v113
    v_cvt_pk_bf16_f32 v9, v114, v115
    v_cvt_pk_bf16_f32 v10, v128, v129
    v_cvt_pk_bf16_f32 v11, v130, v131
    buffer_store_dwordx4 v[8:11], v76, s[16:19], s81 offen offset:64
    v_cvt_pk_bf16_f32 v12, v144, v145
    v_cvt_pk_bf16_f32 v13, v146, v147
    v_cvt_pk_bf16_f32 v14, v160, v161
    v_cvt_pk_bf16_f32 v15, v162, v163
    buffer_store_dwordx4 v[12:15], v76, s[16:19], s81 offen offset:128
    v_cvt_pk_bf16_f32 v16, v176, v177
    v_cvt_pk_bf16_f32 v17, v178, v179
    v_cvt_pk_bf16_f32 v18, v192, v193
    v_cvt_pk_bf16_f32 v19, v194, v195
    buffer_store_dwordx4 v[16:19], v76, s[16:19], s81 offen offset:192
    s_add_u32 s81, s81, 8192
    v_cvt_pk_bf16_f32 v20, v84, v85
    v_cvt_pk_bf16_f32 v21, v86, v87
    v_cvt_pk_bf16_f32 v22, v100, v101
    v_cvt_pk_bf16_f32 v23, v102, v103
    buffer_store_dwordx4 v[20:23], v76, s[16:19], s81 offen offset:0
    v_cvt_pk_bf16_f32 v24, v116, v117
    v_cvt_pk_bf16_f32 v25, v118, v119
    v_cvt_pk_bf16_f32 v26, v132, v133
    v_cvt_pk_bf16_f32 v27, v134, v135
    buffer_store_dwordx4 v[24:27], v76, s[16:19], s81 offen offset:64
    v_cvt_pk_bf16_f32 v28, v148, v149
    v_cvt_pk_bf16_f32 v29, v150, v151
    v_cvt_pk_bf16_f32 v30, v164, v165
    v_cvt_pk_bf16_f32 v31, v166, v167
    buffer_store_dwordx4 v[28:31], v76, s[16:19], s81 offen offset:128
    v_cvt_pk_bf16_f32 v32, v180, v181
    v_cvt_pk_bf16_f32 v33, v182, v183
    v_cvt_pk_bf16_f32 v34, v196, v197
    v_cvt_pk_bf16_f32 v35, v198, v199
    buffer_store_dwordx4 v[32:35], v76, s[16:19], s81 offen offset:192
    s_add_u32 s81, s81, 8192
    v_cvt_pk_bf16_f32 v36, v88, v89
    v_cvt_pk_bf16_f32 v37, v90, v91
    v_cvt_pk_bf16_f32 v38, v104, v105
    v_cvt_pk_bf16_f32 v39, v106, v107
    buffer_store_dwordx4 v[36:39], v76, s[16:19], s81 offen offset:0
    v_cvt_pk_bf16_f32 v40, v120, v121
    v_cvt_pk_bf16_f32 v41, v122, v123
    v_cvt_pk_bf16_f32 v42, v136, v137
    v_cvt_pk_bf16_f32 v43, v138, v139
    buffer_store_dwordx4 v[40:43], v76, s[16:19], s81 offen offset:64
    v_cvt_pk_bf16_f32 v44, v152, v153
    v_cvt_pk_bf16_f32 v45, v154, v155
    v_cvt_pk_bf16_f32 v46, v168, v169
    v_cvt_pk_bf16_f32 v47, v170, v171
    buffer_store_dwordx4 v[44:47], v76, s[16:19], s81 offen offset:128
    v_cvt_pk_bf16_f32 v48, v184, v185
    v_cvt_pk_bf16_f32 v49, v186, v187
    v_cvt_pk_bf16_f32 v50, v200, v201
    v_cvt_pk_bf16_f32 v51, v202, v203
    buffer_store_dwordx4 v[48:51], v76, s[16:19], s81 offen offset:192
    s_add_u32 s81, s81, 8192
    v_cvt_pk_bf16_f32 v52, v92, v93
    v_cvt_pk_bf16_f32 v53, v94, v95
    v_cvt_pk_bf16_f32 v54, v108, v109
    v_cvt_pk_bf16_f32 v55, v110, v111
    buffer_store_dwordx4 v[52:55], v76, s[16:19], s81 offen offset:0
    v_cvt_pk_bf16_f32 v56, v124, v125
    v_cvt_pk_bf16_f32 v57, v126, v127
    v_cvt_pk_bf16_f32 v58, v140, v141
    v_cvt_pk_bf16_f32 v59, v142, v143
    buffer_store_dwordx4 v[56:59], v76, s[16:19], s81 offen offset:64
    v_cvt_pk_bf16_f32 v60, v156, v157
    v_cvt_pk_bf16_f32 v61, v158, v159
    v_cvt_pk_bf16_f32 v62, v172, v173
    v_cvt_pk_bf16_f32 v63, v174, v175
    buffer_store_dwordx4 v[60:63], v76, s[16:19], s81 offen offset:128
    v_cvt_pk_bf16_f32 v64, v188, v189
    v_cvt_pk_bf16_f32 v65, v190, v191
    v_cvt_pk_bf16_f32 v66, v204, v205
    v_cvt_pk_bf16_f32 v67, v206, v207
    buffer_store_dwordx4 v[64:67], v76, s[16:19], s81 offen offset:192
    s_add_u32 s81, s81, 8192
    v_mov_b32 v75, 163760
    v_mov_b32 v76, 0
    s_barrier
    ds_write_b32 v75, v76
    s_waitcnt lgkmcnt(0)
    s_barrier
    v_lshlrev_b32 v5, 4, v1
    v_bfe_u32 v6, v1, 0, 3
    v_lshlrev_b32 v6, 4, v6
    v_bfe_u32 v3, v1, 5, 1
    v_lshl_or_b32 v6, v3, 7, v6
    v_lshlrev_b32 v7, 3, v1
    v_bfe_u32 v2, v1, 5, 1
    v_lshlrev_b32 v2, 2, v2
    v_and_b32 v8, 31, v1
    v_sub_u32 v8, v8, v2
    s_mov_b32 s89, 0x3e0293ee
    s_and_b32 s86, s57, 7
    s_mov_b32 s92, 0
    s_mov_b32 s91, 0
    s_mov_b32 s93, 0
    v_mov_b32 v9, 163760
    s_mov_b32 s4, 0xff
    s_mov_b32 s5, 0xff
    s_add_u32 s93, s93, 1
    s_cmp_lg_u32 s58, 0
    s_cbranch_scc1 at_f_154
    s_cmp_eq_u32 s92, 2097216
    s_cbranch_scc1 at_rb_156
    s_max_u32 s88, s86, 2
    s_sub_u32 s88, s88, 2
    s_and_b32 s88, s88, -4
pollrb_157:
    buffer_load_dword v2, off, s[12:15], s88 offset:160 sc1
    buffer_load_dword v3, off, s[12:15], 0 offset:220 sc1
    s_waitcnt vmcnt(0)
    v_cmp_ne_u32 vcc, 2097216, v2
    s_cbranch_vccz pollrb_ok_158
    s_sub_u32 s77, s77, 1
    s_cbranch_scc0 pollrb_157
    s_mov_b32 s77, 0
pollrb_ok_158:
    v_readfirstlane_b32 s92, v3
at_rb_156:
    v_mov_b32 v2, s93
    ds_write_b32 v9, v2
at_f_154:
    ds_read_b32 v2, v9
    s_waitcnt lgkmcnt(0)
    v_cmp_gt_u32 vcc, s93, v2
    s_cbranch_vccz at_d_155
    s_sub_u32 s77, s77, 1
    s_cbranch_scc0 at_f_154
    s_mov_b32 s77, 0
at_d_155:
    s_lshl_b32 s94, s86, 2
    s_add_u32 s94, s94, s75
    s_lshl_b32 s94, s94, 3
    s_add_u32 s94, s94, s58
    s_lshl_b32 s94, s94, 13
    s_add_u32 s88, s94, 0x0
    buffer_load_dwordx4 v[12:15], v5, s[8:11], s88 offen offset:0 sc1
    buffer_load_dwordx4 v[16:19], v5, s[8:11], s88 offen offset:1024 sc1
    buffer_load_dwordx4 v[20:23], v5, s[8:11], s88 offen offset:2048 sc1
    buffer_load_dwordx4 v[24:27], v5, s[8:11], s88 offen offset:3072 sc1
    s_add_u32 s88, s88, 4096
    buffer_load_dwordx4 v[28:31], v5, s[8:11], s88 offen offset:0 sc1
    buffer_load_dwordx4 v[32:35], v5, s[8:11], s88 offen offset:1024 sc1
    buffer_load_dwordx4 v[36:39], v5, s[8:11], s88 offen offset:2048 sc1
    buffer_load_dwordx4 v[40:43], v5, s[8:11], s88 offen offset:3072 sc1
    s_add_u32 s88, s94, 0x1000000
    buffer_load_dwordx4 v[44:47], v5, s[8:11], s88 offen offset:0 sc1
    buffer_load_dwordx4 v[48:51], v5, s[8:11], s88 offen offset:1024 sc1
    buffer_load_dwordx4 v[52:55], v5, s[8:11], s88 offen offset:2048 sc1
    buffer_load_dwordx4 v[56:59], v5, s[8:11], s88 offen offset:3072 sc1
    s_add_u32 s88, s88, 4096
    buffer_load_dwordx4 v[60:63], v5, s[8:11], s88 offen offset:0 sc1
    buffer_load_dwordx4 v[64:67], v5, s[8:11], s88 offen offset:1024 sc1
    buffer_load_dwordx4 v[68:71], v5, s[8:11], s88 offen offset:2048 sc1
    buffer_load_dwordx4 v[72:75], v5, s[8:11], s88 offen offset:3072 sc1
    s_add_u32 s88, s94, 0x2000000
    buffer_load_dwordx4 v[76:79], v5, s[8:11], s88 offen offset:0 sc1
    buffer_load_dwordx4 v[80:83], v5, s[8:11], s88 offen offset:1024 sc1
    buffer_load_dwordx4 v[84:87], v5, s[8:11], s88 offen offset:2048 sc1
    buffer_load_dwordx4 v[88:91], v5, s[8:11], s88 offen offset:3072 sc1
    s_add_u32 s88, s88, 4096
    buffer_load_dwordx4 v[92:95], v5, s[8:11], s88 offen offset:0 sc1
    buffer_load_dwordx4 v[96:99], v5, s[8:11], s88 offen offset:1024 sc1
    buffer_load_dwordx4 v[100:103], v5, s[8:11], s88 offen offset:2048 sc1
    buffer_load_dwordx4 v[104:107], v5, s[8:11], s88 offen offset:3072 sc1
at_loop_151:
    s_mov_b32 s90, s94
    s_add_u32 s93, s93, 1
    s_cmp_lg_u32 s58, 0
    s_cbranch_scc1 at_f_159
    s_cmp_ge_u32 s86, 48
    s_cselect_b32 s88, 1, 2
    s_add_u32 s88, s88, s86
    s_min_u32 s88, s88, 62
    s_cmp_ge_u32 s91, s88
    s_cbranch_scc1 at_go_153
pollprog_161:
    buffer_load_dword v4, off, s[12:15], 0 offset:64 sc1
    s_waitcnt vmcnt(0)
    v_cmp_gt_u32 vcc, s88, v4
    s_cbranch_vccz pollprog_ok_162
    s_sub_u32 s77, s77, 1
    s_cbranch_scc0 pollprog_161
    s_mov_b32 s77, 0
pollprog_ok_162:
    v_readfirstlane_b32 s91, v4
at_go_153:
    v_mov_b32 v2, s93
    ds_write_b32 v9, v2
at_f_159:
    ds_read_b32 v2, v9
    s_waitcnt lgkmcnt(0)
    v_cmp_gt_u32 vcc, s93, v2
    s_cbranch_vccz at_d_160
    s_sub_u32 s77, s77, 1
    s_cbranch_scc0 at_f_159
    s_mov_b32 s77, 0
at_d_160:
    s_lshr_b32 s88, s90, 2
    s_add_u32 s87, s88, 0x4400000
    s_add_u32 s88, s88, 0x4000000
    buffer_load_dwordx4 v[108:111], v6, s[8:11], s88 offen offset:0 sc1
    buffer_load_dwordx4 v[112:115], v6, s[8:11], s88 offen offset:256 sc1
    buffer_load_dwordx4 v[116:119], v6, s[8:11], s88 offen offset:512 sc1
    buffer_load_dwordx4 v[120:123], v6, s[8:11], s88 offen offset:768 sc1
    buffer_load_dwordx4 v[124:127], v6, s[8:11], s88 offen offset:1024 sc1
    buffer_load_dwordx4 v[128:131], v6, s[8:11], s88 offen offset:1280 sc1
    buffer_load_dwordx4 v[132:135], v6, s[8:11], s88 offen offset:1536 sc1
    buffer_load_dwordx4 v[136:139], v6, s[8:11], s88 offen offset:1792 sc1
    buffer_load_dwordx2 v[236:237], v7, s[8:11], s87 offen offset:0 sc1
    buffer_load_dwordx2 v[238:239], v7, s[8:11], s87 offen offset:512 sc1
    buffer_load_dwordx2 v[240:241], v7, s[8:11], s87 offen offset:1024 sc1
    buffer_load_dwordx2 v[242:243], v7, s[8:11], s87 offen offset:1536 sc1
    s_waitcnt vmcnt(27)
    v_mfma_f32_32x32x16_bf16 v[140:155], v[44:47], v[12:15], 0
    s_waitcnt vmcnt(26)
    v_mfma_f32_32x32x16_bf16 v[140:155], v[48:51], v[16:19], v[140:155]
    s_waitcnt vmcnt(25)
    v_mfma_f32_32x32x16_bf16 v[140:155], v[52:55], v[20:23], v[140:155]
    s_waitcnt vmcnt(24)
    v_mfma_f32_32x32x16_bf16 v[140:155], v[56:59], v[24:27], v[140:155]
    s_waitcnt vmcnt(23)
    v_mfma_f32_32x32x16_bf16 v[140:155], v[60:63], v[28:31], v[140:155]
    s_waitcnt vmcnt(22)
    v_mfma_f32_32x32x16_bf16 v[140:155], v[64:67], v[32:35], v[140:155]
    s_waitcnt vmcnt(21)
    v_mfma_f32_32x32x16_bf16 v[140:155], v[68:71], v[36:39], v[140:155]
    s_waitcnt vmcnt(20)
    v_mfma_f32_32x32x16_bf16 v[140:155], v[72:75], v[40:43], v[140:155]
    v_mov_b32 v3, 0xff800000
    v_cmp_le_i32 vcc, 0, v8
    s_nop 9
    v_cndmask_b32 v140, v3, v140, vcc
    v_cmp_le_i32 vcc, 1, v8
    s_nop 1
    v_cndmask_b32 v141, v3, v141, vcc
    v_cmp_le_i32 vcc, 2, v8
    s_nop 1
    v_cndmask_b32 v142, v3, v142, vcc
    v_cmp_le_i32 vcc, 3, v8
    s_nop 1
    v_cndmask_b32 v143, v3, v143, vcc
    v_cmp_le_i32 vcc, 8, v8
    s_nop 1
    v_cndmask_b32 v144, v3, v144, vcc
    v_cmp_le_i32 vcc, 9, v8
    s_nop 1
    v_cndmask_b32 v145, v3, v145, vcc
    v_cmp_le_i32 vcc, 10, v8
    s_nop 1
    v_cndmask_b32 v146, v3, v146, vcc
    v_cmp_le_i32 vcc, 11, v8
    s_nop 1
    v_cndmask_b32 v147, v3, v147, vcc
    v_cmp_le_i32 vcc, 16, v8
    s_nop 1
    v_cndmask_b32 v148, v3, v148, vcc
    v_cmp_le_i32 vcc, 17, v8
    s_nop 1
    v_cndmask_b32 v149, v3, v149, vcc
    v_cmp_le_i32 vcc, 18, v8
    s_nop 1
    v_cndmask_b32 v150, v3, v150, vcc
    v_cmp_le_i32 vcc, 19, v8
    s_nop 1
    v_cndmask_b32 v151, v3, v151, vcc
    v_cmp_le_i32 vcc, 24, v8
    s_nop 1
    v_cndmask_b32 v152, v3, v152, vcc
    v_cmp_le_i32 vcc, 25, v8
    s_nop 1
    v_cndmask_b32 v153, v3, v153, vcc
    v_cmp_le_i32 vcc, 26, v8
    s_nop 1
    v_cndmask_b32 v154, v3, v154, vcc
    v_cmp_le_i32 vcc, 27, v8
    s_nop 1
    v_cndmask_b32 v155, v3, v155, vcc
    v_max3_f32 v244, v140, v141, v142
    v_max3_f32 v244, v244, v143, v144
    v_max3_f32 v244, v244, v145, v146
    v_max3_f32 v244, v244, v147, v148
    v_max3_f32 v244, v244, v149, v150
    v_max3_f32 v244, v244, v151, v152
    v_max3_f32 v244, v244, v153, v154
    s_waitcnt vmcnt(0)
    v_max3_u32 v2, v108, v112, v116
    v_max3_u32 v2, v2, v120, v124
    v_max3_u32 v2, v2, v128, v132
    v_max_u32 v2, v2, v136
    v_cmp_eq_u32 vcc, -1, v2
    s_cbranch_vccz pollkm_ok_164
pollkm_163:
    buffer_load_dwordx4 v[108:111], v6, s[8:11], s88 offen offset:0 sc1
    buffer_load_dwordx4 v[112:115], v6, s[8:11], s88 offen offset:256 sc1
    buffer_load_dwordx4 v[116:119], v6, s[8:11], s88 offen offset:512 sc1
    buffer_load_dwordx4 v[120:123], v6, s[8:11], s88 offen offset:768 sc1
    buffer_load_dwordx4 v[124:127], v6, s[8:11], s88 offen offset:1024 sc1
    buffer_load_dwordx4 v[128:131], v6, s[8:11], s88 offen offset:1280 sc1
    buffer_load_dwordx4 v[132:135], v6, s[8:11], s88 offen offset:1536 sc1
    buffer_load_dwordx4 v[136:139], v6, s[8:11], s88 offen offset:1792 sc1
    buffer_load_dwordx2 v[236:237], v7, s[8:11], s87 offen offset:0 sc1
    buffer_load_dwordx2 v[238:239], v7, s[8:11], s87 offen offset:512 sc1
    buffer_load_dwordx2 v[240:241], v7, s[8:11], s87 offen offset:1024 sc1
    buffer_load_dwordx2 v[242:243], v7, s[8:11], s87 offen offset:1536 sc1
    s_waitcnt vmcnt(0)
    v_max3_u32 v2, v108, v112, v116
    v_max3_u32 v2, v2, v120, v124
    v_max3_u32 v2, v2, v128, v132
    v_max_u32 v2, v2, v136
    v_cmp_eq_u32 vcc, -1, v2
    s_cbranch_vccz pollkm_ok_164
    s_sub_u32 s77, s77, 1
    s_cbranch_scc0 pollkm_163
    s_mov_b32 s77, 0
pollkm_ok_164:
    v_mfma_f32_32x32x16_bf16 v[172:187], v[108:111], v[12:15], 0
    v_mfma_f32_32x32x16_bf16 v[156:171], v[112:115], v[16:19], 0
    v_mfma_f32_32x32x16_bf16 v[172:187], v[116:119], v[20:23], v[172:187]
    v_mfma_f32_32x32x16_bf16 v[156:171], v[120:123], v[24:27], v[156:171]
    v_mfma_f32_32x32x16_bf16 v[172:187], v[124:127], v[28:31], v[172:187]
    v_mfma_f32_32x32x16_bf16 v[156:171], v[128:131], v[32:35], v[156:171]
    v_mfma_f32_32x32x16_bf16 v[172:187], v[132:135], v[36:39], v[172:187]
    v_mfma_f32_32x32x16_bf16 v[156:171], v[136:139], v[40:43], v[156:171]
    v_max3_u32 v3, v236, v238, v240
    v_max_u32 v3, v3, v242
    v_cmp_eq_u32 vcc, -1, v3
    s_cbranch_vccz at_v_165
    buffer_load_dwordx2 v[236:237], v7, s[8:11], s87 offen offset:0 sc1
    buffer_load_dwordx2 v[238:239], v7, s[8:11], s87 offen offset:512 sc1
    buffer_load_dwordx2 v[240:241], v7, s[8:11], s87 offen offset:1024 sc1
    buffer_load_dwordx2 v[242:243], v7, s[8:11], s87 offen offset:1536 sc1
at_v_165:
    s_mov_b64 s[2:3], vcc
    s_add_u32 s86, s86, 8
    s_mov_b32 s94, 0x5ffffff0
    s_cmp_ge_u32 s86, 64
    s_cbranch_scc1 at_nf_166
    s_add_u32 s93, s93, 1
    s_cmp_lg_u32 s58, 0
    s_cbranch_scc1 at_f_167
    s_cmp_eq_u32 s92, 2097216
    s_cbranch_scc1 at_rb_169
    s_max_u32 s88, s86, 2
    s_sub_u32 s88, s88, 2
    s_and_b32 s88, s88, -4
pollrb_170:
    buffer_load_dword v2, off, s[12:15], s88 offset:160 sc1
    buffer_load_dword v3, off, s[12:15], 0 offset:220 sc1
    s_waitcnt vmcnt(0)
    v_cmp_ne_u32 vcc, 2097216, v2
    s_cbranch_vccz pollrb_ok_171
    s_sub_u32 s77, s77, 1
    s_cbranch_scc0 pollrb_170
    s_mov_b32 s77, 0
pollrb_ok_171:
    v_readfirstlane_b32 s92, v3
at_rb_169:
    v_mov_b32 v2, s93
    ds_write_b32 v9, v2
at_f_167:
    ds_read_b32 v2, v9
    s_waitcnt lgkmcnt(0)
    v_cmp_gt_u32 vcc, s93, v2
    s_cbranch_vccz at_d_168
    s_sub_u32 s77, s77, 1
    s_cbranch_scc0 at_f_167
    s_mov_b32 s77, 0
at_d_168:
    s_lshl_b32 s94, s86, 2
    s_add_u32 s94, s94, s75
    s_lshl_b32 s94, s94, 3
    s_add_u32 s94, s94, s58
    s_lshl_b32 s94, s94, 13
    s_add_u32 s88, s94, 0x0
    buffer_load_dwordx4 v[12:15], v5, s[8:11], s88 offen offset:0 sc1
    buffer_load_dwordx4 v[16:19], v5, s[8:11], s88 offen offset:1024 sc1
    buffer_load_dwordx4 v[20:23], v5, s[8:11], s88 offen offset:2048 sc1
    buffer_load_dwordx4 v[24:27], v5, s[8:11], s88 offen offset:3072 sc1
    s_add_u32 s88, s88, 4096
    buffer_load_dwordx4 v[28:31], v5, s[8:11], s88 offen offset:0 sc1
    buffer_load_dwordx4 v[32:35], v5, s[8:11], s88 offen offset:1024 sc1
    buffer_load_dwordx4 v[36:39], v5, s[8:11], s88 offen offset:2048 sc1
    buffer_load_dwordx4 v[40:43], v5, s[8:11], s88 offen offset:3072 sc1
    s_add_u32 s88, s94, 0x1000000
    buffer_load_dwordx4 v[44:47], v5, s[8:11], s88 offen offset:0 sc1
    buffer_load_dwordx4 v[48:51], v5, s[8:11], s88 offen offset:1024 sc1
    buffer_load_dwordx4 v[52:55], v5, s[8:11], s88 offen offset:2048 sc1
    buffer_load_dwordx4 v[56:59], v5, s[8:11], s88 offen offset:3072 sc1
    s_add_u32 s88, s88, 4096
    buffer_load_dwordx4 v[60:63], v5, s[8:11], s88 offen offset:0 sc1
    buffer_load_dwordx4 v[64:67], v5, s[8:11], s88 offen offset:1024 sc1
    buffer_load_dwordx4 v[68:71], v5, s[8:11], s88 offen offset:2048 sc1
    buffer_load_dwordx4 v[72:75], v5, s[8:11], s88 offen offset:3072 sc1
at_nf_166:
    s_nop 2
    v_pk_add_f32 v[156:157], v[156:157], v[172:173]
    v_pk_add_f32 v[158:159], v[158:159], v[174:175]
    v_max3_f32 v2, v244, v155, v156
    v_max3_f32 v2, v2, v157, v158
    v_max_f32 v2, v2, v159
    v_mov_b32 v3, v2
    s_nop 1
    v_permlane32_swap_b32 v2, v3
    v_max_f32 v2, v2, v3
    v_mul_f32 v2, s89, v2
    v_fma_f32 v140, v140, s89, -v2
    v_fma_f32 v141, v141, s89, -v2
    v_exp_f32 v140, v140
    v_exp_f32 v141, v141
    v_fma_f32 v142, v142, s89, -v2
    v_fma_f32 v143, v143, s89, -v2
    v_exp_f32 v142, v142
    v_exp_f32 v143, v143
    v_cvt_pk_bf16_f32 v244, v140, v141
    v_fma_f32 v144, v144, s89, -v2
    v_fma_f32 v145, v145, s89, -v2
    v_exp_f32 v144, v144
    v_exp_f32 v145, v145
    v_cvt_pk_bf16_f32 v245, v142, v143
    v_fma_f32 v146, v146, s89, -v2
    v_fma_f32 v147, v147, s89, -v2
    v_exp_f32 v146, v146
    v_exp_f32 v147, v147
    v_cvt_pk_bf16_f32 v246, v144, v145
    v_fma_f32 v148, v148, s89, -v2
    v_fma_f32 v149, v149, s89, -v2
    v_exp_f32 v148, v148
    v_exp_f32 v149, v149
    v_cvt_pk_bf16_f32 v247, v146, v147
    v_fma_f32 v150, v150, s89, -v2
    v_fma_f32 v151, v151, s89, -v2
    v_exp_f32 v150, v150
    v_exp_f32 v151, v151
    v_cvt_pk_bf16_f32 v248, v148, v149
    v_mfma_f32_32x32x16_bf16 v[172:187], v[76:79], v[244:247], 0
    v_fma_f32 v152, v152, s89, -v2
    v_fma_f32 v153, v153, s89, -v2
    v_exp_f32 v152, v152
    v_exp_f32 v153, v153
    v_cvt_pk_bf16_f32 v249, v150, v151
    v_mfma_f32_32x32x16_bf16 v[188:203], v[84:87], v[244:247], 0
    v_fma_f32 v154, v154, s89, -v2
    v_fma_f32 v155, v155, s89, -v2
    v_exp_f32 v154, v154
    v_exp_f32 v155, v155
    v_cvt_pk_bf16_f32 v250, v152, v153
    v_mfma_f32_32x32x16_bf16 v[204:219], v[92:95], v[244:247], 0
    v_fma_f32 v156, v156, s89, -v2
    v_fma_f32 v157, v157, s89, -v2
    v_exp_f32 v156, v156
    v_exp_f32 v157, v157
    v_cvt_pk_bf16_f32 v251, v154, v155
    v_mfma_f32_32x32x16_bf16 v[220:235], v[100:103], v[244:247], 0
    v_fma_f32 v158, v158, s89, -v2
    v_fma_f32 v159, v159, s89, -v2
    v_exp_f32 v158, v158
    v_exp_f32 v159, v159
    v_cvt_pk_bf16_f32 v252, v156, v157
    v_add_f32 v2, v140, v141
    v_cvt_pk_bf16_f32 v253, v158, v159
    v_mfma_f32_32x32x16_bf16 v[172:187], v[80:83], v[248:251], v[172:187]
    v_add_f32 v2, v2, v142
    v_add_f32 v2, v2, v143
    v_add_f32 v2, v2, v144
    v_add_f32 v2, v2, v145
    v_add_f32 v2, v2, v146
    v_mfma_f32_32x32x16_bf16 v[188:203], v[88:91], v[248:251], v[188:203]
    v_add_f32 v2, v2, v147
    v_add_f32 v2, v2, v148
    v_add_f32 v2, v2, v149
    v_add_f32 v2, v2, v150
    v_add_f32 v2, v2, v151
    v_mfma_f32_32x32x16_bf16 v[204:219], v[96:99], v[248:251], v[204:219]
    v_add_f32 v2, v2, v152
    v_add_f32 v2, v2, v153
    v_add_f32 v2, v2, v154
    v_add_f32 v2, v2, v155
    v_add_f32 v2, v2, v156
    v_mfma_f32_32x32x16_bf16 v[220:235], v[104:107], v[248:251], v[220:235]
    v_add_f32 v2, v2, v157
    v_add_f32 v2, v2, v158
    v_add_f32 v2, v2, v159
    s_cmp_eq_u64 s[2:3], 0
    s_cbranch_scc1 at_vok_172
    s_waitcnt vmcnt(0)
    v_max3_u32 v3, v236, v238, v240
    v_max_u32 v3, v3, v242
    v_cmp_eq_u32 vcc, -1, v3
    s_cbranch_vccz pollvm_ok_174
pollvm_173:
    buffer_load_dwordx2 v[236:237], v7, s[8:11], s87 offen offset:0 sc1
    buffer_load_dwordx2 v[238:239], v7, s[8:11], s87 offen offset:512 sc1
    buffer_load_dwordx2 v[240:241], v7, s[8:11], s87 offen offset:1024 sc1
    buffer_load_dwordx2 v[242:243], v7, s[8:11], s87 offen offset:1536 sc1
    s_waitcnt vmcnt(0)
    v_max3_u32 v3, v236, v238, v240
    v_max_u32 v3, v3, v242
    v_cmp_eq_u32 vcc, -1, v3
    s_cbranch_vccz pollvm_ok_174
    s_sub_u32 s77, s77, 1
    s_cbranch_scc0 pollvm_173
    s_mov_b32 s77, 0
pollvm_ok_174:
at_vok_172:
    v_mfma_f32_32x32x8_bf16 v[172:187], v[236:237], v[252:253], v[172:187]
    v_mov_b32 v3, v2
    s_add_u32 s87, s90, 0x3000000
    v_mfma_f32_32x32x8_bf16 v[188:203], v[238:239], v[252:253], v[188:203]
    v_permlane32_swap_b32 v2, v3
    v_add_f32 v2, v2, v3
    v_rcp_f32 v2, v2
    v_mfma_f32_32x32x8_bf16 v[204:219], v[240:241], v[252:253], v[204:219]
    v_mfma_f32_32x32x8_bf16 v[220:235], v[242:243], v[252:253], v[220:235]
    s_nop 3
    v_pk_mul_f32 v[172:173], v[172:173], v[2:3] op_sel_hi:[1,0]
    v_pk_mul_f32 v[174:175], v[174:175], v[2:3] op_sel_hi:[1,0]
    v_pk_mul_f32 v[176:177], v[176:177], v[2:3] op_sel_hi:[1,0]
    v_pk_mul_f32 v[178:179], v[178:179], v[2:3] op_sel_hi:[1,0]
    v_cvt_pk_bf16_f32 v108, v172, v173
    v_cvt_pk_bf16_f32 v109, v174, v175
    v_cvt_pk_bf16_f32 v110, v176, v177
    v_cvt_pk_bf16_f32 v111, v178, v179
    buffer_store_dwordx4 v[108:111], v5, s[8:11], s87 offen offset:0 sc1
    v_pk_mul_f32 v[180:181], v[180:181], v[2:3] op_sel_hi:[1,0]
    v_pk_mul_f32 v[182:183], v[182:183], v[2:3] op_sel_hi:[1,0]
    v_pk_mul_f32 v[184:185], v[184:185], v[2:3] op_sel_hi:[1,0]
    v_pk_mul_f32 v[186:187], v[186:187], v[2:3] op_sel_hi:[1,0]
    v_cvt_pk_bf16_f32 v112, v180, v181
    v_cvt_pk_bf16_f32 v113, v182, v183
    v_cvt_pk_bf16_f32 v114, v184, v185
    v_cvt_pk_bf16_f32 v115, v186, v187
    buffer_store_dwordx4 v[112:115], v5, s[8:11], s87 offen offset:1024 sc1
    v_pk_mul_f32 v[188:189], v[188:189], v[2:3] op_sel_hi:[1,0]
    v_pk_mul_f32 v[190:191], v[190:191], v[2:3] op_sel_hi:[1,0]
    v_pk_mul_f32 v[192:193], v[192:193], v[2:3] op_sel_hi:[1,0]
    v_pk_mul_f32 v[194:195], v[194:195], v[2:3] op_sel_hi:[1,0]
    v_cvt_pk_bf16_f32 v116, v188, v189
    v_cvt_pk_bf16_f32 v117, v190, v191
    v_cvt_pk_bf16_f32 v118, v192, v193
    v_cvt_pk_bf16_f32 v119, v194, v195
    buffer_store_dwordx4 v[116:119], v5, s[8:11], s87 offen offset:2048 sc1
    v_pk_mul_f32 v[196:197], v[196:197], v[2:3] op_sel_hi:[1,0]
    v_pk_mul_f32 v[198:199], v[198:199], v[2:3] op_sel_hi:[1,0]
    v_pk_mul_f32 v[200:201], v[200:201], v[2:3] op_sel_hi:[1,0]
    v_pk_mul_f32 v[202:203], v[202:203], v[2:3] op_sel_hi:[1,0]
    v_cvt_pk_bf16_f32 v120, v196, v197
    v_cvt_pk_bf16_f32 v121, v198, v199
    v_cvt_pk_bf16_f32 v122, v200, v201
    v_cvt_pk_bf16_f32 v123, v202, v203
    buffer_store_dwordx4 v[120:123], v5, s[8:11], s87 offen offset:3072 sc1
    v_pk_mul_f32 v[204:205], v[204:205], v[2:3] op_sel_hi:[1,0]
    v_pk_mul_f32 v[206:207], v[206:207], v[2:3] op_sel_hi:[1,0]
    v_pk_mul_f32 v[208:209], v[208:209], v[2:3] op_sel_hi:[1,0]
    v_pk_mul_f32 v[210:211], v[210:211], v[2:3] op_sel_hi:[1,0]
    v_cvt_pk_bf16_f32 v124, v204, v205
    v_cvt_pk_bf16_f32 v125, v206, v207
    v_cvt_pk_bf16_f32 v126, v208, v209
    v_cvt_pk_bf16_f32 v127, v210, v211
    s_add_u32 s87, s87, 4096
    buffer_store_dwordx4 v[124:127], v5, s[8:11], s87 offen offset:0 sc1
    v_pk_mul_f32 v[212:213], v[212:213], v[2:3] op_sel_hi:[1,0]
    v_pk_mul_f32 v[214:215], v[214:215], v[2:3] op_sel_hi:[1,0]
    v_pk_mul_f32 v[216:217], v[216:217], v[2:3] op_sel_hi:[1,0]
    v_pk_mul_f32 v[218:219], v[218:219], v[2:3] op_sel_hi:[1,0]
    v_cvt_pk_bf16_f32 v128, v212, v213
    v_cvt_pk_bf16_f32 v129, v214, v215
    v_cvt_pk_bf16_f32 v130, v216, v217
    v_cvt_pk_bf16_f32 v131, v218, v219
    buffer_store_dwordx4 v[128:131], v5, s[8:11], s87 offen offset:1024 sc1
    v_pk_mul_f32 v[220:221], v[220:221], v[2:3] op_sel_hi:[1,0]
    v_pk_mul_f32 v[222:223], v[222:223], v[2:3] op_sel_hi:[1,0]
    v_pk_mul_f32 v[224:225], v[224:225], v[2:3] op_sel_hi:[1,0]
    v_pk_mul_f32 v[226:227], v[226:227], v[2:3] op_sel_hi:[1,0]
    v_cvt_pk_bf16_f32 v132, v220, v221
    v_cvt_pk_bf16_f32 v133, v222, v223
    v_cvt_pk_bf16_f32 v134, v224, v225
    v_cvt_pk_bf16_f32 v135, v226, v227
    buffer_store_dwordx4 v[132:135], v5, s[8:11], s87 offen offset:2048 sc1
    v_pk_mul_f32 v[228:229], v[228:229], v[2:3] op_sel_hi:[1,0]
    v_pk_mul_f32 v[230:231], v[230:231], v[2:3] op_sel_hi:[1,0]
    v_pk_mul_f32 v[232:233], v[232:233], v[2:3] op_sel_hi:[1,0]
    v_pk_mul_f32 v[234:235], v[234:235], v[2:3] op_sel_hi:[1,0]
    v_cvt_pk_bf16_f32 v136, v228, v229
    v_cvt_pk_bf16_f32 v137, v230, v231
    v_cvt_pk_bf16_f32 v138, v232, v233
    v_cvt_pk_bf16_f32 v139, v234, v235
    buffer_store_dwordx4 v[136:139], v5, s[8:11], s87 offen offset:3072 sc1
    s_add_u32 s88, s94, 0x2000000
    buffer_load_dwordx4 v[76:79], v5, s[8:11], s88 offen offset:0 sc1
    buffer_load_dwordx4 v[80:83], v5, s[8:11], s88 offen offset:1024 sc1
    buffer_load_dwordx4 v[84:87], v5, s[8:11], s88 offen offset:2048 sc1
    buffer_load_dwordx4 v[88:91], v5, s[8:11], s88 offen offset:3072 sc1
    s_add_u32 s88, s88, 4096
    buffer_load_dwordx4 v[92:95], v5, s[8:11], s88 offen offset:0 sc1
    buffer_load_dwordx4 v[96:99], v5, s[8:11], s88 offen offset:1024 sc1
    buffer_load_dwordx4 v[100:103], v5, s[8:11], s88 offen offset:2048 sc1
    buffer_load_dwordx4 v[104:107], v5, s[8:11], s88 offen offset:3072 sc1
    s_bfe_u32 s87, s90, 0x3000d
    s_lshl_b32 s87, s87, 2
    s_bfe_u32 s88, s90, 0x80010
    s_lshl_b32 s88, s88, 7
    s_or_b32 s87, s87, s88
    s_add_u32 s87, s87, 0x5100000
    v_mov_b32 v2, 1
    s_waitcnt vmcnt(8)
    buffer_store_dword v2, off, s[8:11], s87
    s_cmp_lt_u32 s86, 64
    s_cbranch_scc1 at_loop_151
end_63:
    s_waitcnt vmcnt(0)
    s_endpgm
.section .rodata,"a"
.p2align 6
.amdhsa_kernel concat_heads__spectral_gfnet__memory_aug_recurrent_mem_tr__prompt_kernel
  .amdhsa_next_free_vgpr 256
  .amdhsa_next_free_sgpr 102
  .amdhsa_accum_offset 256
  .amdhsa_group_segment_fixed_size 0
  .amdhsa_kernarg_size 104
  .amdhsa_user_sgpr_count 2
  .amdhsa_user_sgpr_kernarg_segment_ptr 1
  .amdhsa_system_sgpr_workgroup_id_x 1
  .amdhsa_float_denorm_mode_32 3
  .amdhsa_float_denorm_mode_16_64 3
.end_amdhsa_kernel
```

```asm
; @launch grid=(256,1,1) block=(512,1,1) lds=163840
.amdgcn_target "amdgcn-amd-amdhsa--gfx950"
.text
.globl concat_heads__spectral_gfnet__memory_aug_recurrent_mem_tr__prompt_kernel
.p2align 8
.type concat_heads__spectral_gfnet__memory_aug_recurrent_mem_tr__prompt_kernel,@function
concat_heads__spectral_gfnet__memory_aug_recurrent_mem_tr__prompt_kernel:
    s_load_dwordx2 s[8:9], s[0:1], 96
    s_load_dwordx2 s[12:13], s[0:1], 88
    s_load_dwordx2 s[16:17], s[0:1], 80
    s_load_dwordx2 s[20:21], s[0:1], 40
    s_load_dwordx2 s[24:25], s[0:1], 48
    s_load_dwordx2 s[28:29], s[0:1], 56
    s_load_dwordx2 s[32:33], s[0:1], 64
    s_load_dwordx2 s[36:37], s[0:1], 24
    s_load_dwordx2 s[40:41], s[0:1], 32
    s_load_dwordx2 s[44:45], s[0:1], 0
    s_load_dwordx2 s[48:49], s[0:1], 8
    s_load_dwordx2 s[52:53], s[0:1], 16
    s_mov_b32 s10, 0x10000000
    s_mov_b32 s11, 0x20000
    s_mov_b32 s14, 0x100
    s_mov_b32 s15, 0x20000
    s_mov_b32 s18, 0x800000
    s_mov_b32 s19, 0x20000
    s_mov_b32 s22, 0x800000
    s_mov_b32 s23, 0x20000
    s_mov_b32 s26, 0x800000
    s_mov_b32 s27, 0x20000
    s_mov_b32 s30, 0x800000
    s_mov_b32 s31, 0x20000
    s_mov_b32 s34, 0x800000
    s_mov_b32 s35, 0x20000
    s_mov_b32 s38, 0x400000
    s_mov_b32 s39, 0x20000
    s_mov_b32 s42, 0x4000
    s_mov_b32 s43, 0x20000
    s_mov_b32 s46, 0x400000
    s_mov_b32 s47, 0x20000
    s_mov_b32 s50, 0x201000
    s_mov_b32 s51, 0x20000
    s_mov_b32 s54, 0x201000
    s_mov_b32 s55, 0x20000
    s_waitcnt lgkmcnt(0)
    s_getreg_b32 s56, hwreg(HW_REG_XCC_ID, 0, 3)
    v_lshrrev_b32 v2, 6, v0
    v_and_b32 v1, 63, v0
    v_readfirstlane_b32 s58, v2
    s_nop 0
    s_cmp_lg_u32 s58, 0
    s_cbranch_scc1 notw0_1
    s_and_b32 s57, s56, 3
    s_mul_i32 s57, s57, 76
    s_and_b32 s3, s56, 4
    s_add_u32 s57, s57, s3
    v_mov_b32 v2, s57
    v_mov_b32 v3, 0x5ffffff0
    v_cmp_eq_u32 vcc, 0, v1
    s_nop 1
    v_cndmask_b32 v2, v3, v2, vcc
    v_mov_b32 v3, 1
    buffer_atomic_add v3, v2, s[12:15], 0 offen sc0 sc1
    v_mov_b32 v4, 0x27ff0
    s_waitcnt vmcnt(0)
    v_readfirstlane_b32 s3, v3
    s_nop 1
    v_mov_b32 v3, s3
    ds_write_b32 v4, v3
    s_waitcnt lgkmcnt(0)
notw0_1:
    s_barrier
    v_mov_b32 v4, 0x27ff0
    ds_read_b32 v3, v4
    s_waitcnt lgkmcnt(0)
    v_readfirstlane_b32 s57, v3
    s_nop 0
    s_cmp_lt_u32 s57, 32
    s_cbranch_scc1 go_3
    s_endpgm
go_3:
    s_cmp_ge_u32 s56, 4
    s_cbranch_scc1 bulk_2
    s_and_b32 s64, s57, 3
    s_lshr_b32 s65, s57, 2
    s_lshl_b32 s66, s56, 3
    s_add_u32 s66, s66, s65
    s_and_b32 s67, s58, 3
    s_mov_b32 s69, 0x40000
    v_and_b32 v6, 15, v1
    v_lshlrev_b32 v8, 4, v1
    v_mov_b32 v14, -1
    v_mov_b32 v15, -1
    v_mov_b32 v16, -1
    v_mov_b32 v17, -1
    s_mov_b32 s86, 0
    s_mov_b32 s87, 0
    s_mov_b32 s88, 0
    s_mov_b32 s89, 0
    s_mov_b32 s90, 0
    s_mov_b32 s91, 0
    s_mov_b32 s92, 0
    s_mov_b32 s93, 0
    s_mov_b32 s94, 0
    s_mov_b32 s95, 0
    s_mov_b32 s96, 0
    s_mov_b32 s97, 0
    s_mov_b32 s98, 0
    v_mov_b32 v2, 0x4444
    v_mov_b32 v3, 0xeeee
    v_and_b32 v4, 2, v1
    v_cmp_eq_u32 vcc, 0, v4
    s_nop 1
    v_cndmask_b32 v7, v3, v2, vcc
    v_bfe_u32 v36, v1, 0, 2
    v_lshlrev_b32 v36, 4, v36
    v_bfe_u32 v2, v1, 5, 1
    v_lshl_or_b32 v36, v2, 6, v36
    v_bfe_u32 v2, v1, 2, 2
    v_lshl_or_b32 v36, v2, 10, v36
    v_bfe_u32 v2, v1, 4, 1
    v_lshl_or_b32 v36, v2, 12, v36
    s_lshl_b32 s70, s56, 2
    s_add_u32 s70, s70, s64
    s_lshl_b32 s70, s70, 15
    s_add_u32 s70, s70, 0x4a00000
    s_lshl_b32 s71, s65, 2
    s_add_u32 s71, s71, s67
    s_lshl_b32 s72, s71, 10
    s_add_u32 s78, s70, s72
    s_lshl_b32 s72, s67, 13
    s_add_u32 s79, s70, s72
    s_lshl_b32 s72, s65, 7
    s_add_u32 s79, s79, s72
    s_bfe_u32 s77, s71, 0x20001
    s_lshl_b32 s77, s77, 7
    s_bfe_u32 s72, s71, 0x10000
    s_lshl_b32 s72, s72, 11
    s_or_b32 s77, s77, s72
    s_bfe_u32 s72, s71, 0x10003
    s_lshl_b32 s72, s72, 12
    s_or_b32 s77, s77, s72
    s_bfe_u32 s72, s71, 0x10004
    s_lshl_b32 s72, s72, 14
    s_or_b32 s77, s77, s72
    s_lshl_b32 s72, s56, 9
    s_add_u32 s77, s77, s72
    s_bfe_u32 s76, s58, 0x10000
    s_lshl_b32 s76, s76, 12
    s_bfe_u32 s72, s58, 0x10001
    s_lshl_b32 s72, s72, 14
    s_or_b32 s76, s76, s72
    s_lshl_b32 s72, s64, 15
    s_add_u32 s76, s76, s72
    s_add_u32 s72, s72, 0x20000
    s_add_u32 s77, s77, s72
    s_sub_u32 s7, 0, s8
    s_and_b32 s7, s7, 0x1fffff
    s_add_u32 s7, s7, 0x6c00000
    v_bfe_u32 v37, v1, 0, 2
    v_lshlrev_b32 v37, 4, v37
    v_bfe_u32 v2, v1, 4, 1
    v_lshl_or_b32 v37, v2, 6, v37
    v_bfe_u32 v2, v1, 2, 2
    v_lshl_or_b32 v37, v2, 7, v37
    v_bfe_u32 v2, v1, 5, 1
    v_lshl_or_b32 v37, v2, 9, v37
    v_add_u32 v37, s7, v37
    v_mov_b32 v5, 0x5ffffff0
    v_add_u32 v3, s7, v8
    v_cmp_gt_u32 vcc, 8, v1
    s_nop 1
    v_cndmask_b32 v35, v5, v3, vcc
    s_lshl_b32 s70, s66, 2
    s_add_u32 s70, s70, s67
    s_lshl_b32 s74, s70, 11
    s_add_u32 s74, s74, 0x4900000
    s_cmp_ge_u32 s58, 4
    s_cbranch_scc1 vo_arm_4
    s_lshl_b32 s73, s70, 12
    s_add_u32 s73, s73, 0x4800000
    s_lshl_b32 s71, s64, 10
    v_add_u32 v34, s71, v8
    s_add_u32 s71, s73, 0x80000
    buffer_store_dwordx4 v[14:17], v34, s[8:11], s73 offen
    buffer_store_dwordx4 v[14:17], v34, s[8:11], s71 offen
    v_bfe_u32 v2, v1, 0, 3
    v_lshlrev_b32 v2, 4, v2
    v_bfe_u32 v3, v1, 3, 1
    v_lshl_or_b32 v2, v3, 13, v2
    v_bfe_u32 v3, v1, 4, 2
    v_lshl_or_b32 v2, v3, 17, v2
    v_add_u32 v2, s7, v2
    buffer_store_dwordx4 v[14:17], v2, s[8:11], s77 offen sc1
    s_add_u32 s77, s77, 0x60000
    s_branch arm_done_5
vo_arm_4:
    s_mov_b32 s73, s74
    v_bfe_u32 v34, v1, 0, 4
    v_lshlrev_b32 v34, 4, v34
    v_bfe_u32 v2, v1, 5, 1
    v_lshl_or_b32 v34, v2, 8, v34
    v_bfe_u32 v2, v1, 4, 1
    v_lshl_or_b32 v34, v2, 10, v34
    s_bfe_u32 s71, s64, 0x10000
    s_lshl_b32 s71, s71, 3
    s_bfe_u32 s72, s64, 0x10001
    s_lshl_b32 s72, s72, 9
    s_or_b32 s71, s71, s72
    v_add_u32 v34, s71, v34
    s_add_u32 s71, s73, 0x40000
    buffer_store_dwordx2 v[14:15], v34, s[8:11], s73 offen
    buffer_store_dwordx2 v[14:15], v34, s[8:11], s71 offen
    s_add_u32 s71, s79, 0x80000
    buffer_store_dwordx4 v[14:17], v36, s[8:11], s79 offen
    buffer_store_dwordx4 v[14:17], v36, s[8:11], s71 offen
    s_add_u32 s2, s77, s7
    s_add_u32 s2, s2, 0x1c0000
    v_bfe_u32 v2, v1, 0, 2
    v_lshlrev_b32 v2, 21, v2
    v_bfe_u32 v3, v1, 2, 1
    v_lshl_or_b32 v2, v3, 13, v2
    s_cmp_lg_u32 s58, 4
    s_cbranch_scc1 arm_done_5
    buffer_store_dword v14, v2, s[8:11], s2 offen sc1
    s_lshl_b32 s71, s66, 7
    s_add_u32 s71, s71, 0x5110000
    buffer_store_dwordx2 v[14:15], off, s[8:11], s71 sc1
arm_done_5:
    v_bfe_u32 v2, v1, 0, 1
    v_lshlrev_b32 v2, 11, v2
    v_bfe_u32 v3, v1, 2, 2
    v_lshl_or_b32 v2, v3, 12, v2
    v_bfe_u32 v3, v1, 1, 1
    v_lshl_or_b32 v2, v3, 8, v2
    v_bfe_u32 v3, v1, 4, 2
    v_lshl_or_b32 v2, v3, 4, v2
    s_lshl_b32 s70, s64, 9
    s_lshl_b32 s71, s67, 6
    s_add_u32 s70, s70, s71
    buffer_load_dwordx4 v[10:13], v2, s[40:43], s70 offen
    v_bfe_u32 v2, v1, 4, 1
    v_lshlrev_b32 v2, 4, v2
    v_bfe_u32 v3, v1, 5, 1
    v_lshl_or_b32 v2, v3, 6, v2
    v_bfe_u32 v3, v1, 4, 2
    v_lshl_or_b32 v2, v3, 13, v2
    v_lshlrev_b32 v3, 4, v6
    v_xor_b32 v38, v2, v3
    v_xor_b32 v39, 0x80, v38
    v_bfe_u32 v2, v1, 5, 1
    v_lshlrev_b32 v2, 5, v2
    v_bfe_u32 v3, v1, 5, 1
    v_lshl_or_b32 v2, v3, 11, v2
    v_bfe_u32 v3, v1, 0, 5
    v_lshlrev_b32 v3, 4, v3
    v_xor_b32 v40, v2, v3
    s_lshl_b32 s71, s67, 6
    v_bfe_u32 v4, v1, 0, 1
    v_lshlrev_b32 v4, 3, v4
    v_bfe_u32 v2, v1, 2, 1
    v_lshl_or_b32 v4, v2, 4, v4
    v_bfe_u32 v2, v1, 1, 1
    v_lshl_or_b32 v4, v2, 5, v4
    v_bfe_u32 v2, v1, 5, 1
    v_lshl_or_b32 v4, v2, 7, v4
    v_bfe_u32 v2, v1, 2, 1
    v_lshl_or_b32 v4, v2, 8, v4
    v_bfe_u32 v2, v1, 4, 2
    v_lshl_or_b32 v4, v2, 10, v4
    v_bfe_u32 v2, v1, 3, 1
    v_lshl_or_b32 v4, v2, 15, v4
    s_lshl_b32 s70, s58, 13
    s_cmp_ge_u32 s58, 4
    s_cselect_b32 s70, 0, s70
    s_or_b32 s70, s70, s71
    v_xor_b32 v126, s70, v4
    v_bfe_u32 v4, v1, 0, 1
    v_lshlrev_b32 v4, 3, v4
    v_bfe_u32 v2, v1, 1, 1
    v_lshl_or_b32 v4, v2, 4, v4
    v_bfe_u32 v2, v1, 2, 1
    v_lshl_or_b32 v4, v2, 5, v4
    v_bfe_u32 v2, v1, 5, 1
    v_lshl_or_b32 v4, v2, 7, v4
    v_bfe_u32 v2, v1, 2, 1
    v_lshl_or_b32 v4, v2, 9, v4
    v_bfe_u32 v2, v1, 5, 1
    v_lshl_or_b32 v4, v2, 11, v4
    v_bfe_u32 v2, v1, 4, 1
    v_lshl_or_b32 v4, v2, 12, v4
    v_bfe_u32 v2, v1, 3, 1
    v_lshl_or_b32 v4, v2, 14, v4
    s_or_b32 s71, s71, 0x10000
    v_xor_b32 v127, s71, v4
    s_lshl_b32 s70, s64, 21
    s_lshl_b32 s71, s58, 18
    s_add_u32 s70, s70, s71
    s_lshl_b32 s71, s66, 8
    s_add_u32 s70, s70, s71
    s_lshl_b32 s71, s58, 13
    s_add_u32 s71, s71, 0
    s_mov_b32 m0, s71
    s_nop 0
    buffer_load_dwordx4 v38, s[24:27], s70 offen lds
    s_add_u32 s71, s71, 0x400
    s_add_u32 s70, s70, 0x8000
    s_mov_b32 m0, s71
    s_nop 0
    buffer_load_dwordx4 v38, s[24:27], s70 offen lds
    s_add_u32 s71, s71, 0x400
    s_add_u32 s70, s70, 0x8000
    s_mov_b32 m0, s71
    s_nop 0
    buffer_load_dwordx4 v39, s[24:27], s70 offen lds
    s_add_u32 s71, s71, 0x400
    s_add_u32 s70, s70, 0x8000
    s_mov_b32 m0, s71
    s_nop 0
    buffer_load_dwordx4 v39, s[24:27], s70 offen lds
    s_add_u32 s71, s71, 0x400
    s_add_u32 s70, s70, 0x8000
    s_mov_b32 m0, s71
    s_nop 0
    buffer_load_dwordx4 v38, s[24:27], s70 offen lds
    s_add_u32 s71, s71, 0x400
    s_add_u32 s70, s70, 0x8000
    s_mov_b32 m0, s71
    s_nop 0
    buffer_load_dwordx4 v38, s[24:27], s70 offen lds
    s_add_u32 s71, s71, 0x400
    s_add_u32 s70, s70, 0x8000
    s_mov_b32 m0, s71
    s_nop 0
    buffer_load_dwordx4 v39, s[24:27], s70 offen lds
    s_add_u32 s71, s71, 0x400
    s_add_u32 s70, s70, 0x8000
    s_mov_b32 m0, s71
    s_nop 0
    buffer_load_dwordx4 v39, s[24:27], s70 offen lds
    s_add_u32 s71, s71, 0x400
    s_add_u32 s70, s70, 0x8000
    s_lshl_b32 s70, s64, 21
    s_lshl_b32 s71, s58, 18
    s_add_u32 s70, s70, s71
    s_lshl_b32 s71, s66, 8
    s_add_u32 s70, s70, s71
    s_lshl_b32 s71, s58, 13
    s_add_u32 s71, s71, 65536
    s_mov_b32 m0, s71
    s_nop 0
    buffer_load_dwordx4 v38, s[28:31], s70 offen lds
    s_add_u32 s71, s71, 0x400
    s_add_u32 s70, s70, 0x8000
    s_mov_b32 m0, s71
    s_nop 0
    buffer_load_dwordx4 v38, s[28:31], s70 offen lds
    s_add_u32 s71, s71, 0x400
    s_add_u32 s70, s70, 0x8000
    s_mov_b32 m0, s71
    s_nop 0
    buffer_load_dwordx4 v39, s[28:31], s70 offen lds
    s_add_u32 s71, s71, 0x400
    s_add_u32 s70, s70, 0x8000
    s_mov_b32 m0, s71
    s_nop 0
    buffer_load_dwordx4 v39, s[28:31], s70 offen lds
    s_add_u32 s71, s71, 0x400
    s_add_u32 s70, s70, 0x8000
    s_mov_b32 m0, s71
    s_nop 0
    buffer_load_dwordx4 v38, s[28:31], s70 offen lds
    s_add_u32 s71, s71, 0x400
    s_add_u32 s70, s70, 0x8000
    s_mov_b32 m0, s71
    s_nop 0
    buffer_load_dwordx4 v38, s[28:31], s70 offen lds
    s_add_u32 s71, s71, 0x400
    s_add_u32 s70, s70, 0x8000
    s_mov_b32 m0, s71
    s_nop 0
    buffer_load_dwordx4 v39, s[28:31], s70 offen lds
    s_add_u32 s71, s71, 0x400
    s_add_u32 s70, s70, 0x8000
    s_mov_b32 m0, s71
    s_nop 0
    buffer_load_dwordx4 v39, s[28:31], s70 offen lds
    s_add_u32 s71, s71, 0x400
    s_add_u32 s70, s70, 0x8000
    s_cmp_lg_u32 s58, 4
    s_cbranch_scc1 novote_6
    s_waitcnt vmcnt(16)
    s_mov_b32 s3, 1
    s_mov_b32 s59, 0
    s_bitcmp1_b32 s57, 0
    s_cselect_b32 s60, -1, 1
    s_cselect_b32 s70, 0x2000, 0
    s_cselect_b32 s71, 0, 0x2000
    s_add_u32 s70, s70, s2
    s_add_u32 s71, s71, s2
    s_mov_b64 s[4:5], 0
    s_buffer_load_dword s4, s[8:11], s70
    s_buffer_load_dword s5, s[8:11], s71
    s_waitcnt lgkmcnt(1)
    s_sub_u32 s72, s4, s5
    s_waitcnt lgkmcnt(0)
    s_mul_i32 s72, s72, s60
    s_add_u32 s72, s72, 1
    s_min_u32 s72, s72, 2
    s_lshl_b32 s72, s72, 10
    s_add_u32 s3, s3, s72
    s_add_u32 s70, s70, 0x200000
    s_add_u32 s71, s71, 0x200000
    s_mov_b64 s[4:5], 0
    s_buffer_load_dword s4, s[8:11], s70
    s_buffer_load_dword s5, s[8:11], s71
    s_waitcnt lgkmcnt(1)
    s_sub_u32 s72, s4, s5
    s_waitcnt lgkmcnt(0)
    s_mul_i32 s72, s72, s60
    s_add_u32 s72, s72, 1
    s_min_u32 s72, s72, 2
    s_lshl_b32 s72, s72, 20
    s_add_u32 s3, s3, s72
    s_add_u32 s70, s70, 0x200000
    s_add_u32 s71, s71, 0x200000
    s_mov_b64 s[4:5], 0
    s_buffer_load_dword s4, s[8:11], s70
    s_buffer_load_dword s5, s[8:11], s71
    s_waitcnt lgkmcnt(1)
    s_sub_u32 s72, s4, s5
    s_waitcnt lgkmcnt(0)
    s_mul_i32 s72, s72, s60
    s_add_u32 s72, s72, 1
    s_min_u32 s72, s72, 2
    s_lshl_b32 s72, s72, 10
    s_add_u32 s59, s59, s72
    s_add_u32 s70, s70, 0x200000
    s_add_u32 s71, s71, 0x200000
    s_mov_b64 s[4:5], 0
    s_buffer_load_dword s4, s[8:11], s70
    s_buffer_load_dword s5, s[8:11], s71
    s_waitcnt lgkmcnt(1)
    s_sub_u32 s72, s4, s5
    s_waitcnt lgkmcnt(0)
    s_mul_i32 s72, s72, s60
    s_add_u32 s72, s72, 1
    s_min_u32 s72, s72, 2
    s_lshl_b32 s72, s72, 20
    s_add_u32 s59, s59, s72
    s_add_u32 s70, s70, 0x200000
    s_add_u32 s71, s71, 0x200000
novote_6:
    s_waitcnt vmcnt(0)
    s_barrier
    s_cmp_lg_u32 s58, 4
    s_cbranch_scc1 nosig_7
    v_mov_b32 v2, s3
    v_mov_b32 v3, s59
    v_cmp_eq_u32 vcc, 0, v1
    v_mov_b32 v5, 32
    v_mov_b32 v4, 0x5ffffff0
    v_cndmask_b32 v4, v4, v5, vcc
    buffer_atomic_add_x2 v[2:3], v4, s[12:15], 0 offen sc1
nosig_7:
    s_cmp_ge_u32 s58, 4
    s_cbranch_scc1 skip_8
    v_xor_b32 v2, 0x0, v126
    v_xor_b32 v3, 0x40, v126
    ds_read_b64_tr_b16 v[192:193], v2 offset:0
    ds_read_b64_tr_b16 v[194:195], v3 offset:512
    ds_read_b64_tr_b16 v[196:197], v2 offset:4096
    ds_read_b64_tr_b16 v[198:199], v3 offset:4608
    v_xor_b32 v2, 0x2000, v126
    v_xor_b32 v3, 0x2040, v126
    ds_read_b64_tr_b16 v[200:201], v2 offset:0
    ds_read_b64_tr_b16 v[202:203], v3 offset:512
    ds_read_b64_tr_b16 v[204:205], v2 offset:4096
    ds_read_b64_tr_b16 v[206:207], v3 offset:4608
    v_xor_b32 v2, 0x4000, v126
    v_xor_b32 v3, 0x4040, v126
    ds_read_b64_tr_b16 v[208:209], v2 offset:0
    ds_read_b64_tr_b16 v[210:211], v3 offset:512
    ds_read_b64_tr_b16 v[212:213], v2 offset:4096
    ds_read_b64_tr_b16 v[214:215], v3 offset:4608
    v_xor_b32 v2, 0x6000, v126
    v_xor_b32 v3, 0x6040, v126
    ds_read_b64_tr_b16 v[216:217], v2 offset:0
    ds_read_b64_tr_b16 v[218:219], v3 offset:512
    ds_read_b64_tr_b16 v[220:221], v2 offset:4096
    ds_read_b64_tr_b16 v[222:223], v3 offset:4608
    s_waitcnt lgkmcnt(0)
    v_xor_b32 v2, 0x10, v126
    v_xor_b32 v3, 0x50, v126
    ds_read_b64_tr_b16 v[224:225], v2 offset:0
    ds_read_b64_tr_b16 v[226:227], v3 offset:512
    ds_read_b64_tr_b16 v[228:229], v2 offset:4096
    ds_read_b64_tr_b16 v[230:231], v3 offset:4608
    v_xor_b32 v2, 0x2010, v126
    v_xor_b32 v3, 0x2050, v126
    ds_read_b64_tr_b16 v[232:233], v2 offset:0
    ds_read_b64_tr_b16 v[234:235], v3 offset:512
    ds_read_b64_tr_b16 v[236:237], v2 offset:4096
    ds_read_b64_tr_b16 v[238:239], v3 offset:4608
    v_xor_b32 v2, 0x4010, v126
    v_xor_b32 v3, 0x4050, v126
    ds_read_b64_tr_b16 v[240:241], v2 offset:0
    ds_read_b64_tr_b16 v[242:243], v3 offset:512
    ds_read_b64_tr_b16 v[244:245], v2 offset:4096
    ds_read_b64_tr_b16 v[246:247], v3 offset:4608
    v_xor_b32 v2, 0x6010, v126
    v_xor_b32 v3, 0x6050, v126
    ds_read_b64_tr_b16 v[248:249], v2 offset:0
    ds_read_b64_tr_b16 v[250:251], v3 offset:512
    ds_read_b64_tr_b16 v[252:253], v2 offset:4096
    ds_read_b64_tr_b16 v[254:255], v3 offset:4608
    s_waitcnt lgkmcnt(0)
skip_8:
    s_cmp_ge_u32 s58, 4
    s_cbranch_scc0 skip_9
    v_xor_b32 v2, 0x10000, v126
    v_xor_b32 v3, 0x10040, v126
    ds_read_b64_tr_b16 v[128:129], v2 offset:0
    ds_read_b64_tr_b16 v[130:131], v3 offset:512
    ds_read_b64_tr_b16 v[132:133], v2 offset:4096
    ds_read_b64_tr_b16 v[134:135], v3 offset:4608
    v_xor_b32 v2, 0x12000, v126
    v_xor_b32 v3, 0x12040, v126
    ds_read_b64_tr_b16 v[136:137], v2 offset:0
    ds_read_b64_tr_b16 v[138:139], v3 offset:512
    ds_read_b64_tr_b16 v[140:141], v2 offset:4096
    ds_read_b64_tr_b16 v[142:143], v3 offset:4608
    v_xor_b32 v2, 0x14000, v126
    v_xor_b32 v3, 0x14040, v126
    ds_read_b64_tr_b16 v[144:145], v2 offset:0
    ds_read_b64_tr_b16 v[146:147], v3 offset:512
    ds_read_b64_tr_b16 v[148:149], v2 offset:4096
    ds_read_b64_tr_b16 v[150:151], v3 offset:4608
    v_xor_b32 v2, 0x16000, v126
    v_xor_b32 v3, 0x16040, v126
    ds_read_b64_tr_b16 v[152:153], v2 offset:0
    ds_read_b64_tr_b16 v[154:155], v3 offset:512
    ds_read_b64_tr_b16 v[156:157], v2 offset:4096
    ds_read_b64_tr_b16 v[158:159], v3 offset:4608
    s_waitcnt lgkmcnt(0)
    v_xor_b32 v2, 0x10010, v126
    v_xor_b32 v3, 0x10050, v126
    ds_read_b64_tr_b16 v[160:161], v2 offset:0
    ds_read_b64_tr_b16 v[162:163], v3 offset:512
    ds_read_b64_tr_b16 v[164:165], v2 offset:4096
    ds_read_b64_tr_b16 v[166:167], v3 offset:4608
    v_xor_b32 v2, 0x12010, v126
    v_xor_b32 v3, 0x12050, v126
    ds_read_b64_tr_b16 v[168:169], v2 offset:0
    ds_read_b64_tr_b16 v[170:171], v3 offset:512
    ds_read_b64_tr_b16 v[172:173], v2 offset:4096
    ds_read_b64_tr_b16 v[174:175], v3 offset:4608
    v_xor_b32 v2, 0x14010, v126
    v_xor_b32 v3, 0x14050, v126
    ds_read_b64_tr_b16 v[176:177], v2 offset:0
    ds_read_b64_tr_b16 v[178:179], v3 offset:512
    ds_read_b64_tr_b16 v[180:181], v2 offset:4096
    ds_read_b64_tr_b16 v[182:183], v3 offset:4608
    v_xor_b32 v2, 0x16010, v126
    v_xor_b32 v3, 0x16050, v126
    ds_read_b64_tr_b16 v[184:185], v2 offset:0
    ds_read_b64_tr_b16 v[186:187], v3 offset:512
    ds_read_b64_tr_b16 v[188:189], v2 offset:4096
    ds_read_b64_tr_b16 v[190:191], v3 offset:4608
    s_waitcnt lgkmcnt(0)
skip_9:
    s_barrier
    s_lshl_b32 s70, s64, 21
    s_lshl_b32 s71, s58, 18
    s_add_u32 s70, s70, s71
    s_lshl_b32 s71, s66, 8
    s_add_u32 s70, s70, s71
    s_lshl_b32 s71, s58, 13
    s_add_u32 s71, s71, 0
    s_mov_b32 m0, s71
    s_nop 0
    buffer_load_dwordx4 v38, s[20:23], s70 offen lds
    s_add_u32 s71, s71, 0x400
    s_add_u32 s70, s70, 0x8000
    s_mov_b32 m0, s71
    s_nop 0
    buffer_load_dwordx4 v38, s[20:23], s70 offen lds
    s_add_u32 s71, s71, 0x400
    s_add_u32 s70, s70, 0x8000
    s_mov_b32 m0, s71
    s_nop 0
    buffer_load_dwordx4 v39, s[20:23], s70 offen lds
    s_add_u32 s71, s71, 0x400
    s_add_u32 s70, s70, 0x8000
    s_mov_b32 m0, s71
    s_nop 0
    buffer_load_dwordx4 v39, s[20:23], s70 offen lds
    s_add_u32 s71, s71, 0x400
    s_add_u32 s70, s70, 0x8000
    s_mov_b32 m0, s71
    s_nop 0
    buffer_load_dwordx4 v38, s[20:23], s70 offen lds
    s_add_u32 s71, s71, 0x400
    s_add_u32 s70, s70, 0x8000
    s_mov_b32 m0, s71
    s_nop 0
    buffer_load_dwordx4 v38, s[20:23], s70 offen lds
    s_add_u32 s71, s71, 0x400
    s_add_u32 s70, s70, 0x8000
    s_mov_b32 m0, s71
    s_nop 0
    buffer_load_dwordx4 v39, s[20:23], s70 offen lds
    s_add_u32 s71, s71, 0x400
    s_add_u32 s70, s70, 0x8000
    s_mov_b32 m0, s71
    s_nop 0
    buffer_load_dwordx4 v39, s[20:23], s70 offen lds
    s_add_u32 s71, s71, 0x400
    s_add_u32 s70, s70, 0x8000
    s_lshl_b32 s70, s66, 18
    s_lshl_b32 s71, s58, 15
    s_add_u32 s70, s70, s71
    s_lshl_b32 s71, s64, 9
    s_add_u32 s70, s70, s71
    s_lshl_b32 s71, s58, 13
    s_add_u32 s71, s71, 65536
    v_xor_b32 v2, 0, v40
    s_mov_b32 m0, s71
    s_nop 0
    buffer_load_dwordx4 v2, s[32:35], s70 offen lds
    s_add_u32 s71, s71, 0x400
    s_add_u32 s70, s70, 0x1000
    v_xor_b32 v2, 64, v40
    s_mov_b32 m0, s71
    s_nop 0
    buffer_load_dwordx4 v2, s[32:35], s70 offen lds
    s_add_u32 s71, s71, 0x400
    s_add_u32 s70, s70, 0x1000
    v_xor_b32 v2, 128, v40
    s_mov_b32 m0, s71
    s_nop 0
    buffer_load_dwordx4 v2, s[32:35], s70 offen lds
    s_add_u32 s71, s71, 0x400
    s_add_u32 s70, s70, 0x1000
    v_xor_b32 v2, 192, v40
    s_mov_b32 m0, s71
    s_nop 0
    buffer_load_dwordx4 v2, s[32:35], s70 offen lds
    s_add_u32 s71, s71, 0x400
    s_add_u32 s70, s70, 0x1000
    v_xor_b32 v2, 0, v40
    s_mov_b32 m0, s71
    s_nop 0
    buffer_load_dwordx4 v2, s[32:35], s70 offen lds
    s_add_u32 s71, s71, 0x400
    s_add_u32 s70, s70, 0x1000
    v_xor_b32 v2, 64, v40
    s_mov_b32 m0, s71
    s_nop 0
    buffer_load_dwordx4 v2, s[32:35], s70 offen lds
    s_add_u32 s71, s71, 0x400
    s_add_u32 s70, s70, 0x1000
    v_xor_b32 v2, 128, v40
    s_mov_b32 m0, s71
    s_nop 0
    buffer_load_dwordx4 v2, s[32:35], s70 offen lds
    s_add_u32 s71, s71, 0x400
    s_add_u32 s70, s70, 0x1000
    v_xor_b32 v2, 192, v40
    s_mov_b32 m0, s71
    s_nop 0
    buffer_load_dwordx4 v2, s[32:35], s70 offen lds
    s_add_u32 s71, s71, 0x400
    s_add_u32 s70, s70, 0x1000
    s_mov_b32 s68, 0
    s_mov_b32 s82, 0
    s_lshl_b32 s80, s66, 11
    s_lshl_b32 s70, s67, 9
    s_add_u32 s80, s80, s70
    v_bfe_u32 v38, v1, 0, 3
    v_lshlrev_b32 v38, 4, v38
    v_bfe_u32 v2, v1, 3, 1
    v_lshl_or_b32 v38, v2, 8, v38
    v_bfe_u32 v2, v1, 4, 2
    v_lshl_or_b32 v38, v2, 9, v38
    s_lshl_b32 s75, s80, 2
    s_add_u32 s75, s75, 0x1000000
    s_cmp_ge_u32 s58, 4
    s_cbranch_scc1 vo_main_10
    s_setprio 3
    s_lshl_b32 s70, s66, 4
    s_lshl_b32 s71, s64, 2
    s_add_u32 s71, s71, s67
    s_add_u32 s3, s70, s71
    s_add_u32 s80, s80, 0x3ff0000
    s_lshl_b32 s70, s67, 10
    v_add_u32 v102, s70, v8
    v_lshrrev_b32 v103, 2, v102
    v_bfe_u32 v2, v1, 0, 3
    v_lshlrev_b32 v2, 4, v2
    v_bfe_u32 v3, v1, 4, 2
    v_lshl_or_b32 v2, v3, 7, v2
    v_mov_b32 v3, 0x5ffffff0
    v_cmp_le_u32 vcc, 8, v6
    s_nop 1
    v_cndmask_b32 v104, v3, v2, vcc
    v_xor_b32 v100, 1024, v102
    v_xor_b32 v101, 2048, v102
    v_xor_b32 v36, 3072, v102
    v_xor_b32 v106, 0x400, v34
    v_bfe_u32 v105, v1, 0, 4
    v_lshlrev_b32 v105, 4, v105
    v_bfe_u32 v2, v1, 4, 2
    v_lshl_or_b32 v105, v2, 9, v105
    s_lshl_b32 s70, s64, 10
    s_xor_b32 s70, s70, 0x800
    v_xor_b32 v105, s70, v105
    v_and_b32 v2, 1, v1
    v_lshlrev_b32 v2, 4, v2
    v_mov_b32 v3, 0x3f80
    v_lshlrev_b32 v2, v2, v3
    v_bfe_u32 v3, v1, 1, 1
    v_bfe_u32 v4, v1, 3, 1
    v_lshl_or_b32 v3, v4, 1, v3
    v_bfe_u32 v4, v1, 2, 1
    v_lshl_or_b32 v3, v4, 2, v3
    v_bfe_u32 v4, v1, 4, 1
    v_lshlrev_b32 v4, 2, v4
    v_xor_b32 v3, v3, v4
    v_cmp_eq_u32 vcc, 0, v3
    s_nop 1
    v_cndmask_b32 v26, 0, v2, vcc
    v_cmp_eq_u32 vcc, 1, v3
    s_nop 1
    v_cndmask_b32 v27, 0, v2, vcc
    v_cmp_eq_u32 vcc, 2, v3
    s_nop 1
    v_cndmask_b32 v28, 0, v2, vcc
    v_cmp_eq_u32 vcc, 3, v3
    s_nop 1
    v_cndmask_b32 v29, 0, v2, vcc
    v_bfe_u32 v3, v1, 1, 1
    v_bfe_u32 v4, v1, 3, 1
    v_lshl_or_b32 v3, v4, 1, v3
    v_bfe_u32 v4, v1, 4, 1
    v_lshl_or_b32 v3, v4, 2, v3
    v_bfe_u32 v4, v1, 2, 1
    v_lshl_or_b32 v3, v4, 3, v3
    v_bfe_u32 v4, v1, 5, 1
    v_lshlrev_b32 v4, 3, v4
    v_xor_b32 v3, v3, v4
    v_cmp_eq_u32 vcc, 0, v3
    s_nop 1
    v_cndmask_b32 v92, 0, v2, vcc
    v_cmp_eq_u32 vcc, 1, v3
    s_nop 1
    v_cndmask_b32 v93, 0, v2, vcc
    v_cmp_eq_u32 vcc, 2, v3
    s_nop 1
    v_cndmask_b32 v94, 0, v2, vcc
    v_cmp_eq_u32 vcc, 3, v3
    s_nop 1
    v_cndmask_b32 v95, 0, v2, vcc
    v_cmp_eq_u32 vcc, 4, v3
    s_nop 1
    v_cndmask_b32 v96, 0, v2, vcc
    v_cmp_eq_u32 vcc, 5, v3
    s_nop 1
    v_cndmask_b32 v97, 0, v2, vcc
    v_cmp_eq_u32 vcc, 6, v3
    s_nop 1
    v_cndmask_b32 v98, 0, v2, vcc
    v_cmp_eq_u32 vcc, 7, v3
    s_nop 1
    v_cndmask_b32 v99, 0, v2, vcc
    v_bfe_u32 v3, v1, 2, 1
    v_bfe_u32 v4, v1, 1, 1
    v_lshl_or_b32 v3, v4, 1, v3
    v_bfe_u32 v4, v1, 3, 1
    v_lshl_or_b32 v3, v4, 2, v3
    v_bfe_u32 v4, v1, 4, 1
    v_lshlrev_b32 v4, 2, v4
    v_xor_b32 v3, v3, v4
    v_cmp_eq_u32 vcc, 0, v3
    s_nop 1
    v_cndmask_b32 v30, 0, v2, vcc
    v_cmp_eq_u32 vcc, 1, v3
    s_nop 1
    v_cndmask_b32 v31, 0, v2, vcc
    v_cmp_eq_u32 vcc, 2, v3
    s_nop 1
    v_cndmask_b32 v32, 0, v2, vcc
    v_cmp_eq_u32 vcc, 3, v3
    s_nop 1
    v_cndmask_b32 v33, 0, v2, vcc
    v_mov_b32 v40, 0
    v_mov_b32 v41, 0
    v_mov_b32 v42, 0
    v_mov_b32 v43, 0
    v_mov_b32 v44, 0
    v_mov_b32 v45, 0
    v_mov_b32 v46, 0
    v_mov_b32 v47, 0
    v_mov_b32 v48, 0
    v_mov_b32 v49, 0
    v_mov_b32 v50, 0
    v_mov_b32 v51, 0
    v_mov_b32 v52, 0
    v_mov_b32 v53, 0
    v_mov_b32 v54, 0
    v_mov_b32 v55, 0
    s_waitcnt vmcnt(8)
    s_barrier
    v_xor_b32 v2, 0x0, v126
    v_xor_b32 v3, 0x40, v126
    ds_read_b64_tr_b16 v[128:129], v2 offset:0
    ds_read_b64_tr_b16 v[130:131], v3 offset:512
    ds_read_b64_tr_b16 v[132:133], v2 offset:4096
    ds_read_b64_tr_b16 v[134:135], v3 offset:4608
    v_xor_b32 v2, 0x2000, v126
    v_xor_b32 v3, 0x2040, v126
    ds_read_b64_tr_b16 v[136:137], v2 offset:0
    ds_read_b64_tr_b16 v[138:139], v3 offset:512
    ds_read_b64_tr_b16 v[140:141], v2 offset:4096
    ds_read_b64_tr_b16 v[142:143], v3 offset:4608
    v_xor_b32 v2, 0x4000, v126
    v_xor_b32 v3, 0x4040, v126
    ds_read_b64_tr_b16 v[144:145], v2 offset:0
    ds_read_b64_tr_b16 v[146:147], v3 offset:512
    ds_read_b64_tr_b16 v[148:149], v2 offset:4096
    ds_read_b64_tr_b16 v[150:151], v3 offset:4608
    v_xor_b32 v2, 0x6000, v126
    v_xor_b32 v3, 0x6040, v126
    ds_read_b64_tr_b16 v[152:153], v2 offset:0
    ds_read_b64_tr_b16 v[154:155], v3 offset:512
    ds_read_b64_tr_b16 v[156:157], v2 offset:4096
    ds_read_b64_tr_b16 v[158:159], v3 offset:4608
    s_waitcnt lgkmcnt(0)
    v_xor_b32 v2, 0x10, v126
    v_xor_b32 v3, 0x50, v126
    ds_read_b64_tr_b16 v[160:161], v2 offset:0
    ds_read_b64_tr_b16 v[162:163], v3 offset:512
    ds_read_b64_tr_b16 v[164:165], v2 offset:4096
    ds_read_b64_tr_b16 v[166:167], v3 offset:4608
    v_xor_b32 v2, 0x2010, v126
    v_xor_b32 v3, 0x2050, v126
    ds_read_b64_tr_b16 v[168:169], v2 offset:0
    ds_read_b64_tr_b16 v[170:171], v3 offset:512
    ds_read_b64_tr_b16 v[172:173], v2 offset:4096
    ds_read_b64_tr_b16 v[174:175], v3 offset:4608
    v_xor_b32 v2, 0x4010, v126
    v_xor_b32 v3, 0x4050, v126
    ds_read_b64_tr_b16 v[176:177], v2 offset:0
    ds_read_b64_tr_b16 v[178:179], v3 offset:512
    ds_read_b64_tr_b16 v[180:181], v2 offset:4096
    ds_read_b64_tr_b16 v[182:183], v3 offset:4608
    v_xor_b32 v2, 0x6010, v126
    v_xor_b32 v3, 0x6050, v126
    ds_read_b64_tr_b16 v[184:185], v2 offset:0
    ds_read_b64_tr_b16 v[186:187], v3 offset:512
    ds_read_b64_tr_b16 v[188:189], v2 offset:4096
    ds_read_b64_tr_b16 v[190:191], v3 offset:4608
    s_waitcnt lgkmcnt(0)
    s_lshl_b32 s4, s66, 7
    s_add_u32 s4, s4, 0x5110000
    s_waitcnt vmcnt(0)
    v_mov_b32 v4, 0x27ff0
    s_barrier
    ds_read_b64 v[2:3], v4
    s_mov_b32 s59, 0
    s_waitcnt lgkmcnt(0)
    v_readfirstlane_b32 s70, v2
    v_readfirstlane_b32 s71, v3
    s_bfe_u32 s72, s70, 0xa000a
    s_cmp_gt_u32 s72, 128
    s_cselect_b32 s72, 1, 0
    s_or_b32 s59, s59, s72
    s_bfe_u32 s72, s70, 0xa0014
    s_cmp_gt_u32 s72, 128
    s_cselect_b32 s72, 2, 0
    s_or_b32 s59, s59, s72
    s_bfe_u32 s72, s71, 0xa000a
    s_cmp_gt_u32 s72, 128
    s_cselect_b32 s72, 4, 0
    s_or_b32 s59, s59, s72
    s_bfe_u32 s72, s71, 0xa0014
    s_cmp_gt_u32 s72, 128
    s_cselect_b32 s72, 8, 0
    s_or_b32 s59, s59, s72
    s_and_b32 s70, s59, 1
    s_lshl_b32 s70, s70, 13
    s_add_u32 s77, s77, s70
    s_add_u32 s76, s76, s70
    s_branch qk_loop_13
.p2align 6
qk_c_14:
    s_barrier
    buffer_load_dwordx4 v[56:59], v37, s[8:11], s76 offen offset:0 sc1
    buffer_load_dwordx4 v[60:63], v37, s[8:11], s76 offen offset:1024 sc1
    buffer_load_dwordx4 v[64:67], v37, s[8:11], s76 offen offset:2048 sc1
    buffer_load_dwordx4 v[68:71], v37, s[8:11], s76 offen offset:3072 sc1
c_w_16:
    s_waitcnt vmcnt(3)
    v_mfma_f32_16x16x32_bf16 v[72:75], v[56:59], v[30:33], 0
    s_waitcnt vmcnt(2)
    v_mfma_f32_16x16x32_bf16 v[72:75], v[60:63], v[30:33], v[72:75]
    s_waitcnt vmcnt(1)
    v_mfma_f32_16x16x32_bf16 v[76:79], v[64:67], v[30:33], 0
    v_max3_u32 v2, v56, v60, v64
    s_waitcnt vmcnt(0)
    v_mfma_f32_16x16x32_bf16 v[76:79], v[68:71], v[30:33], v[76:79]
    v_max_u32 v2, v2, v68
    v_cmp_eq_u32 vcc, -1, v2
    s_cbranch_vccnz c_s_15
c_j_17:
    v_cvt_pk_bf16_f32 v10, v72, v73
    v_cvt_pk_bf16_f32 v11, v74, v75
    s_nop 2
    v_cvt_pk_bf16_f32 v12, v76, v77
    v_cvt_pk_bf16_f32 v13, v78, v79
qk_loop_13:
    ds_write_b128 v102, v[10:13] offset:0
    s_waitcnt lgkmcnt(0)
    s_barrier
    ds_read_b128 v[14:17], v100 offset:0
    ds_read_b128 v[18:21], v101 offset:0
    ds_read_b128 v[22:25], v36 offset:0
    v_smfmac_f32_16x16x64_bf16 v[40:43], v[10:13], v[128:135], v7
    v_smfmac_f32_16x16x64_bf16 v[44:47], v[10:13], v[160:167], v7
    v_smfmac_f32_16x16x64_bf16 v[48:51], v[10:13], v[192:199], v7
    v_smfmac_f32_16x16x64_bf16 v[52:55], v[10:13], v[224:231], v7
    s_waitcnt lgkmcnt(2)
    v_smfmac_f32_16x16x64_bf16 v[40:43], v[14:17], v[136:143], v7
    v_smfmac_f32_16x16x64_bf16 v[44:47], v[14:17], v[168:175], v7
    s_waitcnt lgkmcnt(1)
    v_smfmac_f32_16x16x64_bf16 v[40:43], v[18:21], v[144:151], v7
    v_smfmac_f32_16x16x64_bf16 v[44:47], v[18:21], v[176:183], v7
    s_waitcnt lgkmcnt(0)
    v_smfmac_f32_16x16x64_bf16 v[40:43], v[22:25], v[152:159], v7
    v_smfmac_f32_16x16x64_bf16 v[44:47], v[22:25], v[184:191], v7
    v_smfmac_f32_16x16x64_bf16 v[48:51], v[14:17], v[200:207], v7
    v_smfmac_f32_16x16x64_bf16 v[48:51], v[18:21], v[208:215], v7
    v_smfmac_f32_16x16x64_bf16 v[48:51], v[22:25], v[216:223], v7
    v_smfmac_f32_16x16x64_bf16 v[52:55], v[14:17], v[232:239], v7
    s_nop 1
    v_smfmac_f32_16x16x64_bf16 v[52:55], v[18:21], v[240:247], v7
    v_pk_add_f32 v[40:41], v[40:41], v[42:43]
    v_cvt_pk_bf16_f32 v80, v40, v41
    v_smfmac_f32_16x16x64_bf16 v[52:55], v[22:25], v[248:255], v7
    v_pk_add_f32 v[44:45], v[44:45], v[46:47]
    v_cvt_pk_bf16_f32 v81, v44, v45
    v_pk_add_f32 v[48:49], v[48:49], v[50:51]
    v_cvt_pk_bf16_f32 v82, v48, v49
    v_permlane16_swap_b32 v80, v81
    v_bfi_b32 v80, 1, s82, v80
    s_nop 1
    v_pk_add_f32 v[52:53], v[52:53], v[54:55]
    v_cvt_pk_bf16_f32 v83, v52, v53
    s_nop 1
    v_permlane16_swap_b32 v82, v83
    buffer_store_dwordx4 v[80:83], v34, s[8:11], s73 offen
    s_barrier
    s_cmp_le_u32 s68, 1
    s_cbranch_scc1 kv0_18
kv0j_19:
    v_mfma_f32_16x16x32_bf16 v[72:75], v[80:83], v[92:95], 0
    v_mfma_f32_16x16x32_bf16 v[76:79], v[80:83], v[96:99], 0
    v_mov_b32 v40, 0
    v_mov_b32 v41, 0
    v_mov_b32 v42, 0
    v_mov_b32 v43, 0
    v_mov_b32 v44, 0
    v_mov_b32 v45, 0
    v_mov_b32 v46, 0
    v_mov_b32 v47, 0
    v_mov_b32 v48, 0
    v_mov_b32 v49, 0
    v_mov_b32 v50, 0
    v_mov_b32 v51, 0
    v_mov_b32 v52, 0
    v_mov_b32 v53, 0
    v_mov_b32 v54, 0
    v_mov_b32 v55, 0
    s_add_u32 s80, s80, 0x10000
    s_and_b32 s72, s68, 3
    buffer_load_dwordx4 v[56:59], v106, s[8:11], s73 offen sc1
    buffer_load_dwordx4 v[60:63], v105, s[8:11], s73 offen sc1
    buffer_load_dwordx4 v[64:67], v105, s[8:11], s73 offen offset:256 sc1
x_w_21:
    s_waitcnt vmcnt(2)
    v_mfma_f32_16x16x32_bf16 v[18:21], v[56:59], v[92:95], v[72:75]
    v_mfma_f32_16x16x32_bf16 v[22:25], v[56:59], v[96:99], v[76:79]
    s_waitcnt vmcnt(1)
    v_mfma_f32_16x16x32_bf16 v[18:21], v[60:63], v[26:29], v[18:21]
    v_bitop3_b32 v2, v56, v60, s82 bitop3:0x7e
    s_waitcnt vmcnt(0)
    v_mfma_f32_16x16x32_bf16 v[22:25], v[64:67], v[26:29], v[22:25]
    v_xor_b32 v3, s82, v64
    v_bitop3_b32 v2, v2, v3, 1 bitop3:0xa8
    v_cmp_ne_u32 vcc, 0, v2
    s_cbranch_vccnz x_s_20
x_j_22:
    s_nop 0
    v_cvt_pk_bf16_f32 v80, v18, v19
    v_cvt_pk_bf16_f32 v81, v20, v21
    s_nop 0
    v_cvt_pk_bf16_f32 v82, v22, v23
    v_cvt_pk_bf16_f32 v83, v24, v25
    s_nop 1
    v_mfma_f32_16x16x32_bf16 v[18:21], v[80:83], v[80:83], 0
    s_cmp_eq_u32 s68, 63
    s_cbranch_scc1 lastk_23
    v_mfma_f32_16x16x32_bf16 v[14:17], v[88:91], v[80:83], 0
    s_nop 1
    v_mfma_f32_16x16x32_bf16 v[10:13], v[84:87], v[80:83], 0
    s_nop 1
    v_mov_b32_dpp v18, v20 row_shr:8 row_mask:0xf bank_mask:0xc
    v_mov_b32_dpp v19, v21 row_shr:8 row_mask:0xf bank_mask:0xc
    s_nop 1
    v_permlane32_swap_b32 v18, v19
    ds_write_b32 v103, v19 offset:8192
    v_mov_b32_dpp v10, v14 row_shr:8 row_mask:0xf bank_mask:0xc
    v_mov_b32_dpp v11, v15 row_shr:8 row_mask:0xf bank_mask:0xc
    v_mov_b32_dpp v12, v16 row_shr:8 row_mask:0xf bank_mask:0xc
    v_mov_b32_dpp v13, v17 row_shr:8 row_mask:0xf bank_mask:0xc
    ds_write_b128 v102, v[10:13] offset:4096
    s_waitcnt lgkmcnt(0)
    s_barrier
    s_setprio 0
    s_add_u32 s77, s77, 0x20000
    s_lshr_b32 s60, s77, 21
    s_bitcmp1_b32 s59, s60
    s_cselect_b32 s60, 0x2000, 0
    s_bitset0_b32 s77, 13
    s_or_b32 s77, s77, s60
    s_add_u32 s76, s76, 0x20000
    s_lshr_b32 s60, s76, 21
    s_bitcmp1_b32 s59, s60
    s_cselect_b32 s60, 0x2000, 0
    s_bitset0_b32 s76, 13
    s_or_b32 s76, s76, s60
lastk_23:
    s_cmp_lg_u32 s72, s64
    s_cbranch_scc1 nokm_24
    v_min_u32 v80, -2, v80
    buffer_store_dwordx4 v[80:83], v104, s[8:11], s80 offen sc1
nokm_24:
    s_cmp_eq_u32 s68, 63
    s_cbranch_scc1 chain_end_11
    buffer_load_dwordx4 v[84:87], v38, s[8:11], s75 offen offset:0
    buffer_load_dwordx4 v[88:91], v38, s[8:11], s75 offen offset:128
    s_add_u32 s75, s75, 0x40000
    v_mov_b32 v10, -1
    v_mov_b32 v11, -1
    v_mov_b32 v12, -1
    v_mov_b32 v13, -1
    buffer_store_dwordx4 v[10:13], v35, s[8:11], s77 offen sc1
    s_cmp_lg_u32 s3, 1
    s_cbranch_scc1 noprog_25
    v_mov_b32 v2, s68
    buffer_store_dword v2, off, s[12:15], 0 offset:64 sc1
noprog_25:
    s_barrier
    s_add_u32 s68, s68, 1
    s_bfe_u32 s82, s68, 0x10001
    s_xor_b32 s73, s73, 0x80000
    s_setprio 3
    s_branch qk_c_14
c_s_15:
    buffer_load_dwordx4 v[56:59], v37, s[8:11], s76 offen offset:0 sc1
    buffer_load_dwordx4 v[60:63], v37, s[8:11], s76 offen offset:1024 sc1
    buffer_load_dwordx4 v[64:67], v37, s[8:11], s76 offen offset:2048 sc1
    buffer_load_dwordx4 v[68:71], v37, s[8:11], s76 offen offset:3072 sc1
    s_sub_u32 s69, s69, 1
    s_cbranch_scc0 c_w_16
    s_mov_b32 s69, 0
    s_branch c_j_17
kv0_18:
    s_bitset0_b32 s75, 30
    buffer_load_dwordx4 v[84:87], v38, s[8:11], s75 offen offset:0
    buffer_load_dwordx4 v[88:91], v38, s[8:11], s75 offen offset:128
    s_add_u32 s75, s75, 0x40000
    s_cmp_lt_u32 s68, 1
    s_cbranch_scc0 kv0j_19
    s_add_u32 s75, s75, 0x3ffc0000
    s_branch kv0j_19
x_s_20:
    buffer_load_dwordx4 v[56:59], v106, s[8:11], s73 offen sc1
    buffer_load_dwordx4 v[60:63], v105, s[8:11], s73 offen sc1
    buffer_load_dwordx4 v[64:67], v105, s[8:11], s73 offen offset:256 sc1
    s_sub_u32 s69, s69, 1
    s_cbranch_scc0 x_w_21
    s_mov_b32 s69, 0
    s_branch x_j_22
vo_main_10:
    s_setprio 1
    v_mov_b32 v88, 0x3f803f80
    v_mov_b32 v92, 0x3e803e80
    v_mov_b32 v89, 0x3f803f80
    v_mov_b32 v93, 0x3e803e80
    v_mov_b32 v90, 0x3f803f80
    v_mov_b32 v94, 0x3e803e80
    v_mov_b32 v91, 0x3f803f80
    v_mov_b32 v95, 0x3e803e80
    v_and_b32 v2, 1, v1
    v_lshlrev_b32 v2, 4, v2
    v_mov_b32 v3, 0x3f80
    v_lshlrev_b32 v2, v2, v3
    v_lshrrev_b32 v3, 1, v6
    v_cmp_eq_u32 vcc, 0, v3
    s_nop 1
    v_cndmask_b32 v26, 0, v2, vcc
    v_cmp_eq_u32 vcc, 1, v3
    s_nop 1
    v_cndmask_b32 v27, 0, v2, vcc
    v_cmp_eq_u32 vcc, 2, v3
    s_nop 1
    v_cndmask_b32 v28, 0, v2, vcc
    v_cmp_eq_u32 vcc, 3, v3
    s_nop 1
    v_cndmask_b32 v29, 0, v2, vcc
    v_bfe_u32 v119, v1, 0, 3
    v_lshlrev_b32 v119, 3, v119
    v_bfe_u32 v3, v1, 3, 1
    v_lshl_or_b32 v119, v3, 7, v119
    v_bfe_u32 v3, v1, 5, 1
    v_lshl_or_b32 v119, v3, 6, v119
    v_bfe_u32 v3, v1, 4, 1
    v_lshl_or_b32 v119, v3, 8, v119
    v_bfe_u32 v3, v1, 1, 3
    v_bfe_u32 v4, v1, 4, 1
    v_lshlrev_b32 v4, 1, v4
    v_xor_b32 v3, v3, v4
    v_cmp_eq_u32 vcc, 0, v3
    s_nop 1
    v_cndmask_b32 v100, 0, v2, vcc
    v_cndmask_b32 v102, 0, v2, vcc
    v_cmp_eq_u32 vcc, 1, v3
    s_nop 1
    v_cndmask_b32 v101, 0, v2, vcc
    v_cndmask_b32 v103, 0, v2, vcc
    v_cmp_eq_u32 vcc, 4, v3
    s_nop 1
    v_cndmask_b32 v104, 0, v2, vcc
    v_cndmask_b32 v106, 0, v2, vcc
    v_cmp_eq_u32 vcc, 5, v3
    s_nop 1
    v_cndmask_b32 v105, 0, v2, vcc
    v_cndmask_b32 v107, 0, v2, vcc
    s_add_u32 s80, s80, 0x4400000
    s_mov_b32 s81, 0x3e0293ee
    v_lshlrev_b32 v116, 2, v1
    v_bfe_u32 v118, v1, 0, 1
    v_lshlrev_b32 v118, 4, v118
    v_bfe_u32 v2, v1, 2, 2
    v_lshl_or_b32 v118, v2, 5, v118
    v_bfe_u32 v2, v1, 1, 1
    v_lshl_or_b32 v118, v2, 7, v118
    v_bfe_u32 v2, v1, 4, 2
    v_lshl_or_b32 v118, v2, 8, v118
    v_bfe_u32 v2, v1, 1, 1
    v_lshl_or_b32 v118, v2, 10, v118
    v_bfe_u32 v120, v1, 4, 2
    v_lshlrev_b32 v120, 3, v120
    s_add_u32 s75, s75, 0x1000000
    s_bfe_u32 s70, s67, 0x10000
    s_lshl_b32 s70, s70, 7
    s_bfe_u32 s71, s67, 0x20000
    s_lshl_b32 s71, s71, 10
    s_or_b32 s70, s70, s71
    v_xor_b32 v117, s70, v8
    s_cmp_eq_u32 s58, 4
    s_cselect_b32 s2, 0, 99
    s_mov_b32 s3, 0
    v_mov_b32 v40, 0
    v_mov_b32 v41, 0
    v_mov_b32 v42, 0
    v_mov_b32 v43, 0
    v_mov_b32 v44, 0
    v_mov_b32 v45, 0
    v_mov_b32 v46, 0
    v_mov_b32 v47, 0
    v_mov_b32 v48, 0
    v_mov_b32 v49, 0
    v_mov_b32 v50, 0
    v_mov_b32 v51, 0
    v_mov_b32 v52, 0
    v_mov_b32 v53, 0
    v_mov_b32 v54, 0
    v_mov_b32 v55, 0
    v_mov_b32 v56, 0
    v_mov_b32 v57, 0
    v_mov_b32 v58, 0
    v_mov_b32 v59, 0
    v_mov_b32 v60, 0
    v_mov_b32 v61, 0
    v_mov_b32 v62, 0
    v_mov_b32 v63, 0
    s_waitcnt vmcnt(8)
    s_barrier
    s_lshl_b32 s4, s66, 7
    s_add_u32 s4, s4, 0x5110000
    s_cmp_lg_u32 s58, 4
    s_cbranch_scc1 armi_28
    buffer_load_dwordx2 v[124:125], off, s[12:15], 0 offset:32 sc1
    buffer_load_dwordx2 v[122:123], off, s[8:11], s4 sc1
armi_28:
    s_waitcnt vmcnt(0)
    v_mov_b32 v4, 0x27ff0
    s_cmp_lg_u32 s58, 4
    s_cbranch_scc1 armw_29
    s_waitcnt vmcnt(0)
    v_and_b32 v5, 0x3ff, v124
    v_cmp_gt_u32 vcc, 128, v5
    s_cbranch_vccz armwait_ok_31
armwait_30:
    buffer_load_dwordx2 v[124:125], off, s[12:15], 0 offset:32 sc1
    buffer_load_dwordx2 v[122:123], off, s[8:11], s4 sc1
    s_waitcnt vmcnt(0)
    v_and_b32 v5, 0x3ff, v124
    v_cmp_gt_u32 vcc, 128, v5
    s_cbranch_vccz armwait_ok_31
    s_sub_u32 s69, s69, 1
    s_cbranch_scc0 armwait_30
    s_mov_b32 s69, 0
armwait_ok_31:
    ds_write_b64 v4, v[124:125]
    s_waitcnt lgkmcnt(0)
armw_29:
    s_barrier
    ds_read_b64 v[2:3], v4
    s_mov_b32 s59, 0
    s_waitcnt lgkmcnt(0)
    v_readfirstlane_b32 s70, v2
    v_readfirstlane_b32 s71, v3
    s_bfe_u32 s72, s70, 0xa000a
    s_cmp_gt_u32 s72, 128
    s_cselect_b32 s72, 1, 0
    s_or_b32 s59, s59, s72
    s_bfe_u32 s72, s70, 0xa0014
    s_cmp_gt_u32 s72, 128
    s_cselect_b32 s72, 2, 0
    s_or_b32 s59, s59, s72
    s_bfe_u32 s72, s71, 0xa000a
    s_cmp_gt_u32 s72, 128
    s_cselect_b32 s72, 4, 0
    s_or_b32 s59, s59, s72
    s_bfe_u32 s72, s71, 0xa0014
    s_cmp_gt_u32 s72, 128
    s_cselect_b32 s72, 8, 0
    s_or_b32 s59, s59, s72
    s_and_b32 s70, s59, 1
    s_lshl_b32 s70, s70, 13
    s_add_u32 s77, s77, s70
    s_add_u32 s76, s76, s70
    s_branch vo_loop_26
.p2align 6
vo_loop_26:
    s_barrier
    ds_read_b128 v[10:13], v8 offset:0
    ds_read_b128 v[14:17], v8 offset:1024
    ds_read_b128 v[18:21], v8 offset:2048
    ds_read_b128 v[22:25], v8 offset:3072
    s_cmp_ge_i32 s3, s2
    s_cbranch_scc1 kvg_32
kvj_34:
    s_add_u32 s3, s3, 1
    s_barrier
    s_cmp_le_u32 s68, 1
    s_cbranch_scc1 kv0_35
kv0j_36:
    s_waitcnt lgkmcnt(3)
    v_smfmac_f32_16x16x64_bf16 v[40:43], v[10:13], v[128:135], v7
    v_smfmac_f32_16x16x64_bf16 v[44:47], v[10:13], v[160:167], v7
    s_waitcnt lgkmcnt(2)
    v_smfmac_f32_16x16x64_bf16 v[40:43], v[14:17], v[136:143], v7
    v_smfmac_f32_16x16x64_bf16 v[44:47], v[14:17], v[168:175], v7
    s_waitcnt lgkmcnt(1)
    v_smfmac_f32_16x16x64_bf16 v[40:43], v[18:21], v[144:151], v7
    v_smfmac_f32_16x16x64_bf16 v[44:47], v[18:21], v[176:183], v7
    s_waitcnt lgkmcnt(0)
    v_smfmac_f32_16x16x64_bf16 v[40:43], v[22:25], v[152:159], v7
    v_smfmac_f32_16x16x64_bf16 v[44:47], v[22:25], v[184:191], v7
    s_nop 6
    v_pk_add_f32 v[40:41], v[40:41], v[42:43]
    v_cvt_pk_bf16_f32 v80, v40, v41
    v_pk_add_f32 v[44:45], v[44:45], v[46:47]
    v_cvt_pk_bf16_f32 v81, v44, v45
    s_nop 1
    v_permlane16_swap_b32 v80, v81
    v_bfi_b32 v80, 1, s82, v80
    buffer_store_dwordx2 v[80:81], v34, s[8:11], s73 offen
    s_and_b32 s70, s68, 1
    s_lshl_b32 s70, s70, 19
    s_add_u32 s71, s70, s79
    s_add_u32 s70, s70, s78
    s_cmp_eq_u32 s68, 63
    s_cbranch_scc1 vo_last_27
    s_cmp_eq_u32 s68, 0
    s_cbranch_scc1 wo0_37
wo0j_38:
    s_waitcnt vmcnt(1)
    s_cmp_ge_i32 s3, s2
    s_cbranch_scc1 kvg_39
kvj_41:
    s_barrier
    ds_read_b128 v[10:13], v8 offset:4096
    ds_read_b128 v[14:17], v8 offset:5120
    ds_read2st64_b32 v[30:31], v116 offset0:32 offset1:33
    ds_read_b128 v[18:21], v8 offset:6144
    ds_read_b128 v[22:25], v8 offset:7168
    ds_read2st64_b32 v[32:33], v116 offset0:34 offset1:35
    buffer_load_dwordx4 v[64:67], v8, s[8:11], s73 offen offset:0 sc1
    buffer_load_dwordx4 v[68:71], v8, s[8:11], s73 offen offset:1024 sc1
    s_waitcnt lgkmcnt(4)
    v_pk_add_f32 v[10:11], v[10:11], v[14:15]
    v_pk_add_f32 v[12:13], v[12:13], v[16:17]
    s_waitcnt lgkmcnt(2)
    v_pk_add_f32 v[10:11], v[10:11], v[18:19]
    v_pk_add_f32 v[12:13], v[12:13], v[20:21]
    s_waitcnt lgkmcnt(0)
    v_pk_add_f32 v[30:31], v[30:31], v[32:33]
    v_pk_add_f32 v[10:11], v[10:11], v[22:23]
    v_pk_add_f32 v[12:13], v[12:13], v[24:25]
    v_add_f32 v14, v30, v31
    v_max3_f32 v2, v10, v11, v12
    v_max3_f32 v3, v2, v13, v14
    v_max3_f32 v2, v2, v13, v14
    s_nop 1
    v_permlane32_swap_b32 v2, v3
    v_max_f32 v4, v2, v3
    v_max_f32 v3, v2, v3
    s_nop 1
    v_permlane16_swap_b32 v4, v3
    v_max_f32 v2, v4, v3
    v_mul_f32 v2, s81, v2
    s_nop 1
    v_max_f32_dpp v2, v2, v2 row_ror:8 row_mask:0xf bank_mask:0xf
    v_fma_f32 v10, v10, s81, -v2
    v_fma_f32 v11, v11, s81, -v2
    v_fma_f32 v12, v12, s81, -v2
    v_fma_f32 v13, v13, s81, -v2
    v_fma_f32 v14, v14, s81, -v2
    v_exp_f32 v10, v10
    v_exp_f32 v11, v11
    v_exp_f32 v12, v12
    v_exp_f32 v13, v13
    v_exp_f32 v15, v14
    v_cvt_pk_bf16_f32 v80, v10, v11
    v_cvt_pk_bf16_f32 v81, v12, v13
    v_mov_b32 v14, v15
    v_mov_b32_dpp v82, v80 row_ror:8 row_mask:0xf bank_mask:0xf
    v_mov_b32_dpp v83, v81 row_ror:8 row_mask:0xf bank_mask:0xf
    v_permlane32_swap_b32 v14, v15
    v_cvt_pk_bf16_f32 v84, v14, v15
    v_mfma_f32_16x16x32_bf16 v[108:111], v[72:75], v[80:83], 0
    v_mov_b32 v86, v84
    v_mov_b32_dpp v85, v84 row_ror:8 row_mask:0xf bank_mask:0xf
    v_mov_b32_dpp v87, v84 row_ror:8 row_mask:0xf bank_mask:0xf
    v_mfma_f32_16x16x32_bf16 v[112:115], v[76:79], v[80:83], 0
xv_w_43:
    s_waitcnt vmcnt(0)
    v_mfma_f32_16x16x32_bf16 v[18:21], v[64:67], v[84:87], v[108:111]
    v_bitop3_b32 v2, v64, v66, s82 bitop3:0x7e
    v_bitop3_b32 v3, v68, v70, s82 bitop3:0x7e
    v_mfma_f32_16x16x32_bf16 v[22:25], v[68:71], v[84:87], v[112:115]
    v_bitop3_b32 v2, v2, v3, 1 bitop3:0xa8
    v_cmp_ne_u32 vcc, 0, v2
    s_cbranch_vccnz xv_s_42
xv_j_44:
    v_mfma_f32_16x16x32_bf16 v[96:99], v[88:91], v[80:83], 0
    s_nop 0
    v_cvt_pk_bf16_f32 v108, v18, v19
    v_cvt_pk_bf16_f32 v109, v20, v21
    s_nop 0
    v_cvt_pk_bf16_f32 v110, v22, v23
    v_cvt_pk_bf16_f32 v111, v24, v25
    ds_write_b128 v117, v[108:111] offset:9216
    v_mfma_f32_16x16x32_bf16 v[96:99], v[92:95], v[84:87], v[96:99]
    s_nop 3
    s_waitcnt lgkmcnt(0)
    s_barrier
    ds_read_b128 v[10:13], v118 offset:9216
    ds_read_b128 v[14:17], v118 offset:11264
    v_rcp_f32 v98, v96
    s_nop 0
    ds_bpermute_b32 v96, v120, v98 offset:0
    ds_bpermute_b32 v97, v120, v98 offset:4
    s_waitcnt lgkmcnt(3)
    v_smfmac_f32_16x16x64_bf16 v[48:51], v[10:13], v[192:199], v7
    v_smfmac_f32_16x16x64_bf16 v[52:55], v[10:13], v[208:215], v7
    s_waitcnt lgkmcnt(2)
    v_smfmac_f32_16x16x64_bf16 v[48:51], v[14:17], v[200:207], v7
    s_nop 1
    v_smfmac_f32_16x16x64_bf16 v[52:55], v[14:17], v[216:223], v7
    s_nop 1
    v_smfmac_f32_16x16x64_bf16 v[56:59], v[10:13], v[224:231], v7
    s_waitcnt lgkmcnt(0)
    v_smfmac_f32_16x16x64_bf16 v[56:59], v[14:17], v[232:239], v7
    v_pk_add_f32 v[48:49], v[48:49], v[50:51]
    v_smfmac_f32_16x16x64_bf16 v[60:63], v[10:13], v[240:247], v7
    v_pk_mul_f32 v[48:49], v[48:49], v[96:97]
    v_cvt_pk_bf16_f32 v80, v48, v49
    v_smfmac_f32_16x16x64_bf16 v[60:63], v[14:17], v[248:255], v7
    v_pk_add_f32 v[52:53], v[52:53], v[54:55]
    v_pk_mul_f32 v[52:53], v[52:53], v[96:97]
    v_cvt_pk_bf16_f32 v81, v52, v53
    v_pk_add_f32 v[56:57], v[56:57], v[58:59]
    v_pk_mul_f32 v[56:57], v[56:57], v[96:97]
    v_cvt_pk_bf16_f32 v82, v56, v57
    v_permlane16_swap_b32 v80, v81
    v_bfi_b32 v80, 1, s82, v80
    v_pk_add_f32 v[60:61], v[60:61], v[62:63]
    v_pk_mul_f32 v[60:61], v[60:61], v[96:97]
    v_cvt_pk_bf16_f32 v83, v60, v61
    s_nop 1
    v_permlane16_swap_b32 v82, v83
    buffer_store_dwordx4 v[80:83], v36, s[8:11], s71 offen
    s_waitcnt vmcnt(0)
    buffer_load_dwordx4 v[10:13], v8, s[8:11], s70 offen sc1
b_w_46:
    s_waitcnt vmcnt(0)
    v_mfma_f32_16x16x32_bf16 v[30:33], v[26:29], v[10:13], 0
    v_bitop3_b32 v2, v10, s82, 1 bitop3:0x28
    v_cmp_ne_u32 vcc, 0, v2
    s_cbranch_vccnz b_s_45
b_j_47:
    s_nop 4
    v_add_f32_dpp v30, v30, v30 row_ror:8 row_mask:0xf bank_mask:0xf
    v_add_f32_dpp v31, v31, v31 row_ror:8 row_mask:0xf bank_mask:0xf
    v_add_f32_dpp v32, v32, v32 row_ror:8 row_mask:0xf bank_mask:0xf
    v_add_f32_dpp v33, v33, v33 row_ror:8 row_mask:0xf bank_mask:0xf
    v_cvt_pk_bf16_f32 v30, v30, v31
    v_cvt_pk_bf16_f32 v31, v32, v33
    v_min_u32 v30, -2, v30
    s_nop 0
    v_permlane16_swap_b32 v31, v33
    v_permlane16_swap_b32 v30, v32
    buffer_store_dwordx4 v[30:33], v35, s[8:11], s77 offen sc1
    s_add_u32 s68, s68, 1
    s_bfe_u32 s82, s68, 0x10001
    s_xor_b32 s73, s73, 0x40000
    s_add_u32 s77, s77, 0x20000
    s_lshr_b32 s60, s77, 21
    s_bitcmp1_b32 s59, s60
    s_cselect_b32 s60, 0x2000, 0
    s_bitset0_b32 s77, 13
    s_or_b32 s77, s77, s60
    v_mov_b32 v40, 0
    v_mov_b32 v41, 0
    v_mov_b32 v42, 0
    v_mov_b32 v43, 0
    v_mov_b32 v44, 0
    v_mov_b32 v45, 0
    v_mov_b32 v46, 0
    v_mov_b32 v47, 0
    v_mov_b32 v48, 0
    v_mov_b32 v49, 0
    v_mov_b32 v50, 0
    v_mov_b32 v51, 0
    v_mov_b32 v52, 0
    v_mov_b32 v53, 0
    v_mov_b32 v54, 0
    v_mov_b32 v55, 0
    v_mov_b32 v56, 0
    v_mov_b32 v57, 0
    v_mov_b32 v58, 0
    v_mov_b32 v59, 0
    v_mov_b32 v60, 0
    v_mov_b32 v61, 0
    v_mov_b32 v62, 0
    v_mov_b32 v63, 0
    buffer_load_dwordx4 v[72:75], v38, s[8:11], s75 offen offset:0
    buffer_load_dwordx4 v[76:79], v38, s[8:11], s75 offen offset:128
    s_add_u32 s75, s75, 0x40000
    s_waitcnt vmcnt(2)
cack_48:
    s_barrier
    s_and_b32 s72, s68, 3
    s_cmp_lg_u32 s72, s64
    s_cbranch_scc1 novm_49
    v_mfma_f32_16x16x32_bf16 v[108:111], v[100:103], v[64:67], 0
    v_mfma_f32_16x16x32_bf16 v[108:111], v[104:107], v[68:71], v[108:111]
    s_nop 7
    v_cvt_pk_bf16_f32 v108, v108, v109
    v_cvt_pk_bf16_f32 v109, v110, v111
    v_min_u32 v108, -2, v108
    buffer_store_dwordx2 v[108:109], v119, s[8:11], s80 offen sc1
novm_49:
    s_add_u32 s80, s80, 0x10000
    s_add_u32 s72, s3, 1
    s_cmp_lt_i32 s72, s2
    s_cbranch_scc1 vo_loop_26
    buffer_load_dwordx2 v[122:123], off, s[8:11], s4 sc1
    s_branch vo_loop_26
kvp_33:
    buffer_load_dwordx2 v[122:123], off, s[8:11], s4 sc1
    s_waitcnt vmcnt(0)
kvg_32:
    v_min_i32 v122, v122, v123
    s_nop 0
    v_readfirstlane_b32 s2, v122
    s_nop 0
    s_cmp_lt_i32 s3, s2
    s_cbranch_scc1 kvj_34
    s_sub_u32 s69, s69, 1
    s_cbranch_scc0 kvp_33
    s_mov_b32 s69, 0
    s_branch kvj_34
kv0_35:
    s_bitset0_b32 s75, 30
    buffer_load_dwordx4 v[72:75], v38, s[8:11], s75 offen offset:0
    buffer_load_dwordx4 v[76:79], v38, s[8:11], s75 offen offset:128
    s_add_u32 s75, s75, 0x40000
    s_cmp_lt_u32 s68, 1
    s_cbranch_scc0 kv0j_36
    s_add_u32 s75, s75, 0x3ffc0000
    s_branch kv0j_36
wo0_37:
    v_xor_b32 v2, 0, v127
    v_xor_b32 v3, 64, v127
    ds_read_b64_tr_b16 v[192:193], v2 offset:0
    ds_read_b64_tr_b16 v[194:195], v3 offset:1024
    ds_read_b64_tr_b16 v[196:197], v2 offset:8192
    ds_read_b64_tr_b16 v[198:199], v3 offset:9216
    ds_read_b64_tr_b16 v[200:201], v2 offset:32768
    ds_read_b64_tr_b16 v[202:203], v3 offset:33792
    ds_read_b64_tr_b16 v[204:205], v2 offset:40960
    ds_read_b64_tr_b16 v[206:207], v3 offset:41984
    ds_read_b64_tr_b16 v[224:225], v2 offset:256
    ds_read_b64_tr_b16 v[226:227], v3 offset:1280
    ds_read_b64_tr_b16 v[228:229], v2 offset:8448
    ds_read_b64_tr_b16 v[230:231], v3 offset:9472
    ds_read_b64_tr_b16 v[232:233], v2 offset:33024
    ds_read_b64_tr_b16 v[234:235], v3 offset:34048
    ds_read_b64_tr_b16 v[236:237], v2 offset:41216
    ds_read_b64_tr_b16 v[238:239], v3 offset:42240
    s_waitcnt lgkmcnt(0)
    v_xor_b32 v2, 32, v127
    v_xor_b32 v3, 96, v127
    ds_read_b64_tr_b16 v[208:209], v2 offset:0
    ds_read_b64_tr_b16 v[210:211], v3 offset:1024
    ds_read_b64_tr_b16 v[212:213], v2 offset:8192
    ds_read_b64_tr_b16 v[214:215], v3 offset:9216
    ds_read_b64_tr_b16 v[216:217], v2 offset:32768
    ds_read_b64_tr_b16 v[218:219], v3 offset:33792
    ds_read_b64_tr_b16 v[220:221], v2 offset:40960
    ds_read_b64_tr_b16 v[222:223], v3 offset:41984
    ds_read_b64_tr_b16 v[240:241], v2 offset:256
    ds_read_b64_tr_b16 v[242:243], v3 offset:1280
    ds_read_b64_tr_b16 v[244:245], v2 offset:8448
    ds_read_b64_tr_b16 v[246:247], v3 offset:9472
    ds_read_b64_tr_b16 v[248:249], v2 offset:33024
    ds_read_b64_tr_b16 v[250:251], v3 offset:34048
    ds_read_b64_tr_b16 v[252:253], v2 offset:41216
    ds_read_b64_tr_b16 v[254:255], v3 offset:42240
    s_waitcnt lgkmcnt(0)
    s_branch wo0j_38
kvp_40:
    buffer_load_dwordx2 v[122:123], off, s[8:11], s4 sc1
    s_waitcnt vmcnt(0)
kvg_39:
    s_cmp_lt_u32 s68, 1
    s_cbranch_scc1 kvj_41
    v_min_i32 v122, v122, v123
    s_nop 0
    v_readfirstlane_b32 s2, v122
    s_nop 0
    s_cmp_lt_i32 s3, s2
    s_cbranch_scc1 kvj_41
    s_sub_u32 s69, s69, 1
    s_cbranch_scc0 kvp_40
    s_mov_b32 s69, 0
    s_branch kvj_41
xv_s_42:
    buffer_load_dwordx4 v[64:67], v8, s[8:11], s73 offen offset:0 sc1
    buffer_load_dwordx4 v[68:71], v8, s[8:11], s73 offen offset:1024 sc1
    s_sub_u32 s69, s69, 1
    s_cbranch_scc0 xv_w_43
    s_mov_b32 s69, 0
    s_branch xv_j_44
b_s_45:
    buffer_load_dwordx4 v[10:13], v8, s[8:11], s70 offen sc1
    s_sub_u32 s69, s69, 1
    s_cbranch_scc0 b_w_46
    s_mov_b32 s69, 0
    s_branch b_j_47
vo_last_27:
    s_cmp_lg_u32 s64, 0
    s_cbranch_scc1 chain_end_11
pollvm_50:
    buffer_load_dwordx4 v[64:67], v8, s[8:11], s73 offen offset:0 sc1
    buffer_load_dwordx4 v[68:71], v8, s[8:11], s73 offen offset:1024 sc1
    s_waitcnt vmcnt(0)
    v_bitop3_b32 v2, v64, v66, s82 bitop3:0x7e
    v_bitop3_b32 v3, v68, v70, s82 bitop3:0x7e
    v_bitop3_b32 v2, v2, v3, 1 bitop3:0xa8
    v_cmp_ne_u32 vcc, 0, v2
    s_cbranch_vccz pollvm_ok_51
    s_sub_u32 s69, s69, 1
    s_cbranch_scc0 pollvm_50
    s_mov_b32 s69, 0
pollvm_ok_51:
    v_mfma_f32_16x16x32_bf16 v[108:111], v[100:103], v[64:67], 0
    v_mfma_f32_16x16x32_bf16 v[108:111], v[104:107], v[68:71], v[108:111]
    s_nop 7
    v_cvt_pk_bf16_f32 v108, v108, v109
    v_cvt_pk_bf16_f32 v109, v110, v111
    v_min_u32 v108, -2, v108
    buffer_store_dwordx2 v[108:109], v119, s[8:11], s80 offen sc1
chain_end_11:
    s_waitcnt vmcnt(0)
    s_endpgm
bulk_2:
    s_and_b32 s75, s56, 3
    s_lshl_b32 s76, s75, 5
    s_add_u32 s76, s76, s57
    s_mov_b32 s77, 0x40000
    s_mov_b32 s84, 1
    s_cmp_ge_u32 s57, 24
    s_cbranch_scc1 fft_55
    s_mov_b32 s83, 160
    s_mov_b32 s6, 0x4444557e
    s_mov_b32 s7, 0x44444444
    s_mov_b64 s[60:61], s[36:37]
    s_mov_b32 s62, 0x400000
    s_mov_b32 s63, 0x20000
    s_bitcmp1_b32 s57, 3
    s_cbranch_scc1 sv_56
    s_mov_b64 s[64:65], s[24:25]
    s_mov_b32 s66, 0x800000
    s_mov_b32 s67, 0x20000
    s_mov_b32 s81, 0x1000000
    s_cmp_lt_u32 s57, 8
    s_cbranch_scc1 sf_57
    s_mov_b64 s[64:65], s[20:21]
    s_mov_b32 s66, 0x800000
    s_mov_b32 s67, 0x20000
    s_mov_b32 s81, 0x0
    s_mov_b32 s84, 0x10000
    v_bfe_u32 v120, v1, 0, 1
    v_lshlrev_b32 v120, 7, v120
    v_bfe_u32 v121, v1, 1, 5
    v_lshl_or_b32 v120, v121, 13, v120
    s_bfe_u32 s79, s58, 0x20000
    s_lshl_b32 s79, s79, 19
    s_bfe_u32 s85, s58, 0x10002
    s_lshl_b32 s85, s85, 22
    s_or_b32 s79, s79, s85
    s_bfe_u32 s80, s76, 0x30000
    s_lshl_b32 s80, s80, 8
    s_bfe_u32 s85, s76, 0x20005
    s_lshl_b32 s85, s85, 11
    s_or_b32 s80, s80, s85
    s_bfe_u32 s85, s76, 0x10000
    s_lshl_b32 s85, s85, 21
    s_or_b32 s80, s80, s85
    s_add_u32 s79, s79, s80
    s_xor_b32 s85, s79, 0x200000
    buffer_load_dword v122, v120, s[24:27], s85 offen
    s_xor_b32 s85, s79, 0x200000
    buffer_load_dword v123, v120, s[28:31], s85 offen
    s_add_u32 s79, s76, 8
    s_lshl_b32 s85, s79, 3
    s_add_u32 s85, s85, s58
    v_lshlrev_b32 v4, 2, v1
    v_mul_u32_u24 v4, s85, v4
    v_mov_b32 v8, 253
    v_and_b32 v5, 0x3ff, v4
    v_cvt_f32_u32 v5, v5
    v_mul_f32 v5, 0x3a800000, v5
    v_cos_f32 v6, v5
    v_sin_f32 v7, -v5
    v_add_u32 v4, s85, v4
    v_cvt_pk_bf16_f32 v10, v6, v7
    v_and_b32 v5, 0x3ff, v4
    v_cvt_f32_u32 v5, v5
    v_mul_f32 v5, 0x3a800000, v5
    v_cos_f32 v6, v5
    v_sin_f32 v7, -v5
    v_add_u32 v4, s85, v4
    v_cvt_pk_bf16_f32 v11, v6, v7
    v_and_b32 v5, 0x3ff, v4
    v_cvt_f32_u32 v5, v5
    v_mul_f32 v5, 0x3a800000, v5
    v_cos_f32 v6, v5
    v_sin_f32 v7, -v5
    v_add_u32 v4, s85, v4
    v_cvt_pk_bf16_f32 v12, v6, v7
    v_and_b32 v5, 0x3ff, v4
    v_cvt_f32_u32 v5, v5
    v_mul_f32 v5, 0x3a800000, v5
    v_cos_f32 v6, v5
    v_sin_f32 v7, -v5
    v_mad_u32_u24 v4, s85, v8, v4
    v_cvt_pk_bf16_f32 v13, v6, v7
    v_and_b32 v5, 0x3ff, v4
    v_cvt_f32_u32 v5, v5
    v_mul_f32 v5, 0x3a800000, v5
    v_cos_f32 v6, v5
    v_sin_f32 v7, -v5
    v_add_u32 v4, s85, v4
    v_cvt_pk_bf16_f32 v14, v6, v7
    v_and_b32 v5, 0x3ff, v4
    v_cvt_f32_u32 v5, v5
    v_mul_f32 v5, 0x3a800000, v5
    v_cos_f32 v6, v5
    v_sin_f32 v7, -v5
    v_add_u32 v4, s85, v4
    v_cvt_pk_bf16_f32 v15, v6, v7
    v_and_b32 v5, 0x3ff, v4
    v_cvt_f32_u32 v5, v5
    v_mul_f32 v5, 0x3a800000, v5
    v_cos_f32 v6, v5
    v_sin_f32 v7, -v5
    v_add_u32 v4, s85, v4
    v_cvt_pk_bf16_f32 v16, v6, v7
    v_and_b32 v5, 0x3ff, v4
    v_cvt_f32_u32 v5, v5
    v_mul_f32 v5, 0x3a800000, v5
    v_cos_f32 v6, v5
    v_sin_f32 v7, -v5
    v_add_u32 v4, s85, v4
    v_cvt_pk_bf16_f32 v17, v6, v7
    v_mov_b32 v5, s85
    v_lshlrev_b32 v5, 31, v5
    v_or_b32 v5, 0x3f803f80, v5
    v_cmp_eq_u32 vcc, 0, v1
    s_nop 1
    v_cndmask_b32 v10, v10, v5, vcc
    v_lshlrev_b32 v8, 4, v1
    s_lshl_b32 s85, s85, 11
    s_add_u32 s85, s85, 0x5200000
    buffer_store_dwordx4 v[10:13], v8, s[8:11], s85 offen sc1
    buffer_store_dwordx4 v[14:17], v8, s[8:11], s85 offen offset:1024 sc1
    s_sub_u32 s79, s79, 8
    s_lshl_b32 s85, s79, 3
    s_add_u32 s85, s85, s58
    v_lshlrev_b32 v20, 2, v1
    v_mul_u32_u24 v20, s85, v20
    v_mov_b32 v24, 253
    v_and_b32 v21, 0x3ff, v20
    v_cvt_f32_u32 v21, v21
    v_mul_f32 v21, 0x3a800000, v21
    v_cos_f32 v22, v21
    v_sin_f32 v23, -v21
    v_add_u32 v20, s85, v20
    v_cvt_pk_bf16_f32 v26, v22, v23
    v_and_b32 v21, 0x3ff, v20
    v_cvt_f32_u32 v21, v21
    v_mul_f32 v21, 0x3a800000, v21
    v_cos_f32 v22, v21
    v_sin_f32 v23, -v21
    v_add_u32 v20, s85, v20
    v_cvt_pk_bf16_f32 v27, v22, v23
    v_and_b32 v21, 0x3ff, v20
    v_cvt_f32_u32 v21, v21
    v_mul_f32 v21, 0x3a800000, v21
    v_cos_f32 v22, v21
    v_sin_f32 v23, -v21
    v_add_u32 v20, s85, v20
    v_cvt_pk_bf16_f32 v28, v22, v23
    v_and_b32 v21, 0x3ff, v20
    v_cvt_f32_u32 v21, v21
    v_mul_f32 v21, 0x3a800000, v21
    v_cos_f32 v22, v21
    v_sin_f32 v23, -v21
    v_mad_u32_u24 v20, s85, v24, v20
    v_cvt_pk_bf16_f32 v29, v22, v23
    v_and_b32 v21, 0x3ff, v20
    v_cvt_f32_u32 v21, v21
    v_mul_f32 v21, 0x3a800000, v21
    v_cos_f32 v22, v21
    v_sin_f32 v23, -v21
    v_add_u32 v20, s85, v20
    v_cvt_pk_bf16_f32 v30, v22, v23
    v_and_b32 v21, 0x3ff, v20
    v_cvt_f32_u32 v21, v21
    v_mul_f32 v21, 0x3a800000, v21
    v_cos_f32 v22, v21
    v_sin_f32 v23, -v21
    v_add_u32 v20, s85, v20
    v_cvt_pk_bf16_f32 v31, v22, v23
    v_and_b32 v21, 0x3ff, v20
    v_cvt_f32_u32 v21, v21
    v_mul_f32 v21, 0x3a800000, v21
    v_cos_f32 v22, v21
    v_sin_f32 v23, -v21
    v_add_u32 v20, s85, v20
    v_cvt_pk_bf16_f32 v32, v22, v23
    v_and_b32 v21, 0x3ff, v20
    v_cvt_f32_u32 v21, v21
    v_mul_f32 v21, 0x3a800000, v21
    v_cos_f32 v22, v21
    v_sin_f32 v23, -v21
    v_add_u32 v20, s85, v20
    v_cvt_pk_bf16_f32 v33, v22, v23
    v_mov_b32 v21, s85
    v_lshlrev_b32 v21, 31, v21
    v_or_b32 v21, 0x3f803f80, v21
    v_cmp_eq_u32 vcc, 0, v1
    s_nop 1
    v_cndmask_b32 v26, v26, v21, vcc
    v_lshlrev_b32 v24, 4, v1
    s_lshl_b32 s85, s85, 11
    s_add_u32 s85, s85, 0x5200000
    buffer_store_dwordx4 v[26:29], v24, s[8:11], s85 offen sc1
    buffer_store_dwordx4 v[30:33], v24, s[8:11], s85 offen offset:1024 sc1
    s_sub_u32 s79, s79, 8
    s_lshl_b32 s85, s79, 3
    s_add_u32 s85, s85, s58
    v_lshlrev_b32 v36, 2, v1
    v_mul_u32_u24 v36, s85, v36
    v_mov_b32 v40, 253
    v_and_b32 v37, 0x3ff, v36
    v_cvt_f32_u32 v37, v37
    v_mul_f32 v37, 0x3a800000, v37
    v_cos_f32 v38, v37
    v_sin_f32 v39, -v37
    v_add_u32 v36, s85, v36
    v_cvt_pk_bf16_f32 v42, v38, v39
    v_and_b32 v37, 0x3ff, v36
    v_cvt_f32_u32 v37, v37
    v_mul_f32 v37, 0x3a800000, v37
    v_cos_f32 v38, v37
    v_sin_f32 v39, -v37
    v_add_u32 v36, s85, v36
    v_cvt_pk_bf16_f32 v43, v38, v39
    v_and_b32 v37, 0x3ff, v36
    v_cvt_f32_u32 v37, v37
    v_mul_f32 v37, 0x3a800000, v37
    v_cos_f32 v38, v37
    v_sin_f32 v39, -v37
    v_add_u32 v36, s85, v36
    v_cvt_pk_bf16_f32 v44, v38, v39
    v_and_b32 v37, 0x3ff, v36
    v_cvt_f32_u32 v37, v37
    v_mul_f32 v37, 0x3a800000, v37
    v_cos_f32 v38, v37
    v_sin_f32 v39, -v37
    v_mad_u32_u24 v36, s85, v40, v36
    v_cvt_pk_bf16_f32 v45, v38, v39
    v_and_b32 v37, 0x3ff, v36
    v_cvt_f32_u32 v37, v37
    v_mul_f32 v37, 0x3a800000, v37
    v_cos_f32 v38, v37
    v_sin_f32 v39, -v37
    v_add_u32 v36, s85, v36
    v_cvt_pk_bf16_f32 v46, v38, v39
    v_and_b32 v37, 0x3ff, v36
    v_cvt_f32_u32 v37, v37
    v_mul_f32 v37, 0x3a800000, v37
    v_cos_f32 v38, v37
    v_sin_f32 v39, -v37
    v_add_u32 v36, s85, v36
    v_cvt_pk_bf16_f32 v47, v38, v39
    v_and_b32 v37, 0x3ff, v36
    v_cvt_f32_u32 v37, v37
    v_mul_f32 v37, 0x3a800000, v37
    v_cos_f32 v38, v37
    v_sin_f32 v39, -v37
    v_add_u32 v36, s85, v36
    v_cvt_pk_bf16_f32 v48, v38, v39
    v_and_b32 v37, 0x3ff, v36
    v_cvt_f32_u32 v37, v37
    v_mul_f32 v37, 0x3a800000, v37
    v_cos_f32 v38, v37
    v_sin_f32 v39, -v37
    v_add_u32 v36, s85, v36
    v_cvt_pk_bf16_f32 v49, v38, v39
    v_mov_b32 v37, s85
    v_lshlrev_b32 v37, 31, v37
    v_or_b32 v37, 0x3f803f80, v37
    v_cmp_eq_u32 vcc, 0, v1
    s_nop 1
    v_cndmask_b32 v42, v42, v37, vcc
    v_lshlrev_b32 v40, 4, v1
    s_lshl_b32 s85, s85, 11
    s_add_u32 s85, s85, 0x5200000
    buffer_store_dwordx4 v[42:45], v40, s[8:11], s85 offen sc1
    buffer_store_dwordx4 v[46:49], v40, s[8:11], s85 offen offset:1024 sc1
    s_sub_u32 s79, s79, 8
    s_lshl_b32 s85, s79, 3
    s_add_u32 s85, s85, s58
    v_lshlrev_b32 v52, 2, v1
    v_mul_u32_u24 v52, s85, v52
    v_mov_b32 v56, 253
    v_and_b32 v53, 0x3ff, v52
    v_cvt_f32_u32 v53, v53
    v_mul_f32 v53, 0x3a800000, v53
    v_cos_f32 v54, v53
    v_sin_f32 v55, -v53
    v_add_u32 v52, s85, v52
    v_cvt_pk_bf16_f32 v58, v54, v55
    v_and_b32 v53, 0x3ff, v52
    v_cvt_f32_u32 v53, v53
    v_mul_f32 v53, 0x3a800000, v53
    v_cos_f32 v54, v53
    v_sin_f32 v55, -v53
    v_add_u32 v52, s85, v52
    v_cvt_pk_bf16_f32 v59, v54, v55
    v_and_b32 v53, 0x3ff, v52
    v_cvt_f32_u32 v53, v53
    v_mul_f32 v53, 0x3a800000, v53
    v_cos_f32 v54, v53
    v_sin_f32 v55, -v53
    v_add_u32 v52, s85, v52
    v_cvt_pk_bf16_f32 v60, v54, v55
    v_and_b32 v53, 0x3ff, v52
    v_cvt_f32_u32 v53, v53
    v_mul_f32 v53, 0x3a800000, v53
    v_cos_f32 v54, v53
    v_sin_f32 v55, -v53
    v_mad_u32_u24 v52, s85, v56, v52
    v_cvt_pk_bf16_f32 v61, v54, v55
    v_and_b32 v53, 0x3ff, v52
    v_cvt_f32_u32 v53, v53
    v_mul_f32 v53, 0x3a800000, v53
    v_cos_f32 v54, v53
    v_sin_f32 v55, -v53
    v_add_u32 v52, s85, v52
    v_cvt_pk_bf16_f32 v62, v54, v55
    v_and_b32 v53, 0x3ff, v52
    v_cvt_f32_u32 v53, v53
    v_mul_f32 v53, 0x3a800000, v53
    v_cos_f32 v54, v53
    v_sin_f32 v55, -v53
    v_add_u32 v52, s85, v52
    v_cvt_pk_bf16_f32 v63, v54, v55
    v_and_b32 v53, 0x3ff, v52
    v_cvt_f32_u32 v53, v53
    v_mul_f32 v53, 0x3a800000, v53
    v_cos_f32 v54, v53
    v_sin_f32 v55, -v53
    v_add_u32 v52, s85, v52
    v_cvt_pk_bf16_f32 v64, v54, v55
    v_and_b32 v53, 0x3ff, v52
    v_cvt_f32_u32 v53, v53
    v_mul_f32 v53, 0x3a800000, v53
    v_cos_f32 v54, v53
    v_sin_f32 v55, -v53
    v_add_u32 v52, s85, v52
    v_cvt_pk_bf16_f32 v65, v54, v55
    v_mov_b32 v53, s85
    v_lshlrev_b32 v53, 31, v53
    v_or_b32 v53, 0x3f803f80, v53
    v_cmp_eq_u32 vcc, 0, v1
    s_nop 1
    v_cndmask_b32 v58, v58, v53, vcc
    v_lshlrev_b32 v56, 4, v1
    s_lshl_b32 s85, s85, 11
    s_add_u32 s85, s85, 0x5200000
    buffer_store_dwordx4 v[58:61], v56, s[8:11], s85 offen sc1
    buffer_store_dwordx4 v[62:65], v56, s[8:11], s85 offen offset:1024 sc1
    s_sub_u32 s79, s79, 8
    s_waitcnt vmcnt(0)
sf_57:
    v_bfe_u32 v4, v1, 4, 2
    v_lshlrev_b32 v4, 2, v4
    v_xor_b32 v4, v4, v1
    v_bfe_u32 v84, v4, 0, 1
    v_lshlrev_b32 v84, 5, v84
    v_bfe_u32 v5, v4, 1, 1
    v_lshl_or_b32 v84, v5, 4, v84
    v_bfe_u32 v5, v4, 2, 2
    v_lshl_or_b32 v84, v5, 6, v84
    v_bfe_u32 v5, v4, 4, 2
    v_lshl_or_b32 v84, v5, 13, v84
    v_xor_b32 v85, 16, v84
    s_bfe_u32 s68, s58, 0x20000
    s_lshl_b32 s68, s68, 19
    s_bfe_u32 s71, s58, 0x10002
    s_lshl_b32 s71, s71, 22
    s_or_b32 s68, s68, s71
    s_bfe_u32 s71, s57, 0x30000
    s_lshl_b32 s71, s71, 8
    s_bfe_u32 s72, s57, 0x10000
    s_lshl_b32 s72, s72, 21
    s_or_b32 s71, s71, s72
    s_add_u32 s68, s68, s71
    s_lshl_b32 s71, s75, 11
    s_add_u32 s68, s68, s71
    s_xor_b32 s69, s68, 0x200000
    s_lshl_b32 s70, s58, 14
    s_add_u32 m0, s70, 0
    s_nop 0
    buffer_load_dwordx4 v84, s[64:67], s68 offen lds
    s_add_u32 s68, s68, 0x8000
    s_add_u32 m0, s70, 1024
    s_nop 0
    buffer_load_dwordx4 v84, s[64:67], s68 offen lds
    s_add_u32 s68, s68, 0x8000
    s_add_u32 m0, s70, 2048
    s_nop 0
    buffer_load_dwordx4 v85, s[64:67], s68 offen lds
    s_add_u32 s68, s68, 0x8000
    s_add_u32 m0, s70, 3072
    s_nop 0
    buffer_load_dwordx4 v85, s[64:67], s68 offen lds
    s_add_u32 s68, s68, 0x8000
    s_add_u32 m0, s70, 4096
    s_nop 0
    buffer_load_dwordx4 v84, s[64:67], s68 offen lds
    s_add_u32 s68, s68, 0x8000
    s_add_u32 m0, s70, 5120
    s_nop 0
    buffer_load_dwordx4 v84, s[64:67], s68 offen lds
    s_add_u32 s68, s68, 0x8000
    s_add_u32 m0, s70, 6144
    s_nop 0
    buffer_load_dwordx4 v85, s[64:67], s68 offen lds
    s_add_u32 s68, s68, 0x8000
    s_add_u32 m0, s70, 7168
    s_nop 0
    buffer_load_dwordx4 v85, s[64:67], s68 offen lds
    s_add_u32 s68, s68, 0x8000
    s_add_u32 m0, s70, 8192
    s_nop 0
    buffer_load_dwordx4 v84, s[64:67], s68 offen lds
    s_add_u32 s68, s68, 0x8000
    s_add_u32 m0, s70, 9216
    s_nop 0
    buffer_load_dwordx4 v84, s[64:67], s68 offen lds
    s_add_u32 s68, s68, 0x8000
    s_add_u32 m0, s70, 10240
    s_nop 0
    buffer_load_dwordx4 v85, s[64:67], s68 offen lds
    s_add_u32 s68, s68, 0x8000
    s_add_u32 m0, s70, 11264
    s_nop 0
    buffer_load_dwordx4 v85, s[64:67], s68 offen lds
    s_add_u32 s68, s68, 0x8000
    s_add_u32 m0, s70, 12288
    s_nop 0
    buffer_load_dwordx4 v84, s[64:67], s68 offen lds
    s_add_u32 s68, s68, 0x8000
    s_add_u32 m0, s70, 13312
    s_nop 0
    buffer_load_dwordx4 v84, s[64:67], s68 offen lds
    s_add_u32 s68, s68, 0x8000
    s_add_u32 m0, s70, 14336
    s_nop 0
    buffer_load_dwordx4 v85, s[64:67], s68 offen lds
    s_add_u32 s68, s68, 0x8000
    s_add_u32 m0, s70, 15360
    s_nop 0
    buffer_load_dwordx4 v85, s[64:67], s68 offen lds
    s_add_u32 s68, s68, 0x8000
    s_cmp_lt_u32 s57, 16
    s_cbranch_scc1 sq_67
    s_waitcnt vmcnt(0)
sq_67:
    buffer_load_dwordx4 v[192:195], v84, s[64:67], s69 offen
    s_add_u32 s69, s69, 0x8000
    buffer_load_dwordx4 v[196:199], v84, s[64:67], s69 offen
    s_add_u32 s69, s69, 0x8000
    buffer_load_dwordx4 v[200:203], v85, s[64:67], s69 offen
    s_add_u32 s69, s69, 0x8000
    buffer_load_dwordx4 v[204:207], v85, s[64:67], s69 offen
    s_add_u32 s69, s69, 0x8000
    buffer_load_dwordx4 v[208:211], v84, s[64:67], s69 offen
    s_add_u32 s69, s69, 0x8000
    buffer_load_dwordx4 v[212:215], v84, s[64:67], s69 offen
    s_add_u32 s69, s69, 0x8000
    buffer_load_dwordx4 v[216:219], v85, s[64:67], s69 offen
    s_add_u32 s69, s69, 0x8000
    buffer_load_dwordx4 v[220:223], v85, s[64:67], s69 offen
    s_add_u32 s69, s69, 0x8000
    buffer_load_dwordx4 v[224:227], v84, s[64:67], s69 offen
    s_add_u32 s69, s69, 0x8000
    buffer_load_dwordx4 v[228:231], v84, s[64:67], s69 offen
    s_add_u32 s69, s69, 0x8000
    buffer_load_dwordx4 v[232:235], v85, s[64:67], s69 offen
    s_add_u32 s69, s69, 0x8000
    buffer_load_dwordx4 v[236:239], v85, s[64:67], s69 offen
    s_add_u32 s69, s69, 0x8000
    buffer_load_dwordx4 v[240:243], v84, s[64:67], s69 offen
    s_add_u32 s69, s69, 0x8000
    buffer_load_dwordx4 v[244:247], v84, s[64:67], s69 offen
    s_add_u32 s69, s69, 0x8000
    buffer_load_dwordx4 v[248:251], v85, s[64:67], s69 offen
    s_add_u32 s69, s69, 0x8000
    buffer_load_dwordx4 v[252:255], v85, s[64:67], s69 offen
    s_add_u32 s69, s69, 0x8000
    s_lshl_b32 s71, s57, 3
    s_add_u32 s71, s71, s58
    s_lshl_b32 s71, s71, 13
    s_cmp_lt_u32 s57, 3
    s_cselect_b32 s71, s71, 0x5ffffff0
    v_lshlrev_b32 v4, 7, v1
    buffer_load_dword v99, v4, s[36:39], s71 offen
    v_bfe_u32 v88, v1, 0, 2
    v_lshlrev_b32 v88, 3, v88
    v_bfe_u32 v5, v1, 4, 1
    v_lshl_or_b32 v88, v5, 5, v88
    v_bfe_u32 v5, v1, 2, 2
    v_lshl_or_b32 v88, v5, 6, v88
    v_bfe_u32 v5, v1, 2, 2
    v_lshl_or_b32 v88, v5, 8, v88
    v_bfe_u32 v5, v1, 4, 2
    v_lshl_or_b32 v88, v5, 11, v88
    s_bfe_u32 s71, s58, 0x20000
    s_lshl_b32 s71, s71, 6
    s_bfe_u32 s72, s58, 0x10002
    s_lshl_b32 s72, s72, 16
    s_or_b32 s71, s71, s72
    v_xor_b32 v88, s71, v88
    v_xor_b32 v89, 32, v88
    v_lshl_add_u32 v96, v1, 4, s70
    s_lshl_b32 s71, s75, 16
    s_add_u32 s81, s81, s71
    s_bfe_u32 s68, s57, 0x10000
    s_lshl_b32 s68, s68, 9
    s_lshl_b32 s71, s58, 2
    v_bfe_u32 v4, v1, 5, 1
    v_lshlrev_b32 v4, 4, v4
    v_xor_b32 v4, s71, v4
    v_lshlrev_b32 v4, 11, v4
    s_and_b32 s71, s71, 12
    v_xor_b32 v5, s71, v1
    v_bfe_u32 v84, v5, 0, 5
    v_lshlrev_b32 v84, 4, v84
    v_bfe_u32 v6, v5, 5, 1
    v_lshl_or_b32 v84, v6, 10, v84
    s_mov_b32 s72, 1024
    v_add_u32 v84, v84, v4
    v_xor_b32 v85, 16, v84
    v_add_u32 v85, s72, v85
    v_xor_b32 v86, 48, v85
    v_add_u32 v86, s72, v86
    v_xor_b32 v87, 16, v86
    v_add_u32 v87, s72, v87
    s_xor_b32 s69, s68, 512
    s_lshl_b32 s70, s58, 12
    s_waitcnt vmcnt(17)
    s_barrier
    ds_read_b64_tr_b16 v[128:129], v88 offset:0
    ds_read_b64_tr_b16 v[130:131], v88 offset:1024
    ds_read_b64_tr_b16 v[132:133], v89 offset:0
    ds_read_b64_tr_b16 v[134:135], v89 offset:1024
    ds_read_b64_tr_b16 v[136:137], v88 offset:8192
    ds_read_b64_tr_b16 v[138:139], v88 offset:9216
    ds_read_b64_tr_b16 v[140:141], v89 offset:8192
    ds_read_b64_tr_b16 v[142:143], v89 offset:9216
    s_waitcnt lgkmcnt(4)
    ds_read_b64_tr_b16 v[144:145], v88 offset:16384
    ds_read_b64_tr_b16 v[146:147], v88 offset:17408
    ds_read_b64_tr_b16 v[148:149], v89 offset:16384
    ds_read_b64_tr_b16 v[150:151], v89 offset:17408
    ds_read_b64_tr_b16 v[152:153], v88 offset:24576
    ds_read_b64_tr_b16 v[154:155], v88 offset:25600
    ds_read_b64_tr_b16 v[156:157], v89 offset:24576
    ds_read_b64_tr_b16 v[158:159], v89 offset:25600
    s_waitcnt lgkmcnt(4)
    ds_read_b64_tr_b16 v[160:161], v88 offset:32768
    ds_read_b64_tr_b16 v[162:163], v88 offset:33792
    ds_read_b64_tr_b16 v[164:165], v89 offset:32768
    ds_read_b64_tr_b16 v[166:167], v89 offset:33792
    ds_read_b64_tr_b16 v[168:169], v88 offset:40960
    ds_read_b64_tr_b16 v[170:171], v88 offset:41984
    ds_read_b64_tr_b16 v[172:173], v89 offset:40960
    ds_read_b64_tr_b16 v[174:175], v89 offset:41984
    s_waitcnt lgkmcnt(4)
    ds_read_b64_tr_b16 v[176:177], v88 offset:49152
    ds_read_b64_tr_b16 v[178:179], v88 offset:50176
    ds_read_b64_tr_b16 v[180:181], v89 offset:49152
    ds_read_b64_tr_b16 v[182:183], v89 offset:50176
    ds_read_b64_tr_b16 v[184:185], v88 offset:57344
    ds_read_b64_tr_b16 v[186:187], v88 offset:58368
    ds_read_b64_tr_b16 v[188:189], v89 offset:57344
    ds_read_b64_tr_b16 v[190:191], v89 offset:58368
    s_waitcnt lgkmcnt(0)
    s_barrier
    buffer_load_dwordx4 v[20:23], v84, s[36:39], s68 offen offset:0
    buffer_load_dwordx4 v[24:27], v85, s[36:39], s68 offen offset:1024
    buffer_load_dwordx4 v[28:31], v86, s[36:39], s68 offen offset:2048
    buffer_load_dwordx4 v[32:35], v87, s[36:39], s68 offen offset:3072
    s_add_u32 s68, s68, 0x10000
    buffer_load_dwordx4 v[36:39], v84, s[36:39], s69 offen offset:0
    buffer_load_dwordx4 v[40:43], v85, s[36:39], s69 offen offset:1024
    buffer_load_dwordx4 v[44:47], v86, s[36:39], s69 offen offset:2048
    buffer_load_dwordx4 v[48:51], v87, s[36:39], s69 offen offset:3072
    s_add_u32 s69, s69, 0x10000
    buffer_load_dwordx4 v[52:55], v84, s[36:39], s68 offen offset:0
    buffer_load_dwordx4 v[56:59], v85, s[36:39], s68 offen offset:1024
    buffer_load_dwordx4 v[60:63], v86, s[36:39], s68 offen offset:2048
    buffer_load_dwordx4 v[64:67], v87, s[36:39], s68 offen offset:3072
    s_add_u32 s68, s68, 0x10000
    s_waitcnt vmcnt(28)
    ds_write_b128 v96, v[192:195] offset:0
    s_waitcnt vmcnt(27)
    ds_write_b128 v96, v[196:199] offset:1024
    s_waitcnt vmcnt(26)
    ds_write_b128 v96, v[200:203] offset:2048
    s_waitcnt vmcnt(25)
    ds_write_b128 v96, v[204:207] offset:3072
    s_waitcnt vmcnt(24)
    ds_write_b128 v96, v[208:211] offset:4096
    s_waitcnt vmcnt(23)
    ds_write_b128 v96, v[212:215] offset:5120
    s_waitcnt vmcnt(22)
    ds_write_b128 v96, v[216:219] offset:6144
    s_waitcnt vmcnt(21)
    ds_write_b128 v96, v[220:223] offset:7168
    s_waitcnt vmcnt(20)
    ds_write_b128 v96, v[224:227] offset:8192
    s_waitcnt vmcnt(19)
    ds_write_b128 v96, v[228:231] offset:9216
    s_waitcnt vmcnt(18)
    ds_write_b128 v96, v[232:235] offset:10240
    s_waitcnt vmcnt(17)
    ds_write_b128 v96, v[236:239] offset:11264
    s_waitcnt vmcnt(16)
    ds_write_b128 v96, v[240:243] offset:12288
    s_waitcnt vmcnt(15)
    ds_write_b128 v96, v[244:247] offset:13312
    s_waitcnt vmcnt(14)
    ds_write_b128 v96, v[248:251] offset:14336
    s_waitcnt vmcnt(13)
    ds_write_b128 v96, v[252:255] offset:15360
    s_waitcnt lgkmcnt(0)
    s_barrier
    ds_read_b64_tr_b16 v[192:193], v88 offset:0
    ds_read_b64_tr_b16 v[194:195], v88 offset:1024
    ds_read_b64_tr_b16 v[196:197], v89 offset:0
    ds_read_b64_tr_b16 v[198:199], v89 offset:1024
    ds_read_b64_tr_b16 v[200:201], v88 offset:8192
    ds_read_b64_tr_b16 v[202:203], v88 offset:9216
    ds_read_b64_tr_b16 v[204:205], v89 offset:8192
    ds_read_b64_tr_b16 v[206:207], v89 offset:9216
    s_waitcnt lgkmcnt(4)
    ds_read_b64_tr_b16 v[208:209], v88 offset:16384
    ds_read_b64_tr_b16 v[210:211], v88 offset:17408
    ds_read_b64_tr_b16 v[212:213], v89 offset:16384
    ds_read_b64_tr_b16 v[214:215], v89 offset:17408
    ds_read_b64_tr_b16 v[216:217], v88 offset:24576
    ds_read_b64_tr_b16 v[218:219], v88 offset:25600
    ds_read_b64_tr_b16 v[220:221], v89 offset:24576
    ds_read_b64_tr_b16 v[222:223], v89 offset:25600
    s_waitcnt lgkmcnt(4)
    ds_read_b64_tr_b16 v[224:225], v88 offset:32768
    ds_read_b64_tr_b16 v[226:227], v88 offset:33792
    ds_read_b64_tr_b16 v[228:229], v89 offset:32768
    ds_read_b64_tr_b16 v[230:231], v89 offset:33792
    ds_read_b64_tr_b16 v[232:233], v88 offset:40960
    ds_read_b64_tr_b16 v[234:235], v88 offset:41984
    ds_read_b64_tr_b16 v[236:237], v89 offset:40960
    ds_read_b64_tr_b16 v[238:239], v89 offset:41984
    s_waitcnt lgkmcnt(4)
    ds_read_b64_tr_b16 v[240:241], v88 offset:49152
    ds_read_b64_tr_b16 v[242:243], v88 offset:50176
    ds_read_b64_tr_b16 v[244:245], v89 offset:49152
    ds_read_b64_tr_b16 v[246:247], v89 offset:50176
    ds_read_b64_tr_b16 v[248:249], v88 offset:57344
    ds_read_b64_tr_b16 v[250:251], v88 offset:58368
    ds_read_b64_tr_b16 v[252:253], v89 offset:57344
    ds_read_b64_tr_b16 v[254:255], v89 offset:58368
    s_waitcnt lgkmcnt(0)
    s_barrier
    v_lshl_add_u32 v96, v1, 4, s70
    v_add_u32 v97, 0x10000, v96
    s_waitcnt vmcnt(11)
    ds_write_b128 v96, v[20:23] offset:0
    s_waitcnt vmcnt(10)
    ds_write_b128 v96, v[24:27] offset:1024
    s_waitcnt vmcnt(9)
    ds_write_b128 v96, v[28:31] offset:2048
    s_waitcnt vmcnt(8)
    ds_write_b128 v96, v[32:35] offset:3072
    s_waitcnt vmcnt(7)
    ds_write_b128 v96, v[36:39] offset:32768
    s_waitcnt vmcnt(6)
    ds_write_b128 v96, v[40:43] offset:33792
    s_waitcnt vmcnt(5)
    ds_write_b128 v96, v[44:47] offset:34816
    s_waitcnt vmcnt(4)
    ds_write_b128 v96, v[48:51] offset:35840
    s_waitcnt vmcnt(3)
    ds_write_b128 v97, v[52:55] offset:0
    s_waitcnt vmcnt(2)
    ds_write_b128 v97, v[56:59] offset:1024
    s_waitcnt vmcnt(1)
    ds_write_b128 v97, v[60:63] offset:2048
    s_waitcnt vmcnt(0)
    ds_write_b128 v97, v[64:67] offset:3072
    buffer_load_dword v99, off, s[12:15], s70 offset:32 sc1
    v_lshrrev_b32 v4, 4, v1
    v_xor_b32 v4, v4, v1
    v_bfe_u32 v5, v4, 0, 4
    v_lshlrev_b32 v5, 4, v5
    v_bfe_u32 v4, v1, 0, 4
    v_lshlrev_b32 v4, 10, v4
    s_bfe_u32 s71, s58, 0x10002
    s_lshl_b32 s71, s71, 9
    v_or3_b32 v88, v4, v5, s71
    v_xor_b32 v89, 0x40, v88
    v_xor_b32 v90, 0x80, v88
    v_xor_b32 v91, 0xc0, v88
    v_xor_b32 v92, 0x10000, v88
    v_xor_b32 v93, 0x10040, v88
    v_xor_b32 v94, 0x10080, v88
    v_xor_b32 v95, 0x100c0, v88
    s_lshl_b32 s71, s58, 11
    s_or_b32 s71, s71, 131072
    v_lshl_add_u32 v96, v1, 4, s71
    v_xor_b32 v97, 0x2000, v96
    v_bfe_u32 v98, v1, 0, 4
    v_lshlrev_b32 v98, 4, v98
    v_bfe_u32 v4, v1, 4, 2
    v_lshl_or_b32 v98, v4, 9, v98
    s_bfe_u32 s71, s57, 0x30000
    s_lshl_b32 s71, s71, 13
    s_add_u32 s81, s81, s71
    s_bfe_u32 s71, s58, 0x20000
    s_lshl_b32 s71, s71, 11
    s_bfe_u32 s72, s58, 0x10002
    s_lshl_b32 s72, s72, 8
    s_or_b32 s71, s71, s72
    s_add_u32 s81, s81, s71
    s_mov_b32 s73, 0x5ffffff0
    s_mov_b32 s82, 0
    s_waitcnt vmcnt(8) lgkmcnt(0)
    s_barrier
    ds_read_b128 v[52:55], v88 offset:0
    ds_read_b128 v[56:59], v88 offset:16384
    ds_read_b128 v[60:63], v89 offset:0
    ds_read_b128 v[64:67], v89 offset:16384
    v_mov_b32 v100, 3
    v_cmp_gt_u32 vcc, s58, v100
stream_68:
    s_waitcnt lgkmcnt(2)
    v_mfma_f32_16x16x32_bf16 v[20:23], v[128:131], v[52:55], 0
    ds_read_b128 v[68:71], v90 offset:0
    v_mfma_f32_16x16x32_bf16 v[24:27], v[132:135], v[52:55], 0
    ds_read_b128 v[72:75], v90 offset:16384
    v_mfma_f32_16x16x32_bf16 v[28:31], v[128:131], v[56:59], 0
    s_add_u32 m0, s70, 98304
    s_nop 0
    buffer_load_dwordx4 v84, s[36:39], s69 offen offset:0 lds
    v_mfma_f32_16x16x32_bf16 v[32:35], v[132:135], v[56:59], 0
    s_waitcnt lgkmcnt(2)
    v_mfma_f32_16x16x32_bf16 v[20:23], v[136:139], v[60:63], v[20:23]
    ds_read_b128 v[76:79], v91 offset:0
    v_mfma_f32_16x16x32_bf16 v[24:27], v[140:143], v[60:63], v[24:27]
    ds_read_b128 v[80:83], v91 offset:16384
    v_mfma_f32_16x16x32_bf16 v[28:31], v[136:139], v[64:67], v[28:31]
    buffer_load_dwordx4 v85, s[36:39], s69 offen offset:1024 lds
    v_mfma_f32_16x16x32_bf16 v[32:35], v[140:143], v[64:67], v[32:35]
    ds_write_b128 v96, v[44:47] offset:0
    s_waitcnt lgkmcnt(3)
    v_mfma_f32_16x16x32_bf16 v[20:23], v[144:147], v[68:71], v[20:23]
    ds_read_b128 v[52:55], v88 offset:256
    v_mfma_f32_16x16x32_bf16 v[24:27], v[148:151], v[68:71], v[24:27]
    ds_read_b128 v[56:59], v88 offset:16640
    v_mfma_f32_16x16x32_bf16 v[28:31], v[144:147], v[72:75], v[28:31]
    buffer_load_dwordx4 v86, s[36:39], s69 offen offset:2048 lds
    v_mfma_f32_16x16x32_bf16 v[32:35], v[148:151], v[72:75], v[32:35]
    ds_write_b128 v96, v[48:51] offset:1024
    s_waitcnt lgkmcnt(4)
    v_mfma_f32_16x16x32_bf16 v[20:23], v[152:155], v[76:79], v[20:23]
    ds_read_b128 v[60:63], v89 offset:256
    v_mfma_f32_16x16x32_bf16 v[24:27], v[156:159], v[76:79], v[24:27]
    ds_read_b128 v[64:67], v89 offset:16640
    v_mfma_f32_16x16x32_bf16 v[28:31], v[152:155], v[80:83], v[28:31]
    buffer_load_dwordx4 v87, s[36:39], s69 offen offset:3072 lds
    s_add_u32 s69, s69, 0x10000
    v_mfma_f32_16x16x32_bf16 v[32:35], v[156:159], v[80:83], v[32:35]
    s_waitcnt lgkmcnt(3)
    v_mfma_f32_16x16x32_bf16 v[20:23], v[160:163], v[52:55], v[20:23]
    ds_read_b128 v[68:71], v90 offset:256
    v_mfma_f32_16x16x32_bf16 v[24:27], v[164:167], v[52:55], v[24:27]
    ds_read_b128 v[72:75], v90 offset:16640
    v_mfma_f32_16x16x32_bf16 v[28:31], v[160:163], v[56:59], v[28:31]
    v_mfma_f32_16x16x32_bf16 v[32:35], v[164:167], v[56:59], v[32:35]
    s_waitcnt lgkmcnt(2)
    v_mfma_f32_16x16x32_bf16 v[20:23], v[168:171], v[60:63], v[20:23]
    ds_read_b128 v[76:79], v91 offset:256
    v_mfma_f32_16x16x32_bf16 v[24:27], v[172:175], v[60:63], v[24:27]
    ds_read_b128 v[80:83], v91 offset:16640
    v_mfma_f32_16x16x32_bf16 v[28:31], v[168:171], v[64:67], v[28:31]
    v_mfma_f32_16x16x32_bf16 v[32:35], v[172:175], v[64:67], v[32:35]
    s_waitcnt vmcnt(8) lgkmcnt(0)
    s_barrier
    v_mfma_f32_16x16x32_bf16 v[20:23], v[176:179], v[68:71], v[20:23]
    ds_read_b128 v[4:7], v97 offset:0
    ds_read_b128 v[8:11], v97 offset:1024
    ds_read_b128 v[52:55], v88 offset:32768
    v_mfma_f32_16x16x32_bf16 v[24:27], v[180:183], v[68:71], v[24:27]
    ds_read_b128 v[56:59], v88 offset:49152
    v_mfma_f32_16x16x32_bf16 v[28:31], v[176:179], v[72:75], v[28:31]
    v_mfma_f32_16x16x32_bf16 v[32:35], v[180:183], v[72:75], v[32:35]
    s_waitcnt lgkmcnt(2)
    v_mfma_f32_16x16x32_bf16 v[20:23], v[184:187], v[76:79], v[20:23]
    v_add_f32 v4, v4, v36
    v_add_f32 v5, v5, v37
    v_add_f32 v6, v6, v38
    v_add_f32 v7, v7, v39
    ds_read_b128 v[60:63], v89 offset:32768
    v_mfma_f32_16x16x32_bf16 v[24:27], v[188:191], v[76:79], v[24:27]
    v_cvt_pk_bf16_f32 v12, v4, v5
    v_cvt_pk_bf16_f32 v13, v6, v7
    ds_read_b128 v[64:67], v89 offset:49152
    v_mfma_f32_16x16x32_bf16 v[28:31], v[184:187], v[80:83], v[28:31]
    v_add_f32 v8, v8, v40
    v_add_f32 v9, v9, v41
    v_add_f32 v10, v10, v42
    v_add_f32 v11, v11, v43
    v_mfma_f32_16x16x32_bf16 v[32:35], v[188:191], v[80:83], v[32:35]
    v_cvt_pk_bf16_f32 v14, v8, v9
    v_cvt_pk_bf16_f32 v15, v10, v11
    buffer_store_dwordx4 v[12:15], v98, s[8:11], s73 offen sc1
    s_mov_b32 s73, s81
    s_add_u32 s81, s81, 0x40000
    s_waitcnt lgkmcnt(2)
    v_mfma_f32_16x16x32_bf16 v[20:23], v[192:195], v[52:55], v[20:23]
    ds_read_b128 v[68:71], v90 offset:32768
    v_mfma_f32_16x16x32_bf16 v[24:27], v[196:199], v[52:55], v[24:27]
    ds_read_b128 v[72:75], v90 offset:49152
    v_mfma_f32_16x16x32_bf16 v[28:31], v[192:195], v[56:59], v[28:31]
    s_add_u32 m0, s70, 0
    s_nop 0
    buffer_load_dwordx4 v84, s[36:39], s68 offen offset:0 lds
    v_mfma_f32_16x16x32_bf16 v[32:35], v[196:199], v[56:59], v[32:35]
    s_waitcnt lgkmcnt(2)
    v_mfma_f32_16x16x32_bf16 v[20:23], v[200:203], v[60:63], v[20:23]
    ds_read_b128 v[76:79], v91 offset:32768
    v_mfma_f32_16x16x32_bf16 v[24:27], v[204:207], v[60:63], v[24:27]
    ds_read_b128 v[80:83], v91 offset:49152
    v_mfma_f32_16x16x32_bf16 v[28:31], v[200:203], v[64:67], v[28:31]
    buffer_load_dwordx4 v85, s[36:39], s68 offen offset:1024 lds
    v_mfma_f32_16x16x32_bf16 v[32:35], v[204:207], v[64:67], v[32:35]
    s_waitcnt lgkmcnt(2)
    v_mfma_f32_16x16x32_bf16 v[20:23], v[208:211], v[68:71], v[20:23]
    ds_read_b128 v[52:55], v88 offset:33024
    v_mfma_f32_16x16x32_bf16 v[24:27], v[212:215], v[68:71], v[24:27]
    ds_read_b128 v[56:59], v88 offset:49408
    v_mfma_f32_16x16x32_bf16 v[28:31], v[208:211], v[72:75], v[28:31]
    buffer_load_dwordx4 v86, s[36:39], s68 offen offset:2048 lds
    v_mfma_f32_16x16x32_bf16 v[32:35], v[212:215], v[72:75], v[32:35]
    s_waitcnt lgkmcnt(2)
    v_mfma_f32_16x16x32_bf16 v[20:23], v[216:219], v[76:79], v[20:23]
    ds_read_b128 v[60:63], v89 offset:33024
    v_mfma_f32_16x16x32_bf16 v[24:27], v[220:223], v[76:79], v[24:27]
    ds_read_b128 v[64:67], v89 offset:49408
    v_mfma_f32_16x16x32_bf16 v[28:31], v[216:219], v[80:83], v[28:31]
    buffer_load_dwordx4 v87, s[36:39], s68 offen offset:3072 lds
    s_add_u32 s68, s68, 0x10000
    v_mfma_f32_16x16x32_bf16 v[32:35], v[220:223], v[80:83], v[32:35]
    s_waitcnt lgkmcnt(2)
    v_mfma_f32_16x16x32_bf16 v[20:23], v[224:227], v[52:55], v[20:23]
    ds_read_b128 v[68:71], v90 offset:33024
    v_mfma_f32_16x16x32_bf16 v[24:27], v[228:231], v[52:55], v[24:27]
    ds_read_b128 v[72:75], v90 offset:49408
    v_mfma_f32_16x16x32_bf16 v[28:31], v[224:227], v[56:59], v[28:31]
    v_mfma_f32_16x16x32_bf16 v[32:35], v[228:231], v[56:59], v[32:35]
    s_waitcnt lgkmcnt(2)
    v_mfma_f32_16x16x32_bf16 v[20:23], v[232:235], v[60:63], v[20:23]
    ds_read_b128 v[76:79], v91 offset:33024
    v_mfma_f32_16x16x32_bf16 v[24:27], v[236:239], v[60:63], v[24:27]
    ds_read_b128 v[80:83], v91 offset:49408
    v_mfma_f32_16x16x32_bf16 v[28:31], v[232:235], v[64:67], v[28:31]
    v_mfma_f32_16x16x32_bf16 v[32:35], v[236:239], v[64:67], v[32:35]
    s_bitcmp1_b64 s[6:7], s82
    s_cbranch_scc1 ssig_58
    s_waitcnt vmcnt(8) lgkmcnt(0)
    s_barrier
sretf_59:
    s_add_u32 s82, s82, 1
    v_mfma_f32_16x16x32_bf16 v[20:23], v[240:243], v[68:71], v[20:23]
    ds_read_b128 v[52:55], v92 offset:0
    v_mfma_f32_16x16x32_bf16 v[24:27], v[244:247], v[68:71], v[24:27]
    ds_read_b128 v[56:59], v92 offset:16384
    v_mfma_f32_16x16x32_bf16 v[28:31], v[240:243], v[72:75], v[28:31]
    v_mfma_f32_16x16x32_bf16 v[32:35], v[244:247], v[72:75], v[32:35]
    v_mfma_f32_16x16x32_bf16 v[20:23], v[248:251], v[76:79], v[20:23]
    ds_read_b128 v[60:63], v93 offset:0
    v_mfma_f32_16x16x32_bf16 v[24:27], v[252:255], v[76:79], v[24:27]
    ds_read_b128 v[64:67], v93 offset:16384
    v_mfma_f32_16x16x32_bf16 v[28:31], v[248:251], v[80:83], v[28:31]
    v_mfma_f32_16x16x32_bf16 v[32:35], v[252:255], v[80:83], v[32:35]
    s_waitcnt lgkmcnt(2)
    v_mfma_f32_16x16x32_bf16 v[36:39], v[128:131], v[52:55], 0
    ds_read_b128 v[68:71], v94 offset:0
    v_mfma_f32_16x16x32_bf16 v[40:43], v[132:135], v[52:55], 0
    ds_read_b128 v[72:75], v94 offset:16384
    v_mfma_f32_16x16x32_bf16 v[44:47], v[128:131], v[56:59], 0
    s_add_u32 m0, s70, 32768
    s_nop 0
    buffer_load_dwordx4 v84, s[36:39], s69 offen offset:0 lds
    v_mfma_f32_16x16x32_bf16 v[48:51], v[132:135], v[56:59], 0
    s_waitcnt lgkmcnt(2)
    v_mfma_f32_16x16x32_bf16 v[36:39], v[136:139], v[60:63], v[36:39]
    ds_read_b128 v[76:79], v95 offset:0
    v_mfma_f32_16x16x32_bf16 v[40:43], v[140:143], v[60:63], v[40:43]
    ds_read_b128 v[80:83], v95 offset:16384
    v_mfma_f32_16x16x32_bf16 v[44:47], v[136:139], v[64:67], v[44:47]
    buffer_load_dwordx4 v85, s[36:39], s69 offen offset:1024 lds
    v_mfma_f32_16x16x32_bf16 v[48:51], v[140:143], v[64:67], v[48:51]
    ds_write_b128 v96, v[28:31] offset:0
    s_waitcnt lgkmcnt(3)
    v_mfma_f32_16x16x32_bf16 v[36:39], v[144:147], v[68:71], v[36:39]
    ds_read_b128 v[52:55], v92 offset:256
    v_mfma_f32_16x16x32_bf16 v[40:43], v[148:151], v[68:71], v[40:43]
    ds_read_b128 v[56:59], v92 offset:16640
    v_mfma_f32_16x16x32_bf16 v[44:47], v[144:147], v[72:75], v[44:47]
    buffer_load_dwordx4 v86, s[36:39], s69 offen offset:2048 lds
    v_mfma_f32_16x16x32_bf16 v[48:51], v[148:151], v[72:75], v[48:51]
    ds_write_b128 v96, v[32:35] offset:1024
    s_waitcnt lgkmcnt(4)
    v_mfma_f32_16x16x32_bf16 v[36:39], v[152:155], v[76:79], v[36:39]
    ds_read_b128 v[60:63], v93 offset:256
    v_mfma_f32_16x16x32_bf16 v[40:43], v[156:159], v[76:79], v[40:43]
    ds_read_b128 v[64:67], v93 offset:16640
    v_mfma_f32_16x16x32_bf16 v[44:47], v[152:155], v[80:83], v[44:47]
    buffer_load_dwordx4 v87, s[36:39], s69 offen offset:3072 lds
    s_add_u32 s69, s69, 0x10000
    v_mfma_f32_16x16x32_bf16 v[48:51], v[156:159], v[80:83], v[48:51]
    s_waitcnt lgkmcnt(3)
    v_mfma_f32_16x16x32_bf16 v[36:39], v[160:163], v[52:55], v[36:39]
    ds_read_b128 v[68:71], v94 offset:256
    v_mfma_f32_16x16x32_bf16 v[40:43], v[164:167], v[52:55], v[40:43]
    ds_read_b128 v[72:75], v94 offset:16640
    v_mfma_f32_16x16x32_bf16 v[44:47], v[160:163], v[56:59], v[44:47]
    v_mfma_f32_16x16x32_bf16 v[48:51], v[164:167], v[56:59], v[48:51]
    s_waitcnt lgkmcnt(2)
    v_mfma_f32_16x16x32_bf16 v[36:39], v[168:171], v[60:63], v[36:39]
    ds_read_b128 v[76:79], v95 offset:256
    v_mfma_f32_16x16x32_bf16 v[40:43], v[172:175], v[60:63], v[40:43]
    ds_read_b128 v[80:83], v95 offset:16640
    v_mfma_f32_16x16x32_bf16 v[44:47], v[168:171], v[64:67], v[44:47]
    v_mfma_f32_16x16x32_bf16 v[48:51], v[172:175], v[64:67], v[48:51]
    s_waitcnt vmcnt(8) lgkmcnt(0)
    s_barrier
    v_mfma_f32_16x16x32_bf16 v[36:39], v[176:179], v[68:71], v[36:39]
    ds_read_b128 v[4:7], v97 offset:0
    ds_read_b128 v[8:11], v97 offset:1024
    ds_read_b128 v[52:55], v92 offset:32768
    v_mfma_f32_16x16x32_bf16 v[40:43], v[180:183], v[68:71], v[40:43]
    ds_read_b128 v[56:59], v92 offset:49152
    v_mfma_f32_16x16x32_bf16 v[44:47], v[176:179], v[72:75], v[44:47]
    v_mfma_f32_16x16x32_bf16 v[48:51], v[180:183], v[72:75], v[48:51]
    s_waitcnt lgkmcnt(2)
    v_mfma_f32_16x16x32_bf16 v[36:39], v[184:187], v[76:79], v[36:39]
    v_add_f32 v4, v4, v20
    v_add_f32 v5, v5, v21
    v_add_f32 v6, v6, v22
    v_add_f32 v7, v7, v23
    ds_read_b128 v[60:63], v93 offset:32768
    v_mfma_f32_16x16x32_bf16 v[40:43], v[188:191], v[76:79], v[40:43]
    v_cvt_pk_bf16_f32 v12, v4, v5
    v_cvt_pk_bf16_f32 v13, v6, v7
    ds_read_b128 v[64:67], v93 offset:49152
    v_mfma_f32_16x16x32_bf16 v[44:47], v[184:187], v[80:83], v[44:47]
    v_add_f32 v8, v8, v24
    v_add_f32 v9, v9, v25
    v_add_f32 v10, v10, v26
    v_add_f32 v11, v11, v27
    v_mfma_f32_16x16x32_bf16 v[48:51], v[188:191], v[80:83], v[48:51]
    v_cvt_pk_bf16_f32 v14, v8, v9
    v_cvt_pk_bf16_f32 v15, v10, v11
    buffer_store_dwordx4 v[12:15], v98, s[8:11], s73 offen sc1
    s_mov_b32 s73, s81
    s_add_u32 s81, s81, 0x40000
    s_waitcnt lgkmcnt(2)
    v_mfma_f32_16x16x32_bf16 v[36:39], v[192:195], v[52:55], v[36:39]
    ds_read_b128 v[68:71], v94 offset:32768
    v_mfma_f32_16x16x32_bf16 v[40:43], v[196:199], v[52:55], v[40:43]
    ds_read_b128 v[72:75], v94 offset:49152
    v_mfma_f32_16x16x32_bf16 v[44:47], v[192:195], v[56:59], v[44:47]
    s_add_u32 m0, s70, 65536
    s_nop 0
    buffer_load_dwordx4 v84, s[36:39], s68 offen offset:0 lds
    v_mfma_f32_16x16x32_bf16 v[48:51], v[196:199], v[56:59], v[48:51]
    s_waitcnt lgkmcnt(2)
    v_mfma_f32_16x16x32_bf16 v[36:39], v[200:203], v[60:63], v[36:39]
    ds_read_b128 v[76:79], v95 offset:32768
    v_mfma_f32_16x16x32_bf16 v[40:43], v[204:207], v[60:63], v[40:43]
    ds_read_b128 v[80:83], v95 offset:49152
    v_mfma_f32_16x16x32_bf16 v[44:47], v[200:203], v[64:67], v[44:47]
    buffer_load_dwordx4 v85, s[36:39], s68 offen offset:1024 lds
    v_mfma_f32_16x16x32_bf16 v[48:51], v[204:207], v[64:67], v[48:51]
    s_waitcnt lgkmcnt(2)
    v_mfma_f32_16x16x32_bf16 v[36:39], v[208:211], v[68:71], v[36:39]
    ds_read_b128 v[52:55], v92 offset:33024
    v_mfma_f32_16x16x32_bf16 v[40:43], v[212:215], v[68:71], v[40:43]
    ds_read_b128 v[56:59], v92 offset:49408
    v_mfma_f32_16x16x32_bf16 v[44:47], v[208:211], v[72:75], v[44:47]
    buffer_load_dwordx4 v86, s[36:39], s68 offen offset:2048 lds
    v_mfma_f32_16x16x32_bf16 v[48:51], v[212:215], v[72:75], v[48:51]
    s_waitcnt lgkmcnt(2)
    v_mfma_f32_16x16x32_bf16 v[36:39], v[216:219], v[76:79], v[36:39]
    ds_read_b128 v[60:63], v93 offset:33024
    v_mfma_f32_16x16x32_bf16 v[40:43], v[220:223], v[76:79], v[40:43]
    ds_read_b128 v[64:67], v93 offset:49408
    v_mfma_f32_16x16x32_bf16 v[44:47], v[216:219], v[80:83], v[44:47]
    buffer_load_dwordx4 v87, s[36:39], s68 offen offset:3072 lds
    s_add_u32 s68, s68, 0x10000
    v_mfma_f32_16x16x32_bf16 v[48:51], v[220:223], v[80:83], v[48:51]
    s_waitcnt lgkmcnt(2)
    v_mfma_f32_16x16x32_bf16 v[36:39], v[224:227], v[52:55], v[36:39]
    ds_read_b128 v[68:71], v94 offset:33024
    v_mfma_f32_16x16x32_bf16 v[40:43], v[228:231], v[52:55], v[40:43]
    ds_read_b128 v[72:75], v94 offset:49408
    v_mfma_f32_16x16x32_bf16 v[44:47], v[224:227], v[56:59], v[44:47]
    v_mfma_f32_16x16x32_bf16 v[48:51], v[228:231], v[56:59], v[48:51]
    s_waitcnt lgkmcnt(2)
    v_mfma_f32_16x16x32_bf16 v[36:39], v[232:235], v[60:63], v[36:39]
    ds_read_b128 v[76:79], v95 offset:33024
    v_mfma_f32_16x16x32_bf16 v[40:43], v[236:239], v[60:63], v[40:43]
    ds_read_b128 v[80:83], v95 offset:49408
    v_mfma_f32_16x16x32_bf16 v[44:47], v[232:235], v[64:67], v[44:47]
    v_mfma_f32_16x16x32_bf16 v[48:51], v[236:239], v[64:67], v[48:51]
    s_bitcmp1_b64 s[6:7], s82
    s_cbranch_scc1 ssig_58
    s_waitcnt vmcnt(8) lgkmcnt(0)
    s_barrier
sretf_65:
    s_add_u32 s82, s82, 1
    v_mfma_f32_16x16x32_bf16 v[36:39], v[240:243], v[68:71], v[36:39]
    ds_read_b128 v[52:55], v88 offset:0
    v_mfma_f32_16x16x32_bf16 v[40:43], v[244:247], v[68:71], v[40:43]
    ds_read_b128 v[56:59], v88 offset:16384
    v_mfma_f32_16x16x32_bf16 v[44:47], v[240:243], v[72:75], v[44:47]
    v_mfma_f32_16x16x32_bf16 v[48:51], v[244:247], v[72:75], v[48:51]
    v_mfma_f32_16x16x32_bf16 v[36:39], v[248:251], v[76:79], v[36:39]
    ds_read_b128 v[60:63], v89 offset:0
    v_mfma_f32_16x16x32_bf16 v[40:43], v[252:255], v[76:79], v[40:43]
    ds_read_b128 v[64:67], v89 offset:16384
    v_mfma_f32_16x16x32_bf16 v[44:47], v[248:251], v[80:83], v[44:47]
    v_mfma_f32_16x16x32_bf16 v[48:51], v[252:255], v[80:83], v[48:51]
    s_cmp_lt_u32 s82, 64
    s_cbranch_scc1 stream_68
    s_nop 4
    ds_write_b128 v96, v[44:47] offset:0
    ds_write_b128 v96, v[48:51] offset:1024
    s_waitcnt vmcnt(0) lgkmcnt(0)
    s_barrier
    ds_read_b128 v[4:7], v97 offset:0
    ds_read_b128 v[8:11], v97 offset:1024
    s_waitcnt lgkmcnt(0)
    v_add_f32 v4, v4, v36
    v_add_f32 v5, v5, v37
    v_add_f32 v6, v6, v38
    v_add_f32 v7, v7, v39
    v_cvt_pk_bf16_f32 v12, v4, v5
    v_cvt_pk_bf16_f32 v13, v6, v7
    v_add_f32 v8, v8, v40
    v_add_f32 v9, v9, v41
    v_add_f32 v10, v10, v42
    v_add_f32 v11, v11, v43
    v_cvt_pk_bf16_f32 v14, v8, v9
    v_cvt_pk_bf16_f32 v15, v10, v11
    buffer_store_dwordx4 v[12:15], v98, s[8:11], s73 offen sc1
    s_mov_b32 s73, s81
    s_add_u32 s81, s81, 0x40000
    s_branch send_61
ssig_58:
    s_waitcnt vmcnt(4) lgkmcnt(0)
    s_barrier
    s_cmp_lg_u32 s58, 0
    s_cbranch_scc1 sig_70
    s_cmp_ge_u32 s57, 16
    s_cbranch_scc1 sig_69
    s_waitcnt vmcnt(4)
    v_and_b32 v4, 0x3ff, v99
    v_cmp_gt_u32 vcc, 128, v4
    s_cbranch_vccz armd_ok_72
armd_71:
    buffer_load_dword v99, off, s[12:15], 0 offset:32 sc1
    s_waitcnt vmcnt(0)
    v_and_b32 v4, 0x3ff, v99
    v_cmp_gt_u32 vcc, 128, v4
    s_cbranch_vccz armd_ok_72
    s_sub_u32 s77, s77, 1
    s_cbranch_scc0 armd_71
    s_mov_b32 s77, 0
armd_ok_72:
    s_bfe_u32 s85, s76, 0x10003
    s_lshl_b32 s85, s85, 2
    s_bfe_u32 s79, s76, 0x30000
    s_lshl_b32 s79, s79, 7
    s_or_b32 s85, s85, s79
    s_bfe_u32 s79, s76, 0x20005
    s_lshl_b32 s79, s79, 10
    s_or_b32 s85, s85, s79
    s_add_u32 s85, s85, 0x5110000
    v_mov_b32 v4, s82
    buffer_store_dword v4, off, s[8:11], s85 sc1
sig_69:
    s_bitcmp0_b32 s82, 1
    s_cbranch_scc1 sig_70
    s_cmp_lt_u32 s82, 6
    s_cbranch_scc1 sig_70
    v_mov_b32 v5, s84
    s_mov_b64 exec, 1
    buffer_atomic_add v5, off, s[12:15], s83 sc1
    s_mov_b64 exec, -1
    s_add_u32 s83, s83, 4
sig_70:
    s_cmp_lt_u32 s57, 24
    s_cbranch_scc1 xtra_73
    s_bfe_u32 s79, s76, 0x30000
    s_lshl_b32 s79, s79, 16
    s_bfe_u32 s85, s76, 0x20005
    s_lshl_b32 s85, s85, 19
    s_or_b32 s79, s79, s85
    s_lshl_b32 s85, s58, 13
    s_add_u32 s85, s85, s79
    v_lshlrev_b32 v6, 7, v1
    buffer_load_dword v16, v6, s[36:39], s85 offen
    buffer_load_dword v17, v6, s[48:51], s85 offen
    buffer_load_dword v18, v6, s[52:55], s85 offen
    s_add_u32 s85, s85, 0x200000
    buffer_load_dword v19, v6, s[36:39], s85 offen
    s_branch xtra_74
xtra_73:
    v_lshlrev_b32 v6, 4, v1
    s_bfe_u32 s80, s76, 0x40000
    s_lshl_b32 s80, s80, 3
    s_bfe_u32 s85, s76, 0x20005
    s_lshl_b32 s85, s85, 7
    s_or_b32 s80, s80, s85
    s_add_u32 s80, s80, s58
    s_cmp_lg_u32 s82, 10
    s_cbranch_scc1 xtra_75
    v_mov_b32 v16, 0
    v_mov_b32 v17, 0
    v_mov_b32 v18, 0
    v_mov_b32 v19, 0
    s_lshl_b32 s85, s80, 6
    s_add_u32 s85, s85, 0x5100000
    v_and_b32 v7, 48, v6
    s_cmp_ge_u32 s57, 16
    s_cselect_b32 s85, 0x5ffffff0, s85
    buffer_store_dwordx4 v[16:19], v7, s[8:11], s85 offen sc1
xtra_75:
    s_cmp_lg_u32 s82, 99
    s_cbranch_scc1 xtra_76
    s_lshl_b32 s85, s80, 14
    s_cmp_ge_u32 s57, 16
    s_cbranch_scc1 xtra_76
    v_lshlrev_b32 v7, 6, v1
    buffer_load_dword v16, v7, s[32:35], s85 offen
    s_add_u32 s85, s85, 4096
    buffer_load_dword v17, v7, s[32:35], s85 offen
    s_add_u32 s85, s85, 4096
    buffer_load_dword v18, v7, s[32:35], s85 offen
    s_add_u32 s85, s85, 4096
    buffer_load_dword v19, v7, s[32:35], s85 offen
    s_add_u32 s85, s85, 4096
xtra_76:
    s_bfe_u32 s85, s57, 0x30000
    s_lshl_b32 s85, s85, 2
    s_add_u32 s85, s85, 10
    s_cmp_lg_u32 s82, s85
    s_cbranch_scc1 xtra_74
    v_mov_b32 v8, -1
    v_mov_b32 v9, -1
    v_mov_b32 v10, -1
    v_mov_b32 v11, -1
    s_bfe_u32 s85, s76, 0x20005
    s_lshl_b32 s85, s85, 11
    s_bfe_u32 s79, s76, 0x30000
    s_lshl_b32 s79, s79, 16
    s_or_b32 s85, s85, s79
    s_bfe_u32 s79, s76, 0x20003
    s_lshl_b32 s79, s79, 21
    s_or_b32 s85, s85, s79
    s_lshl_b32 s79, s58, 13
    s_add_u32 s85, s85, s79
    s_add_u32 s85, s85, 0x6000000
    buffer_store_dwordx4 v[8:11], v6, s[8:11], s85 offen offset:0 sc1
    s_add_u32 s85, s85, 0x80000
    buffer_store_dwordx4 v[8:11], v6, s[8:11], s85 offen offset:0 sc1
    s_add_u32 s85, s85, 0x80000
    buffer_store_dwordx4 v[8:11], v6, s[8:11], s85 offen offset:0 sc1
    s_add_u32 s85, s85, 0x80000
    buffer_store_dwordx4 v[8:11], v6, s[8:11], s85 offen offset:0 sc1
    s_add_u32 s85, s85, 0x80000
    s_cmp_ge_u32 s57, 16
    s_cbranch_scc1 xtra_74
    s_bfe_u32 s85, s80, 0x30003
    s_lshl_b32 s85, s85, 11
    s_bfe_u32 s79, s80, 0x20007
    s_lshl_b32 s79, s79, 14
    s_or_b32 s85, s85, s79
    s_bfe_u32 s79, s80, 0x30000
    s_lshl_b32 s79, s79, 17
    s_or_b32 s85, s85, s79
    s_bfe_u32 s79, s80, 0x10006
    s_lshl_b32 s79, s79, 22
    s_or_b32 s85, s85, s79
    s_add_u32 s85, s85, 0x4300000
    buffer_store_dwordx4 v[8:11], v6, s[8:11], s85 offen offset:0 sc1
    buffer_store_dwordx4 v[8:11], v6, s[8:11], s85 offen offset:1024 sc1
    s_add_u32 s85, s85, 0x10000
    buffer_store_dwordx4 v[8:11], v6, s[8:11], s85 offen offset:0 sc1
    buffer_store_dwordx4 v[8:11], v6, s[8:11], s85 offen offset:1024 sc1
xtra_74:
    s_bitcmp1_b32 s82, 0
    s_cbranch_scc1 xtra_77
    s_bitcmp1_b32 s57, 3
    s_cbranch_scc1 srett_60
    s_branch sretf_59
xtra_77:
    s_bitcmp1_b32 s57, 3
    s_cbranch_scc1 srett_66
    s_branch sretf_65
sv_56:
    s_mov_b32 s81, 0x2000000
    v_bfe_u32 v4, v1, 4, 2
    v_lshlrev_b32 v4, 2, v4
    v_xor_b32 v4, v4, v1
    v_bfe_u32 v84, v4, 0, 2
    v_lshlrev_b32 v84, 4, v84
    v_bfe_u32 v5, v4, 2, 2
    v_lshl_or_b32 v84, v5, 6, v84
    v_bfe_u32 v5, v4, 4, 2
    v_lshl_or_b32 v84, v5, 13, v84
    v_xor_b32 v85, 32, v84
    s_bfe_u32 s68, s58, 0x20000
    s_lshl_b32 s68, s68, 19
    s_bfe_u32 s71, s58, 0x10002
    s_lshl_b32 s71, s71, 22
    s_or_b32 s68, s68, s71
    s_bfe_u32 s71, s57, 0x30000
    s_lshl_b32 s71, s71, 8
    s_bfe_u32 s72, s57, 0x10000
    s_lshl_b32 s72, s72, 21
    s_or_b32 s71, s71, s72
    s_add_u32 s68, s68, s71
    s_lshl_b32 s71, s75, 11
    s_add_u32 s68, s68, s71
    s_xor_b32 s69, s68, 0x200000
    s_lshl_b32 s70, s58, 14
    s_add_u32 m0, s70, 0
    s_nop 0
    buffer_load_dwordx4 v84, s[28:31], s68 offen lds
    s_add_u32 s68, s68, 0x8000
    s_add_u32 m0, s70, 1024
    s_nop 0
    buffer_load_dwordx4 v84, s[28:31], s68 offen lds
    s_add_u32 s68, s68, 0x8000
    s_add_u32 m0, s70, 2048
    s_nop 0
    buffer_load_dwordx4 v85, s[28:31], s68 offen lds
    s_add_u32 s68, s68, 0x8000
    s_add_u32 m0, s70, 3072
    s_nop 0
    buffer_load_dwordx4 v85, s[28:31], s68 offen lds
    s_add_u32 s68, s68, 0x8000
    s_add_u32 m0, s70, 4096
    s_nop 0
    buffer_load_dwordx4 v84, s[28:31], s68 offen lds
    s_add_u32 s68, s68, 0x8000
    s_add_u32 m0, s70, 5120
    s_nop 0
    buffer_load_dwordx4 v84, s[28:31], s68 offen lds
    s_add_u32 s68, s68, 0x8000
    s_add_u32 m0, s70, 6144
    s_nop 0
    buffer_load_dwordx4 v85, s[28:31], s68 offen lds
    s_add_u32 s68, s68, 0x8000
    s_add_u32 m0, s70, 7168
    s_nop 0
    buffer_load_dwordx4 v85, s[28:31], s68 offen lds
    s_add_u32 s68, s68, 0x8000
    s_add_u32 m0, s70, 8192
    s_nop 0
    buffer_load_dwordx4 v84, s[28:31], s68 offen lds
    s_add_u32 s68, s68, 0x8000
    s_add_u32 m0, s70, 9216
    s_nop 0
    buffer_load_dwordx4 v84, s[28:31], s68 offen lds
    s_add_u32 s68, s68, 0x8000
    s_add_u32 m0, s70, 10240
    s_nop 0
    buffer_load_dwordx4 v85, s[28:31], s68 offen lds
    s_add_u32 s68, s68, 0x8000
    s_add_u32 m0, s70, 11264
    s_nop 0
    buffer_load_dwordx4 v85, s[28:31], s68 offen lds
    s_add_u32 s68, s68, 0x8000
    s_add_u32 m0, s70, 12288
    s_nop 0
    buffer_load_dwordx4 v84, s[28:31], s68 offen lds
    s_add_u32 s68, s68, 0x8000
    s_add_u32 m0, s70, 13312
    s_nop 0
    buffer_load_dwordx4 v84, s[28:31], s68 offen lds
    s_add_u32 s68, s68, 0x8000
    s_add_u32 m0, s70, 14336
    s_nop 0
    buffer_load_dwordx4 v85, s[28:31], s68 offen lds
    s_add_u32 s68, s68, 0x8000
    s_add_u32 m0, s70, 15360
    s_nop 0
    buffer_load_dwordx4 v85, s[28:31], s68 offen lds
    s_add_u32 s68, s68, 0x8000
    buffer_load_dwordx4 v[192:195], v84, s[28:31], s69 offen
    s_add_u32 s69, s69, 0x8000
    buffer_load_dwordx4 v[196:199], v84, s[28:31], s69 offen
    s_add_u32 s69, s69, 0x8000
    buffer_load_dwordx4 v[200:203], v85, s[28:31], s69 offen
    s_add_u32 s69, s69, 0x8000
    buffer_load_dwordx4 v[204:207], v85, s[28:31], s69 offen
    s_add_u32 s69, s69, 0x8000
    buffer_load_dwordx4 v[208:211], v84, s[28:31], s69 offen
    s_add_u32 s69, s69, 0x8000
    buffer_load_dwordx4 v[212:215], v84, s[28:31], s69 offen
    s_add_u32 s69, s69, 0x8000
    buffer_load_dwordx4 v[216:219], v85, s[28:31], s69 offen
    s_add_u32 s69, s69, 0x8000
    buffer_load_dwordx4 v[220:223], v85, s[28:31], s69 offen
    s_add_u32 s69, s69, 0x8000
    buffer_load_dwordx4 v[224:227], v84, s[28:31], s69 offen
    s_add_u32 s69, s69, 0x8000
    buffer_load_dwordx4 v[228:231], v84, s[28:31], s69 offen
    s_add_u32 s69, s69, 0x8000
    buffer_load_dwordx4 v[232:235], v85, s[28:31], s69 offen
    s_add_u32 s69, s69, 0x8000
    buffer_load_dwordx4 v[236:239], v85, s[28:31], s69 offen
    s_add_u32 s69, s69, 0x8000
    buffer_load_dwordx4 v[240:243], v84, s[28:31], s69 offen
    s_add_u32 s69, s69, 0x8000
    buffer_load_dwordx4 v[244:247], v84, s[28:31], s69 offen
    s_add_u32 s69, s69, 0x8000
    buffer_load_dwordx4 v[248:251], v85, s[28:31], s69 offen
    s_add_u32 s69, s69, 0x8000
    buffer_load_dwordx4 v[252:255], v85, s[28:31], s69 offen
    s_add_u32 s69, s69, 0x8000
    s_lshl_b32 s71, s57, 3
    s_add_u32 s71, s71, s58
    s_lshl_b32 s71, s71, 13
    s_cmp_lt_u32 s57, 3
    s_cselect_b32 s71, s71, 0x5ffffff0
    v_lshlrev_b32 v4, 7, v1
    buffer_load_dword v99, v4, s[36:39], s71 offen
    v_bfe_u32 v88, v1, 0, 2
    v_lshlrev_b32 v88, 3, v88
    v_bfe_u32 v5, v1, 4, 1
    v_lshl_or_b32 v88, v5, 5, v88
    v_bfe_u32 v5, v1, 2, 2
    v_lshl_or_b32 v88, v5, 6, v88
    v_bfe_u32 v5, v1, 2, 2
    v_lshl_or_b32 v88, v5, 8, v88
    v_bfe_u32 v5, v1, 4, 2
    v_lshl_or_b32 v88, v5, 11, v88
    s_bfe_u32 s71, s58, 0x20000
    s_lshl_b32 s71, s71, 6
    s_bfe_u32 s72, s58, 0x10002
    s_lshl_b32 s72, s72, 16
    s_or_b32 s71, s71, s72
    s_bfe_u32 s72, s58, 0x10002
    s_lshl_b32 s72, s72, 5
    s_or_b32 s71, s71, s72
    v_xor_b32 v88, s71, v88
    v_xor_b32 v89, 32, v88
    v_lshl_add_u32 v96, v1, 4, s70
    s_lshl_b32 s71, s75, 16
    s_add_u32 s81, s81, s71
    s_bfe_u32 s68, s57, 0x10000
    s_lshl_b32 s68, s68, 9
    s_mov_b32 s2, 2048
    s_mov_b32 s3, 65536
    s_mov_b32 s4, 262144
    s_mov_b32 s5, 1
    s_lshl_b32 s71, s58, 2
    s_bfe_u32 s72, s71, 0x30000
    s_bfe_u32 s73, s71, 0x10003
    s_lshl_b32 s73, s73, 4
    s_or_b32 s72, s72, s73
    s_bfe_u32 s73, s71, 0x10004
    s_lshl_b32 s73, s73, 3
    s_or_b32 s72, s72, s73
    s_mul_i32 s72, s72, s2
    v_mov_b32 v4, s72
    s_and_b32 s71, s71, 12
    v_xor_b32 v5, s71, v1
    v_bfe_u32 v84, v5, 0, 5
    v_lshlrev_b32 v84, 4, v84
    v_bfe_u32 v6, v5, 5, 1
    v_lshl_or_b32 v84, v6, 10, v84
    s_sub_u32 s72, s2, 1024
    v_add_u32 v84, v84, v4
    v_xor_b32 v85, 16, v84
    v_add_u32 v85, s72, v85
    v_xor_b32 v86, 48, v85
    v_add_u32 v86, s72, v86
    v_xor_b32 v87, 16, v86
    v_add_u32 v87, s72, v87
    s_xor_b32 s69, s68, 512
    s_lshl_b32 s70, s58, 12
    s_waitcnt vmcnt(17)
    s_barrier
    ds_read_b64_tr_b16 v[128:129], v88 offset:0
    ds_read_b64_tr_b16 v[130:131], v88 offset:1024
    ds_read_b64_tr_b16 v[132:133], v89 offset:0
    ds_read_b64_tr_b16 v[134:135], v89 offset:1024
    ds_read_b64_tr_b16 v[136:137], v88 offset:8192
    ds_read_b64_tr_b16 v[138:139], v88 offset:9216
    ds_read_b64_tr_b16 v[140:141], v89 offset:8192
    ds_read_b64_tr_b16 v[142:143], v89 offset:9216
    s_waitcnt lgkmcnt(4)
    ds_read_b64_tr_b16 v[144:145], v88 offset:16384
    ds_read_b64_tr_b16 v[146:147], v88 offset:17408
    ds_read_b64_tr_b16 v[148:149], v89 offset:16384
    ds_read_b64_tr_b16 v[150:151], v89 offset:17408
    ds_read_b64_tr_b16 v[152:153], v88 offset:24576
    ds_read_b64_tr_b16 v[154:155], v88 offset:25600
    ds_read_b64_tr_b16 v[156:157], v89 offset:24576
    ds_read_b64_tr_b16 v[158:159], v89 offset:25600
    s_waitcnt lgkmcnt(4)
    ds_read_b64_tr_b16 v[160:161], v88 offset:32768
    ds_read_b64_tr_b16 v[162:163], v88 offset:33792
    ds_read_b64_tr_b16 v[164:165], v89 offset:32768
    ds_read_b64_tr_b16 v[166:167], v89 offset:33792
    ds_read_b64_tr_b16 v[168:169], v88 offset:40960
    ds_read_b64_tr_b16 v[170:171], v88 offset:41984
    ds_read_b64_tr_b16 v[172:173], v89 offset:40960
    ds_read_b64_tr_b16 v[174:175], v89 offset:41984
    s_waitcnt lgkmcnt(4)
    ds_read_b64_tr_b16 v[176:177], v88 offset:49152
    ds_read_b64_tr_b16 v[178:179], v88 offset:50176
    ds_read_b64_tr_b16 v[180:181], v89 offset:49152
    ds_read_b64_tr_b16 v[182:183], v89 offset:50176
    ds_read_b64_tr_b16 v[184:185], v88 offset:57344
    ds_read_b64_tr_b16 v[186:187], v88 offset:58368
    ds_read_b64_tr_b16 v[188:189], v89 offset:57344
    ds_read_b64_tr_b16 v[190:191], v89 offset:58368
    s_waitcnt lgkmcnt(0)
    s_barrier
    buffer_load_dwordx4 v[20:23], v84, s[60:63], s68 offen offset:0
    buffer_load_dwordx4 v[24:27], v85, s[60:63], s68 offen offset:1024
    buffer_load_dwordx4 v[28:31], v86, s[60:63], s68 offen offset:2048
    buffer_load_dwordx4 v[32:35], v87, s[60:63], s68 offen offset:3072
    s_add_u32 s68, s68, s3
    buffer_load_dwordx4 v[36:39], v84, s[60:63], s69 offen offset:0
    buffer_load_dwordx4 v[40:43], v85, s[60:63], s69 offen offset:1024
    buffer_load_dwordx4 v[44:47], v86, s[60:63], s69 offen offset:2048
    buffer_load_dwordx4 v[48:51], v87, s[60:63], s69 offen offset:3072
    s_add_u32 s69, s69, s3
    buffer_load_dwordx4 v[52:55], v84, s[60:63], s68 offen offset:0
    buffer_load_dwordx4 v[56:59], v85, s[60:63], s68 offen offset:1024
    buffer_load_dwordx4 v[60:63], v86, s[60:63], s68 offen offset:2048
    buffer_load_dwordx4 v[64:67], v87, s[60:63], s68 offen offset:3072
    s_add_u32 s68, s68, s3
    s_waitcnt vmcnt(28)
    ds_write_b128 v96, v[192:195] offset:0
    s_waitcnt vmcnt(27)
    ds_write_b128 v96, v[196:199] offset:1024
    s_waitcnt vmcnt(26)
    ds_write_b128 v96, v[200:203] offset:2048
    s_waitcnt vmcnt(25)
    ds_write_b128 v96, v[204:207] offset:3072
    s_waitcnt vmcnt(24)
    ds_write_b128 v96, v[208:211] offset:4096
    s_waitcnt vmcnt(23)
    ds_write_b128 v96, v[212:215] offset:5120
    s_waitcnt vmcnt(22)
    ds_write_b128 v96, v[216:219] offset:6144
    s_waitcnt vmcnt(21)
    ds_write_b128 v96, v[220:223] offset:7168
    s_waitcnt vmcnt(20)
    ds_write_b128 v96, v[224:227] offset:8192
    s_waitcnt vmcnt(19)
    ds_write_b128 v96, v[228:231] offset:9216
    s_waitcnt vmcnt(18)
    ds_write_b128 v96, v[232:235] offset:10240
    s_waitcnt vmcnt(17)
    ds_write_b128 v96, v[236:239] offset:11264
    s_waitcnt vmcnt(16)
    ds_write_b128 v96, v[240:243] offset:12288
    s_waitcnt vmcnt(15)
    ds_write_b128 v96, v[244:247] offset:13312
    s_waitcnt vmcnt(14)
    ds_write_b128 v96, v[248:251] offset:14336
    s_waitcnt vmcnt(13)
    ds_write_b128 v96, v[252:255] offset:15360
    s_waitcnt lgkmcnt(0)
    s_barrier
    ds_read_b64_tr_b16 v[192:193], v88 offset:0
    ds_read_b64_tr_b16 v[194:195], v88 offset:1024
    ds_read_b64_tr_b16 v[196:197], v89 offset:0
    ds_read_b64_tr_b16 v[198:199], v89 offset:1024
    ds_read_b64_tr_b16 v[200:201], v88 offset:8192
    ds_read_b64_tr_b16 v[202:203], v88 offset:9216
    ds_read_b64_tr_b16 v[204:205], v89 offset:8192
    ds_read_b64_tr_b16 v[206:207], v89 offset:9216
    s_waitcnt lgkmcnt(4)
    ds_read_b64_tr_b16 v[208:209], v88 offset:16384
    ds_read_b64_tr_b16 v[210:211], v88 offset:17408
    ds_read_b64_tr_b16 v[212:213], v89 offset:16384
    ds_read_b64_tr_b16 v[214:215], v89 offset:17408
    ds_read_b64_tr_b16 v[216:217], v88 offset:24576
    ds_read_b64_tr_b16 v[218:219], v88 offset:25600
    ds_read_b64_tr_b16 v[220:221], v89 offset:24576
    ds_read_b64_tr_b16 v[222:223], v89 offset:25600
    s_waitcnt lgkmcnt(4)
    ds_read_b64_tr_b16 v[224:225], v88 offset:32768
    ds_read_b64_tr_b16 v[226:227], v88 offset:33792
    ds_read_b64_tr_b16 v[228:229], v89 offset:32768
    ds_read_b64_tr_b16 v[230:231], v89 offset:33792
    ds_read_b64_tr_b16 v[232:233], v88 offset:40960
    ds_read_b64_tr_b16 v[234:235], v88 offset:41984
    ds_read_b64_tr_b16 v[236:237], v89 offset:40960
    ds_read_b64_tr_b16 v[238:239], v89 offset:41984
    s_waitcnt lgkmcnt(4)
    ds_read_b64_tr_b16 v[240:241], v88 offset:49152
    ds_read_b64_tr_b16 v[242:243], v88 offset:50176
    ds_read_b64_tr_b16 v[244:245], v89 offset:49152
    ds_read_b64_tr_b16 v[246:247], v89 offset:50176
    ds_read_b64_tr_b16 v[248:249], v88 offset:57344
    ds_read_b64_tr_b16 v[250:251], v88 offset:58368
    ds_read_b64_tr_b16 v[252:253], v89 offset:57344
    ds_read_b64_tr_b16 v[254:255], v89 offset:58368
    s_waitcnt lgkmcnt(0)
    s_barrier
    v_lshl_add_u32 v96, v1, 4, s70
    v_add_u32 v97, 0x10000, v96
    s_waitcnt vmcnt(11)
    ds_write_b128 v96, v[20:23] offset:0
    s_waitcnt vmcnt(10)
    ds_write_b128 v96, v[24:27] offset:1024
    s_waitcnt vmcnt(9)
    ds_write_b128 v96, v[28:31] offset:2048
    s_waitcnt vmcnt(8)
    ds_write_b128 v96, v[32:35] offset:3072
    s_waitcnt vmcnt(7)
    ds_write_b128 v96, v[36:39] offset:32768
    s_waitcnt vmcnt(6)
    ds_write_b128 v96, v[40:43] offset:33792
    s_waitcnt vmcnt(5)
    ds_write_b128 v96, v[44:47] offset:34816
    s_waitcnt vmcnt(4)
    ds_write_b128 v96, v[48:51] offset:35840
    s_waitcnt vmcnt(3)
    ds_write_b128 v97, v[52:55] offset:0
    s_waitcnt vmcnt(2)
    ds_write_b128 v97, v[56:59] offset:1024
    s_waitcnt vmcnt(1)
    ds_write_b128 v97, v[60:63] offset:2048
    s_waitcnt vmcnt(0)
    ds_write_b128 v97, v[64:67] offset:3072
    buffer_load_dword v99, off, s[12:15], s70 offset:32 sc1
    s_branch sgo_78
gen_63:
    s_mov_b32 s2, 131072
    s_mov_b32 s3, 2048
    s_mov_b32 s4, 65536
    s_mov_b32 s5, 7
    s_lshl_b32 s71, s75, 20
    s_add_u32 s81, s81, s71
    s_bfe_u32 s68, s57, 0x10000
    s_lshl_b32 s68, s68, 9
    s_lshl_b32 s71, s75, 15
    s_add_u32 s68, s68, s71
    s_bfe_u32 s71, s57, 0x30000
    s_lshl_b32 s71, s71, 7
    s_bfe_u32 s72, s58, 0x20000
    s_lshl_b32 s72, s72, 5
    s_bfe_u32 s73, s58, 0x10002
    s_lshl_b32 s73, s73, 4
    s_or_b32 s72, s72, s73
    s_or_b32 s71, s71, s72
    v_and_or_b32 v4, v1, 15, s71
    v_mov_b32 v6, 1024
    v_cmp_eq_u32 vcc, 1, v4
    s_nop 1
    v_cndmask_b32 v5, v4, v6, vcc
    v_and_b32 v54, 1, v5
    v_lshrrev_b32 v5, 1, v5
    v_cvt_f32_u32 v54, v54
    v_cvt_f32_u32 v5, v5
    v_mul_f32 v54, 0x3e800000, v54
    v_mul_f32 v52, 0x3a800000, v5
    v_xor_b32 v4, 16, v4
    v_cmp_eq_u32 vcc, 1, v4
    s_nop 1
    v_cndmask_b32 v5, v4, v6, vcc
    v_and_b32 v55, 1, v5
    v_lshrrev_b32 v5, 1, v5
    v_cvt_f32_u32 v55, v55
    v_cvt_f32_u32 v5, v5
    v_mul_f32 v55, 0x3e800000, v55
    v_mul_f32 v53, 0x3a800000, v5
    v_xor_b32 v4, 16, v4
    v_bfe_u32 v4, v1, 4, 2
    v_lshlrev_b32 v4, 3, v4
    s_bfe_u32 s71, s58, 0x10002
    s_lshl_b32 s71, s71, 9
    s_bfe_u32 s72, s57, 0x10000
    s_lshl_b32 s72, s72, 8
    s_or_b32 s71, s71, s72
    v_or_b32 v4, s71, v4
    v_cvt_f32_u32 v56, v4
    v_xor_b32 v4, 0x100, v4
    v_fma_f32 v60, v52, v56, v54
    v_fract_f32 v60, v60
    v_add_f32 v61, v60, v52
    v_add_f32 v62, v61, v52
    v_add_f32 v63, v62, v52
    v_add_f32 v64, v63, v52
    v_add_f32 v65, v64, v52
    v_add_f32 v66, v65, v52
    v_add_f32 v67, v66, v52
    v_cos_f32 v60, v60
    v_cos_f32 v61, v61
    v_cos_f32 v62, v62
    v_cos_f32 v63, v63
    v_cos_f32 v64, v64
    v_cos_f32 v65, v65
    v_cos_f32 v66, v66
    v_cos_f32 v67, v67
    v_cvt_pk_bf16_f32 v128, v60, v61
    v_cvt_pk_bf16_f32 v129, v62, v63
    v_cvt_pk_bf16_f32 v130, v64, v65
    v_cvt_pk_bf16_f32 v131, v66, v67
    v_fma_f32 v68, v53, v56, v55
    v_fract_f32 v68, v68
    v_add_f32 v69, v68, v53
    v_add_f32 v70, v69, v53
    v_add_f32 v71, v70, v53
    v_add_f32 v72, v71, v53
    v_add_f32 v73, v72, v53
    v_add_f32 v74, v73, v53
    v_add_f32 v75, v74, v53
    v_cos_f32 v68, v68
    v_cos_f32 v69, v69
    v_cos_f32 v70, v70
    v_cos_f32 v71, v71
    v_cos_f32 v72, v72
    v_cos_f32 v73, v73
    v_cos_f32 v74, v74
    v_cos_f32 v75, v75
    v_cvt_pk_bf16_f32 v132, v68, v69
    v_cvt_pk_bf16_f32 v133, v70, v71
    v_cvt_pk_bf16_f32 v134, v72, v73
    v_cvt_pk_bf16_f32 v135, v74, v75
    v_add_f32 v56, 0x42000000, v56
    v_fma_f32 v60, v52, v56, v54
    v_fract_f32 v60, v60
    v_add_f32 v61, v60, v52
    v_add_f32 v62, v61, v52
    v_add_f32 v63, v62, v52
    v_add_f32 v64, v63, v52
    v_add_f32 v65, v64, v52
    v_add_f32 v66, v65, v52
    v_add_f32 v67, v66, v52
    v_cos_f32 v60, v60
    v_cos_f32 v61, v61
    v_cos_f32 v62, v62
    v_cos_f32 v63, v63
    v_cos_f32 v64, v64
    v_cos_f32 v65, v65
    v_cos_f32 v66, v66
    v_cos_f32 v67, v67
    v_cvt_pk_bf16_f32 v136, v60, v61
    v_cvt_pk_bf16_f32 v137, v62, v63
    v_cvt_pk_bf16_f32 v138, v64, v65
    v_cvt_pk_bf16_f32 v139, v66, v67
    v_fma_f32 v68, v53, v56, v55
    v_fract_f32 v68, v68
    v_add_f32 v69, v68, v53
    v_add_f32 v70, v69, v53
    v_add_f32 v71, v70, v53
    v_add_f32 v72, v71, v53
    v_add_f32 v73, v72, v53
    v_add_f32 v74, v73, v53
    v_add_f32 v75, v74, v53
    v_cos_f32 v68, v68
    v_cos_f32 v69, v69
    v_cos_f32 v70, v70
    v_cos_f32 v71, v71
    v_cos_f32 v72, v72
    v_cos_f32 v73, v73
    v_cos_f32 v74, v74
    v_cos_f32 v75, v75
    v_cvt_pk_bf16_f32 v140, v68, v69
    v_cvt_pk_bf16_f32 v141, v70, v71
    v_cvt_pk_bf16_f32 v142, v72, v73
    v_cvt_pk_bf16_f32 v143, v74, v75
    v_add_f32 v56, 0x42000000, v56
    v_fma_f32 v60, v52, v56, v54
    v_fract_f32 v60, v60
    v_add_f32 v61, v60, v52
    v_add_f32 v62, v61, v52
    v_add_f32 v63, v62, v52
    v_add_f32 v64, v63, v52
    v_add_f32 v65, v64, v52
    v_add_f32 v66, v65, v52
    v_add_f32 v67, v66, v52
    v_cos_f32 v60, v60
    v_cos_f32 v61, v61
    v_cos_f32 v62, v62
    v_cos_f32 v63, v63
    v_cos_f32 v64, v64
    v_cos_f32 v65, v65
    v_cos_f32 v66, v66
    v_cos_f32 v67, v67
    v_cvt_pk_bf16_f32 v144, v60, v61
    v_cvt_pk_bf16_f32 v145, v62, v63
    v_cvt_pk_bf16_f32 v146, v64, v65
    v_cvt_pk_bf16_f32 v147, v66, v67
    v_fma_f32 v68, v53, v56, v55
    v_fract_f32 v68, v68
    v_add_f32 v69, v68, v53
    v_add_f32 v70, v69, v53
    v_add_f32 v71, v70, v53
    v_add_f32 v72, v71, v53
    v_add_f32 v73, v72, v53
    v_add_f32 v74, v73, v53
    v_add_f32 v75, v74, v53
    v_cos_f32 v68, v68
    v_cos_f32 v69, v69
    v_cos_f32 v70, v70
    v_cos_f32 v71, v71
    v_cos_f32 v72, v72
    v_cos_f32 v73, v73
    v_cos_f32 v74, v74
    v_cos_f32 v75, v75
    v_cvt_pk_bf16_f32 v148, v68, v69
    v_cvt_pk_bf16_f32 v149, v70, v71
    v_cvt_pk_bf16_f32 v150, v72, v73
    v_cvt_pk_bf16_f32 v151, v74, v75
    v_add_f32 v56, 0x42000000, v56
    v_fma_f32 v60, v52, v56, v54
    v_fract_f32 v60, v60
    v_add_f32 v61, v60, v52
    v_add_f32 v62, v61, v52
    v_add_f32 v63, v62, v52
    v_add_f32 v64, v63, v52
    v_add_f32 v65, v64, v52
    v_add_f32 v66, v65, v52
    v_add_f32 v67, v66, v52
    v_cos_f32 v60, v60
    v_cos_f32 v61, v61
    v_cos_f32 v62, v62
    v_cos_f32 v63, v63
    v_cos_f32 v64, v64
    v_cos_f32 v65, v65
    v_cos_f32 v66, v66
    v_cos_f32 v67, v67
    v_cvt_pk_bf16_f32 v152, v60, v61
    v_cvt_pk_bf16_f32 v153, v62, v63
    v_cvt_pk_bf16_f32 v154, v64, v65
    v_cvt_pk_bf16_f32 v155, v66, v67
    v_fma_f32 v68, v53, v56, v55
    v_fract_f32 v68, v68
    v_add_f32 v69, v68, v53
    v_add_f32 v70, v69, v53
    v_add_f32 v71, v70, v53
    v_add_f32 v72, v71, v53
    v_add_f32 v73, v72, v53
    v_add_f32 v74, v73, v53
    v_add_f32 v75, v74, v53
    v_cos_f32 v68, v68
    v_cos_f32 v69, v69
    v_cos_f32 v70, v70
    v_cos_f32 v71, v71
    v_cos_f32 v72, v72
    v_cos_f32 v73, v73
    v_cos_f32 v74, v74
    v_cos_f32 v75, v75
    v_cvt_pk_bf16_f32 v156, v68, v69
    v_cvt_pk_bf16_f32 v157, v70, v71
    v_cvt_pk_bf16_f32 v158, v72, v73
    v_cvt_pk_bf16_f32 v159, v74, v75
    v_add_f32 v56, 0x42000000, v56
    v_fma_f32 v60, v52, v56, v54
    v_fract_f32 v60, v60
    v_add_f32 v61, v60, v52
    v_add_f32 v62, v61, v52
    v_add_f32 v63, v62, v52
    v_add_f32 v64, v63, v52
    v_add_f32 v65, v64, v52
    v_add_f32 v66, v65, v52
    v_add_f32 v67, v66, v52
    v_cos_f32 v60, v60
    v_cos_f32 v61, v61
    v_cos_f32 v62, v62
    v_cos_f32 v63, v63
    v_cos_f32 v64, v64
    v_cos_f32 v65, v65
    v_cos_f32 v66, v66
    v_cos_f32 v67, v67
    v_cvt_pk_bf16_f32 v160, v60, v61
    v_cvt_pk_bf16_f32 v161, v62, v63
    v_cvt_pk_bf16_f32 v162, v64, v65
    v_cvt_pk_bf16_f32 v163, v66, v67
    v_fma_f32 v68, v53, v56, v55
    v_fract_f32 v68, v68
    v_add_f32 v69, v68, v53
    v_add_f32 v70, v69, v53
    v_add_f32 v71, v70, v53
    v_add_f32 v72, v71, v53
    v_add_f32 v73, v72, v53
    v_add_f32 v74, v73, v53
    v_add_f32 v75, v74, v53
    v_cos_f32 v68, v68
    v_cos_f32 v69, v69
    v_cos_f32 v70, v70
    v_cos_f32 v71, v71
    v_cos_f32 v72, v72
    v_cos_f32 v73, v73
    v_cos_f32 v74, v74
    v_cos_f32 v75, v75
    v_cvt_pk_bf16_f32 v164, v68, v69
    v_cvt_pk_bf16_f32 v165, v70, v71
    v_cvt_pk_bf16_f32 v166, v72, v73
    v_cvt_pk_bf16_f32 v167, v74, v75
    v_add_f32 v56, 0x42000000, v56
    v_fma_f32 v60, v52, v56, v54
    v_fract_f32 v60, v60
    v_add_f32 v61, v60, v52
    v_add_f32 v62, v61, v52
    v_add_f32 v63, v62, v52
    v_add_f32 v64, v63, v52
    v_add_f32 v65, v64, v52
    v_add_f32 v66, v65, v52
    v_add_f32 v67, v66, v52
    v_cos_f32 v60, v60
    v_cos_f32 v61, v61
    v_cos_f32 v62, v62
    v_cos_f32 v63, v63
    v_cos_f32 v64, v64
    v_cos_f32 v65, v65
    v_cos_f32 v66, v66
    v_cos_f32 v67, v67
    v_cvt_pk_bf16_f32 v168, v60, v61
    v_cvt_pk_bf16_f32 v169, v62, v63
    v_cvt_pk_bf16_f32 v170, v64, v65
    v_cvt_pk_bf16_f32 v171, v66, v67
    v_fma_f32 v68, v53, v56, v55
    v_fract_f32 v68, v68
    v_add_f32 v69, v68, v53
    v_add_f32 v70, v69, v53
    v_add_f32 v71, v70, v53
    v_add_f32 v72, v71, v53
    v_add_f32 v73, v72, v53
    v_add_f32 v74, v73, v53
    v_add_f32 v75, v74, v53
    v_cos_f32 v68, v68
    v_cos_f32 v69, v69
    v_cos_f32 v70, v70
    v_cos_f32 v71, v71
    v_cos_f32 v72, v72
    v_cos_f32 v73, v73
    v_cos_f32 v74, v74
    v_cos_f32 v75, v75
    v_cvt_pk_bf16_f32 v172, v68, v69
    v_cvt_pk_bf16_f32 v173, v70, v71
    v_cvt_pk_bf16_f32 v174, v72, v73
    v_cvt_pk_bf16_f32 v175, v74, v75
    v_add_f32 v56, 0x42000000, v56
    v_fma_f32 v60, v52, v56, v54
    v_fract_f32 v60, v60
    v_add_f32 v61, v60, v52
    v_add_f32 v62, v61, v52
    v_add_f32 v63, v62, v52
    v_add_f32 v64, v63, v52
    v_add_f32 v65, v64, v52
    v_add_f32 v66, v65, v52
    v_add_f32 v67, v66, v52
    v_cos_f32 v60, v60
    v_cos_f32 v61, v61
    v_cos_f32 v62, v62
    v_cos_f32 v63, v63
    v_cos_f32 v64, v64
    v_cos_f32 v65, v65
    v_cos_f32 v66, v66
    v_cos_f32 v67, v67
    v_cvt_pk_bf16_f32 v176, v60, v61
    v_cvt_pk_bf16_f32 v177, v62, v63
    v_cvt_pk_bf16_f32 v178, v64, v65
    v_cvt_pk_bf16_f32 v179, v66, v67
    v_fma_f32 v68, v53, v56, v55
    v_fract_f32 v68, v68
    v_add_f32 v69, v68, v53
    v_add_f32 v70, v69, v53
    v_add_f32 v71, v70, v53
    v_add_f32 v72, v71, v53
    v_add_f32 v73, v72, v53
    v_add_f32 v74, v73, v53
    v_add_f32 v75, v74, v53
    v_cos_f32 v68, v68
    v_cos_f32 v69, v69
    v_cos_f32 v70, v70
    v_cos_f32 v71, v71
    v_cos_f32 v72, v72
    v_cos_f32 v73, v73
    v_cos_f32 v74, v74
    v_cos_f32 v75, v75
    v_cvt_pk_bf16_f32 v180, v68, v69
    v_cvt_pk_bf16_f32 v181, v70, v71
    v_cvt_pk_bf16_f32 v182, v72, v73
    v_cvt_pk_bf16_f32 v183, v74, v75
    v_add_f32 v56, 0x42000000, v56
    v_fma_f32 v60, v52, v56, v54
    v_fract_f32 v60, v60
    v_add_f32 v61, v60, v52
    v_add_f32 v62, v61, v52
    v_add_f32 v63, v62, v52
    v_add_f32 v64, v63, v52
    v_add_f32 v65, v64, v52
    v_add_f32 v66, v65, v52
    v_add_f32 v67, v66, v52
    v_cos_f32 v60, v60
    v_cos_f32 v61, v61
    v_cos_f32 v62, v62
    v_cos_f32 v63, v63
    v_cos_f32 v64, v64
    v_cos_f32 v65, v65
    v_cos_f32 v66, v66
    v_cos_f32 v67, v67
    v_cvt_pk_bf16_f32 v184, v60, v61
    v_cvt_pk_bf16_f32 v185, v62, v63
    v_cvt_pk_bf16_f32 v186, v64, v65
    v_cvt_pk_bf16_f32 v187, v66, v67
    v_fma_f32 v68, v53, v56, v55
    v_fract_f32 v68, v68
    v_add_f32 v69, v68, v53
    v_add_f32 v70, v69, v53
    v_add_f32 v71, v70, v53
    v_add_f32 v72, v71, v53
    v_add_f32 v73, v72, v53
    v_add_f32 v74, v73, v53
    v_add_f32 v75, v74, v53
    v_cos_f32 v68, v68
    v_cos_f32 v69, v69
    v_cos_f32 v70, v70
    v_cos_f32 v71, v71
    v_cos_f32 v72, v72
    v_cos_f32 v73, v73
    v_cos_f32 v74, v74
    v_cos_f32 v75, v75
    v_cvt_pk_bf16_f32 v188, v68, v69
    v_cvt_pk_bf16_f32 v189, v70, v71
    v_cvt_pk_bf16_f32 v190, v72, v73
    v_cvt_pk_bf16_f32 v191, v74, v75
    v_cvt_f32_u32 v56, v4
    v_xor_b32 v4, 0x100, v4
    v_fma_f32 v60, v52, v56, v54
    v_fract_f32 v60, v60
    v_add_f32 v61, v60, v52
    v_add_f32 v62, v61, v52
    v_add_f32 v63, v62, v52
    v_add_f32 v64, v63, v52
    v_add_f32 v65, v64, v52
    v_add_f32 v66, v65, v52
    v_add_f32 v67, v66, v52
    v_cos_f32 v60, v60
    v_cos_f32 v61, v61
    v_cos_f32 v62, v62
    v_cos_f32 v63, v63
    v_cos_f32 v64, v64
    v_cos_f32 v65, v65
    v_cos_f32 v66, v66
    v_cos_f32 v67, v67
    v_cvt_pk_bf16_f32 v192, v60, v61
    v_cvt_pk_bf16_f32 v193, v62, v63
    v_cvt_pk_bf16_f32 v194, v64, v65
    v_cvt_pk_bf16_f32 v195, v66, v67
    v_fma_f32 v68, v53, v56, v55
    v_fract_f32 v68, v68
    v_add_f32 v69, v68, v53
    v_add_f32 v70, v69, v53
    v_add_f32 v71, v70, v53
    v_add_f32 v72, v71, v53
    v_add_f32 v73, v72, v53
    v_add_f32 v74, v73, v53
    v_add_f32 v75, v74, v53
    v_cos_f32 v68, v68
    v_cos_f32 v69, v69
    v_cos_f32 v70, v70
    v_cos_f32 v71, v71
    v_cos_f32 v72, v72
    v_cos_f32 v73, v73
    v_cos_f32 v74, v74
    v_cos_f32 v75, v75
    v_cvt_pk_bf16_f32 v196, v68, v69
    v_cvt_pk_bf16_f32 v197, v70, v71
    v_cvt_pk_bf16_f32 v198, v72, v73
    v_cvt_pk_bf16_f32 v199, v74, v75
    v_add_f32 v56, 0x42000000, v56
    v_fma_f32 v60, v52, v56, v54
    v_fract_f32 v60, v60
    v_add_f32 v61, v60, v52
    v_add_f32 v62, v61, v52
    v_add_f32 v63, v62, v52
    v_add_f32 v64, v63, v52
    v_add_f32 v65, v64, v52
    v_add_f32 v66, v65, v52
    v_add_f32 v67, v66, v52
    v_cos_f32 v60, v60
    v_cos_f32 v61, v61
    v_cos_f32 v62, v62
    v_cos_f32 v63, v63
    v_cos_f32 v64, v64
    v_cos_f32 v65, v65
    v_cos_f32 v66, v66
    v_cos_f32 v67, v67
    v_cvt_pk_bf16_f32 v200, v60, v61
    v_cvt_pk_bf16_f32 v201, v62, v63
    v_cvt_pk_bf16_f32 v202, v64, v65
    v_cvt_pk_bf16_f32 v203, v66, v67
    v_fma_f32 v68, v53, v56, v55
    v_fract_f32 v68, v68
    v_add_f32 v69, v68, v53
    v_add_f32 v70, v69, v53
    v_add_f32 v71, v70, v53
    v_add_f32 v72, v71, v53
    v_add_f32 v73, v72, v53
    v_add_f32 v74, v73, v53
    v_add_f32 v75, v74, v53
    v_cos_f32 v68, v68
    v_cos_f32 v69, v69
    v_cos_f32 v70, v70
    v_cos_f32 v71, v71
    v_cos_f32 v72, v72
    v_cos_f32 v73, v73
    v_cos_f32 v74, v74
    v_cos_f32 v75, v75
    v_cvt_pk_bf16_f32 v204, v68, v69
    v_cvt_pk_bf16_f32 v205, v70, v71
    v_cvt_pk_bf16_f32 v206, v72, v73
    v_cvt_pk_bf16_f32 v207, v74, v75
    v_add_f32 v56, 0x42000000, v56
    v_fma_f32 v60, v52, v56, v54
    v_fract_f32 v60, v60
    v_add_f32 v61, v60, v52
    v_add_f32 v62, v61, v52
    v_add_f32 v63, v62, v52
    v_add_f32 v64, v63, v52
    v_add_f32 v65, v64, v52
    v_add_f32 v66, v65, v52
    v_add_f32 v67, v66, v52
    v_cos_f32 v60, v60
    v_cos_f32 v61, v61
    v_cos_f32 v62, v62
    v_cos_f32 v63, v63
    v_cos_f32 v64, v64
    v_cos_f32 v65, v65
    v_cos_f32 v66, v66
    v_cos_f32 v67, v67
    v_cvt_pk_bf16_f32 v208, v60, v61
    v_cvt_pk_bf16_f32 v209, v62, v63
    v_cvt_pk_bf16_f32 v210, v64, v65
    v_cvt_pk_bf16_f32 v211, v66, v67
    v_fma_f32 v68, v53, v56, v55
    v_fract_f32 v68, v68
    v_add_f32 v69, v68, v53
    v_add_f32 v70, v69, v53
    v_add_f32 v71, v70, v53
    v_add_f32 v72, v71, v53
    v_add_f32 v73, v72, v53
    v_add_f32 v74, v73, v53
    v_add_f32 v75, v74, v53
    v_cos_f32 v68, v68
    v_cos_f32 v69, v69
    v_cos_f32 v70, v70
    v_cos_f32 v71, v71
    v_cos_f32 v72, v72
    v_cos_f32 v73, v73
    v_cos_f32 v74, v74
    v_cos_f32 v75, v75
    v_cvt_pk_bf16_f32 v212, v68, v69
    v_cvt_pk_bf16_f32 v213, v70, v71
    v_cvt_pk_bf16_f32 v214, v72, v73
    v_cvt_pk_bf16_f32 v215, v74, v75
    v_add_f32 v56, 0x42000000, v56
    v_fma_f32 v60, v52, v56, v54
    v_fract_f32 v60, v60
    v_add_f32 v61, v60, v52
    v_add_f32 v62, v61, v52
    v_add_f32 v63, v62, v52
    v_add_f32 v64, v63, v52
    v_add_f32 v65, v64, v52
    v_add_f32 v66, v65, v52
    v_add_f32 v67, v66, v52
    v_cos_f32 v60, v60
    v_cos_f32 v61, v61
    v_cos_f32 v62, v62
    v_cos_f32 v63, v63
    v_cos_f32 v64, v64
    v_cos_f32 v65, v65
    v_cos_f32 v66, v66
    v_cos_f32 v67, v67
    v_cvt_pk_bf16_f32 v216, v60, v61
    v_cvt_pk_bf16_f32 v217, v62, v63
    v_cvt_pk_bf16_f32 v218, v64, v65
    v_cvt_pk_bf16_f32 v219, v66, v67
    v_fma_f32 v68, v53, v56, v55
    v_fract_f32 v68, v68
    v_add_f32 v69, v68, v53
    v_add_f32 v70, v69, v53
    v_add_f32 v71, v70, v53
    v_add_f32 v72, v71, v53
    v_add_f32 v73, v72, v53
    v_add_f32 v74, v73, v53
    v_add_f32 v75, v74, v53
    v_cos_f32 v68, v68
    v_cos_f32 v69, v69
    v_cos_f32 v70, v70
    v_cos_f32 v71, v71
    v_cos_f32 v72, v72
    v_cos_f32 v73, v73
    v_cos_f32 v74, v74
    v_cos_f32 v75, v75
    v_cvt_pk_bf16_f32 v220, v68, v69
    v_cvt_pk_bf16_f32 v221, v70, v71
    v_cvt_pk_bf16_f32 v222, v72, v73
    v_cvt_pk_bf16_f32 v223, v74, v75
    v_add_f32 v56, 0x42000000, v56
    v_fma_f32 v60, v52, v56, v54
    v_fract_f32 v60, v60
    v_add_f32 v61, v60, v52
    v_add_f32 v62, v61, v52
    v_add_f32 v63, v62, v52
    v_add_f32 v64, v63, v52
    v_add_f32 v65, v64, v52
    v_add_f32 v66, v65, v52
    v_add_f32 v67, v66, v52
    v_cos_f32 v60, v60
    v_cos_f32 v61, v61
    v_cos_f32 v62, v62
    v_cos_f32 v63, v63
    v_cos_f32 v64, v64
    v_cos_f32 v65, v65
    v_cos_f32 v66, v66
    v_cos_f32 v67, v67
    v_cvt_pk_bf16_f32 v224, v60, v61
    v_cvt_pk_bf16_f32 v225, v62, v63
    v_cvt_pk_bf16_f32 v226, v64, v65
    v_cvt_pk_bf16_f32 v227, v66, v67
    v_fma_f32 v68, v53, v56, v55
    v_fract_f32 v68, v68
    v_add_f32 v69, v68, v53
    v_add_f32 v70, v69, v53
    v_add_f32 v71, v70, v53
    v_add_f32 v72, v71, v53
    v_add_f32 v73, v72, v53
    v_add_f32 v74, v73, v53
    v_add_f32 v75, v74, v53
    v_cos_f32 v68, v68
    v_cos_f32 v69, v69
    v_cos_f32 v70, v70
    v_cos_f32 v71, v71
    v_cos_f32 v72, v72
    v_cos_f32 v73, v73
    v_cos_f32 v74, v74
    v_cos_f32 v75, v75
    v_cvt_pk_bf16_f32 v228, v68, v69
    v_cvt_pk_bf16_f32 v229, v70, v71
    v_cvt_pk_bf16_f32 v230, v72, v73
    v_cvt_pk_bf16_f32 v231, v74, v75
    v_add_f32 v56, 0x42000000, v56
    v_fma_f32 v60, v52, v56, v54
    v_fract_f32 v60, v60
    v_add_f32 v61, v60, v52
    v_add_f32 v62, v61, v52
    v_add_f32 v63, v62, v52
    v_add_f32 v64, v63, v52
    v_add_f32 v65, v64, v52
    v_add_f32 v66, v65, v52
    v_add_f32 v67, v66, v52
    v_cos_f32 v60, v60
    v_cos_f32 v61, v61
    v_cos_f32 v62, v62
    v_cos_f32 v63, v63
    v_cos_f32 v64, v64
    v_cos_f32 v65, v65
    v_cos_f32 v66, v66
    v_cos_f32 v67, v67
    v_cvt_pk_bf16_f32 v232, v60, v61
    v_cvt_pk_bf16_f32 v233, v62, v63
    v_cvt_pk_bf16_f32 v234, v64, v65
    v_cvt_pk_bf16_f32 v235, v66, v67
    v_fma_f32 v68, v53, v56, v55
    v_fract_f32 v68, v68
    v_add_f32 v69, v68, v53
    v_add_f32 v70, v69, v53
    v_add_f32 v71, v70, v53
    v_add_f32 v72, v71, v53
    v_add_f32 v73, v72, v53
    v_add_f32 v74, v73, v53
    v_add_f32 v75, v74, v53
    v_cos_f32 v68, v68
    v_cos_f32 v69, v69
    v_cos_f32 v70, v70
    v_cos_f32 v71, v71
    v_cos_f32 v72, v72
    v_cos_f32 v73, v73
    v_cos_f32 v74, v74
    v_cos_f32 v75, v75
    v_cvt_pk_bf16_f32 v236, v68, v69
    v_cvt_pk_bf16_f32 v237, v70, v71
    v_cvt_pk_bf16_f32 v238, v72, v73
    v_cvt_pk_bf16_f32 v239, v74, v75
    v_add_f32 v56, 0x42000000, v56
    v_fma_f32 v60, v52, v56, v54
    v_fract_f32 v60, v60
    v_add_f32 v61, v60, v52
    v_add_f32 v62, v61, v52
    v_add_f32 v63, v62, v52
    v_add_f32 v64, v63, v52
    v_add_f32 v65, v64, v52
    v_add_f32 v66, v65, v52
    v_add_f32 v67, v66, v52
    v_cos_f32 v60, v60
    v_cos_f32 v61, v61
    v_cos_f32 v62, v62
    v_cos_f32 v63, v63
    v_cos_f32 v64, v64
    v_cos_f32 v65, v65
    v_cos_f32 v66, v66
    v_cos_f32 v67, v67
    v_cvt_pk_bf16_f32 v240, v60, v61
    v_cvt_pk_bf16_f32 v241, v62, v63
    v_cvt_pk_bf16_f32 v242, v64, v65
    v_cvt_pk_bf16_f32 v243, v66, v67
    v_fma_f32 v68, v53, v56, v55
    v_fract_f32 v68, v68
    v_add_f32 v69, v68, v53
    v_add_f32 v70, v69, v53
    v_add_f32 v71, v70, v53
    v_add_f32 v72, v71, v53
    v_add_f32 v73, v72, v53
    v_add_f32 v74, v73, v53
    v_add_f32 v75, v74, v53
    v_cos_f32 v68, v68
    v_cos_f32 v69, v69
    v_cos_f32 v70, v70
    v_cos_f32 v71, v71
    v_cos_f32 v72, v72
    v_cos_f32 v73, v73
    v_cos_f32 v74, v74
    v_cos_f32 v75, v75
    v_cvt_pk_bf16_f32 v244, v68, v69
    v_cvt_pk_bf16_f32 v245, v70, v71
    v_cvt_pk_bf16_f32 v246, v72, v73
    v_cvt_pk_bf16_f32 v247, v74, v75
    v_add_f32 v56, 0x42000000, v56
    v_fma_f32 v60, v52, v56, v54
    v_fract_f32 v60, v60
    v_add_f32 v61, v60, v52
    v_add_f32 v62, v61, v52
    v_add_f32 v63, v62, v52
    v_add_f32 v64, v63, v52
    v_add_f32 v65, v64, v52
    v_add_f32 v66, v65, v52
    v_add_f32 v67, v66, v52
    v_cos_f32 v60, v60
    v_cos_f32 v61, v61
    v_cos_f32 v62, v62
    v_cos_f32 v63, v63
    v_cos_f32 v64, v64
    v_cos_f32 v65, v65
    v_cos_f32 v66, v66
    v_cos_f32 v67, v67
    v_cvt_pk_bf16_f32 v248, v60, v61
    v_cvt_pk_bf16_f32 v249, v62, v63
    v_cvt_pk_bf16_f32 v250, v64, v65
    v_cvt_pk_bf16_f32 v251, v66, v67
    v_fma_f32 v68, v53, v56, v55
    v_fract_f32 v68, v68
    v_add_f32 v69, v68, v53
    v_add_f32 v70, v69, v53
    v_add_f32 v71, v70, v53
    v_add_f32 v72, v71, v53
    v_add_f32 v73, v72, v53
    v_add_f32 v74, v73, v53
    v_add_f32 v75, v74, v53
    v_cos_f32 v68, v68
    v_cos_f32 v69, v69
    v_cos_f32 v70, v70
    v_cos_f32 v71, v71
    v_cos_f32 v72, v72
    v_cos_f32 v73, v73
    v_cos_f32 v74, v74
    v_cos_f32 v75, v75
    v_cvt_pk_bf16_f32 v252, v68, v69
    v_cvt_pk_bf16_f32 v253, v70, v71
    v_cvt_pk_bf16_f32 v254, v72, v73
    v_cvt_pk_bf16_f32 v255, v74, v75
    s_lshl_b32 s71, s58, 2
    s_bfe_u32 s72, s71, 0x30000
    s_bfe_u32 s73, s71, 0x10003
    s_lshl_b32 s73, s73, 4
    s_or_b32 s72, s72, s73
    s_bfe_u32 s73, s71, 0x10004
    s_lshl_b32 s73, s73, 3
    s_or_b32 s72, s72, s73
    s_mul_i32 s72, s72, s2
    v_mov_b32 v4, s72
    s_and_b32 s71, s71, 12
    v_xor_b32 v5, s71, v1
    v_bfe_u32 v84, v5, 0, 5
    v_lshlrev_b32 v84, 4, v84
    v_bfe_u32 v6, v5, 5, 1
    v_lshl_or_b32 v84, v6, 10, v84
    s_sub_u32 s72, s2, 1024
    v_add_u32 v84, v84, v4
    v_xor_b32 v85, 16, v84
    v_add_u32 v85, s72, v85
    v_xor_b32 v86, 48, v85
    v_add_u32 v86, s72, v86
    v_xor_b32 v87, 16, v86
    v_add_u32 v87, s72, v87
    s_xor_b32 s69, s68, 512
    s_lshl_b32 s70, s58, 12
    s_add_u32 m0, s70, 0
    s_nop 0
    buffer_load_dwordx4 v84, s[60:63], s68 offen offset:0 lds
    buffer_load_dwordx4 v85, s[60:63], s68 offen offset:1024 lds
    buffer_load_dwordx4 v86, s[60:63], s68 offen offset:2048 lds
    buffer_load_dwordx4 v87, s[60:63], s68 offen offset:3072 lds
    s_add_u32 s68, s68, s3
    s_add_u32 m0, s70, 32768
    s_nop 0
    buffer_load_dwordx4 v84, s[60:63], s69 offen offset:0 lds
    buffer_load_dwordx4 v85, s[60:63], s69 offen offset:1024 lds
    buffer_load_dwordx4 v86, s[60:63], s69 offen offset:2048 lds
    buffer_load_dwordx4 v87, s[60:63], s69 offen offset:3072 lds
    s_add_u32 s69, s69, s3
    s_add_u32 m0, s70, 65536
    s_nop 0
    buffer_load_dwordx4 v84, s[60:63], s68 offen offset:0 lds
    buffer_load_dwordx4 v85, s[60:63], s68 offen offset:1024 lds
    buffer_load_dwordx4 v86, s[60:63], s68 offen offset:2048 lds
    buffer_load_dwordx4 v87, s[60:63], s68 offen offset:3072 lds
    s_add_u32 s68, s68, s3
sgo_78:
    v_lshrrev_b32 v4, 4, v1
    v_xor_b32 v4, v4, v1
    v_bfe_u32 v5, v4, 0, 4
    v_lshlrev_b32 v5, 4, v5
    v_bfe_u32 v4, v1, 0, 4
    v_lshlrev_b32 v4, 10, v4
    s_bfe_u32 s71, s58, 0x10002
    s_lshl_b32 s71, s71, 9
    v_or3_b32 v88, v4, v5, s71
    v_xor_b32 v89, 0x40, v88
    v_xor_b32 v90, 0x80, v88
    v_xor_b32 v91, 0xc0, v88
    v_xor_b32 v92, 0x10000, v88
    v_xor_b32 v93, 0x10040, v88
    v_xor_b32 v94, 0x10080, v88
    v_xor_b32 v95, 0x100c0, v88
    s_lshl_b32 s71, s58, 11
    s_or_b32 s71, s71, 131072
    v_lshl_add_u32 v96, v1, 4, s71
    v_xor_b32 v97, 0x2000, v96
    v_bfe_u32 v98, v1, 0, 4
    v_lshlrev_b32 v98, 4, v98
    v_bfe_u32 v4, v1, 4, 2
    v_lshl_or_b32 v98, v4, 9, v98
    s_bfe_u32 s71, s57, 0x30000
    s_lshl_b32 s71, s71, 13
    s_add_u32 s81, s81, s71
    s_bfe_u32 s71, s58, 0x20000
    s_lshl_b32 s71, s71, 11
    s_bfe_u32 s72, s58, 0x10002
    s_lshl_b32 s72, s72, 8
    s_or_b32 s71, s71, s72
    s_add_u32 s81, s81, s71
    s_mov_b32 s73, 0x5ffffff0
    s_mov_b32 s82, 0
    s_waitcnt vmcnt(8) lgkmcnt(0)
    s_barrier
    ds_read_b128 v[52:55], v88 offset:0
    ds_read_b128 v[56:59], v88 offset:16384
    ds_read_b128 v[60:63], v89 offset:0
    ds_read_b128 v[64:67], v89 offset:16384
    v_mov_b32 v100, 3
    v_cmp_gt_u32 vcc, s58, v100
stream_79:
    s_waitcnt lgkmcnt(2)
    v_mfma_f32_16x16x32_bf16 v[20:23], v[52:55], v[128:131], 0
    ds_read_b128 v[68:71], v90 offset:0
    v_mfma_f32_16x16x32_bf16 v[24:27], v[52:55], v[132:135], 0
    ds_read_b128 v[72:75], v90 offset:16384
    v_mfma_f32_16x16x32_bf16 v[28:31], v[56:59], v[128:131], 0
    s_add_u32 m0, s70, 98304
    s_nop 0
    buffer_load_dwordx4 v84, s[60:63], s69 offen offset:0 lds
    v_mfma_f32_16x16x32_bf16 v[32:35], v[56:59], v[132:135], 0
    s_waitcnt lgkmcnt(2)
    v_mfma_f32_16x16x32_bf16 v[20:23], v[60:63], v[136:139], v[20:23]
    ds_read_b128 v[76:79], v91 offset:0
    v_mfma_f32_16x16x32_bf16 v[24:27], v[60:63], v[140:143], v[24:27]
    ds_read_b128 v[80:83], v91 offset:16384
    v_mfma_f32_16x16x32_bf16 v[28:31], v[64:67], v[136:139], v[28:31]
    buffer_load_dwordx4 v85, s[60:63], s69 offen offset:1024 lds
    v_mfma_f32_16x16x32_bf16 v[32:35], v[64:67], v[140:143], v[32:35]
    ds_write_b128 v96, v[40:43] offset:0
    s_waitcnt lgkmcnt(3)
    v_mfma_f32_16x16x32_bf16 v[20:23], v[68:71], v[144:147], v[20:23]
    ds_read_b128 v[52:55], v88 offset:256
    v_mfma_f32_16x16x32_bf16 v[24:27], v[68:71], v[148:151], v[24:27]
    ds_read_b128 v[56:59], v88 offset:16640
    v_mfma_f32_16x16x32_bf16 v[28:31], v[72:75], v[144:147], v[28:31]
    buffer_load_dwordx4 v86, s[60:63], s69 offen offset:2048 lds
    v_mfma_f32_16x16x32_bf16 v[32:35], v[72:75], v[148:151], v[32:35]
    ds_write_b128 v96, v[48:51] offset:1024
    s_waitcnt lgkmcnt(4)
    v_mfma_f32_16x16x32_bf16 v[20:23], v[76:79], v[152:155], v[20:23]
    ds_read_b128 v[60:63], v89 offset:256
    v_mfma_f32_16x16x32_bf16 v[24:27], v[76:79], v[156:159], v[24:27]
    ds_read_b128 v[64:67], v89 offset:16640
    v_mfma_f32_16x16x32_bf16 v[28:31], v[80:83], v[152:155], v[28:31]
    buffer_load_dwordx4 v87, s[60:63], s69 offen offset:3072 lds
    s_add_u32 s69, s69, s3
    v_mfma_f32_16x16x32_bf16 v[32:35], v[80:83], v[156:159], v[32:35]
    s_waitcnt lgkmcnt(3)
    v_mfma_f32_16x16x32_bf16 v[20:23], v[52:55], v[160:163], v[20:23]
    ds_read_b128 v[68:71], v90 offset:256
    v_mfma_f32_16x16x32_bf16 v[24:27], v[52:55], v[164:167], v[24:27]
    ds_read_b128 v[72:75], v90 offset:16640
    v_mfma_f32_16x16x32_bf16 v[28:31], v[56:59], v[160:163], v[28:31]
    v_mfma_f32_16x16x32_bf16 v[32:35], v[56:59], v[164:167], v[32:35]
    s_waitcnt lgkmcnt(2)
    v_mfma_f32_16x16x32_bf16 v[20:23], v[60:63], v[168:171], v[20:23]
    ds_read_b128 v[76:79], v91 offset:256
    v_mfma_f32_16x16x32_bf16 v[24:27], v[60:63], v[172:175], v[24:27]
    ds_read_b128 v[80:83], v91 offset:16640
    v_mfma_f32_16x16x32_bf16 v[28:31], v[64:67], v[168:171], v[28:31]
    v_mfma_f32_16x16x32_bf16 v[32:35], v[64:67], v[172:175], v[32:35]
    s_waitcnt vmcnt(8) lgkmcnt(0)
    s_barrier
    v_mfma_f32_16x16x32_bf16 v[20:23], v[68:71], v[176:179], v[20:23]
    ds_read_b128 v[4:7], v97 offset:0
    ds_read_b128 v[8:11], v97 offset:1024
    ds_read_b128 v[52:55], v88 offset:32768
    v_mfma_f32_16x16x32_bf16 v[24:27], v[68:71], v[180:183], v[24:27]
    ds_read_b128 v[56:59], v88 offset:49152
    v_mfma_f32_16x16x32_bf16 v[28:31], v[72:75], v[176:179], v[28:31]
    v_mfma_f32_16x16x32_bf16 v[32:35], v[72:75], v[180:183], v[32:35]
    s_waitcnt lgkmcnt(2)
    v_mfma_f32_16x16x32_bf16 v[20:23], v[76:79], v[184:187], v[20:23]
    v_add_f32 v4, v4, v36
    v_add_f32 v5, v5, v37
    v_add_f32 v6, v6, v38
    v_add_f32 v7, v7, v39
    ds_read_b128 v[60:63], v89 offset:32768
    v_mfma_f32_16x16x32_bf16 v[24:27], v[76:79], v[188:191], v[24:27]
    v_cvt_pk_bf16_f32 v12, v4, v5
    v_cvt_pk_bf16_f32 v13, v6, v7
    ds_read_b128 v[64:67], v89 offset:49152
    v_mfma_f32_16x16x32_bf16 v[28:31], v[80:83], v[184:187], v[28:31]
    v_add_f32 v8, v8, v44
    v_add_f32 v9, v9, v45
    v_add_f32 v10, v10, v46
    v_add_f32 v11, v11, v47
    v_mfma_f32_16x16x32_bf16 v[32:35], v[80:83], v[188:191], v[32:35]
    v_cvt_pk_bf16_f32 v14, v8, v9
    v_cvt_pk_bf16_f32 v15, v10, v11
    buffer_store_dwordx4 v[12:15], v98, s[8:11], s73 offen sc1
    s_mov_b32 s73, s81
    s_add_u32 s81, s81, s4
    s_waitcnt lgkmcnt(2)
    v_mfma_f32_16x16x32_bf16 v[20:23], v[52:55], v[192:195], v[20:23]
    ds_read_b128 v[68:71], v90 offset:32768
    v_mfma_f32_16x16x32_bf16 v[24:27], v[52:55], v[196:199], v[24:27]
    ds_read_b128 v[72:75], v90 offset:49152
    v_mfma_f32_16x16x32_bf16 v[28:31], v[56:59], v[192:195], v[28:31]
    s_add_u32 m0, s70, 0
    s_nop 0
    buffer_load_dwordx4 v84, s[60:63], s68 offen offset:0 lds
    v_mfma_f32_16x16x32_bf16 v[32:35], v[56:59], v[196:199], v[32:35]
    s_waitcnt lgkmcnt(2)
    v_mfma_f32_16x16x32_bf16 v[20:23], v[60:63], v[200:203], v[20:23]
    ds_read_b128 v[76:79], v91 offset:32768
    v_mfma_f32_16x16x32_bf16 v[24:27], v[60:63], v[204:207], v[24:27]
    ds_read_b128 v[80:83], v91 offset:49152
    v_mfma_f32_16x16x32_bf16 v[28:31], v[64:67], v[200:203], v[28:31]
    buffer_load_dwordx4 v85, s[60:63], s68 offen offset:1024 lds
    v_mfma_f32_16x16x32_bf16 v[32:35], v[64:67], v[204:207], v[32:35]
    s_waitcnt lgkmcnt(2)
    v_mfma_f32_16x16x32_bf16 v[20:23], v[68:71], v[208:211], v[20:23]
    ds_read_b128 v[52:55], v88 offset:33024
    v_mfma_f32_16x16x32_bf16 v[24:27], v[68:71], v[212:215], v[24:27]
    ds_read_b128 v[56:59], v88 offset:49408
    v_mfma_f32_16x16x32_bf16 v[28:31], v[72:75], v[208:211], v[28:31]
    buffer_load_dwordx4 v86, s[60:63], s68 offen offset:2048 lds
    v_mfma_f32_16x16x32_bf16 v[32:35], v[72:75], v[212:215], v[32:35]
    s_waitcnt lgkmcnt(2)
    v_mfma_f32_16x16x32_bf16 v[20:23], v[76:79], v[216:219], v[20:23]
    ds_read_b128 v[60:63], v89 offset:33024
    v_mfma_f32_16x16x32_bf16 v[24:27], v[76:79], v[220:223], v[24:27]
    ds_read_b128 v[64:67], v89 offset:49408
    v_mfma_f32_16x16x32_bf16 v[28:31], v[80:83], v[216:219], v[28:31]
    buffer_load_dwordx4 v87, s[60:63], s68 offen offset:3072 lds
    s_add_u32 s68, s68, s3
    v_mfma_f32_16x16x32_bf16 v[32:35], v[80:83], v[220:223], v[32:35]
    s_waitcnt lgkmcnt(2)
    v_mfma_f32_16x16x32_bf16 v[20:23], v[52:55], v[224:227], v[20:23]
    ds_read_b128 v[68:71], v90 offset:33024
    v_mfma_f32_16x16x32_bf16 v[24:27], v[52:55], v[228:231], v[24:27]
    ds_read_b128 v[72:75], v90 offset:49408
    v_mfma_f32_16x16x32_bf16 v[28:31], v[56:59], v[224:227], v[28:31]
    v_mfma_f32_16x16x32_bf16 v[32:35], v[56:59], v[228:231], v[32:35]
    s_waitcnt lgkmcnt(2)
    v_mfma_f32_16x16x32_bf16 v[20:23], v[60:63], v[232:235], v[20:23]
    ds_read_b128 v[76:79], v91 offset:33024
    v_mfma_f32_16x16x32_bf16 v[24:27], v[60:63], v[236:239], v[24:27]
    ds_read_b128 v[80:83], v91 offset:49408
    v_mfma_f32_16x16x32_bf16 v[28:31], v[64:67], v[232:235], v[28:31]
    v_mfma_f32_16x16x32_bf16 v[32:35], v[64:67], v[236:239], v[32:35]
    s_bitcmp1_b64 s[6:7], s82
    s_cbranch_scc1 ssig_58
    s_waitcnt vmcnt(8) lgkmcnt(0)
    s_barrier
srett_60:
    s_add_u32 s82, s82, 1
    v_mfma_f32_16x16x32_bf16 v[20:23], v[68:71], v[240:243], v[20:23]
    ds_read_b128 v[52:55], v92 offset:0
    v_mfma_f32_16x16x32_bf16 v[24:27], v[68:71], v[244:247], v[24:27]
    ds_read_b128 v[56:59], v92 offset:16384
    v_mfma_f32_16x16x32_bf16 v[28:31], v[72:75], v[240:243], v[28:31]
    v_mfma_f32_16x16x32_bf16 v[32:35], v[72:75], v[244:247], v[32:35]
    v_mfma_f32_16x16x32_bf16 v[20:23], v[76:79], v[248:251], v[20:23]
    ds_read_b128 v[60:63], v93 offset:0
    v_mfma_f32_16x16x32_bf16 v[24:27], v[76:79], v[252:255], v[24:27]
    ds_read_b128 v[64:67], v93 offset:16384
    v_mfma_f32_16x16x32_bf16 v[28:31], v[80:83], v[248:251], v[28:31]
    v_mfma_f32_16x16x32_bf16 v[32:35], v[80:83], v[252:255], v[32:35]
    s_waitcnt lgkmcnt(2)
    v_mfma_f32_16x16x32_bf16 v[36:39], v[52:55], v[128:131], 0
    ds_read_b128 v[68:71], v94 offset:0
    v_mfma_f32_16x16x32_bf16 v[40:43], v[52:55], v[132:135], 0
    ds_read_b128 v[72:75], v94 offset:16384
    v_mfma_f32_16x16x32_bf16 v[44:47], v[56:59], v[128:131], 0
    s_add_u32 m0, s70, 32768
    s_nop 0
    buffer_load_dwordx4 v84, s[60:63], s69 offen offset:0 lds
    v_mfma_f32_16x16x32_bf16 v[48:51], v[56:59], v[132:135], 0
    s_waitcnt lgkmcnt(2)
    v_mfma_f32_16x16x32_bf16 v[36:39], v[60:63], v[136:139], v[36:39]
    ds_read_b128 v[76:79], v95 offset:0
    v_mfma_f32_16x16x32_bf16 v[40:43], v[60:63], v[140:143], v[40:43]
    ds_read_b128 v[80:83], v95 offset:16384
    v_mfma_f32_16x16x32_bf16 v[44:47], v[64:67], v[136:139], v[44:47]
    buffer_load_dwordx4 v85, s[60:63], s69 offen offset:1024 lds
    v_mfma_f32_16x16x32_bf16 v[48:51], v[64:67], v[140:143], v[48:51]
    ds_write_b128 v96, v[24:27] offset:0
    s_waitcnt lgkmcnt(3)
    v_mfma_f32_16x16x32_bf16 v[36:39], v[68:71], v[144:147], v[36:39]
    ds_read_b128 v[52:55], v92 offset:256
    v_mfma_f32_16x16x32_bf16 v[40:43], v[68:71], v[148:151], v[40:43]
    ds_read_b128 v[56:59], v92 offset:16640
    v_mfma_f32_16x16x32_bf16 v[44:47], v[72:75], v[144:147], v[44:47]
    buffer_load_dwordx4 v86, s[60:63], s69 offen offset:2048 lds
    v_mfma_f32_16x16x32_bf16 v[48:51], v[72:75], v[148:151], v[48:51]
    ds_write_b128 v96, v[32:35] offset:1024
    s_waitcnt lgkmcnt(4)
    v_mfma_f32_16x16x32_bf16 v[36:39], v[76:79], v[152:155], v[36:39]
    ds_read_b128 v[60:63], v93 offset:256
    v_mfma_f32_16x16x32_bf16 v[40:43], v[76:79], v[156:159], v[40:43]
    ds_read_b128 v[64:67], v93 offset:16640
    v_mfma_f32_16x16x32_bf16 v[44:47], v[80:83], v[152:155], v[44:47]
    buffer_load_dwordx4 v87, s[60:63], s69 offen offset:3072 lds
    s_add_u32 s69, s69, s3
    v_mfma_f32_16x16x32_bf16 v[48:51], v[80:83], v[156:159], v[48:51]
    s_waitcnt lgkmcnt(3)
    v_mfma_f32_16x16x32_bf16 v[36:39], v[52:55], v[160:163], v[36:39]
    ds_read_b128 v[68:71], v94 offset:256
    v_mfma_f32_16x16x32_bf16 v[40:43], v[52:55], v[164:167], v[40:43]
    ds_read_b128 v[72:75], v94 offset:16640
    v_mfma_f32_16x16x32_bf16 v[44:47], v[56:59], v[160:163], v[44:47]
    v_mfma_f32_16x16x32_bf16 v[48:51], v[56:59], v[164:167], v[48:51]
    s_waitcnt lgkmcnt(2)
    v_mfma_f32_16x16x32_bf16 v[36:39], v[60:63], v[168:171], v[36:39]
    ds_read_b128 v[76:79], v95 offset:256
    v_mfma_f32_16x16x32_bf16 v[40:43], v[60:63], v[172:175], v[40:43]
    ds_read_b128 v[80:83], v95 offset:16640
    v_mfma_f32_16x16x32_bf16 v[44:47], v[64:67], v[168:171], v[44:47]
    v_mfma_f32_16x16x32_bf16 v[48:51], v[64:67], v[172:175], v[48:51]
    s_waitcnt vmcnt(8) lgkmcnt(0)
    s_barrier
    v_mfma_f32_16x16x32_bf16 v[36:39], v[68:71], v[176:179], v[36:39]
    ds_read_b128 v[4:7], v97 offset:0
    ds_read_b128 v[8:11], v97 offset:1024
    ds_read_b128 v[52:55], v92 offset:32768
    v_mfma_f32_16x16x32_bf16 v[40:43], v[68:71], v[180:183], v[40:43]
    ds_read_b128 v[56:59], v92 offset:49152
    v_mfma_f32_16x16x32_bf16 v[44:47], v[72:75], v[176:179], v[44:47]
    v_mfma_f32_16x16x32_bf16 v[48:51], v[72:75], v[180:183], v[48:51]
    s_waitcnt lgkmcnt(2)
    v_mfma_f32_16x16x32_bf16 v[36:39], v[76:79], v[184:187], v[36:39]
    v_add_f32 v4, v4, v20
    v_add_f32 v5, v5, v21
    v_add_f32 v6, v6, v22
    v_add_f32 v7, v7, v23
    ds_read_b128 v[60:63], v93 offset:32768
    v_mfma_f32_16x16x32_bf16 v[40:43], v[76:79], v[188:191], v[40:43]
    v_cvt_pk_bf16_f32 v12, v4, v5
    v_cvt_pk_bf16_f32 v13, v6, v7
    ds_read_b128 v[64:67], v93 offset:49152
    v_mfma_f32_16x16x32_bf16 v[44:47], v[80:83], v[184:187], v[44:47]
    v_add_f32 v8, v8, v28
    v_add_f32 v9, v9, v29
    v_add_f32 v10, v10, v30
    v_add_f32 v11, v11, v31
    v_mfma_f32_16x16x32_bf16 v[48:51], v[80:83], v[188:191], v[48:51]
    v_cvt_pk_bf16_f32 v14, v8, v9
    v_cvt_pk_bf16_f32 v15, v10, v11
    buffer_store_dwordx4 v[12:15], v98, s[8:11], s73 offen sc1
    s_mov_b32 s73, s81
    s_add_u32 s81, s81, s4
    s_waitcnt lgkmcnt(2)
    v_mfma_f32_16x16x32_bf16 v[36:39], v[52:55], v[192:195], v[36:39]
    ds_read_b128 v[68:71], v94 offset:32768
    v_mfma_f32_16x16x32_bf16 v[40:43], v[52:55], v[196:199], v[40:43]
    ds_read_b128 v[72:75], v94 offset:49152
    v_mfma_f32_16x16x32_bf16 v[44:47], v[56:59], v[192:195], v[44:47]
    s_add_u32 m0, s70, 65536
    s_nop 0
    buffer_load_dwordx4 v84, s[60:63], s68 offen offset:0 lds
    v_mfma_f32_16x16x32_bf16 v[48:51], v[56:59], v[196:199], v[48:51]
    s_waitcnt lgkmcnt(2)
    v_mfma_f32_16x16x32_bf16 v[36:39], v[60:63], v[200:203], v[36:39]
    ds_read_b128 v[76:79], v95 offset:32768
    v_mfma_f32_16x16x32_bf16 v[40:43], v[60:63], v[204:207], v[40:43]
    ds_read_b128 v[80:83], v95 offset:49152
    v_mfma_f32_16x16x32_bf16 v[44:47], v[64:67], v[200:203], v[44:47]
    buffer_load_dwordx4 v85, s[60:63], s68 offen offset:1024 lds
    v_mfma_f32_16x16x32_bf16 v[48:51], v[64:67], v[204:207], v[48:51]
    s_waitcnt lgkmcnt(2)
    v_mfma_f32_16x16x32_bf16 v[36:39], v[68:71], v[208:211], v[36:39]
    ds_read_b128 v[52:55], v92 offset:33024
    v_mfma_f32_16x16x32_bf16 v[40:43], v[68:71], v[212:215], v[40:43]
    ds_read_b128 v[56:59], v92 offset:49408
    v_mfma_f32_16x16x32_bf16 v[44:47], v[72:75], v[208:211], v[44:47]
    buffer_load_dwordx4 v86, s[60:63], s68 offen offset:2048 lds
    v_mfma_f32_16x16x32_bf16 v[48:51], v[72:75], v[212:215], v[48:51]
    s_waitcnt lgkmcnt(2)
    v_mfma_f32_16x16x32_bf16 v[36:39], v[76:79], v[216:219], v[36:39]
    ds_read_b128 v[60:63], v93 offset:33024
    v_mfma_f32_16x16x32_bf16 v[40:43], v[76:79], v[220:223], v[40:43]
    ds_read_b128 v[64:67], v93 offset:49408
    v_mfma_f32_16x16x32_bf16 v[44:47], v[80:83], v[216:219], v[44:47]
    buffer_load_dwordx4 v87, s[60:63], s68 offen offset:3072 lds
    s_add_u32 s68, s68, s3
    v_mfma_f32_16x16x32_bf16 v[48:51], v[80:83], v[220:223], v[48:51]
    s_waitcnt lgkmcnt(2)
    v_mfma_f32_16x16x32_bf16 v[36:39], v[52:55], v[224:227], v[36:39]
    ds_read_b128 v[68:71], v94 offset:33024
    v_mfma_f32_16x16x32_bf16 v[40:43], v[52:55], v[228:231], v[40:43]
    ds_read_b128 v[72:75], v94 offset:49408
    v_mfma_f32_16x16x32_bf16 v[44:47], v[56:59], v[224:227], v[44:47]
    v_mfma_f32_16x16x32_bf16 v[48:51], v[56:59], v[228:231], v[48:51]
    s_waitcnt lgkmcnt(2)
    v_mfma_f32_16x16x32_bf16 v[36:39], v[60:63], v[232:235], v[36:39]
    ds_read_b128 v[76:79], v95 offset:33024
    v_mfma_f32_16x16x32_bf16 v[40:43], v[60:63], v[236:239], v[40:43]
    ds_read_b128 v[80:83], v95 offset:49408
    v_mfma_f32_16x16x32_bf16 v[44:47], v[64:67], v[232:235], v[44:47]
    v_mfma_f32_16x16x32_bf16 v[48:51], v[64:67], v[236:239], v[48:51]
    s_bitcmp1_b64 s[6:7], s82
    s_cbranch_scc1 ssig_58
    s_waitcnt vmcnt(8) lgkmcnt(0)
    s_barrier
srett_66:
    s_add_u32 s82, s82, s5
    v_mfma_f32_16x16x32_bf16 v[36:39], v[68:71], v[240:243], v[36:39]
    ds_read_b128 v[52:55], v88 offset:0
    v_mfma_f32_16x16x32_bf16 v[40:43], v[68:71], v[244:247], v[40:43]
    ds_read_b128 v[56:59], v88 offset:16384
    v_mfma_f32_16x16x32_bf16 v[44:47], v[72:75], v[240:243], v[44:47]
    v_mfma_f32_16x16x32_bf16 v[48:51], v[72:75], v[244:247], v[48:51]
    v_mfma_f32_16x16x32_bf16 v[36:39], v[76:79], v[248:251], v[36:39]
    ds_read_b128 v[60:63], v89 offset:0
    v_mfma_f32_16x16x32_bf16 v[40:43], v[76:79], v[252:255], v[40:43]
    ds_read_b128 v[64:67], v89 offset:16384
    v_mfma_f32_16x16x32_bf16 v[44:47], v[80:83], v[248:251], v[44:47]
    v_mfma_f32_16x16x32_bf16 v[48:51], v[80:83], v[252:255], v[48:51]
    s_cmp_lt_u32 s82, 64
    s_cbranch_scc1 stream_79
    s_nop 2
    ds_write_b128 v96, v[40:43] offset:0
    s_nop 1
    ds_write_b128 v96, v[48:51] offset:1024
    s_waitcnt vmcnt(0) lgkmcnt(0)
    s_barrier
    ds_read_b128 v[4:7], v97 offset:0
    ds_read_b128 v[8:11], v97 offset:1024
    s_waitcnt lgkmcnt(0)
    v_add_f32 v4, v4, v36
    v_add_f32 v5, v5, v37
    v_add_f32 v6, v6, v38
    v_add_f32 v7, v7, v39
    v_cvt_pk_bf16_f32 v12, v4, v5
    v_cvt_pk_bf16_f32 v13, v6, v7
    v_add_f32 v8, v8, v44
    v_add_f32 v9, v9, v45
    v_add_f32 v10, v10, v46
    v_add_f32 v11, v11, v47
    v_cvt_pk_bf16_f32 v14, v8, v9
    v_cvt_pk_bf16_f32 v15, v10, v11
    buffer_store_dwordx4 v[12:15], v98, s[8:11], s73 offen sc1
    s_mov_b32 s73, s81
    s_add_u32 s81, s81, s4
    s_cmp_ge_u32 s57, 24
    s_cbranch_scc1 col_62
send_61:
    s_waitcnt vmcnt(0) lgkmcnt(0)
    s_barrier
    s_cmp_lg_u32 s58, 0
    s_cbranch_scc1 sig_81
    s_cmp_ge_u32 s57, 16
    s_cbranch_scc1 sig_80
    s_bfe_u32 s85, s76, 0x10003
    s_lshl_b32 s85, s85, 2
    s_bfe_u32 s79, s76, 0x30000
    s_lshl_b32 s79, s79, 7
    s_or_b32 s85, s85, s79
    s_bfe_u32 s79, s76, 0x20005
    s_lshl_b32 s79, s79, 10
    s_or_b32 s85, s85, s79
    s_add_u32 s85, s85, 0x5110000
    v_mov_b32 v4, s82
    buffer_store_dword v4, off, s[8:11], s85 sc1
sig_80:
    v_mov_b32 v5, s84
    s_mov_b64 exec, 1
    buffer_atomic_add v5, off, s[12:15], s83 sc1
    s_mov_b64 exec, -1
    s_add_u32 s83, s83, 4
sig_81:
    v_bfe_u32 v2, v1, 4, 2
    v_lshlrev_b32 v2, 2, v2
    v_xor_b32 v2, v2, v1
    v_bfe_u32 v119, v2, 0, 4
    v_lshlrev_b32 v119, 4, v119
    v_bfe_u32 v3, v2, 4, 2
    v_lshl_or_b32 v119, v3, 11, v119
    s_lshl_b32 s63, s75, 3
    s_add_u32 s63, s63, s58
    s_lshl_b32 s5, s63, 13
    s_lshl_b32 s64, s63, 18
    s_bfe_u32 s7, s57, 0x30000
    s_lshl_b32 s7, s7, 8
    s_add_u32 s64, s64, s7
    s_lshl_b32 s66, s58, 14
    s_add_u32 m0, s66, 0
    s_nop 0
    buffer_load_dwordx4 v119, s[32:35], s64 offen lds
    s_add_u32 s64, s64, 0x2000
    s_add_u32 m0, s66, 1024
    s_nop 0
    buffer_load_dwordx4 v119, s[32:35], s64 offen lds
    s_add_u32 s64, s64, 0x2000
    s_add_u32 m0, s66, 2048
    s_nop 0
    buffer_load_dwordx4 v119, s[32:35], s64 offen lds
    s_add_u32 s64, s64, 0x2000
    s_add_u32 m0, s66, 3072
    s_nop 0
    buffer_load_dwordx4 v119, s[32:35], s64 offen lds
    s_add_u32 s64, s64, 0x2000
    s_add_u32 m0, s66, 4096
    s_nop 0
    buffer_load_dwordx4 v119, s[32:35], s64 offen lds
    s_add_u32 s64, s64, 0x2000
    s_add_u32 m0, s66, 5120
    s_nop 0
    buffer_load_dwordx4 v119, s[32:35], s64 offen lds
    s_add_u32 s64, s64, 0x2000
    s_add_u32 m0, s66, 6144
    s_nop 0
    buffer_load_dwordx4 v119, s[32:35], s64 offen lds
    s_add_u32 s64, s64, 0x2000
    s_add_u32 m0, s66, 7168
    s_nop 0
    buffer_load_dwordx4 v119, s[32:35], s64 offen lds
    s_add_u32 s64, s64, 0x2000
    s_add_u32 m0, s66, 8192
    s_nop 0
    buffer_load_dwordx4 v119, s[32:35], s64 offen lds
    s_add_u32 s64, s64, 0x2000
    s_add_u32 m0, s66, 9216
    s_nop 0
    buffer_load_dwordx4 v119, s[32:35], s64 offen lds
    s_add_u32 s64, s64, 0x2000
    s_add_u32 m0, s66, 10240
    s_nop 0
    buffer_load_dwordx4 v119, s[32:35], s64 offen lds
    s_add_u32 s64, s64, 0x2000
    s_add_u32 m0, s66, 11264
    s_nop 0
    buffer_load_dwordx4 v119, s[32:35], s64 offen lds
    s_add_u32 s64, s64, 0x2000
    s_add_u32 m0, s66, 12288
    s_nop 0
    buffer_load_dwordx4 v119, s[32:35], s64 offen lds
    s_add_u32 s64, s64, 0x2000
    s_add_u32 m0, s66, 13312
    s_nop 0
    buffer_load_dwordx4 v119, s[32:35], s64 offen lds
    s_add_u32 s64, s64, 0x2000
    s_add_u32 m0, s66, 14336
    s_nop 0
    buffer_load_dwordx4 v119, s[32:35], s64 offen lds
    s_add_u32 s64, s64, 0x2000
    s_add_u32 m0, s66, 15360
    s_nop 0
    buffer_load_dwordx4 v119, s[32:35], s64 offen lds
    s_add_u32 s64, s64, 0x2000
    buffer_load_dwordx4 v[192:195], v119, s[32:35], s64 offen
    s_add_u32 s64, s64, 0x2000
    buffer_load_dwordx4 v[196:199], v119, s[32:35], s64 offen
    s_add_u32 s64, s64, 0x2000
    buffer_load_dwordx4 v[200:203], v119, s[32:35], s64 offen
    s_add_u32 s64, s64, 0x2000
    buffer_load_dwordx4 v[204:207], v119, s[32:35], s64 offen
    s_add_u32 s64, s64, 0x2000
    buffer_load_dwordx4 v[208:211], v119, s[32:35], s64 offen
    s_add_u32 s64, s64, 0x2000
    buffer_load_dwordx4 v[212:215], v119, s[32:35], s64 offen
    s_add_u32 s64, s64, 0x2000
    buffer_load_dwordx4 v[216:219], v119, s[32:35], s64 offen
    s_add_u32 s64, s64, 0x2000
    buffer_load_dwordx4 v[220:223], v119, s[32:35], s64 offen
    s_add_u32 s64, s64, 0x2000
    buffer_load_dwordx4 v[224:227], v119, s[32:35], s64 offen
    s_add_u32 s64, s64, 0x2000
    buffer_load_dwordx4 v[228:231], v119, s[32:35], s64 offen
    s_add_u32 s64, s64, 0x2000
    buffer_load_dwordx4 v[232:235], v119, s[32:35], s64 offen
    s_add_u32 s64, s64, 0x2000
    buffer_load_dwordx4 v[236:239], v119, s[32:35], s64 offen
    s_add_u32 s64, s64, 0x2000
    buffer_load_dwordx4 v[240:243], v119, s[32:35], s64 offen
    s_add_u32 s64, s64, 0x2000
    buffer_load_dwordx4 v[244:247], v119, s[32:35], s64 offen
    s_add_u32 s64, s64, 0x2000
    buffer_load_dwordx4 v[248:251], v119, s[32:35], s64 offen
    s_add_u32 s64, s64, 0x2000
    buffer_load_dwordx4 v[252:255], v119, s[32:35], s64 offen
    s_add_u32 s64, s64, 0x2000
    v_bfe_u32 v121, v1, 0, 2
    v_lshlrev_b32 v121, 4, v121
    v_bfe_u32 v3, v1, 2, 2
    v_lshl_or_b32 v121, v3, 6, v121
    v_bfe_u32 v3, v1, 2, 2
    v_lshl_or_b32 v121, v3, 8, v121
    v_bfe_u32 v3, v1, 4, 1
    v_lshl_or_b32 v121, v3, 10, v121
    v_bfe_u32 v3, v1, 5, 1
    v_lshl_or_b32 v121, v3, 12, v121
    s_bfe_u32 s63, s58, 0x20000
    s_lshl_b32 s63, s63, 6
    s_bfe_u32 s70, s58, 0x10002
    s_lshl_b32 s70, s70, 16
    s_or_b32 s63, s63, s70
    v_xor_b32 v121, s63, v121
    v_lshl_add_u32 v120, v1, 4, s66
    s_waitcnt vmcnt(16)
    s_barrier
    ds_read_b64_tr_b16 v[128:129], v121 offset:0
    ds_read_b64_tr_b16 v[130:131], v121 offset:2048
    ds_read_b64_tr_b16 v[132:133], v121 offset:8
    ds_read_b64_tr_b16 v[134:135], v121 offset:2056
    ds_read_b64_tr_b16 v[136:137], v121 offset:8192
    ds_read_b64_tr_b16 v[138:139], v121 offset:10240
    ds_read_b64_tr_b16 v[140:141], v121 offset:8200
    ds_read_b64_tr_b16 v[142:143], v121 offset:10248
    s_waitcnt lgkmcnt(4)
    ds_read_b64_tr_b16 v[144:145], v121 offset:16384
    ds_read_b64_tr_b16 v[146:147], v121 offset:18432
    ds_read_b64_tr_b16 v[148:149], v121 offset:16392
    ds_read_b64_tr_b16 v[150:151], v121 offset:18440
    ds_read_b64_tr_b16 v[152:153], v121 offset:24576
    ds_read_b64_tr_b16 v[154:155], v121 offset:26624
    ds_read_b64_tr_b16 v[156:157], v121 offset:24584
    ds_read_b64_tr_b16 v[158:159], v121 offset:26632
    s_waitcnt lgkmcnt(4)
    ds_read_b64_tr_b16 v[160:161], v121 offset:32768
    ds_read_b64_tr_b16 v[162:163], v121 offset:34816
    ds_read_b64_tr_b16 v[164:165], v121 offset:32776
    ds_read_b64_tr_b16 v[166:167], v121 offset:34824
    ds_read_b64_tr_b16 v[168:169], v121 offset:40960
    ds_read_b64_tr_b16 v[170:171], v121 offset:43008
    ds_read_b64_tr_b16 v[172:173], v121 offset:40968
    ds_read_b64_tr_b16 v[174:175], v121 offset:43016
    s_waitcnt lgkmcnt(4)
    ds_read_b64_tr_b16 v[176:177], v121 offset:49152
    ds_read_b64_tr_b16 v[178:179], v121 offset:51200
    ds_read_b64_tr_b16 v[180:181], v121 offset:49160
    ds_read_b64_tr_b16 v[182:183], v121 offset:51208
    ds_read_b64_tr_b16 v[184:185], v121 offset:57344
    ds_read_b64_tr_b16 v[186:187], v121 offset:59392
    ds_read_b64_tr_b16 v[188:189], v121 offset:57352
    ds_read_b64_tr_b16 v[190:191], v121 offset:59400
    s_waitcnt lgkmcnt(0)
    s_barrier
    s_waitcnt vmcnt(15)
    ds_write_b128 v120, v[192:195] offset:0
    s_waitcnt vmcnt(14)
    ds_write_b128 v120, v[196:199] offset:1024
    s_waitcnt vmcnt(13)
    ds_write_b128 v120, v[200:203] offset:2048
    s_waitcnt vmcnt(12)
    ds_write_b128 v120, v[204:207] offset:3072
    s_waitcnt vmcnt(11)
    ds_write_b128 v120, v[208:211] offset:4096
    s_waitcnt vmcnt(10)
    ds_write_b128 v120, v[212:215] offset:5120
    s_waitcnt vmcnt(9)
    ds_write_b128 v120, v[216:219] offset:6144
    s_waitcnt vmcnt(8)
    ds_write_b128 v120, v[220:223] offset:7168
    s_waitcnt vmcnt(7)
    ds_write_b128 v120, v[224:227] offset:8192
    s_waitcnt vmcnt(6)
    ds_write_b128 v120, v[228:231] offset:9216
    s_waitcnt vmcnt(5)
    ds_write_b128 v120, v[232:235] offset:10240
    s_waitcnt vmcnt(4)
    ds_write_b128 v120, v[236:239] offset:11264
    s_waitcnt vmcnt(3)
    ds_write_b128 v120, v[240:243] offset:12288
    s_waitcnt vmcnt(2)
    ds_write_b128 v120, v[244:247] offset:13312
    s_waitcnt vmcnt(1)
    ds_write_b128 v120, v[248:251] offset:14336
    s_waitcnt vmcnt(0)
    ds_write_b128 v120, v[252:255] offset:15360
    s_cmp_lg_u32 s58, 0
    s_cbranch_scc1 wall_82
    v_mov_b32 v3, 196
wctr_83:
    buffer_load_dword v2, v3, s[12:15], 0 offen sc1
    s_waitcnt vmcnt(0)
    v_cmp_ne_u32 vcc, 2097216, v2
    s_cbranch_vccz wctr_ok_84
    s_sub_u32 s77, s77, 1
    s_cbranch_scc0 wctr_83
    s_mov_b32 s77, 0
wctr_ok_84:
wall_82:
    s_waitcnt lgkmcnt(0)
    s_barrier
    ds_read_b64_tr_b16 v[192:193], v121 offset:0
    ds_read_b64_tr_b16 v[194:195], v121 offset:2048
    ds_read_b64_tr_b16 v[196:197], v121 offset:8
    ds_read_b64_tr_b16 v[198:199], v121 offset:2056
    ds_read_b64_tr_b16 v[200:201], v121 offset:8192
    ds_read_b64_tr_b16 v[202:203], v121 offset:10240
    ds_read_b64_tr_b16 v[204:205], v121 offset:8200
    ds_read_b64_tr_b16 v[206:207], v121 offset:10248
    s_waitcnt lgkmcnt(4)
    ds_read_b64_tr_b16 v[208:209], v121 offset:16384
    ds_read_b64_tr_b16 v[210:211], v121 offset:18432
    ds_read_b64_tr_b16 v[212:213], v121 offset:16392
    ds_read_b64_tr_b16 v[214:215], v121 offset:18440
    ds_read_b64_tr_b16 v[216:217], v121 offset:24576
    ds_read_b64_tr_b16 v[218:219], v121 offset:26624
    ds_read_b64_tr_b16 v[220:221], v121 offset:24584
    ds_read_b64_tr_b16 v[222:223], v121 offset:26632
    s_waitcnt lgkmcnt(4)
    ds_read_b64_tr_b16 v[224:225], v121 offset:32768
    ds_read_b64_tr_b16 v[226:227], v121 offset:34816
    ds_read_b64_tr_b16 v[228:229], v121 offset:32776
    ds_read_b64_tr_b16 v[230:231], v121 offset:34824
    ds_read_b64_tr_b16 v[232:233], v121 offset:40960
    ds_read_b64_tr_b16 v[234:235], v121 offset:43008
    ds_read_b64_tr_b16 v[236:237], v121 offset:40968
    ds_read_b64_tr_b16 v[238:239], v121 offset:43016
    s_waitcnt lgkmcnt(4)
    ds_read_b64_tr_b16 v[240:241], v121 offset:49152
    ds_read_b64_tr_b16 v[242:243], v121 offset:51200
    ds_read_b64_tr_b16 v[244:245], v121 offset:49160
    ds_read_b64_tr_b16 v[246:247], v121 offset:51208
    ds_read_b64_tr_b16 v[248:249], v121 offset:57344
    ds_read_b64_tr_b16 v[250:251], v121 offset:59392
    ds_read_b64_tr_b16 v[252:253], v121 offset:57352
    ds_read_b64_tr_b16 v[254:255], v121 offset:59400
    s_waitcnt lgkmcnt(0)
    s_barrier
    s_add_u32 s5, s5, 0x3000000
    s_lshl_b32 s6, s75, 7
    s_add_u32 s6, s6, 0x5100000
    s_lshl_b32 s66, s58, 12
    v_lshlrev_b32 v123, 4, v1
    s_bfe_u32 s63, s58, 0x10002
    s_lshl_b32 s63, s63, 8
    v_xor_b32 v119, s63, v123
    v_bfe_u32 v116, v1, 0, 4
    v_lshlrev_b32 v116, 4, v116
    v_bfe_u32 v2, v1, 4, 2
    v_lshl_or_b32 v116, v2, 9, v116
    v_lshl_or_b32 v116, s63, 6, v116
    v_xor_b32 v117, 0x10000, v116
    s_lshl_b32 s63, s58, 11
    s_or_b32 s63, s63, 131072
    v_add_u32 v120, s63, v123
    v_xor_b32 v121, 0x2000, v120
    v_bfe_u32 v122, v1, 4, 2
    v_lshlrev_b32 v122, 4, v122
    v_bfe_u32 v2, v1, 0, 4
    v_lshl_or_b32 v122, v2, 12, v122
    s_bfe_u32 s63, s58, 0x20000
    s_lshl_b32 s63, s63, 6
    s_bfe_u32 s70, s58, 0x10002
    s_lshl_b32 s70, s70, 16
    s_or_b32 s63, s63, s70
    s_add_u32 s7, s7, s63
    s_bfe_u32 s69, s57, 0x30000
    s_lshl_b32 s69, s69, 16
    s_bfe_u32 s63, s57, 0x20003
    s_lshl_b32 s63, s63, 21
    s_or_b32 s69, s69, s63
    s_lshl_b32 s63, s58, 13
    s_add_u32 s69, s69, s63
    s_add_u32 s69, s69, 0x6000000
    s_lshl_b32 s63, s75, 11
    s_add_u32 s69, s69, s63
    s_xor_b32 s2, s69, 2048
    s_xor_b32 s3, s69, 4096
    s_xor_b32 s4, s69, 6144
    s_lshr_b32 s63, s58, 1
    s_xor_b32 s74, s63, s75
    s_mov_b32 s60, 0x92492490
    s_mov_b32 s61, 0x24924924
    s_cmp_lt_u32 s57, 16
    s_cselect_b32 s63, 5, 0
    s_or_b32 s60, s60, s63
    s_lshr_b32 s63, s57, 3
    s_lshl_b64 s[60:61], s[60:61], s63
    v_bfe_u32 v125, v1, 0, 3
    v_lshlrev_b32 v125, 2, v125
    v_lshl_or_b32 v125, s58, 28, v125
    v_mov_b32 v127, 163744
    s_mov_b32 s70, 0
    v_mov_b32 v124, v123
    v_mov_b32 v96, 0x3f80
    v_mov_b32 v97, 0x3f800000
    s_ff1_i32_b64 s62, s[60:61]
    s_bitset0_b64 s[60:61], s62
    s_lshl_b32 s65, s62, 9
    s_add_u32 s65, s65, s6
    s_mov_b32 s59, -1
    s_mov_b32 s73, -1
    s_mov_b32 s67, 0x5ffffff0
wo_slow_85:
    s_lshl_b32 s63, s58, 2
    s_add_u32 s65, s65, s63
pollfl_90:
    buffer_load_dword v118, off, s[8:11], s65 sc1
    s_waitcnt vmcnt(0)
    v_cmp_eq_u32 vcc, 0, v118
    s_cbranch_vccz pollfl_ok_91
    s_sub_u32 s77, s77, 1
    s_cbranch_scc0 pollfl_90
    s_mov_b32 s77, 0
pollfl_ok_91:
    s_mov_b32 s72, s62
    s_lshl_b32 s64, s62, 18
    s_add_u32 s64, s64, s5
    s_ff1_i32_b64 s62, s[60:61]
    s_bitset0_b64 s[60:61], s62
    s_lshl_b32 s65, s62, 9
    s_add_u32 s65, s65, s6
    s_add_u32 m0, s66, 0
    s_nop 0
    buffer_load_dwordx4 v119, s[8:11], s64 offen offset:0 lds
    buffer_load_dwordx4 v119, s[8:11], s64 offen offset:1024 lds
    buffer_load_dwordx4 v119, s[8:11], s64 offen offset:2048 lds
    buffer_load_dwordx4 v119, s[8:11], s64 offen offset:3072 lds
    s_add_u32 s64, s64, 4096
    buffer_load_dword v118, v125, s[8:11], s65 offen sc1
    s_add_u32 m0, s66, 32768
    s_nop 0
    buffer_load_dwordx4 v119, s[8:11], s64 offen offset:0 lds
    buffer_load_dwordx4 v119, s[8:11], s64 offen offset:1024 lds
    buffer_load_dwordx4 v119, s[8:11], s64 offen offset:2048 lds
    buffer_load_dwordx4 v119, s[8:11], s64 offen offset:3072 lds
    s_add_u32 s64, s64, 4096
    s_mov_b32 s63, 0x5ffffff0
    buffer_load_dword v3, off, s[8:11], s63
    s_waitcnt vmcnt(5)
    s_cmp_lg_u32 s58, 0
    s_cbranch_scc1 wo_v_92
    v_cmp_eq_u32 vcc, 0, v118
    s_nop 1
    v_mov_b32 v126, vcc_lo
    ds_write_b32 v127, v126
wo_v_92:
    s_waitcnt lgkmcnt(0)
    s_barrier
    ds_read_b32 v126, v127
    ds_read_b128 v[44:47], v116 offset:0
    ds_read_b128 v[48:51], v116 offset:256
    ds_read_b128 v[52:55], v116 offset:2048
    ds_read_b128 v[56:59], v116 offset:2304
    s_cmp_eq_u32 s74, 0
    s_cbranch_scc0 wo_o_93
    s_setprio 2
wo_o_93:
wo_loop_86:
    s_waitcnt lgkmcnt(2)
    v_mfma_f32_16x16x32_bf16 v[12:15], v[128:131], v[44:47], 0
    ds_read_b128 v[60:63], v116 offset:4096
    v_mfma_f32_16x16x32_bf16 v[16:19], v[132:135], v[44:47], 0
    ds_read_b128 v[64:67], v116 offset:4352
    v_readfirstlane_b32 s68, v126
    s_mov_b32 s73, s59
    s_mov_b32 s59, s72
    s_mov_b32 s64, 0x5ffffff0
    s_lshr_b32 s63, s62, 31
    s_or_b32 s68, s68, s63
    s_cbranch_scc1 wo_np_94
    s_mov_b32 s72, s62
    s_lshl_b32 s64, s62, 18
    s_add_u32 s64, s64, s5
    s_ff1_i32_b64 s62, s[60:61]
    s_bitset0_b64 s[60:61], s62
    s_lshl_b32 s65, s62, 9
    s_add_u32 s65, s65, s6
wo_np_94:
    v_mfma_f32_16x16x32_bf16 v[20:23], v[128:131], v[48:51], 0
    v_mfma_f32_16x16x32_bf16 v[24:27], v[132:135], v[48:51], 0
    s_waitcnt lgkmcnt(2)
    v_mfma_f32_16x16x32_bf16 v[12:15], v[136:139], v[52:55], v[12:15]
    ds_read_b128 v[68:71], v116 offset:6144
    v_mfma_f32_16x16x32_bf16 v[16:19], v[140:143], v[52:55], v[16:19]
    ds_read_b128 v[72:75], v116 offset:6400
    v_mfma_f32_16x16x32_bf16 v[20:23], v[136:139], v[56:59], v[20:23]
    v_mfma_f32_16x16x32_bf16 v[24:27], v[140:143], v[56:59], v[24:27]
    ds_write_b128 v120, v[36:39] offset:0
    buffer_load_dword v118, v125, s[8:11], s65 offen sc1
    s_waitcnt lgkmcnt(3)
    v_mfma_f32_16x16x32_bf16 v[12:15], v[144:147], v[60:63], v[12:15]
    ds_read_b128 v[44:47], v116 offset:8192
    v_mfma_f32_16x16x32_bf16 v[16:19], v[148:151], v[60:63], v[16:19]
    ds_read_b128 v[48:51], v116 offset:8448
    v_mfma_f32_16x16x32_bf16 v[20:23], v[144:147], v[64:67], v[20:23]
    s_add_u32 m0, s66, 65536
    s_nop 0
    buffer_load_dwordx4 v119, s[8:11], s64 offen offset:0 lds
    v_mfma_f32_16x16x32_bf16 v[24:27], v[148:151], v[64:67], v[24:27]
    ds_write_b128 v120, v[40:43] offset:1024
    s_waitcnt lgkmcnt(4)
    v_mfma_f32_16x16x32_bf16 v[12:15], v[152:155], v[68:71], v[12:15]
    ds_read_b128 v[52:55], v116 offset:10240
    v_mfma_f32_16x16x32_bf16 v[16:19], v[156:159], v[68:71], v[16:19]
    ds_read_b128 v[56:59], v116 offset:10496
    v_mfma_f32_16x16x32_bf16 v[20:23], v[152:155], v[72:75], v[20:23]
    buffer_load_dwordx4 v119, s[8:11], s64 offen offset:1024 lds
    v_mfma_f32_16x16x32_bf16 v[24:27], v[156:159], v[72:75], v[24:27]
    s_cmp_eq_u32 s74, 0
    s_cbranch_scc0 wo_o_95
    buffer_load_dwordx4 v[92:95], v124, s[8:11], s2 offen offset:0 sc1
wo_o_95:
    s_waitcnt lgkmcnt(3)
    v_mfma_f32_16x16x32_bf16 v[12:15], v[160:163], v[44:47], v[12:15]
    ds_read_b128 v[60:63], v116 offset:12288
    v_mfma_f32_16x16x32_bf16 v[16:19], v[164:167], v[44:47], v[16:19]
    ds_read_b128 v[64:67], v116 offset:12544
    v_mfma_f32_16x16x32_bf16 v[20:23], v[160:163], v[48:51], v[20:23]
    buffer_load_dwordx4 v119, s[8:11], s64 offen offset:2048 lds
    v_mfma_f32_16x16x32_bf16 v[24:27], v[164:167], v[48:51], v[24:27]
    s_cmp_eq_u32 s74, 0
    s_cbranch_scc0 wo_o_96
    buffer_load_dwordx4 v[100:103], v124, s[8:11], s3 offen offset:0 sc1
wo_o_96:
    s_waitcnt lgkmcnt(2)
    v_mfma_f32_16x16x32_bf16 v[12:15], v[168:171], v[52:55], v[12:15]
    ds_read_b128 v[68:71], v116 offset:14336
    v_mfma_f32_16x16x32_bf16 v[16:19], v[172:175], v[52:55], v[16:19]
    ds_read_b128 v[72:75], v116 offset:14592
    v_mfma_f32_16x16x32_bf16 v[20:23], v[168:171], v[56:59], v[20:23]
    buffer_load_dwordx4 v119, s[8:11], s64 offen offset:3072 lds
    s_add_u32 s64, s64, 4096
    v_mfma_f32_16x16x32_bf16 v[24:27], v[172:175], v[56:59], v[24:27]
    s_cmp_eq_u32 s74, 0
    s_cbranch_scc0 wo_o_97
    buffer_load_dwordx4 v[108:111], v124, s[8:11], s4 offen offset:0 sc1
wo_o_97:
    s_cmp_eq_u32 s74, 0
    s_cbranch_scc1 wo_w_98
    s_waitcnt vmcnt(5)
wo_w_98:
    s_waitcnt vmcnt(9)
    s_waitcnt lgkmcnt(0)
    s_barrier
    v_mfma_f32_16x16x32_bf16 v[12:15], v[176:179], v[60:63], v[12:15]
    ds_read_b128 v[4:7], v121 offset:0
    ds_read_b128 v[8:11], v121 offset:1024
    ds_read_b128 v[44:47], v116 offset:32768
    v_mfma_f32_16x16x32_bf16 v[16:19], v[180:183], v[60:63], v[16:19]
    ds_read_b128 v[48:51], v116 offset:33024
    v_mfma_f32_16x16x32_bf16 v[20:23], v[176:179], v[64:67], v[20:23]
    v_mfma_f32_16x16x32_bf16 v[24:27], v[180:183], v[64:67], v[24:27]
    s_waitcnt lgkmcnt(2)
    v_mfma_f32_16x16x32_bf16 v[12:15], v[184:187], v[68:71], v[12:15]
    ds_read_b128 v[52:55], v116 offset:34816
    v_mfma_f32_16x16x32_bf16 v[16:19], v[188:191], v[68:71], v[16:19]
    ds_read_b128 v[56:59], v116 offset:35072
    v_mfma_f32_16x16x32_bf16 v[20:23], v[184:187], v[72:75], v[20:23]
    v_mfma_f32_16x16x32_bf16 v[24:27], v[188:191], v[72:75], v[24:27]
    v_pk_add_f32 v[84:85], v[4:5], v[28:29]
    v_pk_add_f32 v[86:87], v[6:7], v[30:31]
    v_pk_add_f32 v[88:89], v[8:9], v[32:33]
    v_pk_add_f32 v[90:91], v[10:11], v[34:35]
    s_cmp_eq_u32 s74, 0
    s_cbranch_scc1 wo_e_99
    s_bfe_u32 s71, s70, 0x10002
    s_cmp_lt_i32 s73, 0
    s_cselect_b32 s63, 0x5ffffff0, s69
    v_cvt_pk_bf16_f32 v84, v84, v85
    v_cvt_pk_bf16_f32 v85, v86, v87
    v_cvt_pk_bf16_f32 v86, v88, v89
    v_cvt_pk_bf16_f32 v87, v90, v91
    v_bfi_b32 v84, 1, s71, v84
    buffer_store_dwordx4 v[84:87], v123, s[8:11], s63 offen offset:0 sc1
wo_e_99:
    s_waitcnt lgkmcnt(2)
    v_mfma_f32_16x16x32_bf16 v[12:15], v[192:195], v[44:47], v[12:15]
    ds_read_b128 v[60:63], v116 offset:36864
    v_mfma_f32_16x16x32_bf16 v[16:19], v[196:199], v[44:47], v[16:19]
    ds_read_b128 v[64:67], v116 offset:37120
    v_mfma_f32_16x16x32_bf16 v[20:23], v[192:195], v[48:51], v[20:23]
    v_mfma_f32_16x16x32_bf16 v[24:27], v[196:199], v[48:51], v[24:27]
    s_waitcnt lgkmcnt(2)
    v_mfma_f32_16x16x32_bf16 v[12:15], v[200:203], v[52:55], v[12:15]
    ds_read_b128 v[68:71], v116 offset:38912
    v_mfma_f32_16x16x32_bf16 v[16:19], v[204:207], v[52:55], v[16:19]
    ds_read_b128 v[72:75], v116 offset:39168
    v_mfma_f32_16x16x32_bf16 v[20:23], v[200:203], v[56:59], v[20:23]
    v_mfma_f32_16x16x32_bf16 v[24:27], v[204:207], v[56:59], v[24:27]
    s_cmp_lg_u32 s58, 0
    s_cbranch_scc1 wo_a_100
    s_waitcnt vmcnt(5)
    v_cmp_eq_u32 vcc, 0, v118
    s_cbranch_vccz wo_a_100
    buffer_load_dword v118, v125, s[8:11], s65 offen sc1
wo_a_100:
    s_waitcnt lgkmcnt(2)
    v_mfma_f32_16x16x32_bf16 v[12:15], v[208:211], v[60:63], v[12:15]
    ds_read_b128 v[44:47], v116 offset:40960
    v_mfma_f32_16x16x32_bf16 v[16:19], v[212:215], v[60:63], v[16:19]
    ds_read_b128 v[48:51], v116 offset:41216
    v_mfma_f32_16x16x32_bf16 v[20:23], v[208:211], v[64:67], v[20:23]
    s_add_u32 m0, s66, 98304
    s_nop 0
    buffer_load_dwordx4 v119, s[8:11], s64 offen offset:0 lds
    v_mfma_f32_16x16x32_bf16 v[24:27], v[212:215], v[64:67], v[24:27]
    s_waitcnt lgkmcnt(2)
    v_mfma_f32_16x16x32_bf16 v[12:15], v[216:219], v[68:71], v[12:15]
    ds_read_b128 v[52:55], v116 offset:43008
    v_mfma_f32_16x16x32_bf16 v[16:19], v[220:223], v[68:71], v[16:19]
    ds_read_b128 v[56:59], v116 offset:43264
    v_mfma_f32_16x16x32_bf16 v[20:23], v[216:219], v[72:75], v[20:23]
    buffer_load_dwordx4 v119, s[8:11], s64 offen offset:1024 lds
    v_mfma_f32_16x16x32_bf16 v[24:27], v[220:223], v[72:75], v[24:27]
    s_waitcnt lgkmcnt(2)
    v_mfma_f32_16x16x32_bf16 v[12:15], v[224:227], v[44:47], v[12:15]
    ds_read_b128 v[60:63], v116 offset:45056
    v_mfma_f32_16x16x32_bf16 v[16:19], v[228:231], v[44:47], v[16:19]
    ds_read_b128 v[64:67], v116 offset:45312
    v_mfma_f32_16x16x32_bf16 v[20:23], v[224:227], v[48:51], v[20:23]
    buffer_load_dwordx4 v119, s[8:11], s64 offen offset:2048 lds
    v_mfma_f32_16x16x32_bf16 v[24:27], v[228:231], v[48:51], v[24:27]
    s_cmp_lg_u32 s58, 0
    s_cbranch_scc1 wo_v_101
    s_cbranch_vccz wo_b_102
    s_waitcnt vmcnt(3)
wo_b_102:
    v_cmp_eq_u32 vcc, 0, v118
    s_nop 1
    v_mov_b32 v126, vcc_lo
    ds_write_b32 v127, v126
wo_v_101:
    s_waitcnt lgkmcnt(2)
    v_mfma_f32_16x16x32_bf16 v[12:15], v[232:235], v[52:55], v[12:15]
    ds_read_b128 v[68:71], v116 offset:47104
    v_mfma_f32_16x16x32_bf16 v[16:19], v[236:239], v[52:55], v[16:19]
    ds_read_b128 v[72:75], v116 offset:47360
    v_mfma_f32_16x16x32_bf16 v[20:23], v[232:235], v[56:59], v[20:23]
    buffer_load_dwordx4 v119, s[8:11], s64 offen offset:3072 lds
    s_add_u32 s64, s64, 4096
    v_mfma_f32_16x16x32_bf16 v[24:27], v[236:239], v[56:59], v[24:27]
    s_cmp_eq_u32 s74, 0
    s_cbranch_scc1 wo_w_103
    s_waitcnt vmcnt(5)
wo_w_103:
    s_waitcnt vmcnt(5)
    s_waitcnt lgkmcnt(0)
    s_barrier
    v_mfma_f32_16x16x32_bf16 v[12:15], v[240:243], v[60:63], v[12:15]
    ds_read_b32 v126, v127
    ds_read_b128 v[44:47], v117 offset:0
    v_mfma_f32_16x16x32_bf16 v[16:19], v[244:247], v[60:63], v[16:19]
    ds_read_b128 v[48:51], v117 offset:256
    v_mfma_f32_16x16x32_bf16 v[20:23], v[240:243], v[64:67], v[20:23]
    v_mfma_f32_16x16x32_bf16 v[24:27], v[244:247], v[64:67], v[24:27]
    v_mfma_f32_16x16x32_bf16 v[12:15], v[248:251], v[68:71], v[12:15]
    ds_read_b128 v[52:55], v117 offset:2048
    v_mfma_f32_16x16x32_bf16 v[16:19], v[252:255], v[68:71], v[16:19]
    ds_read_b128 v[56:59], v117 offset:2304
    v_mfma_f32_16x16x32_bf16 v[20:23], v[248:251], v[72:75], v[20:23]
    v_mfma_f32_16x16x32_bf16 v[24:27], v[252:255], v[72:75], v[24:27]
    s_cmp_lg_u32 s74, 0
    s_cbranch_scc1 wo_k_104
    s_cmp_eq_u32 s67, 0x5ffffff0
    s_cbranch_scc1 wo_s_106
    s_waitcnt vmcnt(4)
    v_bitop3_b32 v2, v92, v100, s71 bitop3:0x7e
    v_xor_b32 v3, s71, v108
    v_bitop3_b32 v2, v2, v3, 1 bitop3:0xa8
    v_cmp_ne_u32 vcc, 0, v2
    s_cbranch_vccz pollpart_ok_108
pollpart_107:
    buffer_load_dwordx4 v[92:95], v124, s[8:11], s2 offen offset:0 sc1
    buffer_load_dwordx4 v[100:103], v124, s[8:11], s3 offen offset:0 sc1
    buffer_load_dwordx4 v[108:111], v124, s[8:11], s4 offen offset:0 sc1
    s_waitcnt vmcnt(0)
    v_bitop3_b32 v2, v92, v100, s71 bitop3:0x7e
    v_xor_b32 v3, s71, v108
    v_bitop3_b32 v2, v2, v3, 1 bitop3:0xa8
    v_cmp_ne_u32 vcc, 0, v2
    s_cbranch_vccz pollpart_ok_108
    s_sub_u32 s77, s77, 1
    s_cbranch_scc0 pollpart_107
    s_mov_b32 s77, 0
pollpart_ok_108:
    v_dot2_f32_bf16 v76, v92, v96, v76
    v_dot2_f32_bf16 v77, v92, v97, v77
    v_dot2_f32_bf16 v78, v93, v96, v78
    v_dot2_f32_bf16 v79, v93, v97, v79
    v_dot2_f32_bf16 v80, v94, v96, v80
    v_dot2_f32_bf16 v81, v94, v97, v81
    v_dot2_f32_bf16 v82, v95, v96, v82
    v_dot2_f32_bf16 v83, v95, v97, v83
    v_dot2_f32_bf16 v76, v100, v96, v76
    v_dot2_f32_bf16 v77, v100, v97, v77
    v_dot2_f32_bf16 v78, v101, v96, v78
    v_dot2_f32_bf16 v79, v101, v97, v79
    v_dot2_f32_bf16 v80, v102, v96, v80
    v_dot2_f32_bf16 v81, v102, v97, v81
    v_dot2_f32_bf16 v82, v103, v96, v82
    v_dot2_f32_bf16 v83, v103, v97, v83
    v_dot2_f32_bf16 v76, v108, v96, v76
    v_dot2_f32_bf16 v77, v108, v97, v77
    v_dot2_f32_bf16 v78, v109, v96, v78
    v_dot2_f32_bf16 v79, v109, v97, v79
    v_dot2_f32_bf16 v80, v110, v96, v80
    v_dot2_f32_bf16 v81, v110, v97, v81
    v_dot2_f32_bf16 v82, v111, v96, v82
    v_dot2_f32_bf16 v83, v111, v97, v83
    v_cvt_pk_bf16_f32 v92, v76, v77
    v_cvt_pk_bf16_f32 v93, v78, v79
    v_cvt_pk_bf16_f32 v94, v80, v81
    v_cvt_pk_bf16_f32 v95, v82, v83
wo_s_106:
    buffer_store_dwordx4 v[92:95], v122, s[16:19], s67 offen offset:2048 sc1
wo_k_104:
    s_cmp_lt_i32 s73, 0
    s_cbranch_scc1 wo_e_105
    s_bfe_u32 s71, s70, 0x10002
    s_add_u32 s70, s70, 1
    v_pk_mov_b32 v[76:77], v[84:85], v[84:85] op_sel:[0,1]
    v_pk_mov_b32 v[78:79], v[86:87], v[86:87] op_sel:[0,1]
    v_pk_mov_b32 v[80:81], v[88:89], v[88:89] op_sel:[0,1]
    v_pk_mov_b32 v[82:83], v[90:91], v[90:91] op_sel:[0,1]
    v_mov_b32 v124, v123
    s_lshl_b32 s67, s73, 17
    s_add_u32 s67, s67, s7
    v_add_u32 v123, 0x80000, v123
    v_and_b32 v123, 0x1fffff, v123
wo_e_105:
    s_cmp_eq_u32 s68, 0
    s_cbranch_scc0 wo_fl_87
wo_out_89:
    s_waitcnt lgkmcnt(2)
    v_mfma_f32_16x16x32_bf16 v[28:31], v[128:131], v[44:47], 0
    ds_read_b128 v[60:63], v117 offset:4096
    v_mfma_f32_16x16x32_bf16 v[32:35], v[132:135], v[44:47], 0
    ds_read_b128 v[64:67], v117 offset:4352
    v_readfirstlane_b32 s68, v126
    s_mov_b32 s73, s59
    s_mov_b32 s59, s72
    s_mov_b32 s64, 0x5ffffff0
    s_lshr_b32 s63, s62, 31
    s_or_b32 s68, s68, s63
    s_cbranch_scc1 wo_np_109
    s_mov_b32 s72, s62
    s_lshl_b32 s64, s62, 18
    s_add_u32 s64, s64, s5
    s_ff1_i32_b64 s62, s[60:61]
    s_bitset0_b64 s[60:61], s62
    s_lshl_b32 s65, s62, 9
    s_add_u32 s65, s65, s6
wo_np_109:
    v_mfma_f32_16x16x32_bf16 v[36:39], v[128:131], v[48:51], 0
    v_mfma_f32_16x16x32_bf16 v[40:43], v[132:135], v[48:51], 0
    s_waitcnt lgkmcnt(2)
    v_mfma_f32_16x16x32_bf16 v[28:31], v[136:139], v[52:55], v[28:31]
    ds_read_b128 v[68:71], v117 offset:6144
    v_mfma_f32_16x16x32_bf16 v[32:35], v[140:143], v[52:55], v[32:35]
    ds_read_b128 v[72:75], v117 offset:6400
    v_mfma_f32_16x16x32_bf16 v[36:39], v[136:139], v[56:59], v[36:39]
    v_mfma_f32_16x16x32_bf16 v[40:43], v[140:143], v[56:59], v[40:43]
    ds_write_b128 v120, v[20:23] offset:0
    buffer_load_dword v118, v125, s[8:11], s65 offen sc1
    s_waitcnt lgkmcnt(3)
    v_mfma_f32_16x16x32_bf16 v[28:31], v[144:147], v[60:63], v[28:31]
    ds_read_b128 v[44:47], v117 offset:8192
    v_mfma_f32_16x16x32_bf16 v[32:35], v[148:151], v[60:63], v[32:35]
    ds_read_b128 v[48:51], v117 offset:8448
    v_mfma_f32_16x16x32_bf16 v[36:39], v[144:147], v[64:67], v[36:39]
    s_add_u32 m0, s66, 0
    s_nop 0
    buffer_load_dwordx4 v119, s[8:11], s64 offen offset:0 lds
    v_mfma_f32_16x16x32_bf16 v[40:43], v[148:151], v[64:67], v[40:43]
    ds_write_b128 v120, v[24:27] offset:1024
    s_waitcnt lgkmcnt(4)
    v_mfma_f32_16x16x32_bf16 v[28:31], v[152:155], v[68:71], v[28:31]
    ds_read_b128 v[52:55], v117 offset:10240
    v_mfma_f32_16x16x32_bf16 v[32:35], v[156:159], v[68:71], v[32:35]
    ds_read_b128 v[56:59], v117 offset:10496
    v_mfma_f32_16x16x32_bf16 v[36:39], v[152:155], v[72:75], v[36:39]
    buffer_load_dwordx4 v119, s[8:11], s64 offen offset:1024 lds
    v_mfma_f32_16x16x32_bf16 v[40:43], v[156:159], v[72:75], v[40:43]
    s_cmp_eq_u32 s74, 0
    s_cbranch_scc0 wo_o_110
    buffer_load_dwordx4 v[92:95], v124, s[8:11], s2 offen offset:0 sc1
wo_o_110:
    s_waitcnt lgkmcnt(3)
    v_mfma_f32_16x16x32_bf16 v[28:31], v[160:163], v[44:47], v[28:31]
    ds_read_b128 v[60:63], v117 offset:12288
    v_mfma_f32_16x16x32_bf16 v[32:35], v[164:167], v[44:47], v[32:35]
    ds_read_b128 v[64:67], v117 offset:12544
    v_mfma_f32_16x16x32_bf16 v[36:39], v[160:163], v[48:51], v[36:39]
    buffer_load_dwordx4 v119, s[8:11], s64 offen offset:2048 lds
    v_mfma_f32_16x16x32_bf16 v[40:43], v[164:167], v[48:51], v[40:43]
    s_cmp_eq_u32 s74, 0
    s_cbranch_scc0 wo_o_111
    buffer_load_dwordx4 v[100:103], v124, s[8:11], s3 offen offset:0 sc1
wo_o_111:
    s_waitcnt lgkmcnt(2)
    v_mfma_f32_16x16x32_bf16 v[28:31], v[168:171], v[52:55], v[28:31]
    ds_read_b128 v[68:71], v117 offset:14336
    v_mfma_f32_16x16x32_bf16 v[32:35], v[172:175], v[52:55], v[32:35]
    ds_read_b128 v[72:75], v117 offset:14592
    v_mfma_f32_16x16x32_bf16 v[36:39], v[168:171], v[56:59], v[36:39]
    buffer_load_dwordx4 v119, s[8:11], s64 offen offset:3072 lds
    s_add_u32 s64, s64, 4096
    v_mfma_f32_16x16x32_bf16 v[40:43], v[172:175], v[56:59], v[40:43]
    s_cmp_eq_u32 s74, 0
    s_cbranch_scc0 wo_o_112
    buffer_load_dwordx4 v[108:111], v124, s[8:11], s4 offen offset:0 sc1
wo_o_112:
    s_cmp_eq_u32 s74, 0
    s_cbranch_scc1 wo_w_113
    s_waitcnt vmcnt(5)
wo_w_113:
    s_waitcnt vmcnt(9)
    s_waitcnt lgkmcnt(0)
    s_barrier
    v_mfma_f32_16x16x32_bf16 v[28:31], v[176:179], v[60:63], v[28:31]
    ds_read_b128 v[4:7], v121 offset:0
    ds_read_b128 v[8:11], v121 offset:1024
    ds_read_b128 v[44:47], v117 offset:32768
    v_mfma_f32_16x16x32_bf16 v[32:35], v[180:183], v[60:63], v[32:35]
    ds_read_b128 v[48:51], v117 offset:33024
    v_mfma_f32_16x16x32_bf16 v[36:39], v[176:179], v[64:67], v[36:39]
    v_mfma_f32_16x16x32_bf16 v[40:43], v[180:183], v[64:67], v[40:43]
    s_waitcnt lgkmcnt(2)
    v_mfma_f32_16x16x32_bf16 v[28:31], v[184:187], v[68:71], v[28:31]
    ds_read_b128 v[52:55], v117 offset:34816
    v_mfma_f32_16x16x32_bf16 v[32:35], v[188:191], v[68:71], v[32:35]
    ds_read_b128 v[56:59], v117 offset:35072
    v_mfma_f32_16x16x32_bf16 v[36:39], v[184:187], v[72:75], v[36:39]
    v_mfma_f32_16x16x32_bf16 v[40:43], v[188:191], v[72:75], v[40:43]
    v_pk_add_f32 v[84:85], v[4:5], v[12:13]
    v_pk_add_f32 v[86:87], v[6:7], v[14:15]
    v_pk_add_f32 v[88:89], v[8:9], v[16:17]
    v_pk_add_f32 v[90:91], v[10:11], v[18:19]
    s_cmp_eq_u32 s74, 0
    s_cbranch_scc1 wo_e_114
    s_bfe_u32 s71, s70, 0x10002
    s_cmp_lt_i32 s73, 0
    s_cselect_b32 s63, 0x5ffffff0, s69
    v_cvt_pk_bf16_f32 v84, v84, v85
    v_cvt_pk_bf16_f32 v85, v86, v87
    v_cvt_pk_bf16_f32 v86, v88, v89
    v_cvt_pk_bf16_f32 v87, v90, v91
    v_bfi_b32 v84, 1, s71, v84
    buffer_store_dwordx4 v[84:87], v123, s[8:11], s63 offen offset:0 sc1
wo_e_114:
    s_waitcnt lgkmcnt(2)
    v_mfma_f32_16x16x32_bf16 v[28:31], v[192:195], v[44:47], v[28:31]
    ds_read_b128 v[60:63], v117 offset:36864
    v_mfma_f32_16x16x32_bf16 v[32:35], v[196:199], v[44:47], v[32:35]
    ds_read_b128 v[64:67], v117 offset:37120
    v_mfma_f32_16x16x32_bf16 v[36:39], v[192:195], v[48:51], v[36:39]
    v_mfma_f32_16x16x32_bf16 v[40:43], v[196:199], v[48:51], v[40:43]
    s_waitcnt lgkmcnt(2)
    v_mfma_f32_16x16x32_bf16 v[28:31], v[200:203], v[52:55], v[28:31]
    ds_read_b128 v[68:71], v117 offset:38912
    v_mfma_f32_16x16x32_bf16 v[32:35], v[204:207], v[52:55], v[32:35]
    ds_read_b128 v[72:75], v117 offset:39168
    v_mfma_f32_16x16x32_bf16 v[36:39], v[200:203], v[56:59], v[36:39]
    v_mfma_f32_16x16x32_bf16 v[40:43], v[204:207], v[56:59], v[40:43]
    s_cmp_lg_u32 s58, 0
    s_cbranch_scc1 wo_a_115
    s_waitcnt vmcnt(5)
    v_cmp_eq_u32 vcc, 0, v118
    s_cbranch_vccz wo_a_115
    buffer_load_dword v118, v125, s[8:11], s65 offen sc1
wo_a_115:
    s_waitcnt lgkmcnt(2)
    v_mfma_f32_16x16x32_bf16 v[28:31], v[208:211], v[60:63], v[28:31]
    ds_read_b128 v[44:47], v117 offset:40960
    v_mfma_f32_16x16x32_bf16 v[32:35], v[212:215], v[60:63], v[32:35]
    ds_read_b128 v[48:51], v117 offset:41216
    v_mfma_f32_16x16x32_bf16 v[36:39], v[208:211], v[64:67], v[36:39]
    s_add_u32 m0, s66, 32768
    s_nop 0
    buffer_load_dwordx4 v119, s[8:11], s64 offen offset:0 lds
    v_mfma_f32_16x16x32_bf16 v[40:43], v[212:215], v[64:67], v[40:43]
    s_waitcnt lgkmcnt(2)
    v_mfma_f32_16x16x32_bf16 v[28:31], v[216:219], v[68:71], v[28:31]
    ds_read_b128 v[52:55], v117 offset:43008
    v_mfma_f32_16x16x32_bf16 v[32:35], v[220:223], v[68:71], v[32:35]
    ds_read_b128 v[56:59], v117 offset:43264
    v_mfma_f32_16x16x32_bf16 v[36:39], v[216:219], v[72:75], v[36:39]
    buffer_load_dwordx4 v119, s[8:11], s64 offen offset:1024 lds
    v_mfma_f32_16x16x32_bf16 v[40:43], v[220:223], v[72:75], v[40:43]
    s_waitcnt lgkmcnt(2)
    v_mfma_f32_16x16x32_bf16 v[28:31], v[224:227], v[44:47], v[28:31]
    ds_read_b128 v[60:63], v117 offset:45056
    v_mfma_f32_16x16x32_bf16 v[32:35], v[228:231], v[44:47], v[32:35]
    ds_read_b128 v[64:67], v117 offset:45312
    v_mfma_f32_16x16x32_bf16 v[36:39], v[224:227], v[48:51], v[36:39]
    buffer_load_dwordx4 v119, s[8:11], s64 offen offset:2048 lds
    v_mfma_f32_16x16x32_bf16 v[40:43], v[228:231], v[48:51], v[40:43]
    s_cmp_lg_u32 s58, 0
    s_cbranch_scc1 wo_v_116
    s_cbranch_vccz wo_b_117
    s_waitcnt vmcnt(3)
wo_b_117:
    v_cmp_eq_u32 vcc, 0, v118
    s_nop 1
    v_mov_b32 v126, vcc_lo
    ds_write_b32 v127, v126
wo_v_116:
    s_waitcnt lgkmcnt(2)
    v_mfma_f32_16x16x32_bf16 v[28:31], v[232:235], v[52:55], v[28:31]
    ds_read_b128 v[68:71], v117 offset:47104
    v_mfma_f32_16x16x32_bf16 v[32:35], v[236:239], v[52:55], v[32:35]
    ds_read_b128 v[72:75], v117 offset:47360
    v_mfma_f32_16x16x32_bf16 v[36:39], v[232:235], v[56:59], v[36:39]
    buffer_load_dwordx4 v119, s[8:11], s64 offen offset:3072 lds
    s_add_u32 s64, s64, 4096
    v_mfma_f32_16x16x32_bf16 v[40:43], v[236:239], v[56:59], v[40:43]
    s_cmp_eq_u32 s74, 0
    s_cbranch_scc1 wo_w_118
    s_waitcnt vmcnt(5)
wo_w_118:
    s_waitcnt vmcnt(5)
    s_waitcnt lgkmcnt(0)
    s_barrier
    v_mfma_f32_16x16x32_bf16 v[28:31], v[240:243], v[60:63], v[28:31]
    ds_read_b32 v126, v127
    ds_read_b128 v[44:47], v116 offset:0
    v_mfma_f32_16x16x32_bf16 v[32:35], v[244:247], v[60:63], v[32:35]
    ds_read_b128 v[48:51], v116 offset:256
    v_mfma_f32_16x16x32_bf16 v[36:39], v[240:243], v[64:67], v[36:39]
    v_mfma_f32_16x16x32_bf16 v[40:43], v[244:247], v[64:67], v[40:43]
    v_mfma_f32_16x16x32_bf16 v[28:31], v[248:251], v[68:71], v[28:31]
    ds_read_b128 v[52:55], v116 offset:2048
    v_mfma_f32_16x16x32_bf16 v[32:35], v[252:255], v[68:71], v[32:35]
    ds_read_b128 v[56:59], v116 offset:2304
    v_mfma_f32_16x16x32_bf16 v[36:39], v[248:251], v[72:75], v[36:39]
    v_mfma_f32_16x16x32_bf16 v[40:43], v[252:255], v[72:75], v[40:43]
    s_cmp_lg_u32 s74, 0
    s_cbranch_scc1 wo_k_119
    s_cmp_eq_u32 s67, 0x5ffffff0
    s_cbranch_scc1 wo_s_121
    s_waitcnt vmcnt(4)
    v_bitop3_b32 v2, v92, v100, s71 bitop3:0x7e
    v_xor_b32 v3, s71, v108
    v_bitop3_b32 v2, v2, v3, 1 bitop3:0xa8
    v_cmp_ne_u32 vcc, 0, v2
    s_cbranch_vccz pollpart_ok_123
pollpart_122:
    buffer_load_dwordx4 v[92:95], v124, s[8:11], s2 offen offset:0 sc1
    buffer_load_dwordx4 v[100:103], v124, s[8:11], s3 offen offset:0 sc1
    buffer_load_dwordx4 v[108:111], v124, s[8:11], s4 offen offset:0 sc1
    s_waitcnt vmcnt(0)
    v_bitop3_b32 v2, v92, v100, s71 bitop3:0x7e
    v_xor_b32 v3, s71, v108
    v_bitop3_b32 v2, v2, v3, 1 bitop3:0xa8
    v_cmp_ne_u32 vcc, 0, v2
    s_cbranch_vccz pollpart_ok_123
    s_sub_u32 s77, s77, 1
    s_cbranch_scc0 pollpart_122
    s_mov_b32 s77, 0
pollpart_ok_123:
    v_dot2_f32_bf16 v76, v92, v96, v76
    v_dot2_f32_bf16 v77, v92, v97, v77
    v_dot2_f32_bf16 v78, v93, v96, v78
    v_dot2_f32_bf16 v79, v93, v97, v79
    v_dot2_f32_bf16 v80, v94, v96, v80
    v_dot2_f32_bf16 v81, v94, v97, v81
    v_dot2_f32_bf16 v82, v95, v96, v82
    v_dot2_f32_bf16 v83, v95, v97, v83
    v_dot2_f32_bf16 v76, v100, v96, v76
    v_dot2_f32_bf16 v77, v100, v97, v77
    v_dot2_f32_bf16 v78, v101, v96, v78
    v_dot2_f32_bf16 v79, v101, v97, v79
    v_dot2_f32_bf16 v80, v102, v96, v80
    v_dot2_f32_bf16 v81, v102, v97, v81
    v_dot2_f32_bf16 v82, v103, v96, v82
    v_dot2_f32_bf16 v83, v103, v97, v83
    v_dot2_f32_bf16 v76, v108, v96, v76
    v_dot2_f32_bf16 v77, v108, v97, v77
    v_dot2_f32_bf16 v78, v109, v96, v78
    v_dot2_f32_bf16 v79, v109, v97, v79
    v_dot2_f32_bf16 v80, v110, v96, v80
    v_dot2_f32_bf16 v81, v110, v97, v81
    v_dot2_f32_bf16 v82, v111, v96, v82
    v_dot2_f32_bf16 v83, v111, v97, v83
    v_cvt_pk_bf16_f32 v92, v76, v77
    v_cvt_pk_bf16_f32 v93, v78, v79
    v_cvt_pk_bf16_f32 v94, v80, v81
    v_cvt_pk_bf16_f32 v95, v82, v83
wo_s_121:
    buffer_store_dwordx4 v[92:95], v122, s[16:19], s67 offen offset:2048 sc1
wo_k_119:
    s_cmp_lt_i32 s73, 0
    s_cbranch_scc1 wo_e_120
    s_bfe_u32 s71, s70, 0x10002
    s_add_u32 s70, s70, 1
    v_pk_mov_b32 v[76:77], v[84:85], v[84:85] op_sel:[0,1]
    v_pk_mov_b32 v[78:79], v[86:87], v[86:87] op_sel:[0,1]
    v_pk_mov_b32 v[80:81], v[88:89], v[88:89] op_sel:[0,1]
    v_pk_mov_b32 v[82:83], v[90:91], v[90:91] op_sel:[0,1]
    v_mov_b32 v124, v123
    s_lshl_b32 s67, s73, 17
    s_add_u32 s67, s67, s7
    v_add_u32 v123, 0x80000, v123
    v_and_b32 v123, 0x1fffff, v123
wo_e_120:
    s_cmp_eq_u32 s68, 0
    s_cbranch_scc1 wo_loop_86
    s_cmp_ge_i32 s62, 0
    s_cbranch_scc1 wo_slow_85
wo_f0_88:
    ds_write_b128 v120, v[36:39] offset:0
    ds_write_b128 v120, v[40:43] offset:1024
    s_mov_b32 s73, s59
    s_cmp_eq_u32 s74, 0
    s_cbranch_scc0 wo_o_124
    buffer_load_dwordx4 v[92:95], v124, s[8:11], s2 offen offset:0 sc1
    buffer_load_dwordx4 v[100:103], v124, s[8:11], s3 offen offset:0 sc1
    buffer_load_dwordx4 v[108:111], v124, s[8:11], s4 offen offset:0 sc1
wo_o_124:
    s_waitcnt lgkmcnt(0)
    s_barrier
    ds_read_b128 v[4:7], v121 offset:0
    ds_read_b128 v[8:11], v121 offset:1024
    s_waitcnt lgkmcnt(0)
    v_pk_add_f32 v[84:85], v[4:5], v[28:29]
    v_pk_add_f32 v[86:87], v[6:7], v[30:31]
    v_pk_add_f32 v[88:89], v[8:9], v[32:33]
    v_pk_add_f32 v[90:91], v[10:11], v[34:35]
    s_cmp_eq_u32 s74, 0
    s_cbranch_scc1 wo_e_125
    s_bfe_u32 s71, s70, 0x10002
    s_cmp_lt_i32 s73, 0
    s_cselect_b32 s63, 0x5ffffff0, s69
    v_cvt_pk_bf16_f32 v84, v84, v85
    v_cvt_pk_bf16_f32 v85, v86, v87
    v_cvt_pk_bf16_f32 v86, v88, v89
    v_cvt_pk_bf16_f32 v87, v90, v91
    v_bfi_b32 v84, 1, s71, v84
    buffer_store_dwordx4 v[84:87], v123, s[8:11], s63 offen offset:0 sc1
wo_e_125:
    s_cmp_lg_u32 s74, 0
    s_cbranch_scc1 wo_k_126
    s_cmp_eq_u32 s67, 0x5ffffff0
    s_cbranch_scc1 wo_s_128
    s_waitcnt vmcnt(0)
    v_bitop3_b32 v2, v92, v100, s71 bitop3:0x7e
    v_xor_b32 v3, s71, v108
    v_bitop3_b32 v2, v2, v3, 1 bitop3:0xa8
    v_cmp_ne_u32 vcc, 0, v2
    s_cbranch_vccz pollpart_ok_130
pollpart_129:
    buffer_load_dwordx4 v[92:95], v124, s[8:11], s2 offen offset:0 sc1
    buffer_load_dwordx4 v[100:103], v124, s[8:11], s3 offen offset:0 sc1
    buffer_load_dwordx4 v[108:111], v124, s[8:11], s4 offen offset:0 sc1
    s_waitcnt vmcnt(0)
    v_bitop3_b32 v2, v92, v100, s71 bitop3:0x7e
    v_xor_b32 v3, s71, v108
    v_bitop3_b32 v2, v2, v3, 1 bitop3:0xa8
    v_cmp_ne_u32 vcc, 0, v2
    s_cbranch_vccz pollpart_ok_130
    s_sub_u32 s77, s77, 1
    s_cbranch_scc0 pollpart_129
    s_mov_b32 s77, 0
pollpart_ok_130:
    v_dot2_f32_bf16 v76, v92, v96, v76
    v_dot2_f32_bf16 v77, v92, v97, v77
    v_dot2_f32_bf16 v78, v93, v96, v78
    v_dot2_f32_bf16 v79, v93, v97, v79
    v_dot2_f32_bf16 v80, v94, v96, v80
    v_dot2_f32_bf16 v81, v94, v97, v81
    v_dot2_f32_bf16 v82, v95, v96, v82
    v_dot2_f32_bf16 v83, v95, v97, v83
    v_dot2_f32_bf16 v76, v100, v96, v76
    v_dot2_f32_bf16 v77, v100, v97, v77
    v_dot2_f32_bf16 v78, v101, v96, v78
    v_dot2_f32_bf16 v79, v101, v97, v79
    v_dot2_f32_bf16 v80, v102, v96, v80
    v_dot2_f32_bf16 v81, v102, v97, v81
    v_dot2_f32_bf16 v82, v103, v96, v82
    v_dot2_f32_bf16 v83, v103, v97, v83
    v_dot2_f32_bf16 v76, v108, v96, v76
    v_dot2_f32_bf16 v77, v108, v97, v77
    v_dot2_f32_bf16 v78, v109, v96, v78
    v_dot2_f32_bf16 v79, v109, v97, v79
    v_dot2_f32_bf16 v80, v110, v96, v80
    v_dot2_f32_bf16 v81, v110, v97, v81
    v_dot2_f32_bf16 v82, v111, v96, v82
    v_dot2_f32_bf16 v83, v111, v97, v83
    v_cvt_pk_bf16_f32 v92, v76, v77
    v_cvt_pk_bf16_f32 v93, v78, v79
    v_cvt_pk_bf16_f32 v94, v80, v81
    v_cvt_pk_bf16_f32 v95, v82, v83
wo_s_128:
    buffer_store_dwordx4 v[92:95], v122, s[16:19], s67 offen offset:2048 sc1
wo_k_126:
    s_cmp_lt_i32 s73, 0
    s_cbranch_scc1 wo_e_127
    s_bfe_u32 s71, s70, 0x10002
    s_add_u32 s70, s70, 1
    v_pk_mov_b32 v[76:77], v[84:85], v[84:85] op_sel:[0,1]
    v_pk_mov_b32 v[78:79], v[86:87], v[86:87] op_sel:[0,1]
    v_pk_mov_b32 v[80:81], v[88:89], v[88:89] op_sel:[0,1]
    v_pk_mov_b32 v[82:83], v[90:91], v[90:91] op_sel:[0,1]
    v_mov_b32 v124, v123
    s_lshl_b32 s67, s73, 17
    s_add_u32 s67, s67, s7
    v_add_u32 v123, 0x80000, v123
    v_and_b32 v123, 0x1fffff, v123
wo_e_127:
    s_cmp_eq_u32 s74, 0
    s_cbranch_scc0 wo_o_131
pollpart_132:
    buffer_load_dwordx4 v[92:95], v124, s[8:11], s2 offen offset:0 sc1
    buffer_load_dwordx4 v[100:103], v124, s[8:11], s3 offen offset:0 sc1
    buffer_load_dwordx4 v[108:111], v124, s[8:11], s4 offen offset:0 sc1
    s_waitcnt vmcnt(0)
    v_bitop3_b32 v2, v92, v100, s71 bitop3:0x7e
    v_xor_b32 v3, s71, v108
    v_bitop3_b32 v2, v2, v3, 1 bitop3:0xa8
    v_cmp_ne_u32 vcc, 0, v2
    s_cbranch_vccz pollpart_ok_133
    s_sub_u32 s77, s77, 1
    s_cbranch_scc0 pollpart_132
    s_mov_b32 s77, 0
pollpart_ok_133:
    v_dot2_f32_bf16 v76, v92, v96, v76
    v_dot2_f32_bf16 v77, v92, v97, v77
    v_dot2_f32_bf16 v78, v93, v96, v78
    v_dot2_f32_bf16 v79, v93, v97, v79
    v_dot2_f32_bf16 v80, v94, v96, v80
    v_dot2_f32_bf16 v81, v94, v97, v81
    v_dot2_f32_bf16 v82, v95, v96, v82
    v_dot2_f32_bf16 v83, v95, v97, v83
    v_dot2_f32_bf16 v76, v100, v96, v76
    v_dot2_f32_bf16 v77, v100, v97, v77
    v_dot2_f32_bf16 v78, v101, v96, v78
    v_dot2_f32_bf16 v79, v101, v97, v79
    v_dot2_f32_bf16 v80, v102, v96, v80
    v_dot2_f32_bf16 v81, v102, v97, v81
    v_dot2_f32_bf16 v82, v103, v96, v82
    v_dot2_f32_bf16 v83, v103, v97, v83
    v_dot2_f32_bf16 v76, v108, v96, v76
    v_dot2_f32_bf16 v77, v108, v97, v77
    v_dot2_f32_bf16 v78, v109, v96, v78
    v_dot2_f32_bf16 v79, v109, v97, v79
    v_dot2_f32_bf16 v80, v110, v96, v80
    v_dot2_f32_bf16 v81, v110, v97, v81
    v_dot2_f32_bf16 v82, v111, v96, v82
    v_dot2_f32_bf16 v83, v111, v97, v83
    v_cvt_pk_bf16_f32 v92, v76, v77
    v_cvt_pk_bf16_f32 v93, v78, v79
    v_cvt_pk_bf16_f32 v94, v80, v81
    v_cvt_pk_bf16_f32 v95, v82, v83
    buffer_store_dwordx4 v[92:95], v122, s[16:19], s67 offen offset:2048 sc1
wo_o_131:
    s_branch end_64
wo_fl_87:
    s_cmp_lt_i32 s62, 0
    s_cbranch_scc1 wo_m_134
    s_lshl_b32 s63, s58, 2
    s_add_u32 s65, s65, s63
pollfl_135:
    buffer_load_dword v118, off, s[8:11], s65 sc1
    s_waitcnt vmcnt(0)
    v_cmp_eq_u32 vcc, 0, v118
    s_cbranch_vccz pollfl_ok_136
    s_sub_u32 s77, s77, 1
    s_cbranch_scc0 pollfl_135
    s_mov_b32 s77, 0
pollfl_ok_136:
    s_mov_b32 s72, s62
    s_lshl_b32 s64, s62, 18
    s_add_u32 s64, s64, s5
    s_ff1_i32_b64 s62, s[60:61]
    s_bitset0_b64 s[60:61], s62
    s_lshl_b32 s65, s62, 9
    s_add_u32 s65, s65, s6
    s_add_u32 m0, s66, 65536
    s_nop 0
    buffer_load_dwordx4 v119, s[8:11], s64 offen offset:0 lds
    buffer_load_dwordx4 v119, s[8:11], s64 offen offset:1024 lds
    buffer_load_dwordx4 v119, s[8:11], s64 offen offset:2048 lds
    buffer_load_dwordx4 v119, s[8:11], s64 offen offset:3072 lds
    s_add_u32 s64, s64, 4096
    buffer_load_dword v118, v125, s[8:11], s65 offen sc1
    s_add_u32 m0, s66, 98304
    s_nop 0
    buffer_load_dwordx4 v119, s[8:11], s64 offen offset:0 lds
    buffer_load_dwordx4 v119, s[8:11], s64 offen offset:1024 lds
    buffer_load_dwordx4 v119, s[8:11], s64 offen offset:2048 lds
    buffer_load_dwordx4 v119, s[8:11], s64 offen offset:3072 lds
    s_add_u32 s64, s64, 4096
    s_mov_b32 s63, 0x5ffffff0
    buffer_load_dword v3, off, s[8:11], s63
    s_waitcnt vmcnt(5)
    s_cmp_lg_u32 s58, 0
    s_cbranch_scc1 wo_v_137
    v_cmp_eq_u32 vcc, 0, v118
    s_nop 1
    v_mov_b32 v126, vcc_lo
    ds_write_b32 v127, v126
wo_v_137:
    s_waitcnt lgkmcnt(0)
    s_barrier
    ds_read_b32 v126, v127
    ds_read_b128 v[44:47], v117 offset:0
    ds_read_b128 v[48:51], v117 offset:256
    ds_read_b128 v[52:55], v117 offset:2048
    ds_read_b128 v[56:59], v117 offset:2304
    s_branch wo_out_89
wo_m_134:
    s_nop 7
    v_mov_b32 v28, v12
    v_mov_b32 v29, v13
    v_mov_b32 v30, v14
    v_mov_b32 v31, v15
    v_mov_b32 v32, v16
    v_mov_b32 v33, v17
    v_mov_b32 v34, v18
    v_mov_b32 v35, v19
    v_mov_b32 v36, v20
    v_mov_b32 v37, v21
    v_mov_b32 v38, v22
    v_mov_b32 v39, v23
    v_mov_b32 v40, v24
    v_mov_b32 v41, v25
    v_mov_b32 v42, v26
    v_mov_b32 v43, v27
    s_branch wo_f0_88
fft_55:
    v_bfe_u32 v120, v1, 0, 1
    v_lshlrev_b32 v120, 7, v120
    v_bfe_u32 v121, v1, 1, 5
    v_lshl_or_b32 v120, v121, 13, v120
    s_bfe_u32 s79, s58, 0x20000
    s_lshl_b32 s79, s79, 19
    s_bfe_u32 s85, s58, 0x10002
    s_lshl_b32 s85, s85, 22
    s_or_b32 s79, s79, s85
    s_bfe_u32 s80, s76, 0x30000
    s_lshl_b32 s80, s80, 8
    s_bfe_u32 s85, s76, 0x20005
    s_lshl_b32 s85, s85, 11
    s_or_b32 s80, s80, s85
    s_bfe_u32 s85, s76, 0x10000
    s_lshl_b32 s85, s85, 21
    s_or_b32 s80, s80, s85
    s_add_u32 s79, s79, s80
    s_xor_b32 s85, s79, 0x240000
    buffer_load_dword v122, v120, s[24:27], s85 offen
    s_xor_b32 s85, s79, 0x240000
    buffer_load_dword v123, v120, s[28:31], s85 offen
    s_mov_b64 s[60:61], s[44:45]
    s_mov_b32 s62, 0x400000
    s_mov_b32 s63, 0x20000
    s_mov_b32 s81, 0x5400000
    s_mov_b32 s83, 48
    s_mov_b32 s6, 0x10000
    s_mov_b32 s7, 0
    s_branch gen_63
col_62:
    s_waitcnt vmcnt(0) lgkmcnt(0)
    s_barrier
    s_cmp_lg_u32 s58, 0
    s_cbranch_scc1 sig_138
    v_mov_b32 v75, 0x5ffffff0
    v_mov_b32 v76, 40
    v_cmp_eq_u32 vcc, 0, v1
    s_nop 1
    v_cndmask_b32 v76, v75, v76, vcc
    v_mov_b32 v75, 1
    buffer_atomic_add v75, v76, s[12:15], 0 offen sc1
sig_138:
    s_bfe_u32 s79, s76, 0x30000
    s_bfe_u32 s85, s76, 0x20005
    s_lshl_b32 s85, s85, 3
    s_or_b32 s79, s79, s85
    v_bfe_u32 v231, v1, 0, 5
    v_bfe_u32 v235, v1, 5, 1
    v_lshl_or_b32 v231, v235, 7, v231
    v_mul_u32_u24 v231, 1026, v231
    v_and_b32 v231, -4, v231
    s_mul_i32 s5, s58, 262656
    s_lshl_b32 s2, s79, 5
    s_add_u32 s5, s5, s2
    buffer_load_dwordx4 v[84:87], v231, s[48:51], s5 offen
    buffer_load_dwordx4 v[88:91], v231, s[48:51], s5 offen offset:16
    buffer_load_dword v92, v231, s[48:51], s5 offen offset:32
    buffer_load_dwordx4 v[94:97], v231, s[52:55], s5 offen
    buffer_load_dwordx4 v[98:101], v231, s[52:55], s5 offen offset:16
    buffer_load_dword v102, v231, s[52:55], s5 offen offset:32
    s_add_u32 s5, s5, 32832
    buffer_load_dwordx4 v[104:107], v231, s[48:51], s5 offen
    buffer_load_dwordx4 v[108:111], v231, s[48:51], s5 offen offset:16
    buffer_load_dword v112, v231, s[48:51], s5 offen offset:32
    buffer_load_dwordx4 v[114:117], v231, s[52:55], s5 offen
    buffer_load_dwordx4 v[118:121], v231, s[52:55], s5 offen offset:16
    buffer_load_dword v122, v231, s[52:55], s5 offen offset:32
    s_add_u32 s5, s5, 32832
    buffer_load_dwordx4 v[124:127], v231, s[48:51], s5 offen
    buffer_load_dwordx4 v[128:131], v231, s[48:51], s5 offen offset:16
    buffer_load_dword v132, v231, s[48:51], s5 offen offset:32
    buffer_load_dwordx4 v[134:137], v231, s[52:55], s5 offen
    buffer_load_dwordx4 v[138:141], v231, s[52:55], s5 offen offset:16
    buffer_load_dword v142, v231, s[52:55], s5 offen offset:32
    s_add_u32 s5, s5, 32832
    buffer_load_dwordx4 v[144:147], v231, s[48:51], s5 offen
    buffer_load_dwordx4 v[148:151], v231, s[48:51], s5 offen offset:16
    buffer_load_dword v152, v231, s[48:51], s5 offen offset:32
    buffer_load_dwordx4 v[154:157], v231, s[52:55], s5 offen
    buffer_load_dwordx4 v[158:161], v231, s[52:55], s5 offen offset:16
    buffer_load_dword v162, v231, s[52:55], s5 offen offset:32
    s_add_u32 s5, s5, 32832
    v_and_b32 v235, 31, v1
    v_cvt_f32_u32 v228, v235
    v_and_b32 v235, 32, v1
    v_cvt_f32_u32 v235, v235
    v_mul_f32 v229, v228, v235
    v_mul_f32 v229, 0x3b000000, v229
    v_mul_f32 v234, 0x3d000000, v229
    v_fmamk_f32 v230, v235, 0x3b000000, v234
    v_and_b32 v233, 1, v1
    v_lshlrev_b32 v232, 4, v233
    v_mul_u32_u24 v233, 0x8000, v233
    v_lshl_or_b32 v233, v233, 16, v233
    v_fmamk_f32 v243, v228, 0x0, v229
    v_add_f32 v244, v243, v243
    v_cos_f32 v235, v243
    v_sin_f32 v237, v243
    v_cos_f32 v239, v244
    v_sin_f32 v241, v244
    v_fmamk_f32 v243, v228, 0x3c800000, v229
    v_add_f32 v244, v243, v243
    v_cos_f32 v236, v243
    v_sin_f32 v238, v243
    v_cos_f32 v240, v244
    v_sin_f32 v242, v244
    v_cvt_pk_bf16_f32 v4, v235, v236
    v_cvt_pk_bf16_f32 v36, v237, v238
    v_cvt_pk_bf16_f32 v68, v239, v240
    v_cvt_pk_bf16_f32 v76, v241, v242
    v_fmamk_f32 v243, v228, 0x3d000000, v229
    v_add_f32 v244, v243, v243
    v_cos_f32 v235, v243
    v_sin_f32 v237, v243
    v_cos_f32 v239, v244
    v_sin_f32 v241, v244
    v_fmamk_f32 v243, v228, 0x3d400000, v229
    v_add_f32 v244, v243, v243
    v_cos_f32 v236, v243
    v_sin_f32 v238, v243
    v_cos_f32 v240, v244
    v_sin_f32 v242, v244
    v_cvt_pk_bf16_f32 v5, v235, v236
    v_cvt_pk_bf16_f32 v37, v237, v238
    v_cvt_pk_bf16_f32 v69, v239, v240
    v_cvt_pk_bf16_f32 v77, v241, v242
    v_fmamk_f32 v243, v228, 0x3e000000, v229
    v_add_f32 v244, v243, v243
    v_cos_f32 v235, v243
    v_sin_f32 v237, v243
    v_cos_f32 v239, v244
    v_sin_f32 v241, v244
    v_fmamk_f32 v243, v228, 0x3e100000, v229
    v_add_f32 v244, v243, v243
    v_cos_f32 v236, v243
    v_sin_f32 v238, v243
    v_cos_f32 v240, v244
    v_sin_f32 v242, v244
    v_cvt_pk_bf16_f32 v6, v235, v236
    v_cvt_pk_bf16_f32 v38, v237, v238
    v_cvt_pk_bf16_f32 v70, v239, v240
    v_cvt_pk_bf16_f32 v78, v241, v242
    v_fmamk_f32 v243, v228, 0x3e200000, v229
    v_add_f32 v244, v243, v243
    v_cos_f32 v235, v243
    v_sin_f32 v237, v243
    v_cos_f32 v239, v244
    v_sin_f32 v241, v244
    v_fmamk_f32 v243, v228, 0x3e300000, v229
    v_add_f32 v244, v243, v243
    v_cos_f32 v236, v243
    v_sin_f32 v238, v243
    v_cos_f32 v240, v244
    v_sin_f32 v242, v244
    v_cvt_pk_bf16_f32 v7, v235, v236
    v_cvt_pk_bf16_f32 v39, v237, v238
    v_cvt_pk_bf16_f32 v71, v239, v240
    v_cvt_pk_bf16_f32 v79, v241, v242
    v_fmamk_f32 v243, v228, 0x3e800000, v229
    v_add_f32 v244, v243, v243
    v_cos_f32 v235, v243
    v_sin_f32 v237, v243
    v_cos_f32 v239, v244
    v_sin_f32 v241, v244
    v_fmamk_f32 v243, v228, 0x3e880000, v229
    v_add_f32 v244, v243, v243
    v_cos_f32 v236, v243
    v_sin_f32 v238, v243
    v_cos_f32 v240, v244
    v_sin_f32 v242, v244
    v_cvt_pk_bf16_f32 v8, v235, v236
    v_cvt_pk_bf16_f32 v40, v237, v238
    v_cvt_pk_bf16_f32 v72, v239, v240
    v_cvt_pk_bf16_f32 v80, v241, v242
    v_fmamk_f32 v243, v228, 0x3e900000, v229
    v_add_f32 v244, v243, v243
    v_cos_f32 v235, v243
    v_sin_f32 v237, v243
    v_cos_f32 v239, v244
    v_sin_f32 v241, v244
    v_fmamk_f32 v243, v228, 0x3e980000, v229
    v_add_f32 v244, v243, v243
    v_cos_f32 v236, v243
    v_sin_f32 v238, v243
    v_cos_f32 v240, v244
    v_sin_f32 v242, v244
    v_cvt_pk_bf16_f32 v9, v235, v236
    v_cvt_pk_bf16_f32 v41, v237, v238
    v_cvt_pk_bf16_f32 v73, v239, v240
    v_cvt_pk_bf16_f32 v81, v241, v242
    v_fmamk_f32 v243, v228, 0x3ec00000, v229
    v_add_f32 v244, v243, v243
    v_cos_f32 v235, v243
    v_sin_f32 v237, v243
    v_cos_f32 v239, v244
    v_sin_f32 v241, v244
    v_fmamk_f32 v243, v228, 0x3ec80000, v229
    v_add_f32 v244, v243, v243
    v_cos_f32 v236, v243
    v_sin_f32 v238, v243
    v_cos_f32 v240, v244
    v_sin_f32 v242, v244
    v_cvt_pk_bf16_f32 v10, v235, v236
    v_cvt_pk_bf16_f32 v42, v237, v238
    v_cvt_pk_bf16_f32 v74, v239, v240
    v_cvt_pk_bf16_f32 v82, v241, v242
    v_fmamk_f32 v243, v228, 0x3ed00000, v229
    v_add_f32 v244, v243, v243
    v_cos_f32 v235, v243
    v_sin_f32 v237, v243
    v_cos_f32 v239, v244
    v_sin_f32 v241, v244
    v_fmamk_f32 v243, v228, 0x3ed80000, v229
    v_add_f32 v244, v243, v243
    v_cos_f32 v236, v243
    v_sin_f32 v238, v243
    v_cos_f32 v240, v244
    v_sin_f32 v242, v244
    v_cvt_pk_bf16_f32 v11, v235, v236
    v_cvt_pk_bf16_f32 v43, v237, v238
    v_cvt_pk_bf16_f32 v75, v239, v240
    v_cvt_pk_bf16_f32 v83, v241, v242
    v_xor_b32 v12, v233, v4
    v_xor_b32 v13, v233, v5
    v_xor_b32 v14, v233, v6
    v_xor_b32 v15, v233, v7
    v_xor_b32 v16, v233, v8
    v_xor_b32 v17, v233, v9
    v_xor_b32 v18, v233, v10
    v_xor_b32 v19, v233, v11
    v_xor_b32 v20, 0x80000000, v4
    v_xor_b32 v21, 0x80000000, v5
    v_xor_b32 v22, 0x80000000, v6
    v_xor_b32 v23, 0x80000000, v7
    v_xor_b32 v24, 0x80000000, v8
    v_xor_b32 v25, 0x80000000, v9
    v_xor_b32 v26, 0x80000000, v10
    v_xor_b32 v27, 0x80000000, v11
    v_xor_b32 v28, 0x80000000, v12
    v_xor_b32 v29, 0x80000000, v13
    v_xor_b32 v30, 0x80000000, v14
    v_xor_b32 v31, 0x80000000, v15
    v_xor_b32 v32, 0x80000000, v16
    v_xor_b32 v33, 0x80000000, v17
    v_xor_b32 v34, 0x80000000, v18
    v_xor_b32 v35, 0x80000000, v19
    v_xor_b32 v44, v233, v36
    v_xor_b32 v45, v233, v37
    v_xor_b32 v46, v233, v38
    v_xor_b32 v47, v233, v39
    v_xor_b32 v48, v233, v40
    v_xor_b32 v49, v233, v41
    v_xor_b32 v50, v233, v42
    v_xor_b32 v51, v233, v43
    v_xor_b32 v52, 0x80000000, v36
    v_xor_b32 v53, 0x80000000, v37
    v_xor_b32 v54, 0x80000000, v38
    v_xor_b32 v55, 0x80000000, v39
    v_xor_b32 v56, 0x80000000, v40
    v_xor_b32 v57, 0x80000000, v41
    v_xor_b32 v58, 0x80000000, v42
    v_xor_b32 v59, 0x80000000, v43
    v_xor_b32 v60, 0x80000000, v44
    v_xor_b32 v61, 0x80000000, v45
    v_xor_b32 v62, 0x80000000, v46
    v_xor_b32 v63, 0x80000000, v47
    v_xor_b32 v64, 0x80000000, v48
    v_xor_b32 v65, 0x80000000, v49
    v_xor_b32 v66, 0x80000000, v50
    v_xor_b32 v67, 0x80000000, v51
    s_mov_b32 s2, 0x05040100
    s_mov_b32 s3, 0x07060302
    s_lshl_b32 s5, s58, 10
    v_lshl_add_u32 v231, v1, 4, s5
    v_add_u32 v233, 0x10000, v231
    v_add_u32 v235, 0x20000, v231
    s_waitcnt vmcnt(0)
    v_alignbit_b32 v84, v85, v84, v232
    v_alignbit_b32 v94, v95, v94, v232
    v_alignbit_b32 v104, v105, v104, v232
    v_alignbit_b32 v114, v115, v114, v232
    v_alignbit_b32 v124, v125, v124, v232
    v_alignbit_b32 v134, v135, v134, v232
    v_alignbit_b32 v144, v145, v144, v232
    v_alignbit_b32 v154, v155, v154, v232
    v_perm_b32 v196, v94, v84, s2
    v_perm_b32 v197, v114, v104, s2
    v_perm_b32 v198, v134, v124, s2
    v_perm_b32 v199, v154, v144, s2
    ds_write_b128 v231, v[196:199] offset:0
    v_perm_b32 v200, v94, v84, s3
    v_perm_b32 v201, v114, v104, s3
    v_perm_b32 v202, v134, v124, s3
    v_perm_b32 v203, v154, v144, s3
    ds_write_b128 v231, v[200:203] offset:8192
    v_alignbit_b32 v85, v86, v85, v232
    v_alignbit_b32 v95, v96, v95, v232
    v_alignbit_b32 v105, v106, v105, v232
    v_alignbit_b32 v115, v116, v115, v232
    v_alignbit_b32 v125, v126, v125, v232
    v_alignbit_b32 v135, v136, v135, v232
    v_alignbit_b32 v145, v146, v145, v232
    v_alignbit_b32 v155, v156, v155, v232
    v_perm_b32 v204, v95, v85, s2
    v_perm_b32 v205, v115, v105, s2
    v_perm_b32 v206, v135, v125, s2
    v_perm_b32 v207, v155, v145, s2
    ds_write_b128 v231, v[204:207] offset:16384
    v_perm_b32 v208, v95, v85, s3
    v_perm_b32 v209, v115, v105, s3
    v_perm_b32 v210, v135, v125, s3
    v_perm_b32 v211, v155, v145, s3
    ds_write_b128 v231, v[208:211] offset:24576
    v_alignbit_b32 v86, v87, v86, v232
    v_alignbit_b32 v96, v97, v96, v232
    v_alignbit_b32 v106, v107, v106, v232
    v_alignbit_b32 v116, v117, v116, v232
    v_alignbit_b32 v126, v127, v126, v232
    v_alignbit_b32 v136, v137, v136, v232
    v_alignbit_b32 v146, v147, v146, v232
    v_alignbit_b32 v156, v157, v156, v232
    v_perm_b32 v212, v96, v86, s2
    v_perm_b32 v213, v116, v106, s2
    v_perm_b32 v214, v136, v126, s2
    v_perm_b32 v215, v156, v146, s2
    ds_write_b128 v231, v[212:215] offset:32768
    v_perm_b32 v216, v96, v86, s3
    v_perm_b32 v217, v116, v106, s3
    v_perm_b32 v218, v136, v126, s3
    v_perm_b32 v219, v156, v146, s3
    ds_write_b128 v231, v[216:219] offset:40960
    v_alignbit_b32 v87, v88, v87, v232
    v_alignbit_b32 v97, v98, v97, v232
    v_alignbit_b32 v107, v108, v107, v232
    v_alignbit_b32 v117, v118, v117, v232
    v_alignbit_b32 v127, v128, v127, v232
    v_alignbit_b32 v137, v138, v137, v232
    v_alignbit_b32 v147, v148, v147, v232
    v_alignbit_b32 v157, v158, v157, v232
    v_perm_b32 v220, v97, v87, s2
    v_perm_b32 v221, v117, v107, s2
    v_perm_b32 v222, v137, v127, s2
    v_perm_b32 v223, v157, v147, s2
    ds_write_b128 v231, v[220:223] offset:49152
    v_perm_b32 v224, v97, v87, s3
    v_perm_b32 v225, v117, v107, s3
    v_perm_b32 v226, v137, v127, s3
    v_perm_b32 v227, v157, v147, s3
    ds_write_b128 v231, v[224:227] offset:57344
    v_alignbit_b32 v88, v89, v88, v232
    v_alignbit_b32 v98, v99, v98, v232
    v_alignbit_b32 v108, v109, v108, v232
    v_alignbit_b32 v118, v119, v118, v232
    v_alignbit_b32 v128, v129, v128, v232
    v_alignbit_b32 v138, v139, v138, v232
    v_alignbit_b32 v148, v149, v148, v232
    v_alignbit_b32 v158, v159, v158, v232
    v_perm_b32 v196, v98, v88, s2
    v_perm_b32 v197, v118, v108, s2
    v_perm_b32 v198, v138, v128, s2
    v_perm_b32 v199, v158, v148, s2
    ds_write_b128 v233, v[196:199] offset:0
    v_perm_b32 v200, v98, v88, s3
    v_perm_b32 v201, v118, v108, s3
    v_perm_b32 v202, v138, v128, s3
    v_perm_b32 v203, v158, v148, s3
    ds_write_b128 v233, v[200:203] offset:8192
    v_alignbit_b32 v89, v90, v89, v232
    v_alignbit_b32 v99, v100, v99, v232
    v_alignbit_b32 v109, v110, v109, v232
    v_alignbit_b32 v119, v120, v119, v232
    v_alignbit_b32 v129, v130, v129, v232
    v_alignbit_b32 v139, v140, v139, v232
    v_alignbit_b32 v149, v150, v149, v232
    v_alignbit_b32 v159, v160, v159, v232
    v_perm_b32 v204, v99, v89, s2
    v_perm_b32 v205, v119, v109, s2
    v_perm_b32 v206, v139, v129, s2
    v_perm_b32 v207, v159, v149, s2
    ds_write_b128 v233, v[204:207] offset:16384
    v_perm_b32 v208, v99, v89, s3
    v_perm_b32 v209, v119, v109, s3
    v_perm_b32 v210, v139, v129, s3
    v_perm_b32 v211, v159, v149, s3
    ds_write_b128 v233, v[208:211] offset:24576
    v_alignbit_b32 v90, v91, v90, v232
    v_alignbit_b32 v100, v101, v100, v232
    v_alignbit_b32 v110, v111, v110, v232
    v_alignbit_b32 v120, v121, v120, v232
    v_alignbit_b32 v130, v131, v130, v232
    v_alignbit_b32 v140, v141, v140, v232
    v_alignbit_b32 v150, v151, v150, v232
    v_alignbit_b32 v160, v161, v160, v232
    v_perm_b32 v212, v100, v90, s2
    v_perm_b32 v213, v120, v110, s2
    v_perm_b32 v214, v140, v130, s2
    v_perm_b32 v215, v160, v150, s2
    ds_write_b128 v233, v[212:215] offset:32768
    v_perm_b32 v216, v100, v90, s3
    v_perm_b32 v217, v120, v110, s3
    v_perm_b32 v218, v140, v130, s3
    v_perm_b32 v219, v160, v150, s3
    ds_write_b128 v233, v[216:219] offset:40960
    v_alignbit_b32 v91, v92, v91, v232
    v_alignbit_b32 v101, v102, v101, v232
    v_alignbit_b32 v111, v112, v111, v232
    v_alignbit_b32 v121, v122, v121, v232
    v_alignbit_b32 v131, v132, v131, v232
    v_alignbit_b32 v141, v142, v141, v232
    v_alignbit_b32 v151, v152, v151, v232
    v_alignbit_b32 v161, v162, v161, v232
    v_perm_b32 v220, v101, v91, s2
    v_perm_b32 v221, v121, v111, s2
    v_perm_b32 v222, v141, v131, s2
    v_perm_b32 v223, v161, v151, s2
    ds_write_b128 v233, v[220:223] offset:49152
    v_perm_b32 v224, v101, v91, s3
    v_perm_b32 v225, v121, v111, s3
    v_perm_b32 v226, v141, v131, s3
    v_perm_b32 v227, v161, v151, s3
    ds_write_b128 v233, v[224:227] offset:57344
    v_alignbit_b32 v92, v92, v92, v232
    v_alignbit_b32 v102, v102, v102, v232
    v_alignbit_b32 v112, v112, v112, v232
    v_alignbit_b32 v122, v122, v122, v232
    v_alignbit_b32 v132, v132, v132, v232
    v_alignbit_b32 v142, v142, v142, v232
    v_alignbit_b32 v152, v152, v152, v232
    v_alignbit_b32 v162, v162, v162, v232
    v_perm_b32 v196, v102, v92, s2
    v_perm_b32 v197, v122, v112, s2
    v_perm_b32 v198, v142, v132, s2
    v_perm_b32 v199, v162, v152, s2
    ds_write_b128 v235, v[196:199] offset:0
    s_waitcnt lgkmcnt(0)
    s_cmp_lg_u32 s58, 0
    s_cbranch_scc1 wall_139
    v_mov_b32 v236, 40
wctr_140:
    buffer_load_dword v235, v236, s[12:15], 0 offen sc1
    s_waitcnt vmcnt(0)
    v_cmp_gt_u16 vcc, 32, v235
    s_cbranch_vccz wctr_ok_141
    s_sub_u32 s77, s77, 1
    s_cbranch_scc0 wctr_140
    s_mov_b32 s77, 0
wctr_ok_141:
wall_139:
    s_barrier
    s_mov_b32 s7, s58
colloop_142:
    s_lshl_b32 s3, s79, 4
    s_add_u32 s3, s3, s7
    s_lshl_b32 s3, s3, 1
    s_cmp_eq_u32 s3, 1024
    s_cselect_b32 s3, 1, s3
    s_cmp_lt_u32 s3, 2
    s_cselect_b32 s6, 0x5ffffff0, 0
    s_mov_b32 s4, 0x35800000
    s_cselect_b32 s4, 0x35000000, s4
    v_bfe_u32 v231, v1, 0, 5
    v_lshlrev_b32 v231, 16, v231
    v_bfe_u32 v235, v1, 5, 1
    v_lshl_or_b32 v231, v235, 9, v231
    v_add_u32 v232, s6, v231
    s_bfe_u32 s5, s3, 0x50000
    s_lshl_b32 s5, s5, 4
    s_bfe_u32 s2, s3, 0x50005
    s_lshl_b32 s2, s2, 11
    s_or_b32 s5, s5, s2
    s_add_u32 s5, s5, 0x5400000
    buffer_load_dwordx4 v[84:87], v231, s[8:11], s5 offen offset:0
    buffer_load_dwordx4 v[100:103], v232, s[8:11], s5 offen offset:16
    buffer_load_dwordx4 v[88:91], v231, s[8:11], s5 offen offset:1024
    buffer_load_dwordx4 v[104:107], v232, s[8:11], s5 offen offset:1040
    s_add_u32 s5, s5, 2097152
    buffer_load_dwordx4 v[92:95], v231, s[8:11], s5 offen offset:0
    buffer_load_dwordx4 v[108:111], v232, s[8:11], s5 offen offset:16
    buffer_load_dwordx4 v[96:99], v231, s[8:11], s5 offen offset:1024
    buffer_load_dwordx4 v[112:115], v232, s[8:11], s5 offen offset:1040
    s_add_u32 s5, s5, 2097152
    s_lshl_b32 s5, s7, 13
    v_lshl_add_u32 v235, v1, 4, s5
    ds_read_b128 v[196:199], v235 offset:0
    ds_read_b128 v[200:203], v235 offset:1024
    ds_read_b128 v[204:207], v235 offset:2048
    ds_read_b128 v[208:211], v235 offset:3072
    ds_read_b128 v[212:215], v235 offset:4096
    ds_read_b128 v[216:219], v235 offset:5120
    ds_read_b128 v[220:223], v235 offset:6144
    ds_read_b128 v[224:227], v235 offset:7168
    v_and_b32 v236, 31, v1
    v_cvt_f32_u32 v228, v236
    v_mov_b32 v229, v234
    s_waitcnt vmcnt(0) lgkmcnt(0)
    v_xor_b32 v116, 0x80008000, v84
    v_xor_b32 v117, 0x80008000, v85
    v_xor_b32 v118, 0x80008000, v86
    v_xor_b32 v119, 0x80008000, v87
    v_xor_b32 v120, 0x80008000, v88
    v_xor_b32 v121, 0x80008000, v89
    v_xor_b32 v122, 0x80008000, v90
    v_xor_b32 v123, 0x80008000, v91
    v_xor_b32 v124, 0x80008000, v92
    v_xor_b32 v125, 0x80008000, v93
    v_xor_b32 v126, 0x80008000, v94
    v_xor_b32 v127, 0x80008000, v95
    v_xor_b32 v128, 0x80008000, v96
    v_xor_b32 v129, 0x80008000, v97
    v_xor_b32 v130, 0x80008000, v98
    v_xor_b32 v131, 0x80008000, v99
    v_mfma_f32_32x32x16_bf16 v[132:147], v[84:87], v[68:71], 0
    v_mfma_f32_32x32x16_bf16 v[164:179], v[100:103], v[68:71], 0
    v_mfma_f32_32x32x16_bf16 v[132:147], v[100:103], v[76:79], v[132:147]
    v_mfma_f32_32x32x16_bf16 v[164:179], v[116:119], v[76:79], v[164:179]
    v_mfma_f32_32x32x16_bf16 v[132:147], v[88:91], v[72:75], v[132:147]
    v_mfma_f32_32x32x16_bf16 v[164:179], v[104:107], v[72:75], v[164:179]
    v_mfma_f32_32x32x16_bf16 v[132:147], v[104:107], v[80:83], v[132:147]
    v_mfma_f32_32x32x16_bf16 v[164:179], v[120:123], v[80:83], v[164:179]
    v_mfma_f32_32x32x16_bf16 v[148:163], v[92:95], v[68:71], 0
    v_mfma_f32_32x32x16_bf16 v[180:195], v[108:111], v[68:71], 0
    v_mfma_f32_32x32x16_bf16 v[148:163], v[108:111], v[76:79], v[148:163]
    v_mfma_f32_32x32x16_bf16 v[180:195], v[124:127], v[76:79], v[180:195]
    v_mfma_f32_32x32x16_bf16 v[148:163], v[96:99], v[72:75], v[148:163]
    v_mfma_f32_32x32x16_bf16 v[180:195], v[112:115], v[72:75], v[180:195]
    v_mfma_f32_32x32x16_bf16 v[148:163], v[112:115], v[80:83], v[148:163]
    v_mfma_f32_32x32x16_bf16 v[180:195], v[128:131], v[80:83], v[180:195]
    v_fmamk_f32 v243, v228, 0x0, v229
    v_cos_f32 v239, v243
    v_sin_f32 v240, v243
    v_mul_f32 v239, s4, v239
    v_mul_f32 v240, s4, v240
    v_mul_f32 v235, v132, v239
    v_mul_f32 v237, v164, v239
    v_fma_f32 v235, v164, v240, v235
    v_fma_f32 v237, -v132, v240, v237
    v_fmamk_f32 v243, v228, 0x3a000000, v229
    v_cos_f32 v241, v243
    v_sin_f32 v242, v243
    v_mul_f32 v241, s4, v241
    v_mul_f32 v242, s4, v242
    v_mul_f32 v236, v133, v241
    v_mul_f32 v238, v165, v241
    v_fma_f32 v236, v165, v242, v236
    v_fma_f32 v238, -v133, v242, v238
    v_cvt_pk_bf16_f32 v84, v235, v236
    v_cvt_pk_bf16_f32 v100, v237, v238
    v_cvt_pk_bf16_f32 v116, -v235, -v236
    v_fmamk_f32 v243, v228, 0x3a800000, v229
    v_cos_f32 v239, v243
    v_sin_f32 v240, v243
    v_mul_f32 v239, s4, v239
    v_mul_f32 v240, s4, v240
    v_mul_f32 v235, v134, v239
    v_mul_f32 v237, v166, v239
    v_fma_f32 v235, v166, v240, v235
    v_fma_f32 v237, -v134, v240, v237
    v_fmamk_f32 v243, v228, 0x3ac00000, v229
    v_cos_f32 v241, v243
    v_sin_f32 v242, v243
    v_mul_f32 v241, s4, v241
    v_mul_f32 v242, s4, v242
    v_mul_f32 v236, v135, v241
    v_mul_f32 v238, v167, v241
    v_fma_f32 v236, v167, v242, v236
    v_fma_f32 v238, -v135, v242, v238
    v_cvt_pk_bf16_f32 v85, v235, v236
    v_cvt_pk_bf16_f32 v101, v237, v238
    v_cvt_pk_bf16_f32 v117, -v235, -v236
    v_fmamk_f32 v243, v228, 0x3b800000, v229
    v_cos_f32 v239, v243
    v_sin_f32 v240, v243
    v_mul_f32 v239, s4, v239
    v_mul_f32 v240, s4, v240
    v_mul_f32 v235, v136, v239
    v_mul_f32 v237, v168, v239
    v_fma_f32 v235, v168, v240, v235
    v_fma_f32 v237, -v136, v240, v237
    v_fmamk_f32 v243, v228, 0x3b900000, v229
    v_cos_f32 v241, v243
    v_sin_f32 v242, v243
    v_mul_f32 v241, s4, v241
    v_mul_f32 v242, s4, v242
    v_mul_f32 v236, v137, v241
    v_mul_f32 v238, v169, v241
    v_fma_f32 v236, v169, v242, v236
    v_fma_f32 v238, -v137, v242, v238
    v_cvt_pk_bf16_f32 v86, v235, v236
    v_cvt_pk_bf16_f32 v102, v237, v238
    v_cvt_pk_bf16_f32 v118, -v235, -v236
    v_fmamk_f32 v243, v228, 0x3ba00000, v229
    v_cos_f32 v239, v243
    v_sin_f32 v240, v243
    v_mul_f32 v239, s4, v239
    v_mul_f32 v240, s4, v240
    v_mul_f32 v235, v138, v239
    v_mul_f32 v237, v170, v239
    v_fma_f32 v235, v170, v240, v235
    v_fma_f32 v237, -v138, v240, v237
    v_fmamk_f32 v243, v228, 0x3bb00000, v229
    v_cos_f32 v241, v243
    v_sin_f32 v242, v243
    v_mul_f32 v241, s4, v241
    v_mul_f32 v242, s4, v242
    v_mul_f32 v236, v139, v241
    v_mul_f32 v238, v171, v241
    v_fma_f32 v236, v171, v242, v236
    v_fma_f32 v238, -v139, v242, v238
    v_cvt_pk_bf16_f32 v87, v235, v236
    v_cvt_pk_bf16_f32 v103, v237, v238
    v_cvt_pk_bf16_f32 v119, -v235, -v236
    v_fmamk_f32 v243, v228, 0x3c000000, v229
    v_cos_f32 v239, v243
    v_sin_f32 v240, v243
    v_mul_f32 v239, s4, v239
    v_mul_f32 v240, s4, v240
    v_mul_f32 v235, v140, v239
    v_mul_f32 v237, v172, v239
    v_fma_f32 v235, v172, v240, v235
    v_fma_f32 v237, -v140, v240, v237
    v_fmamk_f32 v243, v228, 0x3c080000, v229
    v_cos_f32 v241, v243
    v_sin_f32 v242, v243
    v_mul_f32 v241, s4, v241
    v_mul_f32 v242, s4, v242
    v_mul_f32 v236, v141, v241
    v_mul_f32 v238, v173, v241
    v_fma_f32 v236, v173, v242, v236
    v_fma_f32 v238, -v141, v242, v238
    v_cvt_pk_bf16_f32 v88, v235, v236
    v_cvt_pk_bf16_f32 v104, v237, v238
    v_cvt_pk_bf16_f32 v120, -v235, -v236
    v_fmamk_f32 v243, v228, 0x3c100000, v229
    v_cos_f32 v239, v243
    v_sin_f32 v240, v243
    v_mul_f32 v239, s4, v239
    v_mul_f32 v240, s4, v240
    v_mul_f32 v235, v142, v239
    v_mul_f32 v237, v174, v239
    v_fma_f32 v235, v174, v240, v235
    v_fma_f32 v237, -v142, v240, v237
    v_fmamk_f32 v243, v228, 0x3c180000, v229
    v_cos_f32 v241, v243
    v_sin_f32 v242, v243
    v_mul_f32 v241, s4, v241
    v_mul_f32 v242, s4, v242
    v_mul_f32 v236, v143, v241
    v_mul_f32 v238, v175, v241
    v_fma_f32 v236, v175, v242, v236
    v_fma_f32 v238, -v143, v242, v238
    v_cvt_pk_bf16_f32 v89, v235, v236
    v_cvt_pk_bf16_f32 v105, v237, v238
    v_cvt_pk_bf16_f32 v121, -v235, -v236
    v_fmamk_f32 v243, v228, 0x3c400000, v229
    v_cos_f32 v239, v243
    v_sin_f32 v240, v243
    v_mul_f32 v239, s4, v239
    v_mul_f32 v240, s4, v240
    v_mul_f32 v235, v144, v239
    v_mul_f32 v237, v176, v239
    v_fma_f32 v235, v176, v240, v235
    v_fma_f32 v237, -v144, v240, v237
    v_fmamk_f32 v243, v228, 0x3c480000, v229
    v_cos_f32 v241, v243
    v_sin_f32 v242, v243
    v_mul_f32 v241, s4, v241
    v_mul_f32 v242, s4, v242
    v_mul_f32 v236, v145, v241
    v_mul_f32 v238, v177, v241
    v_fma_f32 v236, v177, v242, v236
    v_fma_f32 v238, -v145, v242, v238
    v_cvt_pk_bf16_f32 v90, v235, v236
    v_cvt_pk_bf16_f32 v106, v237, v238
    v_cvt_pk_bf16_f32 v122, -v235, -v236
    v_fmamk_f32 v243, v228, 0x3c500000, v229
    v_cos_f32 v239, v243
    v_sin_f32 v240, v243
    v_mul_f32 v239, s4, v239
    v_mul_f32 v240, s4, v240
    v_mul_f32 v235, v146, v239
    v_mul_f32 v237, v178, v239
    v_fma_f32 v235, v178, v240, v235
    v_fma_f32 v237, -v146, v240, v237
    v_fmamk_f32 v243, v228, 0x3c580000, v229
    v_cos_f32 v241, v243
    v_sin_f32 v242, v243
    v_mul_f32 v241, s4, v241
    v_mul_f32 v242, s4, v242
    v_mul_f32 v236, v147, v241
    v_mul_f32 v238, v179, v241
    v_fma_f32 v236, v179, v242, v236
    v_fma_f32 v238, -v147, v242, v238
    v_cvt_pk_bf16_f32 v91, v235, v236
    v_cvt_pk_bf16_f32 v107, v237, v238
    v_cvt_pk_bf16_f32 v123, -v235, -v236
    v_fmamk_f32 v243, v228, 0x3c800000, v229
    v_cos_f32 v239, v243
    v_sin_f32 v240, v243
    v_mul_f32 v239, s4, v239
    v_mul_f32 v240, s4, v240
    v_mul_f32 v235, v148, v239
    v_mul_f32 v237, v180, v239
    v_fma_f32 v235, v180, v240, v235
    v_fma_f32 v237, -v148, v240, v237
    v_fmamk_f32 v243, v228, 0x3c840000, v229
    v_cos_f32 v241, v243
    v_sin_f32 v242, v243
    v_mul_f32 v241, s4, v241
    v_mul_f32 v242, s4, v242
    v_mul_f32 v236, v149, v241
    v_mul_f32 v238, v181, v241
    v_fma_f32 v236, v181, v242, v236
    v_fma_f32 v238, -v149, v242, v238
    v_cvt_pk_bf16_f32 v92, v235, v236
    v_cvt_pk_bf16_f32 v108, v237, v238
    v_cvt_pk_bf16_f32 v124, -v235, -v236
    v_fmamk_f32 v243, v228, 0x3c880000, v229
    v_cos_f32 v239, v243
    v_sin_f32 v240, v243
    v_mul_f32 v239, s4, v239
    v_mul_f32 v240, s4, v240
    v_mul_f32 v235, v150, v239
    v_mul_f32 v237, v182, v239
    v_fma_f32 v235, v182, v240, v235
    v_fma_f32 v237, -v150, v240, v237
    v_fmamk_f32 v243, v228, 0x3c8c0000, v229
    v_cos_f32 v241, v243
    v_sin_f32 v242, v243
    v_mul_f32 v241, s4, v241
    v_mul_f32 v242, s4, v242
    v_mul_f32 v236, v151, v241
    v_mul_f32 v238, v183, v241
    v_fma_f32 v236, v183, v242, v236
    v_fma_f32 v238, -v151, v242, v238
    v_cvt_pk_bf16_f32 v93, v235, v236
    v_cvt_pk_bf16_f32 v109, v237, v238
    v_cvt_pk_bf16_f32 v125, -v235, -v236
    v_fmamk_f32 v243, v228, 0x3ca00000, v229
    v_cos_f32 v239, v243
    v_sin_f32 v240, v243
    v_mul_f32 v239, s4, v239
    v_mul_f32 v240, s4, v240
    v_mul_f32 v235, v152, v239
    v_mul_f32 v237, v184, v239
    v_fma_f32 v235, v184, v240, v235
    v_fma_f32 v237, -v152, v240, v237
    v_fmamk_f32 v243, v228, 0x3ca40000, v229
    v_cos_f32 v241, v243
    v_sin_f32 v242, v243
    v_mul_f32 v241, s4, v241
    v_mul_f32 v242, s4, v242
    v_mul_f32 v236, v153, v241
    v_mul_f32 v238, v185, v241
    v_fma_f32 v236, v185, v242, v236
    v_fma_f32 v238, -v153, v242, v238
    v_cvt_pk_bf16_f32 v94, v235, v236
    v_cvt_pk_bf16_f32 v110, v237, v238
    v_cvt_pk_bf16_f32 v126, -v235, -v236
    v_fmamk_f32 v243, v228, 0x3ca80000, v229
    v_cos_f32 v239, v243
    v_sin_f32 v240, v243
    v_mul_f32 v239, s4, v239
    v_mul_f32 v240, s4, v240
    v_mul_f32 v235, v154, v239
    v_mul_f32 v237, v186, v239
    v_fma_f32 v235, v186, v240, v235
    v_fma_f32 v237, -v154, v240, v237
    v_fmamk_f32 v243, v228, 0x3cac0000, v229
    v_cos_f32 v241, v243
    v_sin_f32 v242, v243
    v_mul_f32 v241, s4, v241
    v_mul_f32 v242, s4, v242
    v_mul_f32 v236, v155, v241
    v_mul_f32 v238, v187, v241
    v_fma_f32 v236, v187, v242, v236
    v_fma_f32 v238, -v155, v242, v238
    v_cvt_pk_bf16_f32 v95, v235, v236
    v_cvt_pk_bf16_f32 v111, v237, v238
    v_cvt_pk_bf16_f32 v127, -v235, -v236
    v_fmamk_f32 v243, v228, 0x3cc00000, v229
    v_cos_f32 v239, v243
    v_sin_f32 v240, v243
    v_mul_f32 v239, s4, v239
    v_mul_f32 v240, s4, v240
    v_mul_f32 v235, v156, v239
    v_mul_f32 v237, v188, v239
    v_fma_f32 v235, v188, v240, v235
    v_fma_f32 v237, -v156, v240, v237
    v_fmamk_f32 v243, v228, 0x3cc40000, v229
    v_cos_f32 v241, v243
    v_sin_f32 v242, v243
    v_mul_f32 v241, s4, v241
    v_mul_f32 v242, s4, v242
    v_mul_f32 v236, v157, v241
    v_mul_f32 v238, v189, v241
    v_fma_f32 v236, v189, v242, v236
    v_fma_f32 v238, -v157, v242, v238
    v_cvt_pk_bf16_f32 v96, v235, v236
    v_cvt_pk_bf16_f32 v112, v237, v238
    v_cvt_pk_bf16_f32 v128, -v235, -v236
    v_fmamk_f32 v243, v228, 0x3cc80000, v229
    v_cos_f32 v239, v243
    v_sin_f32 v240, v243
    v_mul_f32 v239, s4, v239
    v_mul_f32 v240, s4, v240
    v_mul_f32 v235, v158, v239
    v_mul_f32 v237, v190, v239
    v_fma_f32 v235, v190, v240, v235
    v_fma_f32 v237, -v158, v240, v237
    v_fmamk_f32 v243, v228, 0x3ccc0000, v229
    v_cos_f32 v241, v243
    v_sin_f32 v242, v243
    v_mul_f32 v241, s4, v241
    v_mul_f32 v242, s4, v242
    v_mul_f32 v236, v159, v241
    v_mul_f32 v238, v191, v241
    v_fma_f32 v236, v191, v242, v236
    v_fma_f32 v238, -v159, v242, v238
    v_cvt_pk_bf16_f32 v97, v235, v236
    v_cvt_pk_bf16_f32 v113, v237, v238
    v_cvt_pk_bf16_f32 v129, -v235, -v236
    v_fmamk_f32 v243, v228, 0x3ce00000, v229
    v_cos_f32 v239, v243
    v_sin_f32 v240, v243
    v_mul_f32 v239, s4, v239
    v_mul_f32 v240, s4, v240
    v_mul_f32 v235, v160, v239
    v_mul_f32 v237, v192, v239
    v_fma_f32 v235, v192, v240, v235
    v_fma_f32 v237, -v160, v240, v237
    v_fmamk_f32 v243, v228, 0x3ce40000, v229
    v_cos_f32 v241, v243
    v_sin_f32 v242, v243
    v_mul_f32 v241, s4, v241
    v_mul_f32 v242, s4, v242
    v_mul_f32 v236, v161, v241
    v_mul_f32 v238, v193, v241
    v_fma_f32 v236, v193, v242, v236
    v_fma_f32 v238, -v161, v242, v238
    v_cvt_pk_bf16_f32 v98, v235, v236
    v_cvt_pk_bf16_f32 v114, v237, v238
    v_cvt_pk_bf16_f32 v130, -v235, -v236
    v_fmamk_f32 v243, v228, 0x3ce80000, v229
    v_cos_f32 v239, v243
    v_sin_f32 v240, v243
    v_mul_f32 v239, s4, v239
    v_mul_f32 v240, s4, v240
    v_mul_f32 v235, v162, v239
    v_mul_f32 v237, v194, v239
    v_fma_f32 v235, v194, v240, v235
    v_fma_f32 v237, -v162, v240, v237
    v_fmamk_f32 v243, v228, 0x3cec0000, v229
    v_cos_f32 v241, v243
    v_sin_f32 v242, v243
    v_mul_f32 v241, s4, v241
    v_mul_f32 v242, s4, v242
    v_mul_f32 v236, v163, v241
    v_mul_f32 v238, v195, v241
    v_fma_f32 v236, v195, v242, v236
    v_fma_f32 v238, -v163, v242, v238
    v_cvt_pk_bf16_f32 v99, v235, v236
    v_cvt_pk_bf16_f32 v115, v237, v238
    v_cvt_pk_bf16_f32 v131, -v235, -v236
    v_mfma_f32_32x32x16_bf16 v[132:147], v[4:7], v[84:87], 0
    v_mfma_f32_32x32x16_bf16 v[164:179], v[4:7], v[100:103], 0
    v_mfma_f32_32x32x16_bf16 v[132:147], v[36:39], v[100:103], v[132:147]
    v_mfma_f32_32x32x16_bf16 v[164:179], v[36:39], v[116:119], v[164:179]
    v_mfma_f32_32x32x16_bf16 v[132:147], v[8:11], v[88:91], v[132:147]
    v_mfma_f32_32x32x16_bf16 v[164:179], v[8:11], v[104:107], v[164:179]
    v_mfma_f32_32x32x16_bf16 v[132:147], v[40:43], v[104:107], v[132:147]
    v_mfma_f32_32x32x16_bf16 v[164:179], v[40:43], v[120:123], v[164:179]
    v_mfma_f32_32x32x16_bf16 v[132:147], v[12:15], v[92:95], v[132:147]
    v_mfma_f32_32x32x16_bf16 v[164:179], v[12:15], v[108:111], v[164:179]
    v_mfma_f32_32x32x16_bf16 v[132:147], v[44:47], v[108:111], v[132:147]
    v_mfma_f32_32x32x16_bf16 v[164:179], v[44:47], v[124:127], v[164:179]
    v_mfma_f32_32x32x16_bf16 v[132:147], v[16:19], v[96:99], v[132:147]
    v_mfma_f32_32x32x16_bf16 v[164:179], v[16:19], v[112:115], v[164:179]
    v_mfma_f32_32x32x16_bf16 v[132:147], v[48:51], v[112:115], v[132:147]
    v_mfma_f32_32x32x16_bf16 v[164:179], v[48:51], v[128:131], v[164:179]
    v_mfma_f32_32x32x16_bf16 v[148:163], v[20:23], v[84:87], 0
    v_mfma_f32_32x32x16_bf16 v[180:195], v[20:23], v[100:103], 0
    v_mfma_f32_32x32x16_bf16 v[148:163], v[52:55], v[100:103], v[148:163]
    v_mfma_f32_32x32x16_bf16 v[180:195], v[52:55], v[116:119], v[180:195]
    v_mfma_f32_32x32x16_bf16 v[148:163], v[24:27], v[88:91], v[148:163]
    v_mfma_f32_32x32x16_bf16 v[180:195], v[24:27], v[104:107], v[180:195]
    v_mfma_f32_32x32x16_bf16 v[148:163], v[56:59], v[104:107], v[148:163]
    v_mfma_f32_32x32x16_bf16 v[180:195], v[56:59], v[120:123], v[180:195]
    v_mfma_f32_32x32x16_bf16 v[148:163], v[28:31], v[92:95], v[148:163]
    v_mfma_f32_32x32x16_bf16 v[180:195], v[28:31], v[108:111], v[180:195]
    v_mfma_f32_32x32x16_bf16 v[148:163], v[60:63], v[108:111], v[148:163]
    v_mfma_f32_32x32x16_bf16 v[180:195], v[60:63], v[124:127], v[180:195]
    v_mfma_f32_32x32x16_bf16 v[148:163], v[32:35], v[96:99], v[148:163]
    v_mfma_f32_32x32x16_bf16 v[180:195], v[32:35], v[112:115], v[180:195]
    v_mfma_f32_32x32x16_bf16 v[148:163], v[64:67], v[112:115], v[148:163]
    v_mfma_f32_32x32x16_bf16 v[180:195], v[64:67], v[128:131], v[180:195]
    v_lshlrev_b32 v239, 16, v196
    v_and_b32 v240, 0xffff0000, v196
    v_mul_f32 v235, v132, v239
    v_mul_f32 v237, v164, v239
    v_fma_f32 v235, -v164, v240, v235
    v_fma_f32 v237, v132, v240, v237
    v_lshlrev_b32 v241, 16, v197
    v_and_b32 v242, 0xffff0000, v197
    v_mul_f32 v236, v133, v241
    v_mul_f32 v238, v165, v241
    v_fma_f32 v236, -v165, v242, v236
    v_fma_f32 v238, v133, v242, v238
    v_cvt_pk_bf16_f32 v84, v235, v236
    v_cvt_pk_bf16_f32 v100, v237, v238
    v_cvt_pk_bf16_f32 v116, -v237, -v238
    v_lshlrev_b32 v239, 16, v198
    v_and_b32 v240, 0xffff0000, v198
    v_mul_f32 v235, v134, v239
    v_mul_f32 v237, v166, v239
    v_fma_f32 v235, -v166, v240, v235
    v_fma_f32 v237, v134, v240, v237
    v_lshlrev_b32 v241, 16, v199
    v_and_b32 v242, 0xffff0000, v199
    v_mul_f32 v236, v135, v241
    v_mul_f32 v238, v167, v241
    v_fma_f32 v236, -v167, v242, v236
    v_fma_f32 v238, v135, v242, v238
    v_cvt_pk_bf16_f32 v85, v235, v236
    v_cvt_pk_bf16_f32 v101, v237, v238
    v_cvt_pk_bf16_f32 v117, -v237, -v238
    v_lshlrev_b32 v239, 16, v200
    v_and_b32 v240, 0xffff0000, v200
    v_mul_f32 v235, v136, v239
    v_mul_f32 v237, v168, v239
    v_fma_f32 v235, -v168, v240, v235
    v_fma_f32 v237, v136, v240, v237
    v_lshlrev_b32 v241, 16, v201
    v_and_b32 v242, 0xffff0000, v201
    v_mul_f32 v236, v137, v241
    v_mul_f32 v238, v169, v241
    v_fma_f32 v236, -v169, v242, v236
    v_fma_f32 v238, v137, v242, v238
    v_cvt_pk_bf16_f32 v86, v235, v236
    v_cvt_pk_bf16_f32 v102, v237, v238
    v_cvt_pk_bf16_f32 v118, -v237, -v238
    v_lshlrev_b32 v239, 16, v202
    v_and_b32 v240, 0xffff0000, v202
    v_mul_f32 v235, v138, v239
    v_mul_f32 v237, v170, v239
    v_fma_f32 v235, -v170, v240, v235
    v_fma_f32 v237, v138, v240, v237
    v_lshlrev_b32 v241, 16, v203
    v_and_b32 v242, 0xffff0000, v203
    v_mul_f32 v236, v139, v241
    v_mul_f32 v238, v171, v241
    v_fma_f32 v236, -v171, v242, v236
    v_fma_f32 v238, v139, v242, v238
    v_cvt_pk_bf16_f32 v87, v235, v236
    v_cvt_pk_bf16_f32 v103, v237, v238
    v_cvt_pk_bf16_f32 v119, -v237, -v238
    v_lshlrev_b32 v239, 16, v204
    v_and_b32 v240, 0xffff0000, v204
    v_mul_f32 v235, v140, v239
    v_mul_f32 v237, v172, v239
    v_fma_f32 v235, -v172, v240, v235
    v_fma_f32 v237, v140, v240, v237
    v_lshlrev_b32 v241, 16, v205
    v_and_b32 v242, 0xffff0000, v205
    v_mul_f32 v236, v141, v241
    v_mul_f32 v238, v173, v241
    v_fma_f32 v236, -v173, v242, v236
    v_fma_f32 v238, v141, v242, v238
    v_cvt_pk_bf16_f32 v88, v235, v236
    v_cvt_pk_bf16_f32 v104, v237, v238
    v_cvt_pk_bf16_f32 v120, -v237, -v238
    v_lshlrev_b32 v239, 16, v206
    v_and_b32 v240, 0xffff0000, v206
    v_mul_f32 v235, v142, v239
    v_mul_f32 v237, v174, v239
    v_fma_f32 v235, -v174, v240, v235
    v_fma_f32 v237, v142, v240, v237
    v_lshlrev_b32 v241, 16, v207
    v_and_b32 v242, 0xffff0000, v207
    v_mul_f32 v236, v143, v241
    v_mul_f32 v238, v175, v241
    v_fma_f32 v236, -v175, v242, v236
    v_fma_f32 v238, v143, v242, v238
    v_cvt_pk_bf16_f32 v89, v235, v236
    v_cvt_pk_bf16_f32 v105, v237, v238
    v_cvt_pk_bf16_f32 v121, -v237, -v238
    v_lshlrev_b32 v239, 16, v208
    v_and_b32 v240, 0xffff0000, v208
    v_mul_f32 v235, v144, v239
    v_mul_f32 v237, v176, v239
    v_fma_f32 v235, -v176, v240, v235
    v_fma_f32 v237, v144, v240, v237
    v_lshlrev_b32 v241, 16, v209
    v_and_b32 v242, 0xffff0000, v209
    v_mul_f32 v236, v145, v241
    v_mul_f32 v238, v177, v241
    v_fma_f32 v236, -v177, v242, v236
    v_fma_f32 v238, v145, v242, v238
    v_cvt_pk_bf16_f32 v90, v235, v236
    v_cvt_pk_bf16_f32 v106, v237, v238
    v_cvt_pk_bf16_f32 v122, -v237, -v238
    v_lshlrev_b32 v239, 16, v210
    v_and_b32 v240, 0xffff0000, v210
    v_mul_f32 v235, v146, v239
    v_mul_f32 v237, v178, v239
    v_fma_f32 v235, -v178, v240, v235
    v_fma_f32 v237, v146, v240, v237
    v_lshlrev_b32 v241, 16, v211
    v_and_b32 v242, 0xffff0000, v211
    v_mul_f32 v236, v147, v241
    v_mul_f32 v238, v179, v241
    v_fma_f32 v236, -v179, v242, v236
    v_fma_f32 v238, v147, v242, v238
    v_cvt_pk_bf16_f32 v91, v235, v236
    v_cvt_pk_bf16_f32 v107, v237, v238
    v_cvt_pk_bf16_f32 v123, -v237, -v238
    v_lshlrev_b32 v239, 16, v212
    v_and_b32 v240, 0xffff0000, v212
    v_mul_f32 v235, v148, v239
    v_mul_f32 v237, v180, v239
    v_fma_f32 v235, -v180, v240, v235
    v_fma_f32 v237, v148, v240, v237
    v_lshlrev_b32 v241, 16, v213
    v_and_b32 v242, 0xffff0000, v213
    v_mul_f32 v236, v149, v241
    v_mul_f32 v238, v181, v241
    v_fma_f32 v236, -v181, v242, v236
    v_fma_f32 v238, v149, v242, v238
    v_cvt_pk_bf16_f32 v92, v235, v236
    v_cvt_pk_bf16_f32 v108, v237, v238
    v_cvt_pk_bf16_f32 v124, -v237, -v238
    v_lshlrev_b32 v239, 16, v214
    v_and_b32 v240, 0xffff0000, v214
    v_mul_f32 v235, v150, v239
    v_mul_f32 v237, v182, v239
    v_fma_f32 v235, -v182, v240, v235
    v_fma_f32 v237, v150, v240, v237
    v_lshlrev_b32 v241, 16, v215
    v_and_b32 v242, 0xffff0000, v215
    v_mul_f32 v236, v151, v241
    v_mul_f32 v238, v183, v241
    v_fma_f32 v236, -v183, v242, v236
    v_fma_f32 v238, v151, v242, v238
    v_cvt_pk_bf16_f32 v93, v235, v236
    v_cvt_pk_bf16_f32 v109, v237, v238
    v_cvt_pk_bf16_f32 v125, -v237, -v238
    v_lshlrev_b32 v239, 16, v216
    v_and_b32 v240, 0xffff0000, v216
    v_mul_f32 v235, v152, v239
    v_mul_f32 v237, v184, v239
    v_fma_f32 v235, -v184, v240, v235
    v_fma_f32 v237, v152, v240, v237
    v_lshlrev_b32 v241, 16, v217
    v_and_b32 v242, 0xffff0000, v217
    v_mul_f32 v236, v153, v241
    v_mul_f32 v238, v185, v241
    v_fma_f32 v236, -v185, v242, v236
    v_fma_f32 v238, v153, v242, v238
    v_cvt_pk_bf16_f32 v94, v235, v236
    v_cvt_pk_bf16_f32 v110, v237, v238
    v_cvt_pk_bf16_f32 v126, -v237, -v238
    v_lshlrev_b32 v239, 16, v218
    v_and_b32 v240, 0xffff0000, v218
    v_mul_f32 v235, v154, v239
    v_mul_f32 v237, v186, v239
    v_fma_f32 v235, -v186, v240, v235
    v_fma_f32 v237, v154, v240, v237
    v_lshlrev_b32 v241, 16, v219
    v_and_b32 v242, 0xffff0000, v219
    v_mul_f32 v236, v155, v241
    v_mul_f32 v238, v187, v241
    v_fma_f32 v236, -v187, v242, v236
    v_fma_f32 v238, v155, v242, v238
    v_cvt_pk_bf16_f32 v95, v235, v236
    v_cvt_pk_bf16_f32 v111, v237, v238
    v_cvt_pk_bf16_f32 v127, -v237, -v238
    v_lshlrev_b32 v239, 16, v220
    v_and_b32 v240, 0xffff0000, v220
    v_mul_f32 v235, v156, v239
    v_mul_f32 v237, v188, v239
    v_fma_f32 v235, -v188, v240, v235
    v_fma_f32 v237, v156, v240, v237
    v_lshlrev_b32 v241, 16, v221
    v_and_b32 v242, 0xffff0000, v221
    v_mul_f32 v236, v157, v241
    v_mul_f32 v238, v189, v241
    v_fma_f32 v236, -v189, v242, v236
    v_fma_f32 v238, v157, v242, v238
    v_cvt_pk_bf16_f32 v96, v235, v236
    v_cvt_pk_bf16_f32 v112, v237, v238
    v_cvt_pk_bf16_f32 v128, -v237, -v238
    v_lshlrev_b32 v239, 16, v222
    v_and_b32 v240, 0xffff0000, v222
    v_mul_f32 v235, v158, v239
    v_mul_f32 v237, v190, v239
    v_fma_f32 v235, -v190, v240, v235
    v_fma_f32 v237, v158, v240, v237
    v_lshlrev_b32 v241, 16, v223
    v_and_b32 v242, 0xffff0000, v223
    v_mul_f32 v236, v159, v241
    v_mul_f32 v238, v191, v241
    v_fma_f32 v236, -v191, v242, v236
    v_fma_f32 v238, v159, v242, v238
    v_cvt_pk_bf16_f32 v97, v235, v236
    v_cvt_pk_bf16_f32 v113, v237, v238
    v_cvt_pk_bf16_f32 v129, -v237, -v238
    v_lshlrev_b32 v239, 16, v224
    v_and_b32 v240, 0xffff0000, v224
    v_mul_f32 v235, v160, v239
    v_mul_f32 v237, v192, v239
    v_fma_f32 v235, -v192, v240, v235
    v_fma_f32 v237, v160, v240, v237
    v_lshlrev_b32 v241, 16, v225
    v_and_b32 v242, 0xffff0000, v225
    v_mul_f32 v236, v161, v241
    v_mul_f32 v238, v193, v241
    v_fma_f32 v236, -v193, v242, v236
    v_fma_f32 v238, v161, v242, v238
    v_cvt_pk_bf16_f32 v98, v235, v236
    v_cvt_pk_bf16_f32 v114, v237, v238
    v_cvt_pk_bf16_f32 v130, -v237, -v238
    v_lshlrev_b32 v239, 16, v226
    v_and_b32 v240, 0xffff0000, v226
    v_mul_f32 v235, v162, v239
    v_mul_f32 v237, v194, v239
    v_fma_f32 v235, -v194, v240, v235
    v_fma_f32 v237, v162, v240, v237
    v_lshlrev_b32 v241, 16, v227
    v_and_b32 v242, 0xffff0000, v227
    v_mul_f32 v236, v163, v241
    v_mul_f32 v238, v195, v241
    v_fma_f32 v236, -v195, v242, v236
    v_fma_f32 v238, v163, v242, v238
    v_cvt_pk_bf16_f32 v99, v235, v236
    v_cvt_pk_bf16_f32 v115, v237, v238
    v_cvt_pk_bf16_f32 v131, -v237, -v238
    v_mfma_f32_32x32x16_bf16 v[132:147], v[84:87], v[4:7], 0
    v_mfma_f32_32x32x16_bf16 v[164:179], v[100:103], v[4:7], 0
    v_mfma_f32_32x32x16_bf16 v[132:147], v[116:119], v[36:39], v[132:147]
    v_mfma_f32_32x32x16_bf16 v[164:179], v[84:87], v[36:39], v[164:179]
    v_mfma_f32_32x32x16_bf16 v[132:147], v[88:91], v[8:11], v[132:147]
    v_mfma_f32_32x32x16_bf16 v[164:179], v[104:107], v[8:11], v[164:179]
    v_mfma_f32_32x32x16_bf16 v[132:147], v[120:123], v[40:43], v[132:147]
    v_mfma_f32_32x32x16_bf16 v[164:179], v[88:91], v[40:43], v[164:179]
    v_mfma_f32_32x32x16_bf16 v[132:147], v[92:95], v[12:15], v[132:147]
    v_mfma_f32_32x32x16_bf16 v[164:179], v[108:111], v[12:15], v[164:179]
    v_mfma_f32_32x32x16_bf16 v[132:147], v[124:127], v[44:47], v[132:147]
    v_mfma_f32_32x32x16_bf16 v[164:179], v[92:95], v[44:47], v[164:179]
    v_mfma_f32_32x32x16_bf16 v[132:147], v[96:99], v[16:19], v[132:147]
    v_mfma_f32_32x32x16_bf16 v[164:179], v[112:115], v[16:19], v[164:179]
    v_mfma_f32_32x32x16_bf16 v[132:147], v[128:131], v[48:51], v[132:147]
    v_mfma_f32_32x32x16_bf16 v[164:179], v[96:99], v[48:51], v[164:179]
    v_mfma_f32_32x32x16_bf16 v[148:163], v[84:87], v[20:23], 0
    v_mfma_f32_32x32x16_bf16 v[180:195], v[100:103], v[20:23], 0
    v_mfma_f32_32x32x16_bf16 v[148:163], v[116:119], v[52:55], v[148:163]
    v_mfma_f32_32x32x16_bf16 v[180:195], v[84:87], v[52:55], v[180:195]
    v_mfma_f32_32x32x16_bf16 v[148:163], v[88:91], v[24:27], v[148:163]
    v_mfma_f32_32x32x16_bf16 v[180:195], v[104:107], v[24:27], v[180:195]
    v_mfma_f32_32x32x16_bf16 v[148:163], v[120:123], v[56:59], v[148:163]
    v_mfma_f32_32x32x16_bf16 v[180:195], v[88:91], v[56:59], v[180:195]
    v_mfma_f32_32x32x16_bf16 v[148:163], v[92:95], v[28:31], v[148:163]
    v_mfma_f32_32x32x16_bf16 v[180:195], v[108:111], v[28:31], v[180:195]
    v_mfma_f32_32x32x16_bf16 v[148:163], v[124:127], v[60:63], v[148:163]
    v_mfma_f32_32x32x16_bf16 v[180:195], v[92:95], v[60:63], v[180:195]
    v_mfma_f32_32x32x16_bf16 v[148:163], v[96:99], v[32:35], v[148:163]
    v_mfma_f32_32x32x16_bf16 v[180:195], v[112:115], v[32:35], v[180:195]
    v_mfma_f32_32x32x16_bf16 v[148:163], v[128:131], v[64:67], v[148:163]
    v_mfma_f32_32x32x16_bf16 v[180:195], v[96:99], v[64:67], v[180:195]
    v_fmamk_f32 v243, v228, 0x0, v229
    v_cos_f32 v239, v243
    v_sin_f32 v240, v243
    v_mul_f32 v235, v132, v239
    v_mul_f32 v237, v164, v239
    v_fma_f32 v235, -v164, v240, v235
    v_fma_f32 v237, v132, v240, v237
    v_fmamk_f32 v243, v228, 0x3a000000, v229
    v_cos_f32 v241, v243
    v_sin_f32 v242, v243
    v_mul_f32 v236, v133, v241
    v_mul_f32 v238, v165, v241
    v_fma_f32 v236, -v165, v242, v236
    v_fma_f32 v238, v133, v242, v238
    v_cvt_pk_bf16_f32 v84, v235, v236
    v_cvt_pk_bf16_f32 v100, v237, v238
    v_cvt_pk_bf16_f32 v116, -v237, -v238
    v_fmamk_f32 v243, v228, 0x3a800000, v229
    v_cos_f32 v239, v243
    v_sin_f32 v240, v243
    v_mul_f32 v235, v134, v239
    v_mul_f32 v237, v166, v239
    v_fma_f32 v235, -v166, v240, v235
    v_fma_f32 v237, v134, v240, v237
    v_fmamk_f32 v243, v228, 0x3ac00000, v229
    v_cos_f32 v241, v243
    v_sin_f32 v242, v243
    v_mul_f32 v236, v135, v241
    v_mul_f32 v238, v167, v241
    v_fma_f32 v236, -v167, v242, v236
    v_fma_f32 v238, v135, v242, v238
    v_cvt_pk_bf16_f32 v85, v235, v236
    v_cvt_pk_bf16_f32 v101, v237, v238
    v_cvt_pk_bf16_f32 v117, -v237, -v238
    v_fmamk_f32 v243, v228, 0x3b800000, v229
    v_cos_f32 v239, v243
    v_sin_f32 v240, v243
    v_mul_f32 v235, v136, v239
    v_mul_f32 v237, v168, v239
    v_fma_f32 v235, -v168, v240, v235
    v_fma_f32 v237, v136, v240, v237
    v_fmamk_f32 v243, v228, 0x3b900000, v229
    v_cos_f32 v241, v243
    v_sin_f32 v242, v243
    v_mul_f32 v236, v137, v241
    v_mul_f32 v238, v169, v241
    v_fma_f32 v236, -v169, v242, v236
    v_fma_f32 v238, v137, v242, v238
    v_cvt_pk_bf16_f32 v86, v235, v236
    v_cvt_pk_bf16_f32 v102, v237, v238
    v_cvt_pk_bf16_f32 v118, -v237, -v238
    v_fmamk_f32 v243, v228, 0x3ba00000, v229
    v_cos_f32 v239, v243
    v_sin_f32 v240, v243
    v_mul_f32 v235, v138, v239
    v_mul_f32 v237, v170, v239
    v_fma_f32 v235, -v170, v240, v235
    v_fma_f32 v237, v138, v240, v237
    v_fmamk_f32 v243, v228, 0x3bb00000, v229
    v_cos_f32 v241, v243
    v_sin_f32 v242, v243
    v_mul_f32 v236, v139, v241
    v_mul_f32 v238, v171, v241
    v_fma_f32 v236, -v171, v242, v236
    v_fma_f32 v238, v139, v242, v238
    v_cvt_pk_bf16_f32 v87, v235, v236
    v_cvt_pk_bf16_f32 v103, v237, v238
    v_cvt_pk_bf16_f32 v119, -v237, -v238
    v_fmamk_f32 v243, v228, 0x3c000000, v229
    v_cos_f32 v239, v243
    v_sin_f32 v240, v243
    v_mul_f32 v235, v140, v239
    v_mul_f32 v237, v172, v239
    v_fma_f32 v235, -v172, v240, v235
    v_fma_f32 v237, v140, v240, v237
    v_fmamk_f32 v243, v228, 0x3c080000, v229
    v_cos_f32 v241, v243
    v_sin_f32 v242, v243
    v_mul_f32 v236, v141, v241
    v_mul_f32 v238, v173, v241
    v_fma_f32 v236, -v173, v242, v236
    v_fma_f32 v238, v141, v242, v238
    v_cvt_pk_bf16_f32 v88, v235, v236
    v_cvt_pk_bf16_f32 v104, v237, v238
    v_cvt_pk_bf16_f32 v120, -v237, -v238
    v_fmamk_f32 v243, v228, 0x3c100000, v229
    v_cos_f32 v239, v243
    v_sin_f32 v240, v243
    v_mul_f32 v235, v142, v239
    v_mul_f32 v237, v174, v239
    v_fma_f32 v235, -v174, v240, v235
    v_fma_f32 v237, v142, v240, v237
    v_fmamk_f32 v243, v228, 0x3c180000, v229
    v_cos_f32 v241, v243
    v_sin_f32 v242, v243
    v_mul_f32 v236, v143, v241
    v_mul_f32 v238, v175, v241
    v_fma_f32 v236, -v175, v242, v236
    v_fma_f32 v238, v143, v242, v238
    v_cvt_pk_bf16_f32 v89, v235, v236
    v_cvt_pk_bf16_f32 v105, v237, v238
    v_cvt_pk_bf16_f32 v121, -v237, -v238
    v_fmamk_f32 v243, v228, 0x3c400000, v229
    v_cos_f32 v239, v243
    v_sin_f32 v240, v243
    v_mul_f32 v235, v144, v239
    v_mul_f32 v237, v176, v239
    v_fma_f32 v235, -v176, v240, v235
    v_fma_f32 v237, v144, v240, v237
    v_fmamk_f32 v243, v228, 0x3c480000, v229
    v_cos_f32 v241, v243
    v_sin_f32 v242, v243
    v_mul_f32 v236, v145, v241
    v_mul_f32 v238, v177, v241
    v_fma_f32 v236, -v177, v242, v236
    v_fma_f32 v238, v145, v242, v238
    v_cvt_pk_bf16_f32 v90, v235, v236
    v_cvt_pk_bf16_f32 v106, v237, v238
    v_cvt_pk_bf16_f32 v122, -v237, -v238
    v_fmamk_f32 v243, v228, 0x3c500000, v229
    v_cos_f32 v239, v243
    v_sin_f32 v240, v243
    v_mul_f32 v235, v146, v239
    v_mul_f32 v237, v178, v239
    v_fma_f32 v235, -v178, v240, v235
    v_fma_f32 v237, v146, v240, v237
    v_fmamk_f32 v243, v228, 0x3c580000, v229
    v_cos_f32 v241, v243
    v_sin_f32 v242, v243
    v_mul_f32 v236, v147, v241
    v_mul_f32 v238, v179, v241
    v_fma_f32 v236, -v179, v242, v236
    v_fma_f32 v238, v147, v242, v238
    v_cvt_pk_bf16_f32 v91, v235, v236
    v_cvt_pk_bf16_f32 v107, v237, v238
    v_cvt_pk_bf16_f32 v123, -v237, -v238
    v_add_f32 v228, 0x42000000, v228
    v_mov_b32 v229, v230
    v_fmamk_f32 v243, v228, 0x0, v229
    v_cos_f32 v239, v243
    v_sin_f32 v240, v243
    v_mul_f32 v235, v148, v239
    v_mul_f32 v237, v180, v239
    v_fma_f32 v235, -v180, v240, v235
    v_fma_f32 v237, v148, v240, v237
    v_fmamk_f32 v243, v228, 0x3a000000, v229
    v_cos_f32 v241, v243
    v_sin_f32 v242, v243
    v_mul_f32 v236, v149, v241
    v_mul_f32 v238, v181, v241
    v_fma_f32 v236, -v181, v242, v236
    v_fma_f32 v238, v149, v242, v238
    v_cvt_pk_bf16_f32 v92, v235, v236
    v_cvt_pk_bf16_f32 v108, v237, v238
    v_cvt_pk_bf16_f32 v124, -v237, -v238
    v_fmamk_f32 v243, v228, 0x3a800000, v229
    v_cos_f32 v239, v243
    v_sin_f32 v240, v243
    v_mul_f32 v235, v150, v239
    v_mul_f32 v237, v182, v239
    v_fma_f32 v235, -v182, v240, v235
    v_fma_f32 v237, v150, v240, v237
    v_fmamk_f32 v243, v228, 0x3ac00000, v229
    v_cos_f32 v241, v243
    v_sin_f32 v242, v243
    v_mul_f32 v236, v151, v241
    v_mul_f32 v238, v183, v241
    v_fma_f32 v236, -v183, v242, v236
    v_fma_f32 v238, v151, v242, v238
    v_cvt_pk_bf16_f32 v93, v235, v236
    v_cvt_pk_bf16_f32 v109, v237, v238
    v_cvt_pk_bf16_f32 v125, -v237, -v238
    v_fmamk_f32 v243, v228, 0x3b800000, v229
    v_cos_f32 v239, v243
    v_sin_f32 v240, v243
    v_mul_f32 v235, v152, v239
    v_mul_f32 v237, v184, v239
    v_fma_f32 v235, -v184, v240, v235
    v_fma_f32 v237, v152, v240, v237
    v_fmamk_f32 v243, v228, 0x3b900000, v229
    v_cos_f32 v241, v243
    v_sin_f32 v242, v243
    v_mul_f32 v236, v153, v241
    v_mul_f32 v238, v185, v241
    v_fma_f32 v236, -v185, v242, v236
    v_fma_f32 v238, v153, v242, v238
    v_cvt_pk_bf16_f32 v94, v235, v236
    v_cvt_pk_bf16_f32 v110, v237, v238
    v_cvt_pk_bf16_f32 v126, -v237, -v238
    v_fmamk_f32 v243, v228, 0x3ba00000, v229
    v_cos_f32 v239, v243
    v_sin_f32 v240, v243
    v_mul_f32 v235, v154, v239
    v_mul_f32 v237, v186, v239
    v_fma_f32 v235, -v186, v240, v235
    v_fma_f32 v237, v154, v240, v237
    v_fmamk_f32 v243, v228, 0x3bb00000, v229
    v_cos_f32 v241, v243
    v_sin_f32 v242, v243
    v_mul_f32 v236, v155, v241
    v_mul_f32 v238, v187, v241
    v_fma_f32 v236, -v187, v242, v236
    v_fma_f32 v238, v155, v242, v238
    v_cvt_pk_bf16_f32 v95, v235, v236
    v_cvt_pk_bf16_f32 v111, v237, v238
    v_cvt_pk_bf16_f32 v127, -v237, -v238
    v_fmamk_f32 v243, v228, 0x3c000000, v229
    v_cos_f32 v239, v243
    v_sin_f32 v240, v243
    v_mul_f32 v235, v156, v239
    v_mul_f32 v237, v188, v239
    v_fma_f32 v235, -v188, v240, v235
    v_fma_f32 v237, v156, v240, v237
    v_fmamk_f32 v243, v228, 0x3c080000, v229
    v_cos_f32 v241, v243
    v_sin_f32 v242, v243
    v_mul_f32 v236, v157, v241
    v_mul_f32 v238, v189, v241
    v_fma_f32 v236, -v189, v242, v236
    v_fma_f32 v238, v157, v242, v238
    v_cvt_pk_bf16_f32 v96, v235, v236
    v_cvt_pk_bf16_f32 v112, v237, v238
    v_cvt_pk_bf16_f32 v128, -v237, -v238
    v_fmamk_f32 v243, v228, 0x3c100000, v229
    v_cos_f32 v239, v243
    v_sin_f32 v240, v243
    v_mul_f32 v235, v158, v239
    v_mul_f32 v237, v190, v239
    v_fma_f32 v235, -v190, v240, v235
    v_fma_f32 v237, v158, v240, v237
    v_fmamk_f32 v243, v228, 0x3c180000, v229
    v_cos_f32 v241, v243
    v_sin_f32 v242, v243
    v_mul_f32 v236, v159, v241
    v_mul_f32 v238, v191, v241
    v_fma_f32 v236, -v191, v242, v236
    v_fma_f32 v238, v159, v242, v238
    v_cvt_pk_bf16_f32 v97, v235, v236
    v_cvt_pk_bf16_f32 v113, v237, v238
    v_cvt_pk_bf16_f32 v129, -v237, -v238
    v_fmamk_f32 v243, v228, 0x3c400000, v229
    v_cos_f32 v239, v243
    v_sin_f32 v240, v243
    v_mul_f32 v235, v160, v239
    v_mul_f32 v237, v192, v239
    v_fma_f32 v235, -v192, v240, v235
    v_fma_f32 v237, v160, v240, v237
    v_fmamk_f32 v243, v228, 0x3c480000, v229
    v_cos_f32 v241, v243
    v_sin_f32 v242, v243
    v_mul_f32 v236, v161, v241
    v_mul_f32 v238, v193, v241
    v_fma_f32 v236, -v193, v242, v236
    v_fma_f32 v238, v161, v242, v238
    v_cvt_pk_bf16_f32 v98, v235, v236
    v_cvt_pk_bf16_f32 v114, v237, v238
    v_cvt_pk_bf16_f32 v130, -v237, -v238
    v_fmamk_f32 v243, v228, 0x3c500000, v229
    v_cos_f32 v239, v243
    v_sin_f32 v240, v243
    v_mul_f32 v235, v162, v239
    v_mul_f32 v237, v194, v239
    v_fma_f32 v235, -v194, v240, v235
    v_fma_f32 v237, v162, v240, v237
    v_fmamk_f32 v243, v228, 0x3c580000, v229
    v_cos_f32 v241, v243
    v_sin_f32 v242, v243
    v_mul_f32 v236, v163, v241
    v_mul_f32 v238, v195, v241
    v_fma_f32 v236, -v195, v242, v236
    v_fma_f32 v238, v163, v242, v238
    v_cvt_pk_bf16_f32 v99, v235, v236
    v_cvt_pk_bf16_f32 v115, v237, v238
    v_cvt_pk_bf16_f32 v131, -v237, -v238
    v_mfma_f32_32x32x16_bf16 v[132:147], v[68:71], v[84:87], 0
    v_mfma_f32_32x32x16_bf16 v[164:179], v[68:71], v[100:103], 0
    v_mfma_f32_32x32x16_bf16 v[132:147], v[76:79], v[116:119], v[132:147]
    v_mfma_f32_32x32x16_bf16 v[164:179], v[76:79], v[84:87], v[164:179]
    v_mfma_f32_32x32x16_bf16 v[132:147], v[72:75], v[88:91], v[132:147]
    v_mfma_f32_32x32x16_bf16 v[164:179], v[72:75], v[104:107], v[164:179]
    v_mfma_f32_32x32x16_bf16 v[132:147], v[80:83], v[120:123], v[132:147]
    v_mfma_f32_32x32x16_bf16 v[164:179], v[80:83], v[88:91], v[164:179]
    v_mfma_f32_32x32x16_bf16 v[148:163], v[68:71], v[92:95], 0
    v_mfma_f32_32x32x16_bf16 v[180:195], v[68:71], v[108:111], 0
    v_mfma_f32_32x32x16_bf16 v[148:163], v[76:79], v[124:127], v[148:163]
    v_mfma_f32_32x32x16_bf16 v[180:195], v[76:79], v[92:95], v[180:195]
    v_mfma_f32_32x32x16_bf16 v[148:163], v[72:75], v[96:99], v[148:163]
    v_mfma_f32_32x32x16_bf16 v[180:195], v[72:75], v[112:115], v[180:195]
    v_mfma_f32_32x32x16_bf16 v[148:163], v[80:83], v[128:131], v[148:163]
    v_mfma_f32_32x32x16_bf16 v[180:195], v[80:83], v[96:99], v[180:195]
    v_lshlrev_b32 v231, 4, v1
    v_add_u32 v232, s6, v231
    s_lshl_b32 s5, s3, 12
    s_add_u32 s5, s5, 0x5800000
    s_add_u32 s2, s5, 4096
    v_cvt_pk_bf16_f32 v84, v132, v133
    v_cvt_pk_bf16_f32 v85, v134, v135
    v_cvt_pk_bf16_f32 v86, v136, v137
    v_cvt_pk_bf16_f32 v87, v138, v139
    buffer_store_dwordx4 v[84:87], v231, s[8:11], s5 offen offset:0 sc1
    v_cvt_pk_bf16_f32 v88, v140, v141
    v_cvt_pk_bf16_f32 v89, v142, v143
    v_cvt_pk_bf16_f32 v90, v144, v145
    v_cvt_pk_bf16_f32 v91, v146, v147
    buffer_store_dwordx4 v[88:91], v231, s[8:11], s5 offen offset:1024 sc1
    v_cvt_pk_bf16_f32 v92, v148, v149
    v_cvt_pk_bf16_f32 v93, v150, v151
    v_cvt_pk_bf16_f32 v94, v152, v153
    v_cvt_pk_bf16_f32 v95, v154, v155
    buffer_store_dwordx4 v[92:95], v231, s[8:11], s5 offen offset:2048 sc1
    v_cvt_pk_bf16_f32 v96, v156, v157
    v_cvt_pk_bf16_f32 v97, v158, v159
    v_cvt_pk_bf16_f32 v98, v160, v161
    v_cvt_pk_bf16_f32 v99, v162, v163
    buffer_store_dwordx4 v[96:99], v231, s[8:11], s5 offen offset:3072 sc1
    v_cvt_pk_bf16_f32 v100, v164, v165
    v_cvt_pk_bf16_f32 v101, v166, v167
    v_cvt_pk_bf16_f32 v102, v168, v169
    v_cvt_pk_bf16_f32 v103, v170, v171
    buffer_store_dwordx4 v[100:103], v232, s[8:11], s2 offen offset:0 sc1
    v_cvt_pk_bf16_f32 v104, v172, v173
    v_cvt_pk_bf16_f32 v105, v174, v175
    v_cvt_pk_bf16_f32 v106, v176, v177
    v_cvt_pk_bf16_f32 v107, v178, v179
    buffer_store_dwordx4 v[104:107], v232, s[8:11], s2 offen offset:1024 sc1
    v_cvt_pk_bf16_f32 v108, v180, v181
    v_cvt_pk_bf16_f32 v109, v182, v183
    v_cvt_pk_bf16_f32 v110, v184, v185
    v_cvt_pk_bf16_f32 v111, v186, v187
    buffer_store_dwordx4 v[108:111], v232, s[8:11], s2 offen offset:2048 sc1
    v_cvt_pk_bf16_f32 v112, v188, v189
    v_cvt_pk_bf16_f32 v113, v190, v191
    v_cvt_pk_bf16_f32 v114, v192, v193
    v_cvt_pk_bf16_f32 v115, v194, v195
    buffer_store_dwordx4 v[112:115], v232, s[8:11], s2 offen offset:3072 sc1
    s_add_u32 s7, s7, 8
    s_cmp_lt_u32 s7, 16
    s_cbranch_scc1 colloop_142
    s_cmp_eq_u32 s3, 1008
    s_cbranch_scc1 colloop_142
    s_waitcnt vmcnt(0) lgkmcnt(0)
    s_barrier
    s_cmp_lg_u32 s58, 0
    s_cbranch_scc1 sig_144
    v_mov_b32 v75, 0x5ffffff0
    v_mov_b32 v76, 44
    v_cmp_eq_u32 vcc, 0, v1
    s_nop 1
    v_cndmask_b32 v76, v75, v76, vcc
    v_mov_b32 v75, 1
    buffer_atomic_add v75, v76, s[12:15], 0 offen sc1
sig_144:
    v_bfe_u32 v76, v1, 2, 2
    v_sub_u32 v76, 0, v76
    v_lshrrev_b32 v75, 4, v1
    v_xor_b32 v76, v76, v75
    v_and_b32 v76, 3, v76
    v_bfe_u32 v72, v1, 0, 4
    v_lshlrev_b32 v72, 6, v72
    v_lshl_or_b32 v72, v76, 4, v72
    s_lshr_b32 s74, s58, 2
    s_mul_i32 s74, s74, 8192
    v_add_u32 v72, s74, v72
    v_bfe_u32 v73, v1, 0, 2
    v_lshlrev_b32 v73, 3, v73
    v_bfe_u32 v75, v1, 4, 1
    v_lshl_or_b32 v73, v75, 5, v73
    v_bfe_u32 v75, v1, 2, 2
    v_lshl_or_b32 v73, v75, 6, v73
    v_bfe_u32 v75, v1, 2, 2
    v_lshl_or_b32 v73, v75, 9, v73
    v_bfe_u32 v75, v1, 4, 2
    v_lshl_or_b32 v73, v75, 12, v73
    s_and_b32 s74, s58, 3
    s_mul_i32 s74, s74, 128
    s_or_b32 s74, s74, 16384
    v_xor_b32 v73, s74, v73
    s_mov_b64 s[60:61], s[8:9]
    s_mov_b32 s62, 0x10000000
    s_mov_b32 s63, 0x20000
    s_mov_b64 s[64:65], s[8:9]
    s_mov_b32 s66, 0x10000000
    s_mov_b32 s67, 0x20000
    v_lshrrev_b32 v76, 4, v1
    v_sub_u32 v76, 0, v76
    v_xor_b32 v76, v76, v1
    v_and_b32 v76, 3, v76
    s_mul_i32 s74, s58, 32
    v_lshrrev_b32 v77, 2, v1
    v_add3_u32 v77, v77, s74, 0
    v_bfe_u32 v68, v77, 0, 2
    v_lshlrev_b32 v68, 11, v68
    v_bfe_u32 v75, v77, 4, 1
    v_lshl_or_b32 v68, v75, 13, v68
    v_bfe_u32 v75, v77, 2, 2
    v_lshl_or_b32 v68, v75, 14, v68
    v_bfe_u32 v75, v77, 5, 3
    v_lshl_or_b32 v68, v75, 16, v68
    v_lshl_add_u32 v68, v76, 4, v68
    v_lshrrev_b32 v77, 2, v1
    v_add3_u32 v77, v77, s74, 16
    v_bfe_u32 v69, v77, 0, 2
    v_lshlrev_b32 v69, 11, v69
    v_bfe_u32 v75, v77, 4, 1
    v_lshl_or_b32 v69, v75, 13, v69
    v_bfe_u32 v75, v77, 2, 2
    v_lshl_or_b32 v69, v75, 14, v69
    v_bfe_u32 v75, v77, 5, 3
    v_lshl_or_b32 v69, v75, 16, v69
    v_lshl_add_u32 v69, v76, 4, v69
    s_and_b32 s74, s58, 2
    v_bfe_u32 v76, v1, 0, 5
    v_bfe_u32 v77, v1, 5, 1
    v_lshlrev_b32 v77, 2, v77
    v_xor_b32 v76, v76, v77
    v_xor_b32 v76, s74, v76
    v_lshlrev_b32 v77, 4, v76
    v_lshrrev_b32 v76, 5, v1
    v_lshl_add_u32 v70, v76, 12, v77
    v_bfe_u32 v76, v1, 0, 5
    v_bfe_u32 v77, v1, 5, 1
    v_lshlrev_b32 v77, 2, v77
    v_xor_b32 v76, v76, v77
    v_xor_b32 v76, s74, v76
    v_xor_b32 v76, 8, v76
    v_lshlrev_b32 v77, 4, v76
    v_lshrrev_b32 v76, 5, v1
    v_lshl_add_u32 v71, v76, 12, v77
    v_add_u32 v71, 8192, v71
    s_lshl_b32 s74, s58, 14
    v_add_u32 v70, s74, v70
    v_add_u32 v71, s74, v71
    s_mov_b32 s70, 131072
    s_and_b32 s79, s57, 3
    s_bfe_u32 s80, s76, 0x10002
    s_bfe_u32 s85, s76, 0x20005
    s_lshl_b32 s85, s85, 1
    s_or_b32 s80, s80, s85
    s_lshl_b32 s68, s79, 19
    s_add_u32 s68, s68, 0x5200000
    s_lshl_b32 s69, s80, 9
    s_add_u32 s69, s69, 0x5800000
    s_cmp_lg_u32 s58, 0
    s_cbranch_scc1 wall_145
    v_mov_b32 v76, 168
wctr_146:
    buffer_load_dword v75, v76, s[12:15], 0 offen sc1
    s_waitcnt vmcnt(0)
    v_cmp_ne_u32 vcc, 2097216, v75
    s_cbranch_vccz wctr_ok_147
    s_sub_u32 s77, s77, 1
    s_cbranch_scc0 wctr_146
    s_mov_b32 s77, 0
wctr_ok_147:
wall_145:
    s_cmp_lg_u32 s58, 0
    s_cbranch_scc1 wall_148
    v_mov_b32 v76, 44
wctr_149:
    buffer_load_dword v75, v76, s[12:15], 0 offen sc1
    s_waitcnt vmcnt(0)
    v_cmp_gt_u16 vcc, 32, v75
    s_cbranch_vccz wctr_ok_150
    s_sub_u32 s77, s77, 1
    s_cbranch_scc0 wctr_149
    s_mov_b32 s77, 0
wctr_ok_150:
wall_148:
    s_barrier
    s_mul_i32 s71, s58, 2048
    s_mov_b32 m0, s71
    s_nop 0
    buffer_load_dwordx4 v68, s[60:63], s68 offen lds
    s_add_u32 m0, s71, 1024
    s_nop 0
    buffer_load_dwordx4 v69, s[60:63], s68 offen lds
    s_add_u32 m0, s71, 16384
    s_nop 0
    buffer_load_dwordx4 v70, s[64:67], s69 offen lds
    s_add_u32 m0, s71, 17408
    s_nop 0
    buffer_load_dwordx4 v71, s[64:67], s69 offen lds
    s_add_u32 s68, s68, 64
    s_add_u32 s69, s69, s70
    s_add_u32 s71, s71, 32768
    s_and_b32 s71, s71, 0x1ffff
    s_mov_b32 m0, s71
    s_nop 0
    buffer_load_dwordx4 v68, s[60:63], s68 offen lds
    s_add_u32 m0, s71, 1024
    s_nop 0
    buffer_load_dwordx4 v69, s[60:63], s68 offen lds
    s_add_u32 m0, s71, 16384
    s_nop 0
    buffer_load_dwordx4 v70, s[64:67], s69 offen lds
    s_add_u32 m0, s71, 17408
    s_nop 0
    buffer_load_dwordx4 v71, s[64:67], s69 offen lds
    s_add_u32 s68, s68, 64
    s_add_u32 s69, s69, s70
    s_add_u32 s71, s71, 32768
    s_and_b32 s71, s71, 0x1ffff
    s_mov_b32 m0, s71
    s_nop 0
    buffer_load_dwordx4 v68, s[60:63], s68 offen lds
    s_add_u32 m0, s71, 1024
    s_nop 0
    buffer_load_dwordx4 v69, s[60:63], s68 offen lds
    s_add_u32 m0, s71, 16384
    s_nop 0
    buffer_load_dwordx4 v70, s[64:67], s69 offen lds
    s_add_u32 m0, s71, 17408
    s_nop 0
    buffer_load_dwordx4 v71, s[64:67], s69 offen lds
    s_add_u32 s68, s68, 64
    s_add_u32 s69, s69, s70
    s_add_u32 s71, s71, 32768
    s_and_b32 s71, s71, 0x1ffff
    s_mov_b32 m0, s71
    s_nop 0
    buffer_load_dwordx4 v68, s[60:63], s68 offen lds
    s_add_u32 m0, s71, 1024
    s_nop 0
    buffer_load_dwordx4 v69, s[60:63], s68 offen lds
    s_add_u32 m0, s71, 16384
    s_nop 0
    buffer_load_dwordx4 v70, s[64:67], s69 offen lds
    s_add_u32 m0, s71, 17408
    s_nop 0
    buffer_load_dwordx4 v71, s[64:67], s69 offen lds
    s_add_u32 s68, s68, 64
    s_add_u32 s69, s69, s70
    s_add_u32 s71, s71, 32768
    s_and_b32 s71, s71, 0x1ffff
    s_mov_b32 s72, 0
    s_waitcnt vmcnt(12)
    s_barrier
    v_add_u32 v74, s72, v72
    v_add_u32 v75, s72, v73
    v_xor_b32 v76, 32, v75
    v_xor_b32 v77, 64, v75
    v_xor_b32 v78, 96, v75
    s_add_u32 s72, s72, 32768
    s_and_b32 s72, s72, 0x1ffff
    ds_read_b128 v[4:7], v74 offset:0
    ds_read_b128 v[8:11], v74 offset:1024
    ds_read_b128 v[12:15], v74 offset:2048
    ds_read_b128 v[16:19], v74 offset:3072
    ds_read_b64_tr_b16 v[36:37], v75 offset:0
    ds_read_b64_tr_b16 v[38:39], v75 offset:2048
    ds_read_b64_tr_b16 v[40:41], v76 offset:0
    ds_read_b64_tr_b16 v[42:43], v76 offset:2048
    ds_read_b64_tr_b16 v[44:45], v77 offset:0
    ds_read_b64_tr_b16 v[46:47], v77 offset:2048
    ds_read_b64_tr_b16 v[48:49], v78 offset:0
    ds_read_b64_tr_b16 v[50:51], v78 offset:2048
    s_waitcnt lgkmcnt(0)
    v_mfma_f32_16x16x32_bf16 v[80:83], v[4:7], v[36:39], 0
    ds_read_b128 v[20:23], v74 offset:4096
    v_mfma_f32_16x16x32_bf16 v[84:87], v[4:7], v[40:43], 0
    v_mfma_f32_16x16x32_bf16 v[88:91], v[4:7], v[44:47], 0
    ds_read_b128 v[24:27], v74 offset:5120
    v_mfma_f32_16x16x32_bf16 v[92:95], v[4:7], v[48:51], 0
    v_mfma_f32_16x16x32_bf16 v[96:99], v[8:11], v[36:39], 0
    ds_read_b128 v[28:31], v74 offset:6144
    v_mfma_f32_16x16x32_bf16 v[100:103], v[8:11], v[40:43], 0
    v_mfma_f32_16x16x32_bf16 v[104:107], v[8:11], v[44:47], 0
    ds_read_b128 v[32:35], v74 offset:7168
    v_mfma_f32_16x16x32_bf16 v[108:111], v[8:11], v[48:51], 0
    v_mfma_f32_16x16x32_bf16 v[112:115], v[12:15], v[36:39], 0
    v_mfma_f32_16x16x32_bf16 v[116:119], v[12:15], v[40:43], 0
    v_mfma_f32_16x16x32_bf16 v[120:123], v[12:15], v[44:47], 0
    v_mfma_f32_16x16x32_bf16 v[124:127], v[12:15], v[48:51], 0
    v_mfma_f32_16x16x32_bf16 v[128:131], v[16:19], v[36:39], 0
    v_mfma_f32_16x16x32_bf16 v[132:135], v[16:19], v[40:43], 0
    v_mfma_f32_16x16x32_bf16 v[136:139], v[16:19], v[44:47], 0
    v_mfma_f32_16x16x32_bf16 v[140:143], v[16:19], v[48:51], 0
    s_waitcnt vmcnt(8) lgkmcnt(0)
    s_barrier
    v_mfma_f32_16x16x32_bf16 v[144:147], v[20:23], v[36:39], 0
    v_add_u32 v74, s72, v72
    v_add_u32 v75, s72, v73
    v_xor_b32 v76, 32, v75
    v_xor_b32 v77, 64, v75
    v_xor_b32 v78, 96, v75
    v_mfma_f32_16x16x32_bf16 v[148:151], v[20:23], v[40:43], 0
    s_add_u32 s72, s72, 32768
    s_and_b32 s72, s72, 0x1ffff
    ds_read_b128 v[4:7], v74 offset:0
    v_mfma_f32_16x16x32_bf16 v[152:155], v[20:23], v[44:47], 0
    ds_read_b64_tr_b16 v[52:53], v75 offset:0
    v_mfma_f32_16x16x32_bf16 v[156:159], v[20:23], v[48:51], 0
    ds_read_b64_tr_b16 v[54:55], v75 offset:2048
    ds_read_b64_tr_b16 v[56:57], v76 offset:0
    v_mfma_f32_16x16x32_bf16 v[160:163], v[24:27], v[36:39], 0
    ds_read_b64_tr_b16 v[58:59], v76 offset:2048
    v_mfma_f32_16x16x32_bf16 v[164:167], v[24:27], v[40:43], 0
    ds_read_b64_tr_b16 v[60:61], v77 offset:0
    ds_read_b64_tr_b16 v[62:63], v77 offset:2048
    v_mfma_f32_16x16x32_bf16 v[168:171], v[24:27], v[44:47], 0
    ds_read_b64_tr_b16 v[64:65], v78 offset:0
    v_mfma_f32_16x16x32_bf16 v[172:175], v[24:27], v[48:51], 0
    ds_read_b64_tr_b16 v[66:67], v78 offset:2048
    ds_read_b128 v[8:11], v74 offset:1024
    v_mfma_f32_16x16x32_bf16 v[176:179], v[28:31], v[36:39], 0
    ds_read_b128 v[12:15], v74 offset:2048
    ds_read_b128 v[16:19], v74 offset:3072
    v_mfma_f32_16x16x32_bf16 v[180:183], v[28:31], v[40:43], 0
    s_mov_b32 m0, s71
    v_mfma_f32_16x16x32_bf16 v[184:187], v[28:31], v[44:47], 0
    buffer_load_dwordx4 v68, s[60:63], s68 offen lds
    s_add_u32 m0, s71, 1024
    v_mfma_f32_16x16x32_bf16 v[188:191], v[28:31], v[48:51], 0
    buffer_load_dwordx4 v69, s[60:63], s68 offen lds
    v_mfma_f32_16x16x32_bf16 v[192:195], v[32:35], v[36:39], 0
    s_add_u32 m0, s71, 16384
    s_nop 0
    buffer_load_dwordx4 v70, s[64:67], s69 offen lds
    v_mfma_f32_16x16x32_bf16 v[196:199], v[32:35], v[40:43], 0
    s_add_u32 m0, s71, 17408
    v_mfma_f32_16x16x32_bf16 v[200:203], v[32:35], v[44:47], 0
    buffer_load_dwordx4 v71, s[64:67], s69 offen lds
    s_add_u32 s68, s68, 64
    s_add_u32 s69, s69, s70
    v_mfma_f32_16x16x32_bf16 v[204:207], v[32:35], v[48:51], 0
    s_add_u32 s71, s71, 32768
    s_and_b32 s71, s71, 0x1ffff
    s_waitcnt lgkmcnt(0)
    v_mfma_f32_16x16x32_bf16 v[80:83], v[4:7], v[52:55], v[80:83]
    ds_read_b128 v[20:23], v74 offset:4096
    v_mfma_f32_16x16x32_bf16 v[84:87], v[4:7], v[56:59], v[84:87]
    v_mfma_f32_16x16x32_bf16 v[88:91], v[4:7], v[60:63], v[88:91]
    ds_read_b128 v[24:27], v74 offset:5120
    v_mfma_f32_16x16x32_bf16 v[92:95], v[4:7], v[64:67], v[92:95]
    v_mfma_f32_16x16x32_bf16 v[96:99], v[8:11], v[52:55], v[96:99]
    ds_read_b128 v[28:31], v74 offset:6144
    v_mfma_f32_16x16x32_bf16 v[100:103], v[8:11], v[56:59], v[100:103]
    v_mfma_f32_16x16x32_bf16 v[104:107], v[8:11], v[60:63], v[104:107]
    ds_read_b128 v[32:35], v74 offset:7168
    v_mfma_f32_16x16x32_bf16 v[108:111], v[8:11], v[64:67], v[108:111]
    v_mfma_f32_16x16x32_bf16 v[112:115], v[12:15], v[52:55], v[112:115]
    v_mfma_f32_16x16x32_bf16 v[116:119], v[12:15], v[56:59], v[116:119]
    v_mfma_f32_16x16x32_bf16 v[120:123], v[12:15], v[60:63], v[120:123]
    v_mfma_f32_16x16x32_bf16 v[124:127], v[12:15], v[64:67], v[124:127]
    v_mfma_f32_16x16x32_bf16 v[128:131], v[16:19], v[52:55], v[128:131]
    v_mfma_f32_16x16x32_bf16 v[132:135], v[16:19], v[56:59], v[132:135]
    v_mfma_f32_16x16x32_bf16 v[136:139], v[16:19], v[60:63], v[136:139]
    v_mfma_f32_16x16x32_bf16 v[140:143], v[16:19], v[64:67], v[140:143]
    s_waitcnt vmcnt(8) lgkmcnt(0)
    s_barrier
    v_mfma_f32_16x16x32_bf16 v[144:147], v[20:23], v[52:55], v[144:147]
    v_add_u32 v74, s72, v72
    v_add_u32 v75, s72, v73
    v_xor_b32 v76, 32, v75
    v_xor_b32 v77, 64, v75
    v_xor_b32 v78, 96, v75
    v_mfma_f32_16x16x32_bf16 v[148:151], v[20:23], v[56:59], v[148:151]
    s_add_u32 s72, s72, 32768
    s_and_b32 s72, s72, 0x1ffff
    ds_read_b128 v[4:7], v74 offset:0
    v_mfma_f32_16x16x32_bf16 v[152:155], v[20:23], v[60:63], v[152:155]
    ds_read_b64_tr_b16 v[36:37], v75 offset:0
    v_mfma_f32_16x16x32_bf16 v[156:159], v[20:23], v[64:67], v[156:159]
    ds_read_b64_tr_b16 v[38:39], v75 offset:2048
    ds_read_b64_tr_b16 v[40:41], v76 offset:0
    v_mfma_f32_16x16x32_bf16 v[160:163], v[24:27], v[52:55], v[160:163]
    ds_read_b64_tr_b16 v[42:43], v76 offset:2048
    v_mfma_f32_16x16x32_bf16 v[164:167], v[24:27], v[56:59], v[164:167]
    ds_read_b64_tr_b16 v[44:45], v77 offset:0
    ds_read_b64_tr_b16 v[46:47], v77 offset:2048
    v_mfma_f32_16x16x32_bf16 v[168:171], v[24:27], v[60:63], v[168:171]
    ds_read_b64_tr_b16 v[48:49], v78 offset:0
    v_mfma_f32_16x16x32_bf16 v[172:175], v[24:27], v[64:67], v[172:175]
    ds_read_b64_tr_b16 v[50:51], v78 offset:2048
    ds_read_b128 v[8:11], v74 offset:1024
    v_mfma_f32_16x16x32_bf16 v[176:179], v[28:31], v[52:55], v[176:179]
    ds_read_b128 v[12:15], v74 offset:2048
    ds_read_b128 v[16:19], v74 offset:3072
    v_mfma_f32_16x16x32_bf16 v[180:183], v[28:31], v[56:59], v[180:183]
    s_mov_b32 m0, s71
    v_mfma_f32_16x16x32_bf16 v[184:187], v[28:31], v[60:63], v[184:187]
    buffer_load_dwordx4 v68, s[60:63], s68 offen lds
    s_add_u32 m0, s71, 1024
    v_mfma_f32_16x16x32_bf16 v[188:191], v[28:31], v[64:67], v[188:191]
    buffer_load_dwordx4 v69, s[60:63], s68 offen lds
    v_mfma_f32_16x16x32_bf16 v[192:195], v[32:35], v[52:55], v[192:195]
    s_add_u32 m0, s71, 16384
    s_nop 0
    buffer_load_dwordx4 v70, s[64:67], s69 offen lds
    v_mfma_f32_16x16x32_bf16 v[196:199], v[32:35], v[56:59], v[196:199]
    s_add_u32 m0, s71, 17408
    v_mfma_f32_16x16x32_bf16 v[200:203], v[32:35], v[60:63], v[200:203]
    buffer_load_dwordx4 v71, s[64:67], s69 offen lds
    s_add_u32 s68, s68, 64
    s_add_u32 s69, s69, s70
    v_mfma_f32_16x16x32_bf16 v[204:207], v[32:35], v[64:67], v[204:207]
    s_add_u32 s71, s71, 32768
    s_and_b32 s71, s71, 0x1ffff
    s_mov_b32 s73, 13
gl_151:
    s_waitcnt lgkmcnt(0)
    v_mfma_f32_16x16x32_bf16 v[80:83], v[4:7], v[36:39], v[80:83]
    ds_read_b128 v[20:23], v74 offset:4096
    v_mfma_f32_16x16x32_bf16 v[84:87], v[4:7], v[40:43], v[84:87]
    v_mfma_f32_16x16x32_bf16 v[88:91], v[4:7], v[44:47], v[88:91]
    ds_read_b128 v[24:27], v74 offset:5120
    v_mfma_f32_16x16x32_bf16 v[92:95], v[4:7], v[48:51], v[92:95]
    v_mfma_f32_16x16x32_bf16 v[96:99], v[8:11], v[36:39], v[96:99]
    ds_read_b128 v[28:31], v74 offset:6144
    v_mfma_f32_16x16x32_bf16 v[100:103], v[8:11], v[40:43], v[100:103]
    v_mfma_f32_16x16x32_bf16 v[104:107], v[8:11], v[44:47], v[104:107]
    ds_read_b128 v[32:35], v74 offset:7168
    v_mfma_f32_16x16x32_bf16 v[108:111], v[8:11], v[48:51], v[108:111]
    v_mfma_f32_16x16x32_bf16 v[112:115], v[12:15], v[36:39], v[112:115]
    v_mfma_f32_16x16x32_bf16 v[116:119], v[12:15], v[40:43], v[116:119]
    v_mfma_f32_16x16x32_bf16 v[120:123], v[12:15], v[44:47], v[120:123]
    v_mfma_f32_16x16x32_bf16 v[124:127], v[12:15], v[48:51], v[124:127]
    v_mfma_f32_16x16x32_bf16 v[128:131], v[16:19], v[36:39], v[128:131]
    v_mfma_f32_16x16x32_bf16 v[132:135], v[16:19], v[40:43], v[132:135]
    v_mfma_f32_16x16x32_bf16 v[136:139], v[16:19], v[44:47], v[136:139]
    v_mfma_f32_16x16x32_bf16 v[140:143], v[16:19], v[48:51], v[140:143]
    s_waitcnt vmcnt(8) lgkmcnt(0)
    s_barrier
    v_mfma_f32_16x16x32_bf16 v[144:147], v[20:23], v[36:39], v[144:147]
    v_add_u32 v74, s72, v72
    v_add_u32 v75, s72, v73
    v_xor_b32 v76, 32, v75
    v_xor_b32 v77, 64, v75
    v_xor_b32 v78, 96, v75
    v_mfma_f32_16x16x32_bf16 v[148:151], v[20:23], v[40:43], v[148:151]
    s_add_u32 s72, s72, 32768
    s_and_b32 s72, s72, 0x1ffff
    ds_read_b128 v[4:7], v74 offset:0
    v_mfma_f32_16x16x32_bf16 v[152:155], v[20:23], v[44:47], v[152:155]
    ds_read_b64_tr_b16 v[52:53], v75 offset:0
    v_mfma_f32_16x16x32_bf16 v[156:159], v[20:23], v[48:51], v[156:159]
    ds_read_b64_tr_b16 v[54:55], v75 offset:2048
    ds_read_b64_tr_b16 v[56:57], v76 offset:0
    v_mfma_f32_16x16x32_bf16 v[160:163], v[24:27], v[36:39], v[160:163]
    ds_read_b64_tr_b16 v[58:59], v76 offset:2048
    v_mfma_f32_16x16x32_bf16 v[164:167], v[24:27], v[40:43], v[164:167]
    ds_read_b64_tr_b16 v[60:61], v77 offset:0
    ds_read_b64_tr_b16 v[62:63], v77 offset:2048
    v_mfma_f32_16x16x32_bf16 v[168:171], v[24:27], v[44:47], v[168:171]
    ds_read_b64_tr_b16 v[64:65], v78 offset:0
    v_mfma_f32_16x16x32_bf16 v[172:175], v[24:27], v[48:51], v[172:175]
    ds_read_b64_tr_b16 v[66:67], v78 offset:2048
    ds_read_b128 v[8:11], v74 offset:1024
    v_mfma_f32_16x16x32_bf16 v[176:179], v[28:31], v[36:39], v[176:179]
    ds_read_b128 v[12:15], v74 offset:2048
    ds_read_b128 v[16:19], v74 offset:3072
    v_mfma_f32_16x16x32_bf16 v[180:183], v[28:31], v[40:43], v[180:183]
    s_mov_b32 m0, s71
    v_mfma_f32_16x16x32_bf16 v[184:187], v[28:31], v[44:47], v[184:187]
    buffer_load_dwordx4 v68, s[60:63], s68 offen lds
    s_add_u32 m0, s71, 1024
    v_mfma_f32_16x16x32_bf16 v[188:191], v[28:31], v[48:51], v[188:191]
    buffer_load_dwordx4 v69, s[60:63], s68 offen lds
    v_mfma_f32_16x16x32_bf16 v[192:195], v[32:35], v[36:39], v[192:195]
    s_add_u32 m0, s71, 16384
    s_nop 0
    buffer_load_dwordx4 v70, s[64:67], s69 offen lds
    v_mfma_f32_16x16x32_bf16 v[196:199], v[32:35], v[40:43], v[196:199]
    s_add_u32 m0, s71, 17408
    v_mfma_f32_16x16x32_bf16 v[200:203], v[32:35], v[44:47], v[200:203]
    buffer_load_dwordx4 v71, s[64:67], s69 offen lds
    s_add_u32 s68, s68, 64
    s_add_u32 s69, s69, s70
    v_mfma_f32_16x16x32_bf16 v[204:207], v[32:35], v[48:51], v[204:207]
    s_add_u32 s71, s71, 32768
    s_and_b32 s71, s71, 0x1ffff
    s_waitcnt lgkmcnt(0)
    v_mfma_f32_16x16x32_bf16 v[80:83], v[4:7], v[52:55], v[80:83]
    ds_read_b128 v[20:23], v74 offset:4096
    v_mfma_f32_16x16x32_bf16 v[84:87], v[4:7], v[56:59], v[84:87]
    v_mfma_f32_16x16x32_bf16 v[88:91], v[4:7], v[60:63], v[88:91]
    ds_read_b128 v[24:27], v74 offset:5120
    v_mfma_f32_16x16x32_bf16 v[92:95], v[4:7], v[64:67], v[92:95]
    v_mfma_f32_16x16x32_bf16 v[96:99], v[8:11], v[52:55], v[96:99]
    ds_read_b128 v[28:31], v74 offset:6144
    v_mfma_f32_16x16x32_bf16 v[100:103], v[8:11], v[56:59], v[100:103]
    v_mfma_f32_16x16x32_bf16 v[104:107], v[8:11], v[60:63], v[104:107]
    ds_read_b128 v[32:35], v74 offset:7168
    v_mfma_f32_16x16x32_bf16 v[108:111], v[8:11], v[64:67], v[108:111]
    v_mfma_f32_16x16x32_bf16 v[112:115], v[12:15], v[52:55], v[112:115]
    v_mfma_f32_16x16x32_bf16 v[116:119], v[12:15], v[56:59], v[116:119]
    v_mfma_f32_16x16x32_bf16 v[120:123], v[12:15], v[60:63], v[120:123]
    v_mfma_f32_16x16x32_bf16 v[124:127], v[12:15], v[64:67], v[124:127]
    v_mfma_f32_16x16x32_bf16 v[128:131], v[16:19], v[52:55], v[128:131]
    v_mfma_f32_16x16x32_bf16 v[132:135], v[16:19], v[56:59], v[132:135]
    v_mfma_f32_16x16x32_bf16 v[136:139], v[16:19], v[60:63], v[136:139]
    v_mfma_f32_16x16x32_bf16 v[140:143], v[16:19], v[64:67], v[140:143]
    s_waitcnt vmcnt(8) lgkmcnt(0)
    s_barrier
    v_mfma_f32_16x16x32_bf16 v[144:147], v[20:23], v[52:55], v[144:147]
    v_add_u32 v74, s72, v72
    v_add_u32 v75, s72, v73
    v_xor_b32 v76, 32, v75
    v_xor_b32 v77, 64, v75
    v_xor_b32 v78, 96, v75
    v_mfma_f32_16x16x32_bf16 v[148:151], v[20:23], v[56:59], v[148:151]
    s_add_u32 s72, s72, 32768
    s_and_b32 s72, s72, 0x1ffff
    ds_read_b128 v[4:7], v74 offset:0
    v_mfma_f32_16x16x32_bf16 v[152:155], v[20:23], v[60:63], v[152:155]
    ds_read_b64_tr_b16 v[36:37], v75 offset:0
    v_mfma_f32_16x16x32_bf16 v[156:159], v[20:23], v[64:67], v[156:159]
    ds_read_b64_tr_b16 v[38:39], v75 offset:2048
    ds_read_b64_tr_b16 v[40:41], v76 offset:0
    v_mfma_f32_16x16x32_bf16 v[160:163], v[24:27], v[52:55], v[160:163]
    ds_read_b64_tr_b16 v[42:43], v76 offset:2048
    v_mfma_f32_16x16x32_bf16 v[164:167], v[24:27], v[56:59], v[164:167]
    ds_read_b64_tr_b16 v[44:45], v77 offset:0
    ds_read_b64_tr_b16 v[46:47], v77 offset:2048
    v_mfma_f32_16x16x32_bf16 v[168:171], v[24:27], v[60:63], v[168:171]
    ds_read_b64_tr_b16 v[48:49], v78 offset:0
    v_mfma_f32_16x16x32_bf16 v[172:175], v[24:27], v[64:67], v[172:175]
    ds_read_b64_tr_b16 v[50:51], v78 offset:2048
    ds_read_b128 v[8:11], v74 offset:1024
    v_mfma_f32_16x16x32_bf16 v[176:179], v[28:31], v[52:55], v[176:179]
    ds_read_b128 v[12:15], v74 offset:2048
    ds_read_b128 v[16:19], v74 offset:3072
    v_mfma_f32_16x16x32_bf16 v[180:183], v[28:31], v[56:59], v[180:183]
    s_mov_b32 m0, s71
    v_mfma_f32_16x16x32_bf16 v[184:187], v[28:31], v[60:63], v[184:187]
    buffer_load_dwordx4 v68, s[60:63], s68 offen lds
    s_add_u32 m0, s71, 1024
    v_mfma_f32_16x16x32_bf16 v[188:191], v[28:31], v[64:67], v[188:191]
    buffer_load_dwordx4 v69, s[60:63], s68 offen lds
    v_mfma_f32_16x16x32_bf16 v[192:195], v[32:35], v[52:55], v[192:195]
    s_add_u32 m0, s71, 16384
    s_nop 0
    buffer_load_dwordx4 v70, s[64:67], s69 offen lds
    v_mfma_f32_16x16x32_bf16 v[196:199], v[32:35], v[56:59], v[196:199]
    s_add_u32 m0, s71, 17408
    v_mfma_f32_16x16x32_bf16 v[200:203], v[32:35], v[60:63], v[200:203]
    buffer_load_dwordx4 v71, s[64:67], s69 offen lds
    s_add_u32 s68, s68, 64
    s_add_u32 s69, s69, s70
    v_mfma_f32_16x16x32_bf16 v[204:207], v[32:35], v[64:67], v[204:207]
    s_add_u32 s71, s71, 32768
    s_and_b32 s71, s71, 0x1ffff
    s_sub_u32 s73, s73, 1
    s_cmp_lg_u32 s73, 0
    s_cbranch_scc1 gl_151
    s_waitcnt lgkmcnt(0)
    v_mfma_f32_16x16x32_bf16 v[80:83], v[4:7], v[36:39], v[80:83]
    ds_read_b128 v[20:23], v74 offset:4096
    v_mfma_f32_16x16x32_bf16 v[84:87], v[4:7], v[40:43], v[84:87]
    v_mfma_f32_16x16x32_bf16 v[88:91], v[4:7], v[44:47], v[88:91]
    ds_read_b128 v[24:27], v74 offset:5120
    v_mfma_f32_16x16x32_bf16 v[92:95], v[4:7], v[48:51], v[92:95]
    v_mfma_f32_16x16x32_bf16 v[96:99], v[8:11], v[36:39], v[96:99]
    ds_read_b128 v[28:31], v74 offset:6144
    v_mfma_f32_16x16x32_bf16 v[100:103], v[8:11], v[40:43], v[100:103]
    v_mfma_f32_16x16x32_bf16 v[104:107], v[8:11], v[44:47], v[104:107]
    ds_read_b128 v[32:35], v74 offset:7168
    v_mfma_f32_16x16x32_bf16 v[108:111], v[8:11], v[48:51], v[108:111]
    v_mfma_f32_16x16x32_bf16 v[112:115], v[12:15], v[36:39], v[112:115]
    v_mfma_f32_16x16x32_bf16 v[116:119], v[12:15], v[40:43], v[116:119]
    v_mfma_f32_16x16x32_bf16 v[120:123], v[12:15], v[44:47], v[120:123]
    v_mfma_f32_16x16x32_bf16 v[124:127], v[12:15], v[48:51], v[124:127]
    v_mfma_f32_16x16x32_bf16 v[128:131], v[16:19], v[36:39], v[128:131]
    v_mfma_f32_16x16x32_bf16 v[132:135], v[16:19], v[40:43], v[132:135]
    v_mfma_f32_16x16x32_bf16 v[136:139], v[16:19], v[44:47], v[136:139]
    v_mfma_f32_16x16x32_bf16 v[140:143], v[16:19], v[48:51], v[140:143]
    s_waitcnt vmcnt(8) lgkmcnt(0)
    s_barrier
    v_mfma_f32_16x16x32_bf16 v[144:147], v[20:23], v[36:39], v[144:147]
    v_add_u32 v74, s72, v72
    v_add_u32 v75, s72, v73
    v_mfma_f32_16x16x32_bf16 v[148:151], v[20:23], v[40:43], v[148:151]
    v_xor_b32 v76, 32, v75
    v_xor_b32 v77, 64, v75
    v_xor_b32 v78, 96, v75
    v_mfma_f32_16x16x32_bf16 v[152:155], v[20:23], v[44:47], v[152:155]
    s_add_u32 s72, s72, 32768
    s_and_b32 s72, s72, 0x1ffff
    v_mfma_f32_16x16x32_bf16 v[156:159], v[20:23], v[48:51], v[156:159]
    ds_read_b128 v[4:7], v74 offset:0
    v_mfma_f32_16x16x32_bf16 v[160:163], v[24:27], v[36:39], v[160:163]
    ds_read_b64_tr_b16 v[52:53], v75 offset:0
    v_mfma_f32_16x16x32_bf16 v[164:167], v[24:27], v[40:43], v[164:167]
    ds_read_b64_tr_b16 v[54:55], v75 offset:2048
    v_mfma_f32_16x16x32_bf16 v[168:171], v[24:27], v[44:47], v[168:171]
    ds_read_b64_tr_b16 v[56:57], v76 offset:0
    v_mfma_f32_16x16x32_bf16 v[172:175], v[24:27], v[48:51], v[172:175]
    ds_read_b64_tr_b16 v[58:59], v76 offset:2048
    v_mfma_f32_16x16x32_bf16 v[176:179], v[28:31], v[36:39], v[176:179]
    ds_read_b64_tr_b16 v[60:61], v77 offset:0
    v_mfma_f32_16x16x32_bf16 v[180:183], v[28:31], v[40:43], v[180:183]
    ds_read_b64_tr_b16 v[62:63], v77 offset:2048
    v_mfma_f32_16x16x32_bf16 v[184:187], v[28:31], v[44:47], v[184:187]
    ds_read_b64_tr_b16 v[64:65], v78 offset:0
    v_mfma_f32_16x16x32_bf16 v[188:191], v[28:31], v[48:51], v[188:191]
    ds_read_b64_tr_b16 v[66:67], v78 offset:2048
    v_mfma_f32_16x16x32_bf16 v[192:195], v[32:35], v[36:39], v[192:195]
    ds_read_b128 v[8:11], v74 offset:1024
    v_mfma_f32_16x16x32_bf16 v[196:199], v[32:35], v[40:43], v[196:199]
    ds_read_b128 v[12:15], v74 offset:2048
    v_mfma_f32_16x16x32_bf16 v[200:203], v[32:35], v[44:47], v[200:203]
    ds_read_b128 v[16:19], v74 offset:3072
    v_mfma_f32_16x16x32_bf16 v[204:207], v[32:35], v[48:51], v[204:207]
    s_waitcnt lgkmcnt(0)
    v_mfma_f32_16x16x32_bf16 v[80:83], v[4:7], v[52:55], v[80:83]
    ds_read_b128 v[20:23], v74 offset:4096
    v_mfma_f32_16x16x32_bf16 v[84:87], v[4:7], v[56:59], v[84:87]
    v_mfma_f32_16x16x32_bf16 v[88:91], v[4:7], v[60:63], v[88:91]
    ds_read_b128 v[24:27], v74 offset:5120
    v_mfma_f32_16x16x32_bf16 v[92:95], v[4:7], v[64:67], v[92:95]
    v_mfma_f32_16x16x32_bf16 v[96:99], v[8:11], v[52:55], v[96:99]
    ds_read_b128 v[28:31], v74 offset:6144
    v_mfma_f32_16x16x32_bf16 v[100:103], v[8:11], v[56:59], v[100:103]
    v_mfma_f32_16x16x32_bf16 v[104:107], v[8:11], v[60:63], v[104:107]
    ds_read_b128 v[32:35], v74 offset:7168
    v_mfma_f32_16x16x32_bf16 v[108:111], v[8:11], v[64:67], v[108:111]
    v_mfma_f32_16x16x32_bf16 v[112:115], v[12:15], v[52:55], v[112:115]
    v_mfma_f32_16x16x32_bf16 v[116:119], v[12:15], v[56:59], v[116:119]
    v_mfma_f32_16x16x32_bf16 v[120:123], v[12:15], v[60:63], v[120:123]
    v_mfma_f32_16x16x32_bf16 v[124:127], v[12:15], v[64:67], v[124:127]
    v_mfma_f32_16x16x32_bf16 v[128:131], v[16:19], v[52:55], v[128:131]
    v_mfma_f32_16x16x32_bf16 v[132:135], v[16:19], v[56:59], v[132:135]
    v_mfma_f32_16x16x32_bf16 v[136:139], v[16:19], v[60:63], v[136:139]
    v_mfma_f32_16x16x32_bf16 v[140:143], v[16:19], v[64:67], v[140:143]
    s_waitcnt vmcnt(4) lgkmcnt(0)
    s_barrier
    v_mfma_f32_16x16x32_bf16 v[144:147], v[20:23], v[52:55], v[144:147]
    v_add_u32 v74, s72, v72
    v_add_u32 v75, s72, v73
    v_mfma_f32_16x16x32_bf16 v[148:151], v[20:23], v[56:59], v[148:151]
    v_xor_b32 v76, 32, v75
    v_xor_b32 v77, 64, v75
    v_xor_b32 v78, 96, v75
    v_mfma_f32_16x16x32_bf16 v[152:155], v[20:23], v[60:63], v[152:155]
    s_add_u32 s72, s72, 32768
    s_and_b32 s72, s72, 0x1ffff
    v_mfma_f32_16x16x32_bf16 v[156:159], v[20:23], v[64:67], v[156:159]
    ds_read_b128 v[4:7], v74 offset:0
    v_mfma_f32_16x16x32_bf16 v[160:163], v[24:27], v[52:55], v[160:163]
    ds_read_b64_tr_b16 v[36:37], v75 offset:0
    v_mfma_f32_16x16x32_bf16 v[164:167], v[24:27], v[56:59], v[164:167]
    ds_read_b64_tr_b16 v[38:39], v75 offset:2048
    v_mfma_f32_16x16x32_bf16 v[168:171], v[24:27], v[60:63], v[168:171]
    ds_read_b64_tr_b16 v[40:41], v76 offset:0
    v_mfma_f32_16x16x32_bf16 v[172:175], v[24:27], v[64:67], v[172:175]
    ds_read_b64_tr_b16 v[42:43], v76 offset:2048
    v_mfma_f32_16x16x32_bf16 v[176:179], v[28:31], v[52:55], v[176:179]
    ds_read_b64_tr_b16 v[44:45], v77 offset:0
    v_mfma_f32_16x16x32_bf16 v[180:183], v[28:31], v[56:59], v[180:183]
    ds_read_b64_tr_b16 v[46:47], v77 offset:2048
    v_mfma_f32_16x16x32_bf16 v[184:187], v[28:31], v[60:63], v[184:187]
    ds_read_b64_tr_b16 v[48:49], v78 offset:0
    v_mfma_f32_16x16x32_bf16 v[188:191], v[28:31], v[64:67], v[188:191]
    ds_read_b64_tr_b16 v[50:51], v78 offset:2048
    v_mfma_f32_16x16x32_bf16 v[192:195], v[32:35], v[52:55], v[192:195]
    ds_read_b128 v[8:11], v74 offset:1024
    v_mfma_f32_16x16x32_bf16 v[196:199], v[32:35], v[56:59], v[196:199]
    ds_read_b128 v[12:15], v74 offset:2048
    v_mfma_f32_16x16x32_bf16 v[200:203], v[32:35], v[60:63], v[200:203]
    ds_read_b128 v[16:19], v74 offset:3072
    v_mfma_f32_16x16x32_bf16 v[204:207], v[32:35], v[64:67], v[204:207]
    s_waitcnt lgkmcnt(0)
    v_mfma_f32_16x16x32_bf16 v[80:83], v[4:7], v[36:39], v[80:83]
    ds_read_b128 v[20:23], v74 offset:4096
    v_mfma_f32_16x16x32_bf16 v[84:87], v[4:7], v[40:43], v[84:87]
    v_mfma_f32_16x16x32_bf16 v[88:91], v[4:7], v[44:47], v[88:91]
    ds_read_b128 v[24:27], v74 offset:5120
    v_mfma_f32_16x16x32_bf16 v[92:95], v[4:7], v[48:51], v[92:95]
    v_mfma_f32_16x16x32_bf16 v[96:99], v[8:11], v[36:39], v[96:99]
    ds_read_b128 v[28:31], v74 offset:6144
    v_mfma_f32_16x16x32_bf16 v[100:103], v[8:11], v[40:43], v[100:103]
    v_mfma_f32_16x16x32_bf16 v[104:107], v[8:11], v[44:47], v[104:107]
    ds_read_b128 v[32:35], v74 offset:7168
    v_mfma_f32_16x16x32_bf16 v[108:111], v[8:11], v[48:51], v[108:111]
    v_mfma_f32_16x16x32_bf16 v[112:115], v[12:15], v[36:39], v[112:115]
    v_mfma_f32_16x16x32_bf16 v[116:119], v[12:15], v[40:43], v[116:119]
    v_mfma_f32_16x16x32_bf16 v[120:123], v[12:15], v[44:47], v[120:123]
    v_mfma_f32_16x16x32_bf16 v[124:127], v[12:15], v[48:51], v[124:127]
    v_mfma_f32_16x16x32_bf16 v[128:131], v[16:19], v[36:39], v[128:131]
    v_mfma_f32_16x16x32_bf16 v[132:135], v[16:19], v[40:43], v[132:135]
    v_mfma_f32_16x16x32_bf16 v[136:139], v[16:19], v[44:47], v[136:139]
    v_mfma_f32_16x16x32_bf16 v[140:143], v[16:19], v[48:51], v[140:143]
    s_waitcnt vmcnt(0) lgkmcnt(0)
    s_barrier
    v_mfma_f32_16x16x32_bf16 v[144:147], v[20:23], v[36:39], v[144:147]
    v_add_u32 v74, s72, v72
    v_add_u32 v75, s72, v73
    v_mfma_f32_16x16x32_bf16 v[148:151], v[20:23], v[40:43], v[148:151]
    v_xor_b32 v76, 32, v75
    v_xor_b32 v77, 64, v75
    v_xor_b32 v78, 96, v75
    v_mfma_f32_16x16x32_bf16 v[152:155], v[20:23], v[44:47], v[152:155]
    s_add_u32 s72, s72, 32768
    s_and_b32 s72, s72, 0x1ffff
    v_mfma_f32_16x16x32_bf16 v[156:159], v[20:23], v[48:51], v[156:159]
    ds_read_b128 v[4:7], v74 offset:0
    v_mfma_f32_16x16x32_bf16 v[160:163], v[24:27], v[36:39], v[160:163]
    ds_read_b64_tr_b16 v[52:53], v75 offset:0
    v_mfma_f32_16x16x32_bf16 v[164:167], v[24:27], v[40:43], v[164:167]
    ds_read_b64_tr_b16 v[54:55], v75 offset:2048
    v_mfma_f32_16x16x32_bf16 v[168:171], v[24:27], v[44:47], v[168:171]
    ds_read_b64_tr_b16 v[56:57], v76 offset:0
    v_mfma_f32_16x16x32_bf16 v[172:175], v[24:27], v[48:51], v[172:175]
    ds_read_b64_tr_b16 v[58:59], v76 offset:2048
    v_mfma_f32_16x16x32_bf16 v[176:179], v[28:31], v[36:39], v[176:179]
    ds_read_b64_tr_b16 v[60:61], v77 offset:0
    v_mfma_f32_16x16x32_bf16 v[180:183], v[28:31], v[40:43], v[180:183]
    ds_read_b64_tr_b16 v[62:63], v77 offset:2048
    v_mfma_f32_16x16x32_bf16 v[184:187], v[28:31], v[44:47], v[184:187]
    ds_read_b64_tr_b16 v[64:65], v78 offset:0
    v_mfma_f32_16x16x32_bf16 v[188:191], v[28:31], v[48:51], v[188:191]
    ds_read_b64_tr_b16 v[66:67], v78 offset:2048
    v_mfma_f32_16x16x32_bf16 v[192:195], v[32:35], v[36:39], v[192:195]
    ds_read_b128 v[8:11], v74 offset:1024
    v_mfma_f32_16x16x32_bf16 v[196:199], v[32:35], v[40:43], v[196:199]
    ds_read_b128 v[12:15], v74 offset:2048
    v_mfma_f32_16x16x32_bf16 v[200:203], v[32:35], v[44:47], v[200:203]
    ds_read_b128 v[16:19], v74 offset:3072
    v_mfma_f32_16x16x32_bf16 v[204:207], v[32:35], v[48:51], v[204:207]
    s_waitcnt lgkmcnt(0)
    v_mfma_f32_16x16x32_bf16 v[80:83], v[4:7], v[52:55], v[80:83]
    ds_read_b128 v[20:23], v74 offset:4096
    v_mfma_f32_16x16x32_bf16 v[84:87], v[4:7], v[56:59], v[84:87]
    v_mfma_f32_16x16x32_bf16 v[88:91], v[4:7], v[60:63], v[88:91]
    ds_read_b128 v[24:27], v74 offset:5120
    v_mfma_f32_16x16x32_bf16 v[92:95], v[4:7], v[64:67], v[92:95]
    v_mfma_f32_16x16x32_bf16 v[96:99], v[8:11], v[52:55], v[96:99]
    ds_read_b128 v[28:31], v74 offset:6144
    v_mfma_f32_16x16x32_bf16 v[100:103], v[8:11], v[56:59], v[100:103]
    v_mfma_f32_16x16x32_bf16 v[104:107], v[8:11], v[60:63], v[104:107]
    ds_read_b128 v[32:35], v74 offset:7168
    v_mfma_f32_16x16x32_bf16 v[108:111], v[8:11], v[64:67], v[108:111]
    v_mfma_f32_16x16x32_bf16 v[112:115], v[12:15], v[52:55], v[112:115]
    v_mfma_f32_16x16x32_bf16 v[116:119], v[12:15], v[56:59], v[116:119]
    v_mfma_f32_16x16x32_bf16 v[120:123], v[12:15], v[60:63], v[120:123]
    v_mfma_f32_16x16x32_bf16 v[124:127], v[12:15], v[64:67], v[124:127]
    v_mfma_f32_16x16x32_bf16 v[128:131], v[16:19], v[52:55], v[128:131]
    v_mfma_f32_16x16x32_bf16 v[132:135], v[16:19], v[56:59], v[132:135]
    v_mfma_f32_16x16x32_bf16 v[136:139], v[16:19], v[60:63], v[136:139]
    v_mfma_f32_16x16x32_bf16 v[140:143], v[16:19], v[64:67], v[140:143]
    s_waitcnt lgkmcnt(0)
    v_mfma_f32_16x16x32_bf16 v[144:147], v[20:23], v[52:55], v[144:147]
    v_mfma_f32_16x16x32_bf16 v[148:151], v[20:23], v[56:59], v[148:151]
    v_mfma_f32_16x16x32_bf16 v[152:155], v[20:23], v[60:63], v[152:155]
    v_mfma_f32_16x16x32_bf16 v[156:159], v[20:23], v[64:67], v[156:159]
    v_mfma_f32_16x16x32_bf16 v[160:163], v[24:27], v[52:55], v[160:163]
    v_mfma_f32_16x16x32_bf16 v[164:167], v[24:27], v[56:59], v[164:167]
    v_mfma_f32_16x16x32_bf16 v[168:171], v[24:27], v[60:63], v[168:171]
    v_mfma_f32_16x16x32_bf16 v[172:175], v[24:27], v[64:67], v[172:175]
    v_mfma_f32_16x16x32_bf16 v[176:179], v[28:31], v[52:55], v[176:179]
    v_mfma_f32_16x16x32_bf16 v[180:183], v[28:31], v[56:59], v[180:183]
    v_mfma_f32_16x16x32_bf16 v[184:187], v[28:31], v[60:63], v[184:187]
    v_mfma_f32_16x16x32_bf16 v[188:191], v[28:31], v[64:67], v[188:191]
    v_mfma_f32_16x16x32_bf16 v[192:195], v[32:35], v[52:55], v[192:195]
    v_mfma_f32_16x16x32_bf16 v[196:199], v[32:35], v[56:59], v[196:199]
    v_mfma_f32_16x16x32_bf16 v[200:203], v[32:35], v[60:63], v[200:203]
    v_mfma_f32_16x16x32_bf16 v[204:207], v[32:35], v[64:67], v[204:207]
    s_lshl_b32 s85, s80, 2
    s_and_b32 s81, s58, 3
    s_add_u32 s85, s85, s81
    s_lshl_b32 s85, s85, 6
    v_and_b32 v77, 15, v1
    v_add_u32 v77, s85, v77
    v_bfe_u32 v76, v77, 3, 5
    v_lshlrev_b32 v76, 12, v76
    v_bfe_u32 v75, v77, 10, 1
    v_lshl_or_b32 v76, v75, 17, v76
    v_bfe_u32 v75, v77, 0, 2
    v_lshl_or_b32 v76, v75, 18, v76
    v_bfe_u32 v75, v77, 8, 1
    v_lshl_or_b32 v76, v75, 20, v76
    v_bfe_u32 v75, v77, 2, 1
    v_lshl_or_b32 v76, v75, 21, v76
    v_bfe_u32 v75, v77, 9, 1
    v_lshl_or_b32 v76, v75, 22, v76
    v_bfe_u32 v77, v1, 4, 2
    v_lshlrev_b32 v77, 4, v77
    v_add_u32 v76, v76, v77
    s_lshl_b32 s81, s79, 9
    s_lshr_b32 s85, s58, 2
    s_lshl_b32 s85, s85, 8
    s_add_u32 s81, s81, s85
    v_cvt_pk_bf16_f32 v4, v80, v81
    v_cvt_pk_bf16_f32 v5, v82, v83
    v_cvt_pk_bf16_f32 v6, v96, v97
    v_cvt_pk_bf16_f32 v7, v98, v99
    buffer_store_dwordx4 v[4:7], v76, s[16:19], s81 offen offset:0
    v_cvt_pk_bf16_f32 v8, v112, v113
    v_cvt_pk_bf16_f32 v9, v114, v115
    v_cvt_pk_bf16_f32 v10, v128, v129
    v_cvt_pk_bf16_f32 v11, v130, v131
    buffer_store_dwordx4 v[8:11], v76, s[16:19], s81 offen offset:64
    v_cvt_pk_bf16_f32 v12, v144, v145
    v_cvt_pk_bf16_f32 v13, v146, v147
    v_cvt_pk_bf16_f32 v14, v160, v161
    v_cvt_pk_bf16_f32 v15, v162, v163
    buffer_store_dwordx4 v[12:15], v76, s[16:19], s81 offen offset:128
    v_cvt_pk_bf16_f32 v16, v176, v177
    v_cvt_pk_bf16_f32 v17, v178, v179
    v_cvt_pk_bf16_f32 v18, v192, v193
    v_cvt_pk_bf16_f32 v19, v194, v195
    buffer_store_dwordx4 v[16:19], v76, s[16:19], s81 offen offset:192
    s_add_u32 s81, s81, 8192
    v_cvt_pk_bf16_f32 v20, v84, v85
    v_cvt_pk_bf16_f32 v21, v86, v87
    v_cvt_pk_bf16_f32 v22, v100, v101
    v_cvt_pk_bf16_f32 v23, v102, v103
    buffer_store_dwordx4 v[20:23], v76, s[16:19], s81 offen offset:0
    v_cvt_pk_bf16_f32 v24, v116, v117
    v_cvt_pk_bf16_f32 v25, v118, v119
    v_cvt_pk_bf16_f32 v26, v132, v133
    v_cvt_pk_bf16_f32 v27, v134, v135
    buffer_store_dwordx4 v[24:27], v76, s[16:19], s81 offen offset:64
    v_cvt_pk_bf16_f32 v28, v148, v149
    v_cvt_pk_bf16_f32 v29, v150, v151
    v_cvt_pk_bf16_f32 v30, v164, v165
    v_cvt_pk_bf16_f32 v31, v166, v167
    buffer_store_dwordx4 v[28:31], v76, s[16:19], s81 offen offset:128
    v_cvt_pk_bf16_f32 v32, v180, v181
    v_cvt_pk_bf16_f32 v33, v182, v183
    v_cvt_pk_bf16_f32 v34, v196, v197
    v_cvt_pk_bf16_f32 v35, v198, v199
    buffer_store_dwordx4 v[32:35], v76, s[16:19], s81 offen offset:192
    s_add_u32 s81, s81, 8192
    v_cvt_pk_bf16_f32 v36, v88, v89
    v_cvt_pk_bf16_f32 v37, v90, v91
    v_cvt_pk_bf16_f32 v38, v104, v105
    v_cvt_pk_bf16_f32 v39, v106, v107
    buffer_store_dwordx4 v[36:39], v76, s[16:19], s81 offen offset:0
    v_cvt_pk_bf16_f32 v40, v120, v121
    v_cvt_pk_bf16_f32 v41, v122, v123
    v_cvt_pk_bf16_f32 v42, v136, v137
    v_cvt_pk_bf16_f32 v43, v138, v139
    buffer_store_dwordx4 v[40:43], v76, s[16:19], s81 offen offset:64
    v_cvt_pk_bf16_f32 v44, v152, v153
    v_cvt_pk_bf16_f32 v45, v154, v155
    v_cvt_pk_bf16_f32 v46, v168, v169
    v_cvt_pk_bf16_f32 v47, v170, v171
    buffer_store_dwordx4 v[44:47], v76, s[16:19], s81 offen offset:128
    v_cvt_pk_bf16_f32 v48, v184, v185
    v_cvt_pk_bf16_f32 v49, v186, v187
    v_cvt_pk_bf16_f32 v50, v200, v201
    v_cvt_pk_bf16_f32 v51, v202, v203
    buffer_store_dwordx4 v[48:51], v76, s[16:19], s81 offen offset:192
    s_add_u32 s81, s81, 8192
    v_cvt_pk_bf16_f32 v52, v92, v93
    v_cvt_pk_bf16_f32 v53, v94, v95
    v_cvt_pk_bf16_f32 v54, v108, v109
    v_cvt_pk_bf16_f32 v55, v110, v111
    buffer_store_dwordx4 v[52:55], v76, s[16:19], s81 offen offset:0
    v_cvt_pk_bf16_f32 v56, v124, v125
    v_cvt_pk_bf16_f32 v57, v126, v127
    v_cvt_pk_bf16_f32 v58, v140, v141
    v_cvt_pk_bf16_f32 v59, v142, v143
    buffer_store_dwordx4 v[56:59], v76, s[16:19], s81 offen offset:64
    v_cvt_pk_bf16_f32 v60, v156, v157
    v_cvt_pk_bf16_f32 v61, v158, v159
    v_cvt_pk_bf16_f32 v62, v172, v173
    v_cvt_pk_bf16_f32 v63, v174, v175
    buffer_store_dwordx4 v[60:63], v76, s[16:19], s81 offen offset:128
    v_cvt_pk_bf16_f32 v64, v188, v189
    v_cvt_pk_bf16_f32 v65, v190, v191
    v_cvt_pk_bf16_f32 v66, v204, v205
    v_cvt_pk_bf16_f32 v67, v206, v207
    buffer_store_dwordx4 v[64:67], v76, s[16:19], s81 offen offset:192
    s_add_u32 s81, s81, 8192
    v_mov_b32 v75, 163760
    v_mov_b32 v76, 0
    s_barrier
    ds_write_b32 v75, v76
    s_waitcnt lgkmcnt(0)
    s_barrier
    v_lshlrev_b32 v5, 4, v1
    v_bfe_u32 v6, v1, 0, 3
    v_lshlrev_b32 v6, 4, v6
    v_bfe_u32 v3, v1, 5, 1
    v_lshl_or_b32 v6, v3, 7, v6
    v_lshlrev_b32 v7, 3, v1
    v_bfe_u32 v2, v1, 5, 1
    v_lshlrev_b32 v2, 2, v2
    v_and_b32 v8, 31, v1
    v_sub_u32 v8, v8, v2
    s_mov_b32 s89, 0x3e0293ee
    s_and_b32 s86, s57, 7
    s_mov_b32 s92, 0
    s_mov_b32 s91, 0
    s_mov_b32 s93, 0
    v_mov_b32 v9, 163760
    s_mov_b32 s4, 0xff
    s_mov_b32 s5, 0xff
    s_add_u32 s93, s93, 1
    s_cmp_lg_u32 s58, 0
    s_cbranch_scc1 at_f_155
    s_cmp_eq_u32 s92, 2097216
    s_cbranch_scc1 at_rb_157
    s_max_u32 s88, s86, 2
    s_sub_u32 s88, s88, 2
    s_and_b32 s88, s88, -4
pollrb_158:
    buffer_load_dword v2, off, s[12:15], s88 offset:160 sc1
    buffer_load_dword v3, off, s[12:15], 0 offset:220 sc1
    s_waitcnt vmcnt(0)
    v_cmp_ne_u32 vcc, 2097216, v2
    s_cbranch_vccz pollrb_ok_159
    s_sub_u32 s77, s77, 1
    s_cbranch_scc0 pollrb_158
    s_mov_b32 s77, 0
pollrb_ok_159:
    v_readfirstlane_b32 s92, v3
at_rb_157:
    v_mov_b32 v2, s93
    ds_write_b32 v9, v2
at_f_155:
    ds_read_b32 v2, v9
    s_waitcnt lgkmcnt(0)
    v_cmp_gt_u32 vcc, s93, v2
    s_cbranch_vccz at_d_156
    s_sub_u32 s77, s77, 1
    s_cbranch_scc0 at_f_155
    s_mov_b32 s77, 0
at_d_156:
    s_lshl_b32 s94, s86, 2
    s_add_u32 s94, s94, s75
    s_lshl_b32 s94, s94, 3
    s_add_u32 s94, s94, s58
    s_lshl_b32 s94, s94, 13
    s_add_u32 s88, s94, 0x0
    buffer_load_dwordx4 v[12:15], v5, s[8:11], s88 offen offset:0 sc1
    buffer_load_dwordx4 v[16:19], v5, s[8:11], s88 offen offset:1024 sc1
    buffer_load_dwordx4 v[20:23], v5, s[8:11], s88 offen offset:2048 sc1
    buffer_load_dwordx4 v[24:27], v5, s[8:11], s88 offen offset:3072 sc1
    s_add_u32 s88, s88, 4096
    buffer_load_dwordx4 v[28:31], v5, s[8:11], s88 offen offset:0 sc1
    buffer_load_dwordx4 v[32:35], v5, s[8:11], s88 offen offset:1024 sc1
    buffer_load_dwordx4 v[36:39], v5, s[8:11], s88 offen offset:2048 sc1
    buffer_load_dwordx4 v[40:43], v5, s[8:11], s88 offen offset:3072 sc1
    s_add_u32 s88, s94, 0x1000000
    buffer_load_dwordx4 v[44:47], v5, s[8:11], s88 offen offset:0 sc1
    buffer_load_dwordx4 v[48:51], v5, s[8:11], s88 offen offset:1024 sc1
    buffer_load_dwordx4 v[52:55], v5, s[8:11], s88 offen offset:2048 sc1
    buffer_load_dwordx4 v[56:59], v5, s[8:11], s88 offen offset:3072 sc1
    s_add_u32 s88, s88, 4096
    buffer_load_dwordx4 v[60:63], v5, s[8:11], s88 offen offset:0 sc1
    buffer_load_dwordx4 v[64:67], v5, s[8:11], s88 offen offset:1024 sc1
    buffer_load_dwordx4 v[68:71], v5, s[8:11], s88 offen offset:2048 sc1
    buffer_load_dwordx4 v[72:75], v5, s[8:11], s88 offen offset:3072 sc1
    s_add_u32 s88, s94, 0x2000000
    buffer_load_dwordx4 v[76:79], v5, s[8:11], s88 offen offset:0 sc1
    buffer_load_dwordx4 v[80:83], v5, s[8:11], s88 offen offset:1024 sc1
    buffer_load_dwordx4 v[84:87], v5, s[8:11], s88 offen offset:2048 sc1
    buffer_load_dwordx4 v[88:91], v5, s[8:11], s88 offen offset:3072 sc1
    s_add_u32 s88, s88, 4096
    buffer_load_dwordx4 v[92:95], v5, s[8:11], s88 offen offset:0 sc1
    buffer_load_dwordx4 v[96:99], v5, s[8:11], s88 offen offset:1024 sc1
    buffer_load_dwordx4 v[100:103], v5, s[8:11], s88 offen offset:2048 sc1
    buffer_load_dwordx4 v[104:107], v5, s[8:11], s88 offen offset:3072 sc1
at_loop_152:
    s_mov_b32 s90, s94
    s_add_u32 s93, s93, 1
    s_cmp_lg_u32 s58, 0
    s_cbranch_scc1 at_f_160
    s_cmp_ge_u32 s86, 48
    s_cselect_b32 s88, 1, 2
    s_add_u32 s88, s88, s86
    s_min_u32 s88, s88, 62
    s_cmp_ge_u32 s91, s88
    s_cbranch_scc1 at_go_154
pollprog_162:
    buffer_load_dword v4, off, s[12:15], 0 offset:64 sc1
    s_waitcnt vmcnt(0)
    v_cmp_gt_u32 vcc, s88, v4
    s_cbranch_vccz pollprog_ok_163
    s_sub_u32 s77, s77, 1
    s_cbranch_scc0 pollprog_162
    s_mov_b32 s77, 0
pollprog_ok_163:
    v_readfirstlane_b32 s91, v4
at_go_154:
    v_mov_b32 v2, s93
    ds_write_b32 v9, v2
at_f_160:
    ds_read_b32 v2, v9
    s_waitcnt lgkmcnt(0)
    v_cmp_gt_u32 vcc, s93, v2
    s_cbranch_vccz at_d_161
    s_sub_u32 s77, s77, 1
    s_cbranch_scc0 at_f_160
    s_mov_b32 s77, 0
at_d_161:
    s_lshr_b32 s88, s90, 2
    s_add_u32 s87, s88, 0x4400000
    s_add_u32 s88, s88, 0x4000000
    buffer_load_dwordx4 v[108:111], v6, s[8:11], s88 offen offset:0 sc1
    buffer_load_dwordx4 v[112:115], v6, s[8:11], s88 offen offset:256 sc1
    buffer_load_dwordx4 v[116:119], v6, s[8:11], s88 offen offset:512 sc1
    buffer_load_dwordx4 v[120:123], v6, s[8:11], s88 offen offset:768 sc1
    buffer_load_dwordx4 v[124:127], v6, s[8:11], s88 offen offset:1024 sc1
    buffer_load_dwordx4 v[128:131], v6, s[8:11], s88 offen offset:1280 sc1
    buffer_load_dwordx4 v[132:135], v6, s[8:11], s88 offen offset:1536 sc1
    buffer_load_dwordx4 v[136:139], v6, s[8:11], s88 offen offset:1792 sc1
    buffer_load_dwordx2 v[236:237], v7, s[8:11], s87 offen offset:0 sc1
    buffer_load_dwordx2 v[238:239], v7, s[8:11], s87 offen offset:512 sc1
    buffer_load_dwordx2 v[240:241], v7, s[8:11], s87 offen offset:1024 sc1
    buffer_load_dwordx2 v[242:243], v7, s[8:11], s87 offen offset:1536 sc1
    s_waitcnt vmcnt(27)
    v_mfma_f32_32x32x16_bf16 v[140:155], v[44:47], v[12:15], 0
    s_waitcnt vmcnt(26)
    v_mfma_f32_32x32x16_bf16 v[140:155], v[48:51], v[16:19], v[140:155]
    s_waitcnt vmcnt(25)
    v_mfma_f32_32x32x16_bf16 v[140:155], v[52:55], v[20:23], v[140:155]
    s_waitcnt vmcnt(24)
    v_mfma_f32_32x32x16_bf16 v[140:155], v[56:59], v[24:27], v[140:155]
    s_waitcnt vmcnt(23)
    v_mfma_f32_32x32x16_bf16 v[140:155], v[60:63], v[28:31], v[140:155]
    s_waitcnt vmcnt(22)
    v_mfma_f32_32x32x16_bf16 v[140:155], v[64:67], v[32:35], v[140:155]
    s_waitcnt vmcnt(21)
    v_mfma_f32_32x32x16_bf16 v[140:155], v[68:71], v[36:39], v[140:155]
    s_waitcnt vmcnt(20)
    v_mfma_f32_32x32x16_bf16 v[140:155], v[72:75], v[40:43], v[140:155]
    v_mov_b32 v3, 0xff800000
    v_cmp_le_i32 vcc, 0, v8
    s_nop 9
    v_cndmask_b32 v140, v3, v140, vcc
    v_cmp_le_i32 vcc, 1, v8
    s_nop 1
    v_cndmask_b32 v141, v3, v141, vcc
    v_cmp_le_i32 vcc, 2, v8
    s_nop 1
    v_cndmask_b32 v142, v3, v142, vcc
    v_cmp_le_i32 vcc, 3, v8
    s_nop 1
    v_cndmask_b32 v143, v3, v143, vcc
    v_cmp_le_i32 vcc, 8, v8
    s_nop 1
    v_cndmask_b32 v144, v3, v144, vcc
    v_cmp_le_i32 vcc, 9, v8
    s_nop 1
    v_cndmask_b32 v145, v3, v145, vcc
    v_cmp_le_i32 vcc, 10, v8
    s_nop 1
    v_cndmask_b32 v146, v3, v146, vcc
    v_cmp_le_i32 vcc, 11, v8
    s_nop 1
    v_cndmask_b32 v147, v3, v147, vcc
    v_cmp_le_i32 vcc, 16, v8
    s_nop 1
    v_cndmask_b32 v148, v3, v148, vcc
    v_cmp_le_i32 vcc, 17, v8
    s_nop 1
    v_cndmask_b32 v149, v3, v149, vcc
    v_cmp_le_i32 vcc, 18, v8
    s_nop 1
    v_cndmask_b32 v150, v3, v150, vcc
    v_cmp_le_i32 vcc, 19, v8
    s_nop 1
    v_cndmask_b32 v151, v3, v151, vcc
    v_cmp_le_i32 vcc, 24, v8
    s_nop 1
    v_cndmask_b32 v152, v3, v152, vcc
    v_cmp_le_i32 vcc, 25, v8
    s_nop 1
    v_cndmask_b32 v153, v3, v153, vcc
    v_cmp_le_i32 vcc, 26, v8
    s_nop 1
    v_cndmask_b32 v154, v3, v154, vcc
    v_cmp_le_i32 vcc, 27, v8
    s_nop 1
    v_cndmask_b32 v155, v3, v155, vcc
    v_max3_f32 v244, v140, v141, v142
    v_max3_f32 v244, v244, v143, v144
    v_max3_f32 v244, v244, v145, v146
    v_max3_f32 v244, v244, v147, v148
    v_max3_f32 v244, v244, v149, v150
    v_max3_f32 v244, v244, v151, v152
    v_max3_f32 v244, v244, v153, v154
    s_waitcnt vmcnt(0)
    v_max3_u32 v2, v108, v112, v116
    v_max3_u32 v2, v2, v120, v124
    v_max3_u32 v2, v2, v128, v132
    v_max_u32 v2, v2, v136
    v_cmp_eq_u32 vcc, -1, v2
    s_cbranch_vccz pollkm_ok_165
pollkm_164:
    buffer_load_dwordx4 v[108:111], v6, s[8:11], s88 offen offset:0 sc1
    buffer_load_dwordx4 v[112:115], v6, s[8:11], s88 offen offset:256 sc1
    buffer_load_dwordx4 v[116:119], v6, s[8:11], s88 offen offset:512 sc1
    buffer_load_dwordx4 v[120:123], v6, s[8:11], s88 offen offset:768 sc1
    buffer_load_dwordx4 v[124:127], v6, s[8:11], s88 offen offset:1024 sc1
    buffer_load_dwordx4 v[128:131], v6, s[8:11], s88 offen offset:1280 sc1
    buffer_load_dwordx4 v[132:135], v6, s[8:11], s88 offen offset:1536 sc1
    buffer_load_dwordx4 v[136:139], v6, s[8:11], s88 offen offset:1792 sc1
    buffer_load_dwordx2 v[236:237], v7, s[8:11], s87 offen offset:0 sc1
    buffer_load_dwordx2 v[238:239], v7, s[8:11], s87 offen offset:512 sc1
    buffer_load_dwordx2 v[240:241], v7, s[8:11], s87 offen offset:1024 sc1
    buffer_load_dwordx2 v[242:243], v7, s[8:11], s87 offen offset:1536 sc1
    s_waitcnt vmcnt(0)
    v_max3_u32 v2, v108, v112, v116
    v_max3_u32 v2, v2, v120, v124
    v_max3_u32 v2, v2, v128, v132
    v_max_u32 v2, v2, v136
    v_cmp_eq_u32 vcc, -1, v2
    s_cbranch_vccz pollkm_ok_165
    s_sub_u32 s77, s77, 1
    s_cbranch_scc0 pollkm_164
    s_mov_b32 s77, 0
pollkm_ok_165:
    v_mfma_f32_32x32x16_bf16 v[172:187], v[108:111], v[12:15], 0
    v_mfma_f32_32x32x16_bf16 v[156:171], v[112:115], v[16:19], 0
    v_mfma_f32_32x32x16_bf16 v[172:187], v[116:119], v[20:23], v[172:187]
    v_mfma_f32_32x32x16_bf16 v[156:171], v[120:123], v[24:27], v[156:171]
    v_mfma_f32_32x32x16_bf16 v[172:187], v[124:127], v[28:31], v[172:187]
    v_mfma_f32_32x32x16_bf16 v[156:171], v[128:131], v[32:35], v[156:171]
    v_mfma_f32_32x32x16_bf16 v[172:187], v[132:135], v[36:39], v[172:187]
    v_mfma_f32_32x32x16_bf16 v[156:171], v[136:139], v[40:43], v[156:171]
    v_max3_u32 v3, v236, v238, v240
    v_max_u32 v3, v3, v242
    v_cmp_eq_u32 vcc, -1, v3
    s_cbranch_vccz at_v_166
    buffer_load_dwordx2 v[236:237], v7, s[8:11], s87 offen offset:0 sc1
    buffer_load_dwordx2 v[238:239], v7, s[8:11], s87 offen offset:512 sc1
    buffer_load_dwordx2 v[240:241], v7, s[8:11], s87 offen offset:1024 sc1
    buffer_load_dwordx2 v[242:243], v7, s[8:11], s87 offen offset:1536 sc1
at_v_166:
    s_mov_b64 s[2:3], vcc
    s_add_u32 s86, s86, 8
    s_mov_b32 s94, 0x5ffffff0
    s_cmp_ge_u32 s86, 64
    s_cbranch_scc1 at_nf_167
    s_add_u32 s93, s93, 1
    s_cmp_lg_u32 s58, 0
    s_cbranch_scc1 at_f_168
    s_cmp_eq_u32 s92, 2097216
    s_cbranch_scc1 at_rb_170
    s_max_u32 s88, s86, 2
    s_sub_u32 s88, s88, 2
    s_and_b32 s88, s88, -4
pollrb_171:
    buffer_load_dword v2, off, s[12:15], s88 offset:160 sc1
    buffer_load_dword v3, off, s[12:15], 0 offset:220 sc1
    s_waitcnt vmcnt(0)
    v_cmp_ne_u32 vcc, 2097216, v2
    s_cbranch_vccz pollrb_ok_172
    s_sub_u32 s77, s77, 1
    s_cbranch_scc0 pollrb_171
    s_mov_b32 s77, 0
pollrb_ok_172:
    v_readfirstlane_b32 s92, v3
at_rb_170:
    v_mov_b32 v2, s93
    ds_write_b32 v9, v2
at_f_168:
    ds_read_b32 v2, v9
    s_waitcnt lgkmcnt(0)
    v_cmp_gt_u32 vcc, s93, v2
    s_cbranch_vccz at_d_169
    s_sub_u32 s77, s77, 1
    s_cbranch_scc0 at_f_168
    s_mov_b32 s77, 0
at_d_169:
    s_lshl_b32 s94, s86, 2
    s_add_u32 s94, s94, s75
    s_lshl_b32 s94, s94, 3
    s_add_u32 s94, s94, s58
    s_lshl_b32 s94, s94, 13
    s_add_u32 s88, s94, 0x0
    buffer_load_dwordx4 v[12:15], v5, s[8:11], s88 offen offset:0 sc1
    buffer_load_dwordx4 v[16:19], v5, s[8:11], s88 offen offset:1024 sc1
    buffer_load_dwordx4 v[20:23], v5, s[8:11], s88 offen offset:2048 sc1
    buffer_load_dwordx4 v[24:27], v5, s[8:11], s88 offen offset:3072 sc1
    s_add_u32 s88, s88, 4096
    buffer_load_dwordx4 v[28:31], v5, s[8:11], s88 offen offset:0 sc1
    buffer_load_dwordx4 v[32:35], v5, s[8:11], s88 offen offset:1024 sc1
    buffer_load_dwordx4 v[36:39], v5, s[8:11], s88 offen offset:2048 sc1
    buffer_load_dwordx4 v[40:43], v5, s[8:11], s88 offen offset:3072 sc1
    s_add_u32 s88, s94, 0x1000000
    buffer_load_dwordx4 v[44:47], v5, s[8:11], s88 offen offset:0 sc1
    buffer_load_dwordx4 v[48:51], v5, s[8:11], s88 offen offset:1024 sc1
    buffer_load_dwordx4 v[52:55], v5, s[8:11], s88 offen offset:2048 sc1
    buffer_load_dwordx4 v[56:59], v5, s[8:11], s88 offen offset:3072 sc1
    s_add_u32 s88, s88, 4096
    buffer_load_dwordx4 v[60:63], v5, s[8:11], s88 offen offset:0 sc1
    buffer_load_dwordx4 v[64:67], v5, s[8:11], s88 offen offset:1024 sc1
    buffer_load_dwordx4 v[68:71], v5, s[8:11], s88 offen offset:2048 sc1
    buffer_load_dwordx4 v[72:75], v5, s[8:11], s88 offen offset:3072 sc1
at_nf_167:
    s_nop 2
    v_pk_add_f32 v[156:157], v[156:157], v[172:173]
    v_pk_add_f32 v[158:159], v[158:159], v[174:175]
    v_max3_f32 v2, v244, v155, v156
    v_max3_f32 v2, v2, v157, v158
    v_max_f32 v2, v2, v159
    v_mov_b32 v3, v2
    s_nop 1
    v_permlane32_swap_b32 v2, v3
    v_max_f32 v2, v2, v3
    v_mul_f32 v2, s89, v2
    v_fma_f32 v140, v140, s89, -v2
    v_fma_f32 v141, v141, s89, -v2
    v_exp_f32 v140, v140
    v_exp_f32 v141, v141
    v_fma_f32 v142, v142, s89, -v2
    v_fma_f32 v143, v143, s89, -v2
    v_exp_f32 v142, v142
    v_exp_f32 v143, v143
    v_cvt_pk_bf16_f32 v244, v140, v141
    v_fma_f32 v144, v144, s89, -v2
    v_fma_f32 v145, v145, s89, -v2
    v_exp_f32 v144, v144
    v_exp_f32 v145, v145
    v_cvt_pk_bf16_f32 v245, v142, v143
    v_fma_f32 v146, v146, s89, -v2
    v_fma_f32 v147, v147, s89, -v2
    v_exp_f32 v146, v146
    v_exp_f32 v147, v147
    v_cvt_pk_bf16_f32 v246, v144, v145
    v_fma_f32 v148, v148, s89, -v2
    v_fma_f32 v149, v149, s89, -v2
    v_exp_f32 v148, v148
    v_exp_f32 v149, v149
    v_cvt_pk_bf16_f32 v247, v146, v147
    v_fma_f32 v150, v150, s89, -v2
    v_fma_f32 v151, v151, s89, -v2
    v_exp_f32 v150, v150
    v_exp_f32 v151, v151
    v_cvt_pk_bf16_f32 v248, v148, v149
    v_mfma_f32_32x32x16_bf16 v[172:187], v[76:79], v[244:247], 0
    v_fma_f32 v152, v152, s89, -v2
    v_fma_f32 v153, v153, s89, -v2
    v_exp_f32 v152, v152
    v_exp_f32 v153, v153
    v_cvt_pk_bf16_f32 v249, v150, v151
    v_mfma_f32_32x32x16_bf16 v[188:203], v[84:87], v[244:247], 0
    v_fma_f32 v154, v154, s89, -v2
    v_fma_f32 v155, v155, s89, -v2
    v_exp_f32 v154, v154
    v_exp_f32 v155, v155
    v_cvt_pk_bf16_f32 v250, v152, v153
    v_mfma_f32_32x32x16_bf16 v[204:219], v[92:95], v[244:247], 0
    v_fma_f32 v156, v156, s89, -v2
    v_fma_f32 v157, v157, s89, -v2
    v_exp_f32 v156, v156
    v_exp_f32 v157, v157
    v_cvt_pk_bf16_f32 v251, v154, v155
    v_mfma_f32_32x32x16_bf16 v[220:235], v[100:103], v[244:247], 0
    v_fma_f32 v158, v158, s89, -v2
    v_fma_f32 v159, v159, s89, -v2
    v_exp_f32 v158, v158
    v_exp_f32 v159, v159
    v_cvt_pk_bf16_f32 v252, v156, v157
    v_add_f32 v2, v140, v141
    v_cvt_pk_bf16_f32 v253, v158, v159
    v_mfma_f32_32x32x16_bf16 v[172:187], v[80:83], v[248:251], v[172:187]
    v_add_f32 v2, v2, v142
    v_add_f32 v2, v2, v143
    v_add_f32 v2, v2, v144
    v_add_f32 v2, v2, v145
    v_add_f32 v2, v2, v146
    v_mfma_f32_32x32x16_bf16 v[188:203], v[88:91], v[248:251], v[188:203]
    v_add_f32 v2, v2, v147
    v_add_f32 v2, v2, v148
    v_add_f32 v2, v2, v149
    v_add_f32 v2, v2, v150
    v_add_f32 v2, v2, v151
    v_mfma_f32_32x32x16_bf16 v[204:219], v[96:99], v[248:251], v[204:219]
    v_add_f32 v2, v2, v152
    v_add_f32 v2, v2, v153
    v_add_f32 v2, v2, v154
    v_add_f32 v2, v2, v155
    v_add_f32 v2, v2, v156
    v_mfma_f32_32x32x16_bf16 v[220:235], v[104:107], v[248:251], v[220:235]
    v_add_f32 v2, v2, v157
    v_add_f32 v2, v2, v158
    v_add_f32 v2, v2, v159
    s_cmp_eq_u64 s[2:3], 0
    s_cbranch_scc1 at_vok_173
    s_waitcnt vmcnt(0)
    v_max3_u32 v3, v236, v238, v240
    v_max_u32 v3, v3, v242
    v_cmp_eq_u32 vcc, -1, v3
    s_cbranch_vccz pollvm_ok_175
pollvm_174:
    buffer_load_dwordx2 v[236:237], v7, s[8:11], s87 offen offset:0 sc1
    buffer_load_dwordx2 v[238:239], v7, s[8:11], s87 offen offset:512 sc1
    buffer_load_dwordx2 v[240:241], v7, s[8:11], s87 offen offset:1024 sc1
    buffer_load_dwordx2 v[242:243], v7, s[8:11], s87 offen offset:1536 sc1
    s_waitcnt vmcnt(0)
    v_max3_u32 v3, v236, v238, v240
    v_max_u32 v3, v3, v242
    v_cmp_eq_u32 vcc, -1, v3
    s_cbranch_vccz pollvm_ok_175
    s_sub_u32 s77, s77, 1
    s_cbranch_scc0 pollvm_174
    s_mov_b32 s77, 0
pollvm_ok_175:
at_vok_173:
    v_mfma_f32_32x32x8_bf16 v[172:187], v[236:237], v[252:253], v[172:187]
    v_mov_b32 v3, v2
    s_add_u32 s87, s90, 0x3000000
    v_mfma_f32_32x32x8_bf16 v[188:203], v[238:239], v[252:253], v[188:203]
    v_permlane32_swap_b32 v2, v3
    v_add_f32 v2, v2, v3
    v_rcp_f32 v2, v2
    v_mfma_f32_32x32x8_bf16 v[204:219], v[240:241], v[252:253], v[204:219]
    v_mfma_f32_32x32x8_bf16 v[220:235], v[242:243], v[252:253], v[220:235]
    s_nop 3
    v_pk_mul_f32 v[172:173], v[172:173], v[2:3] op_sel_hi:[1,0]
    v_pk_mul_f32 v[174:175], v[174:175], v[2:3] op_sel_hi:[1,0]
    v_pk_mul_f32 v[176:177], v[176:177], v[2:3] op_sel_hi:[1,0]
    v_pk_mul_f32 v[178:179], v[178:179], v[2:3] op_sel_hi:[1,0]
    v_cvt_pk_bf16_f32 v108, v172, v173
    v_cvt_pk_bf16_f32 v109, v174, v175
    v_cvt_pk_bf16_f32 v110, v176, v177
    v_cvt_pk_bf16_f32 v111, v178, v179
    buffer_store_dwordx4 v[108:111], v5, s[8:11], s87 offen offset:0 sc1
    v_pk_mul_f32 v[180:181], v[180:181], v[2:3] op_sel_hi:[1,0]
    v_pk_mul_f32 v[182:183], v[182:183], v[2:3] op_sel_hi:[1,0]
    v_pk_mul_f32 v[184:185], v[184:185], v[2:3] op_sel_hi:[1,0]
    v_pk_mul_f32 v[186:187], v[186:187], v[2:3] op_sel_hi:[1,0]
    v_cvt_pk_bf16_f32 v112, v180, v181
    v_cvt_pk_bf16_f32 v113, v182, v183
    v_cvt_pk_bf16_f32 v114, v184, v185
    v_cvt_pk_bf16_f32 v115, v186, v187
    buffer_store_dwordx4 v[112:115], v5, s[8:11], s87 offen offset:1024 sc1
    v_pk_mul_f32 v[188:189], v[188:189], v[2:3] op_sel_hi:[1,0]
    v_pk_mul_f32 v[190:191], v[190:191], v[2:3] op_sel_hi:[1,0]
    v_pk_mul_f32 v[192:193], v[192:193], v[2:3] op_sel_hi:[1,0]
    v_pk_mul_f32 v[194:195], v[194:195], v[2:3] op_sel_hi:[1,0]
    v_cvt_pk_bf16_f32 v116, v188, v189
    v_cvt_pk_bf16_f32 v117, v190, v191
    v_cvt_pk_bf16_f32 v118, v192, v193
    v_cvt_pk_bf16_f32 v119, v194, v195
    buffer_store_dwordx4 v[116:119], v5, s[8:11], s87 offen offset:2048 sc1
    v_pk_mul_f32 v[196:197], v[196:197], v[2:3] op_sel_hi:[1,0]
    v_pk_mul_f32 v[198:199], v[198:199], v[2:3] op_sel_hi:[1,0]
    v_pk_mul_f32 v[200:201], v[200:201], v[2:3] op_sel_hi:[1,0]
    v_pk_mul_f32 v[202:203], v[202:203], v[2:3] op_sel_hi:[1,0]
    v_cvt_pk_bf16_f32 v120, v196, v197
    v_cvt_pk_bf16_f32 v121, v198, v199
    v_cvt_pk_bf16_f32 v122, v200, v201
    v_cvt_pk_bf16_f32 v123, v202, v203
    buffer_store_dwordx4 v[120:123], v5, s[8:11], s87 offen offset:3072 sc1
    v_pk_mul_f32 v[204:205], v[204:205], v[2:3] op_sel_hi:[1,0]
    v_pk_mul_f32 v[206:207], v[206:207], v[2:3] op_sel_hi:[1,0]
    v_pk_mul_f32 v[208:209], v[208:209], v[2:3] op_sel_hi:[1,0]
    v_pk_mul_f32 v[210:211], v[210:211], v[2:3] op_sel_hi:[1,0]
    v_cvt_pk_bf16_f32 v124, v204, v205
    v_cvt_pk_bf16_f32 v125, v206, v207
    v_cvt_pk_bf16_f32 v126, v208, v209
    v_cvt_pk_bf16_f32 v127, v210, v211
    s_add_u32 s87, s87, 4096
    buffer_store_dwordx4 v[124:127], v5, s[8:11], s87 offen offset:0 sc1
    v_pk_mul_f32 v[212:213], v[212:213], v[2:3] op_sel_hi:[1,0]
    v_pk_mul_f32 v[214:215], v[214:215], v[2:3] op_sel_hi:[1,0]
    v_pk_mul_f32 v[216:217], v[216:217], v[2:3] op_sel_hi:[1,0]
    v_pk_mul_f32 v[218:219], v[218:219], v[2:3] op_sel_hi:[1,0]
    v_cvt_pk_bf16_f32 v128, v212, v213
    v_cvt_pk_bf16_f32 v129, v214, v215
    v_cvt_pk_bf16_f32 v130, v216, v217
    v_cvt_pk_bf16_f32 v131, v218, v219
    buffer_store_dwordx4 v[128:131], v5, s[8:11], s87 offen offset:1024 sc1
    v_pk_mul_f32 v[220:221], v[220:221], v[2:3] op_sel_hi:[1,0]
    v_pk_mul_f32 v[222:223], v[222:223], v[2:3] op_sel_hi:[1,0]
    v_pk_mul_f32 v[224:225], v[224:225], v[2:3] op_sel_hi:[1,0]
    v_pk_mul_f32 v[226:227], v[226:227], v[2:3] op_sel_hi:[1,0]
    v_cvt_pk_bf16_f32 v132, v220, v221
    v_cvt_pk_bf16_f32 v133, v222, v223
    v_cvt_pk_bf16_f32 v134, v224, v225
    v_cvt_pk_bf16_f32 v135, v226, v227
    buffer_store_dwordx4 v[132:135], v5, s[8:11], s87 offen offset:2048 sc1
    v_pk_mul_f32 v[228:229], v[228:229], v[2:3] op_sel_hi:[1,0]
    v_pk_mul_f32 v[230:231], v[230:231], v[2:3] op_sel_hi:[1,0]
    v_pk_mul_f32 v[232:233], v[232:233], v[2:3] op_sel_hi:[1,0]
    v_pk_mul_f32 v[234:235], v[234:235], v[2:3] op_sel_hi:[1,0]
    v_cvt_pk_bf16_f32 v136, v228, v229
    v_cvt_pk_bf16_f32 v137, v230, v231
    v_cvt_pk_bf16_f32 v138, v232, v233
    v_cvt_pk_bf16_f32 v139, v234, v235
    buffer_store_dwordx4 v[136:139], v5, s[8:11], s87 offen offset:3072 sc1
    s_add_u32 s88, s94, 0x2000000
    buffer_load_dwordx4 v[76:79], v5, s[8:11], s88 offen offset:0 sc1
    buffer_load_dwordx4 v[80:83], v5, s[8:11], s88 offen offset:1024 sc1
    buffer_load_dwordx4 v[84:87], v5, s[8:11], s88 offen offset:2048 sc1
    buffer_load_dwordx4 v[88:91], v5, s[8:11], s88 offen offset:3072 sc1
    s_add_u32 s88, s88, 4096
    buffer_load_dwordx4 v[92:95], v5, s[8:11], s88 offen offset:0 sc1
    buffer_load_dwordx4 v[96:99], v5, s[8:11], s88 offen offset:1024 sc1
    buffer_load_dwordx4 v[100:103], v5, s[8:11], s88 offen offset:2048 sc1
    buffer_load_dwordx4 v[104:107], v5, s[8:11], s88 offen offset:3072 sc1
    s_bfe_u32 s87, s90, 0x3000d
    s_lshl_b32 s87, s87, 2
    s_bfe_u32 s88, s90, 0x80010
    s_lshl_b32 s88, s88, 7
    s_or_b32 s87, s87, s88
    s_add_u32 s87, s87, 0x5100000
    v_mov_b32 v2, 1
    s_waitcnt vmcnt(8)
    buffer_store_dword v2, off, s[8:11], s87
    s_cmp_lt_u32 s86, 64
    s_cbranch_scc1 at_loop_152
end_64:
    s_waitcnt vmcnt(0)
    s_endpgm
.section .rodata,"a"
.p2align 6
.amdhsa_kernel concat_heads__spectral_gfnet__memory_aug_recurrent_mem_tr__prompt_kernel
  .amdhsa_next_free_vgpr 256
  .amdhsa_next_free_sgpr 102
  .amdhsa_accum_offset 256
  .amdhsa_group_segment_fixed_size 0
  .amdhsa_kernarg_size 104
  .amdhsa_user_sgpr_count 2
  .amdhsa_user_sgpr_kernarg_segment_ptr 1
  .amdhsa_system_sgpr_workgroup_id_x 1
  .amdhsa_float_denorm_mode_32 3
  .amdhsa_float_denorm_mode_16_64 3
.end_amdhsa_kernel
```
